```python
import torch

def _softmax(x, axis=-1):
    return torch.softmax(x, dim=axis)
def _gelu(x):
    return torch.nn.functional.gelu(x, approximate="tanh")
def _silu(x):
    return torch.nn.functional.silu(x)
def _sigmoid(x):
    return torch.sigmoid(x)
def _layernorm(x, axis=-1, eps=1e-5):
    m = x.mean(dim=axis, keepdim=True)
    v = x.var(dim=axis, keepdim=True, unbiased=False)
    return (x - m) / torch.sqrt(v + eps)
def _scatter_add(tgt, idx, src, axis=0):
    return tgt.clone().index_add_(axis, idx, src)
def _segment_sum(src, seg, n):
    out = torch.zeros((n,) + src.shape[1:], dtype=src.dtype)
    return out.index_add_(0, seg, src)
def _pad(x, pw):
    flat = tuple(v for pair in reversed(pw) for v in pair)
    return torch.nn.functional.pad(x, flat)

kernel_name = 'recurrent_scan__gqa_block_cached__moe_arch_mod__prompt'

def setup_inputs():

    _w = (lambda a: (lambda t: t.to(torch.bfloat16) if t.is_floating_point() else t)(torch.as_tensor(a)))
    def _A_setup():
        B, Sq, D = 1, 2048, 576
        Hq, Hkv, Sk, Dh = 32, 16, 2048, 128
        assert Hq % Hkv == 0, (Hq, Hkv)
        return {
            "x": _w((lambda *s: torch.randn(*s, dtype=torch.bfloat16) * 0.05)(B, Sq, D)),
            "k_cache": _w((lambda *s: torch.randn(*s, dtype=torch.bfloat16) * 0.8)(B, Hkv, Sk, Dh)),
            "v_cache": _w((lambda *s: torch.randn(*s, dtype=torch.bfloat16) * 0.2)(B, Hkv, Sk, Dh)),
            "wq": _w((lambda *s: torch.randn(*s, dtype=torch.bfloat16) * 0.8)(D, Hq * Dh) * (D ** -0.5)),
            "wo": _w((lambda *s: torch.randn(*s, dtype=torch.bfloat16) * 0.2)(Hq * Dh, D) * ((Hq * Dh) ** -0.5)),
        }
    _A_in = _A_setup()

    def _B_setup():
        B, S, D, F, C = 1, 2048, 576, 4608, 8
        return {
            "x": _w((lambda *s: torch.randn(*s, dtype=torch.bfloat16) * 0.05)(B, S, D)),
            "w_r": _w((lambda *s: torch.randn(*s, dtype=torch.bfloat16) * 0.2)(D)),
            "w_gate": _w((lambda *s: torch.randn(*s, dtype=torch.bfloat16) * 0.1)(D, F)),
            "w_up": _w((lambda *s: torch.randn(*s, dtype=torch.bfloat16) * 0.1)(D, F)),
            "w_down": _w((lambda *s: torch.randn(*s, dtype=torch.bfloat16) * 0.1)(F, D)),
        }
    _B_in = _B_setup()

    return {
        "A_x": _A_in["x"],
        "A_k_cache": _A_in["k_cache"],
        "A_v_cache": _A_in["v_cache"],
        "A_wq": _A_in["wq"],
        "A_wo": _A_in["wo"],
        "B_x": _B_in["x"],
        "B_w_r": _B_in["w_r"],
        "B_w_gate": _B_in["w_gate"],
        "B_w_up": _B_in["w_up"],
        "B_w_down": _B_in["w_down"],
    }

def reference(A_x, A_k_cache, A_v_cache, A_wq, A_wo, B_x, B_w_r, B_w_gate, B_w_up, B_w_down):
    def _A_ref(x, k_cache, v_cache, wq, wo):
        B, Sq, D = x.shape
        Hq, Dh = 32, 128
        Hkv = k_cache.shape[1]
        rep = Hq // Hkv
        q = (lambda x, *d: x.permute(*d))((x @ wq).reshape(B, Sq, Hq, Dh), 0, 2, 1, 3)
        k = (lambda x, n, axis: torch.repeat_interleave(x, n, dim=axis))(k_cache, rep, axis=1)
        v = (lambda x, n, axis: torch.repeat_interleave(x, n, dim=axis))(v_cache, rep, axis=1)
        scores = torch.einsum("bhqd,bhkd->bhqk", q, k) * (Dh ** -0.5)
        p = _softmax(scores, axis=-1)
        o = torch.einsum("bhqk,bhkd->bhqd", p, v)
        return (lambda x, *d: x.permute(*d))(o, 0, 2, 1, 3).reshape(B, Sq, Hq * Dh) @ wo

    def _B_ref(x, w_r, w_gate, w_up, w_down):
        B, S, D = x.shape
        C = 8
        r = x @ w_r
        idx = torch.argsort(-r, axis=-1)[:, :C]
        idx_e = (lambda x, n, axis: torch.repeat_interleave(x, n, dim=axis))(idx.reshape(B, C, 1), D, axis=2)
        x_sel = (lambda x, i, axis: torch.take_along_dim(x, i, dim=axis))(x, idx_e, axis=1)
        g = _silu(x_sel @ w_gate)
        u = x_sel @ w_up
        y = (g * u) @ w_down
        r_sel = _sigmoid((lambda x, i, axis: torch.take_along_dim(x, i, dim=axis))(r, idx, axis=1))
        y = y * r_sel.reshape(B, C, 1)
        b_off = (torch.arange(B) * S).reshape(B, 1)
        flat_idx = (idx + b_off).reshape(B * C)
        zero = (x * 0.0).reshape(B * S, D)
        upd = _scatter_add(zero, flat_idx, y.reshape(B * C, D), axis=0)
        return x + upd.reshape(B, S, D)

    x = A_x
    xn = _layernorm(x, axis=-1)
    s = _A_ref(xn, A_k_cache, A_v_cache, A_wq, A_wo)
    g = _silu(_B_ref(xn, B_w_r, B_w_gate, B_w_up, B_w_down))
    return x + s * g
```

```asm
; @launch grid=(256,1,1) block=(256,1,1) lds=163840
.amdgcn_target "amdgcn-amd-amdhsa--gfx950"
.text
.globl recurrent_scan__gqa_block_cached__moe_arch_mod__prompt_kernel
.p2align 8
.type recurrent_scan__gqa_block_cached__moe_arch_mod__prompt_kernel,@function
recurrent_scan__gqa_block_cached__moe_arch_mod__prompt_kernel:
s_cmp_ge_u32 s2, 256
s_cbranch_scc1 K_END
s_getpc_b64 s[96:97]
v_lshlrev_b32 v7, 5, v0
global_load_dword a4, v7, s[96:97]
s_load_dwordx8 s[88:95], s[0:1], 0
s_load_dwordx2 s[86:87], s[0:1], 48
s_load_dwordx4 s[4:7], s[0:1], 88
v_and_b32 v1, 63, v0
v_lshrrev_b32 v5, 6, v0
s_bfe_u32 s35, s2, 0x20001
s_bfe_u32 s36, s2, 0x20003
v_readfirstlane_b32 s32, v5
s_lshl_b32 s33, s35, 2
s_add_u32 s33, s33, s36
s_and_b32 s34, s2, 1
s_lshl_b32 s34, s34, 3
s_lshr_b32 s46, s2, 5
s_add_u32 s34, s34, s46
s_lshl_b32 s46, s34, 7
s_lshl_b32 s47, s33, 3
s_add_u32 s3, s46, s47
v_lshrrev_b32 v8, 5, v0
v_add_u32 v8, s3, v8
v_and_b32 v9, 31, v0
v_mul_u32_u24 v11, 12, v9
v_mul_u32_u24 v10, 0x480, v8
v_add_u32 v10, v10, v11
v_lshrrev_b32 v5, 3, v1
v_and_b32 v6, 7, v1
v_xor_b32 v6, v6, v5
v_mul_u32_u24 v5, 0x480, v5
v_lshl_add_u32 v144, v6, 4, v5
v_add_u32 v145, 8192, v144
v_add_u32 v146, 18432, v144
v_add_u32 v147, 26624, v144
s_lshl_b32 s47, s32, 5
s_add_u32 s55, s46, s47
s_mul_i32 s43, s55, 1152
s_lshl_b32 s37, s32, 12
s_lshr_b32 s46, s35, 1
s_lshl_b32 s47, s46, 11
s_or_b32 s45, s37, s47
s_xor_b32 s85, s45, 2048
s_lshl_b32 s46, s46, 4
s_add_u32 s55, s55, s46
s_mov_b32 s26, 0x240000
s_mov_b32 s27, 0x00020000
s_waitcnt lgkmcnt(0)
s_mov_b32 s24, s88
s_and_b32 s25, s89, 0xffff
buffer_load_dwordx3 v[12:14], v10, s[24:27], 0 offen offset:0
buffer_load_dwordx3 v[16:18], v10, s[24:27], 0 offen offset:384
buffer_load_dwordx3 v[20:22], v10, s[24:27], 0 offen offset:768
s_mov_b32 s28, s86
s_and_b32 s29, s87, 0xffff
s_mov_b32 s30, 0x480
s_mov_b32 s31, 0x00020000
buffer_load_dwordx3 v[24:26], v11, s[28:31], 0 offen offset:0
buffer_load_dwordx3 v[28:30], v11, s[28:31], 0 offen offset:384
buffer_load_dwordx3 v[32:34], v11, s[28:31], 0 offen offset:768
s_add_u32 m0, s45, 32768
s_nop 0
buffer_load_dwordx4 v144, s[24:27], s43 offen offset:0 lds
buffer_load_dwordx4 v145, s[24:27], s43 offen offset:1024 lds
s_add_u32 m0, s85, 32768
s_nop 0
buffer_load_dwordx4 v146, s[24:27], s43 offen offset:0 lds
buffer_load_dwordx4 v147, s[24:27], s43 offen offset:1024 lds
s_add_u32 s43, s43, 128
s_mov_b32 s16, s94
s_and_b32 s17, s95, 0xffff
s_mov_b32 s18, 0x480000
s_mov_b32 s19, 0x00020000
v_lshrrev_b32 v5, 5, v1
v_and_b32 v6, 31, v1
v_lshlrev_b32 v7, 1, v5
v_xor_b32 v6, v6, v7
v_lshlrev_b32 v6, 4, v6
v_lshl_add_u32 v136, v5, 13, v6
s_lshl_b32 s42, s33, 9
s_lshl_b32 s46, s32, 17
s_add_u32 s42, s42, s46
s_lshl_b32 s44, s32, 13
v_xor_b32 v137, 64, v136
v_add_u32 v137, 15360, v137
v_add_u32 v138, 30720, v136
v_xor_b32 v139, 64, v136
v_add_u32 v139, 46080, v139
v_xor_b32 v140, 128, v136
v_add_u32 v140, 65536, v140
v_xor_b32 v141, 192, v136
v_add_u32 v141, 80896, v141
v_xor_b32 v142, 128, v136
v_add_u32 v142, 96256, v142
v_xor_b32 v143, 192, v136
v_add_u32 v143, 111616, v143
s_add_u32 m0, s44, 0
s_nop 0
buffer_load_dwordx4 v136, s[16:19], s42 offen offset:0 lds
buffer_load_dwordx4 v137, s[16:19], s42 offen offset:1024 lds
buffer_load_dwordx4 v138, s[16:19], s42 offen offset:2048 lds
buffer_load_dwordx4 v139, s[16:19], s42 offen offset:3072 lds
s_getpc_b64 s[96:97]
PC_a:
s_sub_u32 s96, s96, PC_a-recurrent_scan__gqa_block_cached__moe_arch_mod__prompt_kernel
s_subb_u32 s97, s97, 0
s_lshr_b32 s46, s2, 3
s_lshl_b32 s46, s46, 2
s_add_u32 s46, s46, s32
s_min_u32 s46, s46, ((K_CODE_END-recurrent_scan__gqa_block_cached__moe_arch_mod__prompt_kernel)>>10)-1
s_lshl_b32 s46, s46, 10
v_lshlrev_b32 v7, 4, v1
v_add_u32 v7, s46, v7
global_load_dwordx4 a[0:3], v7, s[96:97]
s_load_dwordx2 s[68:69], s[0:1], 32
s_load_dwordx4 s[56:59], s[0:1], 56
s_load_dwordx4 s[64:67], s[0:1], 72
s_mov_b32 s100, 0
v_and_b32 v3, 15, v1
v_lshrrev_b32 v4, 4, v1
v_lshlrev_b32 v234, 4, v1
v_mov_b32 v255, 1
s_lshl_b32 s46, s33, 19
s_add_u32 s8, s90, s46
s_addc_u32 s9, s91, 0
s_and_b32 s9, s9, 0xffff
s_mov_b32 s10, 0x80000
s_mov_b32 s11, 0x00020000
s_add_u32 s12, s92, s46
s_addc_u32 s13, s93, 0
s_and_b32 s13, s13, 0xffff
s_mov_b32 s14, 0x80000
s_mov_b32 s15, 0x00020000
s_mov_b32 s20, s6
s_and_b32 s21, s7, 0xffff
s_mov_b32 s22, 0x4000000
s_mov_b32 s23, 0x00020000
v_bfe_u32 v250, v1, 2, 2
v_and_b32 v251, 3, v1
v_and_b32 v5, 1, v4
v_lshl_add_u32 v5, v5, 2, v250
s_lshl_b32 s46, s32, 1
v_xor_b32 v5, s46, v5
v_lshlrev_b32 v5, 5, v5
v_lshl_add_u32 v6, v4, 3, v250
v_lshl_add_u32 v5, v6, 9, v5
v_lshl_add_u32 v184, v251, 3, v5
v_xor_b32 v185, 32, v184
v_xor_b32 v186, 64, v184
v_xor_b32 v187, 96, v184
v_xor_b32 v188, 128, v184
v_xor_b32 v189, 160, v184
v_xor_b32 v190, 192, v184
v_xor_b32 v191, 224, v184
v_and_b32 v5, 7, v3
v_xor_b32 v5, v5, v4
v_lshlrev_b32 v5, 4, v5
v_lshl_add_u32 v5, v3, 7, v5
v_add_u32 v5, s37, v5
v_add_u32 v192, 0x8000, v5
v_xor_b32 v193, 64, v192
v_add_u32 v194, 0x18000, v184
v_add_u32 v195, 0x18000, v185
v_add_u32 v196, 0x18000, v186
v_add_u32 v197, 0x18000, v187
v_add_u32 v198, 0x18000, v188
v_add_u32 v199, 0x18000, v189
v_add_u32 v200, 0x18000, v190
v_add_u32 v201, 0x18000, v191
v_add_u32 v202, 0x18000, v192
v_add_u32 v203, 0x18000, v193
v_add_u32 v204, 0xc000, v184
v_add_u32 v205, 0xc000, v185
v_add_u32 v206, 0xc000, v186
v_add_u32 v207, 0xc000, v187
v_add_u32 v208, 0xc000, v188
v_add_u32 v209, 0xc000, v189
v_add_u32 v210, 0xc000, v190
v_add_u32 v211, 0xc000, v191
v_add_u32 v212, 0xc000, v192
v_add_u32 v213, 0xc000, v193
v_bfe_u32 v5, v1, 1, 1
v_bfe_u32 v6, v1, 5, 1
v_cmp_eq_u32 vcc, v5, v6
v_mov_b32 v7, 0x3f803f80
v_and_b32 v5, 1, v1
v_cndmask_b32 v7, 0, v7, vcc
v_accvgpr_write_b32 a208, v7
v_accvgpr_write_b32 a209, v7
v_accvgpr_write_b32 a210, v7
v_accvgpr_write_b32 a211, v7
v_mul_u32_u24 v5, 0xaaaa, v5
v_add_u32 v235, 0x4444, v5
v_accvgpr_write_b32 a248, 0
v_accvgpr_write_b32 a249, 0
v_accvgpr_write_b32 a250, 0
v_accvgpr_write_b32 a251, 0
v_accvgpr_write_b32 a252, 0
v_accvgpr_write_b32 a253, 0
v_accvgpr_write_b32 a254, 0
v_accvgpr_write_b32 a255, 0
s_lshl_b32 s46, s34, 2
s_add_u32 s47, s46, s35
s_lshl_b32 s47, s47, 2
s_add_u32 s47, s47, s32
s_lshl_b32 s54, s47, 7
s_add_u32 s54, s54, 0x250000
s_add_u32 s47, s46, s36
s_lshl_b32 s47, s47, 2
s_add_u32 s47, s47, s32
s_lshl_b32 s47, s47, 5
s_add_u32 s47, s47, s35
s_lshl_b32 s47, s47, 2
s_add_u32 s38, s47, 0x258000
s_add_u32 s46, s46, s32
s_lshl_b32 s46, s46, 5
s_add_u32 s46, s46, s33
s_lshl_b32 s46, s46, 2
s_add_u32 s39, s46, 0x260000
s_lshl_b32 s46, s36, 3
s_add_u32 s46, s46, s54
v_lshl_add_u32 v60, v1, 2, s46
v_mov_b32 v61, 0
v_writelane_b32 v60, s38, 2
v_writelane_b32 v60, s39, 3
s_mov_b32 s90, 0x3ae38e39
s_mov_b32 s91, 0x3727c5ac
s_mov_b32 s92, 0xffff0000
s_add_u32 m0, s44, 4096
s_nop 0
buffer_load_dwordx4 v140, s[16:19], s42 offen offset:0 lds
buffer_load_dwordx4 v141, s[16:19], s42 offen offset:1024 lds
buffer_load_dwordx4 v142, s[16:19], s42 offen offset:2048 lds
buffer_load_dwordx4 v143, s[16:19], s42 offen offset:3072 lds
s_add_u32 s42, s42, 524288
s_mov_b64 exec, 15
buffer_store_dword v61, v60, s[20:23], 0 offen sc0 sc1
s_mov_b64 exec, -1
s_waitcnt vmcnt(14)
v_lshlrev_b32 v40, 16, v12
v_and_b32 v41, s92, v12
v_lshlrev_b32 v42, 16, v13
v_and_b32 v43, s92, v13
v_lshlrev_b32 v44, 16, v14
v_and_b32 v45, s92, v14
v_lshlrev_b32 v46, 16, v16
v_and_b32 v47, s92, v16
v_lshlrev_b32 v48, 16, v17
v_and_b32 v49, s92, v17
v_lshlrev_b32 v50, 16, v18
v_and_b32 v51, s92, v18
s_add_u32 m0, s45, 131072
v_lshlrev_b32 v52, 16, v20
buffer_load_dwordx4 v144, s[24:27], s43 offen offset:0 lds
v_and_b32 v53, s92, v20
v_lshlrev_b32 v54, 16, v21
v_and_b32 v55, s92, v21
v_lshlrev_b32 v56, 16, v22
v_and_b32 v57, s92, v22
v_pk_add_f32 v[64:65], v[40:41], v[42:43]
v_pk_add_f32 v[66:67], v[44:45], v[46:47]
v_pk_add_f32 v[64:65], v[64:65], v[48:49]
v_pk_add_f32 v[66:67], v[66:67], v[50:51]
v_pk_add_f32 v[64:65], v[64:65], v[52:53]
v_pk_add_f32 v[66:67], v[66:67], v[54:55]
v_pk_add_f32 v[64:65], v[64:65], v[56:57]
buffer_load_dwordx4 v145, s[24:27], s43 offen offset:1024 lds
v_pk_add_f32 v[64:65], v[64:65], v[66:67]
v_add_f32 v64, v64, v65
s_nop 1
v_add_f32_dpp v65, v64, v64 row_ror:8 row_mask:0xf bank_mask:0xf
s_nop 1
v_add_f32_dpp v64, v65, v65 row_ror:4 row_mask:0xf bank_mask:0xf
s_nop 1
v_add_f32_dpp v65, v64, v64 row_ror:2 row_mask:0xf bank_mask:0xf
s_nop 1
v_add_f32_dpp v64, v65, v65 row_ror:1 row_mask:0xf bank_mask:0xf
v_mov_b32 v65, v64
s_nop 1
v_permlane16_swap_b32 v64, v65
v_add_f32 v64, v64, v65
v_mul_f32 v64, s90, v64
v_pk_add_f32 v[72:73], v[40:41], v[64:65] op_sel_hi:[1,0] neg_lo:[0,1] neg_hi:[0,1]
s_add_u32 m0, s85, 131072
v_pk_add_f32 v[74:75], v[42:43], v[64:65] op_sel_hi:[1,0] neg_lo:[0,1] neg_hi:[0,1]
buffer_load_dwordx4 v146, s[24:27], s43 offen offset:0 lds
v_pk_add_f32 v[76:77], v[44:45], v[64:65] op_sel_hi:[1,0] neg_lo:[0,1] neg_hi:[0,1]
v_pk_add_f32 v[78:79], v[46:47], v[64:65] op_sel_hi:[1,0] neg_lo:[0,1] neg_hi:[0,1]
v_pk_add_f32 v[80:81], v[48:49], v[64:65] op_sel_hi:[1,0] neg_lo:[0,1] neg_hi:[0,1]
v_pk_add_f32 v[82:83], v[50:51], v[64:65] op_sel_hi:[1,0] neg_lo:[0,1] neg_hi:[0,1]
v_pk_add_f32 v[84:85], v[52:53], v[64:65] op_sel_hi:[1,0] neg_lo:[0,1] neg_hi:[0,1]
v_pk_add_f32 v[86:87], v[54:55], v[64:65] op_sel_hi:[1,0] neg_lo:[0,1] neg_hi:[0,1]
v_pk_add_f32 v[88:89], v[56:57], v[64:65] op_sel_hi:[1,0] neg_lo:[0,1] neg_hi:[0,1]
v_pk_mul_f32 v[66:67], v[72:73], v[72:73]
v_pk_mul_f32 v[68:69], v[74:75], v[74:75]
v_pk_fma_f32 v[66:67], v[76:77], v[76:77], v[66:67]
v_pk_fma_f32 v[68:69], v[78:79], v[78:79], v[68:69]
v_pk_fma_f32 v[66:67], v[80:81], v[80:81], v[66:67]
buffer_load_dwordx4 v147, s[24:27], s43 offen offset:1024 lds
v_pk_fma_f32 v[68:69], v[82:83], v[82:83], v[68:69]
v_pk_fma_f32 v[66:67], v[84:85], v[84:85], v[66:67]
v_pk_fma_f32 v[68:69], v[86:87], v[86:87], v[68:69]
v_pk_fma_f32 v[66:67], v[88:89], v[88:89], v[66:67]
v_pk_add_f32 v[66:67], v[66:67], v[68:69]
v_add_f32 v69, v66, v67
v_cvt_pk_bf16_f32 v64, v64, v64
v_lshlrev_b32 v64, 16, v64
v_pk_add_f32 v[40:41], v[40:41], v[64:65] op_sel_hi:[1,0] neg_lo:[0,1] neg_hi:[0,1]
v_cvt_pk_bf16_f32 v12, v40, v41
v_add_f32_dpp v68, v69, v69 row_ror:8 row_mask:0xf bank_mask:0xf
s_add_u32 s43, s43, 128
s_add_u32 m0, s44, 98304
v_pk_add_f32 v[42:43], v[42:43], v[64:65] op_sel_hi:[1,0] neg_lo:[0,1] neg_hi:[0,1]
buffer_load_dwordx4 v136, s[16:19], s42 offen offset:0 lds
v_cvt_pk_bf16_f32 v13, v42, v43
v_add_f32_dpp v69, v68, v68 row_ror:4 row_mask:0xf bank_mask:0xf
v_pk_add_f32 v[44:45], v[44:45], v[64:65] op_sel_hi:[1,0] neg_lo:[0,1] neg_hi:[0,1]
v_cvt_pk_bf16_f32 v14, v44, v45
v_add_f32_dpp v68, v69, v69 row_ror:2 row_mask:0xf bank_mask:0xf
v_pk_add_f32 v[46:47], v[46:47], v[64:65] op_sel_hi:[1,0] neg_lo:[0,1] neg_hi:[0,1]
v_cvt_pk_bf16_f32 v16, v46, v47
v_add_f32_dpp v69, v68, v68 row_ror:1 row_mask:0xf bank_mask:0xf
v_mov_b32 v68, v69
v_pk_add_f32 v[48:49], v[48:49], v[64:65] op_sel_hi:[1,0] neg_lo:[0,1] neg_hi:[0,1]
v_cvt_pk_bf16_f32 v17, v48, v49
v_permlane16_swap_b32 v69, v68
buffer_load_dwordx4 v137, s[16:19], s42 offen offset:1024 lds
v_add_f32 v69, v69, v68
v_mul_f32 v69, s90, v69
v_cvt_pk_bf16_f32 v69, v69, v69
v_lshlrev_b32 v69, 16, v69
v_add_f32 v69, s91, v69
v_cvt_pk_bf16_f32 v69, v69, v69
v_lshlrev_b32 v69, 16, v69
v_sqrt_f32 v69, v69
v_pk_add_f32 v[50:51], v[50:51], v[64:65] op_sel_hi:[1,0] neg_lo:[0,1] neg_hi:[0,1]
v_cvt_pk_bf16_f32 v18, v50, v51
v_cvt_pk_bf16_f32 v65, v69, v69
v_lshlrev_b32 v65, 16, v65
buffer_load_dwordx4 v138, s[16:19], s42 offen offset:2048 lds
v_rcp_f32 v66, v65
v_pk_add_f32 v[52:53], v[52:53], v[64:65] op_sel_hi:[1,0] neg_lo:[0,1] neg_hi:[0,1]
v_cvt_pk_bf16_f32 v20, v52, v53
v_pk_add_f32 v[54:55], v[54:55], v[64:65] op_sel_hi:[1,0] neg_lo:[0,1] neg_hi:[0,1]
v_cvt_pk_bf16_f32 v21, v54, v55
v_pk_add_f32 v[56:57], v[56:57], v[64:65] op_sel_hi:[1,0] neg_lo:[0,1] neg_hi:[0,1]
v_cvt_pk_bf16_f32 v22, v56, v57
v_lshlrev_b32 v40, 16, v12
v_and_b32 v41, s92, v12
v_lshlrev_b32 v42, 16, v13
v_and_b32 v43, s92, v13
v_lshlrev_b32 v44, 16, v14
buffer_load_dwordx4 v139, s[16:19], s42 offen offset:3072 lds
v_and_b32 v45, s92, v14
v_lshlrev_b32 v46, 16, v16
v_and_b32 v47, s92, v16
v_lshlrev_b32 v48, 16, v17
v_and_b32 v49, s92, v17
v_lshlrev_b32 v50, 16, v18
v_and_b32 v51, s92, v18
v_lshlrev_b32 v52, 16, v20
v_and_b32 v53, s92, v20
v_lshlrev_b32 v54, 16, v21
v_and_b32 v55, s92, v21
s_add_u32 m0, s44, 102400
v_lshlrev_b32 v56, 16, v22
buffer_load_dwordx4 v140, s[16:19], s42 offen offset:0 lds
v_and_b32 v57, s92, v22
v_lshlrev_b32 v5, 3, v8
s_mov_b32 s46, 0x240000
s_mov_b32 exec_lo, 1
s_mov_b32 exec_hi, 1
buffer_store_dwordx2 v[64:65], v5, s[20:23], s46 offen sc0 sc1
s_mov_b64 exec, -1
v_mov_b32 v70, 0
s_waitcnt lgkmcnt(0)
s_waitcnt vmcnt(11)
s_barrier
ds_read_b128 a[192:195], v192 offset:0
ds_read_b128 a[196:199], v192 offset:2048
ds_read_b64_tr_b16 a[128:129], v184 offset:0
ds_read_b64_tr_b16 a[130:131], v184 offset:2048
ds_read_b64_tr_b16 a[132:133], v185 offset:0
ds_read_b64_tr_b16 a[134:135], v185 offset:2048
ds_read_b64_tr_b16 a[160:161], v184 offset:256
ds_read_b64_tr_b16 a[162:163], v184 offset:2304
ds_read_b64_tr_b16 a[164:165], v185 offset:256
ds_read_b64_tr_b16 a[166:167], v185 offset:2304
ds_read_b64_tr_b16 a[136:137], v186 offset:0
ds_read_b64_tr_b16 a[138:139], v186 offset:2048
ds_read_b64_tr_b16 a[140:141], v187 offset:0
ds_read_b64_tr_b16 a[142:143], v187 offset:2048
ds_read_b64_tr_b16 a[144:145], v188 offset:0
ds_read_b64_tr_b16 a[146:147], v188 offset:2048
ds_read_b64_tr_b16 a[148:149], v189 offset:0
ds_read_b64_tr_b16 a[150:151], v189 offset:2048
ds_read_b64_tr_b16 a[152:153], v190 offset:0
ds_read_b64_tr_b16 a[154:155], v190 offset:2048
ds_read_b64_tr_b16 a[156:157], v191 offset:0
ds_read_b64_tr_b16 a[158:159], v191 offset:2048
ds_read_b64_tr_b16 a[168:169], v186 offset:256
ds_read_b64_tr_b16 a[170:171], v186 offset:2304
ds_read_b64_tr_b16 a[172:173], v187 offset:256
ds_read_b64_tr_b16 a[174:175], v187 offset:2304
ds_read_b64_tr_b16 a[176:177], v188 offset:256
ds_read_b64_tr_b16 a[178:179], v188 offset:2304
ds_read_b64_tr_b16 a[180:181], v189 offset:256
ds_read_b64_tr_b16 a[182:183], v189 offset:2304
ds_read_b64_tr_b16 a[184:185], v190 offset:256
ds_read_b64_tr_b16 a[186:187], v190 offset:2304
ds_read_b64_tr_b16 a[188:189], v191 offset:256
ds_read_b64_tr_b16 a[190:191], v191 offset:2304
v_pk_mul_f32 v[72:73], v[40:41], v[66:67] op_sel_hi:[1,0]
v_pk_fma_f32 v[40:41], v[72:73], v[64:65], v[40:41] op_sel:[0,1,0] op_sel_hi:[1,1,1] neg_lo:[1,0,0] neg_hi:[1,0,0]
v_pk_fma_f32 v[72:73], v[40:41], v[66:67], v[72:73] op_sel_hi:[1,0,1]
v_cvt_pk_bf16_f32 v12, v72, v73
v_dot2_f32_bf16 v70, v12, v24, v70
v_pk_mul_f32 v[74:75], v[42:43], v[66:67] op_sel_hi:[1,0]
v_pk_fma_f32 v[42:43], v[74:75], v[64:65], v[42:43] op_sel:[0,1,0] op_sel_hi:[1,1,1] neg_lo:[1,0,0] neg_hi:[1,0,0]
v_pk_fma_f32 v[74:75], v[42:43], v[66:67], v[74:75] op_sel_hi:[1,0,1]
v_cvt_pk_bf16_f32 v13, v74, v75
buffer_load_dwordx4 v141, s[16:19], s42 offen offset:1024 lds
v_dot2_f32_bf16 v70, v13, v25, v70
v_pk_mul_f32 v[76:77], v[44:45], v[66:67] op_sel_hi:[1,0]
v_pk_fma_f32 v[44:45], v[76:77], v[64:65], v[44:45] op_sel:[0,1,0] op_sel_hi:[1,1,1] neg_lo:[1,0,0] neg_hi:[1,0,0]
v_pk_fma_f32 v[76:77], v[44:45], v[66:67], v[76:77] op_sel_hi:[1,0,1]
v_cvt_pk_bf16_f32 v14, v76, v77
v_dot2_f32_bf16 v70, v14, v26, v70
buffer_store_dwordx3 v[12:14], v10, s[20:23], 0 offen offset:0 sc0 sc1
v_pk_mul_f32 v[78:79], v[46:47], v[66:67] op_sel_hi:[1,0]
v_pk_fma_f32 v[46:47], v[78:79], v[64:65], v[46:47] op_sel:[0,1,0] op_sel_hi:[1,1,1] neg_lo:[1,0,0] neg_hi:[1,0,0]
v_pk_fma_f32 v[78:79], v[46:47], v[66:67], v[78:79] op_sel_hi:[1,0,1]
v_cvt_pk_bf16_f32 v16, v78, v79
v_dot2_f32_bf16 v70, v16, v28, v70
v_pk_mul_f32 v[80:81], v[48:49], v[66:67] op_sel_hi:[1,0]
buffer_load_dwordx4 v142, s[16:19], s42 offen offset:2048 lds
v_pk_fma_f32 v[48:49], v[80:81], v[64:65], v[48:49] op_sel:[0,1,0] op_sel_hi:[1,1,1] neg_lo:[1,0,0] neg_hi:[1,0,0]
v_pk_fma_f32 v[80:81], v[48:49], v[66:67], v[80:81] op_sel_hi:[1,0,1]
v_cvt_pk_bf16_f32 v17, v80, v81
v_dot2_f32_bf16 v70, v17, v29, v70
v_pk_mul_f32 v[82:83], v[50:51], v[66:67] op_sel_hi:[1,0]
v_pk_fma_f32 v[50:51], v[82:83], v[64:65], v[50:51] op_sel:[0,1,0] op_sel_hi:[1,1,1] neg_lo:[1,0,0] neg_hi:[1,0,0]
v_pk_fma_f32 v[82:83], v[50:51], v[66:67], v[82:83] op_sel_hi:[1,0,1]
v_cvt_pk_bf16_f32 v18, v82, v83
v_dot2_f32_bf16 v70, v18, v30, v70
buffer_store_dwordx3 v[16:18], v10, s[20:23], 0 offen offset:384 sc0 sc1
v_pk_mul_f32 v[84:85], v[52:53], v[66:67] op_sel_hi:[1,0]
v_pk_fma_f32 v[52:53], v[84:85], v[64:65], v[52:53] op_sel:[0,1,0] op_sel_hi:[1,1,1] neg_lo:[1,0,0] neg_hi:[1,0,0]
v_pk_fma_f32 v[84:85], v[52:53], v[66:67], v[84:85] op_sel_hi:[1,0,1]
buffer_load_dwordx4 v143, s[16:19], s42 offen offset:3072 lds
s_add_u32 s42, s42, 524288
v_cvt_pk_bf16_f32 v20, v84, v85
v_dot2_f32_bf16 v70, v20, v32, v70
v_pk_mul_f32 v[86:87], v[54:55], v[66:67] op_sel_hi:[1,0]
v_pk_fma_f32 v[54:55], v[86:87], v[64:65], v[54:55] op_sel:[0,1,0] op_sel_hi:[1,1,1] neg_lo:[1,0,0] neg_hi:[1,0,0]
v_pk_fma_f32 v[86:87], v[54:55], v[66:67], v[86:87] op_sel_hi:[1,0,1]
v_cvt_pk_bf16_f32 v21, v86, v87
v_dot2_f32_bf16 v70, v21, v33, v70
v_pk_mul_f32 v[88:89], v[56:57], v[66:67] op_sel_hi:[1,0]
v_pk_fma_f32 v[56:57], v[88:89], v[64:65], v[56:57] op_sel:[0,1,0] op_sel_hi:[1,1,1] neg_lo:[1,0,0] neg_hi:[1,0,0]
v_pk_fma_f32 v[88:89], v[56:57], v[66:67], v[88:89] op_sel_hi:[1,0,1]
v_cvt_pk_bf16_f32 v22, v88, v89
v_dot2_f32_bf16 v70, v22, v34, v70
buffer_store_dwordx3 v[20:22], v10, s[20:23], 0 offen offset:768 sc0 sc1
v_sub_u32 v68, 2047, v8
v_lshlrev_b32 v5, 2, v8
s_nop 1
v_add_f32_dpp v71, v70, v70 row_ror:8 row_mask:0xf bank_mask:0xf
s_nop 1
v_add_f32_dpp v70, v71, v71 row_ror:4 row_mask:0xf bank_mask:0xf
s_nop 1
v_add_f32_dpp v71, v70, v70 row_ror:2 row_mask:0xf bank_mask:0xf
s_nop 1
v_add_f32_dpp v70, v71, v71 row_ror:1 row_mask:0xf bank_mask:0xf
v_mov_b32 v71, v70
s_nop 1
v_permlane16_swap_b32 v70, v71
v_add_f32 v70, v70, v71
v_cvt_pk_bf16_f32 v70, v70, v70
v_ashrrev_i32 v71, 31, v70
v_or_b32 v71, 0x80000000, v71
v_xor_b32 v70, v70, v71
v_and_or_b32 v214, v70, s92, v68
s_mov_b32 s46, 0x244000
s_mov_b32 exec_lo, 1
s_mov_b32 exec_hi, 1
buffer_store_dword v214, v5, s[20:23], s46 offen sc0 sc1
s_mov_b64 exec, -1
s_mov_b32 s28, s4
s_and_b32 s29, s5, 0xffff
s_mov_b32 s30, 0x100
s_mov_b32 s31, 0x00020000
s_waitcnt lgkmcnt(6)
v_mfma_f32_16x16x32_bf16 v[8:11], a[128:131], a[192:195], 0
s_lshl_b32 s46, s32, 2
ds_read_b128 a[200:203], v193 offset:0
ds_read_b128 a[204:207], v193 offset:2048
v_mfma_f32_16x16x32_bf16 v[40:43], a[128:131], a[196:199], 0
s_add_u32 m0, s45, 81920
v_bfrev_b32 v5, v4
v_lshrrev_b32 v5, 30, v5
v_mfma_f32_16x16x32_bf16 v[12:15], a[132:135], a[192:195], 0
buffer_load_dwordx4 v144, s[24:27], s43 offen offset:0 lds
v_mfma_f32_16x16x32_bf16 v[44:47], a[132:135], a[196:199], 0
v_xor_b32 v5, s46, v5
v_xor_b32 v5, v5, v3
v_smfmac_f32_16x16x64_bf16 a[248:251], a[208:211], a[128:135], v235
ds_read_b64_tr_b16 a[128:129], v184 offset:16384
ds_read_b64_tr_b16 a[130:131], v184 offset:18432
v_mfma_f32_16x16x32_bf16 v[72:75], a[160:163], a[192:195], 0
ds_read_b64_tr_b16 a[132:133], v185 offset:16384
ds_read_b64_tr_b16 a[134:135], v185 offset:18432
v_mfma_f32_16x16x32_bf16 v[104:107], a[160:163], a[196:199], 0
buffer_load_dwordx4 v145, s[24:27], s43 offen offset:1024 lds
v_mfma_f32_16x16x32_bf16 v[76:79], a[164:167], a[192:195], 0
v_lshlrev_b32 v5, 4, v5
v_lshl_add_u32 v216, v3, 8, v5
v_mfma_f32_16x16x32_bf16 v[108:111], a[164:167], a[196:199], 0
v_xor_b32 v217, 64, v216
v_xor_b32 v218, 128, v216
v_smfmac_f32_16x16x64_bf16 a[252:255], a[208:211], a[160:167], v235
s_add_u32 m0, s85, 81920
ds_read_b64_tr_b16 a[160:161], v184 offset:16640
ds_read_b64_tr_b16 a[162:163], v184 offset:18688
v_mfma_f32_16x16x32_bf16 v[16:19], a[136:139], a[192:195], 0
buffer_load_dwordx4 v146, s[24:27], s43 offen offset:0 lds
v_mfma_f32_16x16x32_bf16 v[48:51], a[136:139], a[196:199], 0
ds_read_b64_tr_b16 a[164:165], v185 offset:16640
ds_read_b64_tr_b16 a[166:167], v185 offset:18688
v_mfma_f32_16x16x32_bf16 v[20:23], a[140:143], a[192:195], 0
ds_read_b64_tr_b16 a[136:137], v186 offset:16384
ds_read_b64_tr_b16 a[138:139], v186 offset:18432
v_mfma_f32_16x16x32_bf16 v[52:55], a[140:143], a[196:199], 0
ds_read_b64_tr_b16 a[140:141], v187 offset:16384
ds_read_b64_tr_b16 a[142:143], v187 offset:18432
v_mfma_f32_16x16x32_bf16 v[24:27], a[144:147], a[192:195], 0
buffer_load_dwordx4 v147, s[24:27], s43 offen offset:1024 lds
v_mfma_f32_16x16x32_bf16 v[56:59], a[144:147], a[196:199], 0
ds_read_b64_tr_b16 a[144:145], v188 offset:16384
ds_read_b64_tr_b16 a[146:147], v188 offset:18432
v_mfma_f32_16x16x32_bf16 v[28:31], a[148:151], a[192:195], 0
s_add_u32 s43, s43, 128
v_xor_b32 v219, 192, v216
v_lshl_add_u32 v6, v4, 2, v250
v_mfma_f32_16x16x32_bf16 v[60:63], a[148:151], a[196:199], 0
s_add_u32 m0, s44, 49152
ds_read_b64_tr_b16 a[148:149], v189 offset:16384
ds_read_b64_tr_b16 a[150:151], v189 offset:18432
v_mfma_f32_16x16x32_bf16 v[32:35], a[152:155], a[192:195], 0
buffer_load_dwordx4 v136, s[16:19], s42 offen offset:0 lds
v_mfma_f32_16x16x32_bf16 v[64:67], a[152:155], a[196:199], 0
ds_read_b64_tr_b16 a[152:153], v190 offset:16384
ds_read_b64_tr_b16 a[154:155], v190 offset:18432
v_mfma_f32_16x16x32_bf16 v[36:39], a[156:159], a[192:195], 0
v_and_b32 v5, 7, v6
v_lshlrev_b32 v5, 5, v5
v_mfma_f32_16x16x32_bf16 v[68:71], a[156:159], a[196:199], 0
ds_read_b64_tr_b16 a[156:157], v191 offset:16384
ds_read_b64_tr_b16 a[158:159], v191 offset:18432
v_mfma_f32_16x16x32_bf16 v[80:83], a[168:171], a[192:195], 0
v_lshl_add_u32 v5, v6, 8, v5
v_lshl_add_u32 v5, v251, 3, v5
v_mfma_f32_16x16x32_bf16 v[112:115], a[168:171], a[196:199], 0
buffer_load_dwordx4 v137, s[16:19], s42 offen offset:1024 lds
v_mfma_f32_16x16x32_bf16 v[84:87], a[172:175], a[192:195], 0
ds_read_b64_tr_b16 a[168:169], v186 offset:16640
ds_read_b64_tr_b16 a[170:171], v186 offset:18688
v_mfma_f32_16x16x32_bf16 v[116:119], a[172:175], a[196:199], 0
ds_read_b64_tr_b16 a[172:173], v187 offset:16640
ds_read_b64_tr_b16 a[174:175], v187 offset:18688
v_mfma_f32_16x16x32_bf16 v[88:91], a[176:179], a[192:195], 0
v_add_u32 v220, 0x10000, v5
v_xor_b32 v221, 32, v220
v_mfma_f32_16x16x32_bf16 v[120:123], a[176:179], a[196:199], 0
s_waitcnt lgkmcnt(6)
buffer_load_dwordx4 v138, s[16:19], s42 offen offset:2048 lds
v_mfma_f32_16x16x32_bf16 v[92:95], a[180:183], a[192:195], 0
ds_read_b64_tr_b16 a[176:177], v188 offset:16640
ds_read_b64_tr_b16 a[178:179], v188 offset:18688
v_mfma_f32_16x16x32_bf16 v[124:127], a[180:183], a[196:199], 0
ds_read_b64_tr_b16 a[180:181], v189 offset:16640
ds_read_b64_tr_b16 a[182:183], v189 offset:18688
v_mfma_f32_16x16x32_bf16 v[96:99], a[184:187], a[192:195], 0
v_mfma_f32_16x16x32_bf16 v[128:131], a[184:187], a[196:199], 0
buffer_load_dwordx4 v139, s[16:19], s42 offen offset:3072 lds
v_mfma_f32_16x16x32_bf16 v[100:103], a[188:191], a[192:195], 0
ds_read_b64_tr_b16 a[184:185], v190 offset:16640
ds_read_b64_tr_b16 a[186:187], v190 offset:18688
v_mfma_f32_16x16x32_bf16 v[132:135], a[188:191], a[196:199], 0
ds_read_b64_tr_b16 a[188:189], v191 offset:16640
ds_read_b64_tr_b16 a[190:191], v191 offset:18688
v_mfma_f32_16x16x32_bf16 v[8:11], a[128:131], a[200:203], v[8:11]
s_add_u32 m0, s44, 53248
v_xor_b32 v222, 64, v220
v_xor_b32 v223, 96, v220
v_mfma_f32_16x16x32_bf16 v[40:43], a[128:131], a[204:207], v[40:43]
buffer_load_dwordx4 v140, s[16:19], s42 offen offset:0 lds
v_mfma_f32_16x16x32_bf16 v[12:15], a[132:135], a[200:203], v[12:15]
v_xor_b32 v224, 128, v220
v_xor_b32 v225, 160, v220
v_mfma_f32_16x16x32_bf16 v[44:47], a[132:135], a[204:207], v[44:47]
v_xor_b32 v226, 192, v220
v_xor_b32 v227, 224, v220
v_smfmac_f32_16x16x64_bf16 a[248:251], a[208:211], a[128:135], v235
v_xor_b32 v5, v4, v3
v_lshlrev_b32 v5, 4, v5
v_mfma_f32_16x16x32_bf16 v[72:75], a[160:163], a[200:203], v[72:75]
v_lshl_add_u32 v5, v4, 8, v5
v_add_u32 v228, s37, v5
v_mfma_f32_16x16x32_bf16 v[104:107], a[160:163], a[204:207], v[104:107]
s_waitcnt vmcnt(11) lgkmcnt(0)
s_barrier
v_mfma_f32_16x16x32_bf16 v[76:79], a[164:167], a[200:203], v[76:79]
ds_read_b128 a[192:195], v202 offset:0
ds_read_b128 a[196:199], v202 offset:2048
v_mfma_f32_16x16x32_bf16 v[108:111], a[164:167], a[204:207], v[108:111]
buffer_load_dwordx4 v141, s[16:19], s42 offen offset:1024 lds
v_smfmac_f32_16x16x64_bf16 a[252:255], a[208:211], a[160:167], v235
ds_read_b64_tr_b16 a[128:129], v194 offset:0
ds_read_b64_tr_b16 a[130:131], v194 offset:2048
v_mfma_f32_16x16x32_bf16 v[16:19], a[136:139], a[200:203], v[16:19]
ds_read_b64_tr_b16 a[132:133], v195 offset:0
ds_read_b64_tr_b16 a[134:135], v195 offset:2048
v_mfma_f32_16x16x32_bf16 v[48:51], a[136:139], a[204:207], v[48:51]
ds_read_b64_tr_b16 a[160:161], v194 offset:256
ds_read_b64_tr_b16 a[162:163], v194 offset:2304
v_mfma_f32_16x16x32_bf16 v[20:23], a[140:143], a[200:203], v[20:23]
ds_read_b64_tr_b16 a[164:165], v195 offset:256
ds_read_b64_tr_b16 a[166:167], v195 offset:2304
v_mfma_f32_16x16x32_bf16 v[52:55], a[140:143], a[204:207], v[52:55]
buffer_load_dwordx4 v142, s[16:19], s42 offen offset:2048 lds
v_mfma_f32_16x16x32_bf16 v[24:27], a[144:147], a[200:203], v[24:27]
ds_read_b64_tr_b16 a[136:137], v196 offset:0
ds_read_b64_tr_b16 a[138:139], v196 offset:2048
v_mfma_f32_16x16x32_bf16 v[56:59], a[144:147], a[204:207], v[56:59]
ds_read_b64_tr_b16 a[140:141], v197 offset:0
ds_read_b64_tr_b16 a[142:143], v197 offset:2048
v_mfma_f32_16x16x32_bf16 v[28:31], a[148:151], a[200:203], v[28:31]
ds_read_b64_tr_b16 a[144:145], v198 offset:0
ds_read_b64_tr_b16 a[146:147], v198 offset:2048
v_mfma_f32_16x16x32_bf16 v[60:63], a[148:151], a[204:207], v[60:63]
buffer_load_dwordx4 v143, s[16:19], s42 offen offset:3072 lds
v_mfma_f32_16x16x32_bf16 v[32:35], a[152:155], a[200:203], v[32:35]
ds_read_b64_tr_b16 a[148:149], v199 offset:0
ds_read_b64_tr_b16 a[150:151], v199 offset:2048
v_mfma_f32_16x16x32_bf16 v[64:67], a[152:155], a[204:207], v[64:67]
s_add_u32 s42, s42, 524288
ds_read_b64_tr_b16 a[152:153], v200 offset:0
ds_read_b64_tr_b16 a[154:155], v200 offset:2048
v_mfma_f32_16x16x32_bf16 v[36:39], a[156:159], a[200:203], v[36:39]
s_add_u32 m0, s45, 32768
v_xor_b32 v229, 64, v228
v_xor_b32 v230, 128, v228
v_mfma_f32_16x16x32_bf16 v[68:71], a[156:159], a[204:207], v[68:71]
buffer_load_dwordx4 v144, s[24:27], s43 offen offset:0 lds
v_mfma_f32_16x16x32_bf16 v[80:83], a[168:171], a[200:203], v[80:83]
ds_read_b64_tr_b16 a[156:157], v201 offset:0
ds_read_b64_tr_b16 a[158:159], v201 offset:2048
v_mfma_f32_16x16x32_bf16 v[112:115], a[168:171], a[204:207], v[112:115]
ds_read_b64_tr_b16 a[168:169], v196 offset:256
ds_read_b64_tr_b16 a[170:171], v196 offset:2304
v_mfma_f32_16x16x32_bf16 v[84:87], a[172:175], a[200:203], v[84:87]
v_xor_b32 v231, 192, v228
v_lshlrev_b32 v5, 1, v4
v_mfma_f32_16x16x32_bf16 v[116:119], a[172:175], a[204:207], v[116:119]
buffer_load_dwordx4 v145, s[24:27], s43 offen offset:1024 lds
v_mfma_f32_16x16x32_bf16 v[88:91], a[176:179], a[200:203], v[88:91]
ds_read_b64_tr_b16 a[172:173], v197 offset:256
ds_read_b64_tr_b16 a[174:175], v197 offset:2304
v_mfma_f32_16x16x32_bf16 v[120:123], a[176:179], a[204:207], v[120:123]
ds_read_b64_tr_b16 a[176:177], v198 offset:256
ds_read_b64_tr_b16 a[178:179], v198 offset:2304
v_mfma_f32_16x16x32_bf16 v[92:95], a[180:183], a[200:203], v[92:95]
s_add_u32 m0, s85, 32768
v_xor_b32 v5, v5, v3
v_lshlrev_b32 v5, 4, v5
v_mfma_f32_16x16x32_bf16 v[124:127], a[180:183], a[204:207], v[124:127]
buffer_load_dwordx4 v146, s[24:27], s43 offen offset:0 lds
v_mfma_f32_16x16x32_bf16 v[96:99], a[184:187], a[200:203], v[96:99]
ds_read_b64_tr_b16 a[180:181], v199 offset:256
ds_read_b64_tr_b16 a[182:183], v199 offset:2304
v_mfma_f32_16x16x32_bf16 v[128:131], a[184:187], a[204:207], v[128:131]
ds_read_b64_tr_b16 a[184:185], v200 offset:256
ds_read_b64_tr_b16 a[186:187], v200 offset:2304
v_mfma_f32_16x16x32_bf16 v[100:103], a[188:191], a[200:203], v[100:103]
v_mfma_f32_16x16x32_bf16 v[132:135], a[188:191], a[204:207], v[132:135]
s_waitcnt lgkmcnt(6)
ds_read_b64_tr_b16 a[188:189], v201 offset:256
ds_read_b64_tr_b16 a[190:191], v201 offset:2304
v_mfma_f32_16x16x32_bf16 v[8:11], a[128:131], a[192:195], v[8:11]
buffer_load_dwordx4 v147, s[24:27], s43 offen offset:1024 lds
v_mfma_f32_16x16x32_bf16 v[40:43], a[128:131], a[196:199], v[40:43]
ds_read_b128 a[200:203], v203 offset:0
ds_read_b128 a[204:207], v203 offset:2048
v_mfma_f32_16x16x32_bf16 v[12:15], a[132:135], a[192:195], v[12:15]
s_add_u32 s43, s43, 128
v_lshl_add_u32 v5, v4, 8, v5
v_add_u32 v232, s37, v5
v_mfma_f32_16x16x32_bf16 v[44:47], a[132:135], a[196:199], v[44:47]
s_add_u32 m0, s44, 0
v_xor_b32 v233, 128, v232
v_smfmac_f32_16x16x64_bf16 a[248:251], a[208:211], a[128:135], v235
s_mov_b32 s41, 0
buffer_load_dwordx4 v136, s[16:19], s42 offen offset:0 lds
v_mfma_f32_16x16x32_bf16 v[72:75], a[160:163], a[192:195], v[72:75]
s_mul_i32 s49, s32, 9216
ds_read_b64_tr_b16 a[128:129], v194 offset:16384
ds_read_b64_tr_b16 a[130:131], v194 offset:18432
v_mfma_f32_16x16x32_bf16 v[104:107], a[160:163], a[196:199], v[104:107]
s_lshl_b32 s3, s32, 10
ds_read_b64_tr_b16 a[132:133], v195 offset:16384
ds_read_b64_tr_b16 a[134:135], v195 offset:18432
v_mfma_f32_16x16x32_bf16 v[76:79], a[164:167], a[192:195], v[76:79]
s_lshl_b32 s53, s34, 4
v_mfma_f32_16x16x32_bf16 v[108:111], a[164:167], a[196:199], v[108:111]
s_add_u32 s53, s53, s33
buffer_load_dwordx4 v137, s[16:19], s42 offen offset:1024 lds
v_smfmac_f32_16x16x64_bf16 a[252:255], a[208:211], a[160:167], v235
s_lshl_b32 s53, s53, 2
ds_read_b64_tr_b16 a[160:161], v194 offset:16640
ds_read_b64_tr_b16 a[162:163], v194 offset:18688
v_mfma_f32_16x16x32_bf16 v[16:19], a[136:139], a[192:195], v[16:19]
s_add_u32 s53, s53, s32
ds_read_b64_tr_b16 a[164:165], v195 offset:16640
ds_read_b64_tr_b16 a[166:167], v195 offset:18688
v_mfma_f32_16x16x32_bf16 v[48:51], a[136:139], a[196:199], v[48:51]
s_lshl_b32 s53, s53, 14
ds_read_b64_tr_b16 a[136:137], v196 offset:16384
ds_read_b64_tr_b16 a[138:139], v196 offset:18432
v_mfma_f32_16x16x32_bf16 v[20:23], a[140:143], a[192:195], v[20:23]
s_add_u32 s53, s53, 0x400000
buffer_load_dwordx4 v138, s[16:19], s42 offen offset:2048 lds
v_mfma_f32_16x16x32_bf16 v[52:55], a[140:143], a[196:199], v[52:55]
ds_read_b64_tr_b16 a[140:141], v197 offset:16384
ds_read_b64_tr_b16 a[142:143], v197 offset:18432
v_mfma_f32_16x16x32_bf16 v[24:27], a[144:147], a[192:195], v[24:27]
v_add_u32 v5, s46, v4
v_and_b32 v6, 7, v5
v_mfma_f32_16x16x32_bf16 v[56:59], a[144:147], a[196:199], v[56:59]
ds_read_b64_tr_b16 a[144:145], v198 offset:16384
ds_read_b64_tr_b16 a[146:147], v198 offset:18432
v_mfma_f32_16x16x32_bf16 v[28:31], a[148:151], a[192:195], v[28:31]
buffer_load_dwordx4 v139, s[16:19], s42 offen offset:3072 lds
v_mfma_f32_16x16x32_bf16 v[60:63], a[148:151], a[196:199], v[60:63]
ds_read_b64_tr_b16 a[148:149], v199 offset:16384
ds_read_b64_tr_b16 a[150:151], v199 offset:18432
v_mfma_f32_16x16x32_bf16 v[32:35], a[152:155], a[192:195], v[32:35]
v_lshlrev_b32 v6, 1, v6
v_xor_b32 v6, v6, v3
v_mfma_f32_16x16x32_bf16 v[64:67], a[152:155], a[196:199], v[64:67]
ds_read_b64_tr_b16 a[152:153], v200 offset:16384
ds_read_b64_tr_b16 a[154:155], v200 offset:18432
v_mfma_f32_16x16x32_bf16 v[36:39], a[156:159], a[192:195], v[36:39]
s_add_u32 m0, s44, 4096
v_mul_u32_u24 v5, 0x480, v5
v_lshl_add_u32 v236, v6, 4, v5
v_mfma_f32_16x16x32_bf16 v[68:71], a[156:159], a[196:199], v[68:71]
buffer_load_dwordx4 v140, s[16:19], s42 offen offset:0 lds
v_mfma_f32_16x16x32_bf16 v[80:83], a[168:171], a[192:195], v[80:83]
ds_read_b64_tr_b16 a[156:157], v201 offset:16384
ds_read_b64_tr_b16 a[158:159], v201 offset:18432
v_mfma_f32_16x16x32_bf16 v[112:115], a[168:171], a[196:199], v[112:115]
ds_read_b64_tr_b16 a[168:169], v196 offset:16640
ds_read_b64_tr_b16 a[170:171], v196 offset:18688
v_mfma_f32_16x16x32_bf16 v[84:87], a[172:175], a[192:195], v[84:87]
v_lshrrev_b32 v5, 3, v0
v_and_b32 v6, 6, v5
v_mfma_f32_16x16x32_bf16 v[116:119], a[172:175], a[196:199], v[116:119]
s_waitcnt lgkmcnt(6)
buffer_load_dwordx4 v141, s[16:19], s42 offen offset:1024 lds
v_mfma_f32_16x16x32_bf16 v[88:91], a[176:179], a[192:195], v[88:91]
ds_read_b64_tr_b16 a[172:173], v197 offset:16640
ds_read_b64_tr_b16 a[174:175], v197 offset:18688
v_mfma_f32_16x16x32_bf16 v[120:123], a[176:179], a[196:199], v[120:123]
ds_read_b64_tr_b16 a[176:177], v198 offset:16640
ds_read_b64_tr_b16 a[178:179], v198 offset:18688
v_mfma_f32_16x16x32_bf16 v[92:95], a[180:183], a[192:195], v[92:95]
v_and_b32 v7, 7, v1
v_xor_b32 v6, v6, v7
v_mfma_f32_16x16x32_bf16 v[124:127], a[180:183], a[196:199], v[124:127]
buffer_load_dwordx4 v142, s[16:19], s42 offen offset:2048 lds
v_mfma_f32_16x16x32_bf16 v[96:99], a[184:187], a[192:195], v[96:99]
ds_read_b64_tr_b16 a[180:181], v199 offset:16640
ds_read_b64_tr_b16 a[182:183], v199 offset:18688
v_mfma_f32_16x16x32_bf16 v[128:131], a[184:187], a[196:199], v[128:131]
ds_read_b64_tr_b16 a[184:185], v200 offset:16640
ds_read_b64_tr_b16 a[186:187], v200 offset:18688
v_mfma_f32_16x16x32_bf16 v[100:103], a[188:191], a[192:195], v[100:103]
v_mul_u32_u24 v5, 0x480, v5
v_lshl_add_u32 v237, v6, 4, v5
v_mfma_f32_16x16x32_bf16 v[132:135], a[188:191], a[196:199], v[132:135]
ds_read_b64_tr_b16 a[188:189], v201 offset:16640
ds_read_b64_tr_b16 a[190:191], v201 offset:18688
v_lshrrev_b32 v5, 2, v1
v_mfma_f32_16x16x32_bf16 v[8:11], a[128:131], a[200:203], v[8:11]
buffer_load_dwordx4 v143, s[16:19], s42 offen offset:3072 lds
v_mfma_f32_16x16x32_bf16 v[40:43], a[128:131], a[204:207], v[40:43]
s_add_u32 s42, s42, 524288
v_and_b32 v254, 1, v1
v_mul_u32_u24 v5, 0x2400, v5
v_mfma_f32_16x16x32_bf16 v[12:15], a[132:135], a[200:203], v[12:15]
v_lshlrev_b32 v254, 21, v254
v_lshl_add_u32 v238, v251, 4, v5
v_mfma_f32_16x16x32_bf16 v[44:47], a[132:135], a[204:207], v[44:47]
s_add_u32 s48, s42, 0
v_smfmac_f32_16x16x64_bf16 a[248:251], a[208:211], a[128:135], v235
s_lshl_b32 s47, s36, 8
buffer_load_dword v252, v254, s[16:19], s48 offen
v_mfma_f32_16x16x32_bf16 v[72:75], a[160:163], a[200:203], v[72:75]
s_mul_i32 s84, s35, 1179648
v_mfma_f32_16x16x32_bf16 v[104:107], a[160:163], a[204:207], v[104:107]
s_waitcnt vmcnt(13) lgkmcnt(0)
s_barrier
s_cmp_lg_u32 s32, 0
s_cbranch_scc1 K_W0_3
s_lshl_b32 s48, s34, 4
s_mov_b64 exec, 1
buffer_atomic_add v255, v234, s[28:31], s48 offen sc1
s_mov_b64 exec, -1
K_W0_3:
s_add_u32 s84, s84, s47
v_mfma_f32_16x16x32_bf16 v[76:79], a[164:167], a[200:203], v[76:79]
s_mul_i32 s75, s33, 294912
ds_read_b128 a[192:195], v212 offset:0
ds_read_b128 a[196:199], v212 offset:2048
v_mfma_f32_16x16x32_bf16 v[108:111], a[164:167], a[204:207], v[108:111]
s_add_u32 m0, s45, 131072
ds_read_b64_tr_b16 a[128:129], v204 offset:0
ds_read_b64_tr_b16 a[130:131], v204 offset:2048
v_smfmac_f32_16x16x64_bf16 a[252:255], a[208:211], a[160:167], v235
s_add_u32 s51, s75, s47
buffer_load_dwordx4 v144, s[24:27], s43 offen offset:0 lds
v_mfma_f32_16x16x32_bf16 v[16:19], a[136:139], a[200:203], v[16:19]
s_add_u32 s75, s75, 1024
ds_read_b64_tr_b16 a[132:133], v205 offset:0
ds_read_b64_tr_b16 a[134:135], v205 offset:2048
v_mfma_f32_16x16x32_bf16 v[48:51], a[136:139], a[204:207], v[48:51]
s_mov_b64 s[86:87], s[68:69]
ds_read_b64_tr_b16 a[160:161], v204 offset:256
ds_read_b64_tr_b16 a[162:163], v204 offset:2304
v_mfma_f32_16x16x32_bf16 v[20:23], a[140:143], a[200:203], v[20:23]
s_mov_b64 s[88:89], s[56:57]
ds_read_b64_tr_b16 a[164:165], v205 offset:256
ds_read_b64_tr_b16 a[166:167], v205 offset:2304
v_mfma_f32_16x16x32_bf16 v[52:55], a[140:143], a[204:207], v[52:55]
s_mov_b64 s[90:91], s[58:59]
buffer_load_dwordx4 v145, s[24:27], s43 offen offset:1024 lds
v_mfma_f32_16x16x32_bf16 v[24:27], a[144:147], a[200:203], v[24:27]
s_mov_b32 s68, s66
ds_read_b64_tr_b16 a[136:137], v206 offset:0
ds_read_b64_tr_b16 a[138:139], v206 offset:2048
v_mfma_f32_16x16x32_bf16 v[56:59], a[144:147], a[204:207], v[56:59]
s_and_b32 s69, s67, 0xffff
ds_read_b64_tr_b16 a[140:141], v207 offset:0
ds_read_b64_tr_b16 a[142:143], v207 offset:2048
v_mfma_f32_16x16x32_bf16 v[28:31], a[148:151], a[200:203], v[28:31]
s_add_u32 m0, s85, 131072
ds_read_b64_tr_b16 a[144:145], v208 offset:0
ds_read_b64_tr_b16 a[146:147], v208 offset:2048
v_mfma_f32_16x16x32_bf16 v[60:63], a[148:151], a[204:207], v[60:63]
s_mov_b32 s70, 0x240000
buffer_load_dwordx4 v146, s[24:27], s43 offen offset:0 lds
v_mfma_f32_16x16x32_bf16 v[32:35], a[152:155], a[200:203], v[32:35]
s_mov_b32 s71, 0x00020000
ds_read_b64_tr_b16 a[148:149], v209 offset:0
ds_read_b64_tr_b16 a[150:151], v209 offset:2048
v_mfma_f32_16x16x32_bf16 v[64:67], a[152:155], a[204:207], v[64:67]
s_mov_b32 s64, s64
ds_read_b64_tr_b16 a[152:153], v210 offset:0
ds_read_b64_tr_b16 a[154:155], v210 offset:2048
v_mfma_f32_16x16x32_bf16 v[36:39], a[156:159], a[200:203], v[36:39]
s_and_b32 s65, s65, 0xffff
v_mfma_f32_16x16x32_bf16 v[68:71], a[156:159], a[204:207], v[68:71]
s_mov_b32 s66, 0x510000
buffer_load_dwordx4 v147, s[24:27], s43 offen offset:1024 lds
v_mfma_f32_16x16x32_bf16 v[80:83], a[168:171], a[200:203], v[80:83]
s_mov_b32 s67, 0x00020000
ds_read_b64_tr_b16 a[156:157], v211 offset:0
ds_read_b64_tr_b16 a[158:159], v211 offset:2048
v_mfma_f32_16x16x32_bf16 v[112:115], a[168:171], a[204:207], v[112:115]
s_add_u32 s43, s43, 128
ds_read_b64_tr_b16 a[168:169], v206 offset:256
ds_read_b64_tr_b16 a[170:171], v206 offset:2304
v_mfma_f32_16x16x32_bf16 v[84:87], a[172:175], a[200:203], v[84:87]
s_add_u32 m0, s44, 98304
v_mfma_f32_16x16x32_bf16 v[116:119], a[172:175], a[204:207], v[116:119]
s_mov_b32 s56, s88
buffer_load_dwordx4 v136, s[16:19], s42 offen offset:0 lds
v_mfma_f32_16x16x32_bf16 v[88:91], a[176:179], a[200:203], v[88:91]
s_and_b32 s57, s89, 0xffff
ds_read_b64_tr_b16 a[172:173], v207 offset:256
ds_read_b64_tr_b16 a[174:175], v207 offset:2304
v_mfma_f32_16x16x32_bf16 v[120:123], a[176:179], a[204:207], v[120:123]
s_mov_b32 s58, 0x510000
ds_read_b64_tr_b16 a[176:177], v208 offset:256
ds_read_b64_tr_b16 a[178:179], v208 offset:2304
v_mfma_f32_16x16x32_bf16 v[92:95], a[180:183], a[200:203], v[92:95]
s_mov_b32 s59, 0x00020000
v_mfma_f32_16x16x32_bf16 v[124:127], a[180:183], a[204:207], v[124:127]
s_mov_b32 s60, s90
ds_read_b64_tr_b16 a[180:181], v209 offset:256
ds_read_b64_tr_b16 a[182:183], v209 offset:2304
v_mfma_f32_16x16x32_bf16 v[96:99], a[184:187], a[200:203], v[96:99]
s_and_b32 s61, s91, 0xffff
buffer_load_dwordx4 v137, s[16:19], s42 offen offset:1024 lds
v_mfma_f32_16x16x32_bf16 v[128:131], a[184:187], a[204:207], v[128:131]
s_mov_b32 s62, 0x510000
ds_read_b64_tr_b16 a[184:185], v210 offset:256
ds_read_b64_tr_b16 a[186:187], v210 offset:2304
v_mfma_f32_16x16x32_bf16 v[100:103], a[188:191], a[200:203], v[100:103]
s_mov_b32 s63, 0x00020000
v_mfma_f32_16x16x32_bf16 v[132:135], a[188:191], a[204:207], v[132:135]
s_waitcnt lgkmcnt(6)
s_and_b32 s52, s2, 7
ds_read_b64_tr_b16 a[188:189], v211 offset:256
ds_read_b64_tr_b16 a[190:191], v211 offset:2304
s_mul_i32 s52, s52, 18
s_lshr_b32 s47, s2, 3
v_mfma_f32_16x16x32_bf16 v[8:11], a[128:131], a[192:195], v[8:11]
s_add_u32 s52, s52, s47
buffer_load_dwordx4 v138, s[16:19], s42 offen offset:2048 lds
v_mfma_f32_16x16x32_bf16 v[40:43], a[128:131], a[196:199], v[40:43]
s_lshl_b32 s50, s52, 6
ds_read_b128 a[200:203], v213 offset:0
ds_read_b128 a[204:207], v213 offset:2048
v_mfma_f32_16x16x32_bf16 v[12:15], a[132:135], a[192:195], v[12:15]
s_mul_i32 s47, s32, 147456
v_accvgpr_write_b32 a0, 0
v_accvgpr_write_b32 a1, 0
v_mfma_f32_16x16x32_bf16 v[44:47], a[132:135], a[196:199], v[44:47]
s_add_u32 s50, s50, s47
v_accvgpr_write_b32 a2, 0
v_accvgpr_write_b32 a3, 0
v_smfmac_f32_16x16x64_bf16 a[248:251], a[208:211], a[128:135], v235
s_add_u32 s52, s52, 1
buffer_load_dwordx4 v139, s[16:19], s42 offen offset:3072 lds
v_mfma_f32_16x16x32_bf16 v[72:75], a[160:163], a[192:195], v[72:75]
s_mov_b32 s80, 98304
ds_read_b64_tr_b16 a[128:129], v204 offset:16384
ds_read_b64_tr_b16 a[130:131], v204 offset:18432
v_mfma_f32_16x16x32_bf16 v[104:107], a[160:163], a[196:199], v[104:107]
s_mov_b32 s81, 131072
ds_read_b64_tr_b16 a[132:133], v205 offset:16384
ds_read_b64_tr_b16 a[134:135], v205 offset:18432
v_mfma_f32_16x16x32_bf16 v[76:79], a[164:167], a[192:195], v[76:79]
s_add_u32 m0, s44, 102400
v_accvgpr_write_b32 a4, 0
v_accvgpr_write_b32 a5, 0
v_mfma_f32_16x16x32_bf16 v[108:111], a[164:167], a[196:199], v[108:111]
s_mov_b32 s82, 32768
buffer_load_dwordx4 v140, s[16:19], s42 offen offset:0 lds
v_smfmac_f32_16x16x64_bf16 a[252:255], a[208:211], a[160:167], v235
s_mov_b32 s83, 65536
ds_read_b64_tr_b16 a[160:161], v204 offset:16640
ds_read_b64_tr_b16 a[162:163], v204 offset:18688
v_mfma_f32_16x16x32_bf16 v[16:19], a[136:139], a[192:195], v[16:19]
s_mov_b32 s72, 0
ds_read_b64_tr_b16 a[164:165], v205 offset:16640
ds_read_b64_tr_b16 a[166:167], v205 offset:18688
v_mfma_f32_16x16x32_bf16 v[48:51], a[136:139], a[196:199], v[48:51]
s_mov_b32 s73, 16384
ds_read_b64_tr_b16 a[136:137], v206 offset:16384
ds_read_b64_tr_b16 a[138:139], v206 offset:18432
v_mfma_f32_16x16x32_bf16 v[20:23], a[140:143], a[192:195], v[20:23]
s_cmp_lt_u32 s2, 144
s_cselect_b32 s52, s52, 0
buffer_load_dwordx4 v141, s[16:19], s42 offen offset:1024 lds
v_mfma_f32_16x16x32_bf16 v[52:55], a[140:143], a[196:199], v[52:55]
s_cmp_lt_u32 s2, 144
s_cselect_b32 s80, 65536, s80
ds_read_b64_tr_b16 a[140:141], v207 offset:16384
ds_read_b64_tr_b16 a[142:143], v207 offset:18432
v_mfma_f32_16x16x32_bf16 v[24:27], a[144:147], a[192:195], v[24:27]
s_cmp_lt_u32 s2, 144
s_cselect_b32 s82, 98304, s82
v_accvgpr_write_b32 a6, 0
v_accvgpr_write_b32 a7, 0
v_mfma_f32_16x16x32_bf16 v[56:59], a[144:147], a[196:199], v[56:59]
s_cmp_lt_u32 s2, 144
s_cselect_b32 s83, 16384, s83
ds_read_b64_tr_b16 a[144:145], v208 offset:16384
ds_read_b64_tr_b16 a[146:147], v208 offset:18432
v_mfma_f32_16x16x32_bf16 v[28:31], a[148:151], a[192:195], v[28:31]
s_cmp_lt_u32 s2, 144
s_cselect_b32 s72, 49152, s72
v_accvgpr_write_b32 a8, 0
v_accvgpr_write_b32 a9, 0
v_mfma_f32_16x16x32_bf16 v[60:63], a[148:151], a[196:199], v[60:63]
s_cmp_lt_u32 s2, 144
s_cselect_b32 s73, 0, s73
buffer_load_dwordx4 v142, s[16:19], s42 offen offset:2048 lds
v_mfma_f32_16x16x32_bf16 v[32:35], a[152:155], a[192:195], v[32:35]
s_cmp_lt_u32 s2, 144
s_cselect_b32 s74, 2, 4
ds_read_b64_tr_b16 a[148:149], v209 offset:16384
ds_read_b64_tr_b16 a[150:151], v209 offset:18432
v_mfma_f32_16x16x32_bf16 v[64:67], a[152:155], a[196:199], v[64:67]
ds_read_b64_tr_b16 a[152:153], v210 offset:16384
ds_read_b64_tr_b16 a[154:155], v210 offset:18432
v_mfma_f32_16x16x32_bf16 v[36:39], a[156:159], a[192:195], v[36:39]
v_accvgpr_write_b32 a10, 0
v_accvgpr_write_b32 a11, 0
v_mfma_f32_16x16x32_bf16 v[68:71], a[156:159], a[196:199], v[68:71]
buffer_load_dwordx4 v143, s[16:19], s42 offen offset:3072 lds
v_mfma_f32_16x16x32_bf16 v[80:83], a[168:171], a[192:195], v[80:83]
ds_read_b64_tr_b16 a[156:157], v211 offset:16384
ds_read_b64_tr_b16 a[158:159], v211 offset:18432
v_mfma_f32_16x16x32_bf16 v[112:115], a[168:171], a[196:199], v[112:115]
ds_read_b64_tr_b16 a[168:169], v206 offset:16640
ds_read_b64_tr_b16 a[170:171], v206 offset:18688
v_mfma_f32_16x16x32_bf16 v[84:87], a[172:175], a[192:195], v[84:87]
s_add_u32 s42, s42, 524288
v_accvgpr_write_b32 a12, 0
v_accvgpr_write_b32 a13, 0
v_mfma_f32_16x16x32_bf16 v[116:119], a[172:175], a[196:199], v[116:119]
s_waitcnt lgkmcnt(6)
ds_read_b64_tr_b16 a[172:173], v207 offset:16640
ds_read_b64_tr_b16 a[174:175], v207 offset:18688
v_mfma_f32_16x16x32_bf16 v[88:91], a[176:179], a[192:195], v[88:91]
v_accvgpr_write_b32 a14, 0
v_accvgpr_write_b32 a15, 0
v_mfma_f32_16x16x32_bf16 v[120:123], a[176:179], a[196:199], v[120:123]
ds_read_b64_tr_b16 a[176:177], v208 offset:16640
ds_read_b64_tr_b16 a[178:179], v208 offset:18688
v_mfma_f32_16x16x32_bf16 v[92:95], a[180:183], a[192:195], v[92:95]
v_accvgpr_write_b32 a16, 0
v_accvgpr_write_b32 a17, 0
v_mfma_f32_16x16x32_bf16 v[124:127], a[180:183], a[196:199], v[124:127]
ds_read_b64_tr_b16 a[180:181], v209 offset:16640
ds_read_b64_tr_b16 a[182:183], v209 offset:18688
v_mfma_f32_16x16x32_bf16 v[96:99], a[184:187], a[192:195], v[96:99]
v_accvgpr_write_b32 a18, 0
v_accvgpr_write_b32 a19, 0
v_mfma_f32_16x16x32_bf16 v[128:131], a[184:187], a[196:199], v[128:131]
ds_read_b64_tr_b16 a[184:185], v210 offset:16640
ds_read_b64_tr_b16 a[186:187], v210 offset:18688
v_mfma_f32_16x16x32_bf16 v[100:103], a[188:191], a[192:195], v[100:103]
v_mfma_f32_16x16x32_bf16 v[132:135], a[188:191], a[196:199], v[132:135]
ds_read_b64_tr_b16 a[188:189], v211 offset:16640
ds_read_b64_tr_b16 a[190:191], v211 offset:18688
v_mfma_f32_16x16x32_bf16 v[8:11], a[128:131], a[200:203], v[8:11]
v_accvgpr_write_b32 a20, 0
v_accvgpr_write_b32 a21, 0
v_mfma_f32_16x16x32_bf16 v[40:43], a[128:131], a[204:207], v[40:43]
v_accvgpr_write_b32 a22, 0
v_accvgpr_write_b32 a23, 0
v_mfma_f32_16x16x32_bf16 v[12:15], a[132:135], a[200:203], v[12:15]
v_accvgpr_write_b32 a24, 0
v_accvgpr_write_b32 a25, 0
v_mfma_f32_16x16x32_bf16 v[44:47], a[132:135], a[204:207], v[44:47]
v_accvgpr_write_b32 a26, 0
v_accvgpr_write_b32 a27, 0
v_smfmac_f32_16x16x64_bf16 a[248:251], a[208:211], a[128:135], v235
v_accvgpr_write_b32 a28, 0
v_accvgpr_write_b32 a29, 0
v_mfma_f32_16x16x32_bf16 v[72:75], a[160:163], a[200:203], v[72:75]
v_accvgpr_write_b32 a30, 0
v_accvgpr_write_b32 a31, 0
v_mfma_f32_16x16x32_bf16 v[104:107], a[160:163], a[204:207], v[104:107]
s_waitcnt vmcnt(13) lgkmcnt(0)
s_barrier
v_mfma_f32_16x16x32_bf16 v[76:79], a[164:167], a[200:203], v[76:79]
s_add_u32 m0, s45, 81920
ds_read_b128 a[192:195], v192 offset:0
ds_read_b128 a[196:199], v192 offset:2048
v_mfma_f32_16x16x32_bf16 v[108:111], a[164:167], a[204:207], v[108:111]
buffer_load_dwordx4 v144, s[24:27], s43 offen offset:0 lds
v_smfmac_f32_16x16x64_bf16 a[252:255], a[208:211], a[160:167], v235
ds_read_b64_tr_b16 a[128:129], v184 offset:0
ds_read_b64_tr_b16 a[130:131], v184 offset:2048
v_mfma_f32_16x16x32_bf16 v[16:19], a[136:139], a[200:203], v[16:19]
ds_read_b64_tr_b16 a[132:133], v185 offset:0
ds_read_b64_tr_b16 a[134:135], v185 offset:2048
v_mfma_f32_16x16x32_bf16 v[48:51], a[136:139], a[204:207], v[48:51]
ds_read_b64_tr_b16 a[160:161], v184 offset:256
ds_read_b64_tr_b16 a[162:163], v184 offset:2304
v_mfma_f32_16x16x32_bf16 v[20:23], a[140:143], a[200:203], v[20:23]
buffer_load_dwordx4 v145, s[24:27], s43 offen offset:1024 lds
v_mfma_f32_16x16x32_bf16 v[52:55], a[140:143], a[204:207], v[52:55]
ds_read_b64_tr_b16 a[164:165], v185 offset:256
ds_read_b64_tr_b16 a[166:167], v185 offset:2304
v_mfma_f32_16x16x32_bf16 v[24:27], a[144:147], a[200:203], v[24:27]
ds_read_b64_tr_b16 a[136:137], v186 offset:0
ds_read_b64_tr_b16 a[138:139], v186 offset:2048
v_mfma_f32_16x16x32_bf16 v[56:59], a[144:147], a[204:207], v[56:59]
s_add_u32 m0, s85, 81920
ds_read_b64_tr_b16 a[140:141], v187 offset:0
ds_read_b64_tr_b16 a[142:143], v187 offset:2048
v_mfma_f32_16x16x32_bf16 v[28:31], a[148:151], a[200:203], v[28:31]
buffer_load_dwordx4 v146, s[24:27], s43 offen offset:0 lds
v_mfma_f32_16x16x32_bf16 v[60:63], a[148:151], a[204:207], v[60:63]
ds_read_b64_tr_b16 a[144:145], v188 offset:0
ds_read_b64_tr_b16 a[146:147], v188 offset:2048
v_mfma_f32_16x16x32_bf16 v[32:35], a[152:155], a[200:203], v[32:35]
ds_read_b64_tr_b16 a[148:149], v189 offset:0
ds_read_b64_tr_b16 a[150:151], v189 offset:2048
v_mfma_f32_16x16x32_bf16 v[64:67], a[152:155], a[204:207], v[64:67]
ds_read_b64_tr_b16 a[152:153], v190 offset:0
ds_read_b64_tr_b16 a[154:155], v190 offset:2048
v_mfma_f32_16x16x32_bf16 v[36:39], a[156:159], a[200:203], v[36:39]
v_accvgpr_write_b32 a32, 0
v_accvgpr_write_b32 a33, 0
v_mfma_f32_16x16x32_bf16 v[68:71], a[156:159], a[204:207], v[68:71]
buffer_load_dwordx4 v147, s[24:27], s43 offen offset:1024 lds
v_mfma_f32_16x16x32_bf16 v[80:83], a[168:171], a[200:203], v[80:83]
ds_read_b64_tr_b16 a[156:157], v191 offset:0
ds_read_b64_tr_b16 a[158:159], v191 offset:2048
v_mfma_f32_16x16x32_bf16 v[112:115], a[168:171], a[204:207], v[112:115]
s_add_u32 s43, s43, 128
ds_read_b64_tr_b16 a[168:169], v186 offset:256
ds_read_b64_tr_b16 a[170:171], v186 offset:2304
v_mfma_f32_16x16x32_bf16 v[84:87], a[172:175], a[200:203], v[84:87]
s_add_u32 m0, s44, 49152
v_accvgpr_write_b32 a34, 0
v_accvgpr_write_b32 a35, 0
v_mfma_f32_16x16x32_bf16 v[116:119], a[172:175], a[204:207], v[116:119]
buffer_load_dwordx4 v136, s[16:19], s42 offen offset:0 lds
v_mfma_f32_16x16x32_bf16 v[88:91], a[176:179], a[200:203], v[88:91]
ds_read_b64_tr_b16 a[172:173], v187 offset:256
ds_read_b64_tr_b16 a[174:175], v187 offset:2304
v_mfma_f32_16x16x32_bf16 v[120:123], a[176:179], a[204:207], v[120:123]
ds_read_b64_tr_b16 a[176:177], v188 offset:256
ds_read_b64_tr_b16 a[178:179], v188 offset:2304
v_mfma_f32_16x16x32_bf16 v[92:95], a[180:183], a[200:203], v[92:95]
v_accvgpr_write_b32 a36, 0
v_accvgpr_write_b32 a37, 0
v_mfma_f32_16x16x32_bf16 v[124:127], a[180:183], a[204:207], v[124:127]
buffer_load_dwordx4 v137, s[16:19], s42 offen offset:1024 lds
v_mfma_f32_16x16x32_bf16 v[96:99], a[184:187], a[200:203], v[96:99]
ds_read_b64_tr_b16 a[180:181], v189 offset:256
ds_read_b64_tr_b16 a[182:183], v189 offset:2304
v_mfma_f32_16x16x32_bf16 v[128:131], a[184:187], a[204:207], v[128:131]
ds_read_b64_tr_b16 a[184:185], v190 offset:256
ds_read_b64_tr_b16 a[186:187], v190 offset:2304
v_mfma_f32_16x16x32_bf16 v[100:103], a[188:191], a[200:203], v[100:103]
v_mfma_f32_16x16x32_bf16 v[132:135], a[188:191], a[204:207], v[132:135]
s_waitcnt lgkmcnt(6)
ds_read_b64_tr_b16 a[188:189], v191 offset:256
ds_read_b64_tr_b16 a[190:191], v191 offset:2304
v_mfma_f32_16x16x32_bf16 v[8:11], a[128:131], a[192:195], v[8:11]
buffer_load_dwordx4 v138, s[16:19], s42 offen offset:2048 lds
v_mfma_f32_16x16x32_bf16 v[40:43], a[128:131], a[196:199], v[40:43]
ds_read_b128 a[200:203], v193 offset:0
ds_read_b128 a[204:207], v193 offset:2048
v_mfma_f32_16x16x32_bf16 v[12:15], a[132:135], a[192:195], v[12:15]
v_accvgpr_write_b32 a38, 0
v_accvgpr_write_b32 a39, 0
v_mfma_f32_16x16x32_bf16 v[44:47], a[132:135], a[196:199], v[44:47]
v_accvgpr_write_b32 a40, 0
v_accvgpr_write_b32 a41, 0
v_smfmac_f32_16x16x64_bf16 a[248:251], a[208:211], a[128:135], v235
buffer_load_dwordx4 v139, s[16:19], s42 offen offset:3072 lds
v_mfma_f32_16x16x32_bf16 v[72:75], a[160:163], a[192:195], v[72:75]
ds_read_b64_tr_b16 a[128:129], v184 offset:16384
ds_read_b64_tr_b16 a[130:131], v184 offset:18432
v_mfma_f32_16x16x32_bf16 v[104:107], a[160:163], a[196:199], v[104:107]
ds_read_b64_tr_b16 a[132:133], v185 offset:16384
ds_read_b64_tr_b16 a[134:135], v185 offset:18432
v_mfma_f32_16x16x32_bf16 v[76:79], a[164:167], a[192:195], v[76:79]
v_accvgpr_write_b32 a42, 0
v_accvgpr_write_b32 a43, 0
v_mfma_f32_16x16x32_bf16 v[108:111], a[164:167], a[196:199], v[108:111]
s_add_u32 m0, s44, 53248
v_accvgpr_write_b32 a44, 0
v_accvgpr_write_b32 a45, 0
v_smfmac_f32_16x16x64_bf16 a[252:255], a[208:211], a[160:167], v235
buffer_load_dwordx4 v140, s[16:19], s42 offen offset:0 lds
v_mfma_f32_16x16x32_bf16 v[16:19], a[136:139], a[192:195], v[16:19]
ds_read_b64_tr_b16 a[160:161], v184 offset:16640
ds_read_b64_tr_b16 a[162:163], v184 offset:18688
v_mfma_f32_16x16x32_bf16 v[48:51], a[136:139], a[196:199], v[48:51]
ds_read_b64_tr_b16 a[164:165], v185 offset:16640
ds_read_b64_tr_b16 a[166:167], v185 offset:18688
v_mfma_f32_16x16x32_bf16 v[20:23], a[140:143], a[192:195], v[20:23]
ds_read_b64_tr_b16 a[136:137], v186 offset:16384
ds_read_b64_tr_b16 a[138:139], v186 offset:18432
v_mfma_f32_16x16x32_bf16 v[52:55], a[140:143], a[196:199], v[52:55]
buffer_load_dwordx4 v141, s[16:19], s42 offen offset:1024 lds
v_mfma_f32_16x16x32_bf16 v[24:27], a[144:147], a[192:195], v[24:27]
ds_read_b64_tr_b16 a[140:141], v187 offset:16384
ds_read_b64_tr_b16 a[142:143], v187 offset:18432
v_mfma_f32_16x16x32_bf16 v[56:59], a[144:147], a[196:199], v[56:59]
ds_read_b64_tr_b16 a[144:145], v188 offset:16384
ds_read_b64_tr_b16 a[146:147], v188 offset:18432
v_mfma_f32_16x16x32_bf16 v[28:31], a[148:151], a[192:195], v[28:31]
v_accvgpr_write_b32 a46, 0
v_accvgpr_write_b32 a47, 0
v_mfma_f32_16x16x32_bf16 v[60:63], a[148:151], a[196:199], v[60:63]
buffer_load_dwordx4 v142, s[16:19], s42 offen offset:2048 lds
v_mfma_f32_16x16x32_bf16 v[32:35], a[152:155], a[192:195], v[32:35]
ds_read_b64_tr_b16 a[148:149], v189 offset:16384
ds_read_b64_tr_b16 a[150:151], v189 offset:18432
v_mfma_f32_16x16x32_bf16 v[64:67], a[152:155], a[196:199], v[64:67]
ds_read_b64_tr_b16 a[152:153], v190 offset:16384
ds_read_b64_tr_b16 a[154:155], v190 offset:18432
v_mfma_f32_16x16x32_bf16 v[36:39], a[156:159], a[192:195], v[36:39]
v_accvgpr_write_b32 a48, 0
v_accvgpr_write_b32 a49, 0
v_mfma_f32_16x16x32_bf16 v[68:71], a[156:159], a[196:199], v[68:71]
buffer_load_dwordx4 v143, s[16:19], s42 offen offset:3072 lds
v_mfma_f32_16x16x32_bf16 v[80:83], a[168:171], a[192:195], v[80:83]
ds_read_b64_tr_b16 a[156:157], v191 offset:16384
ds_read_b64_tr_b16 a[158:159], v191 offset:18432
v_mfma_f32_16x16x32_bf16 v[112:115], a[168:171], a[196:199], v[112:115]
ds_read_b64_tr_b16 a[168:169], v186 offset:16640
ds_read_b64_tr_b16 a[170:171], v186 offset:18688
v_mfma_f32_16x16x32_bf16 v[84:87], a[172:175], a[192:195], v[84:87]
s_add_u32 s42, s42, 524288
v_accvgpr_write_b32 a50, 0
v_accvgpr_write_b32 a51, 0
v_mfma_f32_16x16x32_bf16 v[116:119], a[172:175], a[196:199], v[116:119]
s_waitcnt lgkmcnt(6)
ds_read_b64_tr_b16 a[172:173], v187 offset:16640
ds_read_b64_tr_b16 a[174:175], v187 offset:18688
v_mfma_f32_16x16x32_bf16 v[88:91], a[176:179], a[192:195], v[88:91]
v_accvgpr_write_b32 a52, 0
v_accvgpr_write_b32 a53, 0
v_mfma_f32_16x16x32_bf16 v[120:123], a[176:179], a[196:199], v[120:123]
ds_read_b64_tr_b16 a[176:177], v188 offset:16640
ds_read_b64_tr_b16 a[178:179], v188 offset:18688
v_mfma_f32_16x16x32_bf16 v[92:95], a[180:183], a[192:195], v[92:95]
v_accvgpr_write_b32 a54, 0
v_accvgpr_write_b32 a55, 0
v_mfma_f32_16x16x32_bf16 v[124:127], a[180:183], a[196:199], v[124:127]
ds_read_b64_tr_b16 a[180:181], v189 offset:16640
ds_read_b64_tr_b16 a[182:183], v189 offset:18688
v_mfma_f32_16x16x32_bf16 v[96:99], a[184:187], a[192:195], v[96:99]
v_accvgpr_write_b32 a56, 0
v_accvgpr_write_b32 a57, 0
v_mfma_f32_16x16x32_bf16 v[128:131], a[184:187], a[196:199], v[128:131]
ds_read_b64_tr_b16 a[184:185], v190 offset:16640
ds_read_b64_tr_b16 a[186:187], v190 offset:18688
v_mfma_f32_16x16x32_bf16 v[100:103], a[188:191], a[192:195], v[100:103]
v_mfma_f32_16x16x32_bf16 v[132:135], a[188:191], a[196:199], v[132:135]
ds_read_b64_tr_b16 a[188:189], v191 offset:16640
ds_read_b64_tr_b16 a[190:191], v191 offset:18688
v_mfma_f32_16x16x32_bf16 v[8:11], a[128:131], a[200:203], v[8:11]
v_accvgpr_write_b32 a58, 0
v_accvgpr_write_b32 a59, 0
v_mfma_f32_16x16x32_bf16 v[40:43], a[128:131], a[204:207], v[40:43]
v_accvgpr_write_b32 a60, 0
v_accvgpr_write_b32 a61, 0
v_mfma_f32_16x16x32_bf16 v[12:15], a[132:135], a[200:203], v[12:15]
v_accvgpr_write_b32 a62, 0
v_accvgpr_write_b32 a63, 0
v_mfma_f32_16x16x32_bf16 v[44:47], a[132:135], a[204:207], v[44:47]
v_accvgpr_write_b32 a64, 0
v_accvgpr_write_b32 a65, 0
v_smfmac_f32_16x16x64_bf16 a[248:251], a[208:211], a[128:135], v235
v_accvgpr_write_b32 a66, 0
v_accvgpr_write_b32 a67, 0
v_mfma_f32_16x16x32_bf16 v[72:75], a[160:163], a[200:203], v[72:75]
v_accvgpr_write_b32 a68, 0
v_accvgpr_write_b32 a69, 0
v_mfma_f32_16x16x32_bf16 v[104:107], a[160:163], a[204:207], v[104:107]
s_waitcnt vmcnt(12) lgkmcnt(0)
s_barrier
v_mfma_f32_16x16x32_bf16 v[76:79], a[164:167], a[200:203], v[76:79]
s_add_u32 m0, s45, 32768
ds_read_b128 a[192:195], v202 offset:0
ds_read_b128 a[196:199], v202 offset:2048
v_mfma_f32_16x16x32_bf16 v[108:111], a[164:167], a[204:207], v[108:111]
buffer_load_dwordx4 v144, s[24:27], s43 offen offset:0 lds
v_smfmac_f32_16x16x64_bf16 a[252:255], a[208:211], a[160:167], v235
ds_read_b64_tr_b16 a[128:129], v194 offset:0
ds_read_b64_tr_b16 a[130:131], v194 offset:2048
v_mfma_f32_16x16x32_bf16 v[16:19], a[136:139], a[200:203], v[16:19]
ds_read_b64_tr_b16 a[132:133], v195 offset:0
ds_read_b64_tr_b16 a[134:135], v195 offset:2048
v_mfma_f32_16x16x32_bf16 v[48:51], a[136:139], a[204:207], v[48:51]
ds_read_b64_tr_b16 a[160:161], v194 offset:256
ds_read_b64_tr_b16 a[162:163], v194 offset:2304
v_mfma_f32_16x16x32_bf16 v[20:23], a[140:143], a[200:203], v[20:23]
ds_read_b64_tr_b16 a[164:165], v195 offset:256
ds_read_b64_tr_b16 a[166:167], v195 offset:2304
v_mfma_f32_16x16x32_bf16 v[52:55], a[140:143], a[204:207], v[52:55]
buffer_load_dwordx4 v145, s[24:27], s43 offen offset:1024 lds
v_mfma_f32_16x16x32_bf16 v[24:27], a[144:147], a[200:203], v[24:27]
ds_read_b64_tr_b16 a[136:137], v196 offset:0
ds_read_b64_tr_b16 a[138:139], v196 offset:2048
v_mfma_f32_16x16x32_bf16 v[56:59], a[144:147], a[204:207], v[56:59]
ds_read_b64_tr_b16 a[140:141], v197 offset:0
ds_read_b64_tr_b16 a[142:143], v197 offset:2048
v_mfma_f32_16x16x32_bf16 v[28:31], a[148:151], a[200:203], v[28:31]
s_add_u32 m0, s85, 32768
ds_read_b64_tr_b16 a[144:145], v198 offset:0
ds_read_b64_tr_b16 a[146:147], v198 offset:2048
v_mfma_f32_16x16x32_bf16 v[60:63], a[148:151], a[204:207], v[60:63]
buffer_load_dwordx4 v146, s[24:27], s43 offen offset:0 lds
v_mfma_f32_16x16x32_bf16 v[32:35], a[152:155], a[200:203], v[32:35]
ds_read_b64_tr_b16 a[148:149], v199 offset:0
ds_read_b64_tr_b16 a[150:151], v199 offset:2048
v_mfma_f32_16x16x32_bf16 v[64:67], a[152:155], a[204:207], v[64:67]
ds_read_b64_tr_b16 a[152:153], v200 offset:0
ds_read_b64_tr_b16 a[154:155], v200 offset:2048
v_mfma_f32_16x16x32_bf16 v[36:39], a[156:159], a[200:203], v[36:39]
v_accvgpr_write_b32 a70, 0
v_accvgpr_write_b32 a71, 0
v_mfma_f32_16x16x32_bf16 v[68:71], a[156:159], a[204:207], v[68:71]
buffer_load_dwordx4 v147, s[24:27], s43 offen offset:1024 lds
v_mfma_f32_16x16x32_bf16 v[80:83], a[168:171], a[200:203], v[80:83]
ds_read_b64_tr_b16 a[156:157], v201 offset:0
ds_read_b64_tr_b16 a[158:159], v201 offset:2048
v_mfma_f32_16x16x32_bf16 v[112:115], a[168:171], a[204:207], v[112:115]
s_add_u32 s43, s43, 128
ds_read_b64_tr_b16 a[168:169], v196 offset:256
ds_read_b64_tr_b16 a[170:171], v196 offset:2304
v_mfma_f32_16x16x32_bf16 v[84:87], a[172:175], a[200:203], v[84:87]
s_add_u32 m0, s44, 0
v_accvgpr_write_b32 a72, 0
v_accvgpr_write_b32 a73, 0
v_mfma_f32_16x16x32_bf16 v[116:119], a[172:175], a[204:207], v[116:119]
buffer_load_dwordx4 v136, s[16:19], s42 offen offset:0 lds
v_mfma_f32_16x16x32_bf16 v[88:91], a[176:179], a[200:203], v[88:91]
ds_read_b64_tr_b16 a[172:173], v197 offset:256
ds_read_b64_tr_b16 a[174:175], v197 offset:2304
v_mfma_f32_16x16x32_bf16 v[120:123], a[176:179], a[204:207], v[120:123]
ds_read_b64_tr_b16 a[176:177], v198 offset:256
ds_read_b64_tr_b16 a[178:179], v198 offset:2304
v_mfma_f32_16x16x32_bf16 v[92:95], a[180:183], a[200:203], v[92:95]
v_accvgpr_write_b32 a74, 0
v_accvgpr_write_b32 a75, 0
v_mfma_f32_16x16x32_bf16 v[124:127], a[180:183], a[204:207], v[124:127]
buffer_load_dwordx4 v137, s[16:19], s42 offen offset:1024 lds
v_mfma_f32_16x16x32_bf16 v[96:99], a[184:187], a[200:203], v[96:99]
ds_read_b64_tr_b16 a[180:181], v199 offset:256
ds_read_b64_tr_b16 a[182:183], v199 offset:2304
v_mfma_f32_16x16x32_bf16 v[128:131], a[184:187], a[204:207], v[128:131]
ds_read_b64_tr_b16 a[184:185], v200 offset:256
ds_read_b64_tr_b16 a[186:187], v200 offset:2304
v_mfma_f32_16x16x32_bf16 v[100:103], a[188:191], a[200:203], v[100:103]
v_mfma_f32_16x16x32_bf16 v[132:135], a[188:191], a[204:207], v[132:135]
s_waitcnt lgkmcnt(6)
ds_read_b64_tr_b16 a[188:189], v201 offset:256
ds_read_b64_tr_b16 a[190:191], v201 offset:2304
v_mfma_f32_16x16x32_bf16 v[8:11], a[128:131], a[192:195], v[8:11]
buffer_load_dwordx4 v138, s[16:19], s42 offen offset:2048 lds
v_mfma_f32_16x16x32_bf16 v[40:43], a[128:131], a[196:199], v[40:43]
ds_read_b128 a[200:203], v203 offset:0
ds_read_b128 a[204:207], v203 offset:2048
v_mfma_f32_16x16x32_bf16 v[12:15], a[132:135], a[192:195], v[12:15]
v_accvgpr_write_b32 a76, 0
v_accvgpr_write_b32 a77, 0
v_mfma_f32_16x16x32_bf16 v[44:47], a[132:135], a[196:199], v[44:47]
v_accvgpr_write_b32 a78, 0
v_accvgpr_write_b32 a79, 0
v_smfmac_f32_16x16x64_bf16 a[248:251], a[208:211], a[128:135], v235
buffer_load_dwordx4 v139, s[16:19], s42 offen offset:3072 lds
v_mfma_f32_16x16x32_bf16 v[72:75], a[160:163], a[192:195], v[72:75]
ds_read_b64_tr_b16 a[128:129], v194 offset:16384
ds_read_b64_tr_b16 a[130:131], v194 offset:18432
v_mfma_f32_16x16x32_bf16 v[104:107], a[160:163], a[196:199], v[104:107]
ds_read_b64_tr_b16 a[132:133], v195 offset:16384
ds_read_b64_tr_b16 a[134:135], v195 offset:18432
v_mfma_f32_16x16x32_bf16 v[76:79], a[164:167], a[192:195], v[76:79]
s_add_u32 m0, s44, 4096
v_accvgpr_write_b32 a80, 0
v_accvgpr_write_b32 a81, 0
v_mfma_f32_16x16x32_bf16 v[108:111], a[164:167], a[196:199], v[108:111]
buffer_load_dwordx4 v140, s[16:19], s42 offen offset:0 lds
v_smfmac_f32_16x16x64_bf16 a[252:255], a[208:211], a[160:167], v235
ds_read_b64_tr_b16 a[160:161], v194 offset:16640
ds_read_b64_tr_b16 a[162:163], v194 offset:18688
v_mfma_f32_16x16x32_bf16 v[16:19], a[136:139], a[192:195], v[16:19]
ds_read_b64_tr_b16 a[164:165], v195 offset:16640
ds_read_b64_tr_b16 a[166:167], v195 offset:18688
v_mfma_f32_16x16x32_bf16 v[48:51], a[136:139], a[196:199], v[48:51]
ds_read_b64_tr_b16 a[136:137], v196 offset:16384
ds_read_b64_tr_b16 a[138:139], v196 offset:18432
v_mfma_f32_16x16x32_bf16 v[20:23], a[140:143], a[192:195], v[20:23]
buffer_load_dwordx4 v141, s[16:19], s42 offen offset:1024 lds
v_mfma_f32_16x16x32_bf16 v[52:55], a[140:143], a[196:199], v[52:55]
ds_read_b64_tr_b16 a[140:141], v197 offset:16384
ds_read_b64_tr_b16 a[142:143], v197 offset:18432
v_mfma_f32_16x16x32_bf16 v[24:27], a[144:147], a[192:195], v[24:27]
v_accvgpr_write_b32 a82, 0
v_accvgpr_write_b32 a83, 0
v_mfma_f32_16x16x32_bf16 v[56:59], a[144:147], a[196:199], v[56:59]
ds_read_b64_tr_b16 a[144:145], v198 offset:16384
ds_read_b64_tr_b16 a[146:147], v198 offset:18432
v_mfma_f32_16x16x32_bf16 v[28:31], a[148:151], a[192:195], v[28:31]
buffer_load_dwordx4 v142, s[16:19], s42 offen offset:2048 lds
v_mfma_f32_16x16x32_bf16 v[60:63], a[148:151], a[196:199], v[60:63]
ds_read_b64_tr_b16 a[148:149], v199 offset:16384
ds_read_b64_tr_b16 a[150:151], v199 offset:18432
v_mfma_f32_16x16x32_bf16 v[32:35], a[152:155], a[192:195], v[32:35]
v_accvgpr_write_b32 a84, 0
v_accvgpr_write_b32 a85, 0
v_mfma_f32_16x16x32_bf16 v[64:67], a[152:155], a[196:199], v[64:67]
ds_read_b64_tr_b16 a[152:153], v200 offset:16384
ds_read_b64_tr_b16 a[154:155], v200 offset:18432
v_mfma_f32_16x16x32_bf16 v[36:39], a[156:159], a[192:195], v[36:39]
v_accvgpr_write_b32 a86, 0
v_accvgpr_write_b32 a87, 0
v_mfma_f32_16x16x32_bf16 v[68:71], a[156:159], a[196:199], v[68:71]
buffer_load_dwordx4 v143, s[16:19], s42 offen offset:3072 lds
v_mfma_f32_16x16x32_bf16 v[80:83], a[168:171], a[192:195], v[80:83]
s_add_u32 s42, s42, 524288
ds_read_b64_tr_b16 a[156:157], v201 offset:16384
ds_read_b64_tr_b16 a[158:159], v201 offset:18432
v_mfma_f32_16x16x32_bf16 v[112:115], a[168:171], a[196:199], v[112:115]
s_lshr_b32 s48, s2, 5
ds_read_b64_tr_b16 a[168:169], v196 offset:16640
ds_read_b64_tr_b16 a[170:171], v196 offset:18688
v_mfma_f32_16x16x32_bf16 v[84:87], a[172:175], a[192:195], v[84:87]
s_lshl_b32 s48, s48, 13
v_lshlrev_b32 v254, 5, v0
v_accvgpr_write_b32 a88, 0
v_mfma_f32_16x16x32_bf16 v[116:119], a[172:175], a[196:199], v[116:119]
s_waitcnt lgkmcnt(6)
buffer_load_dword v252, v254, s[8:11], s48 offen
v_mfma_f32_16x16x32_bf16 v[88:91], a[176:179], a[192:195], v[88:91]
ds_read_b64_tr_b16 a[172:173], v197 offset:16640
ds_read_b64_tr_b16 a[174:175], v197 offset:18688
v_mfma_f32_16x16x32_bf16 v[120:123], a[176:179], a[196:199], v[120:123]
ds_read_b64_tr_b16 a[176:177], v198 offset:16640
ds_read_b64_tr_b16 a[178:179], v198 offset:18688
v_mfma_f32_16x16x32_bf16 v[92:95], a[180:183], a[192:195], v[92:95]
v_accvgpr_write_b32 a89, 0
v_accvgpr_write_b32 a90, 0
v_mfma_f32_16x16x32_bf16 v[124:127], a[180:183], a[196:199], v[124:127]
buffer_load_dword v253, v254, s[12:15], s48 offen
v_mfma_f32_16x16x32_bf16 v[96:99], a[184:187], a[192:195], v[96:99]
ds_read_b64_tr_b16 a[180:181], v199 offset:16640
ds_read_b64_tr_b16 a[182:183], v199 offset:18688
v_mfma_f32_16x16x32_bf16 v[128:131], a[184:187], a[196:199], v[128:131]
ds_read_b64_tr_b16 a[184:185], v200 offset:16640
ds_read_b64_tr_b16 a[186:187], v200 offset:18688
v_mfma_f32_16x16x32_bf16 v[100:103], a[188:191], a[192:195], v[100:103]
v_accvgpr_write_b32 a91, 0
v_mfma_f32_16x16x32_bf16 v[132:135], a[188:191], a[196:199], v[132:135]
ds_read_b64_tr_b16 a[188:189], v201 offset:16640
ds_read_b64_tr_b16 a[190:191], v201 offset:18688
v_mfma_f32_16x16x32_bf16 v[8:11], a[128:131], a[200:203], v[8:11]
v_accvgpr_write_b32 a92, 0
v_accvgpr_write_b32 a93, 0
v_mfma_f32_16x16x32_bf16 v[40:43], a[128:131], a[204:207], v[40:43]
v_accvgpr_write_b32 a94, 0
v_accvgpr_write_b32 a95, 0
v_mfma_f32_16x16x32_bf16 v[12:15], a[132:135], a[200:203], v[12:15]
v_accvgpr_write_b32 a96, 0
v_accvgpr_write_b32 a97, 0
v_mfma_f32_16x16x32_bf16 v[44:47], a[132:135], a[204:207], v[44:47]
v_accvgpr_write_b32 a98, 0
v_accvgpr_write_b32 a99, 0
v_smfmac_f32_16x16x64_bf16 a[248:251], a[208:211], a[128:135], v235
v_accvgpr_write_b32 a100, 0
v_accvgpr_write_b32 a101, 0
v_mfma_f32_16x16x32_bf16 v[72:75], a[160:163], a[200:203], v[72:75]
v_accvgpr_write_b32 a102, 0
v_accvgpr_write_b32 a103, 0
v_mfma_f32_16x16x32_bf16 v[104:107], a[160:163], a[204:207], v[104:107]
s_waitcnt vmcnt(14) lgkmcnt(0)
s_barrier
v_mfma_f32_16x16x32_bf16 v[76:79], a[164:167], a[200:203], v[76:79]
s_add_u32 m0, s45, 131072
ds_read_b128 a[192:195], v212 offset:0
ds_read_b128 a[196:199], v212 offset:2048
v_mfma_f32_16x16x32_bf16 v[108:111], a[164:167], a[204:207], v[108:111]
buffer_load_dwordx4 v144, s[24:27], s43 offen offset:0 lds
v_smfmac_f32_16x16x64_bf16 a[252:255], a[208:211], a[160:167], v235
ds_read_b64_tr_b16 a[128:129], v204 offset:0
ds_read_b64_tr_b16 a[130:131], v204 offset:2048
v_mfma_f32_16x16x32_bf16 v[16:19], a[136:139], a[200:203], v[16:19]
ds_read_b64_tr_b16 a[132:133], v205 offset:0
ds_read_b64_tr_b16 a[134:135], v205 offset:2048
v_mfma_f32_16x16x32_bf16 v[48:51], a[136:139], a[204:207], v[48:51]
ds_read_b64_tr_b16 a[160:161], v204 offset:256
ds_read_b64_tr_b16 a[162:163], v204 offset:2304
v_mfma_f32_16x16x32_bf16 v[20:23], a[140:143], a[200:203], v[20:23]
buffer_load_dwordx4 v145, s[24:27], s43 offen offset:1024 lds
v_mfma_f32_16x16x32_bf16 v[52:55], a[140:143], a[204:207], v[52:55]
ds_read_b64_tr_b16 a[164:165], v205 offset:256
ds_read_b64_tr_b16 a[166:167], v205 offset:2304
v_mfma_f32_16x16x32_bf16 v[24:27], a[144:147], a[200:203], v[24:27]
ds_read_b64_tr_b16 a[136:137], v206 offset:0
ds_read_b64_tr_b16 a[138:139], v206 offset:2048
v_mfma_f32_16x16x32_bf16 v[56:59], a[144:147], a[204:207], v[56:59]
ds_read_b64_tr_b16 a[140:141], v207 offset:0
ds_read_b64_tr_b16 a[142:143], v207 offset:2048
v_mfma_f32_16x16x32_bf16 v[28:31], a[148:151], a[200:203], v[28:31]
s_add_u32 m0, s85, 131072
ds_read_b64_tr_b16 a[144:145], v208 offset:0
ds_read_b64_tr_b16 a[146:147], v208 offset:2048
v_mfma_f32_16x16x32_bf16 v[60:63], a[148:151], a[204:207], v[60:63]
buffer_load_dwordx4 v146, s[24:27], s43 offen offset:0 lds
v_mfma_f32_16x16x32_bf16 v[32:35], a[152:155], a[200:203], v[32:35]
ds_read_b64_tr_b16 a[148:149], v209 offset:0
ds_read_b64_tr_b16 a[150:151], v209 offset:2048
v_mfma_f32_16x16x32_bf16 v[64:67], a[152:155], a[204:207], v[64:67]
ds_read_b64_tr_b16 a[152:153], v210 offset:0
ds_read_b64_tr_b16 a[154:155], v210 offset:2048
v_mfma_f32_16x16x32_bf16 v[36:39], a[156:159], a[200:203], v[36:39]
v_accvgpr_write_b32 a104, 0
v_accvgpr_write_b32 a105, 0
v_mfma_f32_16x16x32_bf16 v[68:71], a[156:159], a[204:207], v[68:71]
buffer_load_dwordx4 v147, s[24:27], s43 offen offset:1024 lds
v_mfma_f32_16x16x32_bf16 v[80:83], a[168:171], a[200:203], v[80:83]
ds_read_b64_tr_b16 a[156:157], v211 offset:0
ds_read_b64_tr_b16 a[158:159], v211 offset:2048
v_mfma_f32_16x16x32_bf16 v[112:115], a[168:171], a[204:207], v[112:115]
s_add_u32 s43, s43, 128
ds_read_b64_tr_b16 a[168:169], v206 offset:256
ds_read_b64_tr_b16 a[170:171], v206 offset:2304
v_mfma_f32_16x16x32_bf16 v[84:87], a[172:175], a[200:203], v[84:87]
s_add_u32 m0, s44, 98304
v_accvgpr_write_b32 a106, 0
v_accvgpr_write_b32 a107, 0
v_mfma_f32_16x16x32_bf16 v[116:119], a[172:175], a[204:207], v[116:119]
buffer_load_dwordx4 v136, s[16:19], s42 offen offset:0 lds
v_mfma_f32_16x16x32_bf16 v[88:91], a[176:179], a[200:203], v[88:91]
ds_read_b64_tr_b16 a[172:173], v207 offset:256
ds_read_b64_tr_b16 a[174:175], v207 offset:2304
v_mfma_f32_16x16x32_bf16 v[120:123], a[176:179], a[204:207], v[120:123]
ds_read_b64_tr_b16 a[176:177], v208 offset:256
ds_read_b64_tr_b16 a[178:179], v208 offset:2304
v_mfma_f32_16x16x32_bf16 v[92:95], a[180:183], a[200:203], v[92:95]
v_accvgpr_write_b32 a108, 0
v_accvgpr_write_b32 a109, 0
v_mfma_f32_16x16x32_bf16 v[124:127], a[180:183], a[204:207], v[124:127]
buffer_load_dwordx4 v137, s[16:19], s42 offen offset:1024 lds
v_mfma_f32_16x16x32_bf16 v[96:99], a[184:187], a[200:203], v[96:99]
ds_read_b64_tr_b16 a[180:181], v209 offset:256
ds_read_b64_tr_b16 a[182:183], v209 offset:2304
v_mfma_f32_16x16x32_bf16 v[128:131], a[184:187], a[204:207], v[128:131]
ds_read_b64_tr_b16 a[184:185], v210 offset:256
ds_read_b64_tr_b16 a[186:187], v210 offset:2304
v_mfma_f32_16x16x32_bf16 v[100:103], a[188:191], a[200:203], v[100:103]
v_mfma_f32_16x16x32_bf16 v[132:135], a[188:191], a[204:207], v[132:135]
s_waitcnt lgkmcnt(6)
ds_read_b64_tr_b16 a[188:189], v211 offset:256
ds_read_b64_tr_b16 a[190:191], v211 offset:2304
v_mfma_f32_16x16x32_bf16 v[8:11], a[128:131], a[192:195], v[8:11]
buffer_load_dwordx4 v138, s[16:19], s42 offen offset:2048 lds
v_mfma_f32_16x16x32_bf16 v[40:43], a[128:131], a[196:199], v[40:43]
ds_read_b128 a[200:203], v213 offset:0
ds_read_b128 a[204:207], v213 offset:2048
v_mfma_f32_16x16x32_bf16 v[12:15], a[132:135], a[192:195], v[12:15]
v_accvgpr_write_b32 a110, 0
v_accvgpr_write_b32 a111, 0
v_mfma_f32_16x16x32_bf16 v[44:47], a[132:135], a[196:199], v[44:47]
v_accvgpr_write_b32 a112, 0
v_accvgpr_write_b32 a113, 0
v_smfmac_f32_16x16x64_bf16 a[248:251], a[208:211], a[128:135], v235
ds_read_b64_tr_b16 a[128:129], v204 offset:16384
ds_read_b64_tr_b16 a[130:131], v204 offset:18432
v_mfma_f32_16x16x32_bf16 v[72:75], a[160:163], a[192:195], v[72:75]
buffer_load_dwordx4 v139, s[16:19], s42 offen offset:3072 lds
v_mfma_f32_16x16x32_bf16 v[104:107], a[160:163], a[196:199], v[104:107]
ds_read_b64_tr_b16 a[132:133], v205 offset:16384
ds_read_b64_tr_b16 a[134:135], v205 offset:18432
v_mfma_f32_16x16x32_bf16 v[76:79], a[164:167], a[192:195], v[76:79]
v_accvgpr_write_b32 a114, 0
v_accvgpr_write_b32 a115, 0
v_mfma_f32_16x16x32_bf16 v[108:111], a[164:167], a[196:199], v[108:111]
s_add_u32 m0, s44, 102400
v_accvgpr_write_b32 a116, 0
v_accvgpr_write_b32 a117, 0
v_smfmac_f32_16x16x64_bf16 a[252:255], a[208:211], a[160:167], v235
buffer_load_dwordx4 v140, s[16:19], s42 offen offset:0 lds
v_mfma_f32_16x16x32_bf16 v[16:19], a[136:139], a[192:195], v[16:19]
ds_read_b64_tr_b16 a[160:161], v204 offset:16640
ds_read_b64_tr_b16 a[162:163], v204 offset:18688
v_mfma_f32_16x16x32_bf16 v[48:51], a[136:139], a[196:199], v[48:51]
ds_read_b64_tr_b16 a[164:165], v205 offset:16640
ds_read_b64_tr_b16 a[166:167], v205 offset:18688
v_mfma_f32_16x16x32_bf16 v[20:23], a[140:143], a[192:195], v[20:23]
ds_read_b64_tr_b16 a[136:137], v206 offset:16384
ds_read_b64_tr_b16 a[138:139], v206 offset:18432
v_mfma_f32_16x16x32_bf16 v[52:55], a[140:143], a[196:199], v[52:55]
buffer_load_dwordx4 v141, s[16:19], s42 offen offset:1024 lds
v_mfma_f32_16x16x32_bf16 v[24:27], a[144:147], a[192:195], v[24:27]
ds_read_b64_tr_b16 a[140:141], v207 offset:16384
ds_read_b64_tr_b16 a[142:143], v207 offset:18432
v_mfma_f32_16x16x32_bf16 v[56:59], a[144:147], a[196:199], v[56:59]
ds_read_b64_tr_b16 a[144:145], v208 offset:16384
ds_read_b64_tr_b16 a[146:147], v208 offset:18432
v_mfma_f32_16x16x32_bf16 v[28:31], a[148:151], a[192:195], v[28:31]
v_accvgpr_write_b32 a118, 0
v_accvgpr_write_b32 a119, 0
v_mfma_f32_16x16x32_bf16 v[60:63], a[148:151], a[196:199], v[60:63]
buffer_load_dwordx4 v142, s[16:19], s42 offen offset:2048 lds
v_mfma_f32_16x16x32_bf16 v[32:35], a[152:155], a[192:195], v[32:35]
ds_read_b64_tr_b16 a[148:149], v209 offset:16384
ds_read_b64_tr_b16 a[150:151], v209 offset:18432
v_mfma_f32_16x16x32_bf16 v[64:67], a[152:155], a[196:199], v[64:67]
ds_read_b64_tr_b16 a[152:153], v210 offset:16384
ds_read_b64_tr_b16 a[154:155], v210 offset:18432
v_mfma_f32_16x16x32_bf16 v[36:39], a[156:159], a[192:195], v[36:39]
v_accvgpr_write_b32 a120, 0
v_accvgpr_write_b32 a121, 0
v_mfma_f32_16x16x32_bf16 v[68:71], a[156:159], a[196:199], v[68:71]
buffer_load_dwordx4 v143, s[16:19], s42 offen offset:3072 lds
v_mfma_f32_16x16x32_bf16 v[80:83], a[168:171], a[192:195], v[80:83]
ds_read_b64_tr_b16 a[156:157], v211 offset:16384
ds_read_b64_tr_b16 a[158:159], v211 offset:18432
v_mfma_f32_16x16x32_bf16 v[112:115], a[168:171], a[196:199], v[112:115]
ds_read_b64_tr_b16 a[168:169], v206 offset:16640
ds_read_b64_tr_b16 a[170:171], v206 offset:18688
v_mfma_f32_16x16x32_bf16 v[84:87], a[172:175], a[192:195], v[84:87]
s_waitcnt lgkmcnt(6)
v_accvgpr_write_b32 a122, 0
v_accvgpr_write_b32 a123, 0
v_mfma_f32_16x16x32_bf16 v[116:119], a[172:175], a[196:199], v[116:119]
s_add_u32 s42, s42, 524288
ds_read_b64_tr_b16 a[172:173], v207 offset:16640
ds_read_b64_tr_b16 a[174:175], v207 offset:18688
v_mfma_f32_16x16x32_bf16 v[88:91], a[176:179], a[192:195], v[88:91]
v_accvgpr_write_b32 a124, 0
v_accvgpr_write_b32 a125, 0
v_mfma_f32_16x16x32_bf16 v[120:123], a[176:179], a[196:199], v[120:123]
ds_read_b64_tr_b16 a[176:177], v208 offset:16640
ds_read_b64_tr_b16 a[178:179], v208 offset:18688
v_mfma_f32_16x16x32_bf16 v[92:95], a[180:183], a[192:195], v[92:95]
v_accvgpr_write_b32 a126, 0
v_accvgpr_write_b32 a127, 0
v_mfma_f32_16x16x32_bf16 v[124:127], a[180:183], a[196:199], v[124:127]
ds_read_b64_tr_b16 a[180:181], v209 offset:16640
ds_read_b64_tr_b16 a[182:183], v209 offset:18688
v_mfma_f32_16x16x32_bf16 v[96:99], a[184:187], a[192:195], v[96:99]
v_mfma_f32_16x16x32_bf16 v[128:131], a[184:187], a[196:199], v[128:131]
ds_read_b64_tr_b16 a[184:185], v210 offset:16640
ds_read_b64_tr_b16 a[186:187], v210 offset:18688
v_mfma_f32_16x16x32_bf16 v[100:103], a[188:191], a[192:195], v[100:103]
v_mfma_f32_16x16x32_bf16 v[132:135], a[188:191], a[196:199], v[132:135]
ds_read_b64_tr_b16 a[188:189], v211 offset:16640
ds_read_b64_tr_b16 a[190:191], v211 offset:18688
v_mfma_f32_16x16x32_bf16 v[8:11], a[128:131], a[200:203], v[8:11]
v_mfma_f32_16x16x32_bf16 v[40:43], a[128:131], a[204:207], v[40:43]
v_mfma_f32_16x16x32_bf16 v[12:15], a[132:135], a[200:203], v[12:15]
v_mfma_f32_16x16x32_bf16 v[44:47], a[132:135], a[204:207], v[44:47]
v_smfmac_f32_16x16x64_bf16 a[248:251], a[208:211], a[128:135], v235
v_mfma_f32_16x16x32_bf16 v[72:75], a[160:163], a[200:203], v[72:75]
v_mfma_f32_16x16x32_bf16 v[104:107], a[160:163], a[204:207], v[104:107]
s_waitcnt vmcnt(14) lgkmcnt(0)
s_barrier
s_cmp_lg_u32 s32, 0
s_cbranch_scc1 K_W0_11
v_lshlrev_b32 v255, 4, v3
buffer_load_dword v254, v255, s[28:31], 0 offen sc0 sc1
K_W0_11:
v_mfma_f32_16x16x32_bf16 v[76:79], a[164:167], a[200:203], v[76:79]
s_add_u32 m0, s45, 81920
ds_read_b128 a[192:195], v192 offset:0
ds_read_b128 a[196:199], v192 offset:2048
v_mfma_f32_16x16x32_bf16 v[108:111], a[164:167], a[204:207], v[108:111]
buffer_load_dwordx4 v144, s[24:27], s43 offen offset:0 lds
v_smfmac_f32_16x16x64_bf16 a[252:255], a[208:211], a[160:167], v235
ds_read_b64_tr_b16 a[128:129], v184 offset:0
ds_read_b64_tr_b16 a[130:131], v184 offset:2048
v_mfma_f32_16x16x32_bf16 v[16:19], a[136:139], a[200:203], v[16:19]
ds_read_b64_tr_b16 a[132:133], v185 offset:0
ds_read_b64_tr_b16 a[134:135], v185 offset:2048
v_mfma_f32_16x16x32_bf16 v[48:51], a[136:139], a[204:207], v[48:51]
ds_read_b64_tr_b16 a[160:161], v184 offset:256
ds_read_b64_tr_b16 a[162:163], v184 offset:2304
v_mfma_f32_16x16x32_bf16 v[20:23], a[140:143], a[200:203], v[20:23]
buffer_load_dwordx4 v145, s[24:27], s43 offen offset:1024 lds
v_mfma_f32_16x16x32_bf16 v[52:55], a[140:143], a[204:207], v[52:55]
ds_read_b64_tr_b16 a[164:165], v185 offset:256
ds_read_b64_tr_b16 a[166:167], v185 offset:2304
v_mfma_f32_16x16x32_bf16 v[24:27], a[144:147], a[200:203], v[24:27]
ds_read_b64_tr_b16 a[136:137], v186 offset:0
ds_read_b64_tr_b16 a[138:139], v186 offset:2048
v_mfma_f32_16x16x32_bf16 v[56:59], a[144:147], a[204:207], v[56:59]
s_add_u32 m0, s85, 81920
ds_read_b64_tr_b16 a[140:141], v187 offset:0
ds_read_b64_tr_b16 a[142:143], v187 offset:2048
v_mfma_f32_16x16x32_bf16 v[28:31], a[148:151], a[200:203], v[28:31]
buffer_load_dwordx4 v146, s[24:27], s43 offen offset:0 lds
v_mfma_f32_16x16x32_bf16 v[60:63], a[148:151], a[204:207], v[60:63]
ds_read_b64_tr_b16 a[144:145], v188 offset:0
ds_read_b64_tr_b16 a[146:147], v188 offset:2048
v_mfma_f32_16x16x32_bf16 v[32:35], a[152:155], a[200:203], v[32:35]
ds_read_b64_tr_b16 a[148:149], v189 offset:0
ds_read_b64_tr_b16 a[150:151], v189 offset:2048
v_mfma_f32_16x16x32_bf16 v[64:67], a[152:155], a[204:207], v[64:67]
ds_read_b64_tr_b16 a[152:153], v190 offset:0
ds_read_b64_tr_b16 a[154:155], v190 offset:2048
v_mfma_f32_16x16x32_bf16 v[36:39], a[156:159], a[200:203], v[36:39]
buffer_load_dwordx4 v147, s[24:27], s43 offen offset:1024 lds
v_mfma_f32_16x16x32_bf16 v[68:71], a[156:159], a[204:207], v[68:71]
ds_read_b64_tr_b16 a[156:157], v191 offset:0
ds_read_b64_tr_b16 a[158:159], v191 offset:2048
v_mfma_f32_16x16x32_bf16 v[80:83], a[168:171], a[200:203], v[80:83]
s_add_u32 s43, s43, 128
v_mfma_f32_16x16x32_bf16 v[112:115], a[168:171], a[204:207], v[112:115]
s_add_u32 m0, s44, 49152
ds_read_b64_tr_b16 a[168:169], v186 offset:256
ds_read_b64_tr_b16 a[170:171], v186 offset:2304
v_mfma_f32_16x16x32_bf16 v[84:87], a[172:175], a[200:203], v[84:87]
buffer_load_dwordx4 v136, s[16:19], s42 offen offset:0 lds
v_mfma_f32_16x16x32_bf16 v[116:119], a[172:175], a[204:207], v[116:119]
ds_read_b64_tr_b16 a[172:173], v187 offset:256
ds_read_b64_tr_b16 a[174:175], v187 offset:2304
v_mfma_f32_16x16x32_bf16 v[88:91], a[176:179], a[200:203], v[88:91]
v_mfma_f32_16x16x32_bf16 v[120:123], a[176:179], a[204:207], v[120:123]
ds_read_b64_tr_b16 a[176:177], v188 offset:256
ds_read_b64_tr_b16 a[178:179], v188 offset:2304
v_mfma_f32_16x16x32_bf16 v[92:95], a[180:183], a[200:203], v[92:95]
v_mfma_f32_16x16x32_bf16 v[124:127], a[180:183], a[204:207], v[124:127]
buffer_load_dwordx4 v137, s[16:19], s42 offen offset:1024 lds
v_mfma_f32_16x16x32_bf16 v[96:99], a[184:187], a[200:203], v[96:99]
ds_read_b64_tr_b16 a[180:181], v189 offset:256
ds_read_b64_tr_b16 a[182:183], v189 offset:2304
v_mfma_f32_16x16x32_bf16 v[128:131], a[184:187], a[204:207], v[128:131]
ds_read_b64_tr_b16 a[184:185], v190 offset:256
ds_read_b64_tr_b16 a[186:187], v190 offset:2304
v_mfma_f32_16x16x32_bf16 v[100:103], a[188:191], a[200:203], v[100:103]
v_mfma_f32_16x16x32_bf16 v[132:135], a[188:191], a[204:207], v[132:135]
s_waitcnt lgkmcnt(6)
ds_read_b64_tr_b16 a[188:189], v191 offset:256
ds_read_b64_tr_b16 a[190:191], v191 offset:2304
v_mfma_f32_16x16x32_bf16 v[8:11], a[128:131], a[192:195], v[8:11]
buffer_load_dwordx4 v138, s[16:19], s42 offen offset:2048 lds
v_mfma_f32_16x16x32_bf16 v[40:43], a[128:131], a[196:199], v[40:43]
ds_read_b128 a[200:203], v193 offset:0
ds_read_b128 a[204:207], v193 offset:2048
v_mfma_f32_16x16x32_bf16 v[12:15], a[132:135], a[192:195], v[12:15]
v_mfma_f32_16x16x32_bf16 v[44:47], a[132:135], a[196:199], v[44:47]
v_smfmac_f32_16x16x64_bf16 a[248:251], a[208:211], a[128:135], v235
buffer_load_dwordx4 v139, s[16:19], s42 offen offset:3072 lds
v_mfma_f32_16x16x32_bf16 v[72:75], a[160:163], a[192:195], v[72:75]
ds_read_b64_tr_b16 a[128:129], v184 offset:16384
ds_read_b64_tr_b16 a[130:131], v184 offset:18432
v_mfma_f32_16x16x32_bf16 v[104:107], a[160:163], a[196:199], v[104:107]
ds_read_b64_tr_b16 a[132:133], v185 offset:16384
ds_read_b64_tr_b16 a[134:135], v185 offset:18432
v_mfma_f32_16x16x32_bf16 v[76:79], a[164:167], a[192:195], v[76:79]
s_add_u32 m0, s44, 53248
v_mfma_f32_16x16x32_bf16 v[108:111], a[164:167], a[196:199], v[108:111]
buffer_load_dwordx4 v140, s[16:19], s42 offen offset:0 lds
v_smfmac_f32_16x16x64_bf16 a[252:255], a[208:211], a[160:167], v235
ds_read_b64_tr_b16 a[160:161], v184 offset:16640
ds_read_b64_tr_b16 a[162:163], v184 offset:18688
v_mfma_f32_16x16x32_bf16 v[16:19], a[136:139], a[192:195], v[16:19]
ds_read_b64_tr_b16 a[164:165], v185 offset:16640
ds_read_b64_tr_b16 a[166:167], v185 offset:18688
v_mfma_f32_16x16x32_bf16 v[48:51], a[136:139], a[196:199], v[48:51]
ds_read_b64_tr_b16 a[136:137], v186 offset:16384
ds_read_b64_tr_b16 a[138:139], v186 offset:18432
v_mfma_f32_16x16x32_bf16 v[20:23], a[140:143], a[192:195], v[20:23]
buffer_load_dwordx4 v141, s[16:19], s42 offen offset:1024 lds
v_mfma_f32_16x16x32_bf16 v[52:55], a[140:143], a[196:199], v[52:55]
ds_read_b64_tr_b16 a[140:141], v187 offset:16384
ds_read_b64_tr_b16 a[142:143], v187 offset:18432
v_mfma_f32_16x16x32_bf16 v[24:27], a[144:147], a[192:195], v[24:27]
v_mfma_f32_16x16x32_bf16 v[56:59], a[144:147], a[196:199], v[56:59]
ds_read_b64_tr_b16 a[144:145], v188 offset:16384
ds_read_b64_tr_b16 a[146:147], v188 offset:18432
v_mfma_f32_16x16x32_bf16 v[28:31], a[148:151], a[192:195], v[28:31]
v_mfma_f32_16x16x32_bf16 v[60:63], a[148:151], a[196:199], v[60:63]
buffer_load_dwordx4 v142, s[16:19], s42 offen offset:2048 lds
v_mfma_f32_16x16x32_bf16 v[32:35], a[152:155], a[192:195], v[32:35]
ds_read_b64_tr_b16 a[148:149], v189 offset:16384
ds_read_b64_tr_b16 a[150:151], v189 offset:18432
v_mfma_f32_16x16x32_bf16 v[64:67], a[152:155], a[196:199], v[64:67]
ds_read_b64_tr_b16 a[152:153], v190 offset:16384
ds_read_b64_tr_b16 a[154:155], v190 offset:18432
v_mfma_f32_16x16x32_bf16 v[36:39], a[156:159], a[192:195], v[36:39]
v_mfma_f32_16x16x32_bf16 v[68:71], a[156:159], a[196:199], v[68:71]
buffer_load_dwordx4 v143, s[16:19], s42 offen offset:3072 lds
v_mfma_f32_16x16x32_bf16 v[80:83], a[168:171], a[192:195], v[80:83]
ds_read_b64_tr_b16 a[156:157], v191 offset:16384
ds_read_b64_tr_b16 a[158:159], v191 offset:18432
v_mfma_f32_16x16x32_bf16 v[112:115], a[168:171], a[196:199], v[112:115]
ds_read_b64_tr_b16 a[168:169], v186 offset:16640
ds_read_b64_tr_b16 a[170:171], v186 offset:18688
v_mfma_f32_16x16x32_bf16 v[84:87], a[172:175], a[192:195], v[84:87]
s_add_u32 s42, s42, 524288
v_mfma_f32_16x16x32_bf16 v[116:119], a[172:175], a[196:199], v[116:119]
s_waitcnt lgkmcnt(6)
ds_read_b64_tr_b16 a[172:173], v187 offset:16640
ds_read_b64_tr_b16 a[174:175], v187 offset:18688
v_mfma_f32_16x16x32_bf16 v[88:91], a[176:179], a[192:195], v[88:91]
v_mfma_f32_16x16x32_bf16 v[120:123], a[176:179], a[196:199], v[120:123]
ds_read_b64_tr_b16 a[176:177], v188 offset:16640
ds_read_b64_tr_b16 a[178:179], v188 offset:18688
v_mfma_f32_16x16x32_bf16 v[92:95], a[180:183], a[192:195], v[92:95]
v_mfma_f32_16x16x32_bf16 v[124:127], a[180:183], a[196:199], v[124:127]
ds_read_b64_tr_b16 a[180:181], v189 offset:16640
ds_read_b64_tr_b16 a[182:183], v189 offset:18688
v_mfma_f32_16x16x32_bf16 v[96:99], a[184:187], a[192:195], v[96:99]
v_mfma_f32_16x16x32_bf16 v[128:131], a[184:187], a[196:199], v[128:131]
ds_read_b64_tr_b16 a[184:185], v190 offset:16640
ds_read_b64_tr_b16 a[186:187], v190 offset:18688
v_mfma_f32_16x16x32_bf16 v[100:103], a[188:191], a[192:195], v[100:103]
v_mfma_f32_16x16x32_bf16 v[132:135], a[188:191], a[196:199], v[132:135]
ds_read_b64_tr_b16 a[188:189], v191 offset:16640
ds_read_b64_tr_b16 a[190:191], v191 offset:18688
v_mfma_f32_16x16x32_bf16 v[8:11], a[128:131], a[200:203], v[8:11]
v_mfma_f32_16x16x32_bf16 v[40:43], a[128:131], a[204:207], v[40:43]
v_mfma_f32_16x16x32_bf16 v[12:15], a[132:135], a[200:203], v[12:15]
v_mfma_f32_16x16x32_bf16 v[44:47], a[132:135], a[204:207], v[44:47]
v_smfmac_f32_16x16x64_bf16 a[248:251], a[208:211], a[128:135], v235
v_mfma_f32_16x16x32_bf16 v[72:75], a[160:163], a[200:203], v[72:75]
v_mfma_f32_16x16x32_bf16 v[104:107], a[160:163], a[204:207], v[104:107]
s_cmp_lg_u32 s32, 0
s_cbranch_scc1 K_CNTOK
s_waitcnt vmcnt(12)
v_cmp_gt_u32 vcc, 16, v254
s_cbranch_vccz K_CNTOK
K_CNTSPIN:
s_sleep 2
s_add_u32 s100, s100, 1
s_bitcmp1_b32 s100, 19
s_cbranch_scc1 K_END
buffer_load_dword v254, v255, s[28:31], 0 offen sc0 sc1
s_waitcnt vmcnt(0)
v_cmp_gt_u32 vcc, 16, v254
s_cbranch_vccnz K_CNTSPIN
K_CNTOK:
s_waitcnt vmcnt(12) lgkmcnt(0)
s_barrier
v_mfma_f32_16x16x32_bf16 v[76:79], a[164:167], a[200:203], v[76:79]
s_mov_b32 s38, 0
ds_read_b128 a[192:195], v202 offset:0
ds_read_b128 a[196:199], v202 offset:2048
v_mfma_f32_16x16x32_bf16 v[108:111], a[164:167], a[204:207], v[108:111]
s_add_u32 m0, s37, 32768
ds_read_b64_tr_b16 a[128:129], v194 offset:0
ds_read_b64_tr_b16 a[130:131], v194 offset:2048
v_smfmac_f32_16x16x64_bf16 a[252:255], a[208:211], a[160:167], v235
buffer_load_dwordx4 v228, s[8:11], s38 offen offset:0 lds
v_mfma_f32_16x16x32_bf16 v[16:19], a[136:139], a[200:203], v[16:19]
ds_read_b64_tr_b16 a[132:133], v195 offset:0
ds_read_b64_tr_b16 a[134:135], v195 offset:2048
v_mfma_f32_16x16x32_bf16 v[48:51], a[136:139], a[204:207], v[48:51]
ds_read_b64_tr_b16 a[160:161], v194 offset:256
ds_read_b64_tr_b16 a[162:163], v194 offset:2304
v_mfma_f32_16x16x32_bf16 v[20:23], a[140:143], a[200:203], v[20:23]
ds_read_b64_tr_b16 a[164:165], v195 offset:256
ds_read_b64_tr_b16 a[166:167], v195 offset:2304
v_mfma_f32_16x16x32_bf16 v[52:55], a[140:143], a[204:207], v[52:55]
buffer_load_dwordx4 v229, s[8:11], s38 offen offset:1024 lds
v_mfma_f32_16x16x32_bf16 v[24:27], a[144:147], a[200:203], v[24:27]
ds_read_b64_tr_b16 a[136:137], v196 offset:0
ds_read_b64_tr_b16 a[138:139], v196 offset:2048
v_mfma_f32_16x16x32_bf16 v[56:59], a[144:147], a[204:207], v[56:59]
ds_read_b64_tr_b16 a[140:141], v197 offset:0
ds_read_b64_tr_b16 a[142:143], v197 offset:2048
v_mfma_f32_16x16x32_bf16 v[28:31], a[148:151], a[200:203], v[28:31]
ds_read_b64_tr_b16 a[144:145], v198 offset:0
ds_read_b64_tr_b16 a[146:147], v198 offset:2048
v_mfma_f32_16x16x32_bf16 v[60:63], a[148:151], a[204:207], v[60:63]
buffer_load_dwordx4 v230, s[8:11], s38 offen offset:2048 lds
v_mfma_f32_16x16x32_bf16 v[32:35], a[152:155], a[200:203], v[32:35]
ds_read_b64_tr_b16 a[148:149], v199 offset:0
ds_read_b64_tr_b16 a[150:151], v199 offset:2048
v_mfma_f32_16x16x32_bf16 v[64:67], a[152:155], a[204:207], v[64:67]
ds_read_b64_tr_b16 a[152:153], v200 offset:0
ds_read_b64_tr_b16 a[154:155], v200 offset:2048
v_mfma_f32_16x16x32_bf16 v[36:39], a[156:159], a[200:203], v[36:39]
v_mfma_f32_16x16x32_bf16 v[68:71], a[156:159], a[204:207], v[68:71]
ds_read_b64_tr_b16 a[156:157], v201 offset:0
ds_read_b64_tr_b16 a[158:159], v201 offset:2048
v_mfma_f32_16x16x32_bf16 v[80:83], a[168:171], a[200:203], v[80:83]
buffer_load_dwordx4 v231, s[8:11], s38 offen offset:3072 lds
v_mfma_f32_16x16x32_bf16 v[112:115], a[168:171], a[204:207], v[112:115]
ds_read_b64_tr_b16 a[168:169], v196 offset:256
ds_read_b64_tr_b16 a[170:171], v196 offset:2304
v_mfma_f32_16x16x32_bf16 v[84:87], a[172:175], a[200:203], v[84:87]
s_add_u32 s38, s38, 16384
v_mfma_f32_16x16x32_bf16 v[116:119], a[172:175], a[204:207], v[116:119]
s_add_u32 m0, s37, 16384
ds_read_b64_tr_b16 a[172:173], v197 offset:256
ds_read_b64_tr_b16 a[174:175], v197 offset:2304
v_mfma_f32_16x16x32_bf16 v[88:91], a[176:179], a[200:203], v[88:91]
buffer_load_dwordx4 v228, s[8:11], s38 offen offset:0 lds
v_mfma_f32_16x16x32_bf16 v[120:123], a[176:179], a[204:207], v[120:123]
ds_read_b64_tr_b16 a[176:177], v198 offset:256
ds_read_b64_tr_b16 a[178:179], v198 offset:2304
v_mfma_f32_16x16x32_bf16 v[92:95], a[180:183], a[200:203], v[92:95]
v_mfma_f32_16x16x32_bf16 v[124:127], a[180:183], a[204:207], v[124:127]
ds_read_b64_tr_b16 a[180:181], v199 offset:256
ds_read_b64_tr_b16 a[182:183], v199 offset:2304
v_mfma_f32_16x16x32_bf16 v[96:99], a[184:187], a[200:203], v[96:99]
buffer_load_dwordx4 v229, s[8:11], s38 offen offset:1024 lds
v_mfma_f32_16x16x32_bf16 v[128:131], a[184:187], a[204:207], v[128:131]
ds_read_b64_tr_b16 a[184:185], v200 offset:256
ds_read_b64_tr_b16 a[186:187], v200 offset:2304
v_mfma_f32_16x16x32_bf16 v[100:103], a[188:191], a[200:203], v[100:103]
v_mfma_f32_16x16x32_bf16 v[132:135], a[188:191], a[204:207], v[132:135]
s_waitcnt lgkmcnt(6)
ds_read_b64_tr_b16 a[188:189], v201 offset:256
ds_read_b64_tr_b16 a[190:191], v201 offset:2304
v_mfma_f32_16x16x32_bf16 v[8:11], a[128:131], a[192:195], v[8:11]
buffer_load_dwordx4 v230, s[8:11], s38 offen offset:2048 lds
v_mfma_f32_16x16x32_bf16 v[40:43], a[128:131], a[196:199], v[40:43]
ds_read_b128 a[200:203], v203 offset:0
ds_read_b128 a[204:207], v203 offset:2048
v_mfma_f32_16x16x32_bf16 v[12:15], a[132:135], a[192:195], v[12:15]
v_mfma_f32_16x16x32_bf16 v[44:47], a[132:135], a[196:199], v[44:47]
v_smfmac_f32_16x16x64_bf16 a[248:251], a[208:211], a[128:135], v235
buffer_load_dwordx4 v231, s[8:11], s38 offen offset:3072 lds
v_mfma_f32_16x16x32_bf16 v[72:75], a[160:163], a[192:195], v[72:75]
ds_read_b64_tr_b16 a[128:129], v194 offset:16384
ds_read_b64_tr_b16 a[130:131], v194 offset:18432
v_mfma_f32_16x16x32_bf16 v[104:107], a[160:163], a[196:199], v[104:107]
ds_read_b64_tr_b16 a[132:133], v195 offset:16384
ds_read_b64_tr_b16 a[134:135], v195 offset:18432
v_mfma_f32_16x16x32_bf16 v[76:79], a[164:167], a[192:195], v[76:79]
s_add_u32 s38, s38, 16384
v_mfma_f32_16x16x32_bf16 v[108:111], a[164:167], a[196:199], v[108:111]
s_add_u32 m0, s37, 0
v_smfmac_f32_16x16x64_bf16 a[252:255], a[208:211], a[160:167], v235
buffer_load_dwordx4 v228, s[8:11], s38 offen offset:0 lds
v_mfma_f32_16x16x32_bf16 v[16:19], a[136:139], a[192:195], v[16:19]
ds_read_b64_tr_b16 a[160:161], v194 offset:16640
ds_read_b64_tr_b16 a[162:163], v194 offset:18688
v_mfma_f32_16x16x32_bf16 v[48:51], a[136:139], a[196:199], v[48:51]
ds_read_b64_tr_b16 a[164:165], v195 offset:16640
ds_read_b64_tr_b16 a[166:167], v195 offset:18688
v_mfma_f32_16x16x32_bf16 v[20:23], a[140:143], a[192:195], v[20:23]
ds_read_b64_tr_b16 a[136:137], v196 offset:16384
ds_read_b64_tr_b16 a[138:139], v196 offset:18432
v_mfma_f32_16x16x32_bf16 v[52:55], a[140:143], a[196:199], v[52:55]
buffer_load_dwordx4 v229, s[8:11], s38 offen offset:1024 lds
v_mfma_f32_16x16x32_bf16 v[24:27], a[144:147], a[192:195], v[24:27]
ds_read_b64_tr_b16 a[140:141], v197 offset:16384
ds_read_b64_tr_b16 a[142:143], v197 offset:18432
v_mfma_f32_16x16x32_bf16 v[56:59], a[144:147], a[196:199], v[56:59]
ds_read_b64_tr_b16 a[144:145], v198 offset:16384
ds_read_b64_tr_b16 a[146:147], v198 offset:18432
v_mfma_f32_16x16x32_bf16 v[28:31], a[148:151], a[192:195], v[28:31]
v_mfma_f32_16x16x32_bf16 v[60:63], a[148:151], a[196:199], v[60:63]
buffer_load_dwordx4 v230, s[8:11], s38 offen offset:2048 lds
v_mfma_f32_16x16x32_bf16 v[32:35], a[152:155], a[192:195], v[32:35]
ds_read_b64_tr_b16 a[148:149], v199 offset:16384
ds_read_b64_tr_b16 a[150:151], v199 offset:18432
v_mfma_f32_16x16x32_bf16 v[64:67], a[152:155], a[196:199], v[64:67]
ds_read_b64_tr_b16 a[152:153], v200 offset:16384
ds_read_b64_tr_b16 a[154:155], v200 offset:18432
v_mfma_f32_16x16x32_bf16 v[36:39], a[156:159], a[192:195], v[36:39]
v_mfma_f32_16x16x32_bf16 v[68:71], a[156:159], a[196:199], v[68:71]
buffer_load_dwordx4 v231, s[8:11], s38 offen offset:3072 lds
v_mfma_f32_16x16x32_bf16 v[80:83], a[168:171], a[192:195], v[80:83]
s_add_u32 s38, s38, 16384
ds_read_b64_tr_b16 a[156:157], v201 offset:16384
v_lshlrev_b32 v255, 3, v3
v_mfma_f32_16x16x32_bf16 v[112:115], a[168:171], a[196:199], v[112:115]
s_lshl_b32 s48, s55, 3
ds_read_b64_tr_b16 a[158:159], v201 offset:18432
ds_read_b64_tr_b16 a[168:169], v196 offset:16640
v_mfma_f32_16x16x32_bf16 v[84:87], a[172:175], a[192:195], v[84:87]
s_add_u32 s48, s48, 0x240000
ds_read_b64_tr_b16 a[170:171], v196 offset:18688
v_mfma_f32_16x16x32_bf16 v[116:119], a[172:175], a[196:199], v[116:119]
s_waitcnt lgkmcnt(6)
buffer_load_dwordx2 v[148:149], v255, s[20:23], s48 offen sc0 sc1
v_mfma_f32_16x16x32_bf16 v[88:91], a[176:179], a[192:195], v[88:91]
ds_read_b64_tr_b16 a[172:173], v197 offset:16640
ds_read_b64_tr_b16 a[174:175], v197 offset:18688
v_mfma_f32_16x16x32_bf16 v[120:123], a[176:179], a[196:199], v[120:123]
ds_read_b64_tr_b16 a[176:177], v198 offset:16640
ds_read_b64_tr_b16 a[178:179], v198 offset:18688
v_mfma_f32_16x16x32_bf16 v[92:95], a[180:183], a[192:195], v[92:95]
v_mfma_f32_16x16x32_bf16 v[124:127], a[180:183], a[196:199], v[124:127]
s_xor_b32 s48, s48, 128
ds_read_b64_tr_b16 a[180:181], v199 offset:16640
ds_read_b64_tr_b16 a[182:183], v199 offset:18688
v_mfma_f32_16x16x32_bf16 v[96:99], a[184:187], a[192:195], v[96:99]
buffer_load_dwordx2 v[150:151], v255, s[20:23], s48 offen sc0 sc1
v_mfma_f32_16x16x32_bf16 v[128:131], a[184:187], a[196:199], v[128:131]
ds_read_b64_tr_b16 a[184:185], v200 offset:16640
ds_read_b64_tr_b16 a[186:187], v200 offset:18688
v_mfma_f32_16x16x32_bf16 v[100:103], a[188:191], a[192:195], v[100:103]
v_mfma_f32_16x16x32_bf16 v[132:135], a[188:191], a[196:199], v[132:135]
ds_read_b64_tr_b16 a[188:189], v201 offset:16640
ds_read_b64_tr_b16 a[190:191], v201 offset:18688
v_mfma_f32_16x16x32_bf16 v[8:11], a[128:131], a[200:203], v[8:11]
v_mfma_f32_16x16x32_bf16 v[40:43], a[128:131], a[204:207], v[40:43]
v_mfma_f32_16x16x32_bf16 v[12:15], a[132:135], a[200:203], v[12:15]
v_mfma_f32_16x16x32_bf16 v[44:47], a[132:135], a[204:207], v[44:47]
v_smfmac_f32_16x16x64_bf16 a[248:251], a[208:211], a[128:135], v235
v_mfma_f32_16x16x32_bf16 v[72:75], a[160:163], a[200:203], v[72:75]
v_mfma_f32_16x16x32_bf16 v[104:107], a[160:163], a[204:207], v[104:107]
s_waitcnt vmcnt(2) lgkmcnt(0)
s_barrier
v_mfma_f32_16x16x32_bf16 v[76:79], a[164:167], a[200:203], v[76:79]
s_mov_b32 s39, 0
ds_read_b128 a[192:195], v212 offset:0
ds_read_b128 a[196:199], v212 offset:2048
v_mfma_f32_16x16x32_bf16 v[108:111], a[164:167], a[204:207], v[108:111]
s_add_u32 m0, s37, 98304
ds_read_b64_tr_b16 a[128:129], v204 offset:0
ds_read_b64_tr_b16 a[130:131], v204 offset:2048
v_smfmac_f32_16x16x64_bf16 a[252:255], a[208:211], a[160:167], v235
buffer_load_dwordx4 v232, s[12:15], s39 offen offset:0 lds
v_mfma_f32_16x16x32_bf16 v[16:19], a[136:139], a[200:203], v[16:19]
ds_read_b64_tr_b16 a[132:133], v205 offset:0
ds_read_b64_tr_b16 a[134:135], v205 offset:2048
v_mfma_f32_16x16x32_bf16 v[48:51], a[136:139], a[204:207], v[48:51]
ds_read_b64_tr_b16 a[160:161], v204 offset:256
ds_read_b64_tr_b16 a[162:163], v204 offset:2304
v_mfma_f32_16x16x32_bf16 v[20:23], a[140:143], a[200:203], v[20:23]
ds_read_b64_tr_b16 a[164:165], v205 offset:256
ds_read_b64_tr_b16 a[166:167], v205 offset:2304
v_mfma_f32_16x16x32_bf16 v[52:55], a[140:143], a[204:207], v[52:55]
buffer_load_dwordx4 v233, s[12:15], s39 offen offset:1024 lds
v_mfma_f32_16x16x32_bf16 v[24:27], a[144:147], a[200:203], v[24:27]
ds_read_b64_tr_b16 a[136:137], v206 offset:0
ds_read_b64_tr_b16 a[138:139], v206 offset:2048
v_mfma_f32_16x16x32_bf16 v[56:59], a[144:147], a[204:207], v[56:59]
ds_read_b64_tr_b16 a[140:141], v207 offset:0
ds_read_b64_tr_b16 a[142:143], v207 offset:2048
v_mfma_f32_16x16x32_bf16 v[28:31], a[148:151], a[200:203], v[28:31]
ds_read_b64_tr_b16 a[144:145], v208 offset:0
ds_read_b64_tr_b16 a[146:147], v208 offset:2048
v_mfma_f32_16x16x32_bf16 v[60:63], a[148:151], a[204:207], v[60:63]
buffer_load_dwordx4 v232, s[12:15], s39 offen offset:2048 lds
v_mfma_f32_16x16x32_bf16 v[32:35], a[152:155], a[200:203], v[32:35]
ds_read_b64_tr_b16 a[148:149], v209 offset:0
ds_read_b64_tr_b16 a[150:151], v209 offset:2048
v_mfma_f32_16x16x32_bf16 v[64:67], a[152:155], a[204:207], v[64:67]
ds_read_b64_tr_b16 a[152:153], v210 offset:0
ds_read_b64_tr_b16 a[154:155], v210 offset:2048
v_mfma_f32_16x16x32_bf16 v[36:39], a[156:159], a[200:203], v[36:39]
v_mfma_f32_16x16x32_bf16 v[68:71], a[156:159], a[204:207], v[68:71]
buffer_load_dwordx4 v233, s[12:15], s39 offen offset:3072 lds
v_mfma_f32_16x16x32_bf16 v[80:83], a[168:171], a[200:203], v[80:83]
ds_read_b64_tr_b16 a[156:157], v211 offset:0
ds_read_b64_tr_b16 a[158:159], v211 offset:2048
v_mfma_f32_16x16x32_bf16 v[112:115], a[168:171], a[204:207], v[112:115]
ds_read_b64_tr_b16 a[168:169], v206 offset:256
ds_read_b64_tr_b16 a[170:171], v206 offset:2304
v_mfma_f32_16x16x32_bf16 v[84:87], a[172:175], a[200:203], v[84:87]
s_add_u32 s39, s39, 16384
v_mfma_f32_16x16x32_bf16 v[116:119], a[172:175], a[204:207], v[116:119]
s_add_u32 m0, s37, 114688
ds_read_b64_tr_b16 a[172:173], v207 offset:256
ds_read_b64_tr_b16 a[174:175], v207 offset:2304
v_mfma_f32_16x16x32_bf16 v[88:91], a[176:179], a[200:203], v[88:91]
buffer_load_dwordx4 v232, s[12:15], s39 offen offset:0 lds
v_mfma_f32_16x16x32_bf16 v[120:123], a[176:179], a[204:207], v[120:123]
ds_read_b64_tr_b16 a[176:177], v208 offset:256
ds_read_b64_tr_b16 a[178:179], v208 offset:2304
v_mfma_f32_16x16x32_bf16 v[92:95], a[180:183], a[200:203], v[92:95]
v_mfma_f32_16x16x32_bf16 v[124:127], a[180:183], a[204:207], v[124:127]
ds_read_b64_tr_b16 a[180:181], v209 offset:256
ds_read_b64_tr_b16 a[182:183], v209 offset:2304
v_mfma_f32_16x16x32_bf16 v[96:99], a[184:187], a[200:203], v[96:99]
buffer_load_dwordx4 v233, s[12:15], s39 offen offset:1024 lds
v_mfma_f32_16x16x32_bf16 v[128:131], a[184:187], a[204:207], v[128:131]
ds_read_b64_tr_b16 a[184:185], v210 offset:256
ds_read_b64_tr_b16 a[186:187], v210 offset:2304
v_mfma_f32_16x16x32_bf16 v[100:103], a[188:191], a[200:203], v[100:103]
v_mfma_f32_16x16x32_bf16 v[132:135], a[188:191], a[204:207], v[132:135]
s_waitcnt lgkmcnt(6)
ds_read_b64_tr_b16 a[188:189], v211 offset:256
ds_read_b64_tr_b16 a[190:191], v211 offset:2304
v_mfma_f32_16x16x32_bf16 v[8:11], a[128:131], a[192:195], v[8:11]
s_lshl_b32 s46, s32, 7
buffer_load_dwordx4 v232, s[12:15], s39 offen offset:2048 lds
v_mfma_f32_16x16x32_bf16 v[40:43], a[128:131], a[196:199], v[40:43]
s_add_u32 s46, s46, 147456
ds_read_b128 a[200:203], v213 offset:0
ds_read_b128 a[204:207], v213 offset:2048
v_mfma_f32_16x16x32_bf16 v[12:15], a[132:135], a[192:195], v[12:15]
v_lshl_add_u32 v144, v3, 2, s46
v_lshl_add_u32 v5, v4, 4, s46
v_mfma_f32_16x16x32_bf16 v[44:47], a[132:135], a[196:199], v[44:47]
v_xor_b32 v6, 128, v5
v_xor_b32 v7, 256, v5
v_smfmac_f32_16x16x64_bf16 a[248:251], a[208:211], a[128:135], v235
buffer_load_dwordx4 v233, s[12:15], s39 offen offset:3072 lds
v_mfma_f32_16x16x32_bf16 v[72:75], a[160:163], a[192:195], v[72:75]
ds_read_b64_tr_b16 a[128:129], v204 offset:16384
ds_read_b64_tr_b16 a[130:131], v204 offset:18432
v_mfma_f32_16x16x32_bf16 v[104:107], a[160:163], a[196:199], v[104:107]
ds_read_b64_tr_b16 a[132:133], v205 offset:16384
ds_read_b64_tr_b16 a[134:135], v205 offset:18432
v_mfma_f32_16x16x32_bf16 v[76:79], a[164:167], a[192:195], v[76:79]
s_add_u32 s39, s39, 16384
v_xor_b32 v254, 384, v5
v_readlane_b32 s92, v214, 0
v_mfma_f32_16x16x32_bf16 v[108:111], a[164:167], a[196:199], v[108:111]
v_readlane_b32 s93, v214, 32
v_smfmac_f32_16x16x64_bf16 a[252:255], a[208:211], a[160:167], v235
ds_read_b64_tr_b16 a[160:161], v204 offset:16640
ds_read_b64_tr_b16 a[162:163], v204 offset:18688
v_mfma_f32_16x16x32_bf16 v[16:19], a[136:139], a[192:195], v[16:19]
ds_read_b64_tr_b16 a[164:165], v205 offset:16640
ds_read_b64_tr_b16 a[166:167], v205 offset:18688
v_mfma_f32_16x16x32_bf16 v[48:51], a[136:139], a[196:199], v[48:51]
ds_read_b64_tr_b16 a[136:137], v206 offset:16384
ds_read_b64_tr_b16 a[138:139], v206 offset:18432
v_mfma_f32_16x16x32_bf16 v[20:23], a[140:143], a[192:195], v[20:23]
v_mfma_f32_16x16x32_bf16 v[52:55], a[140:143], a[196:199], v[52:55]
ds_read_b64_tr_b16 a[140:141], v207 offset:16384
ds_read_b64_tr_b16 a[142:143], v207 offset:18432
v_mfma_f32_16x16x32_bf16 v[24:27], a[144:147], a[192:195], v[24:27]
v_mfma_f32_16x16x32_bf16 v[56:59], a[144:147], a[196:199], v[56:59]
ds_read_b64_tr_b16 a[144:145], v208 offset:16384
ds_read_b64_tr_b16 a[146:147], v208 offset:18432
v_mfma_f32_16x16x32_bf16 v[28:31], a[148:151], a[192:195], v[28:31]
v_mfma_f32_16x16x32_bf16 v[60:63], a[148:151], a[196:199], v[60:63]
ds_read_b64_tr_b16 a[148:149], v209 offset:16384
ds_read_b64_tr_b16 a[150:151], v209 offset:18432
v_mfma_f32_16x16x32_bf16 v[32:35], a[152:155], a[192:195], v[32:35]
v_mfma_f32_16x16x32_bf16 v[64:67], a[152:155], a[196:199], v[64:67]
ds_read_b64_tr_b16 a[152:153], v210 offset:16384
ds_read_b64_tr_b16 a[154:155], v210 offset:18432
v_mfma_f32_16x16x32_bf16 v[36:39], a[156:159], a[192:195], v[36:39]
v_mfma_f32_16x16x32_bf16 v[68:71], a[156:159], a[196:199], v[68:71]
ds_read_b64_tr_b16 a[156:157], v211 offset:16384
ds_read_b64_tr_b16 a[158:159], v211 offset:18432
v_mfma_f32_16x16x32_bf16 v[80:83], a[168:171], a[192:195], v[80:83]
v_mfma_f32_16x16x32_bf16 v[112:115], a[168:171], a[196:199], v[112:115]
ds_read_b64_tr_b16 a[168:169], v206 offset:16640
ds_read_b64_tr_b16 a[170:171], v206 offset:18688
v_mfma_f32_16x16x32_bf16 v[84:87], a[172:175], a[192:195], v[84:87]
v_mfma_f32_16x16x32_bf16 v[116:119], a[172:175], a[196:199], v[116:119]
s_waitcnt lgkmcnt(6)
ds_read_b64_tr_b16 a[172:173], v207 offset:16640
ds_read_b64_tr_b16 a[174:175], v207 offset:18688
v_mfma_f32_16x16x32_bf16 v[88:91], a[176:179], a[192:195], v[88:91]
v_mfma_f32_16x16x32_bf16 v[120:123], a[176:179], a[196:199], v[120:123]
ds_read_b64_tr_b16 a[176:177], v208 offset:16640
ds_read_b64_tr_b16 a[178:179], v208 offset:18688
v_mfma_f32_16x16x32_bf16 v[92:95], a[180:183], a[192:195], v[92:95]
v_mfma_f32_16x16x32_bf16 v[124:127], a[180:183], a[196:199], v[124:127]
ds_read_b64_tr_b16 a[180:181], v209 offset:16640
ds_read_b64_tr_b16 a[182:183], v209 offset:18688
v_mfma_f32_16x16x32_bf16 v[96:99], a[184:187], a[192:195], v[96:99]
v_mfma_f32_16x16x32_bf16 v[128:131], a[184:187], a[196:199], v[128:131]
ds_read_b64_tr_b16 a[184:185], v210 offset:16640
ds_read_b64_tr_b16 a[186:187], v210 offset:18688
v_mfma_f32_16x16x32_bf16 v[100:103], a[188:191], a[192:195], v[100:103]
v_mfma_f32_16x16x32_bf16 v[132:135], a[188:191], a[196:199], v[132:135]
ds_read_b64_tr_b16 a[188:189], v211 offset:16640
ds_read_b64_tr_b16 a[190:191], v211 offset:18688
v_mfma_f32_16x16x32_bf16 v[8:11], a[128:131], a[200:203], v[8:11]
v_mfma_f32_16x16x32_bf16 v[40:43], a[128:131], a[204:207], v[40:43]
v_mfma_f32_16x16x32_bf16 v[12:15], a[132:135], a[200:203], v[12:15]
v_mfma_f32_16x16x32_bf16 v[44:47], a[132:135], a[204:207], v[44:47]
v_smfmac_f32_16x16x64_bf16 a[248:251], a[208:211], a[128:135], v235
ds_read_b128 a[128:131], v216 offset:32768
ds_read_b128 a[132:135], v217 offset:32768
v_mfma_f32_16x16x32_bf16 v[72:75], a[160:163], a[200:203], v[72:75]
v_mfma_f32_16x16x32_bf16 v[104:107], a[160:163], a[204:207], v[104:107]
v_mfma_f32_16x16x32_bf16 v[76:79], a[164:167], a[200:203], v[76:79]
v_mfma_f32_16x16x32_bf16 v[108:111], a[164:167], a[204:207], v[108:111]
v_smfmac_f32_16x16x64_bf16 a[252:255], a[208:211], a[160:167], v235
v_mfma_f32_16x16x32_bf16 v[16:19], a[136:139], a[200:203], v[16:19]
v_accvgpr_read_b32 v136, a248
v_accvgpr_read_b32 v137, a249
v_mfma_f32_16x16x32_bf16 v[48:51], a[136:139], a[204:207], v[48:51]
v_accvgpr_read_b32 v138, a250
v_accvgpr_read_b32 v139, a251
v_mfma_f32_16x16x32_bf16 v[20:23], a[140:143], a[200:203], v[20:23]
ds_read_b128 a[136:139], v218 offset:32768
v_mfma_f32_16x16x32_bf16 v[52:55], a[140:143], a[204:207], v[52:55]
ds_read_b128 a[140:143], v219 offset:32768
v_mfma_f32_16x16x32_bf16 v[24:27], a[144:147], a[200:203], v[24:27]
v_mfma_f32_16x16x32_bf16 v[56:59], a[144:147], a[204:207], v[56:59]
v_accvgpr_read_b32 v140, a252
v_accvgpr_read_b32 v141, a253
v_mfma_f32_16x16x32_bf16 v[28:31], a[148:151], a[200:203], v[28:31]
v_accvgpr_read_b32 v142, a254
v_accvgpr_read_b32 v143, a255
v_mfma_f32_16x16x32_bf16 v[60:63], a[148:151], a[204:207], v[60:63]
s_waitcnt lgkmcnt(6)
v_add_f32 v136, v136, v137
v_add_f32 v138, v138, v139
v_mfma_f32_16x16x32_bf16 v[32:35], a[152:155], a[200:203], v[32:35]
v_add_f32 v140, v140, v141
v_add_f32 v142, v142, v143
v_mfma_f32_16x16x32_bf16 v[64:67], a[152:155], a[204:207], v[64:67]
ds_write_b32 v144, v136 offset:0
ds_write_b32 v144, v138 offset:64
v_mfma_f32_16x16x32_bf16 v[36:39], a[156:159], a[200:203], v[36:39]
ds_write_b32 v144, v140 offset:512
ds_write_b32 v144, v142 offset:576
v_mfma_f32_16x16x32_bf16 v[68:71], a[156:159], a[204:207], v[68:71]
s_waitcnt vmcnt(8)
s_nop 0
ds_read_b128 a[144:147], v216 offset:36864
ds_read_b128 a[148:151], v217 offset:36864
v_mfma_f32_16x16x32_bf16 v[80:83], a[168:171], a[200:203], v[80:83]
ds_read_b128 a[152:155], v218 offset:36864
ds_read_b128 a[156:159], v219 offset:36864
v_mfma_f32_16x16x32_bf16 v[112:115], a[168:171], a[204:207], v[112:115]
v_rcp_f32 v149, v149
v_mfma_f32_16x16x32_bf16 v[84:87], a[172:175], a[200:203], v[84:87]
v_rcp_f32 v151, v151
v_mfma_f32_16x16x32_bf16 v[116:119], a[172:175], a[204:207], v[116:119]
s_waitcnt lgkmcnt(0)
s_barrier
v_mfma_f32_16x16x32_bf16 v[88:91], a[176:179], a[200:203], v[88:91]
ds_read_b128 v[184:187], v5 offset:0
ds_read_b128 v[188:191], v5 offset:64
v_mfma_f32_16x16x32_bf16 v[120:123], a[176:179], a[204:207], v[120:123]
ds_read_b128 v[192:195], v6 offset:0
ds_read_b128 v[196:199], v6 offset:64
v_mfma_f32_16x16x32_bf16 v[92:95], a[180:183], a[200:203], v[92:95]
ds_read_b128 v[200:203], v7 offset:0
ds_read_b128 v[204:207], v7 offset:64
v_mfma_f32_16x16x32_bf16 v[124:127], a[180:183], a[204:207], v[124:127]
ds_read_b128 v[208:211], v254 offset:0
ds_read_b128 v[212:215], v254 offset:64
v_mfma_f32_16x16x32_bf16 v[96:99], a[184:187], a[200:203], v[96:99]
v_sub_f32 v148, 0, v148
v_sub_f32 v150, 0, v150
v_mfma_f32_16x16x32_bf16 v[128:131], a[184:187], a[204:207], v[128:131]
v_mul_f32 v149, 0x3e0293ee, v149
v_mul_f32 v151, 0x3e0293ee, v151
v_mfma_f32_16x16x32_bf16 v[100:103], a[188:191], a[200:203], v[100:103]
v_accvgpr_write_b32 a248, 0
v_accvgpr_write_b32 a249, 0
v_mfma_f32_16x16x32_bf16 v[132:135], a[188:191], a[204:207], v[132:135]
v_accvgpr_write_b32 a250, 0
v_accvgpr_write_b32 a251, 0
v_accvgpr_write_b32 a252, 0
v_accvgpr_write_b32 a253, 0
v_accvgpr_write_b32 a254, 0
v_accvgpr_write_b32 a255, 0
s_waitcnt lgkmcnt(0)
v_pk_fma_f32 v[8:9], v[184:185], v[148:149], v[8:9] op_sel:[0,0,0] op_sel_hi:[1,0,1]
v_pk_fma_f32 v[10:11], v[186:187], v[148:149], v[10:11] op_sel:[0,0,0] op_sel_hi:[1,0,1]
v_pk_mul_f32 v[8:9], v[8:9], v[148:149] op_sel:[0,1] op_sel_hi:[1,1]
v_pk_mul_f32 v[10:11], v[10:11], v[148:149] op_sel:[0,1] op_sel_hi:[1,1]
v_pk_fma_f32 v[12:13], v[188:189], v[148:149], v[12:13] op_sel:[0,0,0] op_sel_hi:[1,0,1]
v_pk_fma_f32 v[14:15], v[190:191], v[148:149], v[14:15] op_sel:[0,0,0] op_sel_hi:[1,0,1]
v_pk_mul_f32 v[12:13], v[12:13], v[148:149] op_sel:[0,1] op_sel_hi:[1,1]
v_pk_mul_f32 v[14:15], v[14:15], v[148:149] op_sel:[0,1] op_sel_hi:[1,1]
v_pk_fma_f32 v[16:17], v[192:193], v[148:149], v[16:17] op_sel:[0,0,0] op_sel_hi:[1,0,1]
v_pk_fma_f32 v[18:19], v[194:195], v[148:149], v[18:19] op_sel:[0,0,0] op_sel_hi:[1,0,1]
v_pk_mul_f32 v[16:17], v[16:17], v[148:149] op_sel:[0,1] op_sel_hi:[1,1]
v_pk_mul_f32 v[18:19], v[18:19], v[148:149] op_sel:[0,1] op_sel_hi:[1,1]
v_pk_fma_f32 v[20:21], v[196:197], v[148:149], v[20:21] op_sel:[0,0,0] op_sel_hi:[1,0,1]
v_pk_fma_f32 v[22:23], v[198:199], v[148:149], v[22:23] op_sel:[0,0,0] op_sel_hi:[1,0,1]
v_pk_mul_f32 v[20:21], v[20:21], v[148:149] op_sel:[0,1] op_sel_hi:[1,1]
v_pk_mul_f32 v[22:23], v[22:23], v[148:149] op_sel:[0,1] op_sel_hi:[1,1]
v_pk_fma_f32 v[24:25], v[200:201], v[148:149], v[24:25] op_sel:[0,0,0] op_sel_hi:[1,0,1]
v_pk_fma_f32 v[26:27], v[202:203], v[148:149], v[26:27] op_sel:[0,0,0] op_sel_hi:[1,0,1]
v_pk_mul_f32 v[24:25], v[24:25], v[148:149] op_sel:[0,1] op_sel_hi:[1,1]
v_pk_mul_f32 v[26:27], v[26:27], v[148:149] op_sel:[0,1] op_sel_hi:[1,1]
v_pk_fma_f32 v[28:29], v[204:205], v[148:149], v[28:29] op_sel:[0,0,0] op_sel_hi:[1,0,1]
v_pk_fma_f32 v[30:31], v[206:207], v[148:149], v[30:31] op_sel:[0,0,0] op_sel_hi:[1,0,1]
v_pk_mul_f32 v[28:29], v[28:29], v[148:149] op_sel:[0,1] op_sel_hi:[1,1]
v_pk_mul_f32 v[30:31], v[30:31], v[148:149] op_sel:[0,1] op_sel_hi:[1,1]
v_pk_fma_f32 v[32:33], v[208:209], v[148:149], v[32:33] op_sel:[0,0,0] op_sel_hi:[1,0,1]
v_pk_fma_f32 v[34:35], v[210:211], v[148:149], v[34:35] op_sel:[0,0,0] op_sel_hi:[1,0,1]
v_pk_mul_f32 v[32:33], v[32:33], v[148:149] op_sel:[0,1] op_sel_hi:[1,1]
v_pk_mul_f32 v[34:35], v[34:35], v[148:149] op_sel:[0,1] op_sel_hi:[1,1]
v_pk_fma_f32 v[36:37], v[212:213], v[148:149], v[36:37] op_sel:[0,0,0] op_sel_hi:[1,0,1]
v_pk_fma_f32 v[38:39], v[214:215], v[148:149], v[38:39] op_sel:[0,0,0] op_sel_hi:[1,0,1]
v_pk_mul_f32 v[36:37], v[36:37], v[148:149] op_sel:[0,1] op_sel_hi:[1,1]
v_pk_mul_f32 v[38:39], v[38:39], v[148:149] op_sel:[0,1] op_sel_hi:[1,1]
v_cvt_pk_bf16_f32 v152, v8, v9
v_cvt_pk_bf16_f32 v153, v10, v11
v_cvt_pk_bf16_f32 v154, v12, v13
v_cvt_pk_bf16_f32 v155, v14, v15
v_cvt_pk_bf16_f32 v156, v16, v17
v_cvt_pk_bf16_f32 v157, v18, v19
v_cvt_pk_bf16_f32 v158, v20, v21
v_cvt_pk_bf16_f32 v159, v22, v23
v_cvt_pk_bf16_f32 v160, v24, v25
v_cvt_pk_bf16_f32 v161, v26, v27
v_cvt_pk_bf16_f32 v162, v28, v29
v_cvt_pk_bf16_f32 v163, v30, v31
v_cvt_pk_bf16_f32 v164, v32, v33
v_cvt_pk_bf16_f32 v165, v34, v35
v_cvt_pk_bf16_f32 v166, v36, v37
v_cvt_pk_bf16_f32 v167, v38, v39
v_permlane16_swap_b32 v152, v154
v_permlane16_swap_b32 v153, v155
v_permlane16_swap_b32 v156, v158
v_permlane16_swap_b32 v157, v159
v_permlane16_swap_b32 v160, v162
v_permlane16_swap_b32 v161, v163
v_permlane16_swap_b32 v164, v166
v_permlane16_swap_b32 v165, v167
v_pk_fma_f32 v[40:41], v[184:185], v[150:151], v[40:41] op_sel:[0,0,0] op_sel_hi:[1,0,1]
v_pk_fma_f32 v[42:43], v[186:187], v[150:151], v[42:43] op_sel:[0,0,0] op_sel_hi:[1,0,1]
v_pk_mul_f32 v[40:41], v[40:41], v[150:151] op_sel:[0,1] op_sel_hi:[1,1]
v_pk_mul_f32 v[42:43], v[42:43], v[150:151] op_sel:[0,1] op_sel_hi:[1,1]
v_pk_fma_f32 v[44:45], v[188:189], v[150:151], v[44:45] op_sel:[0,0,0] op_sel_hi:[1,0,1]
v_pk_fma_f32 v[46:47], v[190:191], v[150:151], v[46:47] op_sel:[0,0,0] op_sel_hi:[1,0,1]
v_pk_mul_f32 v[44:45], v[44:45], v[150:151] op_sel:[0,1] op_sel_hi:[1,1]
v_pk_mul_f32 v[46:47], v[46:47], v[150:151] op_sel:[0,1] op_sel_hi:[1,1]
v_pk_fma_f32 v[48:49], v[192:193], v[150:151], v[48:49] op_sel:[0,0,0] op_sel_hi:[1,0,1]
v_pk_fma_f32 v[50:51], v[194:195], v[150:151], v[50:51] op_sel:[0,0,0] op_sel_hi:[1,0,1]
v_pk_mul_f32 v[48:49], v[48:49], v[150:151] op_sel:[0,1] op_sel_hi:[1,1]
v_pk_mul_f32 v[50:51], v[50:51], v[150:151] op_sel:[0,1] op_sel_hi:[1,1]
v_pk_fma_f32 v[52:53], v[196:197], v[150:151], v[52:53] op_sel:[0,0,0] op_sel_hi:[1,0,1]
v_pk_fma_f32 v[54:55], v[198:199], v[150:151], v[54:55] op_sel:[0,0,0] op_sel_hi:[1,0,1]
v_pk_mul_f32 v[52:53], v[52:53], v[150:151] op_sel:[0,1] op_sel_hi:[1,1]
v_pk_mul_f32 v[54:55], v[54:55], v[150:151] op_sel:[0,1] op_sel_hi:[1,1]
v_pk_fma_f32 v[56:57], v[200:201], v[150:151], v[56:57] op_sel:[0,0,0] op_sel_hi:[1,0,1]
v_pk_fma_f32 v[58:59], v[202:203], v[150:151], v[58:59] op_sel:[0,0,0] op_sel_hi:[1,0,1]
v_pk_mul_f32 v[56:57], v[56:57], v[150:151] op_sel:[0,1] op_sel_hi:[1,1]
v_pk_mul_f32 v[58:59], v[58:59], v[150:151] op_sel:[0,1] op_sel_hi:[1,1]
v_pk_fma_f32 v[60:61], v[204:205], v[150:151], v[60:61] op_sel:[0,0,0] op_sel_hi:[1,0,1]
v_pk_fma_f32 v[62:63], v[206:207], v[150:151], v[62:63] op_sel:[0,0,0] op_sel_hi:[1,0,1]
v_pk_mul_f32 v[60:61], v[60:61], v[150:151] op_sel:[0,1] op_sel_hi:[1,1]
v_pk_mul_f32 v[62:63], v[62:63], v[150:151] op_sel:[0,1] op_sel_hi:[1,1]
v_pk_fma_f32 v[64:65], v[208:209], v[150:151], v[64:65] op_sel:[0,0,0] op_sel_hi:[1,0,1]
v_pk_fma_f32 v[66:67], v[210:211], v[150:151], v[66:67] op_sel:[0,0,0] op_sel_hi:[1,0,1]
v_pk_mul_f32 v[64:65], v[64:65], v[150:151] op_sel:[0,1] op_sel_hi:[1,1]
v_pk_mul_f32 v[66:67], v[66:67], v[150:151] op_sel:[0,1] op_sel_hi:[1,1]
v_pk_fma_f32 v[68:69], v[212:213], v[150:151], v[68:69] op_sel:[0,0,0] op_sel_hi:[1,0,1]
v_pk_fma_f32 v[70:71], v[214:215], v[150:151], v[70:71] op_sel:[0,0,0] op_sel_hi:[1,0,1]
v_pk_mul_f32 v[68:69], v[68:69], v[150:151] op_sel:[0,1] op_sel_hi:[1,1]
v_pk_mul_f32 v[70:71], v[70:71], v[150:151] op_sel:[0,1] op_sel_hi:[1,1]
v_mfma_f32_16x16x32_bf16 v[8:11], a[128:131], v[152:155], 0
ds_read_b128 v[24:27], v5 offset:512
v_cvt_pk_bf16_f32 v168, v40, v41
v_mfma_f32_16x16x32_bf16 v[8:11], a[132:135], v[156:159], v[8:11]
ds_read_b128 v[28:31], v5 offset:576
v_cvt_pk_bf16_f32 v169, v42, v43
v_mfma_f32_16x16x32_bf16 v[8:11], a[136:139], v[160:163], v[8:11]
ds_read_b128 v[32:35], v6 offset:512
v_cvt_pk_bf16_f32 v170, v44, v45
v_mfma_f32_16x16x32_bf16 v[8:11], a[140:143], v[164:167], v[8:11]
ds_read_b128 v[36:39], v6 offset:576
v_cvt_pk_bf16_f32 v171, v46, v47
v_mfma_f32_16x16x32_bf16 v[12:15], a[144:147], v[152:155], 0
ds_read_b128 v[136:139], v7 offset:512
v_cvt_pk_bf16_f32 v172, v48, v49
v_mfma_f32_16x16x32_bf16 v[12:15], a[148:151], v[156:159], v[12:15]
ds_read_b128 v[140:143], v7 offset:576
v_cvt_pk_bf16_f32 v173, v50, v51
v_mfma_f32_16x16x32_bf16 v[12:15], a[152:155], v[160:163], v[12:15]
ds_read_b128 v[144:147], v254 offset:512
v_cvt_pk_bf16_f32 v174, v52, v53
v_mfma_f32_16x16x32_bf16 v[12:15], a[156:159], v[164:167], v[12:15]
ds_read_b128 v[244:247], v254 offset:576
v_cvt_pk_bf16_f32 v175, v54, v55
v_cvt_pk_bf16_f32 v176, v56, v57
v_cvt_pk_bf16_f32 v177, v58, v59
v_cvt_pk_bf16_f32 v178, v60, v61
v_cvt_pk_bf16_f32 v179, v62, v63
v_cvt_pk_bf16_f32 v180, v64, v65
v_cvt_pk_bf16_f32 v181, v66, v67
v_cvt_pk_bf16_f32 v182, v68, v69
v_cvt_pk_bf16_f32 v183, v70, v71
v_permlane16_swap_b32 v168, v170
v_permlane16_swap_b32 v169, v171
v_permlane16_swap_b32 v172, v174
v_permlane16_swap_b32 v173, v175
v_permlane16_swap_b32 v176, v178
v_permlane16_swap_b32 v177, v179
v_permlane16_swap_b32 v180, v182
v_permlane16_swap_b32 v181, v183
s_waitcnt lgkmcnt(0)
v_pk_fma_f32 v[72:73], v[24:25], v[148:149], v[72:73] op_sel:[0,0,0] op_sel_hi:[1,0,1]
v_pk_fma_f32 v[74:75], v[26:27], v[148:149], v[74:75] op_sel:[0,0,0] op_sel_hi:[1,0,1]
v_pk_mul_f32 v[72:73], v[72:73], v[148:149] op_sel:[0,1] op_sel_hi:[1,1]
v_pk_mul_f32 v[74:75], v[74:75], v[148:149] op_sel:[0,1] op_sel_hi:[1,1]
v_pk_fma_f32 v[76:77], v[28:29], v[148:149], v[76:77] op_sel:[0,0,0] op_sel_hi:[1,0,1]
v_pk_fma_f32 v[78:79], v[30:31], v[148:149], v[78:79] op_sel:[0,0,0] op_sel_hi:[1,0,1]
v_pk_mul_f32 v[76:77], v[76:77], v[148:149] op_sel:[0,1] op_sel_hi:[1,1]
v_pk_mul_f32 v[78:79], v[78:79], v[148:149] op_sel:[0,1] op_sel_hi:[1,1]
v_pk_fma_f32 v[80:81], v[32:33], v[148:149], v[80:81] op_sel:[0,0,0] op_sel_hi:[1,0,1]
v_pk_fma_f32 v[82:83], v[34:35], v[148:149], v[82:83] op_sel:[0,0,0] op_sel_hi:[1,0,1]
v_pk_mul_f32 v[80:81], v[80:81], v[148:149] op_sel:[0,1] op_sel_hi:[1,1]
v_pk_mul_f32 v[82:83], v[82:83], v[148:149] op_sel:[0,1] op_sel_hi:[1,1]
v_pk_fma_f32 v[84:85], v[36:37], v[148:149], v[84:85] op_sel:[0,0,0] op_sel_hi:[1,0,1]
v_pk_fma_f32 v[86:87], v[38:39], v[148:149], v[86:87] op_sel:[0,0,0] op_sel_hi:[1,0,1]
v_pk_mul_f32 v[84:85], v[84:85], v[148:149] op_sel:[0,1] op_sel_hi:[1,1]
v_pk_mul_f32 v[86:87], v[86:87], v[148:149] op_sel:[0,1] op_sel_hi:[1,1]
v_pk_fma_f32 v[88:89], v[136:137], v[148:149], v[88:89] op_sel:[0,0,0] op_sel_hi:[1,0,1]
v_pk_fma_f32 v[90:91], v[138:139], v[148:149], v[90:91] op_sel:[0,0,0] op_sel_hi:[1,0,1]
v_pk_mul_f32 v[88:89], v[88:89], v[148:149] op_sel:[0,1] op_sel_hi:[1,1]
v_pk_mul_f32 v[90:91], v[90:91], v[148:149] op_sel:[0,1] op_sel_hi:[1,1]
v_pk_fma_f32 v[92:93], v[140:141], v[148:149], v[92:93] op_sel:[0,0,0] op_sel_hi:[1,0,1]
v_pk_fma_f32 v[94:95], v[142:143], v[148:149], v[94:95] op_sel:[0,0,0] op_sel_hi:[1,0,1]
v_pk_mul_f32 v[92:93], v[92:93], v[148:149] op_sel:[0,1] op_sel_hi:[1,1]
v_pk_mul_f32 v[94:95], v[94:95], v[148:149] op_sel:[0,1] op_sel_hi:[1,1]
v_pk_fma_f32 v[96:97], v[144:145], v[148:149], v[96:97] op_sel:[0,0,0] op_sel_hi:[1,0,1]
v_pk_fma_f32 v[98:99], v[146:147], v[148:149], v[98:99] op_sel:[0,0,0] op_sel_hi:[1,0,1]
v_pk_mul_f32 v[96:97], v[96:97], v[148:149] op_sel:[0,1] op_sel_hi:[1,1]
v_pk_mul_f32 v[98:99], v[98:99], v[148:149] op_sel:[0,1] op_sel_hi:[1,1]
v_pk_fma_f32 v[100:101], v[244:245], v[148:149], v[100:101] op_sel:[0,0,0] op_sel_hi:[1,0,1]
v_pk_fma_f32 v[102:103], v[246:247], v[148:149], v[102:103] op_sel:[0,0,0] op_sel_hi:[1,0,1]
v_pk_mul_f32 v[100:101], v[100:101], v[148:149] op_sel:[0,1] op_sel_hi:[1,1]
v_pk_mul_f32 v[102:103], v[102:103], v[148:149] op_sel:[0,1] op_sel_hi:[1,1]
v_mfma_f32_16x16x32_bf16 v[16:19], a[128:131], v[168:171], 0
v_cvt_pk_bf16_f32 v184, v72, v73
v_cvt_pk_bf16_f32 v185, v74, v75
v_mfma_f32_16x16x32_bf16 v[16:19], a[132:135], v[172:175], v[16:19]
v_cvt_pk_bf16_f32 v186, v76, v77
v_cvt_pk_bf16_f32 v187, v78, v79
v_mfma_f32_16x16x32_bf16 v[16:19], a[136:139], v[176:179], v[16:19]
v_cvt_pk_bf16_f32 v188, v80, v81
v_cvt_pk_bf16_f32 v189, v82, v83
v_mfma_f32_16x16x32_bf16 v[16:19], a[140:143], v[180:183], v[16:19]
v_cvt_pk_bf16_f32 v190, v84, v85
v_cvt_pk_bf16_f32 v191, v86, v87
v_mfma_f32_16x16x32_bf16 v[20:23], a[144:147], v[168:171], 0
v_cvt_pk_bf16_f32 v192, v88, v89
v_cvt_pk_bf16_f32 v193, v90, v91
v_mfma_f32_16x16x32_bf16 v[20:23], a[148:151], v[172:175], v[20:23]
v_cvt_pk_bf16_f32 v194, v92, v93
v_cvt_pk_bf16_f32 v195, v94, v95
v_mfma_f32_16x16x32_bf16 v[20:23], a[152:155], v[176:179], v[20:23]
v_cvt_pk_bf16_f32 v196, v96, v97
v_cvt_pk_bf16_f32 v197, v98, v99
v_mfma_f32_16x16x32_bf16 v[20:23], a[156:159], v[180:183], v[20:23]
v_cvt_pk_bf16_f32 v198, v100, v101
v_cvt_pk_bf16_f32 v199, v102, v103
v_permlane16_swap_b32 v184, v186
v_permlane16_swap_b32 v185, v187
v_permlane16_swap_b32 v188, v190
v_permlane16_swap_b32 v189, v191
v_permlane16_swap_b32 v192, v194
v_permlane16_swap_b32 v193, v195
v_permlane16_swap_b32 v196, v198
v_permlane16_swap_b32 v197, v199
v_pk_fma_f32 v[104:105], v[24:25], v[150:151], v[104:105] op_sel:[0,0,0] op_sel_hi:[1,0,1]
v_pk_fma_f32 v[106:107], v[26:27], v[150:151], v[106:107] op_sel:[0,0,0] op_sel_hi:[1,0,1]
v_pk_mul_f32 v[104:105], v[104:105], v[150:151] op_sel:[0,1] op_sel_hi:[1,1]
v_pk_mul_f32 v[106:107], v[106:107], v[150:151] op_sel:[0,1] op_sel_hi:[1,1]
v_pk_fma_f32 v[108:109], v[28:29], v[150:151], v[108:109] op_sel:[0,0,0] op_sel_hi:[1,0,1]
v_pk_fma_f32 v[110:111], v[30:31], v[150:151], v[110:111] op_sel:[0,0,0] op_sel_hi:[1,0,1]
v_pk_mul_f32 v[108:109], v[108:109], v[150:151] op_sel:[0,1] op_sel_hi:[1,1]
v_pk_mul_f32 v[110:111], v[110:111], v[150:151] op_sel:[0,1] op_sel_hi:[1,1]
v_pk_fma_f32 v[112:113], v[32:33], v[150:151], v[112:113] op_sel:[0,0,0] op_sel_hi:[1,0,1]
v_pk_fma_f32 v[114:115], v[34:35], v[150:151], v[114:115] op_sel:[0,0,0] op_sel_hi:[1,0,1]
v_pk_mul_f32 v[112:113], v[112:113], v[150:151] op_sel:[0,1] op_sel_hi:[1,1]
v_pk_mul_f32 v[114:115], v[114:115], v[150:151] op_sel:[0,1] op_sel_hi:[1,1]
v_pk_fma_f32 v[116:117], v[36:37], v[150:151], v[116:117] op_sel:[0,0,0] op_sel_hi:[1,0,1]
v_pk_fma_f32 v[118:119], v[38:39], v[150:151], v[118:119] op_sel:[0,0,0] op_sel_hi:[1,0,1]
v_pk_mul_f32 v[116:117], v[116:117], v[150:151] op_sel:[0,1] op_sel_hi:[1,1]
v_pk_mul_f32 v[118:119], v[118:119], v[150:151] op_sel:[0,1] op_sel_hi:[1,1]
v_pk_fma_f32 v[120:121], v[136:137], v[150:151], v[120:121] op_sel:[0,0,0] op_sel_hi:[1,0,1]
v_pk_fma_f32 v[122:123], v[138:139], v[150:151], v[122:123] op_sel:[0,0,0] op_sel_hi:[1,0,1]
v_pk_mul_f32 v[120:121], v[120:121], v[150:151] op_sel:[0,1] op_sel_hi:[1,1]
v_pk_mul_f32 v[122:123], v[122:123], v[150:151] op_sel:[0,1] op_sel_hi:[1,1]
v_pk_fma_f32 v[124:125], v[140:141], v[150:151], v[124:125] op_sel:[0,0,0] op_sel_hi:[1,0,1]
v_pk_fma_f32 v[126:127], v[142:143], v[150:151], v[126:127] op_sel:[0,0,0] op_sel_hi:[1,0,1]
v_pk_mul_f32 v[124:125], v[124:125], v[150:151] op_sel:[0,1] op_sel_hi:[1,1]
v_pk_mul_f32 v[126:127], v[126:127], v[150:151] op_sel:[0,1] op_sel_hi:[1,1]
v_pk_fma_f32 v[128:129], v[144:145], v[150:151], v[128:129] op_sel:[0,0,0] op_sel_hi:[1,0,1]
v_pk_fma_f32 v[130:131], v[146:147], v[150:151], v[130:131] op_sel:[0,0,0] op_sel_hi:[1,0,1]
v_pk_mul_f32 v[128:129], v[128:129], v[150:151] op_sel:[0,1] op_sel_hi:[1,1]
v_pk_mul_f32 v[130:131], v[130:131], v[150:151] op_sel:[0,1] op_sel_hi:[1,1]
v_pk_fma_f32 v[132:133], v[244:245], v[150:151], v[132:133] op_sel:[0,0,0] op_sel_hi:[1,0,1]
v_pk_fma_f32 v[134:135], v[246:247], v[150:151], v[134:135] op_sel:[0,0,0] op_sel_hi:[1,0,1]
v_pk_mul_f32 v[132:133], v[132:133], v[150:151] op_sel:[0,1] op_sel_hi:[1,1]
v_pk_mul_f32 v[134:135], v[134:135], v[150:151] op_sel:[0,1] op_sel_hi:[1,1]
v_mfma_f32_16x16x32_bf16 v[24:27], a[128:131], v[184:187], 0
v_cvt_pk_bf16_f32 v200, v104, v105
v_cvt_pk_bf16_f32 v201, v106, v107
v_mfma_f32_16x16x32_bf16 v[24:27], a[132:135], v[188:191], v[24:27]
v_cvt_pk_bf16_f32 v202, v108, v109
v_cvt_pk_bf16_f32 v203, v110, v111
v_mfma_f32_16x16x32_bf16 v[24:27], a[136:139], v[192:195], v[24:27]
v_cvt_pk_bf16_f32 v204, v112, v113
v_cvt_pk_bf16_f32 v205, v114, v115
v_mfma_f32_16x16x32_bf16 v[24:27], a[140:143], v[196:199], v[24:27]
v_cvt_pk_bf16_f32 v206, v116, v117
v_cvt_pk_bf16_f32 v207, v118, v119
v_mfma_f32_16x16x32_bf16 v[28:31], a[144:147], v[184:187], 0
v_cvt_pk_bf16_f32 v208, v120, v121
v_cvt_pk_bf16_f32 v209, v122, v123
v_mfma_f32_16x16x32_bf16 v[28:31], a[148:151], v[188:191], v[28:31]
v_cvt_pk_bf16_f32 v210, v124, v125
v_cvt_pk_bf16_f32 v211, v126, v127
v_mfma_f32_16x16x32_bf16 v[28:31], a[152:155], v[192:195], v[28:31]
v_cvt_pk_bf16_f32 v212, v128, v129
v_cvt_pk_bf16_f32 v213, v130, v131
v_mfma_f32_16x16x32_bf16 v[28:31], a[156:159], v[196:199], v[28:31]
v_cvt_pk_bf16_f32 v214, v132, v133
v_cvt_pk_bf16_f32 v215, v134, v135
v_permlane16_swap_b32 v200, v202
v_permlane16_swap_b32 v201, v203
v_permlane16_swap_b32 v204, v206
v_permlane16_swap_b32 v205, v207
v_permlane16_swap_b32 v208, v210
v_permlane16_swap_b32 v209, v211
v_permlane16_swap_b32 v212, v214
v_permlane16_swap_b32 v213, v215
v_max3_f32 v136, v8, v9, v10
v_max3_f32 v136, v136, v11, v12
v_mfma_f32_16x16x32_bf16 v[32:35], a[128:131], v[200:203], 0
ds_read_b128 a[128:131], v216 offset:40960
v_max3_f32 v136, v136, v13, v14
v_mfma_f32_16x16x32_bf16 v[32:35], a[132:135], v[204:207], v[32:35]
ds_read_b128 a[132:135], v217 offset:40960
v_max_f32 v136, v136, v15
v_mfma_f32_16x16x32_bf16 v[32:35], a[136:139], v[208:211], v[32:35]
ds_read_b128 a[136:139], v218 offset:40960
v_mov_b32 v137, v136
v_mfma_f32_16x16x32_bf16 v[32:35], a[140:143], v[212:215], v[32:35]
ds_read_b128 a[140:143], v219 offset:40960
v_max3_f32 v140, v16, v17, v18
v_mfma_f32_16x16x32_bf16 v[36:39], a[144:147], v[200:203], 0
ds_read_b128 a[144:147], v216 offset:45056
v_max3_f32 v140, v140, v19, v20
v_mfma_f32_16x16x32_bf16 v[36:39], a[148:151], v[204:207], v[36:39]
ds_read_b128 a[148:151], v217 offset:45056
v_max3_f32 v140, v140, v21, v22
v_mfma_f32_16x16x32_bf16 v[36:39], a[152:155], v[208:211], v[36:39]
ds_read_b128 a[152:155], v218 offset:45056
v_max_f32 v140, v140, v23
v_mfma_f32_16x16x32_bf16 v[36:39], a[156:159], v[212:215], v[36:39]
ds_read_b128 a[156:159], v219 offset:45056
v_mov_b32 v141, v140
s_mov_b32 s48, 0x244000
buffer_load_dwordx4 v[104:107], v234, s[20:23], s48 offen offset:0 sc0 sc1
buffer_load_dwordx4 v[108:111], v234, s[20:23], s48 offen offset:1024 sc0 sc1
buffer_load_dwordx4 v[112:115], v234, s[20:23], s48 offen offset:2048 sc0 sc1
buffer_load_dwordx4 v[116:119], v234, s[20:23], s48 offen offset:3072 sc0 sc1
v_max3_f32 v144, v24, v25, v26
v_max3_f32 v144, v144, v27, v28
v_max3_f32 v144, v144, v29, v30
v_max_f32 v144, v144, v31
v_mov_b32 v145, v144
s_mov_b32 s48, 0x245000
buffer_load_dwordx4 v[120:123], v234, s[20:23], s48 offen offset:0 sc0 sc1
buffer_load_dwordx4 v[124:127], v234, s[20:23], s48 offen offset:1024 sc0 sc1
buffer_load_dwordx4 v[128:131], v234, s[20:23], s48 offen offset:2048 sc0 sc1
buffer_load_dwordx4 v[132:135], v234, s[20:23], s48 offen offset:3072 sc0 sc1
v_max3_f32 v148, v32, v33, v34
v_max3_f32 v148, v148, v35, v36
v_max3_f32 v148, v148, v37, v38
v_max_f32 v148, v148, v39
v_mov_b32 v149, v148
v_permlane16_swap_b32 v136, v137
v_permlane16_swap_b32 v140, v141
v_permlane16_swap_b32 v144, v145
v_permlane16_swap_b32 v148, v149
v_max_f32 v136, v136, v137
v_mov_b32 v137, v136
v_max_f32 v140, v140, v141
v_mov_b32 v141, v140
v_max_f32 v144, v144, v145
v_mov_b32 v145, v144
v_max_f32 v148, v148, v149
v_mov_b32 v149, v148
v_permlane32_swap_b32 v136, v137
v_permlane32_swap_b32 v140, v141
v_permlane32_swap_b32 v144, v145
v_permlane32_swap_b32 v148, v149
v_max_f32 v136, v136, v137
v_max_f32 v140, v140, v141
v_max_f32 v144, v144, v145
v_max_f32 v148, v148, v149
v_sub_f32 v139, 0, v136
v_sub_f32 v138, 0, v136
v_sub_f32 v137, 0, v136
v_sub_f32 v136, 0, v136
v_sub_f32 v143, 0, v140
v_sub_f32 v142, 0, v140
v_sub_f32 v141, 0, v140
v_sub_f32 v140, 0, v140
v_sub_f32 v147, 0, v144
v_sub_f32 v146, 0, v144
v_sub_f32 v145, 0, v144
v_sub_f32 v144, 0, v144
v_sub_f32 v151, 0, v148
v_sub_f32 v150, 0, v148
v_sub_f32 v149, 0, v148
v_sub_f32 v148, 0, v148
K_HAVEMAX:
v_pk_add_f32 v[8:9], v[8:9], v[136:137]
v_pk_add_f32 v[10:11], v[10:11], v[136:137]
v_pk_add_f32 v[12:13], v[12:13], v[136:137]
v_pk_add_f32 v[14:15], v[14:15], v[136:137]
v_pk_add_f32 v[16:17], v[16:17], v[140:141]
v_pk_add_f32 v[18:19], v[18:19], v[140:141]
v_pk_add_f32 v[20:21], v[20:21], v[140:141]
v_pk_add_f32 v[22:23], v[22:23], v[140:141]
v_pk_add_f32 v[24:25], v[24:25], v[144:145]
v_pk_add_f32 v[26:27], v[26:27], v[144:145]
v_pk_add_f32 v[28:29], v[28:29], v[144:145]
v_pk_add_f32 v[30:31], v[30:31], v[144:145]
v_pk_add_f32 v[32:33], v[32:33], v[148:149]
v_pk_add_f32 v[34:35], v[34:35], v[148:149]
v_pk_add_f32 v[36:37], v[36:37], v[148:149]
v_pk_add_f32 v[38:39], v[38:39], v[148:149]
s_waitcnt lgkmcnt(6)
v_mfma_f32_16x16x32_bf16 v[40:43], a[128:131], v[152:155], v[136:139]
v_exp_f32 v8, v8
v_exp_f32 v9, v9
v_mfma_f32_16x16x32_bf16 v[40:43], a[132:135], v[156:159], v[40:43]
s_waitcnt lgkmcnt(5)
v_cvt_pk_bf16_f32 v72, v8, v9
v_exp_f32 v10, v10
v_mfma_f32_16x16x32_bf16 v[40:43], a[136:139], v[160:163], v[40:43]
s_waitcnt lgkmcnt(4)
v_exp_f32 v11, v11
v_mfma_f32_16x16x32_bf16 v[40:43], a[140:143], v[164:167], v[40:43]
v_cvt_pk_bf16_f32 v73, v10, v11
v_exp_f32 v12, v12
v_mfma_f32_16x16x32_bf16 v[48:51], a[128:131], v[168:171], v[140:143]
v_exp_f32 v13, v13
v_mfma_f32_16x16x32_bf16 v[48:51], a[132:135], v[172:175], v[48:51]
v_cvt_pk_bf16_f32 v74, v12, v13
v_exp_f32 v14, v14
s_waitcnt vmcnt(8) lgkmcnt(0)
s_barrier
v_mfma_f32_16x16x32_bf16 v[48:51], a[136:139], v[176:179], v[48:51]
ds_read_b64_tr_b16 a[160:161], v220 offset:32768
ds_read_b64_tr_b16 a[162:163], v220 offset:36864
v_exp_f32 v15, v15
v_mfma_f32_16x16x32_bf16 v[48:51], a[140:143], v[180:183], v[48:51]
s_add_u32 m0, s37, 65536
v_exp_f32 v16, v16
v_exp_f32 v17, v17
v_mfma_f32_16x16x32_bf16 v[56:59], a[128:131], v[184:187], v[144:147]
buffer_load_dwordx4 v232, s[12:15], s39 offen offset:0 lds
v_exp_f32 v18, v18
v_mfma_f32_16x16x32_bf16 v[56:59], a[132:135], v[188:191], v[56:59]
ds_read_b64_tr_b16 a[164:165], v221 offset:32768
ds_read_b64_tr_b16 a[166:167], v221 offset:36864
v_exp_f32 v19, v19
v_mfma_f32_16x16x32_bf16 v[56:59], a[136:139], v[192:195], v[56:59]
buffer_load_dwordx4 v233, s[12:15], s39 offen offset:1024 lds
v_exp_f32 v20, v20
v_mfma_f32_16x16x32_bf16 v[56:59], a[140:143], v[196:199], v[56:59]
ds_read_b64_tr_b16 a[168:169], v222 offset:32768
ds_read_b64_tr_b16 a[170:171], v222 offset:36864
v_exp_f32 v21, v21
v_mfma_f32_16x16x32_bf16 v[64:67], a[128:131], v[200:203], v[148:151]
ds_read_b64_tr_b16 a[172:173], v223 offset:32768
ds_read_b64_tr_b16 a[174:175], v223 offset:36864
v_exp_f32 v22, v22
v_mfma_f32_16x16x32_bf16 v[64:67], a[132:135], v[204:207], v[64:67]
ds_read_b128 a[128:131], v216 offset:16384
ds_read_b64_tr_b16 a[176:177], v224 offset:32768
v_exp_f32 v23, v23
v_mfma_f32_16x16x32_bf16 v[64:67], a[136:139], v[208:211], v[64:67]
v_exp_f32 v24, v24
v_exp_f32 v25, v25
v_mfma_f32_16x16x32_bf16 v[64:67], a[140:143], v[212:215], v[64:67]
buffer_load_dwordx4 v232, s[12:15], s39 offen offset:2048 lds
v_exp_f32 v26, v26
v_mfma_f32_16x16x32_bf16 v[44:47], a[144:147], v[152:155], v[136:139]
ds_read_b64_tr_b16 a[178:179], v224 offset:36864
ds_read_b128 a[132:135], v217 offset:16384
v_exp_f32 v27, v27
v_mfma_f32_16x16x32_bf16 v[44:47], a[148:151], v[156:159], v[44:47]
ds_read_b128 a[136:139], v218 offset:16384
ds_read_b128 a[140:143], v219 offset:16384
v_exp_f32 v28, v28
v_mfma_f32_16x16x32_bf16 v[44:47], a[152:155], v[160:163], v[44:47]
buffer_load_dwordx4 v233, s[12:15], s39 offen offset:3072 lds
v_exp_f32 v29, v29
v_mfma_f32_16x16x32_bf16 v[44:47], a[156:159], v[164:167], v[44:47]
ds_read_b64_tr_b16 a[180:181], v225 offset:32768
ds_read_b64_tr_b16 a[182:183], v225 offset:36864
v_exp_f32 v30, v30
v_mfma_f32_16x16x32_bf16 v[52:55], a[144:147], v[168:171], v[140:143]
ds_read_b64_tr_b16 a[184:185], v226 offset:32768
ds_read_b64_tr_b16 a[186:187], v226 offset:36864
v_exp_f32 v31, v31
v_mfma_f32_16x16x32_bf16 v[52:55], a[148:151], v[172:175], v[52:55]
s_add_u32 s39, s39, 16384
v_exp_f32 v32, v32
v_exp_f32 v33, v33
v_mfma_f32_16x16x32_bf16 v[52:55], a[152:155], v[176:179], v[52:55]
s_add_u32 m0, s37, 49152
ds_read_b64_tr_b16 a[188:189], v227 offset:32768
ds_read_b64_tr_b16 a[190:191], v227 offset:36864
v_exp_f32 v34, v34
v_mfma_f32_16x16x32_bf16 v[52:55], a[156:159], v[180:183], v[52:55]
buffer_load_dwordx4 v228, s[8:11], s38 offen offset:0 lds
v_exp_f32 v35, v35
v_mfma_f32_16x16x32_bf16 v[60:63], a[144:147], v[184:187], v[144:147]
v_cvt_pk_bf16_f32 v75, v14, v15
v_cvt_pk_bf16_f32 v76, v16, v17
v_exp_f32 v36, v36
v_mfma_f32_16x16x32_bf16 v[60:63], a[148:151], v[188:191], v[60:63]
buffer_load_dwordx4 v229, s[8:11], s38 offen offset:1024 lds
v_exp_f32 v37, v37
v_mfma_f32_16x16x32_bf16 v[60:63], a[152:155], v[192:195], v[60:63]
v_cvt_pk_bf16_f32 v77, v18, v19
v_cvt_pk_bf16_f32 v78, v20, v21
v_exp_f32 v38, v38
v_mfma_f32_16x16x32_bf16 v[60:63], a[156:159], v[196:199], v[60:63]
v_cvt_pk_bf16_f32 v79, v22, v23
v_cvt_pk_bf16_f32 v80, v24, v25
v_exp_f32 v39, v39
v_mfma_f32_16x16x32_bf16 v[68:71], a[144:147], v[200:203], v[148:151]
ds_read_b128 a[144:147], v216 offset:20480
v_cvt_pk_bf16_f32 v81, v26, v27
v_cvt_pk_bf16_f32 v82, v28, v29
v_cvt_pk_bf16_f32 v83, v30, v31
v_mfma_f32_16x16x32_bf16 v[68:71], a[148:151], v[204:207], v[68:71]
ds_read_b128 a[148:151], v217 offset:20480
v_cvt_pk_bf16_f32 v84, v32, v33
v_cvt_pk_bf16_f32 v85, v34, v35
v_cvt_pk_bf16_f32 v86, v36, v37
v_mfma_f32_16x16x32_bf16 v[68:71], a[152:155], v[208:211], v[68:71]
ds_read_b128 a[152:155], v218 offset:20480
v_cvt_pk_bf16_f32 v87, v38, v39
v_mfma_f32_16x16x32_bf16 v[68:71], a[156:159], v[212:215], v[68:71]
ds_read_b128 a[156:159], v219 offset:20480
s_cmp_lg_u32 s41, 0
s_cbranch_scc1 K_RANKED
s_waitcnt vmcnt(6)
v_max3_u32 v255, v104, v105, v106
s_max_u32 s48, s92, s93
v_max3_u32 v255, v255, v107, v108
v_max3_u32 v255, v255, v109, v110
v_max3_u32 v255, v255, v111, v112
v_max3_u32 v255, v255, v113, v114
v_max3_u32 v255, v255, v115, v116
v_max3_u32 v255, v255, v117, v118
v_max3_u32 v255, v255, v119, v120
v_max3_u32 v255, v255, v121, v122
v_max3_u32 v255, v255, v123, v124
v_max3_u32 v255, v255, v125, v126
v_max3_u32 v255, v255, v127, v128
v_max3_u32 v255, v255, v129, v130
v_max3_u32 v255, v255, v131, v132
v_max3_u32 v255, v255, v133, v134
v_max_u32 v255, v255, v135
v_cmp_lt_u32 vcc, s48, v255
s_bcnt1_i32_b64 s48, vcc
s_cmp_lt_u32 s48, 8
s_cbranch_scc1 K_RANK
K_RANKED:
s_waitcnt lgkmcnt(0)
s_mov_b32 s40, 0
s_mov_b32 s76, s90
s_and_b32 s77, s91, 0xffff
s_mov_b32 s78, 0x0
s_mov_b32 s79, 0x00020000
v_mov_b32 v253, 0
s_mov_b32 s42, 0
s_mov_b32 s43, 0
s_mov_b32 s44, 0x2a000
s_mov_b32 s45, 0x7f000000
.p2align 6
K_LOOP:
v_mfma_f32_16x16x32_bf16 v[8:11], a[128:131], v[152:155], v[136:139]
v_exp_f32 v40, v40
v_mfma_f32_16x16x32_bf16 v[8:11], a[132:135], v[156:159], v[8:11]
v_exp_f32 v41, v41
v_mfma_f32_16x16x32_bf16 v[8:11], a[136:139], v[160:163], v[8:11]
buffer_load_dwordx4 v230, s[8:11], s38 offen offset:2048 lds
v_mfma_f32_16x16x32_bf16 v[8:11], a[140:143], v[164:167], v[8:11]
v_exp_f32 v42, v42
v_mfma_f32_16x16x32_bf16 a[0:3], a[160:163], v[72:75], a[0:3]
v_cvt_pk_bf16_f32 v88, v40, v41
v_mfma_f32_16x16x32_bf16 a[32:35], a[160:163], v[76:79], a[32:35]
v_exp_f32 v43, v43
v_mfma_f32_16x16x32_bf16 a[64:67], a[160:163], v[80:83], a[64:67]
v_cvt_pk_bf16_f32 v89, v42, v43
v_mfma_f32_16x16x32_bf16 a[96:99], a[160:163], v[84:87], a[96:99]
v_exp_f32 v44, v44
v_mfma_f32_16x16x32_bf16 v[16:19], a[128:131], v[168:171], v[140:143]
ds_read_b64_tr_b16 a[160:161], v220 offset:40960
ds_read_b64_tr_b16 a[162:163], v220 offset:45056
v_mfma_f32_16x16x32_bf16 v[16:19], a[132:135], v[172:175], v[16:19]
v_exp_f32 v45, v45
v_mfma_f32_16x16x32_bf16 v[16:19], a[136:139], v[176:179], v[16:19]
v_cvt_pk_bf16_f32 v90, v44, v45
v_mfma_f32_16x16x32_bf16 v[16:19], a[140:143], v[180:183], v[16:19]
v_exp_f32 v46, v46
v_mfma_f32_16x16x32_bf16 a[4:7], a[164:167], v[72:75], a[4:7]
v_mfma_f32_16x16x32_bf16 a[36:39], a[164:167], v[76:79], a[36:39]
v_exp_f32 v47, v47
v_mfma_f32_16x16x32_bf16 a[68:71], a[164:167], v[80:83], a[68:71]
buffer_load_dwordx4 v231, s[8:11], s38 offen offset:3072 lds
v_mfma_f32_16x16x32_bf16 a[100:103], a[164:167], v[84:87], a[100:103]
v_exp_f32 v48, v48
v_smfmac_f32_16x16x64_bf16 a[248:251], a[208:211], v[72:79], v235
ds_read_b64_tr_b16 a[164:165], v221 offset:40960
ds_read_b64_tr_b16 a[166:167], v221 offset:45056
v_mfma_f32_16x16x32_bf16 v[24:27], a[128:131], v[184:187], v[144:147]
v_exp_f32 v49, v49
v_mfma_f32_16x16x32_bf16 v[24:27], a[132:135], v[188:191], v[24:27]
v_cvt_pk_bf16_f32 v91, v46, v47
v_cvt_pk_bf16_f32 v92, v48, v49
v_mfma_f32_16x16x32_bf16 v[24:27], a[136:139], v[192:195], v[24:27]
v_exp_f32 v50, v50
v_mfma_f32_16x16x32_bf16 v[24:27], a[140:143], v[196:199], v[24:27]
v_mfma_f32_16x16x32_bf16 a[8:11], a[168:171], v[72:75], a[8:11]
v_exp_f32 v51, v51
v_mfma_f32_16x16x32_bf16 a[40:43], a[168:171], v[76:79], a[40:43]
v_cvt_pk_bf16_f32 v93, v50, v51
v_mfma_f32_16x16x32_bf16 a[72:75], a[168:171], v[80:83], a[72:75]
v_exp_f32 v52, v52
v_mfma_f32_16x16x32_bf16 a[104:107], a[168:171], v[84:87], a[104:107]
ds_read_b64_tr_b16 a[168:169], v222 offset:40960
ds_read_b64_tr_b16 a[170:171], v222 offset:45056
v_mfma_f32_16x16x32_bf16 v[32:35], a[128:131], v[200:203], v[148:151]
s_add_u32 s38, s38, 16384
v_exp_f32 v53, v53
v_mfma_f32_16x16x32_bf16 v[32:35], a[132:135], v[204:207], v[32:35]
s_add_u32 m0, s37, 81920
ds_read_b128 a[128:131], v216 offset:24576
ds_read_b128 a[132:135], v217 offset:24576
v_mfma_f32_16x16x32_bf16 v[32:35], a[136:139], v[208:211], v[32:35]
v_exp_f32 v54, v54
v_mfma_f32_16x16x32_bf16 v[32:35], a[140:143], v[212:215], v[32:35]
buffer_load_dwordx4 v232, s[12:15], s39 offen offset:0 lds
v_mfma_f32_16x16x32_bf16 a[12:15], a[172:175], v[72:75], a[12:15]
v_exp_f32 v55, v55
v_mfma_f32_16x16x32_bf16 a[44:47], a[172:175], v[76:79], a[44:47]
ds_read_b128 a[136:139], v218 offset:24576
ds_read_b128 a[140:143], v219 offset:24576
v_mfma_f32_16x16x32_bf16 a[76:79], a[172:175], v[80:83], a[76:79]
v_exp_f32 v56, v56
v_mfma_f32_16x16x32_bf16 a[108:111], a[172:175], v[84:87], a[108:111]
s_waitcnt lgkmcnt(6)
v_exp_f32 v57, v57
v_mfma_f32_16x16x32_bf16 v[12:15], a[144:147], v[152:155], v[136:139]
ds_read_b64_tr_b16 a[172:173], v223 offset:40960
ds_read_b64_tr_b16 a[174:175], v223 offset:45056
v_mfma_f32_16x16x32_bf16 v[12:15], a[148:151], v[156:159], v[12:15]
v_exp_f32 v58, v58
v_mfma_f32_16x16x32_bf16 v[12:15], a[152:155], v[160:163], v[12:15]
v_cvt_pk_bf16_f32 v94, v52, v53
v_cvt_pk_bf16_f32 v95, v54, v55
v_mfma_f32_16x16x32_bf16 v[12:15], a[156:159], v[164:167], v[12:15]
v_exp_f32 v59, v59
v_mfma_f32_16x16x32_bf16 a[16:19], a[176:179], v[72:75], a[16:19]
v_cvt_pk_bf16_f32 v96, v56, v57
v_cvt_pk_bf16_f32 v97, v58, v59
v_mfma_f32_16x16x32_bf16 a[48:51], a[176:179], v[76:79], a[48:51]
v_exp_f32 v60, v60
v_mfma_f32_16x16x32_bf16 a[80:83], a[176:179], v[80:83], a[80:83]
buffer_load_dwordx4 v233, s[12:15], s39 offen offset:1024 lds
v_mfma_f32_16x16x32_bf16 a[112:115], a[176:179], v[84:87], a[112:115]
v_exp_f32 v61, v61
v_mfma_f32_16x16x32_bf16 v[20:23], a[144:147], v[168:171], v[140:143]
ds_read_b64_tr_b16 a[176:177], v224 offset:40960
ds_read_b64_tr_b16 a[178:179], v224 offset:45056
v_mfma_f32_16x16x32_bf16 v[20:23], a[148:151], v[172:175], v[20:23]
v_exp_f32 v62, v62
v_mfma_f32_16x16x32_bf16 v[20:23], a[152:155], v[176:179], v[20:23]
v_cvt_pk_bf16_f32 v98, v60, v61
v_mfma_f32_16x16x32_bf16 v[20:23], a[156:159], v[180:183], v[20:23]
v_exp_f32 v63, v63
v_mfma_f32_16x16x32_bf16 a[20:23], a[180:183], v[72:75], a[20:23]
v_cvt_pk_bf16_f32 v99, v62, v63
v_mfma_f32_16x16x32_bf16 a[52:55], a[180:183], v[76:79], a[52:55]
v_exp_f32 v64, v64
v_mfma_f32_16x16x32_bf16 a[84:87], a[180:183], v[80:83], a[84:87]
v_mfma_f32_16x16x32_bf16 a[116:119], a[180:183], v[84:87], a[116:119]
v_exp_f32 v65, v65
v_smfmac_f32_16x16x64_bf16 a[252:255], a[208:211], v[80:87], v235
ds_read_b64_tr_b16 a[180:181], v225 offset:40960
ds_read_b64_tr_b16 a[182:183], v225 offset:45056
v_mfma_f32_16x16x32_bf16 v[28:31], a[144:147], v[184:187], v[144:147]
v_exp_f32 v66, v66
v_mfma_f32_16x16x32_bf16 v[28:31], a[148:151], v[188:191], v[28:31]
buffer_load_dwordx4 v232, s[12:15], s39 offen offset:2048 lds
v_mfma_f32_16x16x32_bf16 v[28:31], a[152:155], v[192:195], v[28:31]
v_exp_f32 v67, v67
v_mfma_f32_16x16x32_bf16 v[28:31], a[156:159], v[196:199], v[28:31]
v_cvt_pk_bf16_f32 v100, v64, v65
v_cvt_pk_bf16_f32 v101, v66, v67
v_mfma_f32_16x16x32_bf16 a[24:27], a[184:187], v[72:75], a[24:27]
v_exp_f32 v68, v68
v_mfma_f32_16x16x32_bf16 a[56:59], a[184:187], v[76:79], a[56:59]
v_mfma_f32_16x16x32_bf16 a[88:91], a[184:187], v[80:83], a[88:91]
v_exp_f32 v69, v69
v_mfma_f32_16x16x32_bf16 a[120:123], a[184:187], v[84:87], a[120:123]
ds_read_b64_tr_b16 a[184:185], v226 offset:40960
ds_read_b64_tr_b16 a[186:187], v226 offset:45056
v_mfma_f32_16x16x32_bf16 v[36:39], a[144:147], v[200:203], v[148:151]
v_exp_f32 v70, v70
v_mfma_f32_16x16x32_bf16 v[36:39], a[148:151], v[204:207], v[36:39]
ds_read_b128 a[144:147], v216 offset:28672
ds_read_b128 a[148:151], v217 offset:28672
v_mfma_f32_16x16x32_bf16 v[36:39], a[152:155], v[208:211], v[36:39]
v_exp_f32 v71, v71
v_mfma_f32_16x16x32_bf16 v[36:39], a[156:159], v[212:215], v[36:39]
ds_read_b128 a[152:155], v218 offset:28672
ds_read_b128 a[156:159], v219 offset:28672
v_mfma_f32_16x16x32_bf16 a[28:31], a[188:191], v[72:75], a[28:31]
v_cvt_pk_bf16_f32 v102, v68, v69
v_cvt_pk_bf16_f32 v103, v70, v71
v_mfma_f32_16x16x32_bf16 a[60:63], a[188:191], v[76:79], a[60:63]
v_mfma_f32_16x16x32_bf16 a[92:95], a[188:191], v[80:83], a[92:95]
v_mfma_f32_16x16x32_bf16 a[124:127], a[188:191], v[84:87], a[124:127]
s_waitcnt lgkmcnt(6)
ds_read_b64_tr_b16 a[188:189], v227 offset:40960
ds_read_b64_tr_b16 a[190:191], v227 offset:45056
v_mfma_f32_16x16x32_bf16 v[40:43], a[128:131], v[152:155], v[136:139]
v_exp_f32 v8, v8
v_mfma_f32_16x16x32_bf16 v[40:43], a[132:135], v[156:159], v[40:43]
v_exp_f32 v9, v9
v_mfma_f32_16x16x32_bf16 v[40:43], a[136:139], v[160:163], v[40:43]
buffer_load_dwordx4 v233, s[12:15], s39 offen offset:3072 lds
v_mfma_f32_16x16x32_bf16 v[40:43], a[140:143], v[164:167], v[40:43]
v_exp_f32 v10, v10
v_mfma_f32_16x16x32_bf16 a[0:3], a[160:163], v[88:91], a[0:3]
v_cvt_pk_bf16_f32 v72, v8, v9
v_mfma_f32_16x16x32_bf16 a[32:35], a[160:163], v[92:95], a[32:35]
v_exp_f32 v11, v11
v_mfma_f32_16x16x32_bf16 a[64:67], a[160:163], v[96:99], a[64:67]
v_cvt_pk_bf16_f32 v73, v10, v11
v_mfma_f32_16x16x32_bf16 a[96:99], a[160:163], v[100:103], a[96:99]
v_exp_f32 v12, v12
v_mfma_f32_16x16x32_bf16 v[48:51], a[128:131], v[168:171], v[140:143]
ds_read_b64_tr_b16 a[160:161], v220 offset:49152
ds_read_b64_tr_b16 a[162:163], v220 offset:53248
v_mfma_f32_16x16x32_bf16 v[48:51], a[132:135], v[172:175], v[48:51]
v_exp_f32 v13, v13
v_mfma_f32_16x16x32_bf16 v[48:51], a[136:139], v[176:179], v[48:51]
v_cvt_pk_bf16_f32 v74, v12, v13
v_mfma_f32_16x16x32_bf16 v[48:51], a[140:143], v[180:183], v[48:51]
v_exp_f32 v14, v14
v_mfma_f32_16x16x32_bf16 a[4:7], a[164:167], v[88:91], a[4:7]
v_mfma_f32_16x16x32_bf16 a[36:39], a[164:167], v[92:95], a[36:39]
s_add_u32 s39, s39, 16384
v_exp_f32 v15, v15
v_mfma_f32_16x16x32_bf16 a[68:71], a[164:167], v[96:99], a[68:71]
s_add_u32 m0, s37, 32768
v_cvt_pk_bf16_f32 v75, v14, v15
v_mfma_f32_16x16x32_bf16 a[100:103], a[164:167], v[100:103], a[100:103]
v_exp_f32 v16, v16
v_smfmac_f32_16x16x64_bf16 a[248:251], a[208:211], v[88:95], v235
buffer_load_dwordx4 v228, s[8:11], s38 offen offset:0 lds
v_mfma_f32_16x16x32_bf16 v[56:59], a[128:131], v[184:187], v[144:147]
v_exp_f32 v17, v17
v_mfma_f32_16x16x32_bf16 v[56:59], a[132:135], v[188:191], v[56:59]
ds_read_b64_tr_b16 a[164:165], v221 offset:49152
ds_read_b64_tr_b16 a[166:167], v221 offset:53248
v_mfma_f32_16x16x32_bf16 v[56:59], a[136:139], v[192:195], v[56:59]
v_exp_f32 v18, v18
v_mfma_f32_16x16x32_bf16 v[56:59], a[140:143], v[196:199], v[56:59]
v_cvt_pk_bf16_f32 v76, v16, v17
v_mfma_f32_16x16x32_bf16 a[8:11], a[168:171], v[88:91], a[8:11]
v_exp_f32 v19, v19
v_mfma_f32_16x16x32_bf16 a[40:43], a[168:171], v[92:95], a[40:43]
v_cvt_pk_bf16_f32 v77, v18, v19
v_mfma_f32_16x16x32_bf16 a[72:75], a[168:171], v[96:99], a[72:75]
v_exp_f32 v20, v20
v_mfma_f32_16x16x32_bf16 a[104:107], a[168:171], v[100:103], a[104:107]
ds_read_b64_tr_b16 a[168:169], v222 offset:49152
ds_read_b64_tr_b16 a[170:171], v222 offset:53248
v_mfma_f32_16x16x32_bf16 v[64:67], a[128:131], v[200:203], v[148:151]
v_exp_f32 v21, v21
v_mfma_f32_16x16x32_bf16 v[64:67], a[132:135], v[204:207], v[64:67]
buffer_load_dwordx4 v229, s[8:11], s38 offen offset:1024 lds
v_mfma_f32_16x16x32_bf16 v[64:67], a[136:139], v[208:211], v[64:67]
v_exp_f32 v22, v22
v_mfma_f32_16x16x32_bf16 v[64:67], a[140:143], v[212:215], v[64:67]
ds_read_b128 a[128:131], v216 offset:0
ds_read_b128 a[132:135], v217 offset:0
v_mfma_f32_16x16x32_bf16 a[12:15], a[172:175], v[88:91], a[12:15]
v_exp_f32 v23, v23
v_mfma_f32_16x16x32_bf16 a[44:47], a[172:175], v[92:95], a[44:47]
ds_read_b128 a[136:139], v218 offset:0
ds_read_b128 a[140:143], v219 offset:0
v_mfma_f32_16x16x32_bf16 a[76:79], a[172:175], v[96:99], a[76:79]
v_exp_f32 v24, v24
v_mfma_f32_16x16x32_bf16 a[108:111], a[172:175], v[100:103], a[108:111]
s_waitcnt lgkmcnt(6)
v_exp_f32 v25, v25
v_mfma_f32_16x16x32_bf16 v[44:47], a[144:147], v[152:155], v[136:139]
ds_read_b64_tr_b16 a[172:173], v223 offset:49152
ds_read_b64_tr_b16 a[174:175], v223 offset:53248
v_mfma_f32_16x16x32_bf16 v[44:47], a[148:151], v[156:159], v[44:47]
v_exp_f32 v26, v26
v_mfma_f32_16x16x32_bf16 v[44:47], a[152:155], v[160:163], v[44:47]
v_cvt_pk_bf16_f32 v78, v20, v21
v_cvt_pk_bf16_f32 v79, v22, v23
v_mfma_f32_16x16x32_bf16 v[44:47], a[156:159], v[164:167], v[44:47]
v_exp_f32 v27, v27
v_mfma_f32_16x16x32_bf16 a[16:19], a[176:179], v[88:91], a[16:19]
v_cvt_pk_bf16_f32 v80, v24, v25
v_cvt_pk_bf16_f32 v81, v26, v27
v_mfma_f32_16x16x32_bf16 a[48:51], a[176:179], v[92:95], a[48:51]
v_exp_f32 v28, v28
v_mfma_f32_16x16x32_bf16 a[80:83], a[176:179], v[96:99], a[80:83]
buffer_load_dwordx4 v230, s[8:11], s38 offen offset:2048 lds
v_mfma_f32_16x16x32_bf16 a[112:115], a[176:179], v[100:103], a[112:115]
v_exp_f32 v29, v29
v_mfma_f32_16x16x32_bf16 v[52:55], a[144:147], v[168:171], v[140:143]
ds_read_b64_tr_b16 a[176:177], v224 offset:49152
ds_read_b64_tr_b16 a[178:179], v224 offset:53248
v_mfma_f32_16x16x32_bf16 v[52:55], a[148:151], v[172:175], v[52:55]
v_exp_f32 v30, v30
v_mfma_f32_16x16x32_bf16 v[52:55], a[152:155], v[176:179], v[52:55]
v_cvt_pk_bf16_f32 v82, v28, v29
v_mfma_f32_16x16x32_bf16 v[52:55], a[156:159], v[180:183], v[52:55]
v_exp_f32 v31, v31
v_mfma_f32_16x16x32_bf16 a[20:23], a[180:183], v[88:91], a[20:23]
v_cvt_pk_bf16_f32 v83, v30, v31
v_mfma_f32_16x16x32_bf16 a[52:55], a[180:183], v[92:95], a[52:55]
v_exp_f32 v32, v32
v_mfma_f32_16x16x32_bf16 a[84:87], a[180:183], v[96:99], a[84:87]
v_mfma_f32_16x16x32_bf16 a[116:119], a[180:183], v[100:103], a[116:119]
v_exp_f32 v33, v33
v_smfmac_f32_16x16x64_bf16 a[252:255], a[208:211], v[96:103], v235
ds_read_b64_tr_b16 a[180:181], v225 offset:49152
ds_read_b64_tr_b16 a[182:183], v225 offset:53248
v_mfma_f32_16x16x32_bf16 v[60:63], a[144:147], v[184:187], v[144:147]
v_exp_f32 v34, v34
v_mfma_f32_16x16x32_bf16 v[60:63], a[148:151], v[188:191], v[60:63]
buffer_load_dwordx4 v231, s[8:11], s38 offen offset:3072 lds
v_mfma_f32_16x16x32_bf16 v[60:63], a[152:155], v[192:195], v[60:63]
v_exp_f32 v35, v35
v_mfma_f32_16x16x32_bf16 v[60:63], a[156:159], v[196:199], v[60:63]
v_cvt_pk_bf16_f32 v84, v32, v33
v_cvt_pk_bf16_f32 v85, v34, v35
v_mfma_f32_16x16x32_bf16 a[24:27], a[184:187], v[88:91], a[24:27]
v_exp_f32 v36, v36
v_mfma_f32_16x16x32_bf16 a[56:59], a[184:187], v[92:95], a[56:59]
v_mfma_f32_16x16x32_bf16 a[88:91], a[184:187], v[96:99], a[88:91]
v_exp_f32 v37, v37
v_mfma_f32_16x16x32_bf16 a[120:123], a[184:187], v[100:103], a[120:123]
ds_read_b64_tr_b16 a[184:185], v226 offset:49152
ds_read_b64_tr_b16 a[186:187], v226 offset:53248
v_mfma_f32_16x16x32_bf16 v[68:71], a[144:147], v[200:203], v[148:151]
v_exp_f32 v38, v38
v_mfma_f32_16x16x32_bf16 v[68:71], a[148:151], v[204:207], v[68:71]
ds_read_b128 a[144:147], v216 offset:4096
ds_read_b128 a[148:151], v217 offset:4096
v_mfma_f32_16x16x32_bf16 v[68:71], a[152:155], v[208:211], v[68:71]
v_exp_f32 v39, v39
v_mfma_f32_16x16x32_bf16 v[68:71], a[156:159], v[212:215], v[68:71]
ds_read_b128 a[152:155], v218 offset:4096
ds_read_b128 a[156:159], v219 offset:4096
v_mfma_f32_16x16x32_bf16 a[28:31], a[188:191], v[88:91], a[28:31]
v_cvt_pk_bf16_f32 v86, v36, v37
v_cvt_pk_bf16_f32 v87, v38, v39
v_mfma_f32_16x16x32_bf16 a[60:63], a[188:191], v[92:95], a[60:63]
s_add_u32 s38, s38, 16384
v_mfma_f32_16x16x32_bf16 a[92:95], a[188:191], v[96:99], a[92:95]
v_mfma_f32_16x16x32_bf16 a[124:127], a[188:191], v[100:103], a[124:127]
s_waitcnt lgkmcnt(6)
ds_read_b64_tr_b16 a[188:189], v227 offset:49152
ds_read_b64_tr_b16 a[190:191], v227 offset:53248
v_mfma_f32_16x16x32_bf16 v[8:11], a[128:131], v[152:155], v[136:139]
v_exp_f32 v40, v40
v_mfma_f32_16x16x32_bf16 v[8:11], a[132:135], v[156:159], v[8:11]
s_mov_b32 m0, s44
v_exp_f32 v41, v41
v_mfma_f32_16x16x32_bf16 v[8:11], a[136:139], v[160:163], v[8:11]
buffer_load_dwordx4 v238, s[60:63], s45 offen lds
v_mfma_f32_16x16x32_bf16 v[8:11], a[140:143], v[164:167], v[8:11]
v_exp_f32 v42, v42
v_mfma_f32_16x16x32_bf16 a[0:3], a[160:163], v[72:75], a[0:3]
v_cvt_pk_bf16_f32 v88, v40, v41
v_mfma_f32_16x16x32_bf16 a[32:35], a[160:163], v[76:79], a[32:35]
v_exp_f32 v43, v43
v_mfma_f32_16x16x32_bf16 a[64:67], a[160:163], v[80:83], a[64:67]
v_cvt_pk_bf16_f32 v89, v42, v43
v_mfma_f32_16x16x32_bf16 a[96:99], a[160:163], v[84:87], a[96:99]
v_exp_f32 v44, v44
v_mfma_f32_16x16x32_bf16 v[16:19], a[128:131], v[168:171], v[140:143]
ds_read_b64_tr_b16 a[160:161], v220 offset:57344
ds_read_b64_tr_b16 a[162:163], v220 offset:61440
v_mfma_f32_16x16x32_bf16 v[16:19], a[132:135], v[172:175], v[16:19]
v_exp_f32 v45, v45
v_mfma_f32_16x16x32_bf16 v[16:19], a[136:139], v[176:179], v[16:19]
v_cvt_pk_bf16_f32 v90, v44, v45
v_mfma_f32_16x16x32_bf16 v[16:19], a[140:143], v[180:183], v[16:19]
v_exp_f32 v46, v46
v_mfma_f32_16x16x32_bf16 a[4:7], a[164:167], v[72:75], a[4:7]
v_mfma_f32_16x16x32_bf16 a[36:39], a[164:167], v[76:79], a[36:39]
v_exp_f32 v47, v47
v_mfma_f32_16x16x32_bf16 a[68:71], a[164:167], v[80:83], a[68:71]
v_cvt_pk_bf16_f32 v91, v46, v47
v_mfma_f32_16x16x32_bf16 a[100:103], a[164:167], v[84:87], a[100:103]
v_exp_f32 v48, v48
v_smfmac_f32_16x16x64_bf16 a[248:251], a[208:211], v[72:79], v235
ds_read_b64_tr_b16 a[164:165], v221 offset:57344
ds_read_b64_tr_b16 a[166:167], v221 offset:61440
v_mfma_f32_16x16x32_bf16 v[24:27], a[128:131], v[184:187], v[144:147]
v_exp_f32 v49, v49
v_mfma_f32_16x16x32_bf16 v[24:27], a[132:135], v[188:191], v[24:27]
v_cvt_pk_bf16_f32 v92, v48, v49
v_mfma_f32_16x16x32_bf16 v[24:27], a[136:139], v[192:195], v[24:27]
s_add_u32 s45, s45, 589824
v_exp_f32 v50, v50
v_mfma_f32_16x16x32_bf16 v[24:27], a[140:143], v[196:199], v[24:27]
s_add_u32 s44, s44, 4096
buffer_load_dword v252, v253, s[76:79], s42 offen
v_mfma_f32_16x16x32_bf16 a[8:11], a[168:171], v[72:75], a[8:11]
v_exp_f32 v51, v51
v_mfma_f32_16x16x32_bf16 a[40:43], a[168:171], v[76:79], a[40:43]
v_cvt_pk_bf16_f32 v93, v50, v51
v_mfma_f32_16x16x32_bf16 a[72:75], a[168:171], v[80:83], a[72:75]
v_exp_f32 v52, v52
v_mfma_f32_16x16x32_bf16 a[104:107], a[168:171], v[84:87], a[104:107]
ds_read_b64_tr_b16 a[168:169], v222 offset:57344
ds_read_b64_tr_b16 a[170:171], v222 offset:61440
v_mfma_f32_16x16x32_bf16 v[32:35], a[128:131], v[200:203], v[148:151]
v_exp_f32 v53, v53
v_mfma_f32_16x16x32_bf16 v[32:35], a[132:135], v[204:207], v[32:35]
ds_read_b128 a[128:131], v216 offset:8192
ds_read_b128 a[132:135], v217 offset:8192
v_mfma_f32_16x16x32_bf16 v[32:35], a[136:139], v[208:211], v[32:35]
v_exp_f32 v54, v54
v_mfma_f32_16x16x32_bf16 v[32:35], a[140:143], v[212:215], v[32:35]
ds_read_b128 a[136:139], v218 offset:8192
ds_read_b128 a[140:143], v219 offset:8192
v_mfma_f32_16x16x32_bf16 a[12:15], a[172:175], v[72:75], a[12:15]
v_exp_f32 v55, v55
v_mfma_f32_16x16x32_bf16 a[44:47], a[172:175], v[76:79], a[44:47]
v_cvt_pk_bf16_f32 v94, v52, v53
v_cvt_pk_bf16_f32 v95, v54, v55
v_mfma_f32_16x16x32_bf16 a[76:79], a[172:175], v[80:83], a[76:79]
v_exp_f32 v56, v56
v_mfma_f32_16x16x32_bf16 a[108:111], a[172:175], v[84:87], a[108:111]
s_waitcnt lgkmcnt(6)
v_exp_f32 v57, v57
v_mfma_f32_16x16x32_bf16 v[12:15], a[144:147], v[152:155], v[136:139]
ds_read_b64_tr_b16 a[172:173], v223 offset:57344
ds_read_b64_tr_b16 a[174:175], v223 offset:61440
v_mfma_f32_16x16x32_bf16 v[12:15], a[148:151], v[156:159], v[12:15]
v_exp_f32 v58, v58
v_mfma_f32_16x16x32_bf16 v[12:15], a[152:155], v[160:163], v[12:15]
v_cvt_pk_bf16_f32 v96, v56, v57
v_mfma_f32_16x16x32_bf16 v[12:15], a[156:159], v[164:167], v[12:15]
v_exp_f32 v59, v59
v_mfma_f32_16x16x32_bf16 a[16:19], a[176:179], v[72:75], a[16:19]
s_add_u32 s42, s42, s43
v_cvt_pk_bf16_f32 v97, v58, v59
v_mfma_f32_16x16x32_bf16 a[48:51], a[176:179], v[76:79], a[48:51]
v_exp_f32 v60, v60
v_mfma_f32_16x16x32_bf16 a[80:83], a[176:179], v[80:83], a[80:83]
v_mfma_f32_16x16x32_bf16 a[112:115], a[176:179], v[84:87], a[112:115]
v_exp_f32 v61, v61
v_mfma_f32_16x16x32_bf16 v[20:23], a[144:147], v[168:171], v[140:143]
ds_read_b64_tr_b16 a[176:177], v224 offset:57344
ds_read_b64_tr_b16 a[178:179], v224 offset:61440
v_mfma_f32_16x16x32_bf16 v[20:23], a[148:151], v[172:175], v[20:23]
v_exp_f32 v62, v62
v_mfma_f32_16x16x32_bf16 v[20:23], a[152:155], v[176:179], v[20:23]
v_cvt_pk_bf16_f32 v98, v60, v61
v_mfma_f32_16x16x32_bf16 v[20:23], a[156:159], v[180:183], v[20:23]
v_exp_f32 v63, v63
v_mfma_f32_16x16x32_bf16 a[20:23], a[180:183], v[72:75], a[20:23]
v_cvt_pk_bf16_f32 v99, v62, v63
v_mfma_f32_16x16x32_bf16 a[52:55], a[180:183], v[76:79], a[52:55]
v_exp_f32 v64, v64
v_mfma_f32_16x16x32_bf16 a[84:87], a[180:183], v[80:83], a[84:87]
v_mfma_f32_16x16x32_bf16 a[116:119], a[180:183], v[84:87], a[116:119]
v_exp_f32 v65, v65
v_smfmac_f32_16x16x64_bf16 a[252:255], a[208:211], v[80:87], v235
ds_read_b64_tr_b16 a[180:181], v225 offset:57344
ds_read_b64_tr_b16 a[182:183], v225 offset:61440
v_mfma_f32_16x16x32_bf16 v[28:31], a[144:147], v[184:187], v[144:147]
v_exp_f32 v66, v66
v_mfma_f32_16x16x32_bf16 v[28:31], a[148:151], v[188:191], v[28:31]
v_cvt_pk_bf16_f32 v100, v64, v65
v_mfma_f32_16x16x32_bf16 v[28:31], a[152:155], v[192:195], v[28:31]
v_exp_f32 v67, v67
v_mfma_f32_16x16x32_bf16 v[28:31], a[156:159], v[196:199], v[28:31]
v_cvt_pk_bf16_f32 v101, v66, v67
v_mfma_f32_16x16x32_bf16 a[24:27], a[184:187], v[72:75], a[24:27]
v_exp_f32 v68, v68
v_mfma_f32_16x16x32_bf16 a[56:59], a[184:187], v[76:79], a[56:59]
v_mfma_f32_16x16x32_bf16 a[88:91], a[184:187], v[80:83], a[88:91]
v_exp_f32 v69, v69
v_mfma_f32_16x16x32_bf16 a[120:123], a[184:187], v[84:87], a[120:123]
ds_read_b64_tr_b16 a[184:185], v226 offset:57344
ds_read_b64_tr_b16 a[186:187], v226 offset:61440
v_mfma_f32_16x16x32_bf16 v[36:39], a[144:147], v[200:203], v[148:151]
v_exp_f32 v70, v70
v_mfma_f32_16x16x32_bf16 v[36:39], a[148:151], v[204:207], v[36:39]
ds_read_b128 a[144:147], v216 offset:12288
ds_read_b128 a[148:151], v217 offset:12288
v_mfma_f32_16x16x32_bf16 v[36:39], a[152:155], v[208:211], v[36:39]
v_exp_f32 v71, v71
v_mfma_f32_16x16x32_bf16 v[36:39], a[156:159], v[212:215], v[36:39]
ds_read_b128 a[152:155], v218 offset:12288
ds_read_b128 a[156:159], v219 offset:12288
v_mfma_f32_16x16x32_bf16 a[28:31], a[188:191], v[72:75], a[28:31]
s_add_u32 s40, s40, 1
v_cvt_pk_bf16_f32 v102, v68, v69
v_cvt_pk_bf16_f32 v103, v70, v71
v_mfma_f32_16x16x32_bf16 a[60:63], a[188:191], v[76:79], a[60:63]
s_cmp_eq_u32 s40, 8
v_mfma_f32_16x16x32_bf16 a[92:95], a[188:191], v[80:83], a[92:95]
v_mfma_f32_16x16x32_bf16 a[124:127], a[188:191], v[84:87], a[124:127]
s_waitcnt lgkmcnt(6)
ds_read_b64_tr_b16 a[188:189], v227 offset:57344
ds_read_b64_tr_b16 a[190:191], v227 offset:61440
s_cbranch_scc1 K_LAST
v_mfma_f32_16x16x32_bf16 v[40:43], a[128:131], v[152:155], v[136:139]
v_exp_f32 v8, v8
v_mfma_f32_16x16x32_bf16 v[40:43], a[132:135], v[156:159], v[40:43]
v_exp_f32 v9, v9
v_mfma_f32_16x16x32_bf16 v[40:43], a[136:139], v[160:163], v[40:43]
v_cvt_pk_bf16_f32 v72, v8, v9
v_mfma_f32_16x16x32_bf16 v[40:43], a[140:143], v[164:167], v[40:43]
v_exp_f32 v10, v10
v_mfma_f32_16x16x32_bf16 a[0:3], a[160:163], v[88:91], a[0:3]
v_mfma_f32_16x16x32_bf16 a[32:35], a[160:163], v[92:95], a[32:35]
v_exp_f32 v11, v11
s_waitcnt vmcnt(2) lgkmcnt(0)
s_barrier
s_cmp_ge_u32 s40, s74
s_cbranch_scc1 K_SIDE
K_SIDED:
v_mfma_f32_16x16x32_bf16 a[64:67], a[160:163], v[96:99], a[64:67]
v_cvt_pk_bf16_f32 v73, v10, v11
v_mfma_f32_16x16x32_bf16 a[96:99], a[160:163], v[100:103], a[96:99]
s_add_u32 m0, s37, 98304
v_exp_f32 v12, v12
v_mfma_f32_16x16x32_bf16 v[48:51], a[128:131], v[168:171], v[140:143]
buffer_load_dwordx4 v232, s[12:15], s39 offen offset:0 lds
v_mfma_f32_16x16x32_bf16 v[48:51], a[132:135], v[172:175], v[48:51]
v_exp_f32 v13, v13
v_mfma_f32_16x16x32_bf16 v[48:51], a[136:139], v[176:179], v[48:51]
ds_read_b64_tr_b16 a[160:161], v220 offset:0
ds_read_b64_tr_b16 a[162:163], v220 offset:4096
v_mfma_f32_16x16x32_bf16 v[48:51], a[140:143], v[180:183], v[48:51]
v_exp_f32 v14, v14
v_mfma_f32_16x16x32_bf16 a[4:7], a[164:167], v[88:91], a[4:7]
v_cvt_pk_bf16_f32 v74, v12, v13
v_mfma_f32_16x16x32_bf16 a[36:39], a[164:167], v[92:95], a[36:39]
v_exp_f32 v15, v15
v_mfma_f32_16x16x32_bf16 a[68:71], a[164:167], v[96:99], a[68:71]
v_cvt_pk_bf16_f32 v75, v14, v15
v_mfma_f32_16x16x32_bf16 a[100:103], a[164:167], v[100:103], a[100:103]
v_exp_f32 v16, v16
v_smfmac_f32_16x16x64_bf16 a[248:251], a[208:211], v[88:95], v235
buffer_load_dwordx4 v233, s[12:15], s39 offen offset:1024 lds
v_mfma_f32_16x16x32_bf16 v[56:59], a[128:131], v[184:187], v[144:147]
v_exp_f32 v17, v17
v_mfma_f32_16x16x32_bf16 v[56:59], a[132:135], v[188:191], v[56:59]
ds_read_b64_tr_b16 a[164:165], v221 offset:0
ds_read_b64_tr_b16 a[166:167], v221 offset:4096
v_mfma_f32_16x16x32_bf16 v[56:59], a[136:139], v[192:195], v[56:59]
v_exp_f32 v18, v18
v_mfma_f32_16x16x32_bf16 v[56:59], a[140:143], v[196:199], v[56:59]
v_cvt_pk_bf16_f32 v76, v16, v17
v_mfma_f32_16x16x32_bf16 a[8:11], a[168:171], v[88:91], a[8:11]
v_exp_f32 v19, v19
v_mfma_f32_16x16x32_bf16 a[40:43], a[168:171], v[92:95], a[40:43]
v_cvt_pk_bf16_f32 v77, v18, v19
v_mfma_f32_16x16x32_bf16 a[72:75], a[168:171], v[96:99], a[72:75]
v_exp_f32 v20, v20
v_mfma_f32_16x16x32_bf16 a[104:107], a[168:171], v[100:103], a[104:107]
ds_read_b64_tr_b16 a[168:169], v222 offset:0
ds_read_b64_tr_b16 a[170:171], v222 offset:4096
v_mfma_f32_16x16x32_bf16 v[64:67], a[128:131], v[200:203], v[148:151]
v_exp_f32 v21, v21
v_mfma_f32_16x16x32_bf16 v[64:67], a[132:135], v[204:207], v[64:67]
buffer_load_dwordx4 v232, s[12:15], s39 offen offset:2048 lds
v_mfma_f32_16x16x32_bf16 v[64:67], a[136:139], v[208:211], v[64:67]
v_exp_f32 v22, v22
v_mfma_f32_16x16x32_bf16 v[64:67], a[140:143], v[212:215], v[64:67]
ds_read_b128 a[128:131], v216 offset:49152
ds_read_b128 a[132:135], v217 offset:49152
v_mfma_f32_16x16x32_bf16 a[12:15], a[172:175], v[88:91], a[12:15]
v_exp_f32 v23, v23
v_mfma_f32_16x16x32_bf16 a[44:47], a[172:175], v[92:95], a[44:47]
ds_read_b128 a[136:139], v218 offset:49152
ds_read_b128 a[140:143], v219 offset:49152
v_mfma_f32_16x16x32_bf16 a[76:79], a[172:175], v[96:99], a[76:79]
v_exp_f32 v24, v24
v_mfma_f32_16x16x32_bf16 a[108:111], a[172:175], v[100:103], a[108:111]
v_exp_f32 v25, v25
v_mfma_f32_16x16x32_bf16 v[44:47], a[144:147], v[152:155], v[136:139]
ds_read_b64_tr_b16 a[172:173], v223 offset:0
ds_read_b64_tr_b16 a[174:175], v223 offset:4096
v_mfma_f32_16x16x32_bf16 v[44:47], a[148:151], v[156:159], v[44:47]
v_exp_f32 v26, v26
v_mfma_f32_16x16x32_bf16 v[44:47], a[152:155], v[160:163], v[44:47]
buffer_load_dwordx4 v233, s[12:15], s39 offen offset:3072 lds
v_mfma_f32_16x16x32_bf16 v[44:47], a[156:159], v[164:167], v[44:47]
v_exp_f32 v27, v27
v_mfma_f32_16x16x32_bf16 a[16:19], a[176:179], v[88:91], a[16:19]
v_cvt_pk_bf16_f32 v78, v20, v21
v_cvt_pk_bf16_f32 v79, v22, v23
v_mfma_f32_16x16x32_bf16 a[48:51], a[176:179], v[92:95], a[48:51]
v_exp_f32 v28, v28
v_mfma_f32_16x16x32_bf16 a[80:83], a[176:179], v[96:99], a[80:83]
v_cvt_pk_bf16_f32 v80, v24, v25
v_cvt_pk_bf16_f32 v81, v26, v27
v_mfma_f32_16x16x32_bf16 a[112:115], a[176:179], v[100:103], a[112:115]
v_exp_f32 v29, v29
v_mfma_f32_16x16x32_bf16 v[52:55], a[144:147], v[168:171], v[140:143]
ds_read_b64_tr_b16 a[176:177], v224 offset:0
ds_read_b64_tr_b16 a[178:179], v224 offset:4096
v_mfma_f32_16x16x32_bf16 v[52:55], a[148:151], v[172:175], v[52:55]
v_exp_f32 v30, v30
v_mfma_f32_16x16x32_bf16 v[52:55], a[152:155], v[176:179], v[52:55]
v_cvt_pk_bf16_f32 v82, v28, v29
v_mfma_f32_16x16x32_bf16 v[52:55], a[156:159], v[180:183], v[52:55]
s_add_u32 s39, s39, 16384
v_exp_f32 v31, v31
v_mfma_f32_16x16x32_bf16 a[20:23], a[180:183], v[88:91], a[20:23]
s_add_u32 m0, s37, 16384
v_cvt_pk_bf16_f32 v83, v30, v31
v_mfma_f32_16x16x32_bf16 a[52:55], a[180:183], v[92:95], a[52:55]
v_exp_f32 v32, v32
v_mfma_f32_16x16x32_bf16 a[84:87], a[180:183], v[96:99], a[84:87]
buffer_load_dwordx4 v228, s[8:11], s38 offen offset:0 lds
v_mfma_f32_16x16x32_bf16 a[116:119], a[180:183], v[100:103], a[116:119]
v_exp_f32 v33, v33
v_smfmac_f32_16x16x64_bf16 a[252:255], a[208:211], v[96:103], v235
ds_read_b64_tr_b16 a[180:181], v225 offset:0
ds_read_b64_tr_b16 a[182:183], v225 offset:4096
v_mfma_f32_16x16x32_bf16 v[60:63], a[144:147], v[184:187], v[144:147]
v_exp_f32 v34, v34
v_mfma_f32_16x16x32_bf16 v[60:63], a[148:151], v[188:191], v[60:63]
v_cvt_pk_bf16_f32 v84, v32, v33
v_mfma_f32_16x16x32_bf16 v[60:63], a[152:155], v[192:195], v[60:63]
v_exp_f32 v35, v35
v_mfma_f32_16x16x32_bf16 v[60:63], a[156:159], v[196:199], v[60:63]
buffer_load_dwordx4 v229, s[8:11], s38 offen offset:1024 lds
v_mfma_f32_16x16x32_bf16 a[24:27], a[184:187], v[88:91], a[24:27]
v_exp_f32 v36, v36
v_mfma_f32_16x16x32_bf16 a[56:59], a[184:187], v[92:95], a[56:59]
v_cvt_pk_bf16_f32 v85, v34, v35
v_mfma_f32_16x16x32_bf16 a[88:91], a[184:187], v[96:99], a[88:91]
v_exp_f32 v37, v37
v_mfma_f32_16x16x32_bf16 a[120:123], a[184:187], v[100:103], a[120:123]
ds_read_b64_tr_b16 a[184:185], v226 offset:0
ds_read_b64_tr_b16 a[186:187], v226 offset:4096
v_mfma_f32_16x16x32_bf16 v[68:71], a[144:147], v[200:203], v[148:151]
v_exp_f32 v38, v38
v_mfma_f32_16x16x32_bf16 v[68:71], a[148:151], v[204:207], v[68:71]
ds_read_b128 a[144:147], v216 offset:53248
ds_read_b128 a[148:151], v217 offset:53248
v_mfma_f32_16x16x32_bf16 v[68:71], a[152:155], v[208:211], v[68:71]
v_exp_f32 v39, v39
v_mfma_f32_16x16x32_bf16 v[68:71], a[156:159], v[212:215], v[68:71]
ds_read_b128 a[152:155], v218 offset:53248
ds_read_b128 a[156:159], v219 offset:53248
v_mfma_f32_16x16x32_bf16 a[28:31], a[188:191], v[88:91], a[28:31]
v_cvt_pk_bf16_f32 v86, v36, v37
v_cvt_pk_bf16_f32 v87, v38, v39
v_mfma_f32_16x16x32_bf16 a[60:63], a[188:191], v[92:95], a[60:63]
v_mfma_f32_16x16x32_bf16 a[92:95], a[188:191], v[96:99], a[92:95]
v_mfma_f32_16x16x32_bf16 a[124:127], a[188:191], v[100:103], a[124:127]
s_waitcnt lgkmcnt(6)
ds_read_b64_tr_b16 a[188:189], v227 offset:0
ds_read_b64_tr_b16 a[190:191], v227 offset:4096
v_mfma_f32_16x16x32_bf16 v[8:11], a[128:131], v[152:155], v[136:139]
v_exp_f32 v40, v40
v_mfma_f32_16x16x32_bf16 v[8:11], a[132:135], v[156:159], v[8:11]
v_exp_f32 v41, v41
v_mfma_f32_16x16x32_bf16 v[8:11], a[136:139], v[160:163], v[8:11]
buffer_load_dwordx4 v230, s[8:11], s38 offen offset:2048 lds
v_mfma_f32_16x16x32_bf16 v[8:11], a[140:143], v[164:167], v[8:11]
v_exp_f32 v42, v42
v_mfma_f32_16x16x32_bf16 a[0:3], a[160:163], v[72:75], a[0:3]
v_cvt_pk_bf16_f32 v88, v40, v41
v_mfma_f32_16x16x32_bf16 a[32:35], a[160:163], v[76:79], a[32:35]
v_exp_f32 v43, v43
v_mfma_f32_16x16x32_bf16 a[64:67], a[160:163], v[80:83], a[64:67]
v_cvt_pk_bf16_f32 v89, v42, v43
v_mfma_f32_16x16x32_bf16 a[96:99], a[160:163], v[84:87], a[96:99]
v_exp_f32 v44, v44
v_mfma_f32_16x16x32_bf16 v[16:19], a[128:131], v[168:171], v[140:143]
ds_read_b64_tr_b16 a[160:161], v220 offset:8192
ds_read_b64_tr_b16 a[162:163], v220 offset:12288
v_mfma_f32_16x16x32_bf16 v[16:19], a[132:135], v[172:175], v[16:19]
v_exp_f32 v45, v45
v_mfma_f32_16x16x32_bf16 v[16:19], a[136:139], v[176:179], v[16:19]
v_cvt_pk_bf16_f32 v90, v44, v45
v_mfma_f32_16x16x32_bf16 v[16:19], a[140:143], v[180:183], v[16:19]
v_exp_f32 v46, v46
v_mfma_f32_16x16x32_bf16 a[4:7], a[164:167], v[72:75], a[4:7]
v_mfma_f32_16x16x32_bf16 a[36:39], a[164:167], v[76:79], a[36:39]
v_exp_f32 v47, v47
v_mfma_f32_16x16x32_bf16 a[68:71], a[164:167], v[80:83], a[68:71]
buffer_load_dwordx4 v231, s[8:11], s38 offen offset:3072 lds
v_mfma_f32_16x16x32_bf16 a[100:103], a[164:167], v[84:87], a[100:103]
v_exp_f32 v48, v48
v_smfmac_f32_16x16x64_bf16 a[248:251], a[208:211], v[72:79], v235
ds_read_b64_tr_b16 a[164:165], v221 offset:8192
ds_read_b64_tr_b16 a[166:167], v221 offset:12288
v_mfma_f32_16x16x32_bf16 v[24:27], a[128:131], v[184:187], v[144:147]
v_exp_f32 v49, v49
v_mfma_f32_16x16x32_bf16 v[24:27], a[132:135], v[188:191], v[24:27]
v_cvt_pk_bf16_f32 v91, v46, v47
v_cvt_pk_bf16_f32 v92, v48, v49
v_mfma_f32_16x16x32_bf16 v[24:27], a[136:139], v[192:195], v[24:27]
v_exp_f32 v50, v50
v_mfma_f32_16x16x32_bf16 v[24:27], a[140:143], v[196:199], v[24:27]
v_mfma_f32_16x16x32_bf16 a[8:11], a[168:171], v[72:75], a[8:11]
v_exp_f32 v51, v51
v_mfma_f32_16x16x32_bf16 a[40:43], a[168:171], v[76:79], a[40:43]
v_cvt_pk_bf16_f32 v93, v50, v51
v_mfma_f32_16x16x32_bf16 a[72:75], a[168:171], v[80:83], a[72:75]
v_exp_f32 v52, v52
v_mfma_f32_16x16x32_bf16 a[104:107], a[168:171], v[84:87], a[104:107]
ds_read_b64_tr_b16 a[168:169], v222 offset:8192
ds_read_b64_tr_b16 a[170:171], v222 offset:12288
v_mfma_f32_16x16x32_bf16 v[32:35], a[128:131], v[200:203], v[148:151]
s_add_u32 s38, s38, 16384
v_exp_f32 v53, v53
v_mfma_f32_16x16x32_bf16 v[32:35], a[132:135], v[204:207], v[32:35]
s_add_u32 m0, s37, 114688
ds_read_b128 a[128:131], v216 offset:57344
ds_read_b128 a[132:135], v217 offset:57344
v_mfma_f32_16x16x32_bf16 v[32:35], a[136:139], v[208:211], v[32:35]
v_exp_f32 v54, v54
v_mfma_f32_16x16x32_bf16 v[32:35], a[140:143], v[212:215], v[32:35]
buffer_load_dwordx4 v232, s[12:15], s39 offen offset:0 lds
v_mfma_f32_16x16x32_bf16 a[12:15], a[172:175], v[72:75], a[12:15]
v_exp_f32 v55, v55
v_mfma_f32_16x16x32_bf16 a[44:47], a[172:175], v[76:79], a[44:47]
ds_read_b128 a[136:139], v218 offset:57344
ds_read_b128 a[140:143], v219 offset:57344
v_mfma_f32_16x16x32_bf16 a[76:79], a[172:175], v[80:83], a[76:79]
v_exp_f32 v56, v56
v_mfma_f32_16x16x32_bf16 a[108:111], a[172:175], v[84:87], a[108:111]
s_waitcnt lgkmcnt(6)
v_exp_f32 v57, v57
v_mfma_f32_16x16x32_bf16 v[12:15], a[144:147], v[152:155], v[136:139]
ds_read_b64_tr_b16 a[172:173], v223 offset:8192
ds_read_b64_tr_b16 a[174:175], v223 offset:12288
v_mfma_f32_16x16x32_bf16 v[12:15], a[148:151], v[156:159], v[12:15]
v_exp_f32 v58, v58
v_mfma_f32_16x16x32_bf16 v[12:15], a[152:155], v[160:163], v[12:15]
v_cvt_pk_bf16_f32 v94, v52, v53
v_cvt_pk_bf16_f32 v95, v54, v55
v_mfma_f32_16x16x32_bf16 v[12:15], a[156:159], v[164:167], v[12:15]
v_exp_f32 v59, v59
v_mfma_f32_16x16x32_bf16 a[16:19], a[176:179], v[72:75], a[16:19]
v_cvt_pk_bf16_f32 v96, v56, v57
v_cvt_pk_bf16_f32 v97, v58, v59
v_mfma_f32_16x16x32_bf16 a[48:51], a[176:179], v[76:79], a[48:51]
v_exp_f32 v60, v60
v_mfma_f32_16x16x32_bf16 a[80:83], a[176:179], v[80:83], a[80:83]
buffer_load_dwordx4 v233, s[12:15], s39 offen offset:1024 lds
v_mfma_f32_16x16x32_bf16 a[112:115], a[176:179], v[84:87], a[112:115]
v_exp_f32 v61, v61
v_mfma_f32_16x16x32_bf16 v[20:23], a[144:147], v[168:171], v[140:143]
ds_read_b64_tr_b16 a[176:177], v224 offset:8192
ds_read_b64_tr_b16 a[178:179], v224 offset:12288
v_mfma_f32_16x16x32_bf16 v[20:23], a[148:151], v[172:175], v[20:23]
v_exp_f32 v62, v62
v_mfma_f32_16x16x32_bf16 v[20:23], a[152:155], v[176:179], v[20:23]
v_cvt_pk_bf16_f32 v98, v60, v61
v_mfma_f32_16x16x32_bf16 v[20:23], a[156:159], v[180:183], v[20:23]
v_exp_f32 v63, v63
v_mfma_f32_16x16x32_bf16 a[20:23], a[180:183], v[72:75], a[20:23]
v_cvt_pk_bf16_f32 v99, v62, v63
v_mfma_f32_16x16x32_bf16 a[52:55], a[180:183], v[76:79], a[52:55]
v_exp_f32 v64, v64
v_mfma_f32_16x16x32_bf16 a[84:87], a[180:183], v[80:83], a[84:87]
v_mfma_f32_16x16x32_bf16 a[116:119], a[180:183], v[84:87], a[116:119]
v_exp_f32 v65, v65
v_smfmac_f32_16x16x64_bf16 a[252:255], a[208:211], v[80:87], v235
ds_read_b64_tr_b16 a[180:181], v225 offset:8192
ds_read_b64_tr_b16 a[182:183], v225 offset:12288
v_mfma_f32_16x16x32_bf16 v[28:31], a[144:147], v[184:187], v[144:147]
v_exp_f32 v66, v66
v_mfma_f32_16x16x32_bf16 v[28:31], a[148:151], v[188:191], v[28:31]
buffer_load_dwordx4 v232, s[12:15], s39 offen offset:2048 lds
v_mfma_f32_16x16x32_bf16 v[28:31], a[152:155], v[192:195], v[28:31]
v_exp_f32 v67, v67
v_mfma_f32_16x16x32_bf16 v[28:31], a[156:159], v[196:199], v[28:31]
v_cvt_pk_bf16_f32 v100, v64, v65
v_cvt_pk_bf16_f32 v101, v66, v67
v_mfma_f32_16x16x32_bf16 a[24:27], a[184:187], v[72:75], a[24:27]
v_exp_f32 v68, v68
v_mfma_f32_16x16x32_bf16 a[56:59], a[184:187], v[76:79], a[56:59]
v_mfma_f32_16x16x32_bf16 a[88:91], a[184:187], v[80:83], a[88:91]
v_exp_f32 v69, v69
v_mfma_f32_16x16x32_bf16 a[120:123], a[184:187], v[84:87], a[120:123]
ds_read_b64_tr_b16 a[184:185], v226 offset:8192
ds_read_b64_tr_b16 a[186:187], v226 offset:12288
v_mfma_f32_16x16x32_bf16 v[36:39], a[144:147], v[200:203], v[148:151]
v_exp_f32 v70, v70
v_mfma_f32_16x16x32_bf16 v[36:39], a[148:151], v[204:207], v[36:39]
ds_read_b128 a[144:147], v216 offset:61440
ds_read_b128 a[148:151], v217 offset:61440
v_mfma_f32_16x16x32_bf16 v[36:39], a[152:155], v[208:211], v[36:39]
v_exp_f32 v71, v71
v_mfma_f32_16x16x32_bf16 v[36:39], a[156:159], v[212:215], v[36:39]
ds_read_b128 a[152:155], v218 offset:61440
ds_read_b128 a[156:159], v219 offset:61440
v_mfma_f32_16x16x32_bf16 a[28:31], a[188:191], v[72:75], a[28:31]
v_cvt_pk_bf16_f32 v102, v68, v69
v_cvt_pk_bf16_f32 v103, v70, v71
v_mfma_f32_16x16x32_bf16 a[60:63], a[188:191], v[76:79], a[60:63]
v_mfma_f32_16x16x32_bf16 a[92:95], a[188:191], v[80:83], a[92:95]
v_mfma_f32_16x16x32_bf16 a[124:127], a[188:191], v[84:87], a[124:127]
s_waitcnt lgkmcnt(6)
ds_read_b64_tr_b16 a[188:189], v227 offset:8192
ds_read_b64_tr_b16 a[190:191], v227 offset:12288
v_mfma_f32_16x16x32_bf16 v[40:43], a[128:131], v[152:155], v[136:139]
v_exp_f32 v8, v8
v_mfma_f32_16x16x32_bf16 v[40:43], a[132:135], v[156:159], v[40:43]
v_exp_f32 v9, v9
v_mfma_f32_16x16x32_bf16 v[40:43], a[136:139], v[160:163], v[40:43]
buffer_load_dwordx4 v233, s[12:15], s39 offen offset:3072 lds
v_mfma_f32_16x16x32_bf16 v[40:43], a[140:143], v[164:167], v[40:43]
v_exp_f32 v10, v10
v_mfma_f32_16x16x32_bf16 a[0:3], a[160:163], v[88:91], a[0:3]
v_cvt_pk_bf16_f32 v72, v8, v9
v_mfma_f32_16x16x32_bf16 a[32:35], a[160:163], v[92:95], a[32:35]
v_exp_f32 v11, v11
v_mfma_f32_16x16x32_bf16 a[64:67], a[160:163], v[96:99], a[64:67]
v_cvt_pk_bf16_f32 v73, v10, v11
v_mfma_f32_16x16x32_bf16 a[96:99], a[160:163], v[100:103], a[96:99]
v_exp_f32 v12, v12
v_mfma_f32_16x16x32_bf16 v[48:51], a[128:131], v[168:171], v[140:143]
ds_read_b64_tr_b16 a[160:161], v220 offset:16384
ds_read_b64_tr_b16 a[162:163], v220 offset:20480
v_mfma_f32_16x16x32_bf16 v[48:51], a[132:135], v[172:175], v[48:51]
v_exp_f32 v13, v13
v_mfma_f32_16x16x32_bf16 v[48:51], a[136:139], v[176:179], v[48:51]
v_cvt_pk_bf16_f32 v74, v12, v13
v_mfma_f32_16x16x32_bf16 v[48:51], a[140:143], v[180:183], v[48:51]
v_exp_f32 v14, v14
v_mfma_f32_16x16x32_bf16 a[4:7], a[164:167], v[88:91], a[4:7]
v_mfma_f32_16x16x32_bf16 a[36:39], a[164:167], v[92:95], a[36:39]
s_add_u32 s39, s39, 16384
v_exp_f32 v15, v15
v_mfma_f32_16x16x32_bf16 a[68:71], a[164:167], v[96:99], a[68:71]
s_add_u32 m0, s37, 0
v_cvt_pk_bf16_f32 v75, v14, v15
v_mfma_f32_16x16x32_bf16 a[100:103], a[164:167], v[100:103], a[100:103]
v_exp_f32 v16, v16
v_smfmac_f32_16x16x64_bf16 a[248:251], a[208:211], v[88:95], v235
buffer_load_dwordx4 v228, s[8:11], s38 offen offset:0 lds
v_mfma_f32_16x16x32_bf16 v[56:59], a[128:131], v[184:187], v[144:147]
v_exp_f32 v17, v17
v_mfma_f32_16x16x32_bf16 v[56:59], a[132:135], v[188:191], v[56:59]
ds_read_b64_tr_b16 a[164:165], v221 offset:16384
ds_read_b64_tr_b16 a[166:167], v221 offset:20480
v_mfma_f32_16x16x32_bf16 v[56:59], a[136:139], v[192:195], v[56:59]
v_exp_f32 v18, v18
v_mfma_f32_16x16x32_bf16 v[56:59], a[140:143], v[196:199], v[56:59]
v_cvt_pk_bf16_f32 v76, v16, v17
v_mfma_f32_16x16x32_bf16 a[8:11], a[168:171], v[88:91], a[8:11]
v_exp_f32 v19, v19
v_mfma_f32_16x16x32_bf16 a[40:43], a[168:171], v[92:95], a[40:43]
v_cvt_pk_bf16_f32 v77, v18, v19
v_mfma_f32_16x16x32_bf16 a[72:75], a[168:171], v[96:99], a[72:75]
v_exp_f32 v20, v20
v_mfma_f32_16x16x32_bf16 a[104:107], a[168:171], v[100:103], a[104:107]
ds_read_b64_tr_b16 a[168:169], v222 offset:16384
ds_read_b64_tr_b16 a[170:171], v222 offset:20480
v_mfma_f32_16x16x32_bf16 v[64:67], a[128:131], v[200:203], v[148:151]
v_exp_f32 v21, v21
v_mfma_f32_16x16x32_bf16 v[64:67], a[132:135], v[204:207], v[64:67]
buffer_load_dwordx4 v229, s[8:11], s38 offen offset:1024 lds
v_mfma_f32_16x16x32_bf16 v[64:67], a[136:139], v[208:211], v[64:67]
v_exp_f32 v22, v22
v_mfma_f32_16x16x32_bf16 v[64:67], a[140:143], v[212:215], v[64:67]
ds_read_b128 a[128:131], v216 offset:32768
ds_read_b128 a[132:135], v217 offset:32768
v_mfma_f32_16x16x32_bf16 a[12:15], a[172:175], v[88:91], a[12:15]
v_exp_f32 v23, v23
v_mfma_f32_16x16x32_bf16 a[44:47], a[172:175], v[92:95], a[44:47]
ds_read_b128 a[136:139], v218 offset:32768
ds_read_b128 a[140:143], v219 offset:32768
v_mfma_f32_16x16x32_bf16 a[76:79], a[172:175], v[96:99], a[76:79]
v_exp_f32 v24, v24
v_mfma_f32_16x16x32_bf16 a[108:111], a[172:175], v[100:103], a[108:111]
s_waitcnt lgkmcnt(6)
v_exp_f32 v25, v25
v_mfma_f32_16x16x32_bf16 v[44:47], a[144:147], v[152:155], v[136:139]
ds_read_b64_tr_b16 a[172:173], v223 offset:16384
ds_read_b64_tr_b16 a[174:175], v223 offset:20480
v_mfma_f32_16x16x32_bf16 v[44:47], a[148:151], v[156:159], v[44:47]
v_exp_f32 v26, v26
v_mfma_f32_16x16x32_bf16 v[44:47], a[152:155], v[160:163], v[44:47]
v_cvt_pk_bf16_f32 v78, v20, v21
v_cvt_pk_bf16_f32 v79, v22, v23
v_mfma_f32_16x16x32_bf16 v[44:47], a[156:159], v[164:167], v[44:47]
v_exp_f32 v27, v27
v_mfma_f32_16x16x32_bf16 a[16:19], a[176:179], v[88:91], a[16:19]
v_cvt_pk_bf16_f32 v80, v24, v25
v_cvt_pk_bf16_f32 v81, v26, v27
v_mfma_f32_16x16x32_bf16 a[48:51], a[176:179], v[92:95], a[48:51]
v_exp_f32 v28, v28
v_mfma_f32_16x16x32_bf16 a[80:83], a[176:179], v[96:99], a[80:83]
buffer_load_dwordx4 v230, s[8:11], s38 offen offset:2048 lds
v_mfma_f32_16x16x32_bf16 a[112:115], a[176:179], v[100:103], a[112:115]
v_exp_f32 v29, v29
v_mfma_f32_16x16x32_bf16 v[52:55], a[144:147], v[168:171], v[140:143]
ds_read_b64_tr_b16 a[176:177], v224 offset:16384
ds_read_b64_tr_b16 a[178:179], v224 offset:20480
v_mfma_f32_16x16x32_bf16 v[52:55], a[148:151], v[172:175], v[52:55]
v_exp_f32 v30, v30
v_mfma_f32_16x16x32_bf16 v[52:55], a[152:155], v[176:179], v[52:55]
v_cvt_pk_bf16_f32 v82, v28, v29
v_mfma_f32_16x16x32_bf16 v[52:55], a[156:159], v[180:183], v[52:55]
v_exp_f32 v31, v31
v_mfma_f32_16x16x32_bf16 a[20:23], a[180:183], v[88:91], a[20:23]
v_cvt_pk_bf16_f32 v83, v30, v31
v_mfma_f32_16x16x32_bf16 a[52:55], a[180:183], v[92:95], a[52:55]
v_exp_f32 v32, v32
v_mfma_f32_16x16x32_bf16 a[84:87], a[180:183], v[96:99], a[84:87]
v_mfma_f32_16x16x32_bf16 a[116:119], a[180:183], v[100:103], a[116:119]
v_exp_f32 v33, v33
v_smfmac_f32_16x16x64_bf16 a[252:255], a[208:211], v[96:103], v235
ds_read_b64_tr_b16 a[180:181], v225 offset:16384
ds_read_b64_tr_b16 a[182:183], v225 offset:20480
v_mfma_f32_16x16x32_bf16 v[60:63], a[144:147], v[184:187], v[144:147]
v_exp_f32 v34, v34
v_mfma_f32_16x16x32_bf16 v[60:63], a[148:151], v[188:191], v[60:63]
buffer_load_dwordx4 v231, s[8:11], s38 offen offset:3072 lds
v_mfma_f32_16x16x32_bf16 v[60:63], a[152:155], v[192:195], v[60:63]
v_exp_f32 v35, v35
v_mfma_f32_16x16x32_bf16 v[60:63], a[156:159], v[196:199], v[60:63]
v_cvt_pk_bf16_f32 v84, v32, v33
v_cvt_pk_bf16_f32 v85, v34, v35
v_mfma_f32_16x16x32_bf16 a[24:27], a[184:187], v[88:91], a[24:27]
v_exp_f32 v36, v36
v_mfma_f32_16x16x32_bf16 a[56:59], a[184:187], v[92:95], a[56:59]
v_mfma_f32_16x16x32_bf16 a[88:91], a[184:187], v[96:99], a[88:91]
v_exp_f32 v37, v37
v_mfma_f32_16x16x32_bf16 a[120:123], a[184:187], v[100:103], a[120:123]
ds_read_b64_tr_b16 a[184:185], v226 offset:16384
ds_read_b64_tr_b16 a[186:187], v226 offset:20480
v_mfma_f32_16x16x32_bf16 v[68:71], a[144:147], v[200:203], v[148:151]
v_exp_f32 v38, v38
v_mfma_f32_16x16x32_bf16 v[68:71], a[148:151], v[204:207], v[68:71]
ds_read_b128 a[144:147], v216 offset:36864
ds_read_b128 a[148:151], v217 offset:36864
v_mfma_f32_16x16x32_bf16 v[68:71], a[152:155], v[208:211], v[68:71]
v_exp_f32 v39, v39
v_mfma_f32_16x16x32_bf16 v[68:71], a[156:159], v[212:215], v[68:71]
ds_read_b128 a[152:155], v218 offset:36864
ds_read_b128 a[156:159], v219 offset:36864
v_mfma_f32_16x16x32_bf16 a[28:31], a[188:191], v[88:91], a[28:31]
v_cvt_pk_bf16_f32 v86, v36, v37
v_cvt_pk_bf16_f32 v87, v38, v39
v_mfma_f32_16x16x32_bf16 a[60:63], a[188:191], v[92:95], a[60:63]
s_add_u32 s38, s38, 16384
v_mfma_f32_16x16x32_bf16 a[92:95], a[188:191], v[96:99], a[92:95]
v_mfma_f32_16x16x32_bf16 a[124:127], a[188:191], v[100:103], a[124:127]
s_waitcnt lgkmcnt(6)
ds_read_b64_tr_b16 a[188:189], v227 offset:16384
ds_read_b64_tr_b16 a[190:191], v227 offset:20480
v_mfma_f32_16x16x32_bf16 v[8:11], a[128:131], v[152:155], v[136:139]
v_exp_f32 v40, v40
v_mfma_f32_16x16x32_bf16 v[8:11], a[132:135], v[156:159], v[8:11]
s_mov_b32 m0, s44
v_exp_f32 v41, v41
v_mfma_f32_16x16x32_bf16 v[8:11], a[136:139], v[160:163], v[8:11]
buffer_load_dwordx4 v238, s[60:63], s45 offen lds
v_mfma_f32_16x16x32_bf16 v[8:11], a[140:143], v[164:167], v[8:11]
v_exp_f32 v42, v42
v_mfma_f32_16x16x32_bf16 a[0:3], a[160:163], v[72:75], a[0:3]
v_cvt_pk_bf16_f32 v88, v40, v41
v_mfma_f32_16x16x32_bf16 a[32:35], a[160:163], v[76:79], a[32:35]
v_exp_f32 v43, v43
v_mfma_f32_16x16x32_bf16 a[64:67], a[160:163], v[80:83], a[64:67]
v_cvt_pk_bf16_f32 v89, v42, v43
v_mfma_f32_16x16x32_bf16 a[96:99], a[160:163], v[84:87], a[96:99]
v_exp_f32 v44, v44
v_mfma_f32_16x16x32_bf16 v[16:19], a[128:131], v[168:171], v[140:143]
ds_read_b64_tr_b16 a[160:161], v220 offset:24576
ds_read_b64_tr_b16 a[162:163], v220 offset:28672
v_mfma_f32_16x16x32_bf16 v[16:19], a[132:135], v[172:175], v[16:19]
v_exp_f32 v45, v45
v_mfma_f32_16x16x32_bf16 v[16:19], a[136:139], v[176:179], v[16:19]
v_cvt_pk_bf16_f32 v90, v44, v45
v_mfma_f32_16x16x32_bf16 v[16:19], a[140:143], v[180:183], v[16:19]
v_exp_f32 v46, v46
v_mfma_f32_16x16x32_bf16 a[4:7], a[164:167], v[72:75], a[4:7]
v_mfma_f32_16x16x32_bf16 a[36:39], a[164:167], v[76:79], a[36:39]
v_exp_f32 v47, v47
v_mfma_f32_16x16x32_bf16 a[68:71], a[164:167], v[80:83], a[68:71]
v_cvt_pk_bf16_f32 v91, v46, v47
v_mfma_f32_16x16x32_bf16 a[100:103], a[164:167], v[84:87], a[100:103]
v_exp_f32 v48, v48
v_smfmac_f32_16x16x64_bf16 a[248:251], a[208:211], v[72:79], v235
ds_read_b64_tr_b16 a[164:165], v221 offset:24576
ds_read_b64_tr_b16 a[166:167], v221 offset:28672
v_mfma_f32_16x16x32_bf16 v[24:27], a[128:131], v[184:187], v[144:147]
v_exp_f32 v49, v49
v_mfma_f32_16x16x32_bf16 v[24:27], a[132:135], v[188:191], v[24:27]
v_cvt_pk_bf16_f32 v92, v48, v49
v_mfma_f32_16x16x32_bf16 v[24:27], a[136:139], v[192:195], v[24:27]
s_add_u32 s45, s45, 589824
v_exp_f32 v50, v50
v_mfma_f32_16x16x32_bf16 v[24:27], a[140:143], v[196:199], v[24:27]
s_add_u32 s44, s44, 4096
buffer_load_dword v252, v253, s[76:79], s42 offen
v_mfma_f32_16x16x32_bf16 a[8:11], a[168:171], v[72:75], a[8:11]
v_exp_f32 v51, v51
v_mfma_f32_16x16x32_bf16 a[40:43], a[168:171], v[76:79], a[40:43]
v_cvt_pk_bf16_f32 v93, v50, v51
v_mfma_f32_16x16x32_bf16 a[72:75], a[168:171], v[80:83], a[72:75]
v_exp_f32 v52, v52
v_mfma_f32_16x16x32_bf16 a[104:107], a[168:171], v[84:87], a[104:107]
ds_read_b64_tr_b16 a[168:169], v222 offset:24576
ds_read_b64_tr_b16 a[170:171], v222 offset:28672
v_mfma_f32_16x16x32_bf16 v[32:35], a[128:131], v[200:203], v[148:151]
v_exp_f32 v53, v53
v_mfma_f32_16x16x32_bf16 v[32:35], a[132:135], v[204:207], v[32:35]
ds_read_b128 a[128:131], v216 offset:40960
ds_read_b128 a[132:135], v217 offset:40960
v_mfma_f32_16x16x32_bf16 v[32:35], a[136:139], v[208:211], v[32:35]
v_exp_f32 v54, v54
v_mfma_f32_16x16x32_bf16 v[32:35], a[140:143], v[212:215], v[32:35]
ds_read_b128 a[136:139], v218 offset:40960
ds_read_b128 a[140:143], v219 offset:40960
v_mfma_f32_16x16x32_bf16 a[12:15], a[172:175], v[72:75], a[12:15]
v_exp_f32 v55, v55
v_mfma_f32_16x16x32_bf16 a[44:47], a[172:175], v[76:79], a[44:47]
v_cvt_pk_bf16_f32 v94, v52, v53
v_cvt_pk_bf16_f32 v95, v54, v55
v_mfma_f32_16x16x32_bf16 a[76:79], a[172:175], v[80:83], a[76:79]
v_exp_f32 v56, v56
v_mfma_f32_16x16x32_bf16 a[108:111], a[172:175], v[84:87], a[108:111]
s_waitcnt lgkmcnt(6)
v_exp_f32 v57, v57
v_mfma_f32_16x16x32_bf16 v[12:15], a[144:147], v[152:155], v[136:139]
ds_read_b64_tr_b16 a[172:173], v223 offset:24576
ds_read_b64_tr_b16 a[174:175], v223 offset:28672
v_mfma_f32_16x16x32_bf16 v[12:15], a[148:151], v[156:159], v[12:15]
v_exp_f32 v58, v58
v_mfma_f32_16x16x32_bf16 v[12:15], a[152:155], v[160:163], v[12:15]
v_cvt_pk_bf16_f32 v96, v56, v57
v_mfma_f32_16x16x32_bf16 v[12:15], a[156:159], v[164:167], v[12:15]
v_exp_f32 v59, v59
v_mfma_f32_16x16x32_bf16 a[16:19], a[176:179], v[72:75], a[16:19]
s_add_u32 s42, s42, s43
v_cvt_pk_bf16_f32 v97, v58, v59
v_mfma_f32_16x16x32_bf16 a[48:51], a[176:179], v[76:79], a[48:51]
v_exp_f32 v60, v60
v_mfma_f32_16x16x32_bf16 a[80:83], a[176:179], v[80:83], a[80:83]
v_mfma_f32_16x16x32_bf16 a[112:115], a[176:179], v[84:87], a[112:115]
v_exp_f32 v61, v61
v_mfma_f32_16x16x32_bf16 v[20:23], a[144:147], v[168:171], v[140:143]
ds_read_b64_tr_b16 a[176:177], v224 offset:24576
ds_read_b64_tr_b16 a[178:179], v224 offset:28672
v_mfma_f32_16x16x32_bf16 v[20:23], a[148:151], v[172:175], v[20:23]
v_exp_f32 v62, v62
v_mfma_f32_16x16x32_bf16 v[20:23], a[152:155], v[176:179], v[20:23]
v_cvt_pk_bf16_f32 v98, v60, v61
v_mfma_f32_16x16x32_bf16 v[20:23], a[156:159], v[180:183], v[20:23]
v_exp_f32 v63, v63
v_mfma_f32_16x16x32_bf16 a[20:23], a[180:183], v[72:75], a[20:23]
v_cvt_pk_bf16_f32 v99, v62, v63
v_mfma_f32_16x16x32_bf16 a[52:55], a[180:183], v[76:79], a[52:55]
v_exp_f32 v64, v64
v_mfma_f32_16x16x32_bf16 a[84:87], a[180:183], v[80:83], a[84:87]
v_mfma_f32_16x16x32_bf16 a[116:119], a[180:183], v[84:87], a[116:119]
v_exp_f32 v65, v65
v_smfmac_f32_16x16x64_bf16 a[252:255], a[208:211], v[80:87], v235
ds_read_b64_tr_b16 a[180:181], v225 offset:24576
ds_read_b64_tr_b16 a[182:183], v225 offset:28672
v_mfma_f32_16x16x32_bf16 v[28:31], a[144:147], v[184:187], v[144:147]
v_exp_f32 v66, v66
v_mfma_f32_16x16x32_bf16 v[28:31], a[148:151], v[188:191], v[28:31]
v_cvt_pk_bf16_f32 v100, v64, v65
v_mfma_f32_16x16x32_bf16 v[28:31], a[152:155], v[192:195], v[28:31]
v_exp_f32 v67, v67
v_mfma_f32_16x16x32_bf16 v[28:31], a[156:159], v[196:199], v[28:31]
v_cvt_pk_bf16_f32 v101, v66, v67
v_mfma_f32_16x16x32_bf16 a[24:27], a[184:187], v[72:75], a[24:27]
v_exp_f32 v68, v68
v_mfma_f32_16x16x32_bf16 a[56:59], a[184:187], v[76:79], a[56:59]
v_mfma_f32_16x16x32_bf16 a[88:91], a[184:187], v[80:83], a[88:91]
v_exp_f32 v69, v69
v_mfma_f32_16x16x32_bf16 a[120:123], a[184:187], v[84:87], a[120:123]
ds_read_b64_tr_b16 a[184:185], v226 offset:24576
ds_read_b64_tr_b16 a[186:187], v226 offset:28672
v_mfma_f32_16x16x32_bf16 v[36:39], a[144:147], v[200:203], v[148:151]
v_exp_f32 v70, v70
v_mfma_f32_16x16x32_bf16 v[36:39], a[148:151], v[204:207], v[36:39]
ds_read_b128 a[144:147], v216 offset:45056
ds_read_b128 a[148:151], v217 offset:45056
v_mfma_f32_16x16x32_bf16 v[36:39], a[152:155], v[208:211], v[36:39]
v_exp_f32 v71, v71
v_mfma_f32_16x16x32_bf16 v[36:39], a[156:159], v[212:215], v[36:39]
ds_read_b128 a[152:155], v218 offset:45056
ds_read_b128 a[156:159], v219 offset:45056
v_mfma_f32_16x16x32_bf16 a[28:31], a[188:191], v[72:75], a[28:31]
v_cvt_pk_bf16_f32 v102, v68, v69
v_cvt_pk_bf16_f32 v103, v70, v71
v_mfma_f32_16x16x32_bf16 a[60:63], a[188:191], v[76:79], a[60:63]
v_mfma_f32_16x16x32_bf16 a[92:95], a[188:191], v[80:83], a[92:95]
v_mfma_f32_16x16x32_bf16 a[124:127], a[188:191], v[84:87], a[124:127]
s_waitcnt lgkmcnt(6)
ds_read_b64_tr_b16 a[188:189], v227 offset:24576
ds_read_b64_tr_b16 a[190:191], v227 offset:28672
v_mfma_f32_16x16x32_bf16 v[40:43], a[128:131], v[152:155], v[136:139]
v_exp_f32 v8, v8
v_mfma_f32_16x16x32_bf16 v[40:43], a[132:135], v[156:159], v[40:43]
v_exp_f32 v9, v9
v_mfma_f32_16x16x32_bf16 v[40:43], a[136:139], v[160:163], v[40:43]
v_cvt_pk_bf16_f32 v72, v8, v9
v_mfma_f32_16x16x32_bf16 v[40:43], a[140:143], v[164:167], v[40:43]
v_exp_f32 v10, v10
v_mfma_f32_16x16x32_bf16 a[0:3], a[160:163], v[88:91], a[0:3]
v_mfma_f32_16x16x32_bf16 a[32:35], a[160:163], v[92:95], a[32:35]
v_exp_f32 v11, v11
s_waitcnt vmcnt(2) lgkmcnt(0)
s_barrier
v_mfma_f32_16x16x32_bf16 a[64:67], a[160:163], v[96:99], a[64:67]
v_cvt_pk_bf16_f32 v73, v10, v11
v_mfma_f32_16x16x32_bf16 a[96:99], a[160:163], v[100:103], a[96:99]
s_add_u32 m0, s37, 65536
v_exp_f32 v12, v12
v_mfma_f32_16x16x32_bf16 v[48:51], a[128:131], v[168:171], v[140:143]
buffer_load_dwordx4 v232, s[12:15], s39 offen offset:0 lds
v_mfma_f32_16x16x32_bf16 v[48:51], a[132:135], v[172:175], v[48:51]
v_exp_f32 v13, v13
v_mfma_f32_16x16x32_bf16 v[48:51], a[136:139], v[176:179], v[48:51]
ds_read_b64_tr_b16 a[160:161], v220 offset:32768
ds_read_b64_tr_b16 a[162:163], v220 offset:36864
v_mfma_f32_16x16x32_bf16 v[48:51], a[140:143], v[180:183], v[48:51]
v_exp_f32 v14, v14
v_mfma_f32_16x16x32_bf16 a[4:7], a[164:167], v[88:91], a[4:7]
v_cvt_pk_bf16_f32 v74, v12, v13
v_mfma_f32_16x16x32_bf16 a[36:39], a[164:167], v[92:95], a[36:39]
v_exp_f32 v15, v15
v_mfma_f32_16x16x32_bf16 a[68:71], a[164:167], v[96:99], a[68:71]
v_cvt_pk_bf16_f32 v75, v14, v15
v_mfma_f32_16x16x32_bf16 a[100:103], a[164:167], v[100:103], a[100:103]
v_exp_f32 v16, v16
v_smfmac_f32_16x16x64_bf16 a[248:251], a[208:211], v[88:95], v235
buffer_load_dwordx4 v233, s[12:15], s39 offen offset:1024 lds
v_mfma_f32_16x16x32_bf16 v[56:59], a[128:131], v[184:187], v[144:147]
v_exp_f32 v17, v17
v_mfma_f32_16x16x32_bf16 v[56:59], a[132:135], v[188:191], v[56:59]
ds_read_b64_tr_b16 a[164:165], v221 offset:32768
ds_read_b64_tr_b16 a[166:167], v221 offset:36864
v_mfma_f32_16x16x32_bf16 v[56:59], a[136:139], v[192:195], v[56:59]
v_exp_f32 v18, v18
v_mfma_f32_16x16x32_bf16 v[56:59], a[140:143], v[196:199], v[56:59]
v_cvt_pk_bf16_f32 v76, v16, v17
v_mfma_f32_16x16x32_bf16 a[8:11], a[168:171], v[88:91], a[8:11]
v_exp_f32 v19, v19
v_mfma_f32_16x16x32_bf16 a[40:43], a[168:171], v[92:95], a[40:43]
v_cvt_pk_bf16_f32 v77, v18, v19
v_mfma_f32_16x16x32_bf16 a[72:75], a[168:171], v[96:99], a[72:75]
v_exp_f32 v20, v20
v_mfma_f32_16x16x32_bf16 a[104:107], a[168:171], v[100:103], a[104:107]
ds_read_b64_tr_b16 a[168:169], v222 offset:32768
ds_read_b64_tr_b16 a[170:171], v222 offset:36864
v_mfma_f32_16x16x32_bf16 v[64:67], a[128:131], v[200:203], v[148:151]
v_exp_f32 v21, v21
v_mfma_f32_16x16x32_bf16 v[64:67], a[132:135], v[204:207], v[64:67]
buffer_load_dwordx4 v232, s[12:15], s39 offen offset:2048 lds
v_mfma_f32_16x16x32_bf16 v[64:67], a[136:139], v[208:211], v[64:67]
v_exp_f32 v22, v22
v_mfma_f32_16x16x32_bf16 v[64:67], a[140:143], v[212:215], v[64:67]
ds_read_b128 a[128:131], v216 offset:16384
ds_read_b128 a[132:135], v217 offset:16384
v_mfma_f32_16x16x32_bf16 a[12:15], a[172:175], v[88:91], a[12:15]
v_exp_f32 v23, v23
v_mfma_f32_16x16x32_bf16 a[44:47], a[172:175], v[92:95], a[44:47]
ds_read_b128 a[136:139], v218 offset:16384
ds_read_b128 a[140:143], v219 offset:16384
v_mfma_f32_16x16x32_bf16 a[76:79], a[172:175], v[96:99], a[76:79]
v_exp_f32 v24, v24
v_mfma_f32_16x16x32_bf16 a[108:111], a[172:175], v[100:103], a[108:111]
v_exp_f32 v25, v25
v_mfma_f32_16x16x32_bf16 v[44:47], a[144:147], v[152:155], v[136:139]
ds_read_b64_tr_b16 a[172:173], v223 offset:32768
ds_read_b64_tr_b16 a[174:175], v223 offset:36864
v_mfma_f32_16x16x32_bf16 v[44:47], a[148:151], v[156:159], v[44:47]
v_exp_f32 v26, v26
v_mfma_f32_16x16x32_bf16 v[44:47], a[152:155], v[160:163], v[44:47]
buffer_load_dwordx4 v233, s[12:15], s39 offen offset:3072 lds
v_mfma_f32_16x16x32_bf16 v[44:47], a[156:159], v[164:167], v[44:47]
v_exp_f32 v27, v27
v_mfma_f32_16x16x32_bf16 a[16:19], a[176:179], v[88:91], a[16:19]
v_cvt_pk_bf16_f32 v78, v20, v21
v_cvt_pk_bf16_f32 v79, v22, v23
v_mfma_f32_16x16x32_bf16 a[48:51], a[176:179], v[92:95], a[48:51]
v_exp_f32 v28, v28
v_mfma_f32_16x16x32_bf16 a[80:83], a[176:179], v[96:99], a[80:83]
v_cvt_pk_bf16_f32 v80, v24, v25
v_cvt_pk_bf16_f32 v81, v26, v27
v_mfma_f32_16x16x32_bf16 a[112:115], a[176:179], v[100:103], a[112:115]
v_exp_f32 v29, v29
v_mfma_f32_16x16x32_bf16 v[52:55], a[144:147], v[168:171], v[140:143]
ds_read_b64_tr_b16 a[176:177], v224 offset:32768
ds_read_b64_tr_b16 a[178:179], v224 offset:36864
v_mfma_f32_16x16x32_bf16 v[52:55], a[148:151], v[172:175], v[52:55]
v_exp_f32 v30, v30
v_mfma_f32_16x16x32_bf16 v[52:55], a[152:155], v[176:179], v[52:55]
v_cvt_pk_bf16_f32 v82, v28, v29
v_mfma_f32_16x16x32_bf16 v[52:55], a[156:159], v[180:183], v[52:55]
s_add_u32 s39, s39, 16384
v_exp_f32 v31, v31
v_mfma_f32_16x16x32_bf16 a[20:23], a[180:183], v[88:91], a[20:23]
s_add_u32 m0, s37, 49152
v_cvt_pk_bf16_f32 v83, v30, v31
v_mfma_f32_16x16x32_bf16 a[52:55], a[180:183], v[92:95], a[52:55]
v_exp_f32 v32, v32
v_mfma_f32_16x16x32_bf16 a[84:87], a[180:183], v[96:99], a[84:87]
buffer_load_dwordx4 v228, s[8:11], s38 offen offset:0 lds
v_mfma_f32_16x16x32_bf16 a[116:119], a[180:183], v[100:103], a[116:119]
v_exp_f32 v33, v33
v_smfmac_f32_16x16x64_bf16 a[252:255], a[208:211], v[96:103], v235
ds_read_b64_tr_b16 a[180:181], v225 offset:32768
ds_read_b64_tr_b16 a[182:183], v225 offset:36864
v_mfma_f32_16x16x32_bf16 v[60:63], a[144:147], v[184:187], v[144:147]
v_exp_f32 v34, v34
v_mfma_f32_16x16x32_bf16 v[60:63], a[148:151], v[188:191], v[60:63]
v_cvt_pk_bf16_f32 v84, v32, v33
v_mfma_f32_16x16x32_bf16 v[60:63], a[152:155], v[192:195], v[60:63]
v_exp_f32 v35, v35
v_mfma_f32_16x16x32_bf16 v[60:63], a[156:159], v[196:199], v[60:63]
buffer_load_dwordx4 v229, s[8:11], s38 offen offset:1024 lds
v_mfma_f32_16x16x32_bf16 a[24:27], a[184:187], v[88:91], a[24:27]
v_exp_f32 v36, v36
v_mfma_f32_16x16x32_bf16 a[56:59], a[184:187], v[92:95], a[56:59]
v_cvt_pk_bf16_f32 v85, v34, v35
v_mfma_f32_16x16x32_bf16 a[88:91], a[184:187], v[96:99], a[88:91]
v_exp_f32 v37, v37
v_mfma_f32_16x16x32_bf16 a[120:123], a[184:187], v[100:103], a[120:123]
ds_read_b64_tr_b16 a[184:185], v226 offset:32768
ds_read_b64_tr_b16 a[186:187], v226 offset:36864
v_mfma_f32_16x16x32_bf16 v[68:71], a[144:147], v[200:203], v[148:151]
v_exp_f32 v38, v38
v_mfma_f32_16x16x32_bf16 v[68:71], a[148:151], v[204:207], v[68:71]
ds_read_b128 a[144:147], v216 offset:20480
ds_read_b128 a[148:151], v217 offset:20480
v_mfma_f32_16x16x32_bf16 v[68:71], a[152:155], v[208:211], v[68:71]
v_exp_f32 v39, v39
v_mfma_f32_16x16x32_bf16 v[68:71], a[156:159], v[212:215], v[68:71]
ds_read_b128 a[152:155], v218 offset:20480
ds_read_b128 a[156:159], v219 offset:20480
v_mfma_f32_16x16x32_bf16 a[28:31], a[188:191], v[88:91], a[28:31]
v_cvt_pk_bf16_f32 v86, v36, v37
v_cvt_pk_bf16_f32 v87, v38, v39
v_mfma_f32_16x16x32_bf16 a[60:63], a[188:191], v[92:95], a[60:63]
v_mfma_f32_16x16x32_bf16 a[92:95], a[188:191], v[96:99], a[92:95]
v_mfma_f32_16x16x32_bf16 a[124:127], a[188:191], v[100:103], a[124:127]
s_waitcnt lgkmcnt(6)
ds_read_b64_tr_b16 a[188:189], v227 offset:32768
ds_read_b64_tr_b16 a[190:191], v227 offset:36864
s_branch K_LOOP
K_LAST:
s_mov_b32 s76, s6
s_and_b32 s77, s7, 0xffff
s_mov_b32 s78, 0x0
s_mov_b32 s79, 0x00020000
s_cmp_lg_u32 s52, 0
s_cbranch_scc1 K_LASTG
v_mfma_f32_16x16x32_bf16 v[40:43], a[128:131], v[152:155], v[136:139]
v_exp_f32 v8, v8
v_mfma_f32_16x16x32_bf16 v[40:43], a[132:135], v[156:159], v[40:43]
v_exp_f32 v9, v9
v_mfma_f32_16x16x32_bf16 v[40:43], a[136:139], v[160:163], v[40:43]
v_cvt_pk_bf16_f32 v72, v8, v9
v_mfma_f32_16x16x32_bf16 v[40:43], a[140:143], v[164:167], v[40:43]
v_exp_f32 v10, v10
v_mfma_f32_16x16x32_bf16 a[0:3], a[160:163], v[88:91], a[0:3]
v_mfma_f32_16x16x32_bf16 a[32:35], a[160:163], v[92:95], a[32:35]
v_exp_f32 v11, v11
s_waitcnt vmcnt(2) lgkmcnt(0)
s_barrier
v_mfma_f32_16x16x32_bf16 a[64:67], a[160:163], v[96:99], a[64:67]
v_cvt_pk_bf16_f32 v73, v10, v11
v_mfma_f32_16x16x32_bf16 a[96:99], a[160:163], v[100:103], a[96:99]
s_add_u32 m0, s3, 98304
v_exp_f32 v12, v12
v_mfma_f32_16x16x32_bf16 v[48:51], a[128:131], v[168:171], v[140:143]
s_add_u32 s48, s51, 0
buffer_load_dwordx4 v236, s[16:19], s48 offen lds
v_mfma_f32_16x16x32_bf16 v[48:51], a[132:135], v[172:175], v[48:51]
v_exp_f32 v13, v13
v_mfma_f32_16x16x32_bf16 v[48:51], a[136:139], v[176:179], v[48:51]
ds_read_b64_tr_b16 a[160:161], v220 offset:0
ds_read_b64_tr_b16 a[162:163], v220 offset:4096
v_mfma_f32_16x16x32_bf16 v[48:51], a[140:143], v[180:183], v[48:51]
v_exp_f32 v14, v14
v_mfma_f32_16x16x32_bf16 a[4:7], a[164:167], v[88:91], a[4:7]
v_cvt_pk_bf16_f32 v74, v12, v13
v_mfma_f32_16x16x32_bf16 a[36:39], a[164:167], v[92:95], a[36:39]
v_exp_f32 v15, v15
v_mfma_f32_16x16x32_bf16 a[68:71], a[164:167], v[96:99], a[68:71]
s_add_u32 m0, s3, 102400
v_cvt_pk_bf16_f32 v75, v14, v15
v_mfma_f32_16x16x32_bf16 a[100:103], a[164:167], v[100:103], a[100:103]
s_add_u32 s48, s51, 18432
v_exp_f32 v16, v16
v_smfmac_f32_16x16x64_bf16 a[248:251], a[208:211], v[88:95], v235
buffer_load_dwordx4 v236, s[16:19], s48 offen lds
v_mfma_f32_16x16x32_bf16 v[56:59], a[128:131], v[184:187], v[144:147]
v_exp_f32 v17, v17
v_mfma_f32_16x16x32_bf16 v[56:59], a[132:135], v[188:191], v[56:59]
ds_read_b64_tr_b16 a[164:165], v221 offset:0
ds_read_b64_tr_b16 a[166:167], v221 offset:4096
v_mfma_f32_16x16x32_bf16 v[56:59], a[136:139], v[192:195], v[56:59]
v_exp_f32 v18, v18
v_mfma_f32_16x16x32_bf16 v[56:59], a[140:143], v[196:199], v[56:59]
v_cvt_pk_bf16_f32 v76, v16, v17
v_mfma_f32_16x16x32_bf16 a[8:11], a[168:171], v[88:91], a[8:11]
s_add_u32 m0, s3, 106496
v_exp_f32 v19, v19
v_mfma_f32_16x16x32_bf16 a[40:43], a[168:171], v[92:95], a[40:43]
s_add_u32 s48, s51, 36864
buffer_load_dwordx4 v236, s[16:19], s48 offen lds
v_mfma_f32_16x16x32_bf16 a[72:75], a[168:171], v[96:99], a[72:75]
v_exp_f32 v20, v20
v_mfma_f32_16x16x32_bf16 a[104:107], a[168:171], v[100:103], a[104:107]
ds_read_b64_tr_b16 a[168:169], v222 offset:0
ds_read_b64_tr_b16 a[170:171], v222 offset:4096
v_mfma_f32_16x16x32_bf16 v[64:67], a[128:131], v[200:203], v[148:151]
v_exp_f32 v21, v21
v_mfma_f32_16x16x32_bf16 v[64:67], a[132:135], v[204:207], v[64:67]
ds_read_b128 a[128:131], v216 offset:49152
ds_read_b128 a[132:135], v217 offset:49152
v_mfma_f32_16x16x32_bf16 v[64:67], a[136:139], v[208:211], v[64:67]
v_exp_f32 v22, v22
v_mfma_f32_16x16x32_bf16 v[64:67], a[140:143], v[212:215], v[64:67]
s_add_u32 m0, s3, 110592
ds_read_b128 a[136:139], v218 offset:49152
ds_read_b128 a[140:143], v219 offset:49152
v_mfma_f32_16x16x32_bf16 a[12:15], a[172:175], v[88:91], a[12:15]
s_add_u32 s48, s51, 55296
v_exp_f32 v23, v23
v_mfma_f32_16x16x32_bf16 a[44:47], a[172:175], v[92:95], a[44:47]
buffer_load_dwordx4 v236, s[16:19], s48 offen lds
v_mfma_f32_16x16x32_bf16 a[76:79], a[172:175], v[96:99], a[76:79]
v_exp_f32 v24, v24
v_mfma_f32_16x16x32_bf16 a[108:111], a[172:175], v[100:103], a[108:111]
v_exp_f32 v25, v25
v_mfma_f32_16x16x32_bf16 v[44:47], a[144:147], v[152:155], v[136:139]
ds_read_b64_tr_b16 a[172:173], v223 offset:0
ds_read_b64_tr_b16 a[174:175], v223 offset:4096
v_mfma_f32_16x16x32_bf16 v[44:47], a[148:151], v[156:159], v[44:47]
v_exp_f32 v26, v26
v_mfma_f32_16x16x32_bf16 v[44:47], a[152:155], v[160:163], v[44:47]
s_add_u32 m0, s3, 114688
v_cvt_pk_bf16_f32 v77, v18, v19
v_cvt_pk_bf16_f32 v78, v20, v21
v_mfma_f32_16x16x32_bf16 v[44:47], a[156:159], v[164:167], v[44:47]
s_add_u32 s48, s51, 73728
v_exp_f32 v27, v27
v_mfma_f32_16x16x32_bf16 a[16:19], a[176:179], v[88:91], a[16:19]
buffer_load_dwordx4 v236, s[16:19], s48 offen lds
v_mfma_f32_16x16x32_bf16 a[48:51], a[176:179], v[92:95], a[48:51]
v_exp_f32 v28, v28
v_mfma_f32_16x16x32_bf16 a[80:83], a[176:179], v[96:99], a[80:83]
v_cvt_pk_bf16_f32 v79, v22, v23
v_cvt_pk_bf16_f32 v80, v24, v25
v_mfma_f32_16x16x32_bf16 a[112:115], a[176:179], v[100:103], a[112:115]
v_exp_f32 v29, v29
v_mfma_f32_16x16x32_bf16 v[52:55], a[144:147], v[168:171], v[140:143]
ds_read_b64_tr_b16 a[176:177], v224 offset:0
ds_read_b64_tr_b16 a[178:179], v224 offset:4096
v_mfma_f32_16x16x32_bf16 v[52:55], a[148:151], v[172:175], v[52:55]
s_add_u32 m0, s3, 118784
v_exp_f32 v30, v30
v_mfma_f32_16x16x32_bf16 v[52:55], a[152:155], v[176:179], v[52:55]
s_add_u32 s48, s51, 92160
buffer_load_dwordx4 v236, s[16:19], s48 offen lds
v_mfma_f32_16x16x32_bf16 v[52:55], a[156:159], v[180:183], v[52:55]
v_exp_f32 v31, v31
v_mfma_f32_16x16x32_bf16 a[20:23], a[180:183], v[88:91], a[20:23]
v_cvt_pk_bf16_f32 v81, v26, v27
v_cvt_pk_bf16_f32 v82, v28, v29
v_mfma_f32_16x16x32_bf16 a[52:55], a[180:183], v[92:95], a[52:55]
v_exp_f32 v32, v32
v_mfma_f32_16x16x32_bf16 a[84:87], a[180:183], v[96:99], a[84:87]
v_cvt_pk_bf16_f32 v83, v30, v31
v_mfma_f32_16x16x32_bf16 a[116:119], a[180:183], v[100:103], a[116:119]
v_exp_f32 v33, v33
v_smfmac_f32_16x16x64_bf16 a[252:255], a[208:211], v[96:103], v235
s_add_u32 m0, s3, 122880
ds_read_b64_tr_b16 a[180:181], v225 offset:0
ds_read_b64_tr_b16 a[182:183], v225 offset:4096
v_mfma_f32_16x16x32_bf16 v[60:63], a[144:147], v[184:187], v[144:147]
s_add_u32 s48, s51, 110592
v_exp_f32 v34, v34
v_mfma_f32_16x16x32_bf16 v[60:63], a[148:151], v[188:191], v[60:63]
buffer_load_dwordx4 v236, s[16:19], s48 offen lds
v_mfma_f32_16x16x32_bf16 v[60:63], a[152:155], v[192:195], v[60:63]
v_exp_f32 v35, v35
v_mfma_f32_16x16x32_bf16 v[60:63], a[156:159], v[196:199], v[60:63]
v_cvt_pk_bf16_f32 v84, v32, v33
v_cvt_pk_bf16_f32 v85, v34, v35
v_mfma_f32_16x16x32_bf16 a[24:27], a[184:187], v[88:91], a[24:27]
v_exp_f32 v36, v36
v_mfma_f32_16x16x32_bf16 a[56:59], a[184:187], v[92:95], a[56:59]
v_mfma_f32_16x16x32_bf16 a[88:91], a[184:187], v[96:99], a[88:91]
s_add_u32 m0, s3, 126976
v_exp_f32 v37, v37
v_mfma_f32_16x16x32_bf16 a[120:123], a[184:187], v[100:103], a[120:123]
s_add_u32 s48, s51, 129024
buffer_load_dwordx4 v236, s[16:19], s48 offen lds
v_mfma_f32_16x16x32_bf16 v[68:71], a[144:147], v[200:203], v[148:151]
v_exp_f32 v38, v38
v_mfma_f32_16x16x32_bf16 v[68:71], a[148:151], v[204:207], v[68:71]
ds_read_b64_tr_b16 a[184:185], v226 offset:0
ds_read_b64_tr_b16 a[186:187], v226 offset:4096
v_mfma_f32_16x16x32_bf16 v[68:71], a[152:155], v[208:211], v[68:71]
v_exp_f32 v39, v39
v_mfma_f32_16x16x32_bf16 v[68:71], a[156:159], v[212:215], v[68:71]
ds_read_b128 a[144:147], v216 offset:53248
ds_read_b128 a[148:151], v217 offset:53248
v_mfma_f32_16x16x32_bf16 a[28:31], a[188:191], v[88:91], a[28:31]
ds_read_b128 a[152:155], v218 offset:53248
ds_read_b128 a[156:159], v219 offset:53248
v_mfma_f32_16x16x32_bf16 a[60:63], a[188:191], v[92:95], a[60:63]
v_cvt_pk_bf16_f32 v86, v36, v37
v_cvt_pk_bf16_f32 v87, v38, v39
v_mfma_f32_16x16x32_bf16 a[92:95], a[188:191], v[96:99], a[92:95]
v_mfma_f32_16x16x32_bf16 a[124:127], a[188:191], v[100:103], a[124:127]
s_waitcnt lgkmcnt(6)
ds_read_b64_tr_b16 a[188:189], v227 offset:0
ds_read_b64_tr_b16 a[190:191], v227 offset:4096
v_mfma_f32_16x16x32_bf16 v[8:11], a[128:131], v[152:155], v[136:139]
v_exp_f32 v40, v40
v_mfma_f32_16x16x32_bf16 v[8:11], a[132:135], v[156:159], v[8:11]
s_add_u32 m0, s3, 131072
v_exp_f32 v41, v41
v_mfma_f32_16x16x32_bf16 v[8:11], a[136:139], v[160:163], v[8:11]
s_add_u32 s48, s51, 147456
buffer_load_dwordx4 v236, s[16:19], s48 offen lds
v_mfma_f32_16x16x32_bf16 v[8:11], a[140:143], v[164:167], v[8:11]
v_exp_f32 v42, v42
v_mfma_f32_16x16x32_bf16 a[0:3], a[160:163], v[72:75], a[0:3]
v_cvt_pk_bf16_f32 v88, v40, v41
v_mfma_f32_16x16x32_bf16 a[32:35], a[160:163], v[76:79], a[32:35]
v_exp_f32 v43, v43
v_mfma_f32_16x16x32_bf16 a[64:67], a[160:163], v[80:83], a[64:67]
v_cvt_pk_bf16_f32 v89, v42, v43
v_mfma_f32_16x16x32_bf16 a[96:99], a[160:163], v[84:87], a[96:99]
v_exp_f32 v44, v44
v_mfma_f32_16x16x32_bf16 v[16:19], a[128:131], v[168:171], v[140:143]
s_add_u32 m0, s3, 135168
ds_read_b64_tr_b16 a[160:161], v220 offset:8192
ds_read_b64_tr_b16 a[162:163], v220 offset:12288
v_mfma_f32_16x16x32_bf16 v[16:19], a[132:135], v[172:175], v[16:19]
s_add_u32 s48, s51, 165888
v_exp_f32 v45, v45
v_mfma_f32_16x16x32_bf16 v[16:19], a[136:139], v[176:179], v[16:19]
buffer_load_dwordx4 v236, s[16:19], s48 offen lds
v_mfma_f32_16x16x32_bf16 v[16:19], a[140:143], v[180:183], v[16:19]
v_exp_f32 v46, v46
v_mfma_f32_16x16x32_bf16 a[4:7], a[164:167], v[72:75], a[4:7]
v_cvt_pk_bf16_f32 v90, v44, v45
v_mfma_f32_16x16x32_bf16 a[36:39], a[164:167], v[76:79], a[36:39]
v_exp_f32 v47, v47
v_mfma_f32_16x16x32_bf16 a[68:71], a[164:167], v[80:83], a[68:71]
v_cvt_pk_bf16_f32 v91, v46, v47
v_mfma_f32_16x16x32_bf16 a[100:103], a[164:167], v[84:87], a[100:103]
v_exp_f32 v48, v48
v_smfmac_f32_16x16x64_bf16 a[248:251], a[208:211], v[72:79], v235
s_add_u32 m0, s3, 139264
ds_read_b64_tr_b16 a[164:165], v221 offset:8192
ds_read_b64_tr_b16 a[166:167], v221 offset:12288
v_mfma_f32_16x16x32_bf16 v[24:27], a[128:131], v[184:187], v[144:147]
s_add_u32 s48, s51, 184320
v_exp_f32 v49, v49
v_mfma_f32_16x16x32_bf16 v[24:27], a[132:135], v[188:191], v[24:27]
buffer_load_dwordx4 v236, s[16:19], s48 offen lds
v_mfma_f32_16x16x32_bf16 v[24:27], a[136:139], v[192:195], v[24:27]
v_exp_f32 v50, v50
v_mfma_f32_16x16x32_bf16 v[24:27], a[140:143], v[196:199], v[24:27]
v_cvt_pk_bf16_f32 v92, v48, v49
v_mfma_f32_16x16x32_bf16 a[8:11], a[168:171], v[72:75], a[8:11]
v_exp_f32 v51, v51
v_mfma_f32_16x16x32_bf16 a[40:43], a[168:171], v[76:79], a[40:43]
v_cvt_pk_bf16_f32 v93, v50, v51
v_mfma_f32_16x16x32_bf16 a[72:75], a[168:171], v[80:83], a[72:75]
v_exp_f32 v52, v52
v_mfma_f32_16x16x32_bf16 a[104:107], a[168:171], v[84:87], a[104:107]
s_add_u32 m0, s3, 143360
ds_read_b64_tr_b16 a[168:169], v222 offset:8192
ds_read_b64_tr_b16 a[170:171], v222 offset:12288
v_mfma_f32_16x16x32_bf16 v[32:35], a[128:131], v[200:203], v[148:151]
s_add_u32 s48, s51, 202752
v_exp_f32 v53, v53
v_mfma_f32_16x16x32_bf16 v[32:35], a[132:135], v[204:207], v[32:35]
buffer_load_dwordx4 v236, s[16:19], s48 offen lds
v_mfma_f32_16x16x32_bf16 v[32:35], a[136:139], v[208:211], v[32:35]
v_exp_f32 v54, v54
v_mfma_f32_16x16x32_bf16 v[32:35], a[140:143], v[212:215], v[32:35]
ds_read_b128 a[128:131], v216 offset:57344
ds_read_b128 a[132:135], v217 offset:57344
v_mfma_f32_16x16x32_bf16 a[12:15], a[172:175], v[72:75], a[12:15]
v_exp_f32 v55, v55
v_mfma_f32_16x16x32_bf16 a[44:47], a[172:175], v[76:79], a[44:47]
ds_read_b128 a[136:139], v218 offset:57344
ds_read_b128 a[140:143], v219 offset:57344
v_mfma_f32_16x16x32_bf16 a[76:79], a[172:175], v[80:83], a[76:79]
s_waitcnt lgkmcnt(6)
v_exp_f32 v56, v56
v_mfma_f32_16x16x32_bf16 a[108:111], a[172:175], v[84:87], a[108:111]
s_add_u32 m0, s3, 147456
v_exp_f32 v57, v57
v_mfma_f32_16x16x32_bf16 v[12:15], a[144:147], v[152:155], v[136:139]
s_add_u32 s48, s51, 221184
buffer_load_dwordx4 v236, s[16:19], s48 offen lds
v_mfma_f32_16x16x32_bf16 v[12:15], a[148:151], v[156:159], v[12:15]
v_exp_f32 v58, v58
v_mfma_f32_16x16x32_bf16 v[12:15], a[152:155], v[160:163], v[12:15]
ds_read_b64_tr_b16 a[172:173], v223 offset:8192
ds_read_b64_tr_b16 a[174:175], v223 offset:12288
v_mfma_f32_16x16x32_bf16 v[12:15], a[156:159], v[164:167], v[12:15]
v_exp_f32 v59, v59
v_mfma_f32_16x16x32_bf16 a[16:19], a[176:179], v[72:75], a[16:19]
v_cvt_pk_bf16_f32 v94, v52, v53
v_cvt_pk_bf16_f32 v95, v54, v55
v_mfma_f32_16x16x32_bf16 a[48:51], a[176:179], v[76:79], a[48:51]
v_exp_f32 v60, v60
v_mfma_f32_16x16x32_bf16 a[80:83], a[176:179], v[80:83], a[80:83]
s_add_u32 m0, s3, 151552
v_cvt_pk_bf16_f32 v96, v56, v57
v_cvt_pk_bf16_f32 v97, v58, v59
v_mfma_f32_16x16x32_bf16 a[112:115], a[176:179], v[84:87], a[112:115]
s_add_u32 s48, s51, 239616
v_exp_f32 v61, v61
v_mfma_f32_16x16x32_bf16 v[20:23], a[144:147], v[168:171], v[140:143]
buffer_load_dwordx4 v236, s[16:19], s48 offen lds
v_mfma_f32_16x16x32_bf16 v[20:23], a[148:151], v[172:175], v[20:23]
v_exp_f32 v62, v62
v_mfma_f32_16x16x32_bf16 v[20:23], a[152:155], v[176:179], v[20:23]
ds_read_b64_tr_b16 a[176:177], v224 offset:8192
ds_read_b64_tr_b16 a[178:179], v224 offset:12288
v_mfma_f32_16x16x32_bf16 v[20:23], a[156:159], v[180:183], v[20:23]
v_exp_f32 v63, v63
v_mfma_f32_16x16x32_bf16 a[20:23], a[180:183], v[72:75], a[20:23]
v_cvt_pk_bf16_f32 v98, v60, v61
v_cvt_pk_bf16_f32 v99, v62, v63
v_mfma_f32_16x16x32_bf16 a[52:55], a[180:183], v[76:79], a[52:55]
v_exp_f32 v64, v64
v_mfma_f32_16x16x32_bf16 a[84:87], a[180:183], v[80:83], a[84:87]
s_add_u32 m0, s3, 155648
v_mfma_f32_16x16x32_bf16 a[116:119], a[180:183], v[84:87], a[116:119]
s_add_u32 s48, s51, 258048
v_exp_f32 v65, v65
v_smfmac_f32_16x16x64_bf16 a[252:255], a[208:211], v[80:87], v235
buffer_load_dwordx4 v236, s[16:19], s48 offen lds
v_mfma_f32_16x16x32_bf16 v[28:31], a[144:147], v[184:187], v[144:147]
v_exp_f32 v66, v66
v_mfma_f32_16x16x32_bf16 v[28:31], a[148:151], v[188:191], v[28:31]
ds_read_b64_tr_b16 a[180:181], v225 offset:8192
ds_read_b64_tr_b16 a[182:183], v225 offset:12288
v_mfma_f32_16x16x32_bf16 v[28:31], a[152:155], v[192:195], v[28:31]
v_exp_f32 v67, v67
v_mfma_f32_16x16x32_bf16 v[28:31], a[156:159], v[196:199], v[28:31]
v_cvt_pk_bf16_f32 v100, v64, v65
v_cvt_pk_bf16_f32 v101, v66, v67
v_mfma_f32_16x16x32_bf16 a[24:27], a[184:187], v[72:75], a[24:27]
v_exp_f32 v68, v68
v_mfma_f32_16x16x32_bf16 a[56:59], a[184:187], v[76:79], a[56:59]
s_add_u32 m0, s3, 159744
v_mfma_f32_16x16x32_bf16 a[88:91], a[184:187], v[80:83], a[88:91]
s_add_u32 s48, s51, 276480
v_exp_f32 v69, v69
v_mfma_f32_16x16x32_bf16 a[120:123], a[184:187], v[84:87], a[120:123]
buffer_load_dwordx4 v236, s[16:19], s48 offen lds
v_mfma_f32_16x16x32_bf16 v[36:39], a[144:147], v[200:203], v[148:151]
v_exp_f32 v70, v70
v_mfma_f32_16x16x32_bf16 v[36:39], a[148:151], v[204:207], v[36:39]
ds_read_b64_tr_b16 a[184:185], v226 offset:8192
ds_read_b64_tr_b16 a[186:187], v226 offset:12288
v_mfma_f32_16x16x32_bf16 v[36:39], a[152:155], v[208:211], v[36:39]
v_exp_f32 v71, v71
v_mfma_f32_16x16x32_bf16 v[36:39], a[156:159], v[212:215], v[36:39]
ds_read_b128 a[144:147], v216 offset:61440
ds_read_b128 a[148:151], v217 offset:61440
v_mfma_f32_16x16x32_bf16 a[28:31], a[188:191], v[72:75], a[28:31]
ds_read_b128 a[152:155], v218 offset:61440
ds_read_b128 a[156:159], v219 offset:61440
v_mfma_f32_16x16x32_bf16 a[60:63], a[188:191], v[76:79], a[60:63]
v_cvt_pk_bf16_f32 v102, v68, v69
v_cvt_pk_bf16_f32 v103, v70, v71
v_mfma_f32_16x16x32_bf16 a[92:95], a[188:191], v[80:83], a[92:95]
v_mfma_f32_16x16x32_bf16 a[124:127], a[188:191], v[84:87], a[124:127]
s_waitcnt lgkmcnt(6)
ds_read_b64_tr_b16 a[188:189], v227 offset:8192
ds_read_b64_tr_b16 a[190:191], v227 offset:12288
v_mfma_f32_16x16x32_bf16 v[40:43], a[128:131], v[152:155], v[136:139]
v_exp_f32 v8, v8
v_mfma_f32_16x16x32_bf16 v[40:43], a[132:135], v[156:159], v[40:43]
s_add_u32 m0, s3, 0
v_exp_f32 v9, v9
v_mfma_f32_16x16x32_bf16 v[40:43], a[136:139], v[160:163], v[40:43]
s_add_u32 s48, s75, 0
buffer_load_dwordx4 v237, s[16:19], s48 offen lds
v_mfma_f32_16x16x32_bf16 v[40:43], a[140:143], v[164:167], v[40:43]
v_exp_f32 v10, v10
v_mfma_f32_16x16x32_bf16 a[0:3], a[160:163], v[88:91], a[0:3]
v_cvt_pk_bf16_f32 v72, v8, v9
v_mfma_f32_16x16x32_bf16 a[32:35], a[160:163], v[92:95], a[32:35]
v_exp_f32 v11, v11
v_mfma_f32_16x16x32_bf16 a[64:67], a[160:163], v[96:99], a[64:67]
v_cvt_pk_bf16_f32 v73, v10, v11
v_mfma_f32_16x16x32_bf16 a[96:99], a[160:163], v[100:103], a[96:99]
v_exp_f32 v12, v12
v_mfma_f32_16x16x32_bf16 v[48:51], a[128:131], v[168:171], v[140:143]
s_add_u32 m0, s3, 4096
ds_read_b64_tr_b16 a[160:161], v220 offset:16384
ds_read_b64_tr_b16 a[162:163], v220 offset:20480
v_mfma_f32_16x16x32_bf16 v[48:51], a[132:135], v[172:175], v[48:51]
s_add_u32 s48, s75, 36864
v_exp_f32 v13, v13
v_mfma_f32_16x16x32_bf16 v[48:51], a[136:139], v[176:179], v[48:51]
buffer_load_dwordx4 v237, s[16:19], s48 offen lds
v_mfma_f32_16x16x32_bf16 v[48:51], a[140:143], v[180:183], v[48:51]
v_exp_f32 v14, v14
v_mfma_f32_16x16x32_bf16 a[4:7], a[164:167], v[88:91], a[4:7]
v_cvt_pk_bf16_f32 v74, v12, v13
v_mfma_f32_16x16x32_bf16 a[36:39], a[164:167], v[92:95], a[36:39]
v_exp_f32 v15, v15
v_mfma_f32_16x16x32_bf16 a[68:71], a[164:167], v[96:99], a[68:71]
v_cvt_pk_bf16_f32 v75, v14, v15
v_mfma_f32_16x16x32_bf16 a[100:103], a[164:167], v[100:103], a[100:103]
v_exp_f32 v16, v16
v_smfmac_f32_16x16x64_bf16 a[248:251], a[208:211], v[88:95], v235
s_add_u32 m0, s3, 8192
ds_read_b64_tr_b16 a[164:165], v221 offset:16384
ds_read_b64_tr_b16 a[166:167], v221 offset:20480
v_mfma_f32_16x16x32_bf16 v[56:59], a[128:131], v[184:187], v[144:147]
s_add_u32 s48, s75, 73728
v_exp_f32 v17, v17
v_mfma_f32_16x16x32_bf16 v[56:59], a[132:135], v[188:191], v[56:59]
buffer_load_dwordx4 v237, s[16:19], s48 offen lds
v_mfma_f32_16x16x32_bf16 v[56:59], a[136:139], v[192:195], v[56:59]
v_exp_f32 v18, v18
v_mfma_f32_16x16x32_bf16 v[56:59], a[140:143], v[196:199], v[56:59]
v_cvt_pk_bf16_f32 v76, v16, v17
v_mfma_f32_16x16x32_bf16 a[8:11], a[168:171], v[88:91], a[8:11]
v_exp_f32 v19, v19
v_mfma_f32_16x16x32_bf16 a[40:43], a[168:171], v[92:95], a[40:43]
v_cvt_pk_bf16_f32 v77, v18, v19
v_mfma_f32_16x16x32_bf16 a[72:75], a[168:171], v[96:99], a[72:75]
v_exp_f32 v20, v20
v_mfma_f32_16x16x32_bf16 a[104:107], a[168:171], v[100:103], a[104:107]
s_add_u32 m0, s3, 12288
ds_read_b64_tr_b16 a[168:169], v222 offset:16384
ds_read_b64_tr_b16 a[170:171], v222 offset:20480
v_mfma_f32_16x16x32_bf16 v[64:67], a[128:131], v[200:203], v[148:151]
s_add_u32 s48, s75, 110592
v_exp_f32 v21, v21
v_mfma_f32_16x16x32_bf16 v[64:67], a[132:135], v[204:207], v[64:67]
buffer_load_dwordx4 v237, s[16:19], s48 offen lds
v_mfma_f32_16x16x32_bf16 v[64:67], a[136:139], v[208:211], v[64:67]
v_exp_f32 v22, v22
v_mfma_f32_16x16x32_bf16 v[64:67], a[140:143], v[212:215], v[64:67]
v_cvt_pk_bf16_f32 v78, v20, v21
v_mfma_f32_16x16x32_bf16 a[12:15], a[172:175], v[88:91], a[12:15]
v_exp_f32 v23, v23
v_mfma_f32_16x16x32_bf16 a[44:47], a[172:175], v[92:95], a[44:47]
v_cvt_pk_bf16_f32 v79, v22, v23
v_mfma_f32_16x16x32_bf16 a[76:79], a[172:175], v[96:99], a[76:79]
s_waitcnt lgkmcnt(6)
v_exp_f32 v24, v24
v_mfma_f32_16x16x32_bf16 a[108:111], a[172:175], v[100:103], a[108:111]
s_add_u32 m0, s3, 16384
v_exp_f32 v25, v25
v_mfma_f32_16x16x32_bf16 v[44:47], a[144:147], v[152:155], v[136:139]
s_add_u32 s48, s75, 147456
buffer_load_dwordx4 v237, s[16:19], s48 offen lds
v_mfma_f32_16x16x32_bf16 v[44:47], a[148:151], v[156:159], v[44:47]
v_exp_f32 v26, v26
v_mfma_f32_16x16x32_bf16 v[44:47], a[152:155], v[160:163], v[44:47]
ds_read_b64_tr_b16 a[172:173], v223 offset:16384
ds_read_b64_tr_b16 a[174:175], v223 offset:20480
v_mfma_f32_16x16x32_bf16 v[44:47], a[156:159], v[164:167], v[44:47]
v_exp_f32 v27, v27
v_mfma_f32_16x16x32_bf16 a[16:19], a[176:179], v[88:91], a[16:19]
v_cvt_pk_bf16_f32 v80, v24, v25
v_cvt_pk_bf16_f32 v81, v26, v27
v_mfma_f32_16x16x32_bf16 a[48:51], a[176:179], v[92:95], a[48:51]
v_exp_f32 v28, v28
v_mfma_f32_16x16x32_bf16 a[80:83], a[176:179], v[96:99], a[80:83]
s_add_u32 m0, s3, 20480
v_mfma_f32_16x16x32_bf16 a[112:115], a[176:179], v[100:103], a[112:115]
s_add_u32 s48, s75, 184320
v_exp_f32 v29, v29
v_mfma_f32_16x16x32_bf16 v[52:55], a[144:147], v[168:171], v[140:143]
buffer_load_dwordx4 v237, s[16:19], s48 offen lds
v_mfma_f32_16x16x32_bf16 v[52:55], a[148:151], v[172:175], v[52:55]
v_exp_f32 v30, v30
v_mfma_f32_16x16x32_bf16 v[52:55], a[152:155], v[176:179], v[52:55]
ds_read_b64_tr_b16 a[176:177], v224 offset:16384
ds_read_b64_tr_b16 a[178:179], v224 offset:20480
v_mfma_f32_16x16x32_bf16 v[52:55], a[156:159], v[180:183], v[52:55]
v_exp_f32 v31, v31
v_mfma_f32_16x16x32_bf16 a[20:23], a[180:183], v[88:91], a[20:23]
v_cvt_pk_bf16_f32 v82, v28, v29
v_cvt_pk_bf16_f32 v83, v30, v31
v_mfma_f32_16x16x32_bf16 a[52:55], a[180:183], v[92:95], a[52:55]
v_exp_f32 v32, v32
v_mfma_f32_16x16x32_bf16 a[84:87], a[180:183], v[96:99], a[84:87]
s_add_u32 m0, s3, 24576
v_mfma_f32_16x16x32_bf16 a[116:119], a[180:183], v[100:103], a[116:119]
s_add_u32 s48, s75, 221184
v_exp_f32 v33, v33
v_smfmac_f32_16x16x64_bf16 a[252:255], a[208:211], v[96:103], v235
buffer_load_dwordx4 v237, s[16:19], s48 offen lds
v_mfma_f32_16x16x32_bf16 v[60:63], a[144:147], v[184:187], v[144:147]
v_exp_f32 v34, v34
v_mfma_f32_16x16x32_bf16 v[60:63], a[148:151], v[188:191], v[60:63]
ds_read_b64_tr_b16 a[180:181], v225 offset:16384
ds_read_b64_tr_b16 a[182:183], v225 offset:20480
v_mfma_f32_16x16x32_bf16 v[60:63], a[152:155], v[192:195], v[60:63]
v_exp_f32 v35, v35
v_mfma_f32_16x16x32_bf16 v[60:63], a[156:159], v[196:199], v[60:63]
v_cvt_pk_bf16_f32 v84, v32, v33
v_cvt_pk_bf16_f32 v85, v34, v35
v_mfma_f32_16x16x32_bf16 a[24:27], a[184:187], v[88:91], a[24:27]
v_exp_f32 v36, v36
v_mfma_f32_16x16x32_bf16 a[56:59], a[184:187], v[92:95], a[56:59]
s_add_u32 m0, s3, 28672
v_mfma_f32_16x16x32_bf16 a[88:91], a[184:187], v[96:99], a[88:91]
s_add_u32 s48, s75, 258048
v_exp_f32 v37, v37
v_mfma_f32_16x16x32_bf16 a[120:123], a[184:187], v[100:103], a[120:123]
buffer_load_dwordx4 v237, s[16:19], s48 offen lds
v_mfma_f32_16x16x32_bf16 v[68:71], a[144:147], v[200:203], v[148:151]
v_exp_f32 v38, v38
v_mfma_f32_16x16x32_bf16 v[68:71], a[148:151], v[204:207], v[68:71]
ds_read_b64_tr_b16 a[184:185], v226 offset:16384
ds_read_b64_tr_b16 a[186:187], v226 offset:20480
v_mfma_f32_16x16x32_bf16 v[68:71], a[152:155], v[208:211], v[68:71]
v_exp_f32 v39, v39
v_mfma_f32_16x16x32_bf16 v[68:71], a[156:159], v[212:215], v[68:71]
v_cvt_pk_bf16_f32 v86, v36, v37
v_cvt_pk_bf16_f32 v87, v38, v39
v_mfma_f32_16x16x32_bf16 a[28:31], a[188:191], v[88:91], a[28:31]
v_mfma_f32_16x16x32_bf16 a[60:63], a[188:191], v[92:95], a[60:63]
v_mfma_f32_16x16x32_bf16 a[92:95], a[188:191], v[96:99], a[92:95]
v_mfma_f32_16x16x32_bf16 a[124:127], a[188:191], v[100:103], a[124:127]
ds_read_b64_tr_b16 a[188:189], v227 offset:16384
ds_read_b64_tr_b16 a[190:191], v227 offset:20480
s_branch K_LAST3
K_LASTG:
s_add_u32 s43, s49, 98304
s_cmp_eq_u32 s32, 3
s_cselect_b32 s43, 36864, s43
s_sub_u32 s42, s52, 1
s_mul_i32 s42, s42, 36864
s_add_u32 s42, s42, s49
v_mfma_f32_16x16x32_bf16 v[40:43], a[128:131], v[152:155], v[136:139]
v_exp_f32 v8, v8
v_mfma_f32_16x16x32_bf16 v[40:43], a[132:135], v[156:159], v[40:43]
v_exp_f32 v9, v9
v_mfma_f32_16x16x32_bf16 v[40:43], a[136:139], v[160:163], v[40:43]
v_cvt_pk_bf16_f32 v72, v8, v9
v_mfma_f32_16x16x32_bf16 v[40:43], a[140:143], v[164:167], v[40:43]
v_exp_f32 v10, v10
v_mfma_f32_16x16x32_bf16 a[0:3], a[160:163], v[88:91], a[0:3]
v_mfma_f32_16x16x32_bf16 a[32:35], a[160:163], v[92:95], a[32:35]
v_exp_f32 v11, v11
s_waitcnt vmcnt(2) lgkmcnt(0)
s_barrier
v_mfma_f32_16x16x32_bf16 a[64:67], a[160:163], v[96:99], a[64:67]
v_cvt_pk_bf16_f32 v73, v10, v11
v_mfma_f32_16x16x32_bf16 a[96:99], a[160:163], v[100:103], a[96:99]
s_add_u32 m0, s3, 0
v_exp_f32 v12, v12
v_mfma_f32_16x16x32_bf16 v[48:51], a[128:131], v[168:171], v[140:143]
s_add_u32 s46, s50, 0
buffer_load_dwordx4 v238, s[56:59], s46 offen lds
v_mfma_f32_16x16x32_bf16 v[48:51], a[132:135], v[172:175], v[48:51]
v_exp_f32 v13, v13
v_mfma_f32_16x16x32_bf16 v[48:51], a[136:139], v[176:179], v[48:51]
ds_read_b64_tr_b16 a[160:161], v220 offset:0
ds_read_b64_tr_b16 a[162:163], v220 offset:4096
v_mfma_f32_16x16x32_bf16 v[48:51], a[140:143], v[180:183], v[48:51]
v_exp_f32 v14, v14
v_mfma_f32_16x16x32_bf16 a[4:7], a[164:167], v[88:91], a[4:7]
v_cvt_pk_bf16_f32 v74, v12, v13
v_mfma_f32_16x16x32_bf16 a[36:39], a[164:167], v[92:95], a[36:39]
v_exp_f32 v15, v15
v_mfma_f32_16x16x32_bf16 a[68:71], a[164:167], v[96:99], a[68:71]
v_cvt_pk_bf16_f32 v75, v14, v15
v_mfma_f32_16x16x32_bf16 a[100:103], a[164:167], v[100:103], a[100:103]
v_exp_f32 v16, v16
v_smfmac_f32_16x16x64_bf16 a[248:251], a[208:211], v[88:95], v235
s_add_u32 m0, s3, 4096
ds_read_b64_tr_b16 a[164:165], v221 offset:0
ds_read_b64_tr_b16 a[166:167], v221 offset:4096
v_mfma_f32_16x16x32_bf16 v[56:59], a[128:131], v[184:187], v[144:147]
s_add_u32 s46, s50, 589824
v_exp_f32 v17, v17
v_mfma_f32_16x16x32_bf16 v[56:59], a[132:135], v[188:191], v[56:59]
buffer_load_dwordx4 v238, s[56:59], s46 offen lds
v_mfma_f32_16x16x32_bf16 v[56:59], a[136:139], v[192:195], v[56:59]
v_exp_f32 v18, v18
v_mfma_f32_16x16x32_bf16 v[56:59], a[140:143], v[196:199], v[56:59]
v_cvt_pk_bf16_f32 v76, v16, v17
v_mfma_f32_16x16x32_bf16 a[8:11], a[168:171], v[88:91], a[8:11]
v_exp_f32 v19, v19
v_mfma_f32_16x16x32_bf16 a[40:43], a[168:171], v[92:95], a[40:43]
v_cvt_pk_bf16_f32 v77, v18, v19
v_mfma_f32_16x16x32_bf16 a[72:75], a[168:171], v[96:99], a[72:75]
v_exp_f32 v20, v20
v_mfma_f32_16x16x32_bf16 a[104:107], a[168:171], v[100:103], a[104:107]
ds_read_b64_tr_b16 a[168:169], v222 offset:0
ds_read_b64_tr_b16 a[170:171], v222 offset:4096
v_mfma_f32_16x16x32_bf16 v[64:67], a[128:131], v[200:203], v[148:151]
s_add_u32 m0, s3, 8192
v_exp_f32 v21, v21
v_mfma_f32_16x16x32_bf16 v[64:67], a[132:135], v[204:207], v[64:67]
s_add_u32 s46, s50, 1179648
buffer_load_dwordx4 v238, s[56:59], s46 offen lds
v_mfma_f32_16x16x32_bf16 v[64:67], a[136:139], v[208:211], v[64:67]
v_exp_f32 v22, v22
v_mfma_f32_16x16x32_bf16 v[64:67], a[140:143], v[212:215], v[64:67]
ds_read_b128 a[128:131], v216 offset:49152
ds_read_b128 a[132:135], v217 offset:49152
v_mfma_f32_16x16x32_bf16 a[12:15], a[172:175], v[88:91], a[12:15]
v_exp_f32 v23, v23
v_mfma_f32_16x16x32_bf16 a[44:47], a[172:175], v[92:95], a[44:47]
ds_read_b128 a[136:139], v218 offset:49152
ds_read_b128 a[140:143], v219 offset:49152
v_mfma_f32_16x16x32_bf16 a[76:79], a[172:175], v[96:99], a[76:79]
v_exp_f32 v24, v24
v_mfma_f32_16x16x32_bf16 a[108:111], a[172:175], v[100:103], a[108:111]
v_exp_f32 v25, v25
v_mfma_f32_16x16x32_bf16 v[44:47], a[144:147], v[152:155], v[136:139]
ds_read_b64_tr_b16 a[172:173], v223 offset:0
ds_read_b64_tr_b16 a[174:175], v223 offset:4096
v_mfma_f32_16x16x32_bf16 v[44:47], a[148:151], v[156:159], v[44:47]
v_exp_f32 v26, v26
v_mfma_f32_16x16x32_bf16 v[44:47], a[152:155], v[160:163], v[44:47]
s_add_u32 m0, s3, 12288
v_cvt_pk_bf16_f32 v78, v20, v21
v_cvt_pk_bf16_f32 v79, v22, v23
v_mfma_f32_16x16x32_bf16 v[44:47], a[156:159], v[164:167], v[44:47]
s_add_u32 s46, s50, 1769472
v_exp_f32 v27, v27
v_mfma_f32_16x16x32_bf16 a[16:19], a[176:179], v[88:91], a[16:19]
buffer_load_dwordx4 v238, s[56:59], s46 offen lds
v_mfma_f32_16x16x32_bf16 a[48:51], a[176:179], v[92:95], a[48:51]
v_exp_f32 v28, v28
v_mfma_f32_16x16x32_bf16 a[80:83], a[176:179], v[96:99], a[80:83]
v_cvt_pk_bf16_f32 v80, v24, v25
v_cvt_pk_bf16_f32 v81, v26, v27
v_mfma_f32_16x16x32_bf16 a[112:115], a[176:179], v[100:103], a[112:115]
v_exp_f32 v29, v29
v_mfma_f32_16x16x32_bf16 v[52:55], a[144:147], v[168:171], v[140:143]
ds_read_b64_tr_b16 a[176:177], v224 offset:0
ds_read_b64_tr_b16 a[178:179], v224 offset:4096
v_mfma_f32_16x16x32_bf16 v[52:55], a[148:151], v[172:175], v[52:55]
v_exp_f32 v30, v30
v_mfma_f32_16x16x32_bf16 v[52:55], a[152:155], v[176:179], v[52:55]
v_cvt_pk_bf16_f32 v82, v28, v29
v_mfma_f32_16x16x32_bf16 v[52:55], a[156:159], v[180:183], v[52:55]
s_add_u32 m0, s3, 16384
v_exp_f32 v31, v31
v_mfma_f32_16x16x32_bf16 a[20:23], a[180:183], v[88:91], a[20:23]
s_add_u32 s46, s50, 2359296
buffer_load_dwordx4 v238, s[56:59], s46 offen lds
v_mfma_f32_16x16x32_bf16 a[52:55], a[180:183], v[92:95], a[52:55]
v_exp_f32 v32, v32
v_mfma_f32_16x16x32_bf16 a[84:87], a[180:183], v[96:99], a[84:87]
v_cvt_pk_bf16_f32 v83, v30, v31
v_mfma_f32_16x16x32_bf16 a[116:119], a[180:183], v[100:103], a[116:119]
v_exp_f32 v33, v33
v_smfmac_f32_16x16x64_bf16 a[252:255], a[208:211], v[96:103], v235
ds_read_b64_tr_b16 a[180:181], v225 offset:0
ds_read_b64_tr_b16 a[182:183], v225 offset:4096
v_mfma_f32_16x16x32_bf16 v[60:63], a[144:147], v[184:187], v[144:147]
v_exp_f32 v34, v34
v_mfma_f32_16x16x32_bf16 v[60:63], a[148:151], v[188:191], v[60:63]
v_cvt_pk_bf16_f32 v84, v32, v33
v_mfma_f32_16x16x32_bf16 v[60:63], a[152:155], v[192:195], v[60:63]
v_exp_f32 v35, v35
v_mfma_f32_16x16x32_bf16 v[60:63], a[156:159], v[196:199], v[60:63]
s_add_u32 m0, s3, 20480
v_cvt_pk_bf16_f32 v85, v34, v35
v_mfma_f32_16x16x32_bf16 a[24:27], a[184:187], v[88:91], a[24:27]
s_add_u32 s46, s50, 2949120
v_exp_f32 v36, v36
v_mfma_f32_16x16x32_bf16 a[56:59], a[184:187], v[92:95], a[56:59]
buffer_load_dwordx4 v238, s[56:59], s46 offen lds
v_mfma_f32_16x16x32_bf16 a[88:91], a[184:187], v[96:99], a[88:91]
v_exp_f32 v37, v37
v_mfma_f32_16x16x32_bf16 a[120:123], a[184:187], v[100:103], a[120:123]
ds_read_b64_tr_b16 a[184:185], v226 offset:0
ds_read_b64_tr_b16 a[186:187], v226 offset:4096
v_mfma_f32_16x16x32_bf16 v[68:71], a[144:147], v[200:203], v[148:151]
v_exp_f32 v38, v38
v_mfma_f32_16x16x32_bf16 v[68:71], a[148:151], v[204:207], v[68:71]
ds_read_b128 a[144:147], v216 offset:53248
ds_read_b128 a[148:151], v217 offset:53248
v_mfma_f32_16x16x32_bf16 v[68:71], a[152:155], v[208:211], v[68:71]
v_exp_f32 v39, v39
v_mfma_f32_16x16x32_bf16 v[68:71], a[156:159], v[212:215], v[68:71]
ds_read_b128 a[152:155], v218 offset:53248
ds_read_b128 a[156:159], v219 offset:53248
v_mfma_f32_16x16x32_bf16 a[28:31], a[188:191], v[88:91], a[28:31]
v_cvt_pk_bf16_f32 v86, v36, v37
v_cvt_pk_bf16_f32 v87, v38, v39
v_mfma_f32_16x16x32_bf16 a[60:63], a[188:191], v[92:95], a[60:63]
v_mfma_f32_16x16x32_bf16 a[92:95], a[188:191], v[96:99], a[92:95]
v_mfma_f32_16x16x32_bf16 a[124:127], a[188:191], v[100:103], a[124:127]
s_waitcnt lgkmcnt(6)
ds_read_b64_tr_b16 a[188:189], v227 offset:0
ds_read_b64_tr_b16 a[190:191], v227 offset:4096
v_mfma_f32_16x16x32_bf16 v[8:11], a[128:131], v[152:155], v[136:139]
v_exp_f32 v40, v40
v_mfma_f32_16x16x32_bf16 v[8:11], a[132:135], v[156:159], v[8:11]
s_add_u32 m0, s3, 24576
v_exp_f32 v41, v41
v_mfma_f32_16x16x32_bf16 v[8:11], a[136:139], v[160:163], v[8:11]
s_add_u32 s46, s50, 3538944
buffer_load_dwordx4 v238, s[56:59], s46 offen lds
v_mfma_f32_16x16x32_bf16 v[8:11], a[140:143], v[164:167], v[8:11]
v_exp_f32 v42, v42
v_mfma_f32_16x16x32_bf16 a[0:3], a[160:163], v[72:75], a[0:3]
v_cvt_pk_bf16_f32 v88, v40, v41
v_mfma_f32_16x16x32_bf16 a[32:35], a[160:163], v[76:79], a[32:35]
v_exp_f32 v43, v43
v_mfma_f32_16x16x32_bf16 a[64:67], a[160:163], v[80:83], a[64:67]
v_cvt_pk_bf16_f32 v89, v42, v43
v_mfma_f32_16x16x32_bf16 a[96:99], a[160:163], v[84:87], a[96:99]
v_exp_f32 v44, v44
v_mfma_f32_16x16x32_bf16 v[16:19], a[128:131], v[168:171], v[140:143]
ds_read_b64_tr_b16 a[160:161], v220 offset:8192
ds_read_b64_tr_b16 a[162:163], v220 offset:12288
v_mfma_f32_16x16x32_bf16 v[16:19], a[132:135], v[172:175], v[16:19]
v_exp_f32 v45, v45
v_mfma_f32_16x16x32_bf16 v[16:19], a[136:139], v[176:179], v[16:19]
v_cvt_pk_bf16_f32 v90, v44, v45
v_mfma_f32_16x16x32_bf16 v[16:19], a[140:143], v[180:183], v[16:19]
s_add_u32 m0, s3, 28672
v_exp_f32 v46, v46
v_mfma_f32_16x16x32_bf16 a[4:7], a[164:167], v[72:75], a[4:7]
s_add_u32 s46, s50, 4128768
buffer_load_dwordx4 v238, s[56:59], s46 offen lds
v_mfma_f32_16x16x32_bf16 a[36:39], a[164:167], v[76:79], a[36:39]
v_exp_f32 v47, v47
v_mfma_f32_16x16x32_bf16 a[68:71], a[164:167], v[80:83], a[68:71]
v_cvt_pk_bf16_f32 v91, v46, v47
v_mfma_f32_16x16x32_bf16 a[100:103], a[164:167], v[84:87], a[100:103]
v_exp_f32 v48, v48
v_smfmac_f32_16x16x64_bf16 a[248:251], a[208:211], v[72:79], v235
ds_read_b64_tr_b16 a[164:165], v221 offset:8192
ds_read_b64_tr_b16 a[166:167], v221 offset:12288
v_mfma_f32_16x16x32_bf16 v[24:27], a[128:131], v[184:187], v[144:147]
v_exp_f32 v49, v49
v_mfma_f32_16x16x32_bf16 v[24:27], a[132:135], v[188:191], v[24:27]
v_cvt_pk_bf16_f32 v92, v48, v49
v_mfma_f32_16x16x32_bf16 v[24:27], a[136:139], v[192:195], v[24:27]
v_exp_f32 v50, v50
v_mfma_f32_16x16x32_bf16 v[24:27], a[140:143], v[196:199], v[24:27]
v_mfma_f32_16x16x32_bf16 a[8:11], a[168:171], v[72:75], a[8:11]
s_add_u32 m0, s3, 32768
v_exp_f32 v51, v51
v_mfma_f32_16x16x32_bf16 a[40:43], a[168:171], v[76:79], a[40:43]
s_add_u32 s46, s50, 4718592
buffer_load_dwordx4 v238, s[56:59], s46 offen lds
v_mfma_f32_16x16x32_bf16 a[72:75], a[168:171], v[80:83], a[72:75]
v_exp_f32 v52, v52
v_mfma_f32_16x16x32_bf16 a[104:107], a[168:171], v[84:87], a[104:107]
ds_read_b64_tr_b16 a[168:169], v222 offset:8192
ds_read_b64_tr_b16 a[170:171], v222 offset:12288
v_mfma_f32_16x16x32_bf16 v[32:35], a[128:131], v[200:203], v[148:151]
v_exp_f32 v53, v53
v_mfma_f32_16x16x32_bf16 v[32:35], a[132:135], v[204:207], v[32:35]
ds_read_b128 a[128:131], v216 offset:57344
ds_read_b128 a[132:135], v217 offset:57344
v_mfma_f32_16x16x32_bf16 v[32:35], a[136:139], v[208:211], v[32:35]
v_exp_f32 v54, v54
v_mfma_f32_16x16x32_bf16 v[32:35], a[140:143], v[212:215], v[32:35]
ds_read_b128 a[136:139], v218 offset:57344
ds_read_b128 a[140:143], v219 offset:57344
v_mfma_f32_16x16x32_bf16 a[12:15], a[172:175], v[72:75], a[12:15]
v_exp_f32 v55, v55
v_mfma_f32_16x16x32_bf16 a[44:47], a[172:175], v[76:79], a[44:47]
v_cvt_pk_bf16_f32 v93, v50, v51
v_cvt_pk_bf16_f32 v94, v52, v53
v_mfma_f32_16x16x32_bf16 a[76:79], a[172:175], v[80:83], a[76:79]
s_waitcnt lgkmcnt(6)
v_exp_f32 v56, v56
v_mfma_f32_16x16x32_bf16 a[108:111], a[172:175], v[84:87], a[108:111]
s_add_u32 m0, s3, 125952
v_exp_f32 v57, v57
v_mfma_f32_16x16x32_bf16 v[12:15], a[144:147], v[152:155], v[136:139]
buffer_load_dwordx4 v238, s[60:63], s46 offen lds
v_mfma_f32_16x16x32_bf16 v[12:15], a[148:151], v[156:159], v[12:15]
v_exp_f32 v58, v58
v_mfma_f32_16x16x32_bf16 v[12:15], a[152:155], v[160:163], v[12:15]
ds_read_b64_tr_b16 a[172:173], v223 offset:8192
ds_read_b64_tr_b16 a[174:175], v223 offset:12288
v_mfma_f32_16x16x32_bf16 v[12:15], a[156:159], v[164:167], v[12:15]
v_exp_f32 v59, v59
v_mfma_f32_16x16x32_bf16 a[16:19], a[176:179], v[72:75], a[16:19]
v_cvt_pk_bf16_f32 v95, v54, v55
v_cvt_pk_bf16_f32 v96, v56, v57
v_mfma_f32_16x16x32_bf16 a[48:51], a[176:179], v[76:79], a[48:51]
v_exp_f32 v60, v60
v_mfma_f32_16x16x32_bf16 a[80:83], a[176:179], v[80:83], a[80:83]
v_cvt_pk_bf16_f32 v97, v58, v59
v_mfma_f32_16x16x32_bf16 a[112:115], a[176:179], v[84:87], a[112:115]
v_exp_f32 v61, v61
v_mfma_f32_16x16x32_bf16 v[20:23], a[144:147], v[168:171], v[140:143]
ds_read_b64_tr_b16 a[176:177], v224 offset:8192
ds_read_b64_tr_b16 a[178:179], v224 offset:12288
v_mfma_f32_16x16x32_bf16 v[20:23], a[148:151], v[172:175], v[20:23]
s_add_u32 m0, s43, 0
v_exp_f32 v62, v62
v_mfma_f32_16x16x32_bf16 v[20:23], a[152:155], v[176:179], v[20:23]
s_add_u32 s46, s42, 0
buffer_load_dwordx4 v234, s[64:67], s46 offen offset:0 lds
v_mfma_f32_16x16x32_bf16 v[20:23], a[156:159], v[180:183], v[20:23]
v_exp_f32 v63, v63
v_mfma_f32_16x16x32_bf16 a[20:23], a[180:183], v[72:75], a[20:23]
v_cvt_pk_bf16_f32 v98, v60, v61
v_cvt_pk_bf16_f32 v99, v62, v63
v_mfma_f32_16x16x32_bf16 a[52:55], a[180:183], v[76:79], a[52:55]
v_exp_f32 v64, v64
v_mfma_f32_16x16x32_bf16 a[84:87], a[180:183], v[80:83], a[84:87]
v_mfma_f32_16x16x32_bf16 a[116:119], a[180:183], v[84:87], a[116:119]
v_exp_f32 v65, v65
v_smfmac_f32_16x16x64_bf16 a[252:255], a[208:211], v[80:87], v235
ds_read_b64_tr_b16 a[180:181], v225 offset:8192
ds_read_b64_tr_b16 a[182:183], v225 offset:12288
v_mfma_f32_16x16x32_bf16 v[28:31], a[144:147], v[184:187], v[144:147]
v_exp_f32 v66, v66
v_mfma_f32_16x16x32_bf16 v[28:31], a[148:151], v[188:191], v[28:31]
v_cvt_pk_bf16_f32 v100, v64, v65
v_mfma_f32_16x16x32_bf16 v[28:31], a[152:155], v[192:195], v[28:31]
v_exp_f32 v67, v67
v_mfma_f32_16x16x32_bf16 v[28:31], a[156:159], v[196:199], v[28:31]
buffer_load_dwordx4 v234, s[64:67], s46 offen offset:1024 lds
v_mfma_f32_16x16x32_bf16 a[24:27], a[184:187], v[72:75], a[24:27]
v_exp_f32 v68, v68
v_mfma_f32_16x16x32_bf16 a[56:59], a[184:187], v[76:79], a[56:59]
v_cvt_pk_bf16_f32 v101, v66, v67
v_mfma_f32_16x16x32_bf16 a[88:91], a[184:187], v[80:83], a[88:91]
v_exp_f32 v69, v69
v_mfma_f32_16x16x32_bf16 a[120:123], a[184:187], v[84:87], a[120:123]
ds_read_b64_tr_b16 a[184:185], v226 offset:8192
ds_read_b64_tr_b16 a[186:187], v226 offset:12288
v_mfma_f32_16x16x32_bf16 v[36:39], a[144:147], v[200:203], v[148:151]
v_exp_f32 v70, v70
v_mfma_f32_16x16x32_bf16 v[36:39], a[148:151], v[204:207], v[36:39]
ds_read_b128 a[144:147], v216 offset:61440
ds_read_b128 a[148:151], v217 offset:61440
v_mfma_f32_16x16x32_bf16 v[36:39], a[152:155], v[208:211], v[36:39]
v_exp_f32 v71, v71
v_mfma_f32_16x16x32_bf16 v[36:39], a[156:159], v[212:215], v[36:39]
ds_read_b128 a[152:155], v218 offset:61440
ds_read_b128 a[156:159], v219 offset:61440
v_mfma_f32_16x16x32_bf16 a[28:31], a[188:191], v[72:75], a[28:31]
v_cvt_pk_bf16_f32 v102, v68, v69
v_cvt_pk_bf16_f32 v103, v70, v71
v_mfma_f32_16x16x32_bf16 a[60:63], a[188:191], v[76:79], a[60:63]
v_mfma_f32_16x16x32_bf16 a[92:95], a[188:191], v[80:83], a[92:95]
v_mfma_f32_16x16x32_bf16 a[124:127], a[188:191], v[84:87], a[124:127]
s_waitcnt lgkmcnt(6)
ds_read_b64_tr_b16 a[188:189], v227 offset:8192
ds_read_b64_tr_b16 a[190:191], v227 offset:12288
v_mfma_f32_16x16x32_bf16 v[40:43], a[128:131], v[152:155], v[136:139]
v_exp_f32 v8, v8
v_mfma_f32_16x16x32_bf16 v[40:43], a[132:135], v[156:159], v[40:43]
v_exp_f32 v9, v9
v_mfma_f32_16x16x32_bf16 v[40:43], a[136:139], v[160:163], v[40:43]
buffer_load_dwordx4 v234, s[64:67], s46 offen offset:2048 lds
v_mfma_f32_16x16x32_bf16 v[40:43], a[140:143], v[164:167], v[40:43]
v_exp_f32 v10, v10
v_mfma_f32_16x16x32_bf16 a[0:3], a[160:163], v[88:91], a[0:3]
v_cvt_pk_bf16_f32 v72, v8, v9
v_mfma_f32_16x16x32_bf16 a[32:35], a[160:163], v[92:95], a[32:35]
v_exp_f32 v11, v11
v_mfma_f32_16x16x32_bf16 a[64:67], a[160:163], v[96:99], a[64:67]
v_cvt_pk_bf16_f32 v73, v10, v11
v_mfma_f32_16x16x32_bf16 a[96:99], a[160:163], v[100:103], a[96:99]
v_exp_f32 v12, v12
v_mfma_f32_16x16x32_bf16 v[48:51], a[128:131], v[168:171], v[140:143]
ds_read_b64_tr_b16 a[160:161], v220 offset:16384
ds_read_b64_tr_b16 a[162:163], v220 offset:20480
v_mfma_f32_16x16x32_bf16 v[48:51], a[132:135], v[172:175], v[48:51]
v_exp_f32 v13, v13
v_mfma_f32_16x16x32_bf16 v[48:51], a[136:139], v[176:179], v[48:51]
buffer_load_dwordx4 v234, s[64:67], s46 offen offset:3072 lds
v_mfma_f32_16x16x32_bf16 v[48:51], a[140:143], v[180:183], v[48:51]
v_exp_f32 v14, v14
v_mfma_f32_16x16x32_bf16 a[4:7], a[164:167], v[88:91], a[4:7]
v_cvt_pk_bf16_f32 v74, v12, v13
v_mfma_f32_16x16x32_bf16 a[36:39], a[164:167], v[92:95], a[36:39]
v_exp_f32 v15, v15
v_mfma_f32_16x16x32_bf16 a[68:71], a[164:167], v[96:99], a[68:71]
v_cvt_pk_bf16_f32 v75, v14, v15
v_mfma_f32_16x16x32_bf16 a[100:103], a[164:167], v[100:103], a[100:103]
v_exp_f32 v16, v16
v_smfmac_f32_16x16x64_bf16 a[248:251], a[208:211], v[88:95], v235
ds_read_b64_tr_b16 a[164:165], v221 offset:16384
ds_read_b64_tr_b16 a[166:167], v221 offset:20480
v_mfma_f32_16x16x32_bf16 v[56:59], a[128:131], v[184:187], v[144:147]
v_exp_f32 v17, v17
v_mfma_f32_16x16x32_bf16 v[56:59], a[132:135], v[188:191], v[56:59]
s_add_u32 m0, s43, 4096
v_cvt_pk_bf16_f32 v76, v16, v17
v_mfma_f32_16x16x32_bf16 v[56:59], a[136:139], v[192:195], v[56:59]
s_add_u32 s46, s42, 4096
v_exp_f32 v18, v18
v_mfma_f32_16x16x32_bf16 v[56:59], a[140:143], v[196:199], v[56:59]
buffer_load_dwordx4 v234, s[64:67], s46 offen offset:0 lds
v_mfma_f32_16x16x32_bf16 a[8:11], a[168:171], v[88:91], a[8:11]
v_exp_f32 v19, v19
v_mfma_f32_16x16x32_bf16 a[40:43], a[168:171], v[92:95], a[40:43]
v_cvt_pk_bf16_f32 v77, v18, v19
v_mfma_f32_16x16x32_bf16 a[72:75], a[168:171], v[96:99], a[72:75]
v_exp_f32 v20, v20
v_mfma_f32_16x16x32_bf16 a[104:107], a[168:171], v[100:103], a[104:107]
ds_read_b64_tr_b16 a[168:169], v222 offset:16384
ds_read_b64_tr_b16 a[170:171], v222 offset:20480
v_mfma_f32_16x16x32_bf16 v[64:67], a[128:131], v[200:203], v[148:151]
v_exp_f32 v21, v21
v_mfma_f32_16x16x32_bf16 v[64:67], a[132:135], v[204:207], v[64:67]
v_cvt_pk_bf16_f32 v78, v20, v21
v_mfma_f32_16x16x32_bf16 v[64:67], a[136:139], v[208:211], v[64:67]
v_exp_f32 v22, v22
v_mfma_f32_16x16x32_bf16 v[64:67], a[140:143], v[212:215], v[64:67]
buffer_load_dwordx4 v234, s[64:67], s46 offen offset:1024 lds
v_mfma_f32_16x16x32_bf16 a[12:15], a[172:175], v[88:91], a[12:15]
v_exp_f32 v23, v23
v_mfma_f32_16x16x32_bf16 a[44:47], a[172:175], v[92:95], a[44:47]
v_cvt_pk_bf16_f32 v79, v22, v23
v_mfma_f32_16x16x32_bf16 a[76:79], a[172:175], v[96:99], a[76:79]
v_exp_f32 v24, v24
v_mfma_f32_16x16x32_bf16 a[108:111], a[172:175], v[100:103], a[108:111]
s_waitcnt lgkmcnt(6)
v_exp_f32 v25, v25
v_mfma_f32_16x16x32_bf16 v[44:47], a[144:147], v[152:155], v[136:139]
ds_read_b64_tr_b16 a[172:173], v223 offset:16384
ds_read_b64_tr_b16 a[174:175], v223 offset:20480
v_mfma_f32_16x16x32_bf16 v[44:47], a[148:151], v[156:159], v[44:47]
v_exp_f32 v26, v26
v_mfma_f32_16x16x32_bf16 v[44:47], a[152:155], v[160:163], v[44:47]
v_cvt_pk_bf16_f32 v80, v24, v25
v_mfma_f32_16x16x32_bf16 v[44:47], a[156:159], v[164:167], v[44:47]
v_exp_f32 v27, v27
v_mfma_f32_16x16x32_bf16 a[16:19], a[176:179], v[88:91], a[16:19]
buffer_load_dwordx4 v234, s[64:67], s46 offen offset:2048 lds
v_mfma_f32_16x16x32_bf16 a[48:51], a[176:179], v[92:95], a[48:51]
v_exp_f32 v28, v28
v_mfma_f32_16x16x32_bf16 a[80:83], a[176:179], v[96:99], a[80:83]
v_cvt_pk_bf16_f32 v81, v26, v27
v_mfma_f32_16x16x32_bf16 a[112:115], a[176:179], v[100:103], a[112:115]
v_exp_f32 v29, v29
v_mfma_f32_16x16x32_bf16 v[52:55], a[144:147], v[168:171], v[140:143]
ds_read_b64_tr_b16 a[176:177], v224 offset:16384
ds_read_b64_tr_b16 a[178:179], v224 offset:20480
v_mfma_f32_16x16x32_bf16 v[52:55], a[148:151], v[172:175], v[52:55]
v_exp_f32 v30, v30
v_mfma_f32_16x16x32_bf16 v[52:55], a[152:155], v[176:179], v[52:55]
v_cvt_pk_bf16_f32 v82, v28, v29
v_mfma_f32_16x16x32_bf16 v[52:55], a[156:159], v[180:183], v[52:55]
v_exp_f32 v31, v31
v_mfma_f32_16x16x32_bf16 a[20:23], a[180:183], v[88:91], a[20:23]
buffer_load_dwordx4 v234, s[64:67], s46 offen offset:3072 lds
v_mfma_f32_16x16x32_bf16 a[52:55], a[180:183], v[92:95], a[52:55]
v_exp_f32 v32, v32
v_mfma_f32_16x16x32_bf16 a[84:87], a[180:183], v[96:99], a[84:87]
v_cvt_pk_bf16_f32 v83, v30, v31
v_mfma_f32_16x16x32_bf16 a[116:119], a[180:183], v[100:103], a[116:119]
v_exp_f32 v33, v33
v_smfmac_f32_16x16x64_bf16 a[252:255], a[208:211], v[96:103], v235
ds_read_b64_tr_b16 a[180:181], v225 offset:16384
ds_read_b64_tr_b16 a[182:183], v225 offset:20480
v_mfma_f32_16x16x32_bf16 v[60:63], a[144:147], v[184:187], v[144:147]
v_exp_f32 v34, v34
v_mfma_f32_16x16x32_bf16 v[60:63], a[148:151], v[188:191], v[60:63]
v_cvt_pk_bf16_f32 v84, v32, v33
v_mfma_f32_16x16x32_bf16 v[60:63], a[152:155], v[192:195], v[60:63]
v_exp_f32 v35, v35
v_mfma_f32_16x16x32_bf16 v[60:63], a[156:159], v[196:199], v[60:63]
v_cvt_pk_bf16_f32 v85, v34, v35
v_mfma_f32_16x16x32_bf16 a[24:27], a[184:187], v[88:91], a[24:27]
s_add_u32 m0, s43, 8192
v_exp_f32 v36, v36
v_mfma_f32_16x16x32_bf16 a[56:59], a[184:187], v[92:95], a[56:59]
s_add_u32 s46, s42, 8192
buffer_load_dwordx4 v234, s[64:67], s46 offen offset:0 lds
v_mfma_f32_16x16x32_bf16 a[88:91], a[184:187], v[96:99], a[88:91]
v_exp_f32 v37, v37
v_mfma_f32_16x16x32_bf16 a[120:123], a[184:187], v[100:103], a[120:123]
ds_read_b64_tr_b16 a[184:185], v226 offset:16384
ds_read_b64_tr_b16 a[186:187], v226 offset:20480
v_mfma_f32_16x16x32_bf16 v[68:71], a[144:147], v[200:203], v[148:151]
v_exp_f32 v38, v38
v_mfma_f32_16x16x32_bf16 v[68:71], a[148:151], v[204:207], v[68:71]
v_cvt_pk_bf16_f32 v86, v36, v37
v_mfma_f32_16x16x32_bf16 v[68:71], a[152:155], v[208:211], v[68:71]
v_exp_f32 v39, v39
v_mfma_f32_16x16x32_bf16 v[68:71], a[156:159], v[212:215], v[68:71]
v_cvt_pk_bf16_f32 v87, v38, v39
v_mfma_f32_16x16x32_bf16 a[28:31], a[188:191], v[88:91], a[28:31]
v_mfma_f32_16x16x32_bf16 a[60:63], a[188:191], v[92:95], a[60:63]
v_mfma_f32_16x16x32_bf16 a[92:95], a[188:191], v[96:99], a[92:95]
v_mfma_f32_16x16x32_bf16 a[124:127], a[188:191], v[100:103], a[124:127]
ds_read_b64_tr_b16 a[188:189], v227 offset:16384
ds_read_b64_tr_b16 a[190:191], v227 offset:20480
K_LAST3:
s_waitcnt lgkmcnt(6)
v_mfma_f32_16x16x32_bf16 a[0:3], a[160:163], v[72:75], a[0:3]
v_exp_f32 v40, v40
v_exp_f32 v41, v41
v_mfma_f32_16x16x32_bf16 a[32:35], a[160:163], v[76:79], a[32:35]
v_cvt_pk_bf16_f32 v88, v40, v41
v_exp_f32 v42, v42
v_mfma_f32_16x16x32_bf16 a[64:67], a[160:163], v[80:83], a[64:67]
v_exp_f32 v43, v43
v_mfma_f32_16x16x32_bf16 a[96:99], a[160:163], v[84:87], a[96:99]
ds_read_b64_tr_b16 a[160:161], v220 offset:24576
ds_read_b64_tr_b16 a[162:163], v220 offset:28672
v_exp_f32 v44, v44
v_mfma_f32_16x16x32_bf16 a[4:7], a[164:167], v[72:75], a[4:7]
v_cvt_pk_bf16_f32 v89, v42, v43
v_exp_f32 v45, v45
v_mfma_f32_16x16x32_bf16 a[36:39], a[164:167], v[76:79], a[36:39]
v_cvt_pk_bf16_f32 v90, v44, v45
v_exp_f32 v46, v46
v_mfma_f32_16x16x32_bf16 a[68:71], a[164:167], v[80:83], a[68:71]
v_exp_f32 v47, v47
v_mfma_f32_16x16x32_bf16 a[100:103], a[164:167], v[84:87], a[100:103]
ds_read_b64_tr_b16 a[164:165], v221 offset:24576
ds_read_b64_tr_b16 a[166:167], v221 offset:28672
v_exp_f32 v48, v48
v_smfmac_f32_16x16x64_bf16 a[248:251], a[208:211], v[72:79], v235
v_cvt_pk_bf16_f32 v91, v46, v47
v_exp_f32 v49, v49
v_mfma_f32_16x16x32_bf16 a[8:11], a[168:171], v[72:75], a[8:11]
v_cvt_pk_bf16_f32 v92, v48, v49
v_exp_f32 v50, v50
v_mfma_f32_16x16x32_bf16 a[40:43], a[168:171], v[76:79], a[40:43]
v_exp_f32 v51, v51
v_mfma_f32_16x16x32_bf16 a[72:75], a[168:171], v[80:83], a[72:75]
v_cvt_pk_bf16_f32 v93, v50, v51
v_exp_f32 v52, v52
v_mfma_f32_16x16x32_bf16 a[104:107], a[168:171], v[84:87], a[104:107]
ds_read_b64_tr_b16 a[168:169], v222 offset:24576
ds_read_b64_tr_b16 a[170:171], v222 offset:28672
v_exp_f32 v53, v53
v_mfma_f32_16x16x32_bf16 a[12:15], a[172:175], v[72:75], a[12:15]
v_cvt_pk_bf16_f32 v94, v52, v53
v_exp_f32 v54, v54
v_mfma_f32_16x16x32_bf16 a[44:47], a[172:175], v[76:79], a[44:47]
v_exp_f32 v55, v55
v_mfma_f32_16x16x32_bf16 a[76:79], a[172:175], v[80:83], a[76:79]
v_exp_f32 v56, v56
v_exp_f32 v57, v57
v_mfma_f32_16x16x32_bf16 a[108:111], a[172:175], v[84:87], a[108:111]
ds_read_b64_tr_b16 a[172:173], v223 offset:24576
ds_read_b64_tr_b16 a[174:175], v223 offset:28672
v_exp_f32 v58, v58
v_mfma_f32_16x16x32_bf16 a[16:19], a[176:179], v[72:75], a[16:19]
v_cvt_pk_bf16_f32 v95, v54, v55
v_cvt_pk_bf16_f32 v96, v56, v57
v_exp_f32 v59, v59
v_mfma_f32_16x16x32_bf16 a[48:51], a[176:179], v[76:79], a[48:51]
v_cvt_pk_bf16_f32 v97, v58, v59
v_exp_f32 v60, v60
v_mfma_f32_16x16x32_bf16 a[80:83], a[176:179], v[80:83], a[80:83]
v_exp_f32 v61, v61
v_mfma_f32_16x16x32_bf16 a[112:115], a[176:179], v[84:87], a[112:115]
s_waitcnt lgkmcnt(6)
ds_read_b64_tr_b16 a[176:177], v224 offset:24576
ds_read_b64_tr_b16 a[178:179], v224 offset:28672
v_exp_f32 v62, v62
v_mfma_f32_16x16x32_bf16 a[20:23], a[180:183], v[72:75], a[20:23]
v_cvt_pk_bf16_f32 v98, v60, v61
v_exp_f32 v63, v63
v_mfma_f32_16x16x32_bf16 a[52:55], a[180:183], v[76:79], a[52:55]
v_cvt_pk_bf16_f32 v99, v62, v63
v_exp_f32 v64, v64
v_mfma_f32_16x16x32_bf16 a[84:87], a[180:183], v[80:83], a[84:87]
v_exp_f32 v65, v65
v_mfma_f32_16x16x32_bf16 a[116:119], a[180:183], v[84:87], a[116:119]
ds_read_b64_tr_b16 a[180:181], v225 offset:24576
ds_read_b64_tr_b16 a[182:183], v225 offset:28672
v_exp_f32 v66, v66
v_smfmac_f32_16x16x64_bf16 a[252:255], a[208:211], v[80:87], v235
v_cvt_pk_bf16_f32 v100, v64, v65
v_exp_f32 v67, v67
v_mfma_f32_16x16x32_bf16 a[24:27], a[184:187], v[72:75], a[24:27]
v_cvt_pk_bf16_f32 v101, v66, v67
v_exp_f32 v68, v68
v_mfma_f32_16x16x32_bf16 a[56:59], a[184:187], v[76:79], a[56:59]
v_exp_f32 v69, v69
v_mfma_f32_16x16x32_bf16 a[88:91], a[184:187], v[80:83], a[88:91]
v_cvt_pk_bf16_f32 v102, v68, v69
v_exp_f32 v70, v70
v_mfma_f32_16x16x32_bf16 a[120:123], a[184:187], v[84:87], a[120:123]
ds_read_b64_tr_b16 a[184:185], v226 offset:24576
ds_read_b64_tr_b16 a[186:187], v226 offset:28672
v_exp_f32 v71, v71
v_mfma_f32_16x16x32_bf16 a[28:31], a[188:191], v[72:75], a[28:31]
v_cvt_pk_bf16_f32 v103, v70, v71
v_mfma_f32_16x16x32_bf16 a[60:63], a[188:191], v[76:79], a[60:63]
v_mfma_f32_16x16x32_bf16 a[92:95], a[188:191], v[80:83], a[92:95]
v_mfma_f32_16x16x32_bf16 a[124:127], a[188:191], v[84:87], a[124:127]
ds_read_b64_tr_b16 a[188:189], v227 offset:24576
ds_read_b64_tr_b16 a[190:191], v227 offset:28672
v_smfmac_f32_16x16x64_bf16 a[248:251], a[208:211], v[88:95], v235
s_cmp_lg_u32 s52, 0
s_mov_b32 s46, 32768
v_smfmac_f32_16x16x64_bf16 a[252:255], a[208:211], v[96:103], v235
s_cselect_b32 s46, 46080, s46
s_cselect_b32 s47, 6, 10
v_mfma_f32_16x16x32_bf16 a[0:3], a[160:163], v[88:91], a[0:3]
v_and_b32 v146, 3, v1
v_lshlrev_b32 v146, s47, v146
s_waitcnt lgkmcnt(6)
v_mfma_f32_16x16x32_bf16 a[4:7], a[164:167], v[88:91], a[4:7]
s_lshl_b32 s47, s32, s47
s_add_u32 s47, s47, s46
v_mfma_f32_16x16x32_bf16 a[8:11], a[168:171], v[88:91], a[8:11]
s_nop 0
s_nop 0
v_mfma_f32_16x16x32_bf16 a[12:15], a[172:175], v[88:91], a[12:15]
v_accvgpr_read_b32 v136, a248
v_accvgpr_read_b32 v137, a249
v_mfma_f32_16x16x32_bf16 a[16:19], a[176:179], v[88:91], a[16:19]
v_accvgpr_read_b32 v138, a250
v_accvgpr_read_b32 v139, a251
s_waitcnt lgkmcnt(4)
v_mfma_f32_16x16x32_bf16 a[20:23], a[180:183], v[88:91], a[20:23]
v_accvgpr_read_b32 v140, a252
v_accvgpr_read_b32 v141, a253
s_waitcnt lgkmcnt(2)
v_mfma_f32_16x16x32_bf16 a[24:27], a[184:187], v[88:91], a[24:27]
v_accvgpr_read_b32 v142, a254
v_accvgpr_read_b32 v143, a255
s_waitcnt lgkmcnt(0)
v_mfma_f32_16x16x32_bf16 a[28:31], a[188:191], v[88:91], a[28:31]
v_add_f32 v136, v136, v137
v_add_f32 v138, v138, v139
v_mfma_f32_16x16x32_bf16 a[32:35], a[160:163], v[92:95], a[32:35]
v_add_f32 v140, v140, v141
v_add_f32 v142, v142, v143
v_mfma_f32_16x16x32_bf16 a[36:39], a[164:167], v[92:95], a[36:39]
v_max3_f32 v144, v136, v138, v140
v_add_f32 v145, v136, v138
v_mfma_f32_16x16x32_bf16 a[40:43], a[168:171], v[92:95], a[40:43]
v_max_f32 v144, v144, v142
v_add_f32 v145, v145, v140
v_mfma_f32_16x16x32_bf16 a[44:47], a[172:175], v[92:95], a[44:47]
v_cmp_nge_f32 vcc, 0x5f800000, v144
v_add_f32 v145, v145, v142
v_mfma_f32_16x16x32_bf16 a[48:51], a[176:179], v[92:95], a[48:51]
v_cmp_u_f32 s[94:95], v145, v145
v_mfma_f32_16x16x32_bf16 a[52:55], a[180:183], v[92:95], a[52:55]
v_mfma_f32_16x16x32_bf16 a[56:59], a[184:187], v[92:95], a[56:59]
v_mfma_f32_16x16x32_bf16 a[60:63], a[188:191], v[92:95], a[60:63]
s_or_b64 vcc, vcc, s[94:95]
s_cmp_lg_u64 vcc, 0
s_cselect_b32 s48, 1, 0
v_mov_b32 v144, s48
s_lshl_b32 s48, s32, 2
s_add_u32 s46, s46, s48
v_add_u32 v146, s46, v146
ds_write_b32 v146, v144
v_rcp_f32 v136, v136
v_rcp_f32 v138, v138
v_rcp_f32 v140, v140
v_rcp_f32 v142, v142
v_mov_b32 v145, s47
s_waitcnt vmcnt(0) lgkmcnt(0)
s_barrier
ds_read_b128 v[148:151], v145
v_mfma_f32_16x16x32_bf16 a[64:67], a[160:163], v[96:99], a[64:67]
s_add_u32 s46, s36, 1
s_and_b32 s46, s46, 3
v_accvgpr_read_b32 v40, a0
v_accvgpr_read_b32 v41, a1
v_mfma_f32_16x16x32_bf16 a[68:71], a[164:167], v[96:99], a[68:71]
s_mul_i32 s42, s46, 294912
s_add_u32 s42, s42, s84
v_accvgpr_read_b32 v42, a2
v_accvgpr_read_b32 v43, a3
v_mfma_f32_16x16x32_bf16 a[72:75], a[168:171], v[96:99], a[72:75]
s_sub_u32 s46, s46, s36
s_lshl_b32 s46, s46, 16
v_accvgpr_read_b32 v44, a4
v_accvgpr_read_b32 v45, a5
v_mfma_f32_16x16x32_bf16 a[76:79], a[172:175], v[96:99], a[76:79]
s_add_u32 s38, s53, s46
s_add_u32 s46, s36, 2
v_accvgpr_read_b32 v46, a6
v_accvgpr_read_b32 v47, a7
v_mfma_f32_16x16x32_bf16 a[80:83], a[176:179], v[96:99], a[80:83]
s_and_b32 s46, s46, 3
s_mul_i32 s43, s46, 294912
v_accvgpr_read_b32 v48, a8
v_accvgpr_read_b32 v49, a9
v_mfma_f32_16x16x32_bf16 a[84:87], a[180:183], v[96:99], a[84:87]
s_add_u32 s43, s43, s84
s_sub_u32 s46, s46, s36
v_accvgpr_read_b32 v50, a10
v_accvgpr_read_b32 v51, a11
v_mfma_f32_16x16x32_bf16 a[88:91], a[184:187], v[96:99], a[88:91]
s_lshl_b32 s46, s46, 16
s_add_u32 s39, s53, s46
v_accvgpr_read_b32 v52, a12
v_accvgpr_read_b32 v53, a13
v_mfma_f32_16x16x32_bf16 a[92:95], a[188:191], v[96:99], a[92:95]
s_add_u32 s46, s36, 3
s_and_b32 s46, s46, 3
v_accvgpr_read_b32 v54, a14
v_accvgpr_read_b32 v55, a15
v_mfma_f32_16x16x32_bf16 a[96:99], a[160:163], v[100:103], a[96:99]
s_mul_i32 s44, s46, 294912
s_add_u32 s44, s44, s84
v_accvgpr_read_b32 v56, a16
v_accvgpr_read_b32 v57, a17
v_mfma_f32_16x16x32_bf16 a[100:103], a[164:167], v[100:103], a[100:103]
s_sub_u32 s46, s46, s36
s_lshl_b32 s46, s46, 16
v_accvgpr_read_b32 v58, a18
v_accvgpr_read_b32 v59, a19
v_mfma_f32_16x16x32_bf16 a[104:107], a[168:171], v[100:103], a[104:107]
s_add_u32 s40, s53, s46
s_cmp_lg_u32 s52, 0
v_accvgpr_read_b32 v60, a20
v_accvgpr_read_b32 v61, a21
v_mfma_f32_16x16x32_bf16 a[108:111], a[172:175], v[100:103], a[108:111]
s_cselect_b32 s93, s51, s42
s_cselect_b32 s94, s80, s82
v_accvgpr_read_b32 v62, a22
v_accvgpr_read_b32 v63, a23
v_mfma_f32_16x16x32_bf16 a[112:115], a[176:179], v[100:103], a[112:115]
s_add_u32 s94, s94, s3
s_mov_b32 s95, 18432
v_accvgpr_read_b32 v64, a24
v_accvgpr_read_b32 v65, a25
v_mfma_f32_16x16x32_bf16 a[116:119], a[180:183], v[100:103], a[116:119]
v_accvgpr_read_b32 v66, a26
v_accvgpr_read_b32 v67, a27
v_mfma_f32_16x16x32_bf16 a[120:123], a[184:187], v[100:103], a[120:123]
v_accvgpr_read_b32 v68, a28
v_accvgpr_read_b32 v69, a29
v_mfma_f32_16x16x32_bf16 a[124:127], a[188:191], v[100:103], a[124:127]
v_accvgpr_read_b32 v70, a30
v_accvgpr_read_b32 v71, a31
s_waitcnt lgkmcnt(0)
v_or3_b32 v148, v148, v149, v150
v_or_b32 v148, v148, v151
v_cmp_ne_u32 vcc, s52, 0
v_readfirstlane_b32 s46, v148
s_andn2_b32 s46, s46, s41
s_cbranch_scc1 K_FB
v_cndmask_b32 v239, v236, v237, vcc
v_pk_mul_f32 v[40:41], v[40:41], v[136:137] op_sel_hi:[1,0]
v_pk_mul_f32 v[42:43], v[42:43], v[136:137] op_sel_hi:[1,0]
v_pk_mul_f32 v[44:45], v[44:45], v[136:137] op_sel_hi:[1,0]
v_pk_mul_f32 v[46:47], v[46:47], v[136:137] op_sel_hi:[1,0]
v_cvt_pk_bf16_f32 v8, v40, v41
v_cvt_pk_bf16_f32 v9, v42, v43
v_cvt_pk_bf16_f32 v10, v44, v45
v_cvt_pk_bf16_f32 v11, v46, v47
s_add_u32 s46, s53, 0
buffer_store_dwordx4 v[8:11], v234, s[20:23], s46 offen offset:0 sc0 sc1
s_mov_b32 m0, s94
s_add_u32 s94, s94, 4096
buffer_load_dwordx4 v236, s[16:19], s93 offen lds
s_add_u32 s93, s93, s95
v_pk_mul_f32 v[48:49], v[48:49], v[136:137] op_sel_hi:[1,0]
v_pk_mul_f32 v[50:51], v[50:51], v[136:137] op_sel_hi:[1,0]
v_pk_mul_f32 v[52:53], v[52:53], v[136:137] op_sel_hi:[1,0]
v_pk_mul_f32 v[54:55], v[54:55], v[136:137] op_sel_hi:[1,0]
v_cvt_pk_bf16_f32 v16, v48, v49
v_cvt_pk_bf16_f32 v17, v50, v51
v_cvt_pk_bf16_f32 v18, v52, v53
v_cvt_pk_bf16_f32 v19, v54, v55
buffer_store_dwordx4 v[16:19], v234, s[20:23], s46 offen offset:2048 sc0 sc1
s_mov_b32 m0, s94
s_add_u32 s94, s94, 4096
buffer_load_dwordx4 v236, s[16:19], s93 offen lds
s_add_u32 s93, s93, s95
v_pk_mul_f32 v[56:57], v[56:57], v[136:137] op_sel_hi:[1,0]
v_pk_mul_f32 v[58:59], v[58:59], v[136:137] op_sel_hi:[1,0]
v_pk_mul_f32 v[60:61], v[60:61], v[136:137] op_sel_hi:[1,0]
v_pk_mul_f32 v[62:63], v[62:63], v[136:137] op_sel_hi:[1,0]
v_cvt_pk_bf16_f32 v24, v56, v57
v_cvt_pk_bf16_f32 v25, v58, v59
v_cvt_pk_bf16_f32 v26, v60, v61
v_cvt_pk_bf16_f32 v27, v62, v63
s_add_u32 s46, s53, 4096
buffer_store_dwordx4 v[24:27], v234, s[20:23], s46 offen offset:0 sc0 sc1
s_mov_b32 m0, s94
s_add_u32 s94, s94, 4096
buffer_load_dwordx4 v236, s[16:19], s93 offen lds
s_add_u32 s93, s93, s95
v_pk_mul_f32 v[64:65], v[64:65], v[136:137] op_sel_hi:[1,0]
v_pk_mul_f32 v[66:67], v[66:67], v[136:137] op_sel_hi:[1,0]
v_pk_mul_f32 v[68:69], v[68:69], v[136:137] op_sel_hi:[1,0]
v_pk_mul_f32 v[70:71], v[70:71], v[136:137] op_sel_hi:[1,0]
v_cvt_pk_bf16_f32 v32, v64, v65
v_cvt_pk_bf16_f32 v33, v66, v67
v_cvt_pk_bf16_f32 v34, v68, v69
v_cvt_pk_bf16_f32 v35, v70, v71
buffer_store_dwordx4 v[32:35], v234, s[20:23], s46 offen offset:2048 sc0 sc1
s_mov_b32 m0, s94
s_add_u32 s94, s94, 4096
buffer_load_dwordx4 v236, s[16:19], s93 offen lds
s_add_u32 s93, s93, s95
v_accvgpr_read_b32 v72, a32
v_accvgpr_read_b32 v73, a33
v_accvgpr_read_b32 v74, a34
v_accvgpr_read_b32 v75, a35
v_accvgpr_read_b32 v76, a36
v_accvgpr_read_b32 v77, a37
v_accvgpr_read_b32 v78, a38
v_accvgpr_read_b32 v79, a39
v_accvgpr_read_b32 v80, a40
v_accvgpr_read_b32 v81, a41
v_accvgpr_read_b32 v82, a42
v_accvgpr_read_b32 v83, a43
v_accvgpr_read_b32 v84, a44
v_accvgpr_read_b32 v85, a45
v_accvgpr_read_b32 v86, a46
v_accvgpr_read_b32 v87, a47
v_accvgpr_read_b32 v88, a48
v_accvgpr_read_b32 v89, a49
v_accvgpr_read_b32 v90, a50
v_accvgpr_read_b32 v91, a51
v_accvgpr_read_b32 v92, a52
v_accvgpr_read_b32 v93, a53
v_accvgpr_read_b32 v94, a54
v_accvgpr_read_b32 v95, a55
v_accvgpr_read_b32 v96, a56
v_accvgpr_read_b32 v97, a57
v_accvgpr_read_b32 v98, a58
v_accvgpr_read_b32 v99, a59
v_accvgpr_read_b32 v100, a60
v_accvgpr_read_b32 v101, a61
v_accvgpr_read_b32 v102, a62
v_accvgpr_read_b32 v103, a63
v_pk_mul_f32 v[72:73], v[72:73], v[138:139] op_sel_hi:[1,0]
v_pk_mul_f32 v[74:75], v[74:75], v[138:139] op_sel_hi:[1,0]
v_pk_mul_f32 v[76:77], v[76:77], v[138:139] op_sel_hi:[1,0]
v_pk_mul_f32 v[78:79], v[78:79], v[138:139] op_sel_hi:[1,0]
v_cvt_pk_bf16_f32 v12, v72, v73
v_cvt_pk_bf16_f32 v13, v74, v75
v_cvt_pk_bf16_f32 v14, v76, v77
v_cvt_pk_bf16_f32 v15, v78, v79
s_add_u32 s46, s53, 0
buffer_store_dwordx4 v[12:15], v234, s[20:23], s46 offen offset:1024 sc0 sc1
s_mov_b32 m0, s94
s_add_u32 s94, s94, 4096
buffer_load_dwordx4 v236, s[16:19], s93 offen lds
s_add_u32 s93, s93, s95
v_pk_mul_f32 v[80:81], v[80:81], v[138:139] op_sel_hi:[1,0]
v_pk_mul_f32 v[82:83], v[82:83], v[138:139] op_sel_hi:[1,0]
v_pk_mul_f32 v[84:85], v[84:85], v[138:139] op_sel_hi:[1,0]
v_pk_mul_f32 v[86:87], v[86:87], v[138:139] op_sel_hi:[1,0]
v_cvt_pk_bf16_f32 v20, v80, v81
v_cvt_pk_bf16_f32 v21, v82, v83
v_cvt_pk_bf16_f32 v22, v84, v85
v_cvt_pk_bf16_f32 v23, v86, v87
buffer_store_dwordx4 v[20:23], v234, s[20:23], s46 offen offset:3072 sc0 sc1
s_mov_b32 m0, s94
s_add_u32 s94, s94, 4096
buffer_load_dwordx4 v236, s[16:19], s93 offen lds
s_add_u32 s93, s93, s95
v_pk_mul_f32 v[88:89], v[88:89], v[138:139] op_sel_hi:[1,0]
v_pk_mul_f32 v[90:91], v[90:91], v[138:139] op_sel_hi:[1,0]
v_pk_mul_f32 v[92:93], v[92:93], v[138:139] op_sel_hi:[1,0]
v_pk_mul_f32 v[94:95], v[94:95], v[138:139] op_sel_hi:[1,0]
v_cvt_pk_bf16_f32 v28, v88, v89
v_cvt_pk_bf16_f32 v29, v90, v91
v_cvt_pk_bf16_f32 v30, v92, v93
v_cvt_pk_bf16_f32 v31, v94, v95
s_add_u32 s46, s53, 4096
buffer_store_dwordx4 v[28:31], v234, s[20:23], s46 offen offset:1024 sc0 sc1
s_mov_b32 m0, s94
s_add_u32 s94, s94, 4096
buffer_load_dwordx4 v236, s[16:19], s93 offen lds
s_add_u32 s93, s93, s95
v_pk_mul_f32 v[96:97], v[96:97], v[138:139] op_sel_hi:[1,0]
v_pk_mul_f32 v[98:99], v[98:99], v[138:139] op_sel_hi:[1,0]
v_pk_mul_f32 v[100:101], v[100:101], v[138:139] op_sel_hi:[1,0]
v_pk_mul_f32 v[102:103], v[102:103], v[138:139] op_sel_hi:[1,0]
v_cvt_pk_bf16_f32 v36, v96, v97
v_cvt_pk_bf16_f32 v37, v98, v99
v_cvt_pk_bf16_f32 v38, v100, v101
v_cvt_pk_bf16_f32 v39, v102, v103
buffer_store_dwordx4 v[36:39], v234, s[20:23], s46 offen offset:3072 sc0 sc1
s_mov_b32 m0, s94
s_add_u32 s94, s94, 4096
buffer_load_dwordx4 v236, s[16:19], s93 offen lds
s_add_u32 s93, s93, s95
v_accvgpr_read_b32 v72, a64
v_accvgpr_read_b32 v73, a65
v_accvgpr_read_b32 v74, a66
v_accvgpr_read_b32 v75, a67
v_accvgpr_read_b32 v76, a68
v_accvgpr_read_b32 v77, a69
v_accvgpr_read_b32 v78, a70
v_accvgpr_read_b32 v79, a71
v_accvgpr_read_b32 v80, a72
v_accvgpr_read_b32 v81, a73
v_accvgpr_read_b32 v82, a74
v_accvgpr_read_b32 v83, a75
v_accvgpr_read_b32 v84, a76
v_accvgpr_read_b32 v85, a77
v_accvgpr_read_b32 v86, a78
v_accvgpr_read_b32 v87, a79
v_accvgpr_read_b32 v88, a80
v_accvgpr_read_b32 v89, a81
v_accvgpr_read_b32 v90, a82
v_accvgpr_read_b32 v91, a83
v_accvgpr_read_b32 v92, a84
v_accvgpr_read_b32 v93, a85
v_accvgpr_read_b32 v94, a86
v_accvgpr_read_b32 v95, a87
v_accvgpr_read_b32 v96, a88
v_accvgpr_read_b32 v97, a89
v_accvgpr_read_b32 v98, a90
v_accvgpr_read_b32 v99, a91
v_accvgpr_read_b32 v100, a92
v_accvgpr_read_b32 v101, a93
v_accvgpr_read_b32 v102, a94
v_accvgpr_read_b32 v103, a95
v_pk_mul_f32 v[72:73], v[72:73], v[140:141] op_sel_hi:[1,0]
v_pk_mul_f32 v[74:75], v[74:75], v[140:141] op_sel_hi:[1,0]
v_pk_mul_f32 v[76:77], v[76:77], v[140:141] op_sel_hi:[1,0]
v_pk_mul_f32 v[78:79], v[78:79], v[140:141] op_sel_hi:[1,0]
v_cvt_pk_bf16_f32 v40, v72, v73
v_cvt_pk_bf16_f32 v41, v74, v75
v_cvt_pk_bf16_f32 v42, v76, v77
v_cvt_pk_bf16_f32 v43, v78, v79
s_add_u32 s46, s53, 8192
buffer_store_dwordx4 v[40:43], v234, s[20:23], s46 offen offset:0 sc0 sc1
s_cmp_lg_u32 s52, 0
s_cselect_b32 s93, s75, s43
s_cselect_b32 s94, s72, s83
s_cselect_b32 s95, 36864, s95
s_add_u32 s94, s94, s3
s_mov_b32 m0, s94
s_add_u32 s94, s94, 4096
buffer_load_dwordx4 v239, s[16:19], s93 offen lds
s_add_u32 s93, s93, s95
v_pk_mul_f32 v[80:81], v[80:81], v[140:141] op_sel_hi:[1,0]
v_pk_mul_f32 v[82:83], v[82:83], v[140:141] op_sel_hi:[1,0]
v_pk_mul_f32 v[84:85], v[84:85], v[140:141] op_sel_hi:[1,0]
v_pk_mul_f32 v[86:87], v[86:87], v[140:141] op_sel_hi:[1,0]
v_cvt_pk_bf16_f32 v48, v80, v81
v_cvt_pk_bf16_f32 v49, v82, v83
v_cvt_pk_bf16_f32 v50, v84, v85
v_cvt_pk_bf16_f32 v51, v86, v87
buffer_store_dwordx4 v[48:51], v234, s[20:23], s46 offen offset:2048 sc0 sc1
s_mov_b32 m0, s94
s_add_u32 s94, s94, 4096
buffer_load_dwordx4 v239, s[16:19], s93 offen lds
s_add_u32 s93, s93, s95
v_pk_mul_f32 v[88:89], v[88:89], v[140:141] op_sel_hi:[1,0]
v_pk_mul_f32 v[90:91], v[90:91], v[140:141] op_sel_hi:[1,0]
v_pk_mul_f32 v[92:93], v[92:93], v[140:141] op_sel_hi:[1,0]
v_pk_mul_f32 v[94:95], v[94:95], v[140:141] op_sel_hi:[1,0]
v_cvt_pk_bf16_f32 v56, v88, v89
v_cvt_pk_bf16_f32 v57, v90, v91
v_cvt_pk_bf16_f32 v58, v92, v93
v_cvt_pk_bf16_f32 v59, v94, v95
s_add_u32 s46, s53, 12288
buffer_store_dwordx4 v[56:59], v234, s[20:23], s46 offen offset:0 sc0 sc1
s_mov_b32 m0, s94
s_add_u32 s94, s94, 4096
buffer_load_dwordx4 v239, s[16:19], s93 offen lds
s_add_u32 s93, s93, s95
v_pk_mul_f32 v[96:97], v[96:97], v[140:141] op_sel_hi:[1,0]
v_pk_mul_f32 v[98:99], v[98:99], v[140:141] op_sel_hi:[1,0]
v_pk_mul_f32 v[100:101], v[100:101], v[140:141] op_sel_hi:[1,0]
v_pk_mul_f32 v[102:103], v[102:103], v[140:141] op_sel_hi:[1,0]
v_cvt_pk_bf16_f32 v64, v96, v97
v_cvt_pk_bf16_f32 v65, v98, v99
v_cvt_pk_bf16_f32 v66, v100, v101
v_cvt_pk_bf16_f32 v67, v102, v103
buffer_store_dwordx4 v[64:67], v234, s[20:23], s46 offen offset:2048 sc0 sc1
s_mov_b32 m0, s94
s_add_u32 s94, s94, 4096
buffer_load_dwordx4 v239, s[16:19], s93 offen lds
s_add_u32 s93, s93, s95
v_accvgpr_read_b32 v72, a96
v_accvgpr_read_b32 v73, a97
v_accvgpr_read_b32 v74, a98
v_accvgpr_read_b32 v75, a99
v_accvgpr_read_b32 v76, a100
v_accvgpr_read_b32 v77, a101
v_accvgpr_read_b32 v78, a102
v_accvgpr_read_b32 v79, a103
v_accvgpr_read_b32 v80, a104
v_accvgpr_read_b32 v81, a105
v_accvgpr_read_b32 v82, a106
v_accvgpr_read_b32 v83, a107
v_accvgpr_read_b32 v84, a108
v_accvgpr_read_b32 v85, a109
v_accvgpr_read_b32 v86, a110
v_accvgpr_read_b32 v87, a111
v_accvgpr_read_b32 v88, a112
v_accvgpr_read_b32 v89, a113
v_accvgpr_read_b32 v90, a114
v_accvgpr_read_b32 v91, a115
v_accvgpr_read_b32 v92, a116
v_accvgpr_read_b32 v93, a117
v_accvgpr_read_b32 v94, a118
v_accvgpr_read_b32 v95, a119
v_accvgpr_read_b32 v96, a120
v_accvgpr_read_b32 v97, a121
v_accvgpr_read_b32 v98, a122
v_accvgpr_read_b32 v99, a123
v_accvgpr_read_b32 v100, a124
v_accvgpr_read_b32 v101, a125
v_accvgpr_read_b32 v102, a126
v_accvgpr_read_b32 v103, a127
v_pk_mul_f32 v[72:73], v[72:73], v[142:143] op_sel_hi:[1,0]
v_pk_mul_f32 v[74:75], v[74:75], v[142:143] op_sel_hi:[1,0]
v_pk_mul_f32 v[76:77], v[76:77], v[142:143] op_sel_hi:[1,0]
v_pk_mul_f32 v[78:79], v[78:79], v[142:143] op_sel_hi:[1,0]
v_cvt_pk_bf16_f32 v44, v72, v73
v_cvt_pk_bf16_f32 v45, v74, v75
v_cvt_pk_bf16_f32 v46, v76, v77
v_cvt_pk_bf16_f32 v47, v78, v79
s_add_u32 s46, s53, 8192
buffer_store_dwordx4 v[44:47], v234, s[20:23], s46 offen offset:1024 sc0 sc1
s_cmp_lg_u32 s52, 0
s_cselect_b32 s94, 0x30000, s94
s_mov_b32 m0, s94
s_add_u32 s94, s94, 4096
buffer_load_dwordx4 v239, s[16:19], s93 offen lds
s_add_u32 s93, s93, s95
v_pk_mul_f32 v[80:81], v[80:81], v[142:143] op_sel_hi:[1,0]
v_pk_mul_f32 v[82:83], v[82:83], v[142:143] op_sel_hi:[1,0]
v_pk_mul_f32 v[84:85], v[84:85], v[142:143] op_sel_hi:[1,0]
v_pk_mul_f32 v[86:87], v[86:87], v[142:143] op_sel_hi:[1,0]
v_cvt_pk_bf16_f32 v52, v80, v81
v_cvt_pk_bf16_f32 v53, v82, v83
v_cvt_pk_bf16_f32 v54, v84, v85
v_cvt_pk_bf16_f32 v55, v86, v87
buffer_store_dwordx4 v[52:55], v234, s[20:23], s46 offen offset:3072 sc0 sc1
s_mov_b32 m0, s94
s_add_u32 s94, s94, 4096
buffer_load_dwordx4 v239, s[16:19], s93 offen lds
s_add_u32 s93, s93, s95
v_pk_mul_f32 v[88:89], v[88:89], v[142:143] op_sel_hi:[1,0]
v_pk_mul_f32 v[90:91], v[90:91], v[142:143] op_sel_hi:[1,0]
v_pk_mul_f32 v[92:93], v[92:93], v[142:143] op_sel_hi:[1,0]
v_pk_mul_f32 v[94:95], v[94:95], v[142:143] op_sel_hi:[1,0]
v_cvt_pk_bf16_f32 v60, v88, v89
v_cvt_pk_bf16_f32 v61, v90, v91
v_cvt_pk_bf16_f32 v62, v92, v93
v_cvt_pk_bf16_f32 v63, v94, v95
s_add_u32 s46, s53, 12288
buffer_store_dwordx4 v[60:63], v234, s[20:23], s46 offen offset:1024 sc0 sc1
s_mov_b32 m0, s94
s_add_u32 s94, s94, 4096
buffer_load_dwordx4 v239, s[16:19], s93 offen lds
s_add_u32 s93, s93, s95
v_pk_mul_f32 v[96:97], v[96:97], v[142:143] op_sel_hi:[1,0]
v_pk_mul_f32 v[98:99], v[98:99], v[142:143] op_sel_hi:[1,0]
v_pk_mul_f32 v[100:101], v[100:101], v[142:143] op_sel_hi:[1,0]
v_pk_mul_f32 v[102:103], v[102:103], v[142:143] op_sel_hi:[1,0]
v_cvt_pk_bf16_f32 v68, v96, v97
v_cvt_pk_bf16_f32 v69, v98, v99
v_cvt_pk_bf16_f32 v70, v100, v101
v_cvt_pk_bf16_f32 v71, v102, v103
buffer_store_dwordx4 v[68:71], v234, s[20:23], s46 offen offset:3072 sc0 sc1
s_mov_b32 m0, s94
s_add_u32 s94, s94, 4096
buffer_load_dwordx4 v239, s[16:19], s93 offen lds
s_add_u32 s93, s93, s95
s_and_b32 s93, s35, 1
s_lshl_b32 s93, s93, 7
s_sub_u32 s46, s80, 0x10000
v_xor_b32 v220, s93, v220
v_add_u32 v168, s46, v220
v_xor_b32 v221, s93, v221
v_add_u32 v169, s46, v221
v_xor_b32 v222, s93, v222
v_add_u32 v170, s46, v222
v_xor_b32 v223, s93, v223
v_add_u32 v171, s46, v223
v_xor_b32 v224, s93, v224
v_add_u32 v172, s46, v224
v_xor_b32 v225, s93, v225
v_add_u32 v173, s46, v225
v_xor_b32 v226, s93, v226
v_add_u32 v174, s46, v226
v_xor_b32 v227, s93, v227
v_add_u32 v175, s46, v227
v_bfe_u32 v5, v1, 2, 2
v_lshl_add_u32 v5, v4, 2, v5
v_bfe_u32 v6, v5, 1, 2
v_lshlrev_b32 v6, 5, v6
v_lshl_add_u32 v6, v5, 7, v6
v_and_b32 v5, 3, v1
v_lshl_add_u32 v6, v5, 3, v6
v_add_u32 v200, s72, v6
v_xor_b32 v201, 32, v200
v_xor_b32 v202, 64, v200
v_xor_b32 v203, 96, v200
v_and_b32 v6, 7, v1
v_lshlrev_b32 v6, 2, v6
s_mov_b32 s92, 0
s_waitcnt vmcnt(17)
v_mov_b32 v5, 1
s_lshl_b32 s46, s36, 3
s_add_u32 s46, s46, s54
s_mov_b64 exec, 1
buffer_store_dword v5, v234, s[20:23], s46 offen offset:0 sc0 sc1
s_mov_b64 exec, -1
s_cmp_lg_u32 s52, 0
s_cbranch_scc1 K_GD
ds_read_b64_tr_b16 a[192:193], v168 offset:0
ds_read_b64_tr_b16 a[194:195], v168 offset:4096
ds_read_b64_tr_b16 a[196:197], v169 offset:0
ds_read_b64_tr_b16 a[198:199], v169 offset:4096
ds_read_b64_tr_b16 a[200:201], v170 offset:0
ds_read_b64_tr_b16 a[202:203], v170 offset:4096
ds_read_b64_tr_b16 a[204:205], v171 offset:0
ds_read_b64_tr_b16 a[206:207], v171 offset:4096
ds_read_b64_tr_b16 a[208:209], v172 offset:0
ds_read_b64_tr_b16 a[210:211], v172 offset:4096
ds_read_b64_tr_b16 a[212:213], v173 offset:0
ds_read_b64_tr_b16 a[214:215], v173 offset:4096
ds_read_b64_tr_b16 a[216:217], v174 offset:0
ds_read_b64_tr_b16 a[218:219], v174 offset:4096
ds_read_b64_tr_b16 a[220:221], v175 offset:0
ds_read_b64_tr_b16 a[222:223], v175 offset:4096
ds_read_b64_tr_b16 a[224:225], v200 offset:0
ds_read_b64_tr_b16 a[226:227], v200 offset:2048
ds_read_b64_tr_b16 a[228:229], v201 offset:0
ds_read_b64_tr_b16 a[230:231], v201 offset:2048
ds_read_b64_tr_b16 a[232:233], v202 offset:0
ds_read_b64_tr_b16 a[234:235], v202 offset:2048
ds_read_b64_tr_b16 a[236:237], v203 offset:0
ds_read_b64_tr_b16 a[238:239], v203 offset:2048
s_sub_u32 s87, s81, 0x10000
s_sub_u32 s88, s82, 0x10000
s_sub_u32 s89, s83, 0x10000
s_sub_u32 s86, s73, s72
s_add_u32 s80, s80, s3
s_add_u32 s81, s81, s3
s_add_u32 s82, s82, s3
s_add_u32 s83, s83, s3
s_waitcnt lgkmcnt(6)
v_mfma_f32_16x16x32_bf16 v[72:75], a[192:195], v[8:11], 0
v_add_u32 v176, s87, v220
v_add_u32 v177, s87, v221
v_mfma_f32_16x16x32_bf16 v[104:107], a[192:195], v[12:15], 0
ds_read_b64_tr_b16 a[192:193], v168 offset:8192
ds_read_b64_tr_b16 a[194:195], v168 offset:12288
v_mfma_f32_16x16x32_bf16 v[76:79], a[196:199], v[8:11], 0
v_add_u32 v178, s87, v222
v_add_u32 v179, s87, v223
v_mfma_f32_16x16x32_bf16 v[108:111], a[196:199], v[12:15], 0
ds_read_b64_tr_b16 a[196:197], v169 offset:8192
ds_read_b64_tr_b16 a[198:199], v169 offset:12288
v_mfma_f32_16x16x32_bf16 v[80:83], a[200:203], v[8:11], 0
v_add_u32 v180, s87, v224
v_add_u32 v181, s87, v225
v_mfma_f32_16x16x32_bf16 v[112:115], a[200:203], v[12:15], 0
ds_read_b64_tr_b16 a[200:201], v170 offset:8192
ds_read_b64_tr_b16 a[202:203], v170 offset:12288
v_mfma_f32_16x16x32_bf16 v[84:87], a[204:207], v[8:11], 0
v_add_u32 v182, s87, v226
v_add_u32 v183, s87, v227
v_mfma_f32_16x16x32_bf16 v[116:119], a[204:207], v[12:15], 0
ds_read_b64_tr_b16 a[204:205], v171 offset:8192
ds_read_b64_tr_b16 a[206:207], v171 offset:12288
v_mfma_f32_16x16x32_bf16 v[88:91], a[208:211], v[8:11], 0
v_add_u32 v204, s86, v200
v_add_u32 v205, s86, v201
v_mfma_f32_16x16x32_bf16 v[120:123], a[208:211], v[12:15], 0
ds_read_b64_tr_b16 a[208:209], v172 offset:8192
ds_read_b64_tr_b16 a[210:211], v172 offset:12288
v_mfma_f32_16x16x32_bf16 v[92:95], a[212:215], v[8:11], 0
v_add_u32 v206, s86, v202
v_add_u32 v207, s86, v203
v_mfma_f32_16x16x32_bf16 v[124:127], a[212:215], v[12:15], 0
ds_read_b64_tr_b16 a[212:213], v173 offset:8192
ds_read_b64_tr_b16 a[214:215], v173 offset:12288
v_mfma_f32_16x16x32_bf16 v[96:99], a[216:219], v[8:11], 0
v_add_u32 v184, s88, v220
v_add_u32 v185, s88, v221
v_mfma_f32_16x16x32_bf16 v[128:131], a[216:219], v[12:15], 0
ds_read_b64_tr_b16 a[216:217], v174 offset:8192
ds_read_b64_tr_b16 a[218:219], v174 offset:12288
v_mfma_f32_16x16x32_bf16 v[100:103], a[220:223], v[8:11], 0
v_add_u32 v186, s88, v222
v_add_u32 v187, s88, v223
v_mfma_f32_16x16x32_bf16 v[132:135], a[220:223], v[12:15], 0
ds_read_b64_tr_b16 a[220:221], v175 offset:8192
ds_read_b64_tr_b16 a[222:223], v175 offset:12288
v_mfma_f32_16x16x32_bf16 v[136:139], a[224:227], v[8:11], 0
v_add_u32 v188, s88, v224
v_add_u32 v189, s88, v225
v_mfma_f32_16x16x32_bf16 v[152:155], a[224:227], v[12:15], 0
s_waitcnt lgkmcnt(6)
ds_read_b64_tr_b16 a[224:225], v200 offset:4096
ds_read_b64_tr_b16 a[226:227], v200 offset:6144
v_mfma_f32_16x16x32_bf16 v[140:143], a[228:231], v[8:11], 0
v_add_u32 v190, s88, v226
v_add_u32 v191, s88, v227
v_mfma_f32_16x16x32_bf16 v[156:159], a[228:231], v[12:15], 0
ds_read_b64_tr_b16 a[228:229], v201 offset:4096
ds_read_b64_tr_b16 a[230:231], v201 offset:6144
v_mfma_f32_16x16x32_bf16 v[144:147], a[232:235], v[8:11], 0
v_add_u32 v192, s89, v220
v_add_u32 v193, s89, v221
v_mfma_f32_16x16x32_bf16 v[160:163], a[232:235], v[12:15], 0
ds_read_b64_tr_b16 a[232:233], v202 offset:4096
ds_read_b64_tr_b16 a[234:235], v202 offset:6144
v_mfma_f32_16x16x32_bf16 v[148:151], a[236:239], v[8:11], 0
v_mfma_f32_16x16x32_bf16 v[164:167], a[236:239], v[12:15], 0
ds_read_b64_tr_b16 a[236:237], v203 offset:4096
ds_read_b64_tr_b16 a[238:239], v203 offset:6144
v_mfma_f32_16x16x32_bf16 v[72:75], a[192:195], v[16:19], v[72:75]
v_add_u32 v194, s89, v222
v_add_u32 v195, s89, v223
v_mfma_f32_16x16x32_bf16 v[104:107], a[192:195], v[20:23], v[104:107]
ds_read_b64_tr_b16 a[192:193], v168 offset:16384
ds_read_b64_tr_b16 a[194:195], v168 offset:20480
v_mfma_f32_16x16x32_bf16 v[76:79], a[196:199], v[16:19], v[76:79]
v_add_u32 v196, s89, v224
v_add_u32 v197, s89, v225
v_mfma_f32_16x16x32_bf16 v[108:111], a[196:199], v[20:23], v[108:111]
ds_read_b64_tr_b16 a[196:197], v169 offset:16384
ds_read_b64_tr_b16 a[198:199], v169 offset:20480
v_mfma_f32_16x16x32_bf16 v[80:83], a[200:203], v[16:19], v[80:83]
v_add_u32 v198, s89, v226
v_add_u32 v199, s89, v227
v_mfma_f32_16x16x32_bf16 v[112:115], a[200:203], v[20:23], v[112:115]
ds_read_b64_tr_b16 a[200:201], v170 offset:16384
ds_read_b64_tr_b16 a[202:203], v170 offset:20480
v_mfma_f32_16x16x32_bf16 v[84:87], a[204:207], v[16:19], v[84:87]
v_mfma_f32_16x16x32_bf16 v[116:119], a[204:207], v[20:23], v[116:119]
ds_read_b64_tr_b16 a[204:205], v171 offset:16384
ds_read_b64_tr_b16 a[206:207], v171 offset:20480
v_mfma_f32_16x16x32_bf16 v[88:91], a[208:211], v[16:19], v[88:91]
v_mfma_f32_16x16x32_bf16 v[120:123], a[208:211], v[20:23], v[120:123]
s_waitcnt lgkmcnt(6)
ds_read_b64_tr_b16 a[208:209], v172 offset:16384
ds_read_b64_tr_b16 a[210:211], v172 offset:20480
v_mfma_f32_16x16x32_bf16 v[92:95], a[212:215], v[16:19], v[92:95]
v_mfma_f32_16x16x32_bf16 v[124:127], a[212:215], v[20:23], v[124:127]
ds_read_b64_tr_b16 a[212:213], v173 offset:16384
ds_read_b64_tr_b16 a[214:215], v173 offset:20480
v_mfma_f32_16x16x32_bf16 v[96:99], a[216:219], v[16:19], v[96:99]
v_mfma_f32_16x16x32_bf16 v[128:131], a[216:219], v[20:23], v[128:131]
ds_read_b64_tr_b16 a[216:217], v174 offset:16384
ds_read_b64_tr_b16 a[218:219], v174 offset:20480
v_mfma_f32_16x16x32_bf16 v[100:103], a[220:223], v[16:19], v[100:103]
v_mfma_f32_16x16x32_bf16 v[132:135], a[220:223], v[20:23], v[132:135]
ds_read_b64_tr_b16 a[220:221], v175 offset:16384
ds_read_b64_tr_b16 a[222:223], v175 offset:20480
v_mfma_f32_16x16x32_bf16 v[136:139], a[224:227], v[16:19], v[136:139]
v_mfma_f32_16x16x32_bf16 v[152:155], a[224:227], v[20:23], v[152:155]
ds_read_b64_tr_b16 a[224:225], v200 offset:8192
ds_read_b64_tr_b16 a[226:227], v200 offset:10240
v_mfma_f32_16x16x32_bf16 v[140:143], a[228:231], v[16:19], v[140:143]
v_mfma_f32_16x16x32_bf16 v[156:159], a[228:231], v[20:23], v[156:159]
ds_read_b64_tr_b16 a[228:229], v201 offset:8192
ds_read_b64_tr_b16 a[230:231], v201 offset:10240
v_mfma_f32_16x16x32_bf16 v[144:147], a[232:235], v[16:19], v[144:147]
v_mfma_f32_16x16x32_bf16 v[160:163], a[232:235], v[20:23], v[160:163]
ds_read_b64_tr_b16 a[232:233], v202 offset:8192
ds_read_b64_tr_b16 a[234:235], v202 offset:10240
v_mfma_f32_16x16x32_bf16 v[148:151], a[236:239], v[16:19], v[148:151]
v_mfma_f32_16x16x32_bf16 v[164:167], a[236:239], v[20:23], v[164:167]
ds_read_b64_tr_b16 a[236:237], v203 offset:8192
ds_read_b64_tr_b16 a[238:239], v203 offset:10240
v_mfma_f32_16x16x32_bf16 v[72:75], a[192:195], v[24:27], v[72:75]
v_mfma_f32_16x16x32_bf16 v[104:107], a[192:195], v[28:31], v[104:107]
s_waitcnt lgkmcnt(6)
ds_read_b64_tr_b16 a[192:193], v168 offset:24576
ds_read_b64_tr_b16 a[194:195], v168 offset:28672
v_mfma_f32_16x16x32_bf16 v[76:79], a[196:199], v[24:27], v[76:79]
v_mfma_f32_16x16x32_bf16 v[108:111], a[196:199], v[28:31], v[108:111]
ds_read_b64_tr_b16 a[196:197], v169 offset:24576
ds_read_b64_tr_b16 a[198:199], v169 offset:28672
v_mfma_f32_16x16x32_bf16 v[80:83], a[200:203], v[24:27], v[80:83]
v_mfma_f32_16x16x32_bf16 v[112:115], a[200:203], v[28:31], v[112:115]
ds_read_b64_tr_b16 a[200:201], v170 offset:24576
ds_read_b64_tr_b16 a[202:203], v170 offset:28672
v_mfma_f32_16x16x32_bf16 v[84:87], a[204:207], v[24:27], v[84:87]
v_mfma_f32_16x16x32_bf16 v[116:119], a[204:207], v[28:31], v[116:119]
ds_read_b64_tr_b16 a[204:205], v171 offset:24576
ds_read_b64_tr_b16 a[206:207], v171 offset:28672
v_mfma_f32_16x16x32_bf16 v[88:91], a[208:211], v[24:27], v[88:91]
v_mfma_f32_16x16x32_bf16 v[120:123], a[208:211], v[28:31], v[120:123]
ds_read_b64_tr_b16 a[208:209], v172 offset:24576
ds_read_b64_tr_b16 a[210:211], v172 offset:28672
v_mfma_f32_16x16x32_bf16 v[92:95], a[212:215], v[24:27], v[92:95]
v_mfma_f32_16x16x32_bf16 v[124:127], a[212:215], v[28:31], v[124:127]
ds_read_b64_tr_b16 a[212:213], v173 offset:24576
ds_read_b64_tr_b16 a[214:215], v173 offset:28672
v_mfma_f32_16x16x32_bf16 v[96:99], a[216:219], v[24:27], v[96:99]
v_mfma_f32_16x16x32_bf16 v[128:131], a[216:219], v[28:31], v[128:131]
ds_read_b64_tr_b16 a[216:217], v174 offset:24576
ds_read_b64_tr_b16 a[218:219], v174 offset:28672
v_mfma_f32_16x16x32_bf16 v[100:103], a[220:223], v[24:27], v[100:103]
v_mfma_f32_16x16x32_bf16 v[132:135], a[220:223], v[28:31], v[132:135]
ds_read_b64_tr_b16 a[220:221], v175 offset:24576
ds_read_b64_tr_b16 a[222:223], v175 offset:28672
v_mfma_f32_16x16x32_bf16 v[136:139], a[224:227], v[24:27], v[136:139]
v_mfma_f32_16x16x32_bf16 v[152:155], a[224:227], v[28:31], v[152:155]
s_waitcnt lgkmcnt(6)
ds_read_b64_tr_b16 a[224:225], v200 offset:12288
ds_read_b64_tr_b16 a[226:227], v200 offset:14336
v_mfma_f32_16x16x32_bf16 v[140:143], a[228:231], v[24:27], v[140:143]
v_mfma_f32_16x16x32_bf16 v[156:159], a[228:231], v[28:31], v[156:159]
ds_read_b64_tr_b16 a[228:229], v201 offset:12288
ds_read_b64_tr_b16 a[230:231], v201 offset:14336
v_mfma_f32_16x16x32_bf16 v[144:147], a[232:235], v[24:27], v[144:147]
v_mfma_f32_16x16x32_bf16 v[160:163], a[232:235], v[28:31], v[160:163]
ds_read_b64_tr_b16 a[232:233], v202 offset:12288
ds_read_b64_tr_b16 a[234:235], v202 offset:14336
v_mfma_f32_16x16x32_bf16 v[148:151], a[236:239], v[24:27], v[148:151]
v_mfma_f32_16x16x32_bf16 v[164:167], a[236:239], v[28:31], v[164:167]
ds_read_b64_tr_b16 a[236:237], v203 offset:12288
ds_read_b64_tr_b16 a[238:239], v203 offset:14336
v_mfma_f32_16x16x32_bf16 v[72:75], a[192:195], v[32:35], v[72:75]
v_mfma_f32_16x16x32_bf16 v[104:107], a[192:195], v[36:39], v[104:107]
v_mfma_f32_16x16x32_bf16 v[76:79], a[196:199], v[32:35], v[76:79]
v_mfma_f32_16x16x32_bf16 v[108:111], a[196:199], v[36:39], v[108:111]
v_mfma_f32_16x16x32_bf16 v[80:83], a[200:203], v[32:35], v[80:83]
s_waitcnt lgkmcnt(0)
s_barrier
v_mfma_f32_16x16x32_bf16 v[112:115], a[200:203], v[36:39], v[112:115]
ds_read_b64_tr_b16 a[192:193], v176 offset:0
ds_read_b64_tr_b16 a[194:195], v176 offset:4096
v_mfma_f32_16x16x32_bf16 v[84:87], a[204:207], v[32:35], v[84:87]
buffer_load_dword v241, v6, s[20:23], s54 offen sc0 sc1
v_mfma_f32_16x16x32_bf16 v[116:119], a[204:207], v[36:39], v[116:119]
ds_read_b64_tr_b16 a[196:197], v177 offset:0
ds_read_b64_tr_b16 a[198:199], v177 offset:4096
v_mfma_f32_16x16x32_bf16 v[88:91], a[208:211], v[32:35], v[88:91]
s_add_u32 m0, s80, 0
ds_read_b64_tr_b16 a[200:201], v178 offset:0
ds_read_b64_tr_b16 a[202:203], v178 offset:4096
v_mfma_f32_16x16x32_bf16 v[120:123], a[208:211], v[36:39], v[120:123]
s_add_u32 s48, s44, 0
ds_read_b64_tr_b16 a[204:205], v179 offset:0
ds_read_b64_tr_b16 a[206:207], v179 offset:4096
v_mfma_f32_16x16x32_bf16 v[92:95], a[212:215], v[32:35], v[92:95]
buffer_load_dwordx4 v236, s[16:19], s48 offen lds
v_mfma_f32_16x16x32_bf16 v[124:127], a[212:215], v[36:39], v[124:127]
ds_read_b64_tr_b16 a[208:209], v180 offset:0
ds_read_b64_tr_b16 a[210:211], v180 offset:4096
v_mfma_f32_16x16x32_bf16 v[96:99], a[216:219], v[32:35], v[96:99]
s_add_u32 m0, s80, 4096
ds_read_b64_tr_b16 a[212:213], v181 offset:0
ds_read_b64_tr_b16 a[214:215], v181 offset:4096
v_mfma_f32_16x16x32_bf16 v[128:131], a[216:219], v[36:39], v[128:131]
s_add_u32 s48, s44, 18432
ds_read_b64_tr_b16 a[216:217], v182 offset:0
ds_read_b64_tr_b16 a[218:219], v182 offset:4096
v_mfma_f32_16x16x32_bf16 v[100:103], a[220:223], v[32:35], v[100:103]
buffer_load_dwordx4 v236, s[16:19], s48 offen lds
v_mfma_f32_16x16x32_bf16 v[132:135], a[220:223], v[36:39], v[132:135]
ds_read_b64_tr_b16 a[220:221], v183 offset:0
ds_read_b64_tr_b16 a[222:223], v183 offset:4096
v_mfma_f32_16x16x32_bf16 v[136:139], a[224:227], v[32:35], v[136:139]
s_add_u32 m0, s80, 8192
v_mfma_f32_16x16x32_bf16 v[152:155], a[224:227], v[36:39], v[152:155]
s_add_u32 s48, s44, 36864
ds_read_b64_tr_b16 a[224:225], v204 offset:0
ds_read_b64_tr_b16 a[226:227], v204 offset:2048
v_mfma_f32_16x16x32_bf16 v[140:143], a[228:231], v[32:35], v[140:143]
buffer_load_dwordx4 v236, s[16:19], s48 offen lds
v_mfma_f32_16x16x32_bf16 v[156:159], a[228:231], v[36:39], v[156:159]
ds_read_b64_tr_b16 a[228:229], v205 offset:0
ds_read_b64_tr_b16 a[230:231], v205 offset:2048
v_mfma_f32_16x16x32_bf16 v[144:147], a[232:235], v[32:35], v[144:147]
v_mfma_f32_16x16x32_bf16 v[160:163], a[232:235], v[36:39], v[160:163]
ds_read_b64_tr_b16 a[232:233], v206 offset:0
ds_read_b64_tr_b16 a[234:235], v206 offset:2048
v_mfma_f32_16x16x32_bf16 v[148:151], a[236:239], v[32:35], v[148:151]
v_mfma_f32_16x16x32_bf16 v[164:167], a[236:239], v[36:39], v[164:167]
s_waitcnt lgkmcnt(6)
ds_read_b64_tr_b16 a[236:237], v207 offset:0
ds_read_b64_tr_b16 a[238:239], v207 offset:2048
v_mfma_f32_16x16x32_bf16 v[72:75], a[192:195], v[40:43], v[72:75]
s_add_u32 m0, s80, 12288
v_mfma_f32_16x16x32_bf16 v[104:107], a[192:195], v[44:47], v[104:107]
s_add_u32 s48, s44, 55296
buffer_load_dwordx4 v236, s[16:19], s48 offen lds
v_mfma_f32_16x16x32_bf16 v[76:79], a[196:199], v[40:43], v[76:79]
ds_read_b64_tr_b16 a[192:193], v176 offset:8192
ds_read_b64_tr_b16 a[194:195], v176 offset:12288
v_mfma_f32_16x16x32_bf16 v[108:111], a[196:199], v[44:47], v[108:111]
s_add_u32 m0, s80, 16384
ds_read_b64_tr_b16 a[196:197], v177 offset:8192
ds_read_b64_tr_b16 a[198:199], v177 offset:12288
v_mfma_f32_16x16x32_bf16 v[80:83], a[200:203], v[40:43], v[80:83]
s_add_u32 s48, s44, 73728
v_mfma_f32_16x16x32_bf16 v[112:115], a[200:203], v[44:47], v[112:115]
buffer_load_dwordx4 v236, s[16:19], s48 offen lds
v_mfma_f32_16x16x32_bf16 v[84:87], a[204:207], v[40:43], v[84:87]
ds_read_b64_tr_b16 a[200:201], v178 offset:8192
ds_read_b64_tr_b16 a[202:203], v178 offset:12288
v_mfma_f32_16x16x32_bf16 v[116:119], a[204:207], v[44:47], v[116:119]
s_add_u32 m0, s80, 20480
ds_read_b64_tr_b16 a[204:205], v179 offset:8192
ds_read_b64_tr_b16 a[206:207], v179 offset:12288
v_mfma_f32_16x16x32_bf16 v[88:91], a[208:211], v[40:43], v[88:91]
s_add_u32 s48, s44, 92160
v_mfma_f32_16x16x32_bf16 v[120:123], a[208:211], v[44:47], v[120:123]
buffer_load_dwordx4 v236, s[16:19], s48 offen lds
v_mfma_f32_16x16x32_bf16 v[92:95], a[212:215], v[40:43], v[92:95]
ds_read_b64_tr_b16 a[208:209], v180 offset:8192
ds_read_b64_tr_b16 a[210:211], v180 offset:12288
v_mfma_f32_16x16x32_bf16 v[124:127], a[212:215], v[44:47], v[124:127]
s_add_u32 m0, s80, 24576
ds_read_b64_tr_b16 a[212:213], v181 offset:8192
ds_read_b64_tr_b16 a[214:215], v181 offset:12288
v_mfma_f32_16x16x32_bf16 v[96:99], a[216:219], v[40:43], v[96:99]
s_add_u32 s48, s44, 110592
v_mfma_f32_16x16x32_bf16 v[128:131], a[216:219], v[44:47], v[128:131]
buffer_load_dwordx4 v236, s[16:19], s48 offen lds
v_mfma_f32_16x16x32_bf16 v[100:103], a[220:223], v[40:43], v[100:103]
s_waitcnt lgkmcnt(6)
ds_read_b64_tr_b16 a[216:217], v182 offset:8192
ds_read_b64_tr_b16 a[218:219], v182 offset:12288
v_mfma_f32_16x16x32_bf16 v[132:135], a[220:223], v[44:47], v[132:135]
s_add_u32 m0, s80, 28672
ds_read_b64_tr_b16 a[220:221], v183 offset:8192
ds_read_b64_tr_b16 a[222:223], v183 offset:12288
v_mfma_f32_16x16x32_bf16 v[136:139], a[224:227], v[40:43], v[136:139]
s_add_u32 s48, s44, 129024
v_mfma_f32_16x16x32_bf16 v[152:155], a[224:227], v[44:47], v[152:155]
buffer_load_dwordx4 v236, s[16:19], s48 offen lds
v_mfma_f32_16x16x32_bf16 v[140:143], a[228:231], v[40:43], v[140:143]
ds_read_b64_tr_b16 a[224:225], v204 offset:4096
ds_read_b64_tr_b16 a[226:227], v204 offset:6144
v_mfma_f32_16x16x32_bf16 v[156:159], a[228:231], v[44:47], v[156:159]
ds_read_b64_tr_b16 a[228:229], v205 offset:4096
ds_read_b64_tr_b16 a[230:231], v205 offset:6144
v_mfma_f32_16x16x32_bf16 v[144:147], a[232:235], v[40:43], v[144:147]
v_mfma_f32_16x16x32_bf16 v[160:163], a[232:235], v[44:47], v[160:163]
ds_read_b64_tr_b16 a[232:233], v206 offset:4096
ds_read_b64_tr_b16 a[234:235], v206 offset:6144
v_mfma_f32_16x16x32_bf16 v[148:151], a[236:239], v[40:43], v[148:151]
v_mfma_f32_16x16x32_bf16 v[164:167], a[236:239], v[44:47], v[164:167]
ds_read_b64_tr_b16 a[236:237], v207 offset:4096
ds_read_b64_tr_b16 a[238:239], v207 offset:6144
s_waitcnt vmcnt(8)
v_mov_b32 v5, 1
s_lshl_b32 s46, s36, 3
s_add_u32 s46, s46, s54
s_mov_b64 exec, 1
buffer_store_dword v5, v234, s[20:23], s46 offen offset:4 sc0 sc1
s_mov_b64 exec, -1
v_cmp_ne_u32 vcc, 1, v241
s_and_b32 s46, vcc_lo, 0x55
s_cselect_b32 s92, 0, 1
s_cselect_b32 s78, 0, 0x4000000
v_mfma_f32_16x16x32_bf16 v[72:75], a[192:195], v[48:51], v[72:75]
s_add_u32 s94, s38, 0
v_mfma_f32_16x16x32_bf16 v[104:107], a[192:195], v[52:55], v[104:107]
buffer_load_dwordx4 a[0:3], v234, s[76:79], s94 offen offset:0 sc0 sc1
v_mfma_f32_16x16x32_bf16 v[76:79], a[196:199], v[48:51], v[76:79]
ds_read_b64_tr_b16 a[192:193], v176 offset:16384
ds_read_b64_tr_b16 a[194:195], v176 offset:20480
v_mfma_f32_16x16x32_bf16 v[108:111], a[196:199], v[52:55], v[108:111]
ds_read_b64_tr_b16 a[196:197], v177 offset:16384
ds_read_b64_tr_b16 a[198:199], v177 offset:20480
v_mfma_f32_16x16x32_bf16 v[80:83], a[200:203], v[48:51], v[80:83]
buffer_load_dwordx4 a[4:7], v234, s[76:79], s94 offen offset:1024 sc0 sc1
v_mfma_f32_16x16x32_bf16 v[112:115], a[200:203], v[52:55], v[112:115]
s_waitcnt lgkmcnt(6)
ds_read_b64_tr_b16 a[200:201], v178 offset:16384
ds_read_b64_tr_b16 a[202:203], v178 offset:20480
v_mfma_f32_16x16x32_bf16 v[84:87], a[204:207], v[48:51], v[84:87]
v_mfma_f32_16x16x32_bf16 v[116:119], a[204:207], v[52:55], v[116:119]
buffer_load_dwordx4 a[8:11], v234, s[76:79], s94 offen offset:2048 sc0 sc1
v_mfma_f32_16x16x32_bf16 v[88:91], a[208:211], v[48:51], v[88:91]
ds_read_b64_tr_b16 a[204:205], v179 offset:16384
ds_read_b64_tr_b16 a[206:207], v179 offset:20480
v_mfma_f32_16x16x32_bf16 v[120:123], a[208:211], v[52:55], v[120:123]
ds_read_b64_tr_b16 a[208:209], v180 offset:16384
ds_read_b64_tr_b16 a[210:211], v180 offset:20480
v_mfma_f32_16x16x32_bf16 v[92:95], a[212:215], v[48:51], v[92:95]
buffer_load_dwordx4 a[12:15], v234, s[76:79], s94 offen offset:3072 sc0 sc1
v_mfma_f32_16x16x32_bf16 v[124:127], a[212:215], v[52:55], v[124:127]
s_add_u32 s94, s38, 4096
ds_read_b64_tr_b16 a[212:213], v181 offset:16384
ds_read_b64_tr_b16 a[214:215], v181 offset:20480
v_mfma_f32_16x16x32_bf16 v[96:99], a[216:219], v[48:51], v[96:99]
v_mfma_f32_16x16x32_bf16 v[128:131], a[216:219], v[52:55], v[128:131]
buffer_load_dwordx4 a[16:19], v234, s[76:79], s94 offen offset:0 sc0 sc1
v_mfma_f32_16x16x32_bf16 v[100:103], a[220:223], v[48:51], v[100:103]
ds_read_b64_tr_b16 a[216:217], v182 offset:16384
ds_read_b64_tr_b16 a[218:219], v182 offset:20480
v_mfma_f32_16x16x32_bf16 v[132:135], a[220:223], v[52:55], v[132:135]
ds_read_b64_tr_b16 a[220:221], v183 offset:16384
ds_read_b64_tr_b16 a[222:223], v183 offset:20480
v_mfma_f32_16x16x32_bf16 v[136:139], a[224:227], v[48:51], v[136:139]
buffer_load_dwordx4 a[20:23], v234, s[76:79], s94 offen offset:1024 sc0 sc1
v_mfma_f32_16x16x32_bf16 v[152:155], a[224:227], v[52:55], v[152:155]
ds_read_b64_tr_b16 a[224:225], v204 offset:8192
ds_read_b64_tr_b16 a[226:227], v204 offset:10240
v_mfma_f32_16x16x32_bf16 v[140:143], a[228:231], v[48:51], v[140:143]
v_mfma_f32_16x16x32_bf16 v[156:159], a[228:231], v[52:55], v[156:159]
buffer_load_dwordx4 a[24:27], v234, s[76:79], s94 offen offset:2048 sc0 sc1
v_mfma_f32_16x16x32_bf16 v[144:147], a[232:235], v[48:51], v[144:147]
ds_read_b64_tr_b16 a[228:229], v205 offset:8192
ds_read_b64_tr_b16 a[230:231], v205 offset:10240
v_mfma_f32_16x16x32_bf16 v[160:163], a[232:235], v[52:55], v[160:163]
s_waitcnt lgkmcnt(6)
ds_read_b64_tr_b16 a[232:233], v206 offset:8192
ds_read_b64_tr_b16 a[234:235], v206 offset:10240
v_mfma_f32_16x16x32_bf16 v[148:151], a[236:239], v[48:51], v[148:151]
buffer_load_dwordx4 a[28:31], v234, s[76:79], s94 offen offset:3072 sc0 sc1
v_mfma_f32_16x16x32_bf16 v[164:167], a[236:239], v[52:55], v[164:167]
ds_read_b64_tr_b16 a[236:237], v207 offset:8192
ds_read_b64_tr_b16 a[238:239], v207 offset:10240
v_mfma_f32_16x16x32_bf16 v[72:75], a[192:195], v[56:59], v[72:75]
s_add_u32 s94, s39, 0
v_mfma_f32_16x16x32_bf16 v[104:107], a[192:195], v[60:63], v[104:107]
buffer_load_dwordx4 a[32:35], v234, s[76:79], s94 offen offset:0 sc0 sc1
v_mfma_f32_16x16x32_bf16 v[76:79], a[196:199], v[56:59], v[76:79]
ds_read_b64_tr_b16 a[192:193], v176 offset:24576
ds_read_b64_tr_b16 a[194:195], v176 offset:28672
v_mfma_f32_16x16x32_bf16 v[108:111], a[196:199], v[60:63], v[108:111]
ds_read_b64_tr_b16 a[196:197], v177 offset:24576
ds_read_b64_tr_b16 a[198:199], v177 offset:28672
v_mfma_f32_16x16x32_bf16 v[80:83], a[200:203], v[56:59], v[80:83]
buffer_load_dwordx4 a[36:39], v234, s[76:79], s94 offen offset:1024 sc0 sc1
v_mfma_f32_16x16x32_bf16 v[112:115], a[200:203], v[60:63], v[112:115]
ds_read_b64_tr_b16 a[200:201], v178 offset:24576
ds_read_b64_tr_b16 a[202:203], v178 offset:28672
v_mfma_f32_16x16x32_bf16 v[84:87], a[204:207], v[56:59], v[84:87]
v_mfma_f32_16x16x32_bf16 v[116:119], a[204:207], v[60:63], v[116:119]
buffer_load_dwordx4 a[40:43], v234, s[76:79], s94 offen offset:2048 sc0 sc1
v_mfma_f32_16x16x32_bf16 v[88:91], a[208:211], v[56:59], v[88:91]
ds_read_b64_tr_b16 a[204:205], v179 offset:24576
ds_read_b64_tr_b16 a[206:207], v179 offset:28672
v_mfma_f32_16x16x32_bf16 v[120:123], a[208:211], v[60:63], v[120:123]
ds_read_b64_tr_b16 a[208:209], v180 offset:24576
ds_read_b64_tr_b16 a[210:211], v180 offset:28672
v_mfma_f32_16x16x32_bf16 v[92:95], a[212:215], v[56:59], v[92:95]
buffer_load_dwordx4 a[44:47], v234, s[76:79], s94 offen offset:3072 sc0 sc1
v_mfma_f32_16x16x32_bf16 v[124:127], a[212:215], v[60:63], v[124:127]
s_add_u32 s94, s39, 4096
ds_read_b64_tr_b16 a[212:213], v181 offset:24576
ds_read_b64_tr_b16 a[214:215], v181 offset:28672
v_mfma_f32_16x16x32_bf16 v[96:99], a[216:219], v[56:59], v[96:99]
v_mfma_f32_16x16x32_bf16 v[128:131], a[216:219], v[60:63], v[128:131]
s_waitcnt lgkmcnt(6)
buffer_load_dwordx4 a[48:51], v234, s[76:79], s94 offen offset:0 sc0 sc1
v_mfma_f32_16x16x32_bf16 v[100:103], a[220:223], v[56:59], v[100:103]
ds_read_b64_tr_b16 a[216:217], v182 offset:24576
ds_read_b64_tr_b16 a[218:219], v182 offset:28672
v_mfma_f32_16x16x32_bf16 v[132:135], a[220:223], v[60:63], v[132:135]
ds_read_b64_tr_b16 a[220:221], v183 offset:24576
ds_read_b64_tr_b16 a[222:223], v183 offset:28672
v_mfma_f32_16x16x32_bf16 v[136:139], a[224:227], v[56:59], v[136:139]
buffer_load_dwordx4 a[52:55], v234, s[76:79], s94 offen offset:1024 sc0 sc1
v_mfma_f32_16x16x32_bf16 v[152:155], a[224:227], v[60:63], v[152:155]
ds_read_b64_tr_b16 a[224:225], v204 offset:12288
ds_read_b64_tr_b16 a[226:227], v204 offset:14336
v_mfma_f32_16x16x32_bf16 v[140:143], a[228:231], v[56:59], v[140:143]
v_mfma_f32_16x16x32_bf16 v[156:159], a[228:231], v[60:63], v[156:159]
buffer_load_dwordx4 a[56:59], v234, s[76:79], s94 offen offset:2048 sc0 sc1
v_mfma_f32_16x16x32_bf16 v[144:147], a[232:235], v[56:59], v[144:147]
ds_read_b64_tr_b16 a[228:229], v205 offset:12288
ds_read_b64_tr_b16 a[230:231], v205 offset:14336
v_mfma_f32_16x16x32_bf16 v[160:163], a[232:235], v[60:63], v[160:163]
ds_read_b64_tr_b16 a[232:233], v206 offset:12288
ds_read_b64_tr_b16 a[234:235], v206 offset:14336
v_mfma_f32_16x16x32_bf16 v[148:151], a[236:239], v[56:59], v[148:151]
buffer_load_dwordx4 a[60:63], v234, s[76:79], s94 offen offset:3072 sc0 sc1
v_mfma_f32_16x16x32_bf16 v[164:167], a[236:239], v[60:63], v[164:167]
ds_read_b64_tr_b16 a[236:237], v207 offset:12288
ds_read_b64_tr_b16 a[238:239], v207 offset:14336
v_mfma_f32_16x16x32_bf16 v[72:75], a[192:195], v[64:67], v[72:75]
v_mfma_f32_16x16x32_bf16 v[104:107], a[192:195], v[68:71], v[104:107]
v_mfma_f32_16x16x32_bf16 v[76:79], a[196:199], v[64:67], v[76:79]
v_mfma_f32_16x16x32_bf16 v[108:111], a[196:199], v[68:71], v[108:111]
v_mfma_f32_16x16x32_bf16 v[80:83], a[200:203], v[64:67], v[80:83]
s_add_u32 s94, s40, 0
buffer_load_dwordx4 a[64:67], v234, s[76:79], s94 offen offset:0 sc0 sc1
buffer_load_dwordx4 a[68:71], v234, s[76:79], s94 offen offset:1024 sc0 sc1
buffer_load_dwordx4 a[72:75], v234, s[76:79], s94 offen offset:2048 sc0 sc1
buffer_load_dwordx4 a[76:79], v234, s[76:79], s94 offen offset:3072 sc0 sc1
s_add_u32 s94, s40, 4096
buffer_load_dwordx4 a[80:83], v234, s[76:79], s94 offen offset:0 sc0 sc1
buffer_load_dwordx4 a[84:87], v234, s[76:79], s94 offen offset:1024 sc0 sc1
buffer_load_dwordx4 a[88:91], v234, s[76:79], s94 offen offset:2048 sc0 sc1
buffer_load_dwordx4 a[92:95], v234, s[76:79], s94 offen offset:3072 sc0 sc1
s_waitcnt vmcnt(35) lgkmcnt(0)
s_barrier
s_cmp_lg_u32 s92, 0
s_cbranch_scc1 K_F0DONE0
K_F0SPIN0:
buffer_load_dword v241, v6, s[20:23], s54 offen sc0 sc1
s_waitcnt vmcnt(0)
v_cmp_ne_u32 vcc, 1, v241
s_and_b32 s46, vcc_lo, 0x55
s_cbranch_scc0 K_F0OK0
s_sleep 1
s_add_u32 s100, s100, 1
s_bitcmp1_b32 s100, 19
s_cbranch_scc1 K_END
s_branch K_F0SPIN0
K_F0OK0:
s_mov_b32 s78, 0x4000000
s_add_u32 s94, s38, 0
buffer_load_dwordx4 a[0:3], v234, s[76:79], s94 offen offset:0 sc0 sc1
buffer_load_dwordx4 a[4:7], v234, s[76:79], s94 offen offset:1024 sc0 sc1
buffer_load_dwordx4 a[8:11], v234, s[76:79], s94 offen offset:2048 sc0 sc1
buffer_load_dwordx4 a[12:15], v234, s[76:79], s94 offen offset:3072 sc0 sc1
s_add_u32 s94, s38, 4096
buffer_load_dwordx4 a[16:19], v234, s[76:79], s94 offen offset:0 sc0 sc1
buffer_load_dwordx4 a[20:23], v234, s[76:79], s94 offen offset:1024 sc0 sc1
buffer_load_dwordx4 a[24:27], v234, s[76:79], s94 offen offset:2048 sc0 sc1
buffer_load_dwordx4 a[28:31], v234, s[76:79], s94 offen offset:3072 sc0 sc1
s_add_u32 s94, s39, 0
buffer_load_dwordx4 a[32:35], v234, s[76:79], s94 offen offset:0 sc0 sc1
buffer_load_dwordx4 a[36:39], v234, s[76:79], s94 offen offset:1024 sc0 sc1
buffer_load_dwordx4 a[40:43], v234, s[76:79], s94 offen offset:2048 sc0 sc1
buffer_load_dwordx4 a[44:47], v234, s[76:79], s94 offen offset:3072 sc0 sc1
s_add_u32 s94, s39, 4096
buffer_load_dwordx4 a[48:51], v234, s[76:79], s94 offen offset:0 sc0 sc1
buffer_load_dwordx4 a[52:55], v234, s[76:79], s94 offen offset:1024 sc0 sc1
buffer_load_dwordx4 a[56:59], v234, s[76:79], s94 offen offset:2048 sc0 sc1
buffer_load_dwordx4 a[60:63], v234, s[76:79], s94 offen offset:3072 sc0 sc1
s_add_u32 s94, s40, 0
buffer_load_dwordx4 a[64:67], v234, s[76:79], s94 offen offset:0 sc0 sc1
buffer_load_dwordx4 a[68:71], v234, s[76:79], s94 offen offset:1024 sc0 sc1
buffer_load_dwordx4 a[72:75], v234, s[76:79], s94 offen offset:2048 sc0 sc1
buffer_load_dwordx4 a[76:79], v234, s[76:79], s94 offen offset:3072 sc0 sc1
s_add_u32 s94, s40, 4096
buffer_load_dwordx4 a[80:83], v234, s[76:79], s94 offen offset:0 sc0 sc1
buffer_load_dwordx4 a[84:87], v234, s[76:79], s94 offen offset:1024 sc0 sc1
buffer_load_dwordx4 a[88:91], v234, s[76:79], s94 offen offset:2048 sc0 sc1
buffer_load_dwordx4 a[92:95], v234, s[76:79], s94 offen offset:3072 sc0 sc1
K_F0DONE0:
v_mfma_f32_16x16x32_bf16 v[112:115], a[200:203], v[68:71], v[112:115]
ds_read_b64_tr_b16 a[192:193], v184 offset:0
ds_read_b64_tr_b16 a[194:195], v184 offset:4096
v_mfma_f32_16x16x32_bf16 v[84:87], a[204:207], v[64:67], v[84:87]
ds_read_b64_tr_b16 a[196:197], v185 offset:0
ds_read_b64_tr_b16 a[198:199], v185 offset:4096
v_mfma_f32_16x16x32_bf16 v[116:119], a[204:207], v[68:71], v[116:119]
ds_read_b64_tr_b16 a[200:201], v186 offset:0
ds_read_b64_tr_b16 a[202:203], v186 offset:4096
v_mfma_f32_16x16x32_bf16 v[88:91], a[208:211], v[64:67], v[88:91]
ds_read_b64_tr_b16 a[204:205], v187 offset:0
ds_read_b64_tr_b16 a[206:207], v187 offset:4096
v_mfma_f32_16x16x32_bf16 v[120:123], a[208:211], v[68:71], v[120:123]
ds_read_b64_tr_b16 a[208:209], v188 offset:0
ds_read_b64_tr_b16 a[210:211], v188 offset:4096
v_mfma_f32_16x16x32_bf16 v[92:95], a[212:215], v[64:67], v[92:95]
v_mfma_f32_16x16x32_bf16 v[124:127], a[212:215], v[68:71], v[124:127]
ds_read_b64_tr_b16 a[212:213], v189 offset:0
ds_read_b64_tr_b16 a[214:215], v189 offset:4096
v_mfma_f32_16x16x32_bf16 v[96:99], a[216:219], v[64:67], v[96:99]
v_mfma_f32_16x16x32_bf16 v[128:131], a[216:219], v[68:71], v[128:131]
ds_read_b64_tr_b16 a[216:217], v190 offset:0
ds_read_b64_tr_b16 a[218:219], v190 offset:4096
v_mfma_f32_16x16x32_bf16 v[100:103], a[220:223], v[64:67], v[100:103]
v_mfma_f32_16x16x32_bf16 v[132:135], a[220:223], v[68:71], v[132:135]
ds_read_b64_tr_b16 a[220:221], v191 offset:0
ds_read_b64_tr_b16 a[222:223], v191 offset:4096
v_mfma_f32_16x16x32_bf16 v[136:139], a[224:227], v[64:67], v[136:139]
v_mfma_f32_16x16x32_bf16 v[152:155], a[224:227], v[68:71], v[152:155]
v_mfma_f32_16x16x32_bf16 v[140:143], a[228:231], v[64:67], v[140:143]
v_mfma_f32_16x16x32_bf16 v[156:159], a[228:231], v[68:71], v[156:159]
v_mfma_f32_16x16x32_bf16 v[144:147], a[232:235], v[64:67], v[144:147]
v_mfma_f32_16x16x32_bf16 v[160:163], a[232:235], v[68:71], v[160:163]
v_mfma_f32_16x16x32_bf16 v[148:151], a[236:239], v[64:67], v[148:151]
v_mfma_f32_16x16x32_bf16 v[164:167], a[236:239], v[68:71], v[164:167]
s_waitcnt lgkmcnt(6)
s_branch K_P2F
K_GD:
v_bfe_u32 v5, v1, 2, 2
v_and_b32 v216, 3, v1
v_lshl_add_u32 v7, v4, 3, v5
v_lshlrev_b32 v7, 6, v7
v_lshl_add_u32 v7, v216, 3, v7
s_and_b32 s46, s32, 1
s_lshl_b32 s46, s46, 5
s_cmp_lt_u32 s32, 2
s_cselect_b32 s47, 0, 131072
s_mov_b32 s94, 125952
s_cselect_b32 s94, 32768, s94
s_add_u32 s47, s46, s47
v_add_u32 v208, s47, v7
s_add_u32 s46, s46, s94
v_add_u32 v209, s46, v7
ds_read_b64_tr_b16 v[72:73], v208 offset:0
ds_read_b64_tr_b16 v[74:75], v208 offset:256
ds_read_b64_tr_b16 v[76:77], v208 offset:2048
ds_read_b64_tr_b16 v[78:79], v208 offset:2304
ds_read_b64_tr_b16 v[80:81], v208 offset:4096
ds_read_b64_tr_b16 v[82:83], v208 offset:4352
ds_read_b64_tr_b16 v[84:85], v208 offset:6144
ds_read_b64_tr_b16 v[86:87], v208 offset:6400
ds_read_b64_tr_b16 v[88:89], v208 offset:8192
ds_read_b64_tr_b16 v[90:91], v208 offset:8448
ds_read_b64_tr_b16 v[92:93], v208 offset:10240
ds_read_b64_tr_b16 v[94:95], v208 offset:10496
ds_read_b64_tr_b16 v[96:97], v208 offset:12288
ds_read_b64_tr_b16 v[98:99], v208 offset:12544
v_lshl_add_u32 v7, v4, 2, v5
v_mul_u32_u24 v7, 0x480, v7
v_lshl_add_u32 v7, v216, 3, v7
s_mul_i32 s46, s32, 288
s_add_u32 s46, s46, 98304
v_add_u32 v210, s46, v7
v_add_u32 v211, 18432, v210
v_subrev_u32 v7, 89088, v211
v_cmp_lt_u32 vcc, 31, v1
s_nop 1
v_cndmask_b32 v211, v211, v7, vcc
ds_read_b64_tr_b16 v[100:101], v208 offset:14336
ds_read_b64_tr_b16 v[102:103], v208 offset:14592
s_waitcnt lgkmcnt(14)
v_mfma_f32_16x16x32_bf16 v[212:215], v[72:75], v[104:107], 0
ds_read_b64_tr_b16 v[72:73], v208 offset:16384
ds_read_b64_tr_b16 v[74:75], v208 offset:16640
s_waitcnt lgkmcnt(14)
v_mfma_f32_16x16x32_bf16 v[212:215], v[76:79], v[108:111], v[212:215]
ds_read_b64_tr_b16 v[76:77], v208 offset:18432
ds_read_b64_tr_b16 v[78:79], v208 offset:18688
s_waitcnt lgkmcnt(14)
v_mfma_f32_16x16x32_bf16 v[212:215], v[80:83], v[112:115], v[212:215]
ds_read_b64_tr_b16 v[80:81], v208 offset:20480
ds_read_b64_tr_b16 v[82:83], v208 offset:20736
s_waitcnt lgkmcnt(14)
v_mfma_f32_16x16x32_bf16 v[212:215], v[84:87], v[116:119], v[212:215]
ds_read_b64_tr_b16 v[84:85], v208 offset:22528
ds_read_b64_tr_b16 v[86:87], v208 offset:22784
s_waitcnt lgkmcnt(14)
v_mfma_f32_16x16x32_bf16 v[212:215], v[88:91], v[120:123], v[212:215]
ds_read_b64_tr_b16 v[88:89], v208 offset:24576
ds_read_b64_tr_b16 v[90:91], v208 offset:24832
s_waitcnt lgkmcnt(14)
v_mfma_f32_16x16x32_bf16 v[212:215], v[92:95], v[124:127], v[212:215]
ds_read_b64_tr_b16 v[92:93], v208 offset:26624
ds_read_b64_tr_b16 v[94:95], v208 offset:26880
s_waitcnt lgkmcnt(14)
v_mfma_f32_16x16x32_bf16 v[212:215], v[96:99], v[128:131], v[212:215]
ds_read_b64_tr_b16 v[96:97], v208 offset:28672
ds_read_b64_tr_b16 v[98:99], v208 offset:28928
s_waitcnt lgkmcnt(14)
v_mfma_f32_16x16x32_bf16 v[212:215], v[100:103], v[132:135], v[212:215]
ds_read_b64_tr_b16 v[100:101], v208 offset:30720
ds_read_b64_tr_b16 v[102:103], v208 offset:30976
s_waitcnt lgkmcnt(14)
v_mfma_f32_16x16x32_bf16 v[212:215], v[72:75], a[192:195], v[212:215]
ds_read_b64_tr_b16 v[72:73], v209 offset:0
ds_read_b64_tr_b16 v[74:75], v209 offset:256
s_waitcnt lgkmcnt(14)
v_mfma_f32_16x16x32_bf16 v[212:215], v[76:79], a[196:199], v[212:215]
ds_read_b64_tr_b16 v[76:77], v209 offset:2048
ds_read_b64_tr_b16 v[78:79], v209 offset:2304
s_waitcnt lgkmcnt(14)
v_mfma_f32_16x16x32_bf16 v[212:215], v[80:83], a[200:203], v[212:215]
ds_read_b64_tr_b16 a[0:1], v210 offset:0
ds_read_b64_tr_b16 a[2:3], v211 offset:0
s_waitcnt lgkmcnt(14)
v_mfma_f32_16x16x32_bf16 v[212:215], v[84:87], a[204:207], v[212:215]
ds_read_b64_tr_b16 a[4:5], v210 offset:32
ds_read_b64_tr_b16 a[6:7], v211 offset:32
s_waitcnt lgkmcnt(14)
v_mfma_f32_16x16x32_bf16 v[212:215], v[88:91], a[212:215], v[212:215]
ds_read_b64_tr_b16 a[8:9], v210 offset:64
ds_read_b64_tr_b16 a[10:11], v211 offset:64
s_waitcnt lgkmcnt(14)
v_mfma_f32_16x16x32_bf16 v[212:215], v[92:95], a[216:219], v[212:215]
ds_read_b64_tr_b16 a[12:13], v210 offset:96
ds_read_b64_tr_b16 a[14:15], v211 offset:96
s_waitcnt lgkmcnt(14)
v_mfma_f32_16x16x32_bf16 v[212:215], v[96:99], a[220:223], v[212:215]
ds_read_b64_tr_b16 a[16:17], v210 offset:128
ds_read_b64_tr_b16 a[18:19], v211 offset:128
s_waitcnt lgkmcnt(14)
v_mfma_f32_16x16x32_bf16 v[212:215], v[100:103], a[224:227], v[212:215]
ds_read_b64_tr_b16 a[20:21], v210 offset:160
ds_read_b64_tr_b16 a[22:23], v211 offset:160
s_waitcnt lgkmcnt(14)
v_mfma_f32_16x16x32_bf16 v[212:215], v[72:75], a[228:231], v[212:215]
ds_read_b64_tr_b16 a[24:25], v210 offset:192
ds_read_b64_tr_b16 a[26:27], v211 offset:192
s_waitcnt lgkmcnt(14)
v_mfma_f32_16x16x32_bf16 v[212:215], v[76:79], a[232:235], v[212:215]
ds_read_b64_tr_b16 a[28:29], v210 offset:224
ds_read_b64_tr_b16 a[30:31], v211 offset:224
ds_read_b64_tr_b16 a[32:33], v210 offset:256
ds_read_b64_tr_b16 a[34:35], v211 offset:256
v_lshlrev_b32 v5, 3, v1
v_add_u32 v5, 47104, v5
s_lshl_b32 s46, s32, 9
v_add_u32 v7, s46, v5
s_nop 0
v_cvt_pk_bf16_f32 v216, v212, v213
v_cvt_pk_bf16_f32 v217, v214, v215
s_cmp_lt_u32 s32, 2
s_cbranch_scc0 K_NOSILU
v_lshlrev_b32 v212, 16, v216
v_and_b32 v213, 0xffff0000, v216
v_lshlrev_b32 v214, 16, v217
v_and_b32 v215, 0xffff0000, v217
v_mul_f32 v216, 0xbfb8aa3b, v212
v_mul_f32 v217, 0xbfb8aa3b, v213
v_mul_f32 v218, 0xbfb8aa3b, v214
v_mul_f32 v219, 0xbfb8aa3b, v215
v_exp_f32 v216, v216
v_exp_f32 v217, v217
v_exp_f32 v218, v218
v_exp_f32 v219, v219
s_nop 0
v_add_f32 v216, 1.0, v216
v_add_f32 v217, 1.0, v217
v_add_f32 v218, 1.0, v218
v_add_f32 v219, 1.0, v219
v_rcp_f32 v216, v216
v_rcp_f32 v217, v217
v_rcp_f32 v218, v218
v_rcp_f32 v219, v219
s_nop 0
v_mul_f32 v212, v212, v216
v_mul_f32 v213, v213, v217
v_mul_f32 v214, v214, v218
v_mul_f32 v215, v215, v219
v_cvt_pk_bf16_f32 v216, v212, v213
v_cvt_pk_bf16_f32 v217, v214, v215
K_NOSILU:
ds_write_b64 v7, v[216:217]
s_waitcnt lgkmcnt(0)
s_barrier
ds_read_b64 v[72:73], v5 offset:0
ds_read_b64 v[74:75], v5 offset:512
ds_read_b64 v[76:77], v5 offset:1024
ds_read_b64 v[78:79], v5 offset:1536
s_add_u32 s94, s81, s3
s_add_u32 s95, s73, s3
s_add_u32 m0, s94, 0
s_add_u32 s48, s51, 147456
buffer_load_dwordx4 v236, s[16:19], s48 offen lds
s_add_u32 m0, s94, 4096
s_add_u32 s48, s51, 165888
buffer_load_dwordx4 v236, s[16:19], s48 offen lds
s_add_u32 m0, s94, 8192
s_add_u32 s48, s51, 184320
buffer_load_dwordx4 v236, s[16:19], s48 offen lds
s_add_u32 m0, s94, 12288
s_add_u32 s48, s51, 202752
buffer_load_dwordx4 v236, s[16:19], s48 offen lds
s_waitcnt lgkmcnt(0)
v_lshlrev_b32 v80, 16, v72
v_and_b32 v81, 0xffff0000, v72
v_lshlrev_b32 v82, 16, v73
v_and_b32 v83, 0xffff0000, v73
v_lshlrev_b32 v84, 16, v74
v_and_b32 v85, 0xffff0000, v74
v_lshlrev_b32 v86, 16, v75
v_and_b32 v87, 0xffff0000, v75
v_lshlrev_b32 v88, 16, v76
v_and_b32 v89, 0xffff0000, v76
v_lshlrev_b32 v90, 16, v77
v_and_b32 v91, 0xffff0000, v77
v_lshlrev_b32 v92, 16, v78
v_and_b32 v93, 0xffff0000, v78
v_lshlrev_b32 v94, 16, v79
v_and_b32 v95, 0xffff0000, v79
v_pk_mul_f32 v[80:81], v[80:81], v[88:89]
v_pk_mul_f32 v[82:83], v[82:83], v[90:91]
v_pk_mul_f32 v[84:85], v[84:85], v[92:93]
v_pk_mul_f32 v[86:87], v[86:87], v[94:95]
v_cvt_pk_bf16_f32 v240, v80, v81
v_cvt_pk_bf16_f32 v241, v82, v83
v_cvt_pk_bf16_f32 v242, v84, v85
v_cvt_pk_bf16_f32 v243, v86, v87
s_mul_i32 s46, s32, 4608
s_add_u32 s46, s46, 16384
v_mul_u32_u24 v5, 576, v3
v_lshl_add_u32 v5, v4, 4, v5
v_add_u32 v5, s46, v5
v_add_u32 v7, s46, v234
v_mfma_f32_16x16x32_bf16 v[104:107], a[0:3], v[240:243], 0
s_add_u32 m0, s94, 16384
s_add_u32 s48, s51, 221184
buffer_load_dwordx4 v236, s[16:19], s48 offen lds
v_mfma_f32_16x16x32_bf16 v[108:111], a[4:7], v[240:243], 0
s_add_u32 m0, s94, 20480
s_add_u32 s48, s51, 239616
buffer_load_dwordx4 v236, s[16:19], s48 offen lds
v_mfma_f32_16x16x32_bf16 v[112:115], a[8:11], v[240:243], 0
s_add_u32 m0, s94, 24576
s_add_u32 s48, s51, 258048
buffer_load_dwordx4 v236, s[16:19], s48 offen lds
v_mfma_f32_16x16x32_bf16 v[116:119], a[12:15], v[240:243], 0
s_add_u32 m0, s94, 28672
s_add_u32 s48, s51, 276480
buffer_load_dwordx4 v236, s[16:19], s48 offen lds
v_mfma_f32_16x16x32_bf16 v[120:123], a[16:19], v[240:243], 0
s_add_u32 m0, s95, 0
s_add_u32 s48, s75, 147456
buffer_load_dwordx4 v237, s[16:19], s48 offen lds
v_mfma_f32_16x16x32_bf16 v[124:127], a[20:23], v[240:243], 0
s_add_u32 m0, s95, 4096
s_add_u32 s48, s75, 184320
buffer_load_dwordx4 v237, s[16:19], s48 offen lds
v_mfma_f32_16x16x32_bf16 v[128:131], a[24:27], v[240:243], 0
s_add_u32 m0, s95, 8192
s_add_u32 s48, s75, 221184
buffer_load_dwordx4 v237, s[16:19], s48 offen lds
v_mfma_f32_16x16x32_bf16 v[132:135], a[28:31], v[240:243], 0
s_add_u32 m0, s95, 12288
s_add_u32 s48, s75, 258048
buffer_load_dwordx4 v237, s[16:19], s48 offen lds
v_mfma_f32_16x16x32_bf16 v[136:139], a[32:35], v[240:243], 0
buffer_load_dword v241, v6, s[20:23], s54 offen sc0 sc1
v_add_u32 v72, 0, v1
v_mul_u32_u24 v80, 1821, v72
v_lshrrev_b32 v80, 16, v80
v_mul_u32_u24 v80, 1728, v80
v_lshl_add_u32 v72, v72, 4, v80
v_add_u32 v73, 64, v1
v_mul_u32_u24 v80, 1821, v73
v_lshrrev_b32 v80, 16, v80
v_mul_u32_u24 v80, 1728, v80
v_lshl_add_u32 v73, v73, 4, v80
v_add_u32 v74, 128, v1
v_mul_u32_u24 v80, 1821, v74
v_lshrrev_b32 v80, 16, v80
v_mul_u32_u24 v80, 1728, v80
v_lshl_add_u32 v74, v74, 4, v80
v_add_u32 v75, 192, v1
v_mul_u32_u24 v80, 1821, v75
v_lshrrev_b32 v80, 16, v80
v_mul_u32_u24 v80, 1728, v80
v_lshl_add_u32 v75, v75, 4, v80
v_add_u32 v76, 256, v1
v_mul_u32_u24 v80, 1821, v76
v_lshrrev_b32 v80, 16, v80
v_mul_u32_u24 v80, 1728, v80
v_lshl_add_u32 v76, v76, 4, v80
s_mov_b32 exec_lo, 0x00ff00ff
s_mov_b32 exec_hi, 0x00ff00ff
ds_write_b128 v5, v[104:107] offset:0
ds_write_b128 v5, v[108:111] offset:64
ds_write_b128 v5, v[112:115] offset:128
ds_write_b128 v5, v[116:119] offset:192
ds_write_b128 v5, v[120:123] offset:256
ds_write_b128 v5, v[124:127] offset:320
ds_write_b128 v5, v[128:131] offset:384
ds_write_b128 v5, v[132:135] offset:448
ds_write_b128 v5, v[136:139] offset:512
s_mov_b64 exec, -1
s_sub_u32 s46, s52, 1
s_mul_i32 s46, s46, 18432
s_mul_i32 s47, s32, 576
s_add_u32 s46, s46, s47
s_add_u32 s46, s46, 0x2400000
ds_read_b128 v[144:147], v7 offset:0
ds_read_b128 v[148:151], v7 offset:1024
ds_read_b128 v[152:155], v7 offset:2048
ds_read_b128 v[156:159], v7 offset:3072
ds_read_b128 v[160:163], v7 offset:4096
s_waitcnt lgkmcnt(4)
buffer_store_dwordx4 v[144:147], v72, s[20:23], s46 offen sc0 sc1
s_waitcnt lgkmcnt(3)
buffer_store_dwordx4 v[148:151], v73, s[20:23], s46 offen sc0 sc1
s_waitcnt lgkmcnt(2)
buffer_store_dwordx4 v[152:155], v74, s[20:23], s46 offen sc0 sc1
s_waitcnt lgkmcnt(1)
buffer_store_dwordx4 v[156:159], v75, s[20:23], s46 offen sc0 sc1
s_waitcnt lgkmcnt(0)
s_mov_b32 exec_hi, 0
buffer_store_dwordx4 v[160:163], v76, s[20:23], s46 offen sc0 sc1
s_mov_b64 exec, -1
s_waitcnt vmcnt(19)
s_barrier
v_mov_b32 v5, 1
s_lshl_b32 s46, s36, 3
s_add_u32 s46, s46, s54
s_mov_b64 exec, 1
buffer_store_dword v5, v234, s[20:23], s46 offen offset:4 sc0 sc1
s_mov_b64 exec, -1
ds_read_b64_tr_b16 a[192:193], v168 offset:0
ds_read_b64_tr_b16 a[194:195], v168 offset:4096
ds_read_b64_tr_b16 a[196:197], v169 offset:0
ds_read_b64_tr_b16 a[198:199], v169 offset:4096
ds_read_b64_tr_b16 a[200:201], v170 offset:0
ds_read_b64_tr_b16 a[202:203], v170 offset:4096
ds_read_b64_tr_b16 a[204:205], v171 offset:0
ds_read_b64_tr_b16 a[206:207], v171 offset:4096
ds_read_b64_tr_b16 a[208:209], v172 offset:0
ds_read_b64_tr_b16 a[210:211], v172 offset:4096
ds_read_b64_tr_b16 a[212:213], v173 offset:0
ds_read_b64_tr_b16 a[214:215], v173 offset:4096
ds_read_b64_tr_b16 a[216:217], v174 offset:0
ds_read_b64_tr_b16 a[218:219], v174 offset:4096
ds_read_b64_tr_b16 a[220:221], v175 offset:0
ds_read_b64_tr_b16 a[222:223], v175 offset:4096
ds_read_b64_tr_b16 a[224:225], v200 offset:0
ds_read_b64_tr_b16 a[226:227], v200 offset:2048
ds_read_b64_tr_b16 a[228:229], v201 offset:0
ds_read_b64_tr_b16 a[230:231], v201 offset:2048
ds_read_b64_tr_b16 a[232:233], v202 offset:0
ds_read_b64_tr_b16 a[234:235], v202 offset:2048
ds_read_b64_tr_b16 a[236:237], v203 offset:0
ds_read_b64_tr_b16 a[238:239], v203 offset:2048
s_sub_u32 s87, s81, 0x10000
s_sub_u32 s88, s82, 0x10000
s_sub_u32 s89, s83, 0x10000
s_sub_u32 s86, s73, s72
s_add_u32 s80, s80, s3
s_add_u32 s81, s81, s3
s_add_u32 s82, s82, s3
s_add_u32 s83, s83, s3
s_waitcnt lgkmcnt(6)
v_mfma_f32_16x16x32_bf16 v[72:75], a[192:195], v[8:11], 0
s_add_u32 m0, s82, 0
v_add_u32 v176, s87, v220
v_add_u32 v177, s87, v221
v_mfma_f32_16x16x32_bf16 v[104:107], a[192:195], v[12:15], 0
s_add_u32 s48, s42, 0
buffer_load_dwordx4 v236, s[16:19], s48 offen lds
v_mfma_f32_16x16x32_bf16 v[76:79], a[196:199], v[8:11], 0
ds_read_b64_tr_b16 a[192:193], v168 offset:8192
ds_read_b64_tr_b16 a[194:195], v168 offset:12288
v_mfma_f32_16x16x32_bf16 v[108:111], a[196:199], v[12:15], 0
s_add_u32 m0, s82, 4096
ds_read_b64_tr_b16 a[196:197], v169 offset:8192
ds_read_b64_tr_b16 a[198:199], v169 offset:12288
v_mfma_f32_16x16x32_bf16 v[80:83], a[200:203], v[8:11], 0
s_add_u32 s48, s42, 18432
v_add_u32 v178, s87, v222
v_add_u32 v179, s87, v223
v_mfma_f32_16x16x32_bf16 v[112:115], a[200:203], v[12:15], 0
buffer_load_dwordx4 v236, s[16:19], s48 offen lds
v_mfma_f32_16x16x32_bf16 v[84:87], a[204:207], v[8:11], 0
ds_read_b64_tr_b16 a[200:201], v170 offset:8192
ds_read_b64_tr_b16 a[202:203], v170 offset:12288
v_mfma_f32_16x16x32_bf16 v[116:119], a[204:207], v[12:15], 0
s_add_u32 m0, s82, 8192
ds_read_b64_tr_b16 a[204:205], v171 offset:8192
ds_read_b64_tr_b16 a[206:207], v171 offset:12288
v_mfma_f32_16x16x32_bf16 v[88:91], a[208:211], v[8:11], 0
s_add_u32 s48, s42, 36864
v_add_u32 v180, s87, v224
v_add_u32 v181, s87, v225
v_mfma_f32_16x16x32_bf16 v[120:123], a[208:211], v[12:15], 0
buffer_load_dwordx4 v236, s[16:19], s48 offen lds
v_mfma_f32_16x16x32_bf16 v[92:95], a[212:215], v[8:11], 0
ds_read_b64_tr_b16 a[208:209], v172 offset:8192
ds_read_b64_tr_b16 a[210:211], v172 offset:12288
v_mfma_f32_16x16x32_bf16 v[124:127], a[212:215], v[12:15], 0
s_add_u32 m0, s82, 12288
ds_read_b64_tr_b16 a[212:213], v173 offset:8192
ds_read_b64_tr_b16 a[214:215], v173 offset:12288
v_mfma_f32_16x16x32_bf16 v[96:99], a[216:219], v[8:11], 0
s_add_u32 s48, s42, 55296
v_add_u32 v182, s87, v226
v_add_u32 v183, s87, v227
v_mfma_f32_16x16x32_bf16 v[128:131], a[216:219], v[12:15], 0
buffer_load_dwordx4 v236, s[16:19], s48 offen lds
v_mfma_f32_16x16x32_bf16 v[100:103], a[220:223], v[8:11], 0
ds_read_b64_tr_b16 a[216:217], v174 offset:8192
ds_read_b64_tr_b16 a[218:219], v174 offset:12288
v_mfma_f32_16x16x32_bf16 v[132:135], a[220:223], v[12:15], 0
s_add_u32 m0, s82, 16384
ds_read_b64_tr_b16 a[220:221], v175 offset:8192
ds_read_b64_tr_b16 a[222:223], v175 offset:12288
v_mfma_f32_16x16x32_bf16 v[136:139], a[224:227], v[8:11], 0
s_add_u32 s48, s42, 73728
v_add_u32 v204, s86, v200
v_add_u32 v205, s86, v201
v_mfma_f32_16x16x32_bf16 v[152:155], a[224:227], v[12:15], 0
s_waitcnt lgkmcnt(6)
buffer_load_dwordx4 v236, s[16:19], s48 offen lds
v_mfma_f32_16x16x32_bf16 v[140:143], a[228:231], v[8:11], 0
ds_read_b64_tr_b16 a[224:225], v200 offset:4096
ds_read_b64_tr_b16 a[226:227], v200 offset:6144
v_mfma_f32_16x16x32_bf16 v[156:159], a[228:231], v[12:15], 0
s_add_u32 m0, s82, 20480
ds_read_b64_tr_b16 a[228:229], v201 offset:4096
ds_read_b64_tr_b16 a[230:231], v201 offset:6144
v_mfma_f32_16x16x32_bf16 v[144:147], a[232:235], v[8:11], 0
s_add_u32 s48, s42, 92160
v_mfma_f32_16x16x32_bf16 v[160:163], a[232:235], v[12:15], 0
buffer_load_dwordx4 v236, s[16:19], s48 offen lds
v_mfma_f32_16x16x32_bf16 v[148:151], a[236:239], v[8:11], 0
ds_read_b64_tr_b16 a[232:233], v202 offset:4096
ds_read_b64_tr_b16 a[234:235], v202 offset:6144
v_mfma_f32_16x16x32_bf16 v[164:167], a[236:239], v[12:15], 0
ds_read_b64_tr_b16 a[236:237], v203 offset:4096
ds_read_b64_tr_b16 a[238:239], v203 offset:6144
v_mfma_f32_16x16x32_bf16 v[72:75], a[192:195], v[16:19], v[72:75]
s_add_u32 m0, s82, 24576
v_add_u32 v206, s86, v202
v_add_u32 v207, s86, v203
v_mfma_f32_16x16x32_bf16 v[104:107], a[192:195], v[20:23], v[104:107]
s_add_u32 s48, s42, 110592
buffer_load_dwordx4 v236, s[16:19], s48 offen lds
v_mfma_f32_16x16x32_bf16 v[76:79], a[196:199], v[16:19], v[76:79]
ds_read_b64_tr_b16 a[192:193], v168 offset:16384
ds_read_b64_tr_b16 a[194:195], v168 offset:20480
v_mfma_f32_16x16x32_bf16 v[108:111], a[196:199], v[20:23], v[108:111]
s_add_u32 m0, s82, 28672
ds_read_b64_tr_b16 a[196:197], v169 offset:16384
ds_read_b64_tr_b16 a[198:199], v169 offset:20480
v_mfma_f32_16x16x32_bf16 v[80:83], a[200:203], v[16:19], v[80:83]
s_add_u32 s48, s42, 129024
v_add_u32 v184, s88, v220
v_add_u32 v185, s88, v221
v_mfma_f32_16x16x32_bf16 v[112:115], a[200:203], v[20:23], v[112:115]
buffer_load_dwordx4 v236, s[16:19], s48 offen lds
v_mfma_f32_16x16x32_bf16 v[84:87], a[204:207], v[16:19], v[84:87]
ds_read_b64_tr_b16 a[200:201], v170 offset:16384
ds_read_b64_tr_b16 a[202:203], v170 offset:20480
v_mfma_f32_16x16x32_bf16 v[116:119], a[204:207], v[20:23], v[116:119]
s_add_u32 m0, s83, 0
ds_read_b64_tr_b16 a[204:205], v171 offset:16384
ds_read_b64_tr_b16 a[206:207], v171 offset:20480
v_mfma_f32_16x16x32_bf16 v[88:91], a[208:211], v[16:19], v[88:91]
s_add_u32 s48, s43, 0
v_add_u32 v186, s88, v222
v_add_u32 v187, s88, v223
v_mfma_f32_16x16x32_bf16 v[120:123], a[208:211], v[20:23], v[120:123]
s_waitcnt lgkmcnt(6)
buffer_load_dwordx4 v236, s[16:19], s48 offen lds
v_mfma_f32_16x16x32_bf16 v[92:95], a[212:215], v[16:19], v[92:95]
ds_read_b64_tr_b16 a[208:209], v172 offset:16384
ds_read_b64_tr_b16 a[210:211], v172 offset:20480
v_mfma_f32_16x16x32_bf16 v[124:127], a[212:215], v[20:23], v[124:127]
s_add_u32 m0, s83, 4096
ds_read_b64_tr_b16 a[212:213], v173 offset:16384
ds_read_b64_tr_b16 a[214:215], v173 offset:20480
v_mfma_f32_16x16x32_bf16 v[96:99], a[216:219], v[16:19], v[96:99]
s_add_u32 s48, s43, 18432
v_add_u32 v188, s88, v224
v_add_u32 v189, s88, v225
v_mfma_f32_16x16x32_bf16 v[128:131], a[216:219], v[20:23], v[128:131]
buffer_load_dwordx4 v236, s[16:19], s48 offen lds
v_mfma_f32_16x16x32_bf16 v[100:103], a[220:223], v[16:19], v[100:103]
ds_read_b64_tr_b16 a[216:217], v174 offset:16384
ds_read_b64_tr_b16 a[218:219], v174 offset:20480
v_mfma_f32_16x16x32_bf16 v[132:135], a[220:223], v[20:23], v[132:135]
s_add_u32 m0, s83, 8192
ds_read_b64_tr_b16 a[220:221], v175 offset:16384
ds_read_b64_tr_b16 a[222:223], v175 offset:20480
v_mfma_f32_16x16x32_bf16 v[136:139], a[224:227], v[16:19], v[136:139]
s_add_u32 s48, s43, 36864
v_add_u32 v190, s88, v226
v_add_u32 v191, s88, v227
v_mfma_f32_16x16x32_bf16 v[152:155], a[224:227], v[20:23], v[152:155]
buffer_load_dwordx4 v236, s[16:19], s48 offen lds
v_mfma_f32_16x16x32_bf16 v[140:143], a[228:231], v[16:19], v[140:143]
ds_read_b64_tr_b16 a[224:225], v200 offset:8192
ds_read_b64_tr_b16 a[226:227], v200 offset:10240
v_mfma_f32_16x16x32_bf16 v[156:159], a[228:231], v[20:23], v[156:159]
s_add_u32 m0, s83, 12288
ds_read_b64_tr_b16 a[228:229], v201 offset:8192
ds_read_b64_tr_b16 a[230:231], v201 offset:10240
v_mfma_f32_16x16x32_bf16 v[144:147], a[232:235], v[16:19], v[144:147]
s_add_u32 s48, s43, 55296
v_mfma_f32_16x16x32_bf16 v[160:163], a[232:235], v[20:23], v[160:163]
buffer_load_dwordx4 v236, s[16:19], s48 offen lds
v_mfma_f32_16x16x32_bf16 v[148:151], a[236:239], v[16:19], v[148:151]
ds_read_b64_tr_b16 a[232:233], v202 offset:8192
ds_read_b64_tr_b16 a[234:235], v202 offset:10240
v_mfma_f32_16x16x32_bf16 v[164:167], a[236:239], v[20:23], v[164:167]
ds_read_b64_tr_b16 a[236:237], v203 offset:8192
ds_read_b64_tr_b16 a[238:239], v203 offset:10240
v_mfma_f32_16x16x32_bf16 v[72:75], a[192:195], v[24:27], v[72:75]
s_add_u32 m0, s83, 16384
v_add_u32 v192, s89, v220
v_add_u32 v193, s89, v221
v_mfma_f32_16x16x32_bf16 v[104:107], a[192:195], v[28:31], v[104:107]
s_waitcnt lgkmcnt(6)
s_add_u32 s48, s43, 73728
buffer_load_dwordx4 v236, s[16:19], s48 offen lds
v_mfma_f32_16x16x32_bf16 v[76:79], a[196:199], v[24:27], v[76:79]
ds_read_b64_tr_b16 a[192:193], v168 offset:24576
ds_read_b64_tr_b16 a[194:195], v168 offset:28672
v_mfma_f32_16x16x32_bf16 v[108:111], a[196:199], v[28:31], v[108:111]
s_add_u32 m0, s83, 20480
ds_read_b64_tr_b16 a[196:197], v169 offset:24576
ds_read_b64_tr_b16 a[198:199], v169 offset:28672
v_mfma_f32_16x16x32_bf16 v[80:83], a[200:203], v[24:27], v[80:83]
s_add_u32 s48, s43, 92160
v_add_u32 v194, s89, v222
v_add_u32 v195, s89, v223
v_mfma_f32_16x16x32_bf16 v[112:115], a[200:203], v[28:31], v[112:115]
buffer_load_dwordx4 v236, s[16:19], s48 offen lds
v_mfma_f32_16x16x32_bf16 v[84:87], a[204:207], v[24:27], v[84:87]
ds_read_b64_tr_b16 a[200:201], v170 offset:24576
ds_read_b64_tr_b16 a[202:203], v170 offset:28672
v_mfma_f32_16x16x32_bf16 v[116:119], a[204:207], v[28:31], v[116:119]
s_add_u32 m0, s83, 24576
ds_read_b64_tr_b16 a[204:205], v171 offset:24576
ds_read_b64_tr_b16 a[206:207], v171 offset:28672
v_mfma_f32_16x16x32_bf16 v[88:91], a[208:211], v[24:27], v[88:91]
s_add_u32 s48, s43, 110592
v_add_u32 v196, s89, v224
v_add_u32 v197, s89, v225
v_mfma_f32_16x16x32_bf16 v[120:123], a[208:211], v[28:31], v[120:123]
buffer_load_dwordx4 v236, s[16:19], s48 offen lds
v_mfma_f32_16x16x32_bf16 v[92:95], a[212:215], v[24:27], v[92:95]
ds_read_b64_tr_b16 a[208:209], v172 offset:24576
ds_read_b64_tr_b16 a[210:211], v172 offset:28672
v_mfma_f32_16x16x32_bf16 v[124:127], a[212:215], v[28:31], v[124:127]
s_add_u32 m0, s83, 28672
ds_read_b64_tr_b16 a[212:213], v173 offset:24576
ds_read_b64_tr_b16 a[214:215], v173 offset:28672
v_mfma_f32_16x16x32_bf16 v[96:99], a[216:219], v[24:27], v[96:99]
s_add_u32 s48, s43, 129024
v_add_u32 v198, s89, v226
v_add_u32 v199, s89, v227
v_mfma_f32_16x16x32_bf16 v[128:131], a[216:219], v[28:31], v[128:131]
buffer_load_dwordx4 v236, s[16:19], s48 offen lds
v_mfma_f32_16x16x32_bf16 v[100:103], a[220:223], v[24:27], v[100:103]
ds_read_b64_tr_b16 a[216:217], v174 offset:24576
ds_read_b64_tr_b16 a[218:219], v174 offset:28672
v_mfma_f32_16x16x32_bf16 v[132:135], a[220:223], v[28:31], v[132:135]
ds_read_b64_tr_b16 a[220:221], v175 offset:24576
ds_read_b64_tr_b16 a[222:223], v175 offset:28672
v_mfma_f32_16x16x32_bf16 v[136:139], a[224:227], v[24:27], v[136:139]
v_mfma_f32_16x16x32_bf16 v[152:155], a[224:227], v[28:31], v[152:155]
s_waitcnt lgkmcnt(6)
ds_read_b64_tr_b16 a[224:225], v200 offset:12288
ds_read_b64_tr_b16 a[226:227], v200 offset:14336
v_mfma_f32_16x16x32_bf16 v[140:143], a[228:231], v[24:27], v[140:143]
v_mfma_f32_16x16x32_bf16 v[156:159], a[228:231], v[28:31], v[156:159]
ds_read_b64_tr_b16 a[228:229], v201 offset:12288
ds_read_b64_tr_b16 a[230:231], v201 offset:14336
v_mfma_f32_16x16x32_bf16 v[144:147], a[232:235], v[24:27], v[144:147]
v_mfma_f32_16x16x32_bf16 v[160:163], a[232:235], v[28:31], v[160:163]
ds_read_b64_tr_b16 a[232:233], v202 offset:12288
ds_read_b64_tr_b16 a[234:235], v202 offset:14336
v_mfma_f32_16x16x32_bf16 v[148:151], a[236:239], v[24:27], v[148:151]
v_mfma_f32_16x16x32_bf16 v[164:167], a[236:239], v[28:31], v[164:167]
ds_read_b64_tr_b16 a[236:237], v203 offset:12288
ds_read_b64_tr_b16 a[238:239], v203 offset:14336
v_mfma_f32_16x16x32_bf16 v[72:75], a[192:195], v[32:35], v[72:75]
v_mfma_f32_16x16x32_bf16 v[104:107], a[192:195], v[36:39], v[104:107]
v_mfma_f32_16x16x32_bf16 v[76:79], a[196:199], v[32:35], v[76:79]
v_mfma_f32_16x16x32_bf16 v[108:111], a[196:199], v[36:39], v[108:111]
v_mfma_f32_16x16x32_bf16 v[80:83], a[200:203], v[32:35], v[80:83]
s_waitcnt vmcnt(22) lgkmcnt(0)
s_barrier
v_cmp_ne_u32 vcc, 1, v241
s_and_b32 s46, vcc_lo, 0x55
s_cselect_b32 s92, 0, 1
s_cselect_b32 s78, 0, 0x4000000
v_mfma_f32_16x16x32_bf16 v[112:115], a[200:203], v[36:39], v[112:115]
s_add_u32 s94, s38, 0
ds_read_b64_tr_b16 a[192:193], v176 offset:0
ds_read_b64_tr_b16 a[194:195], v176 offset:4096
v_mfma_f32_16x16x32_bf16 v[84:87], a[204:207], v[32:35], v[84:87]
buffer_load_dwordx4 a[0:3], v234, s[76:79], s94 offen offset:0 sc0 sc1
v_mfma_f32_16x16x32_bf16 v[116:119], a[204:207], v[36:39], v[116:119]
ds_read_b64_tr_b16 a[196:197], v177 offset:0
ds_read_b64_tr_b16 a[198:199], v177 offset:4096
v_mfma_f32_16x16x32_bf16 v[88:91], a[208:211], v[32:35], v[88:91]
ds_read_b64_tr_b16 a[200:201], v178 offset:0
ds_read_b64_tr_b16 a[202:203], v178 offset:4096
v_mfma_f32_16x16x32_bf16 v[120:123], a[208:211], v[36:39], v[120:123]
ds_read_b64_tr_b16 a[204:205], v179 offset:0
ds_read_b64_tr_b16 a[206:207], v179 offset:4096
v_mfma_f32_16x16x32_bf16 v[92:95], a[212:215], v[32:35], v[92:95]
buffer_load_dwordx4 a[4:7], v234, s[76:79], s94 offen offset:1024 sc0 sc1
v_mfma_f32_16x16x32_bf16 v[124:127], a[212:215], v[36:39], v[124:127]
ds_read_b64_tr_b16 a[208:209], v180 offset:0
ds_read_b64_tr_b16 a[210:211], v180 offset:4096
v_mfma_f32_16x16x32_bf16 v[96:99], a[216:219], v[32:35], v[96:99]
ds_read_b64_tr_b16 a[212:213], v181 offset:0
ds_read_b64_tr_b16 a[214:215], v181 offset:4096
v_mfma_f32_16x16x32_bf16 v[128:131], a[216:219], v[36:39], v[128:131]
ds_read_b64_tr_b16 a[216:217], v182 offset:0
ds_read_b64_tr_b16 a[218:219], v182 offset:4096
v_mfma_f32_16x16x32_bf16 v[100:103], a[220:223], v[32:35], v[100:103]
buffer_load_dwordx4 a[8:11], v234, s[76:79], s94 offen offset:2048 sc0 sc1
v_mfma_f32_16x16x32_bf16 v[132:135], a[220:223], v[36:39], v[132:135]
ds_read_b64_tr_b16 a[220:221], v183 offset:0
ds_read_b64_tr_b16 a[222:223], v183 offset:4096
v_mfma_f32_16x16x32_bf16 v[136:139], a[224:227], v[32:35], v[136:139]
v_mfma_f32_16x16x32_bf16 v[152:155], a[224:227], v[36:39], v[152:155]
ds_read_b64_tr_b16 a[224:225], v204 offset:0
ds_read_b64_tr_b16 a[226:227], v204 offset:2048
v_mfma_f32_16x16x32_bf16 v[140:143], a[228:231], v[32:35], v[140:143]
buffer_load_dwordx4 a[12:15], v234, s[76:79], s94 offen offset:3072 sc0 sc1
v_mfma_f32_16x16x32_bf16 v[156:159], a[228:231], v[36:39], v[156:159]
ds_read_b64_tr_b16 a[228:229], v205 offset:0
ds_read_b64_tr_b16 a[230:231], v205 offset:2048
v_mfma_f32_16x16x32_bf16 v[144:147], a[232:235], v[32:35], v[144:147]
v_mfma_f32_16x16x32_bf16 v[160:163], a[232:235], v[36:39], v[160:163]
ds_read_b64_tr_b16 a[232:233], v206 offset:0
ds_read_b64_tr_b16 a[234:235], v206 offset:2048
v_mfma_f32_16x16x32_bf16 v[148:151], a[236:239], v[32:35], v[148:151]
v_mfma_f32_16x16x32_bf16 v[164:167], a[236:239], v[36:39], v[164:167]
s_waitcnt lgkmcnt(6)
ds_read_b64_tr_b16 a[236:237], v207 offset:0
ds_read_b64_tr_b16 a[238:239], v207 offset:2048
v_mfma_f32_16x16x32_bf16 v[72:75], a[192:195], v[40:43], v[72:75]
s_add_u32 s94, s38, 4096
v_mfma_f32_16x16x32_bf16 v[104:107], a[192:195], v[44:47], v[104:107]
buffer_load_dwordx4 a[16:19], v234, s[76:79], s94 offen offset:0 sc0 sc1
v_mfma_f32_16x16x32_bf16 v[76:79], a[196:199], v[40:43], v[76:79]
ds_read_b64_tr_b16 a[192:193], v176 offset:8192
ds_read_b64_tr_b16 a[194:195], v176 offset:12288
v_mfma_f32_16x16x32_bf16 v[108:111], a[196:199], v[44:47], v[108:111]
ds_read_b64_tr_b16 a[196:197], v177 offset:8192
ds_read_b64_tr_b16 a[198:199], v177 offset:12288
v_mfma_f32_16x16x32_bf16 v[80:83], a[200:203], v[40:43], v[80:83]
v_mfma_f32_16x16x32_bf16 v[112:115], a[200:203], v[44:47], v[112:115]
buffer_load_dwordx4 a[20:23], v234, s[76:79], s94 offen offset:1024 sc0 sc1
v_mfma_f32_16x16x32_bf16 v[84:87], a[204:207], v[40:43], v[84:87]
ds_read_b64_tr_b16 a[200:201], v178 offset:8192
ds_read_b64_tr_b16 a[202:203], v178 offset:12288
v_mfma_f32_16x16x32_bf16 v[116:119], a[204:207], v[44:47], v[116:119]
ds_read_b64_tr_b16 a[204:205], v179 offset:8192
ds_read_b64_tr_b16 a[206:207], v179 offset:12288
v_mfma_f32_16x16x32_bf16 v[88:91], a[208:211], v[40:43], v[88:91]
v_mfma_f32_16x16x32_bf16 v[120:123], a[208:211], v[44:47], v[120:123]
buffer_load_dwordx4 a[24:27], v234, s[76:79], s94 offen offset:2048 sc0 sc1
v_mfma_f32_16x16x32_bf16 v[92:95], a[212:215], v[40:43], v[92:95]
ds_read_b64_tr_b16 a[208:209], v180 offset:8192
ds_read_b64_tr_b16 a[210:211], v180 offset:12288
v_mfma_f32_16x16x32_bf16 v[124:127], a[212:215], v[44:47], v[124:127]
ds_read_b64_tr_b16 a[212:213], v181 offset:8192
ds_read_b64_tr_b16 a[214:215], v181 offset:12288
v_mfma_f32_16x16x32_bf16 v[96:99], a[216:219], v[40:43], v[96:99]
v_mfma_f32_16x16x32_bf16 v[128:131], a[216:219], v[44:47], v[128:131]
buffer_load_dwordx4 a[28:31], v234, s[76:79], s94 offen offset:3072 sc0 sc1
v_mfma_f32_16x16x32_bf16 v[100:103], a[220:223], v[40:43], v[100:103]
s_waitcnt lgkmcnt(6)
ds_read_b64_tr_b16 a[216:217], v182 offset:8192
ds_read_b64_tr_b16 a[218:219], v182 offset:12288
v_mfma_f32_16x16x32_bf16 v[132:135], a[220:223], v[44:47], v[132:135]
s_add_u32 s94, s39, 0
ds_read_b64_tr_b16 a[220:221], v183 offset:8192
ds_read_b64_tr_b16 a[222:223], v183 offset:12288
v_mfma_f32_16x16x32_bf16 v[136:139], a[224:227], v[40:43], v[136:139]
v_mfma_f32_16x16x32_bf16 v[152:155], a[224:227], v[44:47], v[152:155]
buffer_load_dwordx4 a[32:35], v234, s[76:79], s94 offen offset:0 sc0 sc1
v_mfma_f32_16x16x32_bf16 v[140:143], a[228:231], v[40:43], v[140:143]
ds_read_b64_tr_b16 a[224:225], v204 offset:4096
ds_read_b64_tr_b16 a[226:227], v204 offset:6144
v_mfma_f32_16x16x32_bf16 v[156:159], a[228:231], v[44:47], v[156:159]
ds_read_b64_tr_b16 a[228:229], v205 offset:4096
ds_read_b64_tr_b16 a[230:231], v205 offset:6144
v_mfma_f32_16x16x32_bf16 v[144:147], a[232:235], v[40:43], v[144:147]
v_mfma_f32_16x16x32_bf16 v[160:163], a[232:235], v[44:47], v[160:163]
buffer_load_dwordx4 a[36:39], v234, s[76:79], s94 offen offset:1024 sc0 sc1
v_mfma_f32_16x16x32_bf16 v[148:151], a[236:239], v[40:43], v[148:151]
ds_read_b64_tr_b16 a[232:233], v206 offset:4096
ds_read_b64_tr_b16 a[234:235], v206 offset:6144
v_mfma_f32_16x16x32_bf16 v[164:167], a[236:239], v[44:47], v[164:167]
ds_read_b64_tr_b16 a[236:237], v207 offset:4096
ds_read_b64_tr_b16 a[238:239], v207 offset:6144
v_mfma_f32_16x16x32_bf16 v[72:75], a[192:195], v[48:51], v[72:75]
v_mfma_f32_16x16x32_bf16 v[104:107], a[192:195], v[52:55], v[104:107]
buffer_load_dwordx4 a[40:43], v234, s[76:79], s94 offen offset:2048 sc0 sc1
v_mfma_f32_16x16x32_bf16 v[76:79], a[196:199], v[48:51], v[76:79]
ds_read_b64_tr_b16 a[192:193], v176 offset:16384
ds_read_b64_tr_b16 a[194:195], v176 offset:20480
v_mfma_f32_16x16x32_bf16 v[108:111], a[196:199], v[52:55], v[108:111]
ds_read_b64_tr_b16 a[196:197], v177 offset:16384
ds_read_b64_tr_b16 a[198:199], v177 offset:20480
v_mfma_f32_16x16x32_bf16 v[80:83], a[200:203], v[48:51], v[80:83]
v_mfma_f32_16x16x32_bf16 v[112:115], a[200:203], v[52:55], v[112:115]
s_waitcnt lgkmcnt(6)
buffer_load_dwordx4 a[44:47], v234, s[76:79], s94 offen offset:3072 sc0 sc1
v_mfma_f32_16x16x32_bf16 v[84:87], a[204:207], v[48:51], v[84:87]
ds_read_b64_tr_b16 a[200:201], v178 offset:16384
ds_read_b64_tr_b16 a[202:203], v178 offset:20480
v_mfma_f32_16x16x32_bf16 v[116:119], a[204:207], v[52:55], v[116:119]
s_add_u32 s94, s39, 4096
ds_read_b64_tr_b16 a[204:205], v179 offset:16384
ds_read_b64_tr_b16 a[206:207], v179 offset:20480
v_mfma_f32_16x16x32_bf16 v[88:91], a[208:211], v[48:51], v[88:91]
v_mfma_f32_16x16x32_bf16 v[120:123], a[208:211], v[52:55], v[120:123]
buffer_load_dwordx4 a[48:51], v234, s[76:79], s94 offen offset:0 sc0 sc1
v_mfma_f32_16x16x32_bf16 v[92:95], a[212:215], v[48:51], v[92:95]
ds_read_b64_tr_b16 a[208:209], v180 offset:16384
ds_read_b64_tr_b16 a[210:211], v180 offset:20480
v_mfma_f32_16x16x32_bf16 v[124:127], a[212:215], v[52:55], v[124:127]
ds_read_b64_tr_b16 a[212:213], v181 offset:16384
ds_read_b64_tr_b16 a[214:215], v181 offset:20480
v_mfma_f32_16x16x32_bf16 v[96:99], a[216:219], v[48:51], v[96:99]
v_mfma_f32_16x16x32_bf16 v[128:131], a[216:219], v[52:55], v[128:131]
buffer_load_dwordx4 a[52:55], v234, s[76:79], s94 offen offset:1024 sc0 sc1
v_mfma_f32_16x16x32_bf16 v[100:103], a[220:223], v[48:51], v[100:103]
ds_read_b64_tr_b16 a[216:217], v182 offset:16384
ds_read_b64_tr_b16 a[218:219], v182 offset:20480
v_mfma_f32_16x16x32_bf16 v[132:135], a[220:223], v[52:55], v[132:135]
ds_read_b64_tr_b16 a[220:221], v183 offset:16384
ds_read_b64_tr_b16 a[222:223], v183 offset:20480
v_mfma_f32_16x16x32_bf16 v[136:139], a[224:227], v[48:51], v[136:139]
v_mfma_f32_16x16x32_bf16 v[152:155], a[224:227], v[52:55], v[152:155]
buffer_load_dwordx4 a[56:59], v234, s[76:79], s94 offen offset:2048 sc0 sc1
v_mfma_f32_16x16x32_bf16 v[140:143], a[228:231], v[48:51], v[140:143]
ds_read_b64_tr_b16 a[224:225], v204 offset:8192
ds_read_b64_tr_b16 a[226:227], v204 offset:10240
v_mfma_f32_16x16x32_bf16 v[156:159], a[228:231], v[52:55], v[156:159]
ds_read_b64_tr_b16 a[228:229], v205 offset:8192
ds_read_b64_tr_b16 a[230:231], v205 offset:10240
v_mfma_f32_16x16x32_bf16 v[144:147], a[232:235], v[48:51], v[144:147]
v_mfma_f32_16x16x32_bf16 v[160:163], a[232:235], v[52:55], v[160:163]
s_waitcnt lgkmcnt(6)
buffer_load_dwordx4 a[60:63], v234, s[76:79], s94 offen offset:3072 sc0 sc1
v_mfma_f32_16x16x32_bf16 v[148:151], a[236:239], v[48:51], v[148:151]
ds_read_b64_tr_b16 a[232:233], v206 offset:8192
ds_read_b64_tr_b16 a[234:235], v206 offset:10240
v_mfma_f32_16x16x32_bf16 v[164:167], a[236:239], v[52:55], v[164:167]
ds_read_b64_tr_b16 a[236:237], v207 offset:8192
ds_read_b64_tr_b16 a[238:239], v207 offset:10240
v_mfma_f32_16x16x32_bf16 v[72:75], a[192:195], v[56:59], v[72:75]
s_add_u32 s94, s40, 0
v_mfma_f32_16x16x32_bf16 v[104:107], a[192:195], v[60:63], v[104:107]
buffer_load_dwordx4 a[64:67], v234, s[76:79], s94 offen offset:0 sc0 sc1
v_mfma_f32_16x16x32_bf16 v[76:79], a[196:199], v[56:59], v[76:79]
ds_read_b64_tr_b16 a[192:193], v176 offset:24576
ds_read_b64_tr_b16 a[194:195], v176 offset:28672
v_mfma_f32_16x16x32_bf16 v[108:111], a[196:199], v[60:63], v[108:111]
ds_read_b64_tr_b16 a[196:197], v177 offset:24576
ds_read_b64_tr_b16 a[198:199], v177 offset:28672
v_mfma_f32_16x16x32_bf16 v[80:83], a[200:203], v[56:59], v[80:83]
v_mfma_f32_16x16x32_bf16 v[112:115], a[200:203], v[60:63], v[112:115]
buffer_load_dwordx4 a[68:71], v234, s[76:79], s94 offen offset:1024 sc0 sc1
v_mfma_f32_16x16x32_bf16 v[84:87], a[204:207], v[56:59], v[84:87]
ds_read_b64_tr_b16 a[200:201], v178 offset:24576
ds_read_b64_tr_b16 a[202:203], v178 offset:28672
v_mfma_f32_16x16x32_bf16 v[116:119], a[204:207], v[60:63], v[116:119]
ds_read_b64_tr_b16 a[204:205], v179 offset:24576
ds_read_b64_tr_b16 a[206:207], v179 offset:28672
v_mfma_f32_16x16x32_bf16 v[88:91], a[208:211], v[56:59], v[88:91]
v_mfma_f32_16x16x32_bf16 v[120:123], a[208:211], v[60:63], v[120:123]
buffer_load_dwordx4 a[72:75], v234, s[76:79], s94 offen offset:2048 sc0 sc1
v_mfma_f32_16x16x32_bf16 v[92:95], a[212:215], v[56:59], v[92:95]
ds_read_b64_tr_b16 a[208:209], v180 offset:24576
ds_read_b64_tr_b16 a[210:211], v180 offset:28672
v_mfma_f32_16x16x32_bf16 v[124:127], a[212:215], v[60:63], v[124:127]
ds_read_b64_tr_b16 a[212:213], v181 offset:24576
ds_read_b64_tr_b16 a[214:215], v181 offset:28672
v_mfma_f32_16x16x32_bf16 v[96:99], a[216:219], v[56:59], v[96:99]
v_mfma_f32_16x16x32_bf16 v[128:131], a[216:219], v[60:63], v[128:131]
s_waitcnt lgkmcnt(6)
buffer_load_dwordx4 a[76:79], v234, s[76:79], s94 offen offset:3072 sc0 sc1
v_mfma_f32_16x16x32_bf16 v[100:103], a[220:223], v[56:59], v[100:103]
ds_read_b64_tr_b16 a[216:217], v182 offset:24576
ds_read_b64_tr_b16 a[218:219], v182 offset:28672
v_mfma_f32_16x16x32_bf16 v[132:135], a[220:223], v[60:63], v[132:135]
s_add_u32 s94, s40, 4096
ds_read_b64_tr_b16 a[220:221], v183 offset:24576
ds_read_b64_tr_b16 a[222:223], v183 offset:28672
v_mfma_f32_16x16x32_bf16 v[136:139], a[224:227], v[56:59], v[136:139]
v_mfma_f32_16x16x32_bf16 v[152:155], a[224:227], v[60:63], v[152:155]
buffer_load_dwordx4 a[80:83], v234, s[76:79], s94 offen offset:0 sc0 sc1
v_mfma_f32_16x16x32_bf16 v[140:143], a[228:231], v[56:59], v[140:143]
ds_read_b64_tr_b16 a[224:225], v204 offset:12288
ds_read_b64_tr_b16 a[226:227], v204 offset:14336
v_mfma_f32_16x16x32_bf16 v[156:159], a[228:231], v[60:63], v[156:159]
ds_read_b64_tr_b16 a[228:229], v205 offset:12288
ds_read_b64_tr_b16 a[230:231], v205 offset:14336
v_mfma_f32_16x16x32_bf16 v[144:147], a[232:235], v[56:59], v[144:147]
v_mfma_f32_16x16x32_bf16 v[160:163], a[232:235], v[60:63], v[160:163]
buffer_load_dwordx4 a[84:87], v234, s[76:79], s94 offen offset:1024 sc0 sc1
v_mfma_f32_16x16x32_bf16 v[148:151], a[236:239], v[56:59], v[148:151]
ds_read_b64_tr_b16 a[232:233], v206 offset:12288
ds_read_b64_tr_b16 a[234:235], v206 offset:14336
v_mfma_f32_16x16x32_bf16 v[164:167], a[236:239], v[60:63], v[164:167]
ds_read_b64_tr_b16 a[236:237], v207 offset:12288
ds_read_b64_tr_b16 a[238:239], v207 offset:14336
v_mfma_f32_16x16x32_bf16 v[72:75], a[192:195], v[64:67], v[72:75]
v_mfma_f32_16x16x32_bf16 v[104:107], a[192:195], v[68:71], v[104:107]
v_mfma_f32_16x16x32_bf16 v[76:79], a[196:199], v[64:67], v[76:79]
v_mfma_f32_16x16x32_bf16 v[108:111], a[196:199], v[68:71], v[108:111]
v_mfma_f32_16x16x32_bf16 v[80:83], a[200:203], v[64:67], v[80:83]
buffer_load_dwordx4 a[88:91], v234, s[76:79], s94 offen offset:2048 sc0 sc1
buffer_load_dwordx4 a[92:95], v234, s[76:79], s94 offen offset:3072 sc0 sc1
s_waitcnt vmcnt(24) lgkmcnt(0)
s_barrier
s_cmp_lg_u32 s32, 0
s_cbranch_scc1 K_NOYP
v_mov_b32 v5, 1
s_mov_b64 exec, 1
buffer_atomic_add v5, v234, s[28:31], 0 offen offset:4 sc1
s_mov_b64 exec, -1
K_NOYP:
s_cmp_lg_u32 s92, 0
s_cbranch_scc1 K_F0DONE1
K_F0SPIN1:
buffer_load_dword v241, v6, s[20:23], s54 offen sc0 sc1
s_waitcnt vmcnt(0)
v_cmp_ne_u32 vcc, 1, v241
s_and_b32 s46, vcc_lo, 0x55
s_cbranch_scc0 K_F0OK1
s_sleep 1
s_add_u32 s100, s100, 1
s_bitcmp1_b32 s100, 19
s_cbranch_scc1 K_END
s_branch K_F0SPIN1
K_F0OK1:
s_mov_b32 s78, 0x4000000
s_add_u32 s94, s38, 0
buffer_load_dwordx4 a[0:3], v234, s[76:79], s94 offen offset:0 sc0 sc1
buffer_load_dwordx4 a[4:7], v234, s[76:79], s94 offen offset:1024 sc0 sc1
buffer_load_dwordx4 a[8:11], v234, s[76:79], s94 offen offset:2048 sc0 sc1
buffer_load_dwordx4 a[12:15], v234, s[76:79], s94 offen offset:3072 sc0 sc1
s_add_u32 s94, s38, 4096
buffer_load_dwordx4 a[16:19], v234, s[76:79], s94 offen offset:0 sc0 sc1
buffer_load_dwordx4 a[20:23], v234, s[76:79], s94 offen offset:1024 sc0 sc1
buffer_load_dwordx4 a[24:27], v234, s[76:79], s94 offen offset:2048 sc0 sc1
buffer_load_dwordx4 a[28:31], v234, s[76:79], s94 offen offset:3072 sc0 sc1
s_add_u32 s94, s39, 0
buffer_load_dwordx4 a[32:35], v234, s[76:79], s94 offen offset:0 sc0 sc1
buffer_load_dwordx4 a[36:39], v234, s[76:79], s94 offen offset:1024 sc0 sc1
buffer_load_dwordx4 a[40:43], v234, s[76:79], s94 offen offset:2048 sc0 sc1
buffer_load_dwordx4 a[44:47], v234, s[76:79], s94 offen offset:3072 sc0 sc1
s_add_u32 s94, s39, 4096
buffer_load_dwordx4 a[48:51], v234, s[76:79], s94 offen offset:0 sc0 sc1
buffer_load_dwordx4 a[52:55], v234, s[76:79], s94 offen offset:1024 sc0 sc1
buffer_load_dwordx4 a[56:59], v234, s[76:79], s94 offen offset:2048 sc0 sc1
buffer_load_dwordx4 a[60:63], v234, s[76:79], s94 offen offset:3072 sc0 sc1
s_add_u32 s94, s40, 0
buffer_load_dwordx4 a[64:67], v234, s[76:79], s94 offen offset:0 sc0 sc1
buffer_load_dwordx4 a[68:71], v234, s[76:79], s94 offen offset:1024 sc0 sc1
buffer_load_dwordx4 a[72:75], v234, s[76:79], s94 offen offset:2048 sc0 sc1
buffer_load_dwordx4 a[76:79], v234, s[76:79], s94 offen offset:3072 sc0 sc1
s_add_u32 s94, s40, 4096
buffer_load_dwordx4 a[80:83], v234, s[76:79], s94 offen offset:0 sc0 sc1
buffer_load_dwordx4 a[84:87], v234, s[76:79], s94 offen offset:1024 sc0 sc1
buffer_load_dwordx4 a[88:91], v234, s[76:79], s94 offen offset:2048 sc0 sc1
buffer_load_dwordx4 a[92:95], v234, s[76:79], s94 offen offset:3072 sc0 sc1
K_F0DONE1:
v_mfma_f32_16x16x32_bf16 v[112:115], a[200:203], v[68:71], v[112:115]
s_add_u32 m0, s80, 0
ds_read_b64_tr_b16 a[192:193], v184 offset:0
ds_read_b64_tr_b16 a[194:195], v184 offset:4096
v_mfma_f32_16x16x32_bf16 v[84:87], a[204:207], v[64:67], v[84:87]
s_add_u32 s48, s44, 0
buffer_load_dwordx4 v236, s[16:19], s48 offen lds
v_mfma_f32_16x16x32_bf16 v[116:119], a[204:207], v[68:71], v[116:119]
ds_read_b64_tr_b16 a[196:197], v185 offset:0
ds_read_b64_tr_b16 a[198:199], v185 offset:4096
v_mfma_f32_16x16x32_bf16 v[88:91], a[208:211], v[64:67], v[88:91]
s_add_u32 m0, s80, 4096
ds_read_b64_tr_b16 a[200:201], v186 offset:0
ds_read_b64_tr_b16 a[202:203], v186 offset:4096
v_mfma_f32_16x16x32_bf16 v[120:123], a[208:211], v[68:71], v[120:123]
s_add_u32 s48, s44, 18432
ds_read_b64_tr_b16 a[204:205], v187 offset:0
ds_read_b64_tr_b16 a[206:207], v187 offset:4096
v_mfma_f32_16x16x32_bf16 v[92:95], a[212:215], v[64:67], v[92:95]
buffer_load_dwordx4 v236, s[16:19], s48 offen lds
v_mfma_f32_16x16x32_bf16 v[124:127], a[212:215], v[68:71], v[124:127]
ds_read_b64_tr_b16 a[208:209], v188 offset:0
ds_read_b64_tr_b16 a[210:211], v188 offset:4096
v_mfma_f32_16x16x32_bf16 v[96:99], a[216:219], v[64:67], v[96:99]
s_add_u32 m0, s80, 8192
ds_read_b64_tr_b16 a[212:213], v189 offset:0
ds_read_b64_tr_b16 a[214:215], v189 offset:4096
v_mfma_f32_16x16x32_bf16 v[128:131], a[216:219], v[68:71], v[128:131]
s_add_u32 s48, s44, 36864
ds_read_b64_tr_b16 a[216:217], v190 offset:0
ds_read_b64_tr_b16 a[218:219], v190 offset:4096
v_mfma_f32_16x16x32_bf16 v[100:103], a[220:223], v[64:67], v[100:103]
buffer_load_dwordx4 v236, s[16:19], s48 offen lds
v_mfma_f32_16x16x32_bf16 v[132:135], a[220:223], v[68:71], v[132:135]
ds_read_b64_tr_b16 a[220:221], v191 offset:0
ds_read_b64_tr_b16 a[222:223], v191 offset:4096
v_mfma_f32_16x16x32_bf16 v[136:139], a[224:227], v[64:67], v[136:139]
s_add_u32 m0, s80, 12288
v_mfma_f32_16x16x32_bf16 v[152:155], a[224:227], v[68:71], v[152:155]
s_add_u32 s48, s44, 55296
v_mfma_f32_16x16x32_bf16 v[140:143], a[228:231], v[64:67], v[140:143]
buffer_load_dwordx4 v236, s[16:19], s48 offen lds
v_mfma_f32_16x16x32_bf16 v[156:159], a[228:231], v[68:71], v[156:159]
v_mfma_f32_16x16x32_bf16 v[144:147], a[232:235], v[64:67], v[144:147]
v_mfma_f32_16x16x32_bf16 v[160:163], a[232:235], v[68:71], v[160:163]
v_mfma_f32_16x16x32_bf16 v[148:151], a[236:239], v[64:67], v[148:151]
v_mfma_f32_16x16x32_bf16 v[164:167], a[236:239], v[68:71], v[164:167]
s_waitcnt lgkmcnt(6)
s_add_u32 m0, s80, 16384
s_add_u32 s48, s44, 73728
buffer_load_dwordx4 v236, s[16:19], s48 offen lds
s_add_u32 m0, s80, 20480
s_add_u32 s48, s44, 92160
buffer_load_dwordx4 v236, s[16:19], s48 offen lds
s_add_u32 m0, s80, 24576
s_add_u32 s48, s44, 110592
buffer_load_dwordx4 v236, s[16:19], s48 offen lds
s_add_u32 m0, s80, 28672
s_add_u32 s48, s44, 129024
buffer_load_dwordx4 v236, s[16:19], s48 offen lds
K_P2F:
s_add_u32 s86, s72, s37
s_mul_i32 s87, s55, 1152
s_lshl_b32 s46, s36, 5
s_add_u32 s88, s87, s46
s_add_u32 s88, s88, 1024
s_lshl_b32 s46, s36, 8
s_add_u32 s87, s87, s46
s_add_u32 s87, s87, s93
s_lshl_b32 s46, s34, 2
s_add_u32 s46, s46, s32
s_lshl_b32 s46, s46, 1
s_lshr_b32 s47, s35, 1
s_add_u32 s46, s46, s47
s_lshl_b32 s89, s46, 15
s_add_u32 s89, s89, 0x2000000
s_lshl_b32 s46, s33, 9
s_add_u32 s90, s89, s46
s_xor_b32 s91, s90, 0x8000
s_lshl_b32 s46, s34, 2
s_add_u32 s46, s46, s32
s_lshl_b32 s46, s46, 7
s_add_u32 s45, s46, 0x260000
s_waitcnt vmcnt(16)
v_mfma_f32_16x16x32_bf16 v[72:75], a[192:195], a[0:3], v[72:75]
v_mfma_f32_16x16x32_bf16 v[104:107], a[192:195], a[4:7], v[104:107]
buffer_load_dword v241, v6, s[20:23], s54 offen sc0 sc1
v_mfma_f32_16x16x32_bf16 v[76:79], a[196:199], a[0:3], v[76:79]
ds_read_b64_tr_b16 a[192:193], v184 offset:8192
ds_read_b64_tr_b16 a[194:195], v184 offset:12288
v_mfma_f32_16x16x32_bf16 v[108:111], a[196:199], a[4:7], v[108:111]
s_add_u32 m0, s81, 0
ds_read_b64_tr_b16 a[196:197], v185 offset:8192
ds_read_b64_tr_b16 a[198:199], v185 offset:12288
v_mfma_f32_16x16x32_bf16 v[80:83], a[200:203], a[0:3], v[80:83]
s_add_u32 s48, s42, 147456
v_lshlrev_b32 v243, 3, v1
v_mfma_f32_16x16x32_bf16 v[112:115], a[200:203], a[4:7], v[112:115]
buffer_load_dwordx4 v236, s[16:19], s48 offen lds
v_mfma_f32_16x16x32_bf16 v[84:87], a[204:207], a[0:3], v[84:87]
ds_read_b64_tr_b16 a[200:201], v186 offset:8192
ds_read_b64_tr_b16 a[202:203], v186 offset:12288
v_mfma_f32_16x16x32_bf16 v[116:119], a[204:207], a[4:7], v[116:119]
s_add_u32 m0, s81, 4096
ds_read_b64_tr_b16 a[204:205], v187 offset:8192
ds_read_b64_tr_b16 a[206:207], v187 offset:12288
v_mfma_f32_16x16x32_bf16 v[88:91], a[208:211], a[0:3], v[88:91]
s_add_u32 s48, s42, 165888
v_cvt_pk_bf16_f32 v8, v136, v137
v_cvt_pk_bf16_f32 v9, v138, v139
v_mfma_f32_16x16x32_bf16 v[120:123], a[208:211], a[4:7], v[120:123]
s_waitcnt lgkmcnt(6)
buffer_load_dwordx4 v236, s[16:19], s48 offen lds
v_mfma_f32_16x16x32_bf16 v[92:95], a[212:215], a[0:3], v[92:95]
ds_read_b64_tr_b16 a[208:209], v188 offset:8192
ds_read_b64_tr_b16 a[210:211], v188 offset:12288
v_mfma_f32_16x16x32_bf16 v[124:127], a[212:215], a[4:7], v[124:127]
s_add_u32 m0, s81, 8192
ds_read_b64_tr_b16 a[212:213], v189 offset:8192
ds_read_b64_tr_b16 a[214:215], v189 offset:12288
v_mfma_f32_16x16x32_bf16 v[96:99], a[216:219], a[0:3], v[96:99]
s_add_u32 s48, s42, 184320
v_cvt_pk_bf16_f32 v10, v140, v141
v_cvt_pk_bf16_f32 v11, v142, v143
v_mfma_f32_16x16x32_bf16 v[128:131], a[216:219], a[4:7], v[128:131]
buffer_load_dwordx4 v236, s[16:19], s48 offen lds
v_mfma_f32_16x16x32_bf16 v[100:103], a[220:223], a[0:3], v[100:103]
ds_read_b64_tr_b16 a[216:217], v190 offset:8192
ds_read_b64_tr_b16 a[218:219], v190 offset:12288
v_mfma_f32_16x16x32_bf16 v[132:135], a[220:223], a[4:7], v[132:135]
ds_read_b64_tr_b16 a[220:221], v191 offset:8192
ds_read_b64_tr_b16 a[222:223], v191 offset:12288
v_cvt_pk_bf16_f32 v12, v144, v145
v_mfma_f32_16x16x32_bf16 v[72:75], a[192:195], a[8:11], v[72:75]
s_add_u32 m0, s81, 12288
v_mfma_f32_16x16x32_bf16 v[104:107], a[192:195], a[12:15], v[104:107]
s_waitcnt lgkmcnt(6)
s_add_u32 s48, s42, 202752
buffer_load_dwordx4 v236, s[16:19], s48 offen lds
v_mfma_f32_16x16x32_bf16 v[76:79], a[196:199], a[8:11], v[76:79]
ds_read_b64_tr_b16 a[192:193], v184 offset:16384
ds_read_b64_tr_b16 a[194:195], v184 offset:20480
v_mfma_f32_16x16x32_bf16 v[108:111], a[196:199], a[12:15], v[108:111]
s_add_u32 m0, s81, 16384
ds_read_b64_tr_b16 a[196:197], v185 offset:16384
ds_read_b64_tr_b16 a[198:199], v185 offset:20480
v_mfma_f32_16x16x32_bf16 v[80:83], a[200:203], a[8:11], v[80:83]
s_add_u32 s48, s42, 221184
v_mfma_f32_16x16x32_bf16 v[112:115], a[200:203], a[12:15], v[112:115]
buffer_load_dwordx4 v236, s[16:19], s48 offen lds
v_mfma_f32_16x16x32_bf16 v[84:87], a[204:207], a[8:11], v[84:87]
ds_read_b64_tr_b16 a[200:201], v186 offset:16384
ds_read_b64_tr_b16 a[202:203], v186 offset:20480
v_mfma_f32_16x16x32_bf16 v[116:119], a[204:207], a[12:15], v[116:119]
s_add_u32 m0, s81, 20480
ds_read_b64_tr_b16 a[204:205], v187 offset:16384
ds_read_b64_tr_b16 a[206:207], v187 offset:20480
v_mfma_f32_16x16x32_bf16 v[88:91], a[208:211], a[8:11], v[88:91]
s_add_u32 s48, s42, 239616
v_cvt_pk_bf16_f32 v13, v146, v147
v_cvt_pk_bf16_f32 v14, v148, v149
v_mfma_f32_16x16x32_bf16 v[120:123], a[208:211], a[12:15], v[120:123]
s_waitcnt lgkmcnt(6)
buffer_load_dwordx4 v236, s[16:19], s48 offen lds
v_mfma_f32_16x16x32_bf16 v[92:95], a[212:215], a[8:11], v[92:95]
ds_read_b64_tr_b16 a[208:209], v188 offset:16384
ds_read_b64_tr_b16 a[210:211], v188 offset:20480
v_mfma_f32_16x16x32_bf16 v[124:127], a[212:215], a[12:15], v[124:127]
s_add_u32 m0, s81, 24576
ds_read_b64_tr_b16 a[212:213], v189 offset:16384
ds_read_b64_tr_b16 a[214:215], v189 offset:20480
v_mfma_f32_16x16x32_bf16 v[96:99], a[216:219], a[8:11], v[96:99]
s_add_u32 s48, s42, 258048
v_cvt_pk_bf16_f32 v15, v150, v151
v_cvt_pk_bf16_f32 v16, v152, v153
v_mfma_f32_16x16x32_bf16 v[128:131], a[216:219], a[12:15], v[128:131]
buffer_load_dwordx4 v236, s[16:19], s48 offen lds
v_mfma_f32_16x16x32_bf16 v[100:103], a[220:223], a[8:11], v[100:103]
ds_read_b64_tr_b16 a[216:217], v190 offset:16384
ds_read_b64_tr_b16 a[218:219], v190 offset:20480
v_mfma_f32_16x16x32_bf16 v[132:135], a[220:223], a[12:15], v[132:135]
ds_read_b64_tr_b16 a[220:221], v191 offset:16384
ds_read_b64_tr_b16 a[222:223], v191 offset:20480
v_cvt_pk_bf16_f32 v17, v154, v155
v_cvt_pk_bf16_f32 v18, v156, v157
s_waitcnt vmcnt(7)
v_cmp_ne_u32 vcc, 1, v241
s_and_b32 s46, vcc_lo, 0xaa
s_cbranch_scc0 K_F1OK
K_F1SPIN:
s_sleep 2
s_add_u32 s100, s100, 1
s_bitcmp1_b32 s100, 19
s_cbranch_scc1 K_END
buffer_load_dword v241, v6, s[20:23], s54 offen sc0 sc1
s_waitcnt vmcnt(0)
v_cmp_ne_u32 vcc, 1, v241
s_and_b32 s46, vcc_lo, 0xaa
s_cbranch_scc1 K_F1SPIN
K_F1OK:
v_mfma_f32_16x16x32_bf16 v[72:75], a[192:195], a[16:19], v[72:75]
s_add_u32 m0, s81, 28672
v_mfma_f32_16x16x32_bf16 v[104:107], a[192:195], a[20:23], v[104:107]
s_waitcnt lgkmcnt(6)
s_add_u32 s48, s42, 276480
buffer_load_dwordx4 v236, s[16:19], s48 offen lds
v_mfma_f32_16x16x32_bf16 v[76:79], a[196:199], a[16:19], v[76:79]
ds_read_b64_tr_b16 a[192:193], v184 offset:24576
ds_read_b64_tr_b16 a[194:195], v184 offset:28672
v_mfma_f32_16x16x32_bf16 v[108:111], a[196:199], a[20:23], v[108:111]
s_add_u32 s94, s38, 8192
ds_read_b64_tr_b16 a[196:197], v185 offset:24576
ds_read_b64_tr_b16 a[198:199], v185 offset:28672
v_mfma_f32_16x16x32_bf16 v[80:83], a[200:203], a[16:19], v[80:83]
v_mfma_f32_16x16x32_bf16 v[112:115], a[200:203], a[20:23], v[112:115]
buffer_load_dwordx4 a[96:99], v234, s[76:79], s94 offen offset:0 sc0 sc1
v_mfma_f32_16x16x32_bf16 v[84:87], a[204:207], a[16:19], v[84:87]
ds_read_b64_tr_b16 a[200:201], v186 offset:24576
ds_read_b64_tr_b16 a[202:203], v186 offset:28672
v_mfma_f32_16x16x32_bf16 v[116:119], a[204:207], a[20:23], v[116:119]
ds_read_b64_tr_b16 a[204:205], v187 offset:24576
ds_read_b64_tr_b16 a[206:207], v187 offset:28672
v_mfma_f32_16x16x32_bf16 v[88:91], a[208:211], a[16:19], v[88:91]
v_cvt_pk_bf16_f32 v19, v158, v159
v_cvt_pk_bf16_f32 v20, v160, v161
v_mfma_f32_16x16x32_bf16 v[120:123], a[208:211], a[20:23], v[120:123]
s_waitcnt lgkmcnt(6)
buffer_load_dwordx4 a[100:103], v234, s[76:79], s94 offen offset:1024 sc0 sc1
v_mfma_f32_16x16x32_bf16 v[92:95], a[212:215], a[16:19], v[92:95]
ds_read_b64_tr_b16 a[208:209], v188 offset:24576
ds_read_b64_tr_b16 a[210:211], v188 offset:28672
v_mfma_f32_16x16x32_bf16 v[124:127], a[212:215], a[20:23], v[124:127]
ds_read_b64_tr_b16 a[212:213], v189 offset:24576
ds_read_b64_tr_b16 a[214:215], v189 offset:28672
v_mfma_f32_16x16x32_bf16 v[96:99], a[216:219], a[16:19], v[96:99]
v_cvt_pk_bf16_f32 v21, v162, v163
v_cvt_pk_bf16_f32 v22, v164, v165
v_mfma_f32_16x16x32_bf16 v[128:131], a[216:219], a[20:23], v[128:131]
buffer_load_dwordx4 a[104:107], v234, s[76:79], s94 offen offset:2048 sc0 sc1
v_mfma_f32_16x16x32_bf16 v[100:103], a[220:223], a[16:19], v[100:103]
ds_read_b64_tr_b16 a[216:217], v190 offset:24576
ds_read_b64_tr_b16 a[218:219], v190 offset:28672
v_mfma_f32_16x16x32_bf16 v[132:135], a[220:223], a[20:23], v[132:135]
ds_read_b64_tr_b16 a[220:221], v191 offset:24576
ds_read_b64_tr_b16 a[222:223], v191 offset:28672
v_cvt_pk_bf16_f32 v23, v166, v167
v_lshrrev_b32 v5, 3, v1
v_mfma_f32_16x16x32_bf16 v[72:75], a[192:195], a[24:27], v[72:75]
v_and_b32 v7, 7, v1
v_xor_b32 v7, v7, v4
v_mfma_f32_16x16x32_bf16 v[104:107], a[192:195], a[28:31], v[104:107]
s_waitcnt lgkmcnt(6)
buffer_load_dwordx4 a[108:111], v234, s[76:79], s94 offen offset:3072 sc0 sc1
v_mfma_f32_16x16x32_bf16 v[76:79], a[196:199], a[24:27], v[76:79]
ds_read_b64_tr_b16 a[192:193], v192 offset:0
ds_read_b64_tr_b16 a[194:195], v192 offset:4096
v_mfma_f32_16x16x32_bf16 v[108:111], a[196:199], a[28:31], v[108:111]
s_add_u32 s95, s90, 0
ds_read_b64_tr_b16 a[196:197], v193 offset:0
ds_read_b64_tr_b16 a[198:199], v193 offset:4096
v_mfma_f32_16x16x32_bf16 v[80:83], a[200:203], a[24:27], v[80:83]
v_mul_u32_u24 v5, 0x480, v5
v_lshl_add_u32 v232, v7, 4, v5
v_mfma_f32_16x16x32_bf16 v[112:115], a[200:203], a[28:31], v[112:115]
buffer_store_dwordx2 v[8:9], v243, s[20:23], s95 offen sc0 sc1
v_mfma_f32_16x16x32_bf16 v[84:87], a[204:207], a[24:27], v[84:87]
ds_read_b64_tr_b16 a[200:201], v194 offset:0
ds_read_b64_tr_b16 a[202:203], v194 offset:4096
v_mfma_f32_16x16x32_bf16 v[116:119], a[204:207], a[28:31], v[116:119]
s_add_u32 s95, s90, 8192
ds_read_b64_tr_b16 a[204:205], v195 offset:0
ds_read_b64_tr_b16 a[206:207], v195 offset:4096
v_mfma_f32_16x16x32_bf16 v[88:91], a[208:211], a[24:27], v[88:91]
v_xor_b32 v233, 64, v232
v_add_u32 v233, 9216, v233
v_mfma_f32_16x16x32_bf16 v[120:123], a[208:211], a[28:31], v[120:123]
s_waitcnt lgkmcnt(6)
buffer_store_dwordx2 v[10:11], v243, s[20:23], s95 offen sc0 sc1
v_mfma_f32_16x16x32_bf16 v[92:95], a[212:215], a[24:27], v[92:95]
ds_read_b64_tr_b16 a[208:209], v196 offset:0
ds_read_b64_tr_b16 a[210:211], v196 offset:4096
v_mfma_f32_16x16x32_bf16 v[124:127], a[212:215], a[28:31], v[124:127]
s_add_u32 s95, s90, 16384
ds_read_b64_tr_b16 a[212:213], v197 offset:0
ds_read_b64_tr_b16 a[214:215], v197 offset:4096
v_mfma_f32_16x16x32_bf16 v[96:99], a[216:219], a[24:27], v[96:99]
v_mfma_f32_16x16x32_bf16 v[128:131], a[216:219], a[28:31], v[128:131]
buffer_store_dwordx2 v[12:13], v243, s[20:23], s95 offen sc0 sc1
v_mfma_f32_16x16x32_bf16 v[100:103], a[220:223], a[24:27], v[100:103]
ds_read_b64_tr_b16 a[216:217], v198 offset:0
ds_read_b64_tr_b16 a[218:219], v198 offset:4096
v_mfma_f32_16x16x32_bf16 v[132:135], a[220:223], a[28:31], v[132:135]
ds_read_b64_tr_b16 a[220:221], v199 offset:0
ds_read_b64_tr_b16 a[222:223], v199 offset:4096
s_waitcnt vmcnt(24)
v_mfma_f32_16x16x32_bf16 v[72:75], a[192:195], a[32:35], v[72:75]
s_add_u32 s95, s90, 24576
v_lshrrev_b32 v5, 1, v4
v_lshrrev_b32 v7, 1, v3
v_mfma_f32_16x16x32_bf16 v[104:107], a[192:195], a[36:39], v[104:107]
s_waitcnt lgkmcnt(6)
buffer_store_dwordx2 v[14:15], v243, s[20:23], s95 offen sc0 sc1
v_mfma_f32_16x16x32_bf16 v[76:79], a[196:199], a[32:35], v[76:79]
ds_read_b64_tr_b16 a[192:193], v192 offset:8192
ds_read_b64_tr_b16 a[194:195], v192 offset:12288
v_mfma_f32_16x16x32_bf16 v[108:111], a[196:199], a[36:39], v[108:111]
s_add_u32 s95, s91, 0
ds_read_b64_tr_b16 a[196:197], v193 offset:8192
ds_read_b64_tr_b16 a[198:199], v193 offset:12288
v_mfma_f32_16x16x32_bf16 v[80:83], a[200:203], a[32:35], v[80:83]
v_xor_b32 v5, v5, v7
v_lshlrev_b32 v5, 4, v5
v_mfma_f32_16x16x32_bf16 v[112:115], a[200:203], a[36:39], v[112:115]
buffer_store_dwordx2 v[16:17], v243, s[20:23], s95 offen sc0 sc1
v_mfma_f32_16x16x32_bf16 v[84:87], a[204:207], a[32:35], v[84:87]
ds_read_b64_tr_b16 a[200:201], v194 offset:8192
ds_read_b64_tr_b16 a[202:203], v194 offset:12288
v_mfma_f32_16x16x32_bf16 v[116:119], a[204:207], a[36:39], v[116:119]
s_add_u32 s95, s91, 8192
ds_read_b64_tr_b16 a[204:205], v195 offset:8192
ds_read_b64_tr_b16 a[206:207], v195 offset:12288
v_mfma_f32_16x16x32_bf16 v[88:91], a[208:211], a[32:35], v[88:91]
v_lshl_add_u32 v5, v3, 7, v5
v_and_b32 v7, 1, v4
v_mfma_f32_16x16x32_bf16 v[120:123], a[208:211], a[36:39], v[120:123]
s_waitcnt lgkmcnt(6)
buffer_store_dwordx2 v[18:19], v243, s[20:23], s95 offen sc0 sc1
v_mfma_f32_16x16x32_bf16 v[92:95], a[212:215], a[32:35], v[92:95]
ds_read_b64_tr_b16 a[208:209], v196 offset:8192
ds_read_b64_tr_b16 a[210:211], v196 offset:12288
v_mfma_f32_16x16x32_bf16 v[124:127], a[212:215], a[36:39], v[124:127]
s_add_u32 s95, s91, 16384
ds_read_b64_tr_b16 a[212:213], v197 offset:8192
ds_read_b64_tr_b16 a[214:215], v197 offset:12288
v_mfma_f32_16x16x32_bf16 v[96:99], a[216:219], a[32:35], v[96:99]
v_mfma_f32_16x16x32_bf16 v[128:131], a[216:219], a[36:39], v[128:131]
buffer_store_dwordx2 v[20:21], v243, s[20:23], s95 offen sc0 sc1
v_mfma_f32_16x16x32_bf16 v[100:103], a[220:223], a[32:35], v[100:103]
ds_read_b64_tr_b16 a[216:217], v198 offset:8192
ds_read_b64_tr_b16 a[218:219], v198 offset:12288
v_mfma_f32_16x16x32_bf16 v[132:135], a[220:223], a[36:39], v[132:135]
ds_read_b64_tr_b16 a[220:221], v199 offset:8192
ds_read_b64_tr_b16 a[222:223], v199 offset:12288
v_mfma_f32_16x16x32_bf16 v[72:75], a[192:195], a[40:43], v[72:75]
s_add_u32 s95, s91, 24576
v_lshl_add_u32 v5, v7, 3, v5
v_add_u32 v228, s86, v5
v_mfma_f32_16x16x32_bf16 v[104:107], a[192:195], a[44:47], v[104:107]
s_waitcnt lgkmcnt(6)
buffer_store_dwordx2 v[22:23], v243, s[20:23], s95 offen sc0 sc1
v_mfma_f32_16x16x32_bf16 v[76:79], a[196:199], a[40:43], v[76:79]
ds_read_b64_tr_b16 a[192:193], v192 offset:16384
ds_read_b64_tr_b16 a[194:195], v192 offset:20480
v_mfma_f32_16x16x32_bf16 v[108:111], a[196:199], a[44:47], v[108:111]
s_add_u32 s94, s38, 12288
ds_read_b64_tr_b16 a[196:197], v193 offset:16384
ds_read_b64_tr_b16 a[198:199], v193 offset:20480
v_mfma_f32_16x16x32_bf16 v[80:83], a[200:203], a[40:43], v[80:83]
v_xor_b32 v229, 32, v228
v_xor_b32 v230, 64, v228
v_mfma_f32_16x16x32_bf16 v[112:115], a[200:203], a[44:47], v[112:115]
buffer_load_dwordx4 a[112:115], v234, s[76:79], s94 offen offset:0 sc0 sc1
v_mfma_f32_16x16x32_bf16 v[84:87], a[204:207], a[40:43], v[84:87]
ds_read_b64_tr_b16 a[200:201], v194 offset:16384
ds_read_b64_tr_b16 a[202:203], v194 offset:20480
v_mfma_f32_16x16x32_bf16 v[116:119], a[204:207], a[44:47], v[116:119]
ds_read_b64_tr_b16 a[204:205], v195 offset:16384
ds_read_b64_tr_b16 a[206:207], v195 offset:20480
v_mfma_f32_16x16x32_bf16 v[88:91], a[208:211], a[40:43], v[88:91]
v_xor_b32 v231, 96, v228
v_mul_u32_u24 v5, 0x480, v3
v_mfma_f32_16x16x32_bf16 v[120:123], a[208:211], a[44:47], v[120:123]
s_waitcnt lgkmcnt(6)
buffer_load_dwordx4 a[116:119], v234, s[76:79], s94 offen offset:1024 sc0 sc1
v_mfma_f32_16x16x32_bf16 v[92:95], a[212:215], a[40:43], v[92:95]
ds_read_b64_tr_b16 a[208:209], v196 offset:16384
ds_read_b64_tr_b16 a[210:211], v196 offset:20480
v_mfma_f32_16x16x32_bf16 v[124:127], a[212:215], a[44:47], v[124:127]
ds_read_b64_tr_b16 a[212:213], v197 offset:16384
ds_read_b64_tr_b16 a[214:215], v197 offset:20480
v_mfma_f32_16x16x32_bf16 v[96:99], a[216:219], a[40:43], v[96:99]
v_mfma_f32_16x16x32_bf16 v[128:131], a[216:219], a[44:47], v[128:131]
buffer_load_dwordx4 a[120:123], v234, s[76:79], s94 offen offset:2048 sc0 sc1
v_mfma_f32_16x16x32_bf16 v[100:103], a[220:223], a[40:43], v[100:103]
ds_read_b64_tr_b16 a[216:217], v198 offset:16384
ds_read_b64_tr_b16 a[218:219], v198 offset:20480
v_mfma_f32_16x16x32_bf16 v[132:135], a[220:223], a[44:47], v[132:135]
ds_read_b64_tr_b16 a[220:221], v199 offset:16384
ds_read_b64_tr_b16 a[222:223], v199 offset:20480
v_mfma_f32_16x16x32_bf16 v[72:75], a[192:195], a[48:51], v[72:75]
v_lshl_add_u32 v242, v4, 3, v5
v_mfma_f32_16x16x32_bf16 v[104:107], a[192:195], a[52:55], v[104:107]
s_waitcnt lgkmcnt(6)
buffer_load_dwordx4 a[124:127], v234, s[76:79], s94 offen offset:3072 sc0 sc1
v_mfma_f32_16x16x32_bf16 v[76:79], a[196:199], a[48:51], v[76:79]
ds_read_b64_tr_b16 a[192:193], v192 offset:24576
ds_read_b64_tr_b16 a[194:195], v192 offset:28672
v_mfma_f32_16x16x32_bf16 v[108:111], a[196:199], a[52:55], v[108:111]
ds_read_b64_tr_b16 a[196:197], v193 offset:24576
ds_read_b64_tr_b16 a[198:199], v193 offset:28672
v_mfma_f32_16x16x32_bf16 v[80:83], a[200:203], a[48:51], v[80:83]
v_mfma_f32_16x16x32_bf16 v[112:115], a[200:203], a[52:55], v[112:115]
ds_read_b64_tr_b16 a[200:201], v194 offset:24576
ds_read_b64_tr_b16 a[202:203], v194 offset:28672
v_mfma_f32_16x16x32_bf16 v[84:87], a[204:207], a[48:51], v[84:87]
v_mfma_f32_16x16x32_bf16 v[116:119], a[204:207], a[52:55], v[116:119]
ds_read_b64_tr_b16 a[204:205], v195 offset:24576
ds_read_b64_tr_b16 a[206:207], v195 offset:28672
v_mfma_f32_16x16x32_bf16 v[88:91], a[208:211], a[48:51], v[88:91]
v_mfma_f32_16x16x32_bf16 v[120:123], a[208:211], a[52:55], v[120:123]
s_waitcnt lgkmcnt(6)
ds_read_b64_tr_b16 a[208:209], v196 offset:24576
ds_read_b64_tr_b16 a[210:211], v196 offset:28672
v_mfma_f32_16x16x32_bf16 v[92:95], a[212:215], a[48:51], v[92:95]
v_mfma_f32_16x16x32_bf16 v[124:127], a[212:215], a[52:55], v[124:127]
ds_read_b64_tr_b16 a[212:213], v197 offset:24576
ds_read_b64_tr_b16 a[214:215], v197 offset:28672
v_mfma_f32_16x16x32_bf16 v[96:99], a[216:219], a[48:51], v[96:99]
v_mfma_f32_16x16x32_bf16 v[128:131], a[216:219], a[52:55], v[128:131]
ds_read_b64_tr_b16 a[216:217], v198 offset:24576
ds_read_b64_tr_b16 a[218:219], v198 offset:28672
v_mfma_f32_16x16x32_bf16 v[100:103], a[220:223], a[48:51], v[100:103]
v_mfma_f32_16x16x32_bf16 v[132:135], a[220:223], a[52:55], v[132:135]
ds_read_b64_tr_b16 a[220:221], v199 offset:24576
ds_read_b64_tr_b16 a[222:223], v199 offset:28672
v_mfma_f32_16x16x32_bf16 v[72:75], a[192:195], a[56:59], v[72:75]
v_mfma_f32_16x16x32_bf16 v[104:107], a[192:195], a[60:63], v[104:107]
s_waitcnt lgkmcnt(6)
v_mfma_f32_16x16x32_bf16 v[76:79], a[196:199], a[56:59], v[76:79]
v_mfma_f32_16x16x32_bf16 v[108:111], a[196:199], a[60:63], v[108:111]
v_mfma_f32_16x16x32_bf16 v[80:83], a[200:203], a[56:59], v[80:83]
s_waitcnt vmcnt(16) lgkmcnt(0)
s_barrier
v_mfma_f32_16x16x32_bf16 v[112:115], a[200:203], a[60:63], v[112:115]
s_add_u32 m0, s82, 0
ds_read_b64_tr_b16 a[192:193], v168 offset:0
ds_read_b64_tr_b16 a[194:195], v168 offset:4096
v_mfma_f32_16x16x32_bf16 v[84:87], a[204:207], a[56:59], v[84:87]
s_add_u32 s48, s43, 147456
buffer_load_dwordx4 v236, s[16:19], s48 offen lds
v_mfma_f32_16x16x32_bf16 v[116:119], a[204:207], a[60:63], v[116:119]
ds_read_b64_tr_b16 a[196:197], v169 offset:0
ds_read_b64_tr_b16 a[198:199], v169 offset:4096
v_mfma_f32_16x16x32_bf16 v[88:91], a[208:211], a[56:59], v[88:91]
s_add_u32 m0, s82, 4096
ds_read_b64_tr_b16 a[200:201], v170 offset:0
ds_read_b64_tr_b16 a[202:203], v170 offset:4096
v_mfma_f32_16x16x32_bf16 v[120:123], a[208:211], a[60:63], v[120:123]
s_add_u32 s48, s43, 165888
ds_read_b64_tr_b16 a[204:205], v171 offset:0
ds_read_b64_tr_b16 a[206:207], v171 offset:4096
v_mfma_f32_16x16x32_bf16 v[92:95], a[212:215], a[56:59], v[92:95]
buffer_load_dwordx4 v236, s[16:19], s48 offen lds
v_mfma_f32_16x16x32_bf16 v[124:127], a[212:215], a[60:63], v[124:127]
ds_read_b64_tr_b16 a[208:209], v172 offset:0
ds_read_b64_tr_b16 a[210:211], v172 offset:4096
v_mfma_f32_16x16x32_bf16 v[96:99], a[216:219], a[56:59], v[96:99]
ds_read_b64_tr_b16 a[212:213], v173 offset:0
ds_read_b64_tr_b16 a[214:215], v173 offset:4096
v_mfma_f32_16x16x32_bf16 v[128:131], a[216:219], a[60:63], v[128:131]
ds_read_b64_tr_b16 a[216:217], v174 offset:0
ds_read_b64_tr_b16 a[218:219], v174 offset:4096
v_mfma_f32_16x16x32_bf16 v[100:103], a[220:223], a[56:59], v[100:103]
v_mfma_f32_16x16x32_bf16 v[132:135], a[220:223], a[60:63], v[132:135]
s_waitcnt lgkmcnt(6)
ds_read_b64_tr_b16 a[220:221], v175 offset:0
ds_read_b64_tr_b16 a[222:223], v175 offset:4096
s_waitcnt vmcnt(27)
v_mfma_f32_16x16x32_bf16 v[72:75], a[192:195], a[64:67], v[72:75]
s_add_u32 m0, s82, 8192
v_mfma_f32_16x16x32_bf16 v[104:107], a[192:195], a[68:71], v[104:107]
s_add_u32 s48, s43, 184320
buffer_load_dwordx4 v236, s[16:19], s48 offen lds
v_mfma_f32_16x16x32_bf16 v[76:79], a[196:199], a[64:67], v[76:79]
ds_read_b64_tr_b16 a[192:193], v168 offset:8192
ds_read_b64_tr_b16 a[194:195], v168 offset:12288
v_mfma_f32_16x16x32_bf16 v[108:111], a[196:199], a[68:71], v[108:111]
s_add_u32 m0, s82, 12288
ds_read_b64_tr_b16 a[196:197], v169 offset:8192
ds_read_b64_tr_b16 a[198:199], v169 offset:12288
v_mfma_f32_16x16x32_bf16 v[80:83], a[200:203], a[64:67], v[80:83]
s_add_u32 s48, s43, 202752
v_mfma_f32_16x16x32_bf16 v[112:115], a[200:203], a[68:71], v[112:115]
buffer_load_dwordx4 v236, s[16:19], s48 offen lds
v_mfma_f32_16x16x32_bf16 v[84:87], a[204:207], a[64:67], v[84:87]
s_waitcnt lgkmcnt(6)
ds_read_b64_tr_b16 a[200:201], v170 offset:8192
ds_read_b64_tr_b16 a[202:203], v170 offset:12288
v_mfma_f32_16x16x32_bf16 v[116:119], a[204:207], a[68:71], v[116:119]
s_add_u32 m0, s82, 16384
ds_read_b64_tr_b16 a[204:205], v171 offset:8192
ds_read_b64_tr_b16 a[206:207], v171 offset:12288
v_mfma_f32_16x16x32_bf16 v[88:91], a[208:211], a[64:67], v[88:91]
s_add_u32 s48, s43, 221184
v_mfma_f32_16x16x32_bf16 v[120:123], a[208:211], a[68:71], v[120:123]
buffer_load_dwordx4 v236, s[16:19], s48 offen lds
v_mfma_f32_16x16x32_bf16 v[92:95], a[212:215], a[64:67], v[92:95]
ds_read_b64_tr_b16 a[208:209], v172 offset:8192
ds_read_b64_tr_b16 a[210:211], v172 offset:12288
v_mfma_f32_16x16x32_bf16 v[124:127], a[212:215], a[68:71], v[124:127]
s_add_u32 m0, s82, 20480
ds_read_b64_tr_b16 a[212:213], v173 offset:8192
ds_read_b64_tr_b16 a[214:215], v173 offset:12288
v_mfma_f32_16x16x32_bf16 v[96:99], a[216:219], a[64:67], v[96:99]
s_add_u32 s48, s43, 239616
v_mfma_f32_16x16x32_bf16 v[128:131], a[216:219], a[68:71], v[128:131]
s_waitcnt lgkmcnt(6)
buffer_load_dwordx4 v236, s[16:19], s48 offen lds
v_mfma_f32_16x16x32_bf16 v[100:103], a[220:223], a[64:67], v[100:103]
ds_read_b64_tr_b16 a[216:217], v174 offset:8192
ds_read_b64_tr_b16 a[218:219], v174 offset:12288
v_mfma_f32_16x16x32_bf16 v[132:135], a[220:223], a[68:71], v[132:135]
ds_read_b64_tr_b16 a[220:221], v175 offset:8192
ds_read_b64_tr_b16 a[222:223], v175 offset:12288
v_mfma_f32_16x16x32_bf16 v[72:75], a[192:195], a[72:75], v[72:75]
s_add_u32 m0, s82, 24576
v_mfma_f32_16x16x32_bf16 v[104:107], a[192:195], a[76:79], v[104:107]
s_add_u32 s48, s43, 258048
buffer_load_dwordx4 v236, s[16:19], s48 offen lds
v_mfma_f32_16x16x32_bf16 v[76:79], a[196:199], a[72:75], v[76:79]
ds_read_b64_tr_b16 a[192:193], v168 offset:16384
ds_read_b64_tr_b16 a[194:195], v168 offset:20480
v_mfma_f32_16x16x32_bf16 v[108:111], a[196:199], a[76:79], v[108:111]
s_add_u32 m0, s82, 28672
ds_read_b64_tr_b16 a[196:197], v169 offset:16384
ds_read_b64_tr_b16 a[198:199], v169 offset:20480
v_mfma_f32_16x16x32_bf16 v[80:83], a[200:203], a[72:75], v[80:83]
s_add_u32 s48, s43, 276480
v_mfma_f32_16x16x32_bf16 v[112:115], a[200:203], a[76:79], v[112:115]
s_waitcnt lgkmcnt(6)
buffer_load_dwordx4 v236, s[16:19], s48 offen lds
v_mfma_f32_16x16x32_bf16 v[84:87], a[204:207], a[72:75], v[84:87]
ds_read_b64_tr_b16 a[200:201], v170 offset:16384
ds_read_b64_tr_b16 a[202:203], v170 offset:20480
v_mfma_f32_16x16x32_bf16 v[116:119], a[204:207], a[76:79], v[116:119]
s_add_u32 m0, s83, 0
ds_read_b64_tr_b16 a[204:205], v171 offset:16384
ds_read_b64_tr_b16 a[206:207], v171 offset:20480
v_mfma_f32_16x16x32_bf16 v[88:91], a[208:211], a[72:75], v[88:91]
s_add_u32 s48, s44, 147456
v_mfma_f32_16x16x32_bf16 v[120:123], a[208:211], a[76:79], v[120:123]
buffer_load_dwordx4 v236, s[16:19], s48 offen lds
v_mfma_f32_16x16x32_bf16 v[92:95], a[212:215], a[72:75], v[92:95]
ds_read_b64_tr_b16 a[208:209], v172 offset:16384
ds_read_b64_tr_b16 a[210:211], v172 offset:20480
v_mfma_f32_16x16x32_bf16 v[124:127], a[212:215], a[76:79], v[124:127]
s_add_u32 m0, s83, 4096
ds_read_b64_tr_b16 a[212:213], v173 offset:16384
ds_read_b64_tr_b16 a[214:215], v173 offset:20480
v_mfma_f32_16x16x32_bf16 v[96:99], a[216:219], a[72:75], v[96:99]
s_add_u32 s48, s44, 165888
v_mfma_f32_16x16x32_bf16 v[128:131], a[216:219], a[76:79], v[128:131]
s_waitcnt lgkmcnt(6)
buffer_load_dwordx4 v236, s[16:19], s48 offen lds
v_mfma_f32_16x16x32_bf16 v[100:103], a[220:223], a[72:75], v[100:103]
ds_read_b64_tr_b16 a[216:217], v174 offset:16384
ds_read_b64_tr_b16 a[218:219], v174 offset:20480
v_mfma_f32_16x16x32_bf16 v[132:135], a[220:223], a[76:79], v[132:135]
ds_read_b64_tr_b16 a[220:221], v175 offset:16384
ds_read_b64_tr_b16 a[222:223], v175 offset:20480
v_mfma_f32_16x16x32_bf16 v[72:75], a[192:195], a[80:83], v[72:75]
s_add_u32 m0, s83, 8192
v_mfma_f32_16x16x32_bf16 v[104:107], a[192:195], a[84:87], v[104:107]
s_add_u32 s48, s44, 184320
buffer_load_dwordx4 v236, s[16:19], s48 offen lds
v_mfma_f32_16x16x32_bf16 v[76:79], a[196:199], a[80:83], v[76:79]
ds_read_b64_tr_b16 a[192:193], v168 offset:24576
ds_read_b64_tr_b16 a[194:195], v168 offset:28672
v_mfma_f32_16x16x32_bf16 v[108:111], a[196:199], a[84:87], v[108:111]
s_add_u32 m0, s83, 12288
ds_read_b64_tr_b16 a[196:197], v169 offset:24576
ds_read_b64_tr_b16 a[198:199], v169 offset:28672
v_mfma_f32_16x16x32_bf16 v[80:83], a[200:203], a[80:83], v[80:83]
s_add_u32 s48, s44, 202752
v_mfma_f32_16x16x32_bf16 v[112:115], a[200:203], a[84:87], v[112:115]
s_waitcnt lgkmcnt(6)
buffer_load_dwordx4 v236, s[16:19], s48 offen lds
v_mfma_f32_16x16x32_bf16 v[84:87], a[204:207], a[80:83], v[84:87]
ds_read_b64_tr_b16 a[200:201], v170 offset:24576
ds_read_b64_tr_b16 a[202:203], v170 offset:28672
v_mfma_f32_16x16x32_bf16 v[116:119], a[204:207], a[84:87], v[116:119]
s_add_u32 m0, s83, 16384
ds_read_b64_tr_b16 a[204:205], v171 offset:24576
ds_read_b64_tr_b16 a[206:207], v171 offset:28672
v_mfma_f32_16x16x32_bf16 v[88:91], a[208:211], a[80:83], v[88:91]
s_add_u32 s48, s44, 221184
v_mfma_f32_16x16x32_bf16 v[120:123], a[208:211], a[84:87], v[120:123]
buffer_load_dwordx4 v236, s[16:19], s48 offen lds
v_mfma_f32_16x16x32_bf16 v[92:95], a[212:215], a[80:83], v[92:95]
ds_read_b64_tr_b16 a[208:209], v172 offset:24576
ds_read_b64_tr_b16 a[210:211], v172 offset:28672
v_mfma_f32_16x16x32_bf16 v[124:127], a[212:215], a[84:87], v[124:127]
s_add_u32 m0, s83, 20480
ds_read_b64_tr_b16 a[212:213], v173 offset:24576
ds_read_b64_tr_b16 a[214:215], v173 offset:28672
v_mfma_f32_16x16x32_bf16 v[96:99], a[216:219], a[80:83], v[96:99]
s_add_u32 s48, s44, 239616
v_mfma_f32_16x16x32_bf16 v[128:131], a[216:219], a[84:87], v[128:131]
s_waitcnt lgkmcnt(6)
buffer_load_dwordx4 v236, s[16:19], s48 offen lds
v_mfma_f32_16x16x32_bf16 v[100:103], a[220:223], a[80:83], v[100:103]
ds_read_b64_tr_b16 a[216:217], v174 offset:24576
ds_read_b64_tr_b16 a[218:219], v174 offset:28672
v_mfma_f32_16x16x32_bf16 v[132:135], a[220:223], a[84:87], v[132:135]
ds_read_b64_tr_b16 a[220:221], v175 offset:24576
ds_read_b64_tr_b16 a[222:223], v175 offset:28672
s_waitcnt vmcnt(18)
v_mov_b32 v5, 1
s_lshl_b32 s46, s33, 2
s_add_u32 s46, s46, s45
s_mov_b64 exec, 1
buffer_store_dword v5, v234, s[20:23], s46 offen sc0 sc1
s_mov_b64 exec, -1
v_mfma_f32_16x16x32_bf16 v[72:75], a[192:195], a[88:91], v[72:75]
s_add_u32 m0, s83, 24576
v_mfma_f32_16x16x32_bf16 v[104:107], a[192:195], a[92:95], v[104:107]
s_add_u32 s48, s44, 258048
buffer_load_dwordx4 v236, s[16:19], s48 offen lds
v_mfma_f32_16x16x32_bf16 v[76:79], a[196:199], a[88:91], v[76:79]
ds_read_b64_tr_b16 a[192:193], v176 offset:0
ds_read_b64_tr_b16 a[194:195], v176 offset:4096
v_mfma_f32_16x16x32_bf16 v[108:111], a[196:199], a[92:95], v[108:111]
s_add_u32 m0, s83, 28672
ds_read_b64_tr_b16 a[196:197], v177 offset:0
ds_read_b64_tr_b16 a[198:199], v177 offset:4096
v_mfma_f32_16x16x32_bf16 v[80:83], a[200:203], a[88:91], v[80:83]
s_add_u32 s48, s44, 276480
v_mfma_f32_16x16x32_bf16 v[112:115], a[200:203], a[92:95], v[112:115]
s_waitcnt lgkmcnt(6)
buffer_load_dwordx4 v236, s[16:19], s48 offen lds
v_mfma_f32_16x16x32_bf16 v[84:87], a[204:207], a[88:91], v[84:87]
ds_read_b64_tr_b16 a[200:201], v178 offset:0
ds_read_b64_tr_b16 a[202:203], v178 offset:4096
v_mfma_f32_16x16x32_bf16 v[116:119], a[204:207], a[92:95], v[116:119]
s_add_u32 s94, s39, 8192
ds_read_b64_tr_b16 a[204:205], v179 offset:0
ds_read_b64_tr_b16 a[206:207], v179 offset:4096
v_mfma_f32_16x16x32_bf16 v[88:91], a[208:211], a[88:91], v[88:91]
v_mfma_f32_16x16x32_bf16 v[120:123], a[208:211], a[92:95], v[120:123]
buffer_load_dwordx4 a[128:131], v234, s[76:79], s94 offen offset:0 sc0 sc1
v_mfma_f32_16x16x32_bf16 v[92:95], a[212:215], a[88:91], v[92:95]
ds_read_b64_tr_b16 a[208:209], v180 offset:0
ds_read_b64_tr_b16 a[210:211], v180 offset:4096
v_mfma_f32_16x16x32_bf16 v[124:127], a[212:215], a[92:95], v[124:127]
ds_read_b64_tr_b16 a[212:213], v181 offset:0
ds_read_b64_tr_b16 a[214:215], v181 offset:4096
v_mfma_f32_16x16x32_bf16 v[96:99], a[216:219], a[88:91], v[96:99]
v_mfma_f32_16x16x32_bf16 v[128:131], a[216:219], a[92:95], v[128:131]
s_waitcnt lgkmcnt(6)
buffer_load_dwordx4 a[132:135], v234, s[76:79], s94 offen offset:1024 sc0 sc1
v_mfma_f32_16x16x32_bf16 v[100:103], a[220:223], a[88:91], v[100:103]
ds_read_b64_tr_b16 a[216:217], v182 offset:0
ds_read_b64_tr_b16 a[218:219], v182 offset:4096
v_mfma_f32_16x16x32_bf16 v[132:135], a[220:223], a[92:95], v[132:135]
ds_read_b64_tr_b16 a[220:221], v183 offset:0
ds_read_b64_tr_b16 a[222:223], v183 offset:4096
s_waitcnt vmcnt(19)
v_mfma_f32_16x16x32_bf16 v[72:75], a[192:195], a[96:99], v[72:75]
v_mfma_f32_16x16x32_bf16 v[104:107], a[192:195], a[100:103], v[104:107]
buffer_load_dwordx4 a[136:139], v234, s[76:79], s94 offen offset:2048 sc0 sc1
v_mfma_f32_16x16x32_bf16 v[76:79], a[196:199], a[96:99], v[76:79]
ds_read_b64_tr_b16 a[192:193], v176 offset:8192
ds_read_b64_tr_b16 a[194:195], v176 offset:12288
v_mfma_f32_16x16x32_bf16 v[108:111], a[196:199], a[100:103], v[108:111]
ds_read_b64_tr_b16 a[196:197], v177 offset:8192
ds_read_b64_tr_b16 a[198:199], v177 offset:12288
v_mfma_f32_16x16x32_bf16 v[80:83], a[200:203], a[96:99], v[80:83]
v_mfma_f32_16x16x32_bf16 v[112:115], a[200:203], a[100:103], v[112:115]
s_waitcnt lgkmcnt(6)
buffer_load_dwordx4 a[140:143], v234, s[76:79], s94 offen offset:3072 sc0 sc1
v_mfma_f32_16x16x32_bf16 v[84:87], a[204:207], a[96:99], v[84:87]
ds_read_b64_tr_b16 a[200:201], v178 offset:8192
ds_read_b64_tr_b16 a[202:203], v178 offset:12288
v_mfma_f32_16x16x32_bf16 v[116:119], a[204:207], a[100:103], v[116:119]
s_add_u32 s94, s39, 12288
ds_read_b64_tr_b16 a[204:205], v179 offset:8192
ds_read_b64_tr_b16 a[206:207], v179 offset:12288
v_mfma_f32_16x16x32_bf16 v[88:91], a[208:211], a[96:99], v[88:91]
v_mfma_f32_16x16x32_bf16 v[120:123], a[208:211], a[100:103], v[120:123]
buffer_load_dwordx4 a[144:147], v234, s[76:79], s94 offen offset:0 sc0 sc1
v_mfma_f32_16x16x32_bf16 v[92:95], a[212:215], a[96:99], v[92:95]
ds_read_b64_tr_b16 a[208:209], v180 offset:8192
ds_read_b64_tr_b16 a[210:211], v180 offset:12288
v_mfma_f32_16x16x32_bf16 v[124:127], a[212:215], a[100:103], v[124:127]
ds_read_b64_tr_b16 a[212:213], v181 offset:8192
ds_read_b64_tr_b16 a[214:215], v181 offset:12288
v_mfma_f32_16x16x32_bf16 v[96:99], a[216:219], a[96:99], v[96:99]
v_mfma_f32_16x16x32_bf16 v[128:131], a[216:219], a[100:103], v[128:131]
s_waitcnt lgkmcnt(6)
buffer_load_dwordx4 a[148:151], v234, s[76:79], s94 offen offset:1024 sc0 sc1
v_mfma_f32_16x16x32_bf16 v[100:103], a[220:223], a[96:99], v[100:103]
ds_read_b64_tr_b16 a[216:217], v182 offset:8192
ds_read_b64_tr_b16 a[218:219], v182 offset:12288
v_mfma_f32_16x16x32_bf16 v[132:135], a[220:223], a[100:103], v[132:135]
ds_read_b64_tr_b16 a[220:221], v183 offset:8192
ds_read_b64_tr_b16 a[222:223], v183 offset:12288
v_mfma_f32_16x16x32_bf16 v[72:75], a[192:195], a[104:107], v[72:75]
v_mfma_f32_16x16x32_bf16 v[104:107], a[192:195], a[108:111], v[104:107]
buffer_load_dwordx4 a[152:155], v234, s[76:79], s94 offen offset:2048 sc0 sc1
v_mfma_f32_16x16x32_bf16 v[76:79], a[196:199], a[104:107], v[76:79]
ds_read_b64_tr_b16 a[192:193], v176 offset:16384
ds_read_b64_tr_b16 a[194:195], v176 offset:20480
v_mfma_f32_16x16x32_bf16 v[108:111], a[196:199], a[108:111], v[108:111]
ds_read_b64_tr_b16 a[196:197], v177 offset:16384
ds_read_b64_tr_b16 a[198:199], v177 offset:20480
v_mfma_f32_16x16x32_bf16 v[80:83], a[200:203], a[104:107], v[80:83]
v_mfma_f32_16x16x32_bf16 v[112:115], a[200:203], a[108:111], v[112:115]
s_waitcnt lgkmcnt(6)
buffer_load_dwordx4 a[156:159], v234, s[76:79], s94 offen offset:3072 sc0 sc1
v_mfma_f32_16x16x32_bf16 v[84:87], a[204:207], a[104:107], v[84:87]
ds_read_b64_tr_b16 a[200:201], v178 offset:16384
ds_read_b64_tr_b16 a[202:203], v178 offset:20480
v_mfma_f32_16x16x32_bf16 v[116:119], a[204:207], a[108:111], v[116:119]
s_add_u32 s94, s40, 8192
ds_read_b64_tr_b16 a[204:205], v179 offset:16384
ds_read_b64_tr_b16 a[206:207], v179 offset:20480
v_mfma_f32_16x16x32_bf16 v[88:91], a[208:211], a[104:107], v[88:91]
v_mfma_f32_16x16x32_bf16 v[120:123], a[208:211], a[108:111], v[120:123]
buffer_load_dwordx4 a[160:163], v234, s[76:79], s94 offen offset:0 sc0 sc1
v_mfma_f32_16x16x32_bf16 v[92:95], a[212:215], a[104:107], v[92:95]
ds_read_b64_tr_b16 a[208:209], v180 offset:16384
ds_read_b64_tr_b16 a[210:211], v180 offset:20480
v_mfma_f32_16x16x32_bf16 v[124:127], a[212:215], a[108:111], v[124:127]
ds_read_b64_tr_b16 a[212:213], v181 offset:16384
ds_read_b64_tr_b16 a[214:215], v181 offset:20480
v_mfma_f32_16x16x32_bf16 v[96:99], a[216:219], a[104:107], v[96:99]
v_mfma_f32_16x16x32_bf16 v[128:131], a[216:219], a[108:111], v[128:131]
s_waitcnt lgkmcnt(6)
buffer_load_dwordx4 a[164:167], v234, s[76:79], s94 offen offset:1024 sc0 sc1
v_mfma_f32_16x16x32_bf16 v[100:103], a[220:223], a[104:107], v[100:103]
ds_read_b64_tr_b16 a[216:217], v182 offset:16384
ds_read_b64_tr_b16 a[218:219], v182 offset:20480
v_mfma_f32_16x16x32_bf16 v[132:135], a[220:223], a[108:111], v[132:135]
ds_read_b64_tr_b16 a[220:221], v183 offset:16384
ds_read_b64_tr_b16 a[222:223], v183 offset:20480
v_mfma_f32_16x16x32_bf16 v[72:75], a[192:195], a[112:115], v[72:75]
v_mfma_f32_16x16x32_bf16 v[104:107], a[192:195], a[116:119], v[104:107]
buffer_load_dwordx4 a[168:171], v234, s[76:79], s94 offen offset:2048 sc0 sc1
v_mfma_f32_16x16x32_bf16 v[76:79], a[196:199], a[112:115], v[76:79]
ds_read_b64_tr_b16 a[192:193], v176 offset:24576
ds_read_b64_tr_b16 a[194:195], v176 offset:28672
v_mfma_f32_16x16x32_bf16 v[108:111], a[196:199], a[116:119], v[108:111]
ds_read_b64_tr_b16 a[196:197], v177 offset:24576
ds_read_b64_tr_b16 a[198:199], v177 offset:28672
v_mfma_f32_16x16x32_bf16 v[80:83], a[200:203], a[112:115], v[80:83]
v_mfma_f32_16x16x32_bf16 v[112:115], a[200:203], a[116:119], v[112:115]
s_waitcnt lgkmcnt(6)
buffer_load_dwordx4 a[172:175], v234, s[76:79], s94 offen offset:3072 sc0 sc1
v_mfma_f32_16x16x32_bf16 v[84:87], a[204:207], a[112:115], v[84:87]
ds_read_b64_tr_b16 a[200:201], v178 offset:24576
ds_read_b64_tr_b16 a[202:203], v178 offset:28672
v_mfma_f32_16x16x32_bf16 v[116:119], a[204:207], a[116:119], v[116:119]
s_add_u32 s94, s40, 12288
ds_read_b64_tr_b16 a[204:205], v179 offset:24576
ds_read_b64_tr_b16 a[206:207], v179 offset:28672
v_mfma_f32_16x16x32_bf16 v[88:91], a[208:211], a[112:115], v[88:91]
v_mfma_f32_16x16x32_bf16 v[120:123], a[208:211], a[116:119], v[120:123]
buffer_load_dwordx4 a[176:179], v234, s[76:79], s94 offen offset:0 sc0 sc1
v_mfma_f32_16x16x32_bf16 v[92:95], a[212:215], a[112:115], v[92:95]
ds_read_b64_tr_b16 a[208:209], v180 offset:24576
ds_read_b64_tr_b16 a[210:211], v180 offset:28672
v_mfma_f32_16x16x32_bf16 v[124:127], a[212:215], a[116:119], v[124:127]
ds_read_b64_tr_b16 a[212:213], v181 offset:24576
ds_read_b64_tr_b16 a[214:215], v181 offset:28672
v_mfma_f32_16x16x32_bf16 v[96:99], a[216:219], a[112:115], v[96:99]
v_mfma_f32_16x16x32_bf16 v[128:131], a[216:219], a[116:119], v[128:131]
s_waitcnt lgkmcnt(6)
buffer_load_dwordx4 a[180:183], v234, s[76:79], s94 offen offset:1024 sc0 sc1
v_mfma_f32_16x16x32_bf16 v[100:103], a[220:223], a[112:115], v[100:103]
ds_read_b64_tr_b16 a[216:217], v182 offset:24576
ds_read_b64_tr_b16 a[218:219], v182 offset:28672
v_mfma_f32_16x16x32_bf16 v[132:135], a[220:223], a[116:119], v[132:135]
ds_read_b64_tr_b16 a[220:221], v183 offset:24576
ds_read_b64_tr_b16 a[222:223], v183 offset:28672
v_mfma_f32_16x16x32_bf16 v[72:75], a[192:195], a[120:123], v[72:75]
v_mfma_f32_16x16x32_bf16 v[104:107], a[192:195], a[124:127], v[104:107]
v_mfma_f32_16x16x32_bf16 v[76:79], a[196:199], a[120:123], v[76:79]
v_mfma_f32_16x16x32_bf16 v[108:111], a[196:199], a[124:127], v[108:111]
v_mfma_f32_16x16x32_bf16 v[80:83], a[200:203], a[120:123], v[80:83]
s_waitcnt vmcnt(14) lgkmcnt(0)
s_barrier
v_mfma_f32_16x16x32_bf16 v[112:115], a[200:203], a[124:127], v[112:115]
ds_read_b64_tr_b16 a[192:193], v184 offset:0
ds_read_b64_tr_b16 a[194:195], v184 offset:4096
v_mfma_f32_16x16x32_bf16 v[84:87], a[204:207], a[120:123], v[84:87]
buffer_load_dwordx4 a[184:187], v234, s[76:79], s94 offen offset:2048 sc0 sc1
v_mfma_f32_16x16x32_bf16 v[116:119], a[204:207], a[124:127], v[116:119]
ds_read_b64_tr_b16 a[196:197], v185 offset:0
ds_read_b64_tr_b16 a[198:199], v185 offset:4096
v_mfma_f32_16x16x32_bf16 v[88:91], a[208:211], a[120:123], v[88:91]
ds_read_b64_tr_b16 a[200:201], v186 offset:0
ds_read_b64_tr_b16 a[202:203], v186 offset:4096
v_mfma_f32_16x16x32_bf16 v[120:123], a[208:211], a[124:127], v[120:123]
ds_read_b64_tr_b16 a[204:205], v187 offset:0
ds_read_b64_tr_b16 a[206:207], v187 offset:4096
v_mfma_f32_16x16x32_bf16 v[92:95], a[212:215], a[120:123], v[92:95]
buffer_load_dwordx4 a[188:191], v234, s[76:79], s94 offen offset:3072 sc0 sc1
v_mfma_f32_16x16x32_bf16 v[124:127], a[212:215], a[124:127], v[124:127]
ds_read_b64_tr_b16 a[208:209], v188 offset:0
ds_read_b64_tr_b16 a[210:211], v188 offset:4096
v_mfma_f32_16x16x32_bf16 v[96:99], a[216:219], a[120:123], v[96:99]
ds_read_b64_tr_b16 a[212:213], v189 offset:0
ds_read_b64_tr_b16 a[214:215], v189 offset:4096
v_mfma_f32_16x16x32_bf16 v[128:131], a[216:219], a[124:127], v[128:131]
ds_read_b64_tr_b16 a[216:217], v190 offset:0
ds_read_b64_tr_b16 a[218:219], v190 offset:4096
v_mfma_f32_16x16x32_bf16 v[100:103], a[220:223], a[120:123], v[100:103]
v_mfma_f32_16x16x32_bf16 v[132:135], a[220:223], a[124:127], v[132:135]
s_waitcnt lgkmcnt(6)
ds_read_b64_tr_b16 a[220:221], v191 offset:0
ds_read_b64_tr_b16 a[222:223], v191 offset:4096
s_waitcnt vmcnt(8)
v_mfma_f32_16x16x32_bf16 v[72:75], a[192:195], a[128:131], v[72:75]
s_add_u32 m0, s86, 0
v_mfma_f32_16x16x32_bf16 v[104:107], a[192:195], a[132:135], v[104:107]
buffer_load_dwordx4 v232, s[24:27], s87 offen  lds
v_mfma_f32_16x16x32_bf16 v[76:79], a[196:199], a[128:131], v[76:79]
ds_read_b64_tr_b16 a[192:193], v184 offset:8192
ds_read_b64_tr_b16 a[194:195], v184 offset:12288
v_mfma_f32_16x16x32_bf16 v[108:111], a[196:199], a[132:135], v[108:111]
s_add_u32 m0, s86, 1024
ds_read_b64_tr_b16 a[196:197], v185 offset:8192
ds_read_b64_tr_b16 a[198:199], v185 offset:12288
v_mfma_f32_16x16x32_bf16 v[80:83], a[200:203], a[128:131], v[80:83]
v_mfma_f32_16x16x32_bf16 v[112:115], a[200:203], a[132:135], v[112:115]
buffer_load_dwordx4 v233, s[24:27], s87 offen  lds
v_mfma_f32_16x16x32_bf16 v[84:87], a[204:207], a[128:131], v[84:87]
ds_read_b64_tr_b16 a[200:201], v186 offset:8192
ds_read_b64_tr_b16 a[202:203], v186 offset:12288
v_mfma_f32_16x16x32_bf16 v[116:119], a[204:207], a[132:135], v[116:119]
s_waitcnt lgkmcnt(6)
ds_read_b64_tr_b16 a[204:205], v187 offset:8192
ds_read_b64_tr_b16 a[206:207], v187 offset:12288
v_mfma_f32_16x16x32_bf16 v[88:91], a[208:211], a[128:131], v[88:91]
v_mfma_f32_16x16x32_bf16 v[120:123], a[208:211], a[132:135], v[120:123]
buffer_load_dwordx2 v[216:217], v242, s[24:27], s88 offen
v_mfma_f32_16x16x32_bf16 v[92:95], a[212:215], a[128:131], v[92:95]
ds_read_b64_tr_b16 a[208:209], v188 offset:8192
ds_read_b64_tr_b16 a[210:211], v188 offset:12288
v_mfma_f32_16x16x32_bf16 v[124:127], a[212:215], a[132:135], v[124:127]
s_add_u32 m0, s86, 2048
ds_read_b64_tr_b16 a[212:213], v189 offset:8192
ds_read_b64_tr_b16 a[214:215], v189 offset:12288
v_mfma_f32_16x16x32_bf16 v[96:99], a[216:219], a[128:131], v[96:99]
v_mfma_f32_16x16x32_bf16 v[128:131], a[216:219], a[132:135], v[128:131]
buffer_load_dwordx4 v232, s[20:23], s87 offen sc0 sc1 lds
v_mfma_f32_16x16x32_bf16 v[100:103], a[220:223], a[128:131], v[100:103]
ds_read_b64_tr_b16 a[216:217], v190 offset:8192
ds_read_b64_tr_b16 a[218:219], v190 offset:12288
v_mfma_f32_16x16x32_bf16 v[132:135], a[220:223], a[132:135], v[132:135]
s_waitcnt lgkmcnt(6)
ds_read_b64_tr_b16 a[220:221], v191 offset:8192
ds_read_b64_tr_b16 a[222:223], v191 offset:12288
v_mfma_f32_16x16x32_bf16 v[72:75], a[192:195], a[136:139], v[72:75]
s_add_u32 m0, s86, 3072
v_mfma_f32_16x16x32_bf16 v[104:107], a[192:195], a[140:143], v[104:107]
buffer_load_dwordx4 v233, s[20:23], s87 offen sc0 sc1 lds
v_mfma_f32_16x16x32_bf16 v[76:79], a[196:199], a[136:139], v[76:79]
ds_read_b64_tr_b16 a[192:193], v184 offset:16384
ds_read_b64_tr_b16 a[194:195], v184 offset:20480
v_mfma_f32_16x16x32_bf16 v[108:111], a[196:199], a[140:143], v[108:111]
ds_read_b64_tr_b16 a[196:197], v185 offset:16384
ds_read_b64_tr_b16 a[198:199], v185 offset:20480
v_mfma_f32_16x16x32_bf16 v[80:83], a[200:203], a[136:139], v[80:83]
v_mfma_f32_16x16x32_bf16 v[112:115], a[200:203], a[140:143], v[112:115]
buffer_load_dwordx2 v[226:227], v242, s[20:23], s88 offen sc0 sc1
v_mfma_f32_16x16x32_bf16 v[84:87], a[204:207], a[136:139], v[84:87]
ds_read_b64_tr_b16 a[200:201], v186 offset:16384
ds_read_b64_tr_b16 a[202:203], v186 offset:20480
v_mfma_f32_16x16x32_bf16 v[116:119], a[204:207], a[140:143], v[116:119]
s_waitcnt lgkmcnt(6)
ds_read_b64_tr_b16 a[204:205], v187 offset:16384
ds_read_b64_tr_b16 a[206:207], v187 offset:20480
v_mfma_f32_16x16x32_bf16 v[88:91], a[208:211], a[136:139], v[88:91]
v_mfma_f32_16x16x32_bf16 v[120:123], a[208:211], a[140:143], v[120:123]
ds_read_b64_tr_b16 a[208:209], v188 offset:16384
ds_read_b64_tr_b16 a[210:211], v188 offset:20480
v_mfma_f32_16x16x32_bf16 v[92:95], a[212:215], a[136:139], v[92:95]
v_mfma_f32_16x16x32_bf16 v[124:127], a[212:215], a[140:143], v[124:127]
ds_read_b64_tr_b16 a[212:213], v189 offset:16384
ds_read_b64_tr_b16 a[214:215], v189 offset:20480
v_mfma_f32_16x16x32_bf16 v[96:99], a[216:219], a[136:139], v[96:99]
v_mfma_f32_16x16x32_bf16 v[128:131], a[216:219], a[140:143], v[128:131]
ds_read_b64_tr_b16 a[216:217], v190 offset:16384
ds_read_b64_tr_b16 a[218:219], v190 offset:20480
v_mfma_f32_16x16x32_bf16 v[100:103], a[220:223], a[136:139], v[100:103]
v_mfma_f32_16x16x32_bf16 v[132:135], a[220:223], a[140:143], v[132:135]
s_waitcnt lgkmcnt(6)
ds_read_b64_tr_b16 a[220:221], v191 offset:16384
ds_read_b64_tr_b16 a[222:223], v191 offset:20480
v_mfma_f32_16x16x32_bf16 v[72:75], a[192:195], a[144:147], v[72:75]
v_mfma_f32_16x16x32_bf16 v[104:107], a[192:195], a[148:151], v[104:107]
ds_read_b64_tr_b16 a[192:193], v184 offset:24576
ds_read_b64_tr_b16 a[194:195], v184 offset:28672
v_mfma_f32_16x16x32_bf16 v[76:79], a[196:199], a[144:147], v[76:79]
v_mfma_f32_16x16x32_bf16 v[108:111], a[196:199], a[148:151], v[108:111]
ds_read_b64_tr_b16 a[196:197], v185 offset:24576
ds_read_b64_tr_b16 a[198:199], v185 offset:28672
v_mfma_f32_16x16x32_bf16 v[80:83], a[200:203], a[144:147], v[80:83]
v_mfma_f32_16x16x32_bf16 v[112:115], a[200:203], a[148:151], v[112:115]
ds_read_b64_tr_b16 a[200:201], v186 offset:24576
ds_read_b64_tr_b16 a[202:203], v186 offset:28672
v_mfma_f32_16x16x32_bf16 v[84:87], a[204:207], a[144:147], v[84:87]
v_mfma_f32_16x16x32_bf16 v[116:119], a[204:207], a[148:151], v[116:119]
s_waitcnt lgkmcnt(6)
ds_read_b64_tr_b16 a[204:205], v187 offset:24576
ds_read_b64_tr_b16 a[206:207], v187 offset:28672
v_mfma_f32_16x16x32_bf16 v[88:91], a[208:211], a[144:147], v[88:91]
v_mfma_f32_16x16x32_bf16 v[120:123], a[208:211], a[148:151], v[120:123]
ds_read_b64_tr_b16 a[208:209], v188 offset:24576
ds_read_b64_tr_b16 a[210:211], v188 offset:28672
v_mfma_f32_16x16x32_bf16 v[92:95], a[212:215], a[144:147], v[92:95]
v_mfma_f32_16x16x32_bf16 v[124:127], a[212:215], a[148:151], v[124:127]
ds_read_b64_tr_b16 a[212:213], v189 offset:24576
ds_read_b64_tr_b16 a[214:215], v189 offset:28672
v_mfma_f32_16x16x32_bf16 v[96:99], a[216:219], a[144:147], v[96:99]
v_mfma_f32_16x16x32_bf16 v[128:131], a[216:219], a[148:151], v[128:131]
ds_read_b64_tr_b16 a[216:217], v190 offset:24576
ds_read_b64_tr_b16 a[218:219], v190 offset:28672
v_mfma_f32_16x16x32_bf16 v[100:103], a[220:223], a[144:147], v[100:103]
v_mfma_f32_16x16x32_bf16 v[132:135], a[220:223], a[148:151], v[132:135]
s_waitcnt lgkmcnt(6)
ds_read_b64_tr_b16 a[220:221], v191 offset:24576
ds_read_b64_tr_b16 a[222:223], v191 offset:28672
v_mfma_f32_16x16x32_bf16 v[72:75], a[192:195], a[152:155], v[72:75]
v_mfma_f32_16x16x32_bf16 v[104:107], a[192:195], a[156:159], v[104:107]
ds_read_b64_tr_b16 a[192:193], v192 offset:0
ds_read_b64_tr_b16 a[194:195], v192 offset:4096
v_mfma_f32_16x16x32_bf16 v[76:79], a[196:199], a[152:155], v[76:79]
v_mfma_f32_16x16x32_bf16 v[108:111], a[196:199], a[156:159], v[108:111]
ds_read_b64_tr_b16 a[196:197], v193 offset:0
ds_read_b64_tr_b16 a[198:199], v193 offset:4096
v_mfma_f32_16x16x32_bf16 v[80:83], a[200:203], a[152:155], v[80:83]
v_mfma_f32_16x16x32_bf16 v[112:115], a[200:203], a[156:159], v[112:115]
ds_read_b64_tr_b16 a[200:201], v194 offset:0
ds_read_b64_tr_b16 a[202:203], v194 offset:4096
v_mfma_f32_16x16x32_bf16 v[84:87], a[204:207], a[152:155], v[84:87]
v_mfma_f32_16x16x32_bf16 v[116:119], a[204:207], a[156:159], v[116:119]
s_waitcnt lgkmcnt(6)
ds_read_b64_tr_b16 a[204:205], v195 offset:0
ds_read_b64_tr_b16 a[206:207], v195 offset:4096
v_mfma_f32_16x16x32_bf16 v[88:91], a[208:211], a[152:155], v[88:91]
v_mfma_f32_16x16x32_bf16 v[120:123], a[208:211], a[156:159], v[120:123]
ds_read_b64_tr_b16 a[208:209], v196 offset:0
ds_read_b64_tr_b16 a[210:211], v196 offset:4096
v_mfma_f32_16x16x32_bf16 v[92:95], a[212:215], a[152:155], v[92:95]
v_mfma_f32_16x16x32_bf16 v[124:127], a[212:215], a[156:159], v[124:127]
ds_read_b64_tr_b16 a[212:213], v197 offset:0
ds_read_b64_tr_b16 a[214:215], v197 offset:4096
v_mfma_f32_16x16x32_bf16 v[96:99], a[216:219], a[152:155], v[96:99]
v_mfma_f32_16x16x32_bf16 v[128:131], a[216:219], a[156:159], v[128:131]
ds_read_b64_tr_b16 a[216:217], v198 offset:0
ds_read_b64_tr_b16 a[218:219], v198 offset:4096
v_mfma_f32_16x16x32_bf16 v[100:103], a[220:223], a[152:155], v[100:103]
v_mfma_f32_16x16x32_bf16 v[132:135], a[220:223], a[156:159], v[132:135]
s_waitcnt lgkmcnt(6)
ds_read_b64_tr_b16 a[220:221], v199 offset:0
ds_read_b64_tr_b16 a[222:223], v199 offset:4096
s_waitcnt vmcnt(6)
v_subrev_u32 v245, s55, v254
v_subrev_u32 v245, 1, v245
v_cmp_gt_u32 vcc, 16, v245
s_and_b32 s92, vcc_lo, 0xff
s_cselect_b32 s47, 4, 0x1000
v_mfma_f32_16x16x32_bf16 v[72:75], a[192:195], a[160:163], v[72:75]
v_lshlrev_b32 v7, 2, v3
v_mov_b32 v40, 0
v_mfma_f32_16x16x32_bf16 v[104:107], a[192:195], a[164:167], v[104:107]
buffer_load_dword v241, v7, s[20:23], s45 offen sc0 sc1
v_mfma_f32_16x16x32_bf16 v[76:79], a[196:199], a[160:163], v[76:79]
ds_read_b64_tr_b16 a[192:193], v192 offset:8192
ds_read_b64_tr_b16 a[194:195], v192 offset:12288
v_mfma_f32_16x16x32_bf16 v[108:111], a[196:199], a[164:167], v[108:111]
ds_read_b64_tr_b16 a[196:197], v193 offset:8192
v_mov_b32 v6, 0
v_mfma_f32_16x16x32_bf16 v[80:83], a[200:203], a[160:163], v[80:83]
ds_read_b64_tr_b16 a[198:199], v193 offset:12288
v_mov_b32 v41, 0
v_mfma_f32_16x16x32_bf16 v[112:115], a[200:203], a[164:167], v[112:115]
buffer_load_dword v244, v6, s[28:31], s47 offen sc0 sc1
v_mfma_f32_16x16x32_bf16 v[84:87], a[204:207], a[160:163], v[84:87]
ds_read_b64_tr_b16 a[200:201], v194 offset:8192
ds_read_b64_tr_b16 a[202:203], v194 offset:12288
v_mfma_f32_16x16x32_bf16 v[116:119], a[204:207], a[164:167], v[116:119]
s_waitcnt lgkmcnt(6)
ds_read_b64_tr_b16 a[204:205], v195 offset:8192
ds_read_b64_tr_b16 a[206:207], v195 offset:12288
v_mfma_f32_16x16x32_bf16 v[88:91], a[208:211], a[160:163], v[88:91]
v_mov_b32 v42, 0
v_mov_b32 v43, 0
v_mfma_f32_16x16x32_bf16 v[120:123], a[208:211], a[164:167], v[120:123]
ds_read_b64_tr_b16 a[208:209], v196 offset:8192
ds_read_b64_tr_b16 a[210:211], v196 offset:12288
v_mfma_f32_16x16x32_bf16 v[92:95], a[212:215], a[160:163], v[92:95]
v_mov_b32 v44, 0
v_mov_b32 v45, 0
v_mfma_f32_16x16x32_bf16 v[124:127], a[212:215], a[164:167], v[124:127]
ds_read_b64_tr_b16 a[212:213], v197 offset:8192
ds_read_b64_tr_b16 a[214:215], v197 offset:12288
v_mfma_f32_16x16x32_bf16 v[96:99], a[216:219], a[160:163], v[96:99]
v_mov_b32 v46, 0
v_mov_b32 v47, 0
v_mfma_f32_16x16x32_bf16 v[128:131], a[216:219], a[164:167], v[128:131]
ds_read_b64_tr_b16 a[216:217], v198 offset:8192
ds_read_b64_tr_b16 a[218:219], v198 offset:12288
v_mfma_f32_16x16x32_bf16 v[100:103], a[220:223], a[160:163], v[100:103]
v_mov_b32 v48, 0
v_mov_b32 v49, 0
v_mfma_f32_16x16x32_bf16 v[132:135], a[220:223], a[164:167], v[132:135]
s_waitcnt lgkmcnt(6)
ds_read_b64_tr_b16 a[220:221], v199 offset:8192
ds_read_b64_tr_b16 a[222:223], v199 offset:12288
v_mfma_f32_16x16x32_bf16 v[72:75], a[192:195], a[168:171], v[72:75]
v_mov_b32 v50, 0
v_mov_b32 v51, 0
v_mfma_f32_16x16x32_bf16 v[104:107], a[192:195], a[172:175], v[104:107]
ds_read_b64_tr_b16 a[192:193], v192 offset:16384
ds_read_b64_tr_b16 a[194:195], v192 offset:20480
v_mfma_f32_16x16x32_bf16 v[76:79], a[196:199], a[168:171], v[76:79]
v_mov_b32 v52, 0
v_mov_b32 v53, 0
v_mfma_f32_16x16x32_bf16 v[108:111], a[196:199], a[172:175], v[108:111]
ds_read_b64_tr_b16 a[196:197], v193 offset:16384
ds_read_b64_tr_b16 a[198:199], v193 offset:20480
v_mfma_f32_16x16x32_bf16 v[80:83], a[200:203], a[168:171], v[80:83]
v_mov_b32 v54, 0
v_mov_b32 v55, 0
v_mfma_f32_16x16x32_bf16 v[112:115], a[200:203], a[172:175], v[112:115]
ds_read_b64_tr_b16 a[200:201], v194 offset:16384
ds_read_b64_tr_b16 a[202:203], v194 offset:20480
v_mfma_f32_16x16x32_bf16 v[84:87], a[204:207], a[168:171], v[84:87]
v_mov_b32 v56, 0
v_mov_b32 v57, 0
v_mfma_f32_16x16x32_bf16 v[116:119], a[204:207], a[172:175], v[116:119]
s_waitcnt lgkmcnt(6)
ds_read_b64_tr_b16 a[204:205], v195 offset:16384
ds_read_b64_tr_b16 a[206:207], v195 offset:20480
v_mfma_f32_16x16x32_bf16 v[88:91], a[208:211], a[168:171], v[88:91]
v_mov_b32 v58, 0
v_mov_b32 v59, 0
v_mfma_f32_16x16x32_bf16 v[120:123], a[208:211], a[172:175], v[120:123]
ds_read_b64_tr_b16 a[208:209], v196 offset:16384
ds_read_b64_tr_b16 a[210:211], v196 offset:20480
v_mfma_f32_16x16x32_bf16 v[92:95], a[212:215], a[168:171], v[92:95]
v_mfma_f32_16x16x32_bf16 v[124:127], a[212:215], a[172:175], v[124:127]
ds_read_b64_tr_b16 a[212:213], v197 offset:16384
ds_read_b64_tr_b16 a[214:215], v197 offset:20480
v_mfma_f32_16x16x32_bf16 v[96:99], a[216:219], a[168:171], v[96:99]
v_mfma_f32_16x16x32_bf16 v[128:131], a[216:219], a[172:175], v[128:131]
ds_read_b64_tr_b16 a[216:217], v198 offset:16384
ds_read_b64_tr_b16 a[218:219], v198 offset:20480
v_mfma_f32_16x16x32_bf16 v[100:103], a[220:223], a[168:171], v[100:103]
v_mfma_f32_16x16x32_bf16 v[132:135], a[220:223], a[172:175], v[132:135]
s_waitcnt lgkmcnt(6)
ds_read_b64_tr_b16 a[220:221], v199 offset:16384
ds_read_b64_tr_b16 a[222:223], v199 offset:20480
v_mfma_f32_16x16x32_bf16 v[72:75], a[192:195], a[176:179], v[72:75]
v_mfma_f32_16x16x32_bf16 v[104:107], a[192:195], a[180:183], v[104:107]
ds_read_b64_tr_b16 a[192:193], v192 offset:24576
ds_read_b64_tr_b16 a[194:195], v192 offset:28672
v_mfma_f32_16x16x32_bf16 v[76:79], a[196:199], a[176:179], v[76:79]
v_mfma_f32_16x16x32_bf16 v[108:111], a[196:199], a[180:183], v[108:111]
ds_read_b64_tr_b16 a[196:197], v193 offset:24576
ds_read_b64_tr_b16 a[198:199], v193 offset:28672
v_mfma_f32_16x16x32_bf16 v[80:83], a[200:203], a[176:179], v[80:83]
v_mfma_f32_16x16x32_bf16 v[112:115], a[200:203], a[180:183], v[112:115]
ds_read_b64_tr_b16 a[200:201], v194 offset:24576
ds_read_b64_tr_b16 a[202:203], v194 offset:28672
v_mfma_f32_16x16x32_bf16 v[84:87], a[204:207], a[176:179], v[84:87]
v_mfma_f32_16x16x32_bf16 v[116:119], a[204:207], a[180:183], v[116:119]
s_waitcnt lgkmcnt(6)
ds_read_b64_tr_b16 a[204:205], v195 offset:24576
ds_read_b64_tr_b16 a[206:207], v195 offset:28672
v_mfma_f32_16x16x32_bf16 v[88:91], a[208:211], a[176:179], v[88:91]
v_mfma_f32_16x16x32_bf16 v[120:123], a[208:211], a[180:183], v[120:123]
ds_read_b64_tr_b16 a[208:209], v196 offset:24576
ds_read_b64_tr_b16 a[210:211], v196 offset:28672
v_mfma_f32_16x16x32_bf16 v[92:95], a[212:215], a[176:179], v[92:95]
v_mfma_f32_16x16x32_bf16 v[124:127], a[212:215], a[180:183], v[124:127]
ds_read_b64_tr_b16 a[212:213], v197 offset:24576
ds_read_b64_tr_b16 a[214:215], v197 offset:28672
v_mfma_f32_16x16x32_bf16 v[96:99], a[216:219], a[176:179], v[96:99]
v_mfma_f32_16x16x32_bf16 v[128:131], a[216:219], a[180:183], v[128:131]
ds_read_b64_tr_b16 a[216:217], v198 offset:24576
ds_read_b64_tr_b16 a[218:219], v198 offset:28672
v_mfma_f32_16x16x32_bf16 v[100:103], a[220:223], a[176:179], v[100:103]
v_mfma_f32_16x16x32_bf16 v[132:135], a[220:223], a[180:183], v[132:135]
s_waitcnt lgkmcnt(6)
ds_read_b64_tr_b16 a[220:221], v199 offset:24576
ds_read_b64_tr_b16 a[222:223], v199 offset:28672
v_mfma_f32_16x16x32_bf16 v[72:75], a[192:195], a[184:187], v[72:75]
v_mfma_f32_16x16x32_bf16 v[104:107], a[192:195], a[188:191], v[104:107]
v_mfma_f32_16x16x32_bf16 v[76:79], a[196:199], a[184:187], v[76:79]
v_mfma_f32_16x16x32_bf16 v[108:111], a[196:199], a[188:191], v[108:111]
v_mfma_f32_16x16x32_bf16 v[80:83], a[200:203], a[184:187], v[80:83]
v_mfma_f32_16x16x32_bf16 v[112:115], a[200:203], a[188:191], v[112:115]
v_mfma_f32_16x16x32_bf16 v[84:87], a[204:207], a[184:187], v[84:87]
v_mfma_f32_16x16x32_bf16 v[116:119], a[204:207], a[188:191], v[116:119]
s_waitcnt lgkmcnt(6)
v_mfma_f32_16x16x32_bf16 v[88:91], a[208:211], a[184:187], v[88:91]
v_mfma_f32_16x16x32_bf16 v[120:123], a[208:211], a[188:191], v[120:123]
s_waitcnt lgkmcnt(4)
v_mfma_f32_16x16x32_bf16 v[92:95], a[212:215], a[184:187], v[92:95]
v_mfma_f32_16x16x32_bf16 v[124:127], a[212:215], a[188:191], v[124:127]
s_waitcnt lgkmcnt(2)
v_mfma_f32_16x16x32_bf16 v[96:99], a[216:219], a[184:187], v[96:99]
v_mfma_f32_16x16x32_bf16 v[128:131], a[216:219], a[188:191], v[128:131]
s_waitcnt lgkmcnt(0)
v_mfma_f32_16x16x32_bf16 v[100:103], a[220:223], a[184:187], v[100:103]
v_mfma_f32_16x16x32_bf16 v[132:135], a[220:223], a[188:191], v[132:135]
s_lshl_b32 s46, s34, 2
s_add_u32 s46, s46, s36
s_lshl_b32 s48, s46, 2
s_add_u32 s48, s48, s32
s_lshl_b32 s48, s48, 7
s_add_u32 s54, s48, 0x258000
s_lshl_b32 s46, s46, 6
s_add_u32 s46, s46, s32
s_lshl_b32 s53, s46, 11
s_add_u32 s53, s53, 0x1400000
s_lshl_b32 s47, s35, 13
s_add_u32 s47, s47, s53
s_xor_b32 s46, s35, 2
s_lshl_b32 s46, s46, 15
s_add_u32 s46, s46, s47
v_cvt_pk_bf16_f32 v8, v104, v105
v_cvt_pk_bf16_f32 v9, v106, v107
v_cvt_pk_bf16_f32 v10, v108, v109
v_cvt_pk_bf16_f32 v11, v110, v111
buffer_store_dwordx4 v[8:11], v234, s[20:23], s46 offen offset:0 sc0 sc1
v_cvt_pk_bf16_f32 v12, v112, v113
v_cvt_pk_bf16_f32 v13, v114, v115
v_cvt_pk_bf16_f32 v14, v116, v117
v_cvt_pk_bf16_f32 v15, v118, v119
buffer_store_dwordx4 v[12:15], v234, s[20:23], s46 offen offset:1024 sc0 sc1
s_xor_b32 s46, s35, 1
s_lshl_b32 s46, s46, 15
s_add_u32 s46, s46, s47
v_cvt_pk_bf16_f32 v16, v88, v89
v_cvt_pk_bf16_f32 v17, v90, v91
v_cvt_pk_bf16_f32 v18, v92, v93
v_cvt_pk_bf16_f32 v19, v94, v95
buffer_store_dwordx4 v[16:19], v234, s[20:23], s46 offen offset:0 sc0 sc1
v_cvt_pk_bf16_f32 v20, v96, v97
v_cvt_pk_bf16_f32 v21, v98, v99
v_cvt_pk_bf16_f32 v22, v100, v101
v_cvt_pk_bf16_f32 v23, v102, v103
buffer_store_dwordx4 v[20:23], v234, s[20:23], s46 offen offset:1024 sc0 sc1
s_xor_b32 s46, s35, 3
s_lshl_b32 s46, s46, 15
s_add_u32 s46, s46, s47
v_cvt_pk_bf16_f32 v24, v120, v121
v_cvt_pk_bf16_f32 v25, v122, v123
v_cvt_pk_bf16_f32 v26, v124, v125
v_cvt_pk_bf16_f32 v27, v126, v127
buffer_store_dwordx4 v[24:27], v234, s[20:23], s46 offen offset:0 sc0 sc1
v_cvt_pk_bf16_f32 v28, v128, v129
v_cvt_pk_bf16_f32 v29, v130, v131
v_cvt_pk_bf16_f32 v30, v132, v133
v_cvt_pk_bf16_f32 v31, v134, v135
buffer_store_dwordx4 v[28:31], v234, s[20:23], s46 offen offset:1024 sc0 sc1
s_waitcnt vmcnt(6)
ds_read_b64 v[208:209], v228
ds_read_b64 v[218:219], v228 offset:2048
ds_read_b64 v[210:211], v229
ds_read_b64 v[220:221], v229 offset:2048
ds_read_b64 v[212:213], v230
ds_read_b64 v[222:223], v230 offset:2048
ds_read_b64 v[214:215], v231
ds_read_b64 v[224:225], v231 offset:2048
v_mov_b32 v6, 1
s_lshl_b32 s95, s35, 2
s_add_u32 s95, s95, s54
s_cmp_lg_u32 s92, 0
s_cbranch_scc1 K_YG
s_waitcnt vmcnt(0)
s_mov_b64 exec, 1
buffer_store_dword v6, v234, s[20:23], s95 offen sc0 sc1
s_mov_b64 exec, -1
K_YGD:
s_bitcmp1_b32 s35, 0
s_cbranch_scc1 K_NOEX
v_cmp_ne_u32 vcc, 1, v241
s_cbranch_vccz K_EOK
v_lshlrev_b32 v7, 2, v3
K_ESPIN:
s_sleep 2
s_add_u32 s100, s100, 1
s_bitcmp1_b32 s100, 19
s_cbranch_scc1 K_END
buffer_load_dword v241, v7, s[20:23], s45 offen sc0 sc1
s_waitcnt vmcnt(0)
v_cmp_ne_u32 vcc, 1, v241
s_cbranch_vccnz K_ESPIN
K_EOK:
s_lshl_b32 s46, s36, 13
s_add_u32 s46, s46, s89
s_add_u32 s47, s46, 4096
buffer_load_dwordx2 v[136:137], v243, s[20:23], s46 offen offset:0 sc0 sc1
buffer_load_dwordx2 v[138:139], v243, s[20:23], s46 offen offset:512 sc0 sc1
buffer_load_dwordx2 v[140:141], v243, s[20:23], s46 offen offset:1024 sc0 sc1
buffer_load_dwordx2 v[142:143], v243, s[20:23], s46 offen offset:1536 sc0 sc1
buffer_load_dwordx2 v[144:145], v243, s[20:23], s46 offen offset:2048 sc0 sc1
buffer_load_dwordx2 v[146:147], v243, s[20:23], s46 offen offset:2560 sc0 sc1
buffer_load_dwordx2 v[148:149], v243, s[20:23], s46 offen offset:3072 sc0 sc1
buffer_load_dwordx2 v[150:151], v243, s[20:23], s46 offen offset:3584 sc0 sc1
buffer_load_dwordx2 v[152:153], v243, s[20:23], s47 offen offset:0 sc0 sc1
buffer_load_dwordx2 v[154:155], v243, s[20:23], s47 offen offset:512 sc0 sc1
buffer_load_dwordx2 v[156:157], v243, s[20:23], s47 offen offset:1024 sc0 sc1
buffer_load_dwordx2 v[158:159], v243, s[20:23], s47 offen offset:1536 sc0 sc1
buffer_load_dwordx2 v[160:161], v243, s[20:23], s47 offen offset:2048 sc0 sc1
buffer_load_dwordx2 v[162:163], v243, s[20:23], s47 offen offset:2560 sc0 sc1
buffer_load_dwordx2 v[164:165], v243, s[20:23], s47 offen offset:3072 sc0 sc1
buffer_load_dwordx2 v[166:167], v243, s[20:23], s47 offen offset:3584 sc0 sc1
K_NOEX:
s_mov_b32 s43, 0xbfb8aa3b
s_mov_b32 s42, 0xffff0000
s_waitcnt lgkmcnt(0)
v_lshlrev_b32 v180, 16, v218
v_and_b32 v181, s42, v218
v_lshlrev_b32 v182, 16, v219
v_and_b32 v183, s42, v219
v_pk_add_f32 v[180:181], v[180:181], v[40:41]
v_pk_add_f32 v[182:183], v[182:183], v[42:43]
v_cvt_pk_bf16_f32 v200, v180, v181
v_cvt_pk_bf16_f32 v201, v182, v183
v_lshlrev_b32 v180, 16, v200
v_and_b32 v181, s42, v200
v_lshlrev_b32 v182, 16, v201
v_and_b32 v183, s42, v201
v_mul_f32 v202, s43, v180
v_mul_f32 v203, s43, v181
v_mul_f32 v204, s43, v182
v_mul_f32 v205, s43, v183
v_exp_f32 v202, v202
v_exp_f32 v203, v203
v_exp_f32 v204, v204
v_exp_f32 v205, v205
s_nop 0
v_add_f32 v202, 1.0, v202
v_add_f32 v203, 1.0, v203
v_add_f32 v204, 1.0, v204
v_add_f32 v205, 1.0, v205
v_rcp_f32 v202, v202
v_rcp_f32 v203, v203
v_rcp_f32 v204, v204
v_rcp_f32 v205, v205
s_nop 0
v_pk_mul_f32 v[180:181], v[180:181], v[202:203]
v_pk_mul_f32 v[182:183], v[182:183], v[204:205]
v_cvt_pk_bf16_f32 v200, v180, v181
v_cvt_pk_bf16_f32 v201, v182, v183
v_lshlrev_b32 v180, 16, v200
v_and_b32 v181, s42, v200
v_lshlrev_b32 v182, 16, v201
v_and_b32 v183, s42, v201
v_lshlrev_b32 v184, 16, v220
v_and_b32 v185, s42, v220
v_lshlrev_b32 v186, 16, v221
v_and_b32 v187, s42, v221
v_pk_add_f32 v[184:185], v[184:185], v[44:45]
v_pk_add_f32 v[186:187], v[186:187], v[46:47]
v_cvt_pk_bf16_f32 v200, v184, v185
v_cvt_pk_bf16_f32 v201, v186, v187
v_lshlrev_b32 v184, 16, v200
v_and_b32 v185, s42, v200
v_lshlrev_b32 v186, 16, v201
v_and_b32 v187, s42, v201
v_mul_f32 v202, s43, v184
v_mul_f32 v203, s43, v185
v_mul_f32 v204, s43, v186
v_mul_f32 v205, s43, v187
v_exp_f32 v202, v202
v_exp_f32 v203, v203
v_exp_f32 v204, v204
v_exp_f32 v205, v205
s_nop 0
v_add_f32 v202, 1.0, v202
v_add_f32 v203, 1.0, v203
v_add_f32 v204, 1.0, v204
v_add_f32 v205, 1.0, v205
v_rcp_f32 v202, v202
v_rcp_f32 v203, v203
v_rcp_f32 v204, v204
v_rcp_f32 v205, v205
s_nop 0
v_pk_mul_f32 v[184:185], v[184:185], v[202:203]
v_pk_mul_f32 v[186:187], v[186:187], v[204:205]
v_cvt_pk_bf16_f32 v200, v184, v185
v_cvt_pk_bf16_f32 v201, v186, v187
v_lshlrev_b32 v184, 16, v200
v_and_b32 v185, s42, v200
v_lshlrev_b32 v186, 16, v201
v_and_b32 v187, s42, v201
v_lshlrev_b32 v188, 16, v222
v_and_b32 v189, s42, v222
v_lshlrev_b32 v190, 16, v223
v_and_b32 v191, s42, v223
v_pk_add_f32 v[188:189], v[188:189], v[48:49]
v_pk_add_f32 v[190:191], v[190:191], v[50:51]
v_cvt_pk_bf16_f32 v200, v188, v189
v_cvt_pk_bf16_f32 v201, v190, v191
v_lshlrev_b32 v188, 16, v200
v_and_b32 v189, s42, v200
v_lshlrev_b32 v190, 16, v201
v_and_b32 v191, s42, v201
v_mul_f32 v202, s43, v188
v_mul_f32 v203, s43, v189
v_mul_f32 v204, s43, v190
v_mul_f32 v205, s43, v191
v_exp_f32 v202, v202
v_exp_f32 v203, v203
v_exp_f32 v204, v204
v_exp_f32 v205, v205
s_nop 0
v_add_f32 v202, 1.0, v202
v_add_f32 v203, 1.0, v203
v_add_f32 v204, 1.0, v204
v_add_f32 v205, 1.0, v205
v_rcp_f32 v202, v202
v_rcp_f32 v203, v203
v_rcp_f32 v204, v204
v_rcp_f32 v205, v205
s_nop 0
v_pk_mul_f32 v[188:189], v[188:189], v[202:203]
v_pk_mul_f32 v[190:191], v[190:191], v[204:205]
v_cvt_pk_bf16_f32 v200, v188, v189
v_cvt_pk_bf16_f32 v201, v190, v191
v_lshlrev_b32 v188, 16, v200
v_and_b32 v189, s42, v200
v_lshlrev_b32 v190, 16, v201
v_and_b32 v191, s42, v201
v_lshlrev_b32 v192, 16, v224
v_and_b32 v193, s42, v224
v_lshlrev_b32 v194, 16, v225
v_and_b32 v195, s42, v225
v_pk_add_f32 v[192:193], v[192:193], v[52:53]
v_pk_add_f32 v[194:195], v[194:195], v[54:55]
v_cvt_pk_bf16_f32 v200, v192, v193
v_cvt_pk_bf16_f32 v201, v194, v195
v_lshlrev_b32 v192, 16, v200
v_and_b32 v193, s42, v200
v_lshlrev_b32 v194, 16, v201
v_and_b32 v195, s42, v201
v_mul_f32 v202, s43, v192
v_mul_f32 v203, s43, v193
v_mul_f32 v204, s43, v194
v_mul_f32 v205, s43, v195
v_exp_f32 v202, v202
v_exp_f32 v203, v203
v_exp_f32 v204, v204
v_exp_f32 v205, v205
s_nop 0
v_add_f32 v202, 1.0, v202
v_add_f32 v203, 1.0, v203
v_add_f32 v204, 1.0, v204
v_add_f32 v205, 1.0, v205
v_rcp_f32 v202, v202
v_rcp_f32 v203, v203
v_rcp_f32 v204, v204
v_rcp_f32 v205, v205
s_nop 0
v_pk_mul_f32 v[192:193], v[192:193], v[202:203]
v_pk_mul_f32 v[194:195], v[194:195], v[204:205]
v_cvt_pk_bf16_f32 v200, v192, v193
v_cvt_pk_bf16_f32 v201, v194, v195
v_lshlrev_b32 v192, 16, v200
v_and_b32 v193, s42, v200
v_lshlrev_b32 v194, 16, v201
v_and_b32 v195, s42, v201
v_lshlrev_b32 v196, 16, v226
v_and_b32 v197, s42, v226
v_lshlrev_b32 v198, 16, v227
v_and_b32 v199, s42, v227
v_pk_add_f32 v[196:197], v[196:197], v[56:57]
v_pk_add_f32 v[198:199], v[198:199], v[58:59]
v_cvt_pk_bf16_f32 v200, v196, v197
v_cvt_pk_bf16_f32 v201, v198, v199
v_lshlrev_b32 v196, 16, v200
v_and_b32 v197, s42, v200
v_lshlrev_b32 v198, 16, v201
v_and_b32 v199, s42, v201
v_mul_f32 v202, s43, v196
v_mul_f32 v203, s43, v197
v_mul_f32 v204, s43, v198
v_mul_f32 v205, s43, v199
v_exp_f32 v202, v202
v_exp_f32 v203, v203
v_exp_f32 v204, v204
v_exp_f32 v205, v205
s_nop 0
v_add_f32 v202, 1.0, v202
v_add_f32 v203, 1.0, v203
v_add_f32 v204, 1.0, v204
v_add_f32 v205, 1.0, v205
v_rcp_f32 v202, v202
v_rcp_f32 v203, v203
v_rcp_f32 v204, v204
v_rcp_f32 v205, v205
s_nop 0
v_pk_mul_f32 v[196:197], v[196:197], v[202:203]
v_pk_mul_f32 v[198:199], v[198:199], v[204:205]
v_cvt_pk_bf16_f32 v200, v196, v197
v_cvt_pk_bf16_f32 v201, v198, v199
v_lshlrev_b32 v196, 16, v200
v_and_b32 v197, s42, v200
v_lshlrev_b32 v198, 16, v201
v_and_b32 v199, s42, v201
v_lshlrev_b32 v40, 16, v208
v_and_b32 v41, s42, v208
v_lshlrev_b32 v42, 16, v209
v_and_b32 v43, s42, v209
v_lshlrev_b32 v44, 16, v210
v_and_b32 v45, s42, v210
v_lshlrev_b32 v46, 16, v211
v_and_b32 v47, s42, v211
v_lshlrev_b32 v48, 16, v212
v_and_b32 v49, s42, v212
v_lshlrev_b32 v50, 16, v213
v_and_b32 v51, s42, v213
v_lshlrev_b32 v52, 16, v214
v_and_b32 v53, s42, v214
v_lshlrev_b32 v54, 16, v215
v_and_b32 v55, s42, v215
v_lshlrev_b32 v56, 16, v216
v_and_b32 v57, s42, v216
v_lshlrev_b32 v58, 16, v217
v_and_b32 v59, s42, v217
v_and_b32 v5, 3, v1
v_lshlrev_b32 v5, 2, v5
buffer_load_dword v6, v5, s[20:23], s54 offen sc0 sc1
s_bitcmp1_b32 s35, 0
s_cbranch_scc1 K_NOEX2
s_waitcnt vmcnt(1)
v_lshlrev_b32 v168, 16, v136
v_and_b32 v169, s42, v136
v_lshlrev_b32 v170, 16, v137
v_and_b32 v171, s42, v137
v_lshlrev_b32 v202, 16, v138
v_and_b32 v203, s42, v138
v_lshlrev_b32 v204, 16, v139
v_and_b32 v205, s42, v139
v_pk_add_f32 v[168:169], v[168:169], v[202:203]
v_pk_add_f32 v[170:171], v[170:171], v[204:205]
v_lshlrev_b32 v202, 16, v140
v_and_b32 v203, s42, v140
v_lshlrev_b32 v204, 16, v141
v_and_b32 v205, s42, v141
v_pk_add_f32 v[168:169], v[168:169], v[202:203]
v_pk_add_f32 v[170:171], v[170:171], v[204:205]
v_lshlrev_b32 v202, 16, v142
v_and_b32 v203, s42, v142
v_lshlrev_b32 v204, 16, v143
v_and_b32 v205, s42, v143
v_pk_add_f32 v[168:169], v[168:169], v[202:203]
v_pk_add_f32 v[170:171], v[170:171], v[204:205]
v_lshlrev_b32 v202, 16, v144
v_and_b32 v203, s42, v144
v_lshlrev_b32 v204, 16, v145
v_and_b32 v205, s42, v145
v_pk_add_f32 v[168:169], v[168:169], v[202:203]
v_pk_add_f32 v[170:171], v[170:171], v[204:205]
v_lshlrev_b32 v202, 16, v146
v_and_b32 v203, s42, v146
v_lshlrev_b32 v204, 16, v147
v_and_b32 v205, s42, v147
v_pk_add_f32 v[168:169], v[168:169], v[202:203]
v_pk_add_f32 v[170:171], v[170:171], v[204:205]
v_lshlrev_b32 v202, 16, v148
v_and_b32 v203, s42, v148
v_lshlrev_b32 v204, 16, v149
v_and_b32 v205, s42, v149
v_pk_add_f32 v[168:169], v[168:169], v[202:203]
v_pk_add_f32 v[170:171], v[170:171], v[204:205]
v_lshlrev_b32 v202, 16, v150
v_and_b32 v203, s42, v150
v_lshlrev_b32 v204, 16, v151
v_and_b32 v205, s42, v151
v_pk_add_f32 v[168:169], v[168:169], v[202:203]
v_pk_add_f32 v[170:171], v[170:171], v[204:205]
v_lshlrev_b32 v202, 16, v152
v_and_b32 v203, s42, v152
v_lshlrev_b32 v204, 16, v153
v_and_b32 v205, s42, v153
v_pk_add_f32 v[168:169], v[168:169], v[202:203]
v_pk_add_f32 v[170:171], v[170:171], v[204:205]
v_lshlrev_b32 v202, 16, v154
v_and_b32 v203, s42, v154
v_lshlrev_b32 v204, 16, v155
v_and_b32 v205, s42, v155
v_pk_add_f32 v[168:169], v[168:169], v[202:203]
v_pk_add_f32 v[170:171], v[170:171], v[204:205]
v_lshlrev_b32 v202, 16, v156
v_and_b32 v203, s42, v156
v_lshlrev_b32 v204, 16, v157
v_and_b32 v205, s42, v157
v_pk_add_f32 v[168:169], v[168:169], v[202:203]
v_pk_add_f32 v[170:171], v[170:171], v[204:205]
v_lshlrev_b32 v202, 16, v158
v_and_b32 v203, s42, v158
v_lshlrev_b32 v204, 16, v159
v_and_b32 v205, s42, v159
v_pk_add_f32 v[168:169], v[168:169], v[202:203]
v_pk_add_f32 v[170:171], v[170:171], v[204:205]
v_lshlrev_b32 v202, 16, v160
v_and_b32 v203, s42, v160
v_lshlrev_b32 v204, 16, v161
v_and_b32 v205, s42, v161
v_pk_add_f32 v[168:169], v[168:169], v[202:203]
v_pk_add_f32 v[170:171], v[170:171], v[204:205]
v_lshlrev_b32 v202, 16, v162
v_and_b32 v203, s42, v162
v_lshlrev_b32 v204, 16, v163
v_and_b32 v205, s42, v163
v_pk_add_f32 v[168:169], v[168:169], v[202:203]
v_pk_add_f32 v[170:171], v[170:171], v[204:205]
v_lshlrev_b32 v202, 16, v164
v_and_b32 v203, s42, v164
v_lshlrev_b32 v204, 16, v165
v_and_b32 v205, s42, v165
v_pk_add_f32 v[168:169], v[168:169], v[202:203]
v_pk_add_f32 v[170:171], v[170:171], v[204:205]
v_lshlrev_b32 v202, 16, v166
v_and_b32 v203, s42, v166
v_lshlrev_b32 v204, 16, v167
v_and_b32 v205, s42, v167
v_pk_add_f32 v[168:169], v[168:169], v[202:203]
v_pk_add_f32 v[170:171], v[170:171], v[204:205]
v_cvt_pk_bf16_f32 v200, v168, v169
v_cvt_pk_bf16_f32 v201, v170, v171
v_lshlrev_b32 v168, 16, v200
v_and_b32 v169, s42, v200
v_lshlrev_b32 v170, 16, v201
v_and_b32 v171, s42, v201
v_pk_mul_f32 v[168:169], v[168:169], v[196:197]
v_pk_mul_f32 v[170:171], v[170:171], v[198:199]
v_cvt_pk_bf16_f32 v200, v168, v169
v_cvt_pk_bf16_f32 v201, v170, v171
v_lshlrev_b32 v168, 16, v200
v_and_b32 v169, s42, v200
v_lshlrev_b32 v170, 16, v201
v_and_b32 v171, s42, v201
v_pk_add_f32 v[168:169], v[168:169], v[56:57]
v_pk_add_f32 v[170:171], v[170:171], v[58:59]
v_cvt_pk_bf16_f32 v168, v168, v169
v_cvt_pk_bf16_f32 v169, v170, v171
s_waitcnt vmcnt(0)
buffer_store_dwordx2 v[168:169], v242, s[68:71], s88 offen
s_branch K_XCHK
K_XPOLL:
s_sleep 1
s_add_u32 s100, s100, 1
s_bitcmp1_b32 s100, 19
s_cbranch_scc1 K_END
buffer_load_dword v6, v5, s[20:23], s54 offen sc0 sc1
K_NOEX2:
s_waitcnt vmcnt(0)
K_XCHK:
v_cmp_ne_u32 vcc, 1, v6
s_cbranch_vccnz K_XPOLL
s_lshl_b32 s47, s35, 15
s_add_u32 s47, s47, s53
s_xor_b32 s46, s35, 1
s_lshl_b32 s46, s46, 13
s_add_u32 s46, s46, s47
buffer_load_dwordx4 v[8:11], v234, s[20:23], s46 offen offset:0 sc0 sc1
s_xor_b32 s46, s35, 2
s_lshl_b32 s46, s46, 13
s_add_u32 s46, s46, s47
buffer_load_dwordx4 v[16:19], v234, s[20:23], s46 offen offset:0 sc0 sc1
s_xor_b32 s46, s35, 3
s_lshl_b32 s46, s46, 13
s_add_u32 s46, s46, s47
buffer_load_dwordx4 v[24:27], v234, s[20:23], s46 offen offset:0 sc0 sc1
s_xor_b32 s46, s35, 1
s_lshl_b32 s46, s46, 13
s_add_u32 s46, s46, s47
buffer_load_dwordx4 v[12:15], v234, s[20:23], s46 offen offset:1024 sc0 sc1
s_xor_b32 s46, s35, 2
s_lshl_b32 s46, s46, 13
s_add_u32 s46, s46, s47
buffer_load_dwordx4 v[20:23], v234, s[20:23], s46 offen offset:1024 sc0 sc1
s_xor_b32 s46, s35, 3
s_lshl_b32 s46, s46, 13
s_add_u32 s46, s46, s47
buffer_load_dwordx4 v[28:31], v234, s[20:23], s46 offen offset:1024 sc0 sc1
v_add_u32 v5, s86, v234
s_waitcnt vmcnt(3)
v_lshlrev_b32 v202, 16, v8
v_and_b32 v203, s42, v8
v_lshlrev_b32 v204, 16, v9
v_and_b32 v205, s42, v9
v_pk_add_f32 v[72:73], v[72:73], v[202:203]
v_pk_add_f32 v[74:75], v[74:75], v[204:205]
v_lshlrev_b32 v202, 16, v16
v_and_b32 v203, s42, v16
v_lshlrev_b32 v204, 16, v17
v_and_b32 v205, s42, v17
v_pk_add_f32 v[72:73], v[72:73], v[202:203]
v_pk_add_f32 v[74:75], v[74:75], v[204:205]
v_lshlrev_b32 v202, 16, v24
v_and_b32 v203, s42, v24
v_lshlrev_b32 v204, 16, v25
v_and_b32 v205, s42, v25
v_pk_add_f32 v[72:73], v[72:73], v[202:203]
v_pk_add_f32 v[74:75], v[74:75], v[204:205]
v_cvt_pk_bf16_f32 v200, v72, v73
v_cvt_pk_bf16_f32 v201, v74, v75
v_lshlrev_b32 v72, 16, v200
v_and_b32 v73, s42, v200
v_lshlrev_b32 v74, 16, v201
v_and_b32 v75, s42, v201
v_pk_mul_f32 v[72:73], v[72:73], v[180:181]
v_pk_mul_f32 v[74:75], v[74:75], v[182:183]
v_cvt_pk_bf16_f32 v200, v72, v73
v_cvt_pk_bf16_f32 v201, v74, v75
v_lshlrev_b32 v72, 16, v200
v_and_b32 v73, s42, v200
v_lshlrev_b32 v74, 16, v201
v_and_b32 v75, s42, v201
v_pk_add_f32 v[72:73], v[72:73], v[40:41]
v_pk_add_f32 v[74:75], v[74:75], v[42:43]
v_cvt_pk_bf16_f32 v72, v72, v73
v_cvt_pk_bf16_f32 v73, v74, v75
ds_write_b64 v228, v[72:73]
v_lshlrev_b32 v202, 16, v10
v_and_b32 v203, s42, v10
v_lshlrev_b32 v204, 16, v11
v_and_b32 v205, s42, v11
v_pk_add_f32 v[76:77], v[76:77], v[202:203]
v_pk_add_f32 v[78:79], v[78:79], v[204:205]
v_lshlrev_b32 v202, 16, v18
v_and_b32 v203, s42, v18
v_lshlrev_b32 v204, 16, v19
v_and_b32 v205, s42, v19
v_pk_add_f32 v[76:77], v[76:77], v[202:203]
v_pk_add_f32 v[78:79], v[78:79], v[204:205]
v_lshlrev_b32 v202, 16, v26
v_and_b32 v203, s42, v26
v_lshlrev_b32 v204, 16, v27
v_and_b32 v205, s42, v27
v_pk_add_f32 v[76:77], v[76:77], v[202:203]
v_pk_add_f32 v[78:79], v[78:79], v[204:205]
v_cvt_pk_bf16_f32 v200, v76, v77
v_cvt_pk_bf16_f32 v201, v78, v79
v_lshlrev_b32 v76, 16, v200
v_and_b32 v77, s42, v200
v_lshlrev_b32 v78, 16, v201
v_and_b32 v79, s42, v201
v_pk_mul_f32 v[76:77], v[76:77], v[184:185]
v_pk_mul_f32 v[78:79], v[78:79], v[186:187]
v_cvt_pk_bf16_f32 v200, v76, v77
v_cvt_pk_bf16_f32 v201, v78, v79
v_lshlrev_b32 v76, 16, v200
v_and_b32 v77, s42, v200
v_lshlrev_b32 v78, 16, v201
v_and_b32 v79, s42, v201
v_pk_add_f32 v[76:77], v[76:77], v[44:45]
v_pk_add_f32 v[78:79], v[78:79], v[46:47]
v_cvt_pk_bf16_f32 v76, v76, v77
v_cvt_pk_bf16_f32 v77, v78, v79
ds_write_b64 v229, v[76:77]
s_waitcnt vmcnt(0)
v_lshlrev_b32 v202, 16, v12
v_and_b32 v203, s42, v12
v_lshlrev_b32 v204, 16, v13
v_and_b32 v205, s42, v13
v_pk_add_f32 v[80:81], v[80:81], v[202:203]
v_pk_add_f32 v[82:83], v[82:83], v[204:205]
v_lshlrev_b32 v202, 16, v20
v_and_b32 v203, s42, v20
v_lshlrev_b32 v204, 16, v21
v_and_b32 v205, s42, v21
v_pk_add_f32 v[80:81], v[80:81], v[202:203]
v_pk_add_f32 v[82:83], v[82:83], v[204:205]
v_lshlrev_b32 v202, 16, v28
v_and_b32 v203, s42, v28
v_lshlrev_b32 v204, 16, v29
v_and_b32 v205, s42, v29
v_pk_add_f32 v[80:81], v[80:81], v[202:203]
v_pk_add_f32 v[82:83], v[82:83], v[204:205]
v_cvt_pk_bf16_f32 v200, v80, v81
v_cvt_pk_bf16_f32 v201, v82, v83
v_lshlrev_b32 v80, 16, v200
v_and_b32 v81, s42, v200
v_lshlrev_b32 v82, 16, v201
v_and_b32 v83, s42, v201
v_pk_mul_f32 v[80:81], v[80:81], v[188:189]
v_pk_mul_f32 v[82:83], v[82:83], v[190:191]
v_cvt_pk_bf16_f32 v200, v80, v81
v_cvt_pk_bf16_f32 v201, v82, v83
v_lshlrev_b32 v80, 16, v200
v_and_b32 v81, s42, v200
v_lshlrev_b32 v82, 16, v201
v_and_b32 v83, s42, v201
v_pk_add_f32 v[80:81], v[80:81], v[48:49]
v_pk_add_f32 v[82:83], v[82:83], v[50:51]
v_cvt_pk_bf16_f32 v80, v80, v81
v_cvt_pk_bf16_f32 v81, v82, v83
ds_write_b64 v230, v[80:81]
v_lshlrev_b32 v202, 16, v14
v_and_b32 v203, s42, v14
v_lshlrev_b32 v204, 16, v15
v_and_b32 v205, s42, v15
v_pk_add_f32 v[84:85], v[84:85], v[202:203]
v_pk_add_f32 v[86:87], v[86:87], v[204:205]
v_lshlrev_b32 v202, 16, v22
v_and_b32 v203, s42, v22
v_lshlrev_b32 v204, 16, v23
v_and_b32 v205, s42, v23
v_pk_add_f32 v[84:85], v[84:85], v[202:203]
v_pk_add_f32 v[86:87], v[86:87], v[204:205]
v_lshlrev_b32 v202, 16, v30
v_and_b32 v203, s42, v30
v_lshlrev_b32 v204, 16, v31
v_and_b32 v205, s42, v31
v_pk_add_f32 v[84:85], v[84:85], v[202:203]
v_pk_add_f32 v[86:87], v[86:87], v[204:205]
v_cvt_pk_bf16_f32 v200, v84, v85
v_cvt_pk_bf16_f32 v201, v86, v87
v_lshlrev_b32 v84, 16, v200
v_and_b32 v85, s42, v200
v_lshlrev_b32 v86, 16, v201
v_and_b32 v87, s42, v201
v_pk_mul_f32 v[84:85], v[84:85], v[192:193]
v_pk_mul_f32 v[86:87], v[86:87], v[194:195]
v_cvt_pk_bf16_f32 v200, v84, v85
v_cvt_pk_bf16_f32 v201, v86, v87
v_lshlrev_b32 v84, 16, v200
v_and_b32 v85, s42, v200
v_lshlrev_b32 v86, 16, v201
v_and_b32 v87, s42, v201
v_pk_add_f32 v[84:85], v[84:85], v[52:53]
v_pk_add_f32 v[86:87], v[86:87], v[54:55]
v_cvt_pk_bf16_f32 v84, v84, v85
v_cvt_pk_bf16_f32 v85, v86, v87
ds_write_b64 v231, v[84:85]
ds_read_b128 v[8:11], v5
ds_read_b128 v[12:15], v5 offset:1024
s_waitcnt lgkmcnt(1)
buffer_store_dwordx4 v[8:11], v232, s[68:71], s87 offen
s_waitcnt lgkmcnt(0)
buffer_store_dwordx4 v[12:15], v233, s[68:71], s87 offen
K_END:
s_endpgm
K_YG:
s_mov_b32 s94, 0
v_cmp_gt_u32 vcc, 144, v244
s_cbranch_vccz K_YOK
s_waitcnt vmcnt(0)
s_mov_b64 exec, 1
buffer_store_dword v6, v234, s[20:23], s95 offen sc0 sc1
s_mov_b64 exec, -1
s_mov_b32 s94, 1
v_mov_b32 v5, 0
K_YPOLL:
s_sleep 2
s_add_u32 s100, s100, 1
s_bitcmp1_b32 s100, 19
s_cbranch_scc1 K_END
buffer_load_dword v244, v5, s[28:31], 0 offen offset:4 sc0 sc1
s_waitcnt vmcnt(0)
v_cmp_gt_u32 vcc, 144, v244
s_cbranch_vccnz K_YPOLL
K_YOK:
s_lshl_b32 s46, s36, 9
s_lshl_b32 s47, s93, 1
s_add_u32 s46, s46, s47
v_mul_u32_u24 v60, 18432, v4
v_lshl_add_u32 v60, v3, 4, v60
v_add_u32 v60, s46, v60
s_lshl_b32 s46, s36, 6
s_add_u32 s46, s46, 2048
v_lshrrev_b32 v61, 2, v1
v_mul_u32_u24 v61, 18432, v61
v_and_b32 v5, 3, v1
v_lshl_add_u32 v61, v5, 4, v61
v_add_u32 v61, s46, v61
s_lshl_b32 s46, s3, 1
s_add_u32 s46, s46, s73
v_add_u32 v62, s46, v234
v_lshl_add_u32 v63, v4, 4, s46
K_YTOK:
s_ff1_i32_b32 s48, s92
s_bitset0_b32 s92, s48
s_mul_i32 s46, s48, 2304
s_add_u32 s46, s46, 0x2400000
s_mov_b32 s47, s46
buffer_load_dwordx4 a[0:3], v61, s[20:23], s47 offen sc0 sc1
s_add_u32 s47, s47, 294912
buffer_load_dwordx4 a[4:7], v61, s[20:23], s47 offen sc0 sc1
s_add_u32 s47, s47, 294912
buffer_load_dwordx4 a[8:11], v61, s[20:23], s47 offen sc0 sc1
s_add_u32 s47, s47, 294912
buffer_load_dwordx4 a[12:15], v61, s[20:23], s47 offen sc0 sc1
s_add_u32 s47, s47, 294912
buffer_load_dwordx4 a[16:19], v61, s[20:23], s47 offen sc0 sc1
s_add_u32 s47, s47, 294912
buffer_load_dwordx4 a[20:23], v61, s[20:23], s47 offen sc0 sc1
s_add_u32 s47, s47, 294912
buffer_load_dwordx4 a[24:27], v61, s[20:23], s47 offen sc0 sc1
s_add_u32 s47, s47, 294912
buffer_load_dwordx4 a[28:31], v61, s[20:23], s47 offen sc0 sc1
s_add_u32 s47, s47, 294912
buffer_load_dwordx4 a[32:35], v61, s[20:23], s47 offen sc0 sc1
s_add_u32 s47, s47, 294912
buffer_load_dwordx4 v[8:11], v60, s[20:23], s46 offen sc0 sc1
s_add_u32 s46, s46, 73728
buffer_load_dwordx4 v[12:15], v60, s[20:23], s46 offen sc0 sc1
s_add_u32 s46, s46, 73728
buffer_load_dwordx4 v[16:19], v60, s[20:23], s46 offen sc0 sc1
s_add_u32 s46, s46, 73728
buffer_load_dwordx4 v[20:23], v60, s[20:23], s46 offen sc0 sc1
s_add_u32 s46, s46, 73728
buffer_load_dwordx4 v[24:27], v60, s[20:23], s46 offen sc0 sc1
s_add_u32 s46, s46, 73728
buffer_load_dwordx4 v[28:31], v60, s[20:23], s46 offen sc0 sc1
s_add_u32 s46, s46, 73728
buffer_load_dwordx4 v[32:35], v60, s[20:23], s46 offen sc0 sc1
s_add_u32 s46, s46, 73728
buffer_load_dwordx4 v[36:39], v60, s[20:23], s46 offen sc0 sc1
s_add_u32 s46, s46, 73728
buffer_load_dwordx4 v[88:91], v60, s[20:23], s46 offen sc0 sc1
s_add_u32 s46, s46, 73728
buffer_load_dwordx4 v[92:95], v60, s[20:23], s46 offen sc0 sc1
s_add_u32 s46, s46, 73728
buffer_load_dwordx4 v[96:99], v60, s[20:23], s46 offen sc0 sc1
s_add_u32 s46, s46, 73728
buffer_load_dwordx4 v[100:103], v60, s[20:23], s46 offen sc0 sc1
s_add_u32 s46, s46, 73728
buffer_load_dwordx4 v[104:107], v60, s[20:23], s46 offen sc0 sc1
s_add_u32 s46, s46, 73728
buffer_load_dwordx4 v[108:111], v60, s[20:23], s46 offen sc0 sc1
s_add_u32 s46, s46, 73728
buffer_load_dwordx4 v[112:115], v60, s[20:23], s46 offen sc0 sc1
s_add_u32 s46, s46, 73728
buffer_load_dwordx4 v[116:119], v60, s[20:23], s46 offen sc0 sc1
s_add_u32 s46, s46, 73728
buffer_load_dwordx4 v[120:123], v60, s[20:23], s46 offen sc0 sc1
s_add_u32 s46, s46, 73728
buffer_load_dwordx4 v[124:127], v60, s[20:23], s46 offen sc0 sc1
s_add_u32 s46, s46, 73728
s_cmp_lg_u32 s94, 0
s_cbranch_scc1 K_YNF
s_waitcnt vmcnt(27)
s_mov_b64 exec, 1
buffer_store_dword v6, v234, s[20:23], s95 offen sc0 sc1
s_mov_b64 exec, -1
s_mov_b32 s94, 1
K_YNF:
buffer_load_dwordx4 v[128:131], v60, s[20:23], s46 offen sc0 sc1
s_add_u32 s46, s46, 73728
buffer_load_dwordx4 v[132:135], v60, s[20:23], s46 offen sc0 sc1
s_add_u32 s46, s46, 73728
buffer_load_dwordx4 v[136:139], v60, s[20:23], s46 offen sc0 sc1
s_add_u32 s46, s46, 73728
buffer_load_dwordx4 v[140:143], v60, s[20:23], s46 offen sc0 sc1
s_add_u32 s46, s46, 73728
buffer_load_dwordx4 v[144:147], v60, s[20:23], s46 offen sc0 sc1
s_add_u32 s46, s46, 73728
buffer_load_dwordx4 v[148:151], v60, s[20:23], s46 offen sc0 sc1
s_add_u32 s46, s46, 73728
buffer_load_dwordx4 v[152:155], v60, s[20:23], s46 offen sc0 sc1
s_add_u32 s46, s46, 73728
buffer_load_dwordx4 v[156:159], v60, s[20:23], s46 offen sc0 sc1
s_add_u32 s46, s46, 73728
buffer_load_dwordx4 v[160:163], v60, s[20:23], s46 offen sc0 sc1
s_add_u32 s46, s46, 73728
buffer_load_dwordx4 v[164:167], v60, s[20:23], s46 offen sc0 sc1
s_add_u32 s46, s46, 73728
buffer_load_dwordx4 v[168:171], v60, s[20:23], s46 offen sc0 sc1
s_add_u32 s46, s46, 73728
buffer_load_dwordx4 v[172:175], v60, s[20:23], s46 offen sc0 sc1
s_add_u32 s46, s46, 73728
buffer_load_dwordx4 v[176:179], v60, s[20:23], s46 offen sc0 sc1
s_add_u32 s46, s46, 73728
buffer_load_dwordx4 v[180:183], v60, s[20:23], s46 offen sc0 sc1
s_add_u32 s46, s46, 73728
buffer_load_dwordx4 v[184:187], v60, s[20:23], s46 offen sc0 sc1
s_add_u32 s46, s46, 73728
buffer_load_dwordx4 v[188:191], v60, s[20:23], s46 offen sc0 sc1
s_add_u32 s46, s46, 73728
buffer_load_dwordx4 v[192:195], v60, s[20:23], s46 offen sc0 sc1
s_add_u32 s46, s46, 73728
buffer_load_dwordx4 v[196:199], v60, s[20:23], s46 offen sc0 sc1
s_add_u32 s46, s46, 73728
v_readlane_b32 s46, v245, s48
v_readlane_b32 s47, v255, s48
s_waitcnt vmcnt(36)
v_accvgpr_read_b32 v64, a0
v_accvgpr_read_b32 v65, a1
v_accvgpr_read_b32 v66, a2
v_accvgpr_read_b32 v67, a3
v_accvgpr_read_b32 v68, a4
v_accvgpr_read_b32 v69, a5
v_accvgpr_read_b32 v70, a6
v_accvgpr_read_b32 v71, a7
v_pk_add_f32 v[64:65], v[64:65], v[68:69]
v_pk_add_f32 v[66:67], v[66:67], v[70:71]
v_accvgpr_read_b32 v68, a8
v_accvgpr_read_b32 v69, a9
v_accvgpr_read_b32 v70, a10
v_accvgpr_read_b32 v71, a11
v_pk_add_f32 v[64:65], v[64:65], v[68:69]
v_pk_add_f32 v[66:67], v[66:67], v[70:71]
v_accvgpr_read_b32 v68, a12
v_accvgpr_read_b32 v69, a13
v_accvgpr_read_b32 v70, a14
v_accvgpr_read_b32 v71, a15
v_pk_add_f32 v[64:65], v[64:65], v[68:69]
v_pk_add_f32 v[66:67], v[66:67], v[70:71]
v_accvgpr_read_b32 v68, a16
v_accvgpr_read_b32 v69, a17
v_accvgpr_read_b32 v70, a18
v_accvgpr_read_b32 v71, a19
v_pk_add_f32 v[64:65], v[64:65], v[68:69]
v_pk_add_f32 v[66:67], v[66:67], v[70:71]
v_accvgpr_read_b32 v68, a20
v_accvgpr_read_b32 v69, a21
v_accvgpr_read_b32 v70, a22
v_accvgpr_read_b32 v71, a23
v_pk_add_f32 v[64:65], v[64:65], v[68:69]
v_pk_add_f32 v[66:67], v[66:67], v[70:71]
v_accvgpr_read_b32 v68, a24
v_accvgpr_read_b32 v69, a25
v_accvgpr_read_b32 v70, a26
v_accvgpr_read_b32 v71, a27
v_pk_add_f32 v[64:65], v[64:65], v[68:69]
v_pk_add_f32 v[66:67], v[66:67], v[70:71]
v_accvgpr_read_b32 v68, a28
v_accvgpr_read_b32 v69, a29
v_accvgpr_read_b32 v70, a30
v_accvgpr_read_b32 v71, a31
v_pk_add_f32 v[64:65], v[64:65], v[68:69]
v_pk_add_f32 v[66:67], v[66:67], v[70:71]
v_accvgpr_read_b32 v68, a32
v_accvgpr_read_b32 v69, a33
v_accvgpr_read_b32 v70, a34
v_accvgpr_read_b32 v71, a35
v_pk_add_f32 v[64:65], v[64:65], v[68:69]
v_pk_add_f32 v[66:67], v[66:67], v[70:71]
s_nop 0
v_add_f32_dpp v64, v64, v64 row_ror:8 row_mask:0xf bank_mask:0xf
v_add_f32_dpp v65, v65, v65 row_ror:8 row_mask:0xf bank_mask:0xf
v_add_f32_dpp v66, v66, v66 row_ror:8 row_mask:0xf bank_mask:0xf
v_add_f32_dpp v67, v67, v67 row_ror:8 row_mask:0xf bank_mask:0xf
s_nop 0
v_add_f32_dpp v64, v64, v64 row_ror:4 row_mask:0xf bank_mask:0xf
v_add_f32_dpp v65, v65, v65 row_ror:4 row_mask:0xf bank_mask:0xf
v_add_f32_dpp v66, v66, v66 row_ror:4 row_mask:0xf bank_mask:0xf
v_add_f32_dpp v67, v67, v67 row_ror:4 row_mask:0xf bank_mask:0xf
s_waitcnt vmcnt(29)
v_pk_add_f32 v[8:9], v[8:9], v[12:13]
v_pk_add_f32 v[10:11], v[10:11], v[14:15]
v_pk_add_f32 v[8:9], v[8:9], v[16:17]
v_pk_add_f32 v[10:11], v[10:11], v[18:19]
v_pk_add_f32 v[8:9], v[8:9], v[20:21]
v_pk_add_f32 v[10:11], v[10:11], v[22:23]
v_pk_add_f32 v[8:9], v[8:9], v[24:25]
v_pk_add_f32 v[10:11], v[10:11], v[26:27]
v_pk_add_f32 v[8:9], v[8:9], v[28:29]
v_pk_add_f32 v[10:11], v[10:11], v[30:31]
v_pk_add_f32 v[8:9], v[8:9], v[32:33]
v_pk_add_f32 v[10:11], v[10:11], v[34:35]
s_waitcnt vmcnt(23)
v_pk_add_f32 v[8:9], v[8:9], v[36:37]
v_pk_add_f32 v[10:11], v[10:11], v[38:39]
v_pk_add_f32 v[8:9], v[8:9], v[88:89]
v_pk_add_f32 v[10:11], v[10:11], v[90:91]
v_pk_add_f32 v[8:9], v[8:9], v[92:93]
v_pk_add_f32 v[10:11], v[10:11], v[94:95]
v_pk_add_f32 v[8:9], v[8:9], v[96:97]
v_pk_add_f32 v[10:11], v[10:11], v[98:99]
v_pk_add_f32 v[8:9], v[8:9], v[100:101]
v_pk_add_f32 v[10:11], v[10:11], v[102:103]
v_pk_add_f32 v[8:9], v[8:9], v[104:105]
v_pk_add_f32 v[10:11], v[10:11], v[106:107]
s_waitcnt vmcnt(17)
v_pk_add_f32 v[8:9], v[8:9], v[108:109]
v_pk_add_f32 v[10:11], v[10:11], v[110:111]
v_pk_add_f32 v[8:9], v[8:9], v[112:113]
v_pk_add_f32 v[10:11], v[10:11], v[114:115]
v_pk_add_f32 v[8:9], v[8:9], v[116:117]
v_pk_add_f32 v[10:11], v[10:11], v[118:119]
v_pk_add_f32 v[8:9], v[8:9], v[120:121]
v_pk_add_f32 v[10:11], v[10:11], v[122:123]
v_pk_add_f32 v[8:9], v[8:9], v[124:125]
v_pk_add_f32 v[10:11], v[10:11], v[126:127]
v_pk_add_f32 v[8:9], v[8:9], v[128:129]
v_pk_add_f32 v[10:11], v[10:11], v[130:131]
s_waitcnt vmcnt(11)
v_pk_add_f32 v[8:9], v[8:9], v[132:133]
v_pk_add_f32 v[10:11], v[10:11], v[134:135]
v_pk_add_f32 v[8:9], v[8:9], v[136:137]
v_pk_add_f32 v[10:11], v[10:11], v[138:139]
v_pk_add_f32 v[8:9], v[8:9], v[140:141]
v_pk_add_f32 v[10:11], v[10:11], v[142:143]
v_pk_add_f32 v[8:9], v[8:9], v[144:145]
v_pk_add_f32 v[10:11], v[10:11], v[146:147]
v_pk_add_f32 v[8:9], v[8:9], v[148:149]
v_pk_add_f32 v[10:11], v[10:11], v[150:151]
v_pk_add_f32 v[8:9], v[8:9], v[152:153]
v_pk_add_f32 v[10:11], v[10:11], v[154:155]
s_waitcnt vmcnt(5)
v_pk_add_f32 v[8:9], v[8:9], v[156:157]
v_pk_add_f32 v[10:11], v[10:11], v[158:159]
v_pk_add_f32 v[8:9], v[8:9], v[160:161]
v_pk_add_f32 v[10:11], v[10:11], v[162:163]
v_pk_add_f32 v[8:9], v[8:9], v[164:165]
v_pk_add_f32 v[10:11], v[10:11], v[166:167]
v_pk_add_f32 v[8:9], v[8:9], v[168:169]
v_pk_add_f32 v[10:11], v[10:11], v[170:171]
v_pk_add_f32 v[8:9], v[8:9], v[172:173]
v_pk_add_f32 v[10:11], v[10:11], v[174:175]
v_pk_add_f32 v[8:9], v[8:9], v[176:177]
v_pk_add_f32 v[10:11], v[10:11], v[178:179]
s_waitcnt vmcnt(0)
v_pk_add_f32 v[8:9], v[8:9], v[180:181]
v_pk_add_f32 v[10:11], v[10:11], v[182:183]
v_pk_add_f32 v[8:9], v[8:9], v[184:185]
v_pk_add_f32 v[10:11], v[10:11], v[186:187]
v_pk_add_f32 v[8:9], v[8:9], v[188:189]
v_pk_add_f32 v[10:11], v[10:11], v[190:191]
v_pk_add_f32 v[8:9], v[8:9], v[192:193]
v_pk_add_f32 v[10:11], v[10:11], v[194:195]
v_pk_add_f32 v[8:9], v[8:9], v[196:197]
v_pk_add_f32 v[10:11], v[10:11], v[198:199]
ds_write_b128 v62, v[8:11]
ds_write_b128 v62, v[64:67] offset:1024
ds_read_b128 v[88:91], v63 offset:0
ds_read_b128 v[92:95], v63 offset:256
ds_read_b128 v[96:99], v63 offset:512
ds_read_b128 v[100:103], v63 offset:768
ds_read_b128 v[104:107], v63 offset:64
ds_read_b128 v[108:111], v63 offset:320
ds_read_b128 v[112:115], v63 offset:576
ds_read_b128 v[116:119], v63 offset:832
ds_read_b128 v[120:123], v63 offset:128
ds_read_b128 v[124:127], v63 offset:384
ds_read_b128 v[128:131], v63 offset:640
ds_read_b128 v[132:135], v63 offset:896
ds_read_b128 v[136:139], v63 offset:192
ds_read_b128 v[140:143], v63 offset:448
ds_read_b128 v[144:147], v63 offset:704
ds_read_b128 v[148:151], v63 offset:960
ds_read_b128 v[152:155], v63 offset:1024
ds_read_b128 v[156:159], v63 offset:1280
ds_read_b128 v[160:163], v63 offset:1536
ds_read_b128 v[164:167], v63 offset:1792
v_cmp_eq_u32 vcc, s46, v3
s_waitcnt lgkmcnt(0)
s_mov_b64 exec, vcc
v_pk_add_f32 v[88:89], v[88:89], v[92:93]
v_pk_add_f32 v[96:97], v[96:97], v[100:101]
v_pk_add_f32 v[88:89], v[88:89], v[96:97]
v_cvt_pk_bf16_f32 v88, v88, v89
v_lshlrev_b32 v40, 16, v88
v_and_b32 v41, 0xffff0000, v88
v_mul_f32 v40, s47, v40
v_mul_f32 v41, s47, v41
v_cvt_pk_bf16_f32 v88, v40, v41
v_lshlrev_b32 v40, 16, v88
v_and_b32 v41, 0xffff0000, v88
v_pk_add_f32 v[90:91], v[90:91], v[94:95]
v_pk_add_f32 v[98:99], v[98:99], v[102:103]
v_pk_add_f32 v[90:91], v[90:91], v[98:99]
v_cvt_pk_bf16_f32 v90, v90, v91
v_lshlrev_b32 v42, 16, v90
v_and_b32 v43, 0xffff0000, v90
v_mul_f32 v42, s47, v42
v_mul_f32 v43, s47, v43
v_cvt_pk_bf16_f32 v90, v42, v43
v_lshlrev_b32 v42, 16, v90
v_and_b32 v43, 0xffff0000, v90
v_pk_add_f32 v[104:105], v[104:105], v[108:109]
v_pk_add_f32 v[112:113], v[112:113], v[116:117]
v_pk_add_f32 v[104:105], v[104:105], v[112:113]
v_cvt_pk_bf16_f32 v104, v104, v105
v_lshlrev_b32 v44, 16, v104
v_and_b32 v45, 0xffff0000, v104
v_mul_f32 v44, s47, v44
v_mul_f32 v45, s47, v45
v_cvt_pk_bf16_f32 v104, v44, v45
v_lshlrev_b32 v44, 16, v104
v_and_b32 v45, 0xffff0000, v104
v_pk_add_f32 v[106:107], v[106:107], v[110:111]
v_pk_add_f32 v[114:115], v[114:115], v[118:119]
v_pk_add_f32 v[106:107], v[106:107], v[114:115]
v_cvt_pk_bf16_f32 v106, v106, v107
v_lshlrev_b32 v46, 16, v106
v_and_b32 v47, 0xffff0000, v106
v_mul_f32 v46, s47, v46
v_mul_f32 v47, s47, v47
v_cvt_pk_bf16_f32 v106, v46, v47
v_lshlrev_b32 v46, 16, v106
v_and_b32 v47, 0xffff0000, v106
v_pk_add_f32 v[120:121], v[120:121], v[124:125]
v_pk_add_f32 v[128:129], v[128:129], v[132:133]
v_pk_add_f32 v[120:121], v[120:121], v[128:129]
v_cvt_pk_bf16_f32 v120, v120, v121
v_lshlrev_b32 v48, 16, v120
v_and_b32 v49, 0xffff0000, v120
v_mul_f32 v48, s47, v48
v_mul_f32 v49, s47, v49
v_cvt_pk_bf16_f32 v120, v48, v49
v_lshlrev_b32 v48, 16, v120
v_and_b32 v49, 0xffff0000, v120
v_pk_add_f32 v[122:123], v[122:123], v[126:127]
v_pk_add_f32 v[130:131], v[130:131], v[134:135]
v_pk_add_f32 v[122:123], v[122:123], v[130:131]
v_cvt_pk_bf16_f32 v122, v122, v123
v_lshlrev_b32 v50, 16, v122
v_and_b32 v51, 0xffff0000, v122
v_mul_f32 v50, s47, v50
v_mul_f32 v51, s47, v51
v_cvt_pk_bf16_f32 v122, v50, v51
v_lshlrev_b32 v50, 16, v122
v_and_b32 v51, 0xffff0000, v122
v_pk_add_f32 v[136:137], v[136:137], v[140:141]
v_pk_add_f32 v[144:145], v[144:145], v[148:149]
v_pk_add_f32 v[136:137], v[136:137], v[144:145]
v_cvt_pk_bf16_f32 v136, v136, v137
v_lshlrev_b32 v52, 16, v136
v_and_b32 v53, 0xffff0000, v136
v_mul_f32 v52, s47, v52
v_mul_f32 v53, s47, v53
v_cvt_pk_bf16_f32 v136, v52, v53
v_lshlrev_b32 v52, 16, v136
v_and_b32 v53, 0xffff0000, v136
v_pk_add_f32 v[138:139], v[138:139], v[142:143]
v_pk_add_f32 v[146:147], v[146:147], v[150:151]
v_pk_add_f32 v[138:139], v[138:139], v[146:147]
v_cvt_pk_bf16_f32 v138, v138, v139
v_lshlrev_b32 v54, 16, v138
v_and_b32 v55, 0xffff0000, v138
v_mul_f32 v54, s47, v54
v_mul_f32 v55, s47, v55
v_cvt_pk_bf16_f32 v138, v54, v55
v_lshlrev_b32 v54, 16, v138
v_and_b32 v55, 0xffff0000, v138
v_pk_add_f32 v[152:153], v[152:153], v[156:157]
v_pk_add_f32 v[160:161], v[160:161], v[164:165]
v_pk_add_f32 v[152:153], v[152:153], v[160:161]
v_cvt_pk_bf16_f32 v152, v152, v153
v_lshlrev_b32 v56, 16, v152
v_and_b32 v57, 0xffff0000, v152
v_mul_f32 v56, s47, v56
v_mul_f32 v57, s47, v57
v_cvt_pk_bf16_f32 v152, v56, v57
v_lshlrev_b32 v56, 16, v152
v_and_b32 v57, 0xffff0000, v152
v_pk_add_f32 v[154:155], v[154:155], v[158:159]
v_pk_add_f32 v[162:163], v[162:163], v[166:167]
v_pk_add_f32 v[154:155], v[154:155], v[162:163]
v_cvt_pk_bf16_f32 v154, v154, v155
v_lshlrev_b32 v58, 16, v154
v_and_b32 v59, 0xffff0000, v154
v_mul_f32 v58, s47, v58
v_mul_f32 v59, s47, v59
v_cvt_pk_bf16_f32 v154, v58, v59
v_lshlrev_b32 v58, 16, v154
v_and_b32 v59, 0xffff0000, v154
s_mov_b64 exec, -1
s_cmp_lg_u32 s92, 0
s_cbranch_scc1 K_YTOK
s_branch K_YGD
K_SIDE:
s_cmp_eq_u32 s40, 7
s_cbranch_scc1 K_SIDE_7
s_cmp_eq_u32 s40, 6
s_cbranch_scc1 K_SIDE_6
s_cmp_eq_u32 s40, 5
s_cbranch_scc1 K_SIDE_5
s_cmp_eq_u32 s40, 4
s_cbranch_scc1 K_SIDE_4
s_cmp_eq_u32 s40, 3
s_cbranch_scc1 K_SIDE_3
v_and_b32 v5, 7, v1
v_lshlrev_b32 v5, 4, v5
buffer_load_dwordx2 v[254:255], v5, s[28:31], 0 offen offset:8 sc0 sc1
s_mov_b32 s45, s50
s_add_u32 s44, s3, 131072
s_branch K_SIDED
K_SIDE_3:
v_cmp_eq_u32 vcc, 0, v254
s_cbranch_vccz K_IDXOK0
K_IDXSPIN0:
s_sleep 4
s_add_u32 s100, s100, 1
s_bitcmp1_b32 s100, 19
s_cbranch_scc1 K_END
buffer_load_dwordx2 v[254:255], v5, s[28:31], 0 offen offset:8 sc0 sc1
s_waitcnt vmcnt(0)
v_cmp_eq_u32 vcc, 0, v254
s_cbranch_vccnz K_IDXSPIN0
K_IDXOK0:
s_lshl_b32 s46, s32, 1
s_add_u32 s47, s46, 1
v_readlane_b32 s46, v254, s46
v_readlane_b32 s47, v254, s47
s_mul_i32 s48, s32, 2304
s_sub_u32 s46, s46, 1
s_sub_u32 s47, s47, 1
s_mul_i32 s46, s46, 1152
s_mul_i32 s47, s47, 1152
s_add_u32 m0, s48, 151552
s_nop 0
buffer_load_dwordx4 v234, s[20:23], s46 offen sc0 sc1 lds
s_mov_b64 exec, 0xff
buffer_load_dwordx4 v234, s[20:23], s46 offen offset:1024 sc0 sc1 lds
s_mov_b64 exec, -1
s_add_u32 m0, s48, 152704
s_nop 0
buffer_load_dwordx4 v234, s[20:23], s47 offen sc0 sc1 lds
s_mov_b64 exec, 0xff
buffer_load_dwordx4 v234, s[20:23], s47 offen offset:1024 sc0 sc1 lds
s_mov_b64 exec, -1
s_branch K_SIDED
K_SIDE_4:
s_cmp_eq_u32 s52, 0
s_cbranch_scc1 K_SIDE_4A
v_and_b32 v6, 7, v1
v_mul_u32_u24 v6, 0x480, v6
v_lshl_add_u32 v6, v4, 4, v6
v_add_u32 v6, 0x25000, v6
ds_read_b128 v[104:107], v6 offset:0
ds_read_b128 v[108:111], v6 offset:64
ds_read_b128 v[112:115], v6 offset:128
ds_read_b128 v[116:119], v6 offset:192
ds_read_b128 v[120:123], v6 offset:256
ds_read_b128 v[124:127], v6 offset:320
ds_read_b128 v[128:131], v6 offset:384
ds_read_b128 v[132:135], v6 offset:448
ds_read_b128 a[192:195], v6 offset:512
ds_read_b128 a[196:199], v6 offset:576
ds_read_b128 a[200:203], v6 offset:640
ds_read_b128 a[204:207], v6 offset:704
ds_read_b128 a[212:215], v6 offset:768
ds_read_b128 a[216:219], v6 offset:832
ds_read_b128 a[220:223], v6 offset:896
ds_read_b128 a[224:227], v6 offset:960
ds_read_b128 a[228:231], v6 offset:1024
ds_read_b128 a[232:235], v6 offset:1088
s_branch K_SIDE_4B
K_SIDE_4A:
v_and_b32 v5, 7, v1
v_lshlrev_b32 v5, 4, v5
buffer_load_dwordx2 v[254:255], v5, s[28:31], 0 offen offset:8 sc0 sc1
K_SIDE_4B:
s_mov_b32 s76, s88
s_and_b32 s77, s89, 0xffff
s_mov_b32 s78, 0x510000
s_mov_b32 s79, 0x00020000
s_lshr_b32 s46, s2, 3
s_lshl_b32 s46, s46, 2
s_add_u32 s46, s46, s32
v_min_u32 v6, 35, v1
v_mul_u32_u24 v7, 7282, v6
v_lshrrev_b32 v7, 16, v7
v_lshlrev_b32 v6, 7, v6
v_mul_u32_u24 v7, 8064, v7
v_add_u32 v253, v6, v7
s_and_b32 s42, s2, 7
s_mul_i32 s42, s42, 1152
s_mul_i32 s46, s46, 36864
s_add_u32 s42, s42, s46
s_mov_b32 s43, 4718592
s_branch K_SIDED
K_SIDE_5:
v_cmp_eq_u32 vcc, 0, v254
s_cbranch_vccz K_IDXOK1
K_IDXSPIN1:
s_sleep 4
s_add_u32 s100, s100, 1
s_bitcmp1_b32 s100, 19
s_cbranch_scc1 K_END
buffer_load_dwordx2 v[254:255], v5, s[28:31], 0 offen offset:8 sc0 sc1
s_waitcnt vmcnt(0)
v_cmp_eq_u32 vcc, 0, v254
s_cbranch_vccnz K_IDXSPIN1
K_IDXOK1:
s_and_b32 s42, s2, 7
s_mul_i32 s42, s42, 663552
s_add_u32 s47, s42, 663552
s_mov_b32 s76, s64
s_and_b32 s77, s65, 0xffff
s_mov_b32 s78, s47
s_mov_b32 s79, 0x00020000
s_lshr_b32 s46, s2, 3
s_lshl_b32 s46, s46, 2
s_add_u32 s46, s46, s32
s_lshl_b32 s46, s46, 12
s_add_u32 s42, s42, s46
s_mov_b32 s43, 524288
v_lshlrev_b32 v253, 6, v1
s_branch K_SIDED
K_SIDE_6:
s_mov_b32 s16, s86
s_and_b32 s17, s87, 0xffff
s_mov_b32 s18, 0x480000
s_mov_b32 s19, 0x00020000
s_mul_i32 s42, s35, 1179648
s_add_u32 s47, s42, 1179648
s_mov_b32 s76, s86
s_and_b32 s77, s87, 0xffff
s_mov_b32 s78, s47
s_mov_b32 s79, 0x00020000
s_lshr_b32 s46, s2, 3
s_lshl_b32 s46, s46, 2
s_add_u32 s46, s46, s32
s_lshl_b32 s46, s46, 12
s_add_u32 s42, s42, s46
s_branch K_SIDED
K_SIDE_7:
s_getpc_b64 s[96:97]
PC_b:
s_sub_u32 s96, s96, PC_b-K_LAST
s_subb_u32 s97, s97, 0
s_lshr_b32 s46, s2, 3
s_lshl_b32 s46, s46, 2
s_add_u32 s46, s46, s32
s_min_u32 s46, s46, ((K_CODE_END-K_LAST)>>10)-1
s_lshl_b32 s46, s46, 10
v_lshlrev_b32 v7, 4, v1
v_add_u32 v7, s46, v7
global_load_dwordx4 a[240:243], v7, s[96:97]
s_branch K_SIDED
K_RANK:
s_mov_b32 s46, 2
K_RANK1:
v_cmp_lt_u32 vcc, s92, v255
s_bcnt1_i32_b64 s48, vcc
s_cmp_lt_u32 s48, 8
s_cbranch_scc0 K_RANK2
v_mov_b32 v246, 0
v_cmp_lt_u32 vcc, s92, v104
v_addc_co_u32 v246, vcc, 0, v246, vcc
v_cmp_lt_u32 vcc, s92, v105
v_addc_co_u32 v246, vcc, 0, v246, vcc
v_cmp_lt_u32 vcc, s92, v106
v_addc_co_u32 v246, vcc, 0, v246, vcc
v_cmp_lt_u32 vcc, s92, v107
v_addc_co_u32 v246, vcc, 0, v246, vcc
v_cmp_lt_u32 vcc, s92, v108
v_addc_co_u32 v246, vcc, 0, v246, vcc
v_cmp_lt_u32 vcc, s92, v109
v_addc_co_u32 v246, vcc, 0, v246, vcc
v_cmp_lt_u32 vcc, s92, v110
v_addc_co_u32 v246, vcc, 0, v246, vcc
v_cmp_lt_u32 vcc, s92, v111
v_addc_co_u32 v246, vcc, 0, v246, vcc
v_cmp_lt_u32 vcc, s92, v112
v_addc_co_u32 v246, vcc, 0, v246, vcc
v_cmp_lt_u32 vcc, s92, v113
v_addc_co_u32 v246, vcc, 0, v246, vcc
v_cmp_lt_u32 vcc, s92, v114
v_addc_co_u32 v246, vcc, 0, v246, vcc
v_cmp_lt_u32 vcc, s92, v115
v_addc_co_u32 v246, vcc, 0, v246, vcc
v_cmp_lt_u32 vcc, s92, v116
v_addc_co_u32 v246, vcc, 0, v246, vcc
v_cmp_lt_u32 vcc, s92, v117
v_addc_co_u32 v246, vcc, 0, v246, vcc
v_cmp_lt_u32 vcc, s92, v118
v_addc_co_u32 v246, vcc, 0, v246, vcc
v_cmp_lt_u32 vcc, s92, v119
v_addc_co_u32 v246, vcc, 0, v246, vcc
v_cmp_lt_u32 vcc, s92, v120
v_addc_co_u32 v246, vcc, 0, v246, vcc
v_cmp_lt_u32 vcc, s92, v121
v_addc_co_u32 v246, vcc, 0, v246, vcc
v_cmp_lt_u32 vcc, s92, v122
v_addc_co_u32 v246, vcc, 0, v246, vcc
v_cmp_lt_u32 vcc, s92, v123
v_addc_co_u32 v246, vcc, 0, v246, vcc
v_cmp_lt_u32 vcc, s92, v124
v_addc_co_u32 v246, vcc, 0, v246, vcc
v_cmp_lt_u32 vcc, s92, v125
v_addc_co_u32 v246, vcc, 0, v246, vcc
v_cmp_lt_u32 vcc, s92, v126
v_addc_co_u32 v246, vcc, 0, v246, vcc
v_cmp_lt_u32 vcc, s92, v127
v_addc_co_u32 v246, vcc, 0, v246, vcc
v_cmp_lt_u32 vcc, s92, v128
v_addc_co_u32 v246, vcc, 0, v246, vcc
v_cmp_lt_u32 vcc, s92, v129
v_addc_co_u32 v246, vcc, 0, v246, vcc
v_cmp_lt_u32 vcc, s92, v130
v_addc_co_u32 v246, vcc, 0, v246, vcc
v_cmp_lt_u32 vcc, s92, v131
v_addc_co_u32 v246, vcc, 0, v246, vcc
v_cmp_lt_u32 vcc, s92, v132
v_addc_co_u32 v246, vcc, 0, v246, vcc
v_cmp_lt_u32 vcc, s92, v133
v_addc_co_u32 v246, vcc, 0, v246, vcc
v_cmp_lt_u32 vcc, s92, v134
v_addc_co_u32 v246, vcc, 0, v246, vcc
v_cmp_lt_u32 vcc, s92, v135
v_addc_co_u32 v246, vcc, 0, v246, vcc
s_mov_b32 s48, 0
v_cmp_lt_u32 vcc, 0, v246
s_bcnt1_i32_b64 s47, vcc
s_add_u32 s48, s48, s47
v_cmp_lt_u32 vcc, 1, v246
s_bcnt1_i32_b64 s47, vcc
s_add_u32 s48, s48, s47
v_cmp_lt_u32 vcc, 2, v246
s_bcnt1_i32_b64 s47, vcc
s_add_u32 s48, s48, s47
v_cmp_lt_u32 vcc, 3, v246
s_bcnt1_i32_b64 s47, vcc
s_add_u32 s48, s48, s47
v_cmp_lt_u32 vcc, 4, v246
s_bcnt1_i32_b64 s47, vcc
s_add_u32 s48, s48, s47
v_cmp_lt_u32 vcc, 5, v246
s_bcnt1_i32_b64 s47, vcc
s_add_u32 s48, s48, s47
v_cmp_lt_u32 vcc, 6, v246
s_bcnt1_i32_b64 s47, vcc
s_add_u32 s48, s48, s47
v_cmp_lt_u32 vcc, 7, v246
s_bcnt1_i32_b64 s47, vcc
s_add_u32 s48, s48, s47
s_cmp_lt_u32 s48, 8
s_cbranch_scc0 K_RANK2
s_and_b32 s47, s92, 0xffff
s_sub_u32 s47, 2048, s47
s_ashr_i32 s94, s92, 31
s_not_b32 s94, s94
s_or_b32 s94, s94, 0x80000000
s_xor_b32 s94, s94, s92
s_and_b32 s94, s94, 0xffff0000
v_mov_b32 v247, s94
v_mul_f32 v247, 0xbfb8aa3b, v247
v_exp_f32 v247, v247
s_nop 0
v_add_f32 v247, 1.0, v247
v_rcp_f32 v247, v247
s_nop 0
v_cvt_pk_bf16_f32 v247, v247, v247
v_lshlrev_b32 v247, 16, v247
v_mov_b32 v246, s47
s_lshl_b32 s48, s48, 4
s_mov_b64 exec, 1
buffer_store_dwordx2 v[246:247], v234, s[28:31], s48 offen offset:8 sc0 sc1
s_mov_b64 exec, -1
K_RANK2:
s_mov_b32 s92, s93
s_sub_u32 s46, s46, 1
s_cmp_lg_u32 s46, 0
s_cbranch_scc1 K_RANK1
s_branch K_RANKED
K_CODE_END:
K_FB:
s_mov_b32 s41, 1
s_waitcnt vmcnt(0) lgkmcnt(0)
s_barrier
v_mov_b32 v136, 0xff800000
v_mov_b32 v140, 0xff800000
v_mov_b32 v144, 0xff800000
v_mov_b32 v148, 0xff800000
s_mov_b32 s38, 0
s_mov_b32 s40, 32
K_FBLOOP:
s_add_u32 m0, s37, 0
s_nop 0
buffer_load_dwordx4 v228, s[8:11], s38 offen offset:0 lds
buffer_load_dwordx4 v229, s[8:11], s38 offen offset:1024 lds
buffer_load_dwordx4 v230, s[8:11], s38 offen offset:2048 lds
buffer_load_dwordx4 v231, s[8:11], s38 offen offset:3072 lds
s_add_u32 s38, s38, 16384
s_waitcnt vmcnt(0)
s_barrier
ds_read_b128 a[128:131], v216 offset:0
ds_read_b128 a[132:135], v217 offset:0
ds_read_b128 a[136:139], v218 offset:0
ds_read_b128 a[140:143], v219 offset:0
ds_read_b128 a[144:147], v216 offset:4096
ds_read_b128 a[148:151], v217 offset:4096
ds_read_b128 a[152:155], v218 offset:4096
ds_read_b128 a[156:159], v219 offset:4096
s_waitcnt lgkmcnt(0)
v_mfma_f32_16x16x32_bf16 v[8:11], a[128:131], v[152:155], 0
v_mfma_f32_16x16x32_bf16 v[8:11], a[132:135], v[156:159], v[8:11]
v_mfma_f32_16x16x32_bf16 v[8:11], a[136:139], v[160:163], v[8:11]
v_mfma_f32_16x16x32_bf16 v[8:11], a[140:143], v[164:167], v[8:11]
v_mfma_f32_16x16x32_bf16 v[12:15], a[144:147], v[152:155], 0
v_mfma_f32_16x16x32_bf16 v[12:15], a[148:151], v[156:159], v[12:15]
v_mfma_f32_16x16x32_bf16 v[12:15], a[152:155], v[160:163], v[12:15]
v_mfma_f32_16x16x32_bf16 v[12:15], a[156:159], v[164:167], v[12:15]
v_mfma_f32_16x16x32_bf16 v[16:19], a[128:131], v[168:171], 0
v_mfma_f32_16x16x32_bf16 v[16:19], a[132:135], v[172:175], v[16:19]
v_mfma_f32_16x16x32_bf16 v[16:19], a[136:139], v[176:179], v[16:19]
v_mfma_f32_16x16x32_bf16 v[16:19], a[140:143], v[180:183], v[16:19]
v_mfma_f32_16x16x32_bf16 v[20:23], a[144:147], v[168:171], 0
v_mfma_f32_16x16x32_bf16 v[20:23], a[148:151], v[172:175], v[20:23]
v_mfma_f32_16x16x32_bf16 v[20:23], a[152:155], v[176:179], v[20:23]
v_mfma_f32_16x16x32_bf16 v[20:23], a[156:159], v[180:183], v[20:23]
v_mfma_f32_16x16x32_bf16 v[24:27], a[128:131], v[184:187], 0
v_mfma_f32_16x16x32_bf16 v[24:27], a[132:135], v[188:191], v[24:27]
v_mfma_f32_16x16x32_bf16 v[24:27], a[136:139], v[192:195], v[24:27]
v_mfma_f32_16x16x32_bf16 v[24:27], a[140:143], v[196:199], v[24:27]
v_mfma_f32_16x16x32_bf16 v[28:31], a[144:147], v[184:187], 0
v_mfma_f32_16x16x32_bf16 v[28:31], a[148:151], v[188:191], v[28:31]
v_mfma_f32_16x16x32_bf16 v[28:31], a[152:155], v[192:195], v[28:31]
v_mfma_f32_16x16x32_bf16 v[28:31], a[156:159], v[196:199], v[28:31]
v_mfma_f32_16x16x32_bf16 v[32:35], a[128:131], v[200:203], 0
v_mfma_f32_16x16x32_bf16 v[32:35], a[132:135], v[204:207], v[32:35]
v_mfma_f32_16x16x32_bf16 v[32:35], a[136:139], v[208:211], v[32:35]
v_mfma_f32_16x16x32_bf16 v[32:35], a[140:143], v[212:215], v[32:35]
v_mfma_f32_16x16x32_bf16 v[36:39], a[144:147], v[200:203], 0
v_mfma_f32_16x16x32_bf16 v[36:39], a[148:151], v[204:207], v[36:39]
v_mfma_f32_16x16x32_bf16 v[36:39], a[152:155], v[208:211], v[36:39]
v_mfma_f32_16x16x32_bf16 v[36:39], a[156:159], v[212:215], v[36:39]
s_nop 7
v_max3_f32 v136, v136, v8, v9
v_max3_f32 v136, v136, v10, v11
v_max3_f32 v136, v136, v12, v13
v_max3_f32 v136, v136, v14, v15
v_max3_f32 v140, v140, v16, v17
v_max3_f32 v140, v140, v18, v19
v_max3_f32 v140, v140, v20, v21
v_max3_f32 v140, v140, v22, v23
v_max3_f32 v144, v144, v24, v25
v_max3_f32 v144, v144, v26, v27
v_max3_f32 v144, v144, v28, v29
v_max3_f32 v144, v144, v30, v31
v_max3_f32 v148, v148, v32, v33
v_max3_f32 v148, v148, v34, v35
v_max3_f32 v148, v148, v36, v37
v_max3_f32 v148, v148, v38, v39
ds_read_b128 a[128:131], v216 offset:8192
ds_read_b128 a[132:135], v217 offset:8192
ds_read_b128 a[136:139], v218 offset:8192
ds_read_b128 a[140:143], v219 offset:8192
ds_read_b128 a[144:147], v216 offset:12288
ds_read_b128 a[148:151], v217 offset:12288
ds_read_b128 a[152:155], v218 offset:12288
ds_read_b128 a[156:159], v219 offset:12288
s_waitcnt lgkmcnt(0)
v_mfma_f32_16x16x32_bf16 v[8:11], a[128:131], v[152:155], 0
v_mfma_f32_16x16x32_bf16 v[8:11], a[132:135], v[156:159], v[8:11]
v_mfma_f32_16x16x32_bf16 v[8:11], a[136:139], v[160:163], v[8:11]
v_mfma_f32_16x16x32_bf16 v[8:11], a[140:143], v[164:167], v[8:11]
v_mfma_f32_16x16x32_bf16 v[12:15], a[144:147], v[152:155], 0
v_mfma_f32_16x16x32_bf16 v[12:15], a[148:151], v[156:159], v[12:15]
v_mfma_f32_16x16x32_bf16 v[12:15], a[152:155], v[160:163], v[12:15]
v_mfma_f32_16x16x32_bf16 v[12:15], a[156:159], v[164:167], v[12:15]
v_mfma_f32_16x16x32_bf16 v[16:19], a[128:131], v[168:171], 0
v_mfma_f32_16x16x32_bf16 v[16:19], a[132:135], v[172:175], v[16:19]
v_mfma_f32_16x16x32_bf16 v[16:19], a[136:139], v[176:179], v[16:19]
v_mfma_f32_16x16x32_bf16 v[16:19], a[140:143], v[180:183], v[16:19]
v_mfma_f32_16x16x32_bf16 v[20:23], a[144:147], v[168:171], 0
v_mfma_f32_16x16x32_bf16 v[20:23], a[148:151], v[172:175], v[20:23]
v_mfma_f32_16x16x32_bf16 v[20:23], a[152:155], v[176:179], v[20:23]
v_mfma_f32_16x16x32_bf16 v[20:23], a[156:159], v[180:183], v[20:23]
v_mfma_f32_16x16x32_bf16 v[24:27], a[128:131], v[184:187], 0
v_mfma_f32_16x16x32_bf16 v[24:27], a[132:135], v[188:191], v[24:27]
v_mfma_f32_16x16x32_bf16 v[24:27], a[136:139], v[192:195], v[24:27]
v_mfma_f32_16x16x32_bf16 v[24:27], a[140:143], v[196:199], v[24:27]
v_mfma_f32_16x16x32_bf16 v[28:31], a[144:147], v[184:187], 0
v_mfma_f32_16x16x32_bf16 v[28:31], a[148:151], v[188:191], v[28:31]
v_mfma_f32_16x16x32_bf16 v[28:31], a[152:155], v[192:195], v[28:31]
v_mfma_f32_16x16x32_bf16 v[28:31], a[156:159], v[196:199], v[28:31]
v_mfma_f32_16x16x32_bf16 v[32:35], a[128:131], v[200:203], 0
v_mfma_f32_16x16x32_bf16 v[32:35], a[132:135], v[204:207], v[32:35]
v_mfma_f32_16x16x32_bf16 v[32:35], a[136:139], v[208:211], v[32:35]
v_mfma_f32_16x16x32_bf16 v[32:35], a[140:143], v[212:215], v[32:35]
v_mfma_f32_16x16x32_bf16 v[36:39], a[144:147], v[200:203], 0
v_mfma_f32_16x16x32_bf16 v[36:39], a[148:151], v[204:207], v[36:39]
v_mfma_f32_16x16x32_bf16 v[36:39], a[152:155], v[208:211], v[36:39]
v_mfma_f32_16x16x32_bf16 v[36:39], a[156:159], v[212:215], v[36:39]
s_nop 7
v_max3_f32 v136, v136, v8, v9
v_max3_f32 v136, v136, v10, v11
v_max3_f32 v136, v136, v12, v13
v_max3_f32 v136, v136, v14, v15
v_max3_f32 v140, v140, v16, v17
v_max3_f32 v140, v140, v18, v19
v_max3_f32 v140, v140, v20, v21
v_max3_f32 v140, v140, v22, v23
v_max3_f32 v144, v144, v24, v25
v_max3_f32 v144, v144, v26, v27
v_max3_f32 v144, v144, v28, v29
v_max3_f32 v144, v144, v30, v31
v_max3_f32 v148, v148, v32, v33
v_max3_f32 v148, v148, v34, v35
v_max3_f32 v148, v148, v36, v37
v_max3_f32 v148, v148, v38, v39
s_barrier
s_sub_u32 s40, s40, 1
s_cmp_lg_u32 s40, 0
s_cbranch_scc1 K_FBLOOP
v_mov_b32 v137, v136
s_nop 1
v_permlane16_swap_b32 v136, v137
v_max_f32 v136, v136, v137
v_mov_b32 v137, v136
s_nop 1
v_permlane32_swap_b32 v136, v137
v_max_f32 v136, v136, v137
v_sub_f32 v139, 0, v136
v_sub_f32 v138, 0, v136
v_sub_f32 v137, 0, v136
v_sub_f32 v136, 0, v136
v_mov_b32 v141, v140
s_nop 1
v_permlane16_swap_b32 v140, v141
v_max_f32 v140, v140, v141
v_mov_b32 v141, v140
s_nop 1
v_permlane32_swap_b32 v140, v141
v_max_f32 v140, v140, v141
v_sub_f32 v143, 0, v140
v_sub_f32 v142, 0, v140
v_sub_f32 v141, 0, v140
v_sub_f32 v140, 0, v140
v_mov_b32 v145, v144
s_nop 1
v_permlane16_swap_b32 v144, v145
v_max_f32 v144, v144, v145
v_mov_b32 v145, v144
s_nop 1
v_permlane32_swap_b32 v144, v145
v_max_f32 v144, v144, v145
v_sub_f32 v147, 0, v144
v_sub_f32 v146, 0, v144
v_sub_f32 v145, 0, v144
v_sub_f32 v144, 0, v144
v_mov_b32 v149, v148
s_nop 1
v_permlane16_swap_b32 v148, v149
v_max_f32 v148, v148, v149
v_mov_b32 v149, v148
s_nop 1
v_permlane32_swap_b32 v148, v149
v_max_f32 v148, v148, v149
v_sub_f32 v151, 0, v148
v_sub_f32 v150, 0, v148
v_sub_f32 v149, 0, v148
v_sub_f32 v148, 0, v148
s_mov_b32 s38, 0
s_add_u32 m0, s37, 32768
s_nop 0
buffer_load_dwordx4 v228, s[8:11], s38 offen offset:0 lds
buffer_load_dwordx4 v229, s[8:11], s38 offen offset:1024 lds
buffer_load_dwordx4 v230, s[8:11], s38 offen offset:2048 lds
buffer_load_dwordx4 v231, s[8:11], s38 offen offset:3072 lds
s_add_u32 s38, s38, 16384
s_add_u32 m0, s37, 16384
s_nop 0
buffer_load_dwordx4 v228, s[8:11], s38 offen offset:0 lds
buffer_load_dwordx4 v229, s[8:11], s38 offen offset:1024 lds
buffer_load_dwordx4 v230, s[8:11], s38 offen offset:2048 lds
buffer_load_dwordx4 v231, s[8:11], s38 offen offset:3072 lds
s_add_u32 s38, s38, 16384
s_add_u32 m0, s37, 0
s_nop 0
buffer_load_dwordx4 v228, s[8:11], s38 offen offset:0 lds
buffer_load_dwordx4 v229, s[8:11], s38 offen offset:1024 lds
buffer_load_dwordx4 v230, s[8:11], s38 offen offset:2048 lds
buffer_load_dwordx4 v231, s[8:11], s38 offen offset:3072 lds
s_add_u32 s38, s38, 16384
s_mov_b32 s39, 0
s_add_u32 m0, s37, 98304
s_nop 0
buffer_load_dwordx4 v232, s[12:15], s39 offen offset:0 lds
buffer_load_dwordx4 v233, s[12:15], s39 offen offset:1024 lds
buffer_load_dwordx4 v232, s[12:15], s39 offen offset:2048 lds
buffer_load_dwordx4 v233, s[12:15], s39 offen offset:3072 lds
s_add_u32 s39, s39, 16384
s_add_u32 m0, s37, 114688
s_nop 0
buffer_load_dwordx4 v232, s[12:15], s39 offen offset:0 lds
buffer_load_dwordx4 v233, s[12:15], s39 offen offset:1024 lds
buffer_load_dwordx4 v232, s[12:15], s39 offen offset:2048 lds
buffer_load_dwordx4 v233, s[12:15], s39 offen offset:3072 lds
s_add_u32 s39, s39, 16384
s_mov_b32 s40, 0
v_accvgpr_write_b32 a0, 0
v_accvgpr_write_b32 a1, 0
v_accvgpr_write_b32 a2, 0
v_accvgpr_write_b32 a3, 0
v_accvgpr_write_b32 a4, 0
v_accvgpr_write_b32 a5, 0
v_accvgpr_write_b32 a6, 0
v_accvgpr_write_b32 a7, 0
v_accvgpr_write_b32 a8, 0
v_accvgpr_write_b32 a9, 0
v_accvgpr_write_b32 a10, 0
v_accvgpr_write_b32 a11, 0
v_accvgpr_write_b32 a12, 0
v_accvgpr_write_b32 a13, 0
v_accvgpr_write_b32 a14, 0
v_accvgpr_write_b32 a15, 0
v_accvgpr_write_b32 a16, 0
v_accvgpr_write_b32 a17, 0
v_accvgpr_write_b32 a18, 0
v_accvgpr_write_b32 a19, 0
v_accvgpr_write_b32 a20, 0
v_accvgpr_write_b32 a21, 0
v_accvgpr_write_b32 a22, 0
v_accvgpr_write_b32 a23, 0
v_accvgpr_write_b32 a24, 0
v_accvgpr_write_b32 a25, 0
v_accvgpr_write_b32 a26, 0
v_accvgpr_write_b32 a27, 0
v_accvgpr_write_b32 a28, 0
v_accvgpr_write_b32 a29, 0
v_accvgpr_write_b32 a30, 0
v_accvgpr_write_b32 a31, 0
v_accvgpr_write_b32 a32, 0
v_accvgpr_write_b32 a33, 0
v_accvgpr_write_b32 a34, 0
v_accvgpr_write_b32 a35, 0
v_accvgpr_write_b32 a36, 0
v_accvgpr_write_b32 a37, 0
v_accvgpr_write_b32 a38, 0
v_accvgpr_write_b32 a39, 0
v_accvgpr_write_b32 a40, 0
v_accvgpr_write_b32 a41, 0
v_accvgpr_write_b32 a42, 0
v_accvgpr_write_b32 a43, 0
v_accvgpr_write_b32 a44, 0
v_accvgpr_write_b32 a45, 0
v_accvgpr_write_b32 a46, 0
v_accvgpr_write_b32 a47, 0
v_accvgpr_write_b32 a48, 0
v_accvgpr_write_b32 a49, 0
v_accvgpr_write_b32 a50, 0
v_accvgpr_write_b32 a51, 0
v_accvgpr_write_b32 a52, 0
v_accvgpr_write_b32 a53, 0
v_accvgpr_write_b32 a54, 0
v_accvgpr_write_b32 a55, 0
v_accvgpr_write_b32 a56, 0
v_accvgpr_write_b32 a57, 0
v_accvgpr_write_b32 a58, 0
v_accvgpr_write_b32 a59, 0
v_accvgpr_write_b32 a60, 0
v_accvgpr_write_b32 a61, 0
v_accvgpr_write_b32 a62, 0
v_accvgpr_write_b32 a63, 0
v_accvgpr_write_b32 a64, 0
v_accvgpr_write_b32 a65, 0
v_accvgpr_write_b32 a66, 0
v_accvgpr_write_b32 a67, 0
v_accvgpr_write_b32 a68, 0
v_accvgpr_write_b32 a69, 0
v_accvgpr_write_b32 a70, 0
v_accvgpr_write_b32 a71, 0
v_accvgpr_write_b32 a72, 0
v_accvgpr_write_b32 a73, 0
v_accvgpr_write_b32 a74, 0
v_accvgpr_write_b32 a75, 0
v_accvgpr_write_b32 a76, 0
v_accvgpr_write_b32 a77, 0
v_accvgpr_write_b32 a78, 0
v_accvgpr_write_b32 a79, 0
v_accvgpr_write_b32 a80, 0
v_accvgpr_write_b32 a81, 0
v_accvgpr_write_b32 a82, 0
v_accvgpr_write_b32 a83, 0
v_accvgpr_write_b32 a84, 0
v_accvgpr_write_b32 a85, 0
v_accvgpr_write_b32 a86, 0
v_accvgpr_write_b32 a87, 0
v_accvgpr_write_b32 a88, 0
v_accvgpr_write_b32 a89, 0
v_accvgpr_write_b32 a90, 0
v_accvgpr_write_b32 a91, 0
v_accvgpr_write_b32 a92, 0
v_accvgpr_write_b32 a93, 0
v_accvgpr_write_b32 a94, 0
v_accvgpr_write_b32 a95, 0
v_accvgpr_write_b32 a96, 0
v_accvgpr_write_b32 a97, 0
v_accvgpr_write_b32 a98, 0
v_accvgpr_write_b32 a99, 0
v_accvgpr_write_b32 a100, 0
v_accvgpr_write_b32 a101, 0
v_accvgpr_write_b32 a102, 0
v_accvgpr_write_b32 a103, 0
v_accvgpr_write_b32 a104, 0
v_accvgpr_write_b32 a105, 0
v_accvgpr_write_b32 a106, 0
v_accvgpr_write_b32 a107, 0
v_accvgpr_write_b32 a108, 0
v_accvgpr_write_b32 a109, 0
v_accvgpr_write_b32 a110, 0
v_accvgpr_write_b32 a111, 0
v_accvgpr_write_b32 a112, 0
v_accvgpr_write_b32 a113, 0
v_accvgpr_write_b32 a114, 0
v_accvgpr_write_b32 a115, 0
v_accvgpr_write_b32 a116, 0
v_accvgpr_write_b32 a117, 0
v_accvgpr_write_b32 a118, 0
v_accvgpr_write_b32 a119, 0
v_accvgpr_write_b32 a120, 0
v_accvgpr_write_b32 a121, 0
v_accvgpr_write_b32 a122, 0
v_accvgpr_write_b32 a123, 0
v_accvgpr_write_b32 a124, 0
v_accvgpr_write_b32 a125, 0
v_accvgpr_write_b32 a126, 0
v_accvgpr_write_b32 a127, 0
v_accvgpr_write_b32 a248, 0
v_accvgpr_write_b32 a249, 0
v_accvgpr_write_b32 a250, 0
v_accvgpr_write_b32 a251, 0
v_accvgpr_write_b32 a252, 0
v_accvgpr_write_b32 a253, 0
v_accvgpr_write_b32 a254, 0
v_accvgpr_write_b32 a255, 0
s_waitcnt vmcnt(0)
s_barrier
ds_read_b128 a[128:131], v216 offset:32768
ds_read_b128 a[132:135], v217 offset:32768
ds_read_b128 a[136:139], v218 offset:32768
ds_read_b128 a[140:143], v219 offset:32768
ds_read_b128 a[144:147], v216 offset:36864
ds_read_b128 a[148:151], v217 offset:36864
ds_read_b128 a[152:155], v218 offset:36864
ds_read_b128 a[156:159], v219 offset:36864
s_waitcnt lgkmcnt(0)
v_mfma_f32_16x16x32_bf16 v[8:11], a[128:131], v[152:155], 0
v_mfma_f32_16x16x32_bf16 v[8:11], a[132:135], v[156:159], v[8:11]
v_mfma_f32_16x16x32_bf16 v[8:11], a[136:139], v[160:163], v[8:11]
v_mfma_f32_16x16x32_bf16 v[8:11], a[140:143], v[164:167], v[8:11]
v_mfma_f32_16x16x32_bf16 v[12:15], a[144:147], v[152:155], 0
v_mfma_f32_16x16x32_bf16 v[12:15], a[148:151], v[156:159], v[12:15]
v_mfma_f32_16x16x32_bf16 v[12:15], a[152:155], v[160:163], v[12:15]
v_mfma_f32_16x16x32_bf16 v[12:15], a[156:159], v[164:167], v[12:15]
v_mfma_f32_16x16x32_bf16 v[16:19], a[128:131], v[168:171], 0
v_mfma_f32_16x16x32_bf16 v[16:19], a[132:135], v[172:175], v[16:19]
v_mfma_f32_16x16x32_bf16 v[16:19], a[136:139], v[176:179], v[16:19]
v_mfma_f32_16x16x32_bf16 v[16:19], a[140:143], v[180:183], v[16:19]
v_mfma_f32_16x16x32_bf16 v[20:23], a[144:147], v[168:171], 0
v_mfma_f32_16x16x32_bf16 v[20:23], a[148:151], v[172:175], v[20:23]
v_mfma_f32_16x16x32_bf16 v[20:23], a[152:155], v[176:179], v[20:23]
v_mfma_f32_16x16x32_bf16 v[20:23], a[156:159], v[180:183], v[20:23]
v_mfma_f32_16x16x32_bf16 v[24:27], a[128:131], v[184:187], 0
v_mfma_f32_16x16x32_bf16 v[24:27], a[132:135], v[188:191], v[24:27]
v_mfma_f32_16x16x32_bf16 v[24:27], a[136:139], v[192:195], v[24:27]
v_mfma_f32_16x16x32_bf16 v[24:27], a[140:143], v[196:199], v[24:27]
v_mfma_f32_16x16x32_bf16 v[28:31], a[144:147], v[184:187], 0
v_mfma_f32_16x16x32_bf16 v[28:31], a[148:151], v[188:191], v[28:31]
v_mfma_f32_16x16x32_bf16 v[28:31], a[152:155], v[192:195], v[28:31]
v_mfma_f32_16x16x32_bf16 v[28:31], a[156:159], v[196:199], v[28:31]
v_mfma_f32_16x16x32_bf16 v[32:35], a[128:131], v[200:203], 0
v_mfma_f32_16x16x32_bf16 v[32:35], a[132:135], v[204:207], v[32:35]
v_mfma_f32_16x16x32_bf16 v[32:35], a[136:139], v[208:211], v[32:35]
v_mfma_f32_16x16x32_bf16 v[32:35], a[140:143], v[212:215], v[32:35]
v_mfma_f32_16x16x32_bf16 v[36:39], a[144:147], v[200:203], 0
v_mfma_f32_16x16x32_bf16 v[36:39], a[148:151], v[204:207], v[36:39]
v_mfma_f32_16x16x32_bf16 v[36:39], a[152:155], v[208:211], v[36:39]
v_mfma_f32_16x16x32_bf16 v[36:39], a[156:159], v[212:215], v[36:39]
ds_read_b128 a[128:131], v216 offset:40960
ds_read_b128 a[132:135], v217 offset:40960
ds_read_b128 a[136:139], v218 offset:40960
ds_read_b128 a[140:143], v219 offset:40960
ds_read_b128 a[144:147], v216 offset:45056
ds_read_b128 a[148:151], v217 offset:45056
ds_read_b128 a[152:155], v218 offset:45056
ds_read_b128 a[156:159], v219 offset:45056
s_waitcnt lgkmcnt(0)
s_branch K_HAVEMAX
.section .rodata,"a"
.p2align 6
.amdhsa_kernel recurrent_scan__gqa_block_cached__moe_arch_mod__prompt_kernel
  .amdhsa_next_free_vgpr 512
  .amdhsa_next_free_sgpr 102
  .amdhsa_accum_offset 256
  .amdhsa_group_segment_fixed_size 0
  .amdhsa_kernarg_size 104
  .amdhsa_user_sgpr_count 2
  .amdhsa_user_sgpr_kernarg_segment_ptr 1
  .amdhsa_system_sgpr_workgroup_id_x 1
  .amdhsa_float_denorm_mode_32 3
.end_amdhsa_kernel
```

```asm
; @launch grid=(256,1,1) block=(256,1,1) lds=163840
.amdgcn_target "amdgcn-amd-amdhsa--gfx950"
.text
.globl recurrent_scan__gqa_block_cached__moe_arch_mod__prompt_kernel
.p2align 8
.type recurrent_scan__gqa_block_cached__moe_arch_mod__prompt_kernel,@function
recurrent_scan__gqa_block_cached__moe_arch_mod__prompt_kernel:
s_cmp_ge_u32 s2, 256
s_cbranch_scc1 K_END
s_getpc_b64 s[96:97]
v_lshlrev_b32 v7, 5, v0
global_load_dword a4, v7, s[96:97]
s_load_dwordx8 s[88:95], s[0:1], 0
s_load_dwordx2 s[86:87], s[0:1], 48
s_load_dwordx4 s[4:7], s[0:1], 88
v_and_b32 v1, 63, v0
v_lshrrev_b32 v5, 6, v0
s_bfe_u32 s35, s2, 0x20001
s_bfe_u32 s36, s2, 0x20003
v_readfirstlane_b32 s32, v5
s_lshl_b32 s33, s35, 2
s_add_u32 s33, s33, s36
s_and_b32 s34, s2, 1
s_lshl_b32 s34, s34, 3
s_lshr_b32 s46, s2, 5
s_add_u32 s34, s34, s46
s_lshl_b32 s46, s34, 7
s_lshl_b32 s47, s33, 3
s_add_u32 s3, s46, s47
v_lshrrev_b32 v8, 5, v0
v_add_u32 v8, s3, v8
v_and_b32 v9, 31, v0
v_mul_u32_u24 v11, 12, v9
v_mul_u32_u24 v10, 0x480, v8
v_add_u32 v10, v10, v11
v_lshrrev_b32 v5, 3, v1
v_and_b32 v6, 7, v1
v_xor_b32 v6, v6, v5
v_mul_u32_u24 v5, 0x480, v5
v_lshl_add_u32 v144, v6, 4, v5
v_add_u32 v145, 8192, v144
v_add_u32 v146, 18432, v144
v_add_u32 v147, 26624, v144
s_lshl_b32 s47, s32, 5
s_add_u32 s55, s46, s47
s_mul_i32 s43, s55, 1152
s_and_b32 s74, s34, 7
s_mul_i32 s74, s74, 1
s_mul_i32 s47, s36, 2
s_add_u32 s74, s74, s47
s_mul_i32 s47, s74, 57
s_lshr_b32 s47, s47, 9
s_mul_i32 s47, s47, 9
s_sub_u32 s74, s74, s47
s_movk_i32 s73, -1024
s_lshl_b32 s47, s74, 7
s_add_u32 s43, s43, s47
s_lshl_b32 s37, s32, 12
s_lshr_b32 s46, s35, 1
s_lshl_b32 s47, s46, 11
s_or_b32 s45, s37, s47
s_xor_b32 s85, s45, 2048
s_lshl_b32 s46, s46, 4
s_add_u32 s55, s55, s46
s_mov_b32 s26, 0x240000
s_mov_b32 s27, 0x00020000
s_waitcnt lgkmcnt(0)
s_mov_b32 s24, s88
s_and_b32 s25, s89, 0xffff
buffer_load_dwordx3 v[12:14], v10, s[24:27], 0 offen offset:0
buffer_load_dwordx3 v[16:18], v10, s[24:27], 0 offen offset:384
buffer_load_dwordx3 v[20:22], v10, s[24:27], 0 offen offset:768
s_mov_b32 s28, s86
s_and_b32 s29, s87, 0xffff
s_mov_b32 s30, 0x480
s_mov_b32 s31, 0x00020000
s_add_u32 m0, s45, 32768
s_nop 0
buffer_load_dwordx4 v144, s[24:27], s43 offen offset:0 lds
buffer_load_dwordx4 v145, s[24:27], s43 offen offset:1024 lds
s_add_u32 m0, s85, 32768
s_nop 0
buffer_load_dwordx4 v146, s[24:27], s43 offen offset:0 lds
buffer_load_dwordx4 v147, s[24:27], s43 offen offset:1024 lds
s_cmp_eq_u32 s74, 8
s_cselect_b32 s72, s73, 128
s_add_u32 s43, s43, s72
s_mov_b32 s16, s94
s_and_b32 s17, s95, 0xffff
s_mov_b32 s18, 0x480000
s_mov_b32 s19, 0x00020000
v_lshrrev_b32 v5, 5, v1
v_and_b32 v6, 31, v1
v_lshlrev_b32 v7, 1, v5
v_xor_b32 v6, v6, v7
v_lshlrev_b32 v6, 4, v6
v_lshl_add_u32 v136, v5, 13, v6
s_lshl_b32 s42, s33, 9
s_lshl_b32 s46, s32, 17
s_add_u32 s42, s42, s46
s_lshl_b32 s44, s32, 13
s_lshl_b32 s46, s74, 19
s_add_u32 s42, s42, s46
v_xor_b32 v137, 64, v136
v_add_u32 v137, 15360, v137
v_add_u32 v138, 30720, v136
v_xor_b32 v139, 64, v136
v_add_u32 v139, 46080, v139
v_xor_b32 v140, 128, v136
v_add_u32 v140, 65536, v140
v_xor_b32 v141, 192, v136
v_add_u32 v141, 80896, v141
v_xor_b32 v142, 128, v136
v_add_u32 v142, 96256, v142
v_xor_b32 v143, 192, v136
v_add_u32 v143, 111616, v143
s_add_u32 m0, s44, 0
s_nop 0
buffer_load_dwordx4 v136, s[16:19], s42 offen offset:0 lds
buffer_load_dwordx4 v137, s[16:19], s42 offen offset:1024 lds
buffer_load_dwordx4 v138, s[16:19], s42 offen offset:2048 lds
buffer_load_dwordx4 v139, s[16:19], s42 offen offset:3072 lds
s_add_u32 m0, s44, 4096
s_nop 0
buffer_load_dwordx4 v140, s[16:19], s42 offen offset:0 lds
buffer_load_dwordx4 v141, s[16:19], s42 offen offset:1024 lds
buffer_load_dwordx4 v142, s[16:19], s42 offen offset:2048 lds
buffer_load_dwordx4 v143, s[16:19], s42 offen offset:3072 lds
s_lshl_b32 s72, s72, 12
s_add_u32 s42, s42, s72
s_load_dwordx2 s[68:69], s[0:1], 32
s_load_dwordx4 s[56:59], s[0:1], 56
s_load_dwordx4 s[64:67], s[0:1], 72
s_mov_b32 s100, 0
v_and_b32 v3, 15, v1
v_lshrrev_b32 v4, 4, v1
v_lshlrev_b32 v234, 4, v1
v_mov_b32 v255, 1
s_lshl_b32 s46, s33, 19
s_add_u32 s8, s90, s46
s_addc_u32 s9, s91, 0
s_and_b32 s9, s9, 0xffff
s_mov_b32 s10, 0x80000
s_mov_b32 s11, 0x00020000
s_add_u32 s12, s92, s46
s_addc_u32 s13, s93, 0
s_and_b32 s13, s13, 0xffff
s_mov_b32 s14, 0x80000
s_mov_b32 s15, 0x00020000
s_mov_b32 s20, s6
s_and_b32 s21, s7, 0xffff
s_mov_b32 s22, 0x4000000
s_mov_b32 s23, 0x00020000
v_bfe_u32 v248, v1, 2, 2
v_and_b32 v249, 3, v1
v_and_b32 v5, 1, v4
v_lshl_add_u32 v5, v5, 2, v248
s_lshl_b32 s46, s32, 1
v_xor_b32 v5, s46, v5
v_lshlrev_b32 v5, 5, v5
v_lshl_add_u32 v6, v4, 3, v248
v_lshl_add_u32 v5, v6, 9, v5
v_lshl_add_u32 v184, v249, 3, v5
v_xor_b32 v185, 32, v184
v_xor_b32 v186, 64, v184
v_xor_b32 v187, 96, v184
v_xor_b32 v188, 128, v184
v_xor_b32 v189, 160, v184
v_xor_b32 v190, 192, v184
v_xor_b32 v191, 224, v184
v_and_b32 v5, 7, v3
v_xor_b32 v5, v5, v4
v_lshlrev_b32 v5, 4, v5
v_lshl_add_u32 v5, v3, 7, v5
v_add_u32 v5, s37, v5
v_add_u32 v192, 0x8000, v5
v_xor_b32 v193, 64, v192
v_add_u32 v194, 0x18000, v184
v_add_u32 v195, 0x18000, v185
v_add_u32 v196, 0x18000, v186
v_add_u32 v197, 0x18000, v187
v_add_u32 v198, 0x18000, v188
v_add_u32 v199, 0x18000, v189
v_add_u32 v200, 0x18000, v190
v_add_u32 v201, 0x18000, v191
v_add_u32 v202, 0x18000, v192
v_add_u32 v203, 0x18000, v193
v_add_u32 v204, 0xc000, v184
v_add_u32 v205, 0xc000, v185
v_add_u32 v206, 0xc000, v186
v_add_u32 v207, 0xc000, v187
v_add_u32 v208, 0xc000, v188
v_add_u32 v209, 0xc000, v189
v_add_u32 v210, 0xc000, v190
v_add_u32 v211, 0xc000, v191
v_add_u32 v212, 0xc000, v192
v_add_u32 v213, 0xc000, v193
v_lshrrev_b32 v5, 1, v4
v_and_b32 v6, 7, v3
v_xor_b32 v5, v5, v6
v_lshlrev_b32 v5, 4, v5
v_lshl_add_u32 v5, v3, 7, v5
v_and_b32 v6, 1, v4
v_lshl_add_u32 v241, v6, 3, v5
s_lshl_b32 s83, s36, 1
s_and_b32 s46, s35, 1
s_add_u32 s83, s83, s46
s_sub_u32 s83, s83, s74
s_cselect_b32 s46, 9, 0
s_add_u32 s83, s83, s46
s_add_u32 s46, s37, 0x8000
v_add_u32 v152, s46, v241
v_xor_b32 v153, 32, v152
v_xor_b32 v154, 64, v152
v_xor_b32 v155, 96, v152
s_lshl_b32 s46, s36, 5
v_xor_b32 v156, s46, v152
s_lshr_b32 s40, 0x100, s74
s_bitset1_b32 s40, s83
v_bfe_u32 v5, v1, 1, 1
v_bfe_u32 v6, v1, 5, 1
v_cmp_eq_u32 vcc, v5, v6
v_mov_b32 v7, 0x3f803f80
v_and_b32 v5, 1, v1
v_cndmask_b32 v7, 0, v7, vcc
v_accvgpr_write_b32 a208, v7
v_accvgpr_write_b32 a209, v7
v_accvgpr_write_b32 a210, v7
v_accvgpr_write_b32 a211, v7
v_mul_u32_u24 v5, 0xaaaa, v5
v_add_u32 v235, 0x4444, v5
v_accvgpr_write_b32 a248, 0
v_accvgpr_write_b32 a249, 0
v_accvgpr_write_b32 a250, 0
v_accvgpr_write_b32 a251, 0
v_accvgpr_write_b32 a252, 0
v_accvgpr_write_b32 a253, 0
v_accvgpr_write_b32 a254, 0
v_accvgpr_write_b32 a255, 0
s_lshl_b32 s46, s34, 2
s_add_u32 s47, s46, s35
s_lshl_b32 s47, s47, 2
s_add_u32 s47, s47, s32
s_lshl_b32 s54, s47, 7
s_add_u32 s54, s54, 0x250000
s_add_u32 s47, s46, s36
s_lshl_b32 s47, s47, 2
s_add_u32 s47, s47, s32
s_lshl_b32 s47, s47, 7
s_add_u32 s47, s47, s35
s_lshl_b32 s47, s47, 2
s_add_u32 s38, s47, 0x280000
s_add_u32 s46, s46, s32
s_lshl_b32 s46, s46, 5
s_add_u32 s46, s46, s33
s_lshl_b32 s46, s46, 2
s_add_u32 s39, s46, 0x260000
s_lshl_b32 s46, s36, 3
s_add_u32 s46, s46, s54
s_add_u32 s47, s46, 4
v_lshl_add_u32 v60, v1, 7, s38
v_mov_b32 v61, 0
v_writelane_b32 v60, s46, 4
v_writelane_b32 v60, s47, 5
v_writelane_b32 v60, s39, 6
s_lshl_b32 s46, s34, 2
s_add_u32 s46, s46, s35
s_lshl_b32 s46, s46, 3
s_add_u32 s46, s46, 0x270000
s_or_b32 s47, s36, s32
s_cselect_b32 s46, 0x7f000000, s46
v_writelane_b32 v60, s46, 7
s_add_u32 s46, s46, 4
v_writelane_b32 v60, s46, 8
s_lshl_b32 s47, s32, 8
s_or_b32 s47, s47, s2
s_lshl_b32 s46, s2, 7
s_add_u32 s46, s46, 0x272000
s_cmp_lt_u32 s47, 32
s_cselect_b32 s46, s46, 0x7f000000
v_writelane_b32 v60, s46, 9
buffer_load_dwordx3 v[24:26], v11, s[28:31], 0 offen offset:0
buffer_load_dwordx3 v[28:30], v11, s[28:31], 0 offen offset:384
buffer_load_dwordx3 v[32:34], v11, s[28:31], 0 offen offset:768
s_getpc_b64 s[96:97]
PC_a:
s_sub_u32 s96, s96, PC_a-recurrent_scan__gqa_block_cached__moe_arch_mod__prompt_kernel
s_subb_u32 s97, s97, 0
s_lshr_b32 s46, s2, 3
s_lshl_b32 s46, s46, 2
s_add_u32 s46, s46, s32
s_min_u32 s46, s46, (K_CODE_END-recurrent_scan__gqa_block_cached__moe_arch_mod__prompt_kernel)>>10
s_lshl_b32 s46, s46, 10
v_lshlrev_b32 v7, 4, v1
v_add_u32 v7, s46, v7
global_load_dwordx4 a[0:3], v7, s[96:97]
s_waitcnt lgkmcnt(0)
s_lshl_b32 s46, s32, 2
v_bfrev_b32 v5, v4
v_lshrrev_b32 v5, 30, v5
v_xor_b32 v5, s46, v5
v_xor_b32 v5, v5, v3
v_lshlrev_b32 v5, 4, v5
v_lshl_add_u32 v216, v3, 8, v5
v_xor_b32 v217, 64, v216
v_xor_b32 v218, 128, v216
v_xor_b32 v219, 192, v216
v_lshl_add_u32 v6, v4, 2, v248
v_and_b32 v5, 7, v6
v_lshlrev_b32 v5, 5, v5
v_lshl_add_u32 v5, v6, 8, v5
v_lshl_add_u32 v5, v249, 3, v5
v_add_u32 v220, 0x10000, v5
v_xor_b32 v221, 32, v220
v_xor_b32 v222, 64, v220
v_xor_b32 v223, 96, v220
v_xor_b32 v224, 128, v220
v_xor_b32 v225, 160, v220
v_xor_b32 v226, 192, v220
v_xor_b32 v227, 224, v220
v_xor_b32 v5, v4, v3
v_lshlrev_b32 v5, 4, v5
v_lshl_add_u32 v5, v4, 8, v5
v_add_u32 v228, s37, v5
v_xor_b32 v229, 64, v228
v_xor_b32 v230, 128, v228
v_xor_b32 v231, 192, v228
v_lshlrev_b32 v5, 1, v4
v_xor_b32 v5, v5, v3
v_lshlrev_b32 v5, 4, v5
v_lshl_add_u32 v5, v4, 8, v5
v_add_u32 v232, s37, v5
v_xor_b32 v233, 128, v232
s_mov_b32 s41, 0
s_lshl_b32 s49, s32, 13
s_add_u32 s49, s49, 131072
s_lshl_b32 s3, s32, 10
s_lshl_b32 s53, s34, 4
s_add_u32 s53, s53, s33
s_lshl_b32 s53, s53, 2
s_add_u32 s53, s53, s32
s_lshl_b32 s53, s53, 14
s_add_u32 s53, s53, 0x400000
v_add_u32 v5, s46, v4
v_and_b32 v6, 7, v5
v_lshlrev_b32 v6, 1, v6
v_xor_b32 v6, v6, v3
v_mul_u32_u24 v5, 0x480, v5
v_lshl_add_u32 v236, v6, 4, v5
v_lshrrev_b32 v5, 3, v0
v_and_b32 v6, 6, v5
v_and_b32 v7, 7, v1
v_xor_b32 v6, v6, v7
v_mul_u32_u24 v5, 0x480, v5
v_lshl_add_u32 v237, v6, 4, v5
v_lshrrev_b32 v5, 2, v1
v_mul_u32_u24 v5, 0x2400, v5
v_lshl_add_u32 v238, v249, 4, v5
s_lshl_b32 s47, s36, 8
s_mul_i32 s84, s35, 1179648
s_add_u32 s84, s84, s47
s_mul_i32 s75, s33, 294912
s_add_u32 s51, s75, s47
s_add_u32 s75, s75, 1024
s_mov_b64 s[86:87], s[68:69]
s_mov_b64 s[88:89], s[56:57]
s_mov_b64 s[90:91], s[58:59]
s_mov_b32 s68, s66
s_and_b32 s69, s67, 0xffff
s_mov_b32 s70, 0x240000
s_mov_b32 s71, 0x00020000
s_mov_b32 s64, s64
s_and_b32 s65, s65, 0xffff
s_mov_b32 s66, 0x510000
s_mov_b32 s67, 0x00020000
s_mov_b32 s56, s88
s_and_b32 s57, s89, 0xffff
s_mov_b32 s58, 0x510000
s_mov_b32 s59, 0x00020000
s_mov_b32 s60, s90
s_and_b32 s61, s91, 0xffff
s_mov_b32 s62, 0x510000
s_mov_b32 s63, 0x00020000
s_mov_b32 s52, 0
s_and_b32 s82, s35, 1
s_lshl_b32 s82, s82, 7
s_mul_i32 s80, s55, 1152
s_lshl_b32 s46, s36, 5
s_add_u32 s81, s80, s46
s_add_u32 s81, s81, 1024
s_add_u32 s80, s80, s47
s_add_u32 s80, s80, s82
s_bitcmp1_b32 s35, 0
s_cselect_b32 s81, 0x7f000000, s81
v_mov_b32 v239, v144
v_mul_u32_u24 v5, 0x480, v3
v_lshl_add_u32 v240, v4, 3, v5
v_min_u32 v243, 35, v1
v_lshlrev_b32 v243, 7, v243
v_lshlrev_b32 v251, 3, v1
v_accvgpr_write_b32 a16, 0
v_accvgpr_write_b32 a17, 0
v_accvgpr_write_b32 a18, 0
v_accvgpr_write_b32 a19, 0
v_accvgpr_write_b32 a20, 0
v_accvgpr_write_b32 a21, 0
v_accvgpr_write_b32 a22, 0
v_accvgpr_write_b32 a23, 0
v_accvgpr_write_b32 a24, 0
v_accvgpr_write_b32 a25, 0
v_accvgpr_write_b32 a26, 0
v_accvgpr_write_b32 a27, 0
v_accvgpr_write_b32 a28, 0
v_accvgpr_write_b32 a29, 0
v_accvgpr_write_b32 a30, 0
v_accvgpr_write_b32 a31, 0
v_accvgpr_write_b32 a32, 0
v_accvgpr_write_b32 a33, 0
v_accvgpr_write_b32 a34, 0
v_accvgpr_write_b32 a35, 0
v_accvgpr_write_b32 a36, 0
v_accvgpr_write_b32 a37, 0
v_accvgpr_write_b32 a38, 0
v_accvgpr_write_b32 a39, 0
v_accvgpr_write_b32 a40, 0
v_accvgpr_write_b32 a41, 0
v_accvgpr_write_b32 a42, 0
v_accvgpr_write_b32 a43, 0
v_accvgpr_write_b32 a44, 0
v_accvgpr_write_b32 a45, 0
v_accvgpr_write_b32 a46, 0
v_accvgpr_write_b32 a47, 0
v_accvgpr_write_b32 a48, 0
v_accvgpr_write_b32 a49, 0
v_accvgpr_write_b32 a50, 0
v_accvgpr_write_b32 a51, 0
v_accvgpr_write_b32 a52, 0
v_accvgpr_write_b32 a53, 0
v_accvgpr_write_b32 a54, 0
v_accvgpr_write_b32 a55, 0
v_accvgpr_write_b32 a56, 0
v_accvgpr_write_b32 a57, 0
v_accvgpr_write_b32 a58, 0
v_accvgpr_write_b32 a59, 0
v_accvgpr_write_b32 a60, 0
v_accvgpr_write_b32 a61, 0
v_accvgpr_write_b32 a62, 0
v_accvgpr_write_b32 a63, 0
v_accvgpr_write_b32 a64, 0
v_accvgpr_write_b32 a65, 0
v_accvgpr_write_b32 a66, 0
v_accvgpr_write_b32 a67, 0
v_accvgpr_write_b32 a68, 0
v_accvgpr_write_b32 a69, 0
v_accvgpr_write_b32 a70, 0
v_accvgpr_write_b32 a71, 0
v_accvgpr_write_b32 a72, 0
v_accvgpr_write_b32 a73, 0
v_accvgpr_write_b32 a74, 0
v_accvgpr_write_b32 a75, 0
v_accvgpr_write_b32 a76, 0
v_accvgpr_write_b32 a77, 0
v_accvgpr_write_b32 a78, 0
v_accvgpr_write_b32 a79, 0
v_accvgpr_write_b32 a80, 0
v_accvgpr_write_b32 a81, 0
v_accvgpr_write_b32 a82, 0
v_accvgpr_write_b32 a83, 0
v_accvgpr_write_b32 a84, 0
v_accvgpr_write_b32 a85, 0
v_accvgpr_write_b32 a86, 0
v_accvgpr_write_b32 a87, 0
v_accvgpr_write_b32 a88, 0
v_accvgpr_write_b32 a89, 0
v_accvgpr_write_b32 a90, 0
v_accvgpr_write_b32 a91, 0
v_accvgpr_write_b32 a92, 0
v_accvgpr_write_b32 a93, 0
v_accvgpr_write_b32 a94, 0
v_accvgpr_write_b32 a95, 0
v_accvgpr_write_b32 a96, 0
v_accvgpr_write_b32 a97, 0
v_accvgpr_write_b32 a98, 0
v_accvgpr_write_b32 a99, 0
v_accvgpr_write_b32 a100, 0
v_accvgpr_write_b32 a101, 0
v_accvgpr_write_b32 a102, 0
v_accvgpr_write_b32 a103, 0
v_accvgpr_write_b32 a104, 0
v_accvgpr_write_b32 a105, 0
v_accvgpr_write_b32 a106, 0
v_accvgpr_write_b32 a107, 0
v_accvgpr_write_b32 a108, 0
v_accvgpr_write_b32 a109, 0
v_accvgpr_write_b32 a110, 0
v_accvgpr_write_b32 a111, 0
v_accvgpr_write_b32 a112, 0
v_accvgpr_write_b32 a113, 0
v_accvgpr_write_b32 a114, 0
v_accvgpr_write_b32 a115, 0
v_accvgpr_write_b32 a116, 0
v_accvgpr_write_b32 a117, 0
v_accvgpr_write_b32 a118, 0
v_accvgpr_write_b32 a119, 0
v_accvgpr_write_b32 a120, 0
v_accvgpr_write_b32 a121, 0
v_accvgpr_write_b32 a122, 0
v_accvgpr_write_b32 a123, 0
v_accvgpr_write_b32 a124, 0
v_accvgpr_write_b32 a125, 0
v_accvgpr_write_b32 a126, 0
v_accvgpr_write_b32 a127, 0
s_mov_b32 s92, 0x3ae38e39
s_mov_b32 s93, 0x3727c5ac
s_mov_b32 s94, 0xffff0000
v_and_b32 v5, 3, v1
v_lshlrev_b32 v5, 21, v5
buffer_load_dword a7, v61, s[8:11], 0 offen
buffer_load_dword a8, v61, s[12:15], 0 offen
buffer_load_dword a9, v5, s[16:19], 0 offen
s_mov_b64 exec, 0x3ff
buffer_store_dword v61, v60, s[20:23], 0 offen sc0 sc1
s_mov_b64 exec, -1
s_waitcnt vmcnt(20)
v_lshlrev_b32 v40, 16, v12
v_and_b32 v41, s94, v12
v_lshlrev_b32 v42, 16, v13
v_and_b32 v43, s94, v13
v_lshlrev_b32 v44, 16, v14
v_and_b32 v45, s94, v14
v_lshlrev_b32 v46, 16, v16
v_and_b32 v47, s94, v16
v_lshlrev_b32 v48, 16, v17
v_and_b32 v49, s94, v17
v_lshlrev_b32 v50, 16, v18
v_and_b32 v51, s94, v18
s_add_u32 m0, s45, 131072
v_lshlrev_b32 v52, 16, v20
buffer_load_dwordx4 v144, s[24:27], s43 offen offset:0 lds
v_and_b32 v53, s94, v20
v_lshlrev_b32 v54, 16, v21
v_and_b32 v55, s94, v21
v_lshlrev_b32 v56, 16, v22
v_and_b32 v57, s94, v22
v_pk_add_f32 v[64:65], v[40:41], v[42:43]
v_pk_add_f32 v[66:67], v[44:45], v[46:47]
v_pk_add_f32 v[64:65], v[64:65], v[48:49]
v_pk_add_f32 v[66:67], v[66:67], v[50:51]
v_pk_add_f32 v[64:65], v[64:65], v[52:53]
v_pk_add_f32 v[66:67], v[66:67], v[54:55]
v_pk_add_f32 v[64:65], v[64:65], v[56:57]
buffer_load_dwordx4 v145, s[24:27], s43 offen offset:1024 lds
v_pk_add_f32 v[64:65], v[64:65], v[66:67]
v_add_f32 v64, v64, v65
s_nop 1
v_add_f32_dpp v65, v64, v64 row_ror:8 row_mask:0xf bank_mask:0xf
s_nop 1
v_add_f32_dpp v64, v65, v65 row_ror:4 row_mask:0xf bank_mask:0xf
s_nop 1
v_add_f32_dpp v65, v64, v64 row_ror:2 row_mask:0xf bank_mask:0xf
s_nop 1
v_add_f32_dpp v64, v65, v65 row_ror:1 row_mask:0xf bank_mask:0xf
v_mov_b32 v65, v64
s_nop 1
v_permlane16_swap_b32 v64, v65
v_add_f32 v64, v64, v65
v_mul_f32 v64, s92, v64
v_pk_add_f32 v[72:73], v[40:41], v[64:65] op_sel_hi:[1,0] neg_lo:[0,1] neg_hi:[0,1]
s_add_u32 m0, s85, 131072
v_pk_add_f32 v[74:75], v[42:43], v[64:65] op_sel_hi:[1,0] neg_lo:[0,1] neg_hi:[0,1]
buffer_load_dwordx4 v146, s[24:27], s43 offen offset:0 lds
v_pk_add_f32 v[76:77], v[44:45], v[64:65] op_sel_hi:[1,0] neg_lo:[0,1] neg_hi:[0,1]
v_pk_add_f32 v[78:79], v[46:47], v[64:65] op_sel_hi:[1,0] neg_lo:[0,1] neg_hi:[0,1]
v_pk_add_f32 v[80:81], v[48:49], v[64:65] op_sel_hi:[1,0] neg_lo:[0,1] neg_hi:[0,1]
v_pk_add_f32 v[82:83], v[50:51], v[64:65] op_sel_hi:[1,0] neg_lo:[0,1] neg_hi:[0,1]
v_pk_add_f32 v[84:85], v[52:53], v[64:65] op_sel_hi:[1,0] neg_lo:[0,1] neg_hi:[0,1]
v_pk_add_f32 v[86:87], v[54:55], v[64:65] op_sel_hi:[1,0] neg_lo:[0,1] neg_hi:[0,1]
v_pk_add_f32 v[88:89], v[56:57], v[64:65] op_sel_hi:[1,0] neg_lo:[0,1] neg_hi:[0,1]
v_pk_mul_f32 v[66:67], v[72:73], v[72:73]
v_pk_mul_f32 v[68:69], v[74:75], v[74:75]
v_pk_fma_f32 v[66:67], v[76:77], v[76:77], v[66:67]
v_pk_fma_f32 v[68:69], v[78:79], v[78:79], v[68:69]
v_pk_fma_f32 v[66:67], v[80:81], v[80:81], v[66:67]
buffer_load_dwordx4 v147, s[24:27], s43 offen offset:1024 lds
v_pk_fma_f32 v[68:69], v[82:83], v[82:83], v[68:69]
v_pk_fma_f32 v[66:67], v[84:85], v[84:85], v[66:67]
v_pk_fma_f32 v[68:69], v[86:87], v[86:87], v[68:69]
v_pk_fma_f32 v[66:67], v[88:89], v[88:89], v[66:67]
v_pk_add_f32 v[66:67], v[66:67], v[68:69]
v_add_f32 v69, v66, v67
v_cvt_pk_bf16_f32 v64, v64, v64
v_lshlrev_b32 v64, 16, v64
v_pk_add_f32 v[40:41], v[40:41], v[64:65] op_sel_hi:[1,0] neg_lo:[0,1] neg_hi:[0,1]
v_cvt_pk_bf16_f32 v12, v40, v41
v_add_f32_dpp v68, v69, v69 row_ror:8 row_mask:0xf bank_mask:0xf
s_cmp_eq_u32 s74, 7
s_cselect_b32 s72, s73, 128
s_add_u32 s43, s43, s72
s_add_u32 m0, s44, 98304
v_pk_add_f32 v[42:43], v[42:43], v[64:65] op_sel_hi:[1,0] neg_lo:[0,1] neg_hi:[0,1]
buffer_load_dwordx4 v136, s[16:19], s42 offen offset:0 lds
v_cvt_pk_bf16_f32 v13, v42, v43
v_add_f32_dpp v69, v68, v68 row_ror:4 row_mask:0xf bank_mask:0xf
v_pk_add_f32 v[44:45], v[44:45], v[64:65] op_sel_hi:[1,0] neg_lo:[0,1] neg_hi:[0,1]
v_cvt_pk_bf16_f32 v14, v44, v45
v_add_f32_dpp v68, v69, v69 row_ror:2 row_mask:0xf bank_mask:0xf
v_pk_add_f32 v[46:47], v[46:47], v[64:65] op_sel_hi:[1,0] neg_lo:[0,1] neg_hi:[0,1]
v_cvt_pk_bf16_f32 v16, v46, v47
v_add_f32_dpp v69, v68, v68 row_ror:1 row_mask:0xf bank_mask:0xf
v_mov_b32 v68, v69
v_pk_add_f32 v[48:49], v[48:49], v[64:65] op_sel_hi:[1,0] neg_lo:[0,1] neg_hi:[0,1]
v_cvt_pk_bf16_f32 v17, v48, v49
v_permlane16_swap_b32 v69, v68
buffer_load_dwordx4 v137, s[16:19], s42 offen offset:1024 lds
v_add_f32 v69, v69, v68
v_mul_f32 v69, s92, v69
v_cvt_pk_bf16_f32 v69, v69, v69
v_lshlrev_b32 v69, 16, v69
v_add_f32 v69, s93, v69
v_cvt_pk_bf16_f32 v69, v69, v69
v_lshlrev_b32 v69, 16, v69
v_sqrt_f32 v69, v69
v_pk_add_f32 v[50:51], v[50:51], v[64:65] op_sel_hi:[1,0] neg_lo:[0,1] neg_hi:[0,1]
v_cvt_pk_bf16_f32 v18, v50, v51
v_cvt_pk_bf16_f32 v65, v69, v69
v_lshlrev_b32 v65, 16, v65
buffer_load_dwordx4 v138, s[16:19], s42 offen offset:2048 lds
v_rcp_f32 v66, v65
v_pk_add_f32 v[52:53], v[52:53], v[64:65] op_sel_hi:[1,0] neg_lo:[0,1] neg_hi:[0,1]
v_cvt_pk_bf16_f32 v20, v52, v53
v_pk_add_f32 v[54:55], v[54:55], v[64:65] op_sel_hi:[1,0] neg_lo:[0,1] neg_hi:[0,1]
v_cvt_pk_bf16_f32 v21, v54, v55
v_pk_add_f32 v[56:57], v[56:57], v[64:65] op_sel_hi:[1,0] neg_lo:[0,1] neg_hi:[0,1]
v_cvt_pk_bf16_f32 v22, v56, v57
v_lshlrev_b32 v40, 16, v12
v_and_b32 v41, s94, v12
v_lshlrev_b32 v42, 16, v13
v_and_b32 v43, s94, v13
v_lshlrev_b32 v44, 16, v14
buffer_load_dwordx4 v139, s[16:19], s42 offen offset:3072 lds
v_and_b32 v45, s94, v14
v_lshlrev_b32 v46, 16, v16
v_and_b32 v47, s94, v16
v_lshlrev_b32 v48, 16, v17
v_and_b32 v49, s94, v17
v_lshlrev_b32 v50, 16, v18
v_and_b32 v51, s94, v18
v_lshlrev_b32 v52, 16, v20
v_and_b32 v53, s94, v20
v_lshlrev_b32 v54, 16, v21
v_and_b32 v55, s94, v21
s_add_u32 m0, s44, 102400
v_lshlrev_b32 v56, 16, v22
buffer_load_dwordx4 v140, s[16:19], s42 offen offset:0 lds
v_and_b32 v57, s94, v22
v_lshlrev_b32 v5, 3, v8
s_mov_b32 s46, 0x240000
s_mov_b32 exec_lo, 1
s_mov_b32 exec_hi, 1
buffer_store_dwordx2 v[64:65], v5, s[20:23], s46 offen sc0 sc1
s_mov_b64 exec, -1
v_mov_b32 v70, 0
s_waitcnt lgkmcnt(0)
v_pk_mul_f32 v[72:73], v[40:41], v[66:67] op_sel_hi:[1,0]
v_pk_fma_f32 v[40:41], v[72:73], v[64:65], v[40:41] op_sel:[0,1,0] op_sel_hi:[1,1,1] neg_lo:[1,0,0] neg_hi:[1,0,0]
v_pk_fma_f32 v[72:73], v[40:41], v[66:67], v[72:73] op_sel_hi:[1,0,1]
v_cvt_pk_bf16_f32 v12, v72, v73
v_pk_mul_f32 v[74:75], v[42:43], v[66:67] op_sel_hi:[1,0]
v_pk_fma_f32 v[42:43], v[74:75], v[64:65], v[42:43] op_sel:[0,1,0] op_sel_hi:[1,1,1] neg_lo:[1,0,0] neg_hi:[1,0,0]
v_pk_fma_f32 v[74:75], v[42:43], v[66:67], v[74:75] op_sel_hi:[1,0,1]
v_cvt_pk_bf16_f32 v13, v74, v75
v_pk_mul_f32 v[76:77], v[44:45], v[66:67] op_sel_hi:[1,0]
buffer_load_dwordx4 v141, s[16:19], s42 offen offset:1024 lds
v_pk_fma_f32 v[44:45], v[76:77], v[64:65], v[44:45] op_sel:[0,1,0] op_sel_hi:[1,1,1] neg_lo:[1,0,0] neg_hi:[1,0,0]
v_pk_fma_f32 v[76:77], v[44:45], v[66:67], v[76:77] op_sel_hi:[1,0,1]
v_cvt_pk_bf16_f32 v14, v76, v77
buffer_store_dwordx3 v[12:14], v10, s[20:23], 0 offen offset:0 sc0 sc1
v_pk_mul_f32 v[78:79], v[46:47], v[66:67] op_sel_hi:[1,0]
v_pk_fma_f32 v[46:47], v[78:79], v[64:65], v[46:47] op_sel:[0,1,0] op_sel_hi:[1,1,1] neg_lo:[1,0,0] neg_hi:[1,0,0]
v_pk_fma_f32 v[78:79], v[46:47], v[66:67], v[78:79] op_sel_hi:[1,0,1]
v_cvt_pk_bf16_f32 v16, v78, v79
v_pk_mul_f32 v[80:81], v[48:49], v[66:67] op_sel_hi:[1,0]
v_pk_fma_f32 v[48:49], v[80:81], v[64:65], v[48:49] op_sel:[0,1,0] op_sel_hi:[1,1,1] neg_lo:[1,0,0] neg_hi:[1,0,0]
v_pk_fma_f32 v[80:81], v[48:49], v[66:67], v[80:81] op_sel_hi:[1,0,1]
v_cvt_pk_bf16_f32 v17, v80, v81
v_pk_mul_f32 v[82:83], v[50:51], v[66:67] op_sel_hi:[1,0]
buffer_load_dwordx4 v142, s[16:19], s42 offen offset:2048 lds
v_pk_fma_f32 v[50:51], v[82:83], v[64:65], v[50:51] op_sel:[0,1,0] op_sel_hi:[1,1,1] neg_lo:[1,0,0] neg_hi:[1,0,0]
v_pk_fma_f32 v[82:83], v[50:51], v[66:67], v[82:83] op_sel_hi:[1,0,1]
v_cvt_pk_bf16_f32 v18, v82, v83
buffer_store_dwordx3 v[16:18], v10, s[20:23], 0 offen offset:384 sc0 sc1
v_pk_mul_f32 v[84:85], v[52:53], v[66:67] op_sel_hi:[1,0]
v_pk_fma_f32 v[52:53], v[84:85], v[64:65], v[52:53] op_sel:[0,1,0] op_sel_hi:[1,1,1] neg_lo:[1,0,0] neg_hi:[1,0,0]
v_pk_fma_f32 v[84:85], v[52:53], v[66:67], v[84:85] op_sel_hi:[1,0,1]
v_cvt_pk_bf16_f32 v20, v84, v85
v_pk_mul_f32 v[86:87], v[54:55], v[66:67] op_sel_hi:[1,0]
v_pk_fma_f32 v[54:55], v[86:87], v[64:65], v[54:55] op_sel:[0,1,0] op_sel_hi:[1,1,1] neg_lo:[1,0,0] neg_hi:[1,0,0]
v_pk_fma_f32 v[86:87], v[54:55], v[66:67], v[86:87] op_sel_hi:[1,0,1]
v_cvt_pk_bf16_f32 v21, v86, v87
v_pk_mul_f32 v[88:89], v[56:57], v[66:67] op_sel_hi:[1,0]
buffer_load_dwordx4 v143, s[16:19], s42 offen offset:3072 lds
s_lshl_b32 s72, s72, 12
s_add_u32 s42, s42, s72
v_pk_fma_f32 v[56:57], v[88:89], v[64:65], v[56:57] op_sel:[0,1,0] op_sel_hi:[1,1,1] neg_lo:[1,0,0] neg_hi:[1,0,0]
v_pk_fma_f32 v[88:89], v[56:57], v[66:67], v[88:89] op_sel_hi:[1,0,1]
v_cvt_pk_bf16_f32 v22, v88, v89
buffer_store_dwordx3 v[20:22], v10, s[20:23], 0 offen offset:768 sc0 sc1
s_waitcnt vmcnt(21)
v_dot2_f32_bf16 v70, v12, v24, v70
v_dot2_f32_bf16 v70, v13, v25, v70
v_dot2_f32_bf16 v70, v14, v26, v70
v_dot2_f32_bf16 v70, v16, v28, v70
v_dot2_f32_bf16 v70, v17, v29, v70
v_dot2_f32_bf16 v70, v18, v30, v70
v_dot2_f32_bf16 v70, v20, v32, v70
v_dot2_f32_bf16 v70, v21, v33, v70
v_dot2_f32_bf16 v70, v22, v34, v70
v_sub_u32 v68, 2047, v8
v_lshlrev_b32 v5, 2, v8
s_nop 1
v_add_f32_dpp v71, v70, v70 row_ror:8 row_mask:0xf bank_mask:0xf
s_nop 1
v_add_f32_dpp v70, v71, v71 row_ror:4 row_mask:0xf bank_mask:0xf
s_nop 1
v_add_f32_dpp v71, v70, v70 row_ror:2 row_mask:0xf bank_mask:0xf
s_nop 1
v_add_f32_dpp v70, v71, v71 row_ror:1 row_mask:0xf bank_mask:0xf
v_mov_b32 v71, v70
s_nop 1
v_permlane16_swap_b32 v70, v71
v_add_f32 v70, v70, v71
v_cvt_pk_bf16_f32 v70, v70, v70
v_ashrrev_i32 v71, 31, v70
v_or_b32 v71, 0x80000000, v71
v_xor_b32 v70, v70, v71
v_and_or_b32 v214, v70, s94, v68
s_mov_b32 s46, 0x244000
s_mov_b32 exec_lo, 1
s_mov_b32 exec_hi, 1
buffer_store_dword v214, v5, s[20:23], s46 offen sc0 sc1
s_mov_b64 exec, -1
s_mov_b32 s28, s4
s_and_b32 s29, s5, 0xffff
s_mov_b32 s30, 0x100
s_mov_b32 s31, 0x00020000
s_waitcnt vmcnt(25)
s_barrier
ds_read_b128 a[192:195], v192 offset:0
ds_read_b128 a[196:199], v192 offset:2048
ds_read_b64_tr_b16 a[128:129], v184 offset:0
ds_read_b64_tr_b16 a[130:131], v184 offset:2048
ds_read_b64_tr_b16 a[132:133], v185 offset:0
ds_read_b64_tr_b16 a[134:135], v185 offset:2048
ds_read_b64_tr_b16 a[160:161], v184 offset:256
ds_read_b64_tr_b16 a[162:163], v184 offset:2304
ds_read_b64_tr_b16 a[164:165], v185 offset:256
ds_read_b64_tr_b16 a[166:167], v185 offset:2304
ds_read_b64_tr_b16 a[136:137], v186 offset:0
ds_read_b64_tr_b16 a[138:139], v186 offset:2048
ds_read_b64_tr_b16 a[140:141], v187 offset:0
ds_read_b64_tr_b16 a[142:143], v187 offset:2048
ds_read_b64_tr_b16 a[144:145], v188 offset:0
ds_read_b64_tr_b16 a[146:147], v188 offset:2048
ds_read_b64_tr_b16 a[148:149], v189 offset:0
ds_read_b64_tr_b16 a[150:151], v189 offset:2048
ds_read_b64_tr_b16 a[152:153], v190 offset:0
ds_read_b64_tr_b16 a[154:155], v190 offset:2048
ds_read_b64_tr_b16 a[156:157], v191 offset:0
ds_read_b64_tr_b16 a[158:159], v191 offset:2048
ds_read_b64_tr_b16 a[168:169], v186 offset:256
ds_read_b64_tr_b16 a[170:171], v186 offset:2304
ds_read_b64_tr_b16 a[172:173], v187 offset:256
ds_read_b64_tr_b16 a[174:175], v187 offset:2304
ds_read_b64_tr_b16 a[176:177], v188 offset:256
ds_read_b64_tr_b16 a[178:179], v188 offset:2304
ds_read_b64_tr_b16 a[180:181], v189 offset:256
ds_read_b64_tr_b16 a[182:183], v189 offset:2304
ds_read_b64_tr_b16 a[184:185], v190 offset:256
ds_read_b64_tr_b16 a[186:187], v190 offset:2304
ds_read_b64_tr_b16 a[188:189], v191 offset:256
ds_read_b64_tr_b16 a[190:191], v191 offset:2304
s_bitcmp1_b32 s40, 0
s_cbranch_scc1 K_XP0
K_XP0D:
s_waitcnt lgkmcnt(15)
v_mfma_f32_16x16x32_bf16 v[8:11], a[128:131], a[192:195], 0
ds_read_b128 a[200:203], v193 offset:0
ds_read_b128 a[204:207], v193 offset:2048
v_mfma_f32_16x16x32_bf16 v[40:43], a[128:131], a[196:199], 0
s_add_u32 m0, s45, 81920
v_mfma_f32_16x16x32_bf16 v[12:15], a[132:135], a[192:195], 0
buffer_load_dwordx4 v144, s[24:27], s43 offen offset:0 lds
v_mfma_f32_16x16x32_bf16 v[44:47], a[132:135], a[196:199], 0
v_smfmac_f32_16x16x64_bf16 a[248:251], a[208:211], a[128:135], v235
ds_read_b64_tr_b16 a[128:129], v184 offset:16384
ds_read_b64_tr_b16 a[130:131], v184 offset:18432
v_mfma_f32_16x16x32_bf16 v[72:75], a[160:163], a[192:195], 0
ds_read_b64_tr_b16 a[132:133], v185 offset:16384
ds_read_b64_tr_b16 a[134:135], v185 offset:18432
v_mfma_f32_16x16x32_bf16 v[104:107], a[160:163], a[196:199], 0
buffer_load_dwordx4 v145, s[24:27], s43 offen offset:1024 lds
v_mfma_f32_16x16x32_bf16 v[76:79], a[164:167], a[192:195], 0
v_mfma_f32_16x16x32_bf16 v[108:111], a[164:167], a[196:199], 0
v_smfmac_f32_16x16x64_bf16 a[252:255], a[208:211], a[160:167], v235
s_add_u32 m0, s85, 81920
ds_read_b64_tr_b16 a[160:161], v184 offset:16640
ds_read_b64_tr_b16 a[162:163], v184 offset:18688
v_mfma_f32_16x16x32_bf16 v[16:19], a[136:139], a[192:195], 0
buffer_load_dwordx4 v146, s[24:27], s43 offen offset:0 lds
v_mfma_f32_16x16x32_bf16 v[48:51], a[136:139], a[196:199], 0
ds_read_b64_tr_b16 a[164:165], v185 offset:16640
ds_read_b64_tr_b16 a[166:167], v185 offset:18688
v_mfma_f32_16x16x32_bf16 v[20:23], a[140:143], a[192:195], 0
ds_read_b64_tr_b16 a[136:137], v186 offset:16384
ds_read_b64_tr_b16 a[138:139], v186 offset:18432
v_mfma_f32_16x16x32_bf16 v[52:55], a[140:143], a[196:199], 0
ds_read_b64_tr_b16 a[140:141], v187 offset:16384
ds_read_b64_tr_b16 a[142:143], v187 offset:18432
v_mfma_f32_16x16x32_bf16 v[24:27], a[144:147], a[192:195], 0
buffer_load_dwordx4 v147, s[24:27], s43 offen offset:1024 lds
v_mfma_f32_16x16x32_bf16 v[56:59], a[144:147], a[196:199], 0
s_cmp_eq_u32 s74, 6
s_cselect_b32 s72, s73, 128
ds_read_b64_tr_b16 a[144:145], v188 offset:16384
ds_read_b64_tr_b16 a[146:147], v188 offset:18432
v_mfma_f32_16x16x32_bf16 v[28:31], a[148:151], a[192:195], 0
s_add_u32 s43, s43, s72
v_mfma_f32_16x16x32_bf16 v[60:63], a[148:151], a[196:199], 0
s_waitcnt lgkmcnt(10)
s_add_u32 m0, s44, 49152
ds_read_b64_tr_b16 a[148:149], v189 offset:16384
ds_read_b64_tr_b16 a[150:151], v189 offset:18432
v_mfma_f32_16x16x32_bf16 v[32:35], a[152:155], a[192:195], 0
buffer_load_dwordx4 v136, s[16:19], s42 offen offset:0 lds
v_mfma_f32_16x16x32_bf16 v[64:67], a[152:155], a[196:199], 0
ds_read_b64_tr_b16 a[152:153], v190 offset:16384
ds_read_b64_tr_b16 a[154:155], v190 offset:18432
v_mfma_f32_16x16x32_bf16 v[36:39], a[156:159], a[192:195], 0
v_mfma_f32_16x16x32_bf16 v[68:71], a[156:159], a[196:199], 0
ds_read_b64_tr_b16 a[156:157], v191 offset:16384
ds_read_b64_tr_b16 a[158:159], v191 offset:18432
v_mfma_f32_16x16x32_bf16 v[80:83], a[168:171], a[192:195], 0
v_mfma_f32_16x16x32_bf16 v[112:115], a[168:171], a[196:199], 0
buffer_load_dwordx4 v137, s[16:19], s42 offen offset:1024 lds
v_mfma_f32_16x16x32_bf16 v[84:87], a[172:175], a[192:195], 0
ds_read_b64_tr_b16 a[168:169], v186 offset:16640
ds_read_b64_tr_b16 a[170:171], v186 offset:18688
v_mfma_f32_16x16x32_bf16 v[116:119], a[172:175], a[196:199], 0
ds_read_b64_tr_b16 a[172:173], v187 offset:16640
ds_read_b64_tr_b16 a[174:175], v187 offset:18688
v_mfma_f32_16x16x32_bf16 v[88:91], a[176:179], a[192:195], 0
v_mfma_f32_16x16x32_bf16 v[120:123], a[176:179], a[196:199], 0
buffer_load_dwordx4 v138, s[16:19], s42 offen offset:2048 lds
v_mfma_f32_16x16x32_bf16 v[92:95], a[180:183], a[192:195], 0
ds_read_b64_tr_b16 a[176:177], v188 offset:16640
ds_read_b64_tr_b16 a[178:179], v188 offset:18688
v_mfma_f32_16x16x32_bf16 v[124:127], a[180:183], a[196:199], 0
ds_read_b64_tr_b16 a[180:181], v189 offset:16640
ds_read_b64_tr_b16 a[182:183], v189 offset:18688
v_mfma_f32_16x16x32_bf16 v[96:99], a[184:187], a[192:195], 0
v_mfma_f32_16x16x32_bf16 v[128:131], a[184:187], a[196:199], 0
buffer_load_dwordx4 v139, s[16:19], s42 offen offset:3072 lds
v_mfma_f32_16x16x32_bf16 v[100:103], a[188:191], a[192:195], 0
ds_read_b64_tr_b16 a[184:185], v190 offset:16640
ds_read_b64_tr_b16 a[186:187], v190 offset:18688
v_mfma_f32_16x16x32_bf16 v[132:135], a[188:191], a[196:199], 0
ds_read_b64_tr_b16 a[188:189], v191 offset:16640
ds_read_b64_tr_b16 a[190:191], v191 offset:18688
v_mfma_f32_16x16x32_bf16 v[8:11], a[128:131], a[200:203], v[8:11]
s_add_u32 m0, s44, 53248
v_mfma_f32_16x16x32_bf16 v[40:43], a[128:131], a[204:207], v[40:43]
buffer_load_dwordx4 v140, s[16:19], s42 offen offset:0 lds
v_mfma_f32_16x16x32_bf16 v[12:15], a[132:135], a[200:203], v[12:15]
v_mfma_f32_16x16x32_bf16 v[44:47], a[132:135], a[204:207], v[44:47]
v_smfmac_f32_16x16x64_bf16 a[248:251], a[208:211], a[128:135], v235
s_waitcnt lgkmcnt(6)
v_mfma_f32_16x16x32_bf16 v[72:75], a[160:163], a[200:203], v[72:75]
v_mfma_f32_16x16x32_bf16 v[104:107], a[160:163], a[204:207], v[104:107]
s_waitcnt vmcnt(11) lgkmcnt(0)
s_barrier
v_mfma_f32_16x16x32_bf16 v[76:79], a[164:167], a[200:203], v[76:79]
ds_read_b128 a[192:195], v202 offset:0
ds_read_b128 a[196:199], v202 offset:2048
v_mfma_f32_16x16x32_bf16 v[108:111], a[164:167], a[204:207], v[108:111]
buffer_load_dwordx4 v141, s[16:19], s42 offen offset:1024 lds
v_smfmac_f32_16x16x64_bf16 a[252:255], a[208:211], a[160:167], v235
ds_read_b64_tr_b16 a[128:129], v194 offset:0
ds_read_b64_tr_b16 a[130:131], v194 offset:2048
v_mfma_f32_16x16x32_bf16 v[16:19], a[136:139], a[200:203], v[16:19]
ds_read_b64_tr_b16 a[132:133], v195 offset:0
ds_read_b64_tr_b16 a[134:135], v195 offset:2048
v_mfma_f32_16x16x32_bf16 v[48:51], a[136:139], a[204:207], v[48:51]
ds_read_b64_tr_b16 a[160:161], v194 offset:256
ds_read_b64_tr_b16 a[162:163], v194 offset:2304
v_mfma_f32_16x16x32_bf16 v[20:23], a[140:143], a[200:203], v[20:23]
ds_read_b64_tr_b16 a[164:165], v195 offset:256
ds_read_b64_tr_b16 a[166:167], v195 offset:2304
v_mfma_f32_16x16x32_bf16 v[52:55], a[140:143], a[204:207], v[52:55]
buffer_load_dwordx4 v142, s[16:19], s42 offen offset:2048 lds
v_mfma_f32_16x16x32_bf16 v[24:27], a[144:147], a[200:203], v[24:27]
ds_read_b64_tr_b16 a[136:137], v196 offset:0
ds_read_b64_tr_b16 a[138:139], v196 offset:2048
v_mfma_f32_16x16x32_bf16 v[56:59], a[144:147], a[204:207], v[56:59]
ds_read_b64_tr_b16 a[140:141], v197 offset:0
ds_read_b64_tr_b16 a[142:143], v197 offset:2048
v_mfma_f32_16x16x32_bf16 v[28:31], a[148:151], a[200:203], v[28:31]
ds_read_b64_tr_b16 a[144:145], v198 offset:0
ds_read_b64_tr_b16 a[146:147], v198 offset:2048
v_mfma_f32_16x16x32_bf16 v[60:63], a[148:151], a[204:207], v[60:63]
buffer_load_dwordx4 v143, s[16:19], s42 offen offset:3072 lds
v_mfma_f32_16x16x32_bf16 v[32:35], a[152:155], a[200:203], v[32:35]
s_lshl_b32 s72, s72, 12
ds_read_b64_tr_b16 a[148:149], v199 offset:0
ds_read_b64_tr_b16 a[150:151], v199 offset:2048
v_mfma_f32_16x16x32_bf16 v[64:67], a[152:155], a[204:207], v[64:67]
s_add_u32 s42, s42, s72
ds_read_b64_tr_b16 a[152:153], v200 offset:0
ds_read_b64_tr_b16 a[154:155], v200 offset:2048
v_mfma_f32_16x16x32_bf16 v[36:39], a[156:159], a[200:203], v[36:39]
s_add_u32 m0, s45, 32768
v_mfma_f32_16x16x32_bf16 v[68:71], a[156:159], a[204:207], v[68:71]
buffer_load_dwordx4 v144, s[24:27], s43 offen offset:0 lds
v_mfma_f32_16x16x32_bf16 v[80:83], a[168:171], a[200:203], v[80:83]
ds_read_b64_tr_b16 a[156:157], v201 offset:0
ds_read_b64_tr_b16 a[158:159], v201 offset:2048
v_mfma_f32_16x16x32_bf16 v[112:115], a[168:171], a[204:207], v[112:115]
ds_read_b64_tr_b16 a[168:169], v196 offset:256
ds_read_b64_tr_b16 a[170:171], v196 offset:2304
v_mfma_f32_16x16x32_bf16 v[84:87], a[172:175], a[200:203], v[84:87]
v_mfma_f32_16x16x32_bf16 v[116:119], a[172:175], a[204:207], v[116:119]
buffer_load_dwordx4 v145, s[24:27], s43 offen offset:1024 lds
v_mfma_f32_16x16x32_bf16 v[88:91], a[176:179], a[200:203], v[88:91]
ds_read_b64_tr_b16 a[172:173], v197 offset:256
ds_read_b64_tr_b16 a[174:175], v197 offset:2304
v_mfma_f32_16x16x32_bf16 v[120:123], a[176:179], a[204:207], v[120:123]
ds_read_b64_tr_b16 a[176:177], v198 offset:256
ds_read_b64_tr_b16 a[178:179], v198 offset:2304
v_mfma_f32_16x16x32_bf16 v[92:95], a[180:183], a[200:203], v[92:95]
s_add_u32 m0, s85, 32768
v_mfma_f32_16x16x32_bf16 v[124:127], a[180:183], a[204:207], v[124:127]
buffer_load_dwordx4 v146, s[24:27], s43 offen offset:0 lds
v_mfma_f32_16x16x32_bf16 v[96:99], a[184:187], a[200:203], v[96:99]
ds_read_b64_tr_b16 a[180:181], v199 offset:256
ds_read_b64_tr_b16 a[182:183], v199 offset:2304
v_mfma_f32_16x16x32_bf16 v[128:131], a[184:187], a[204:207], v[128:131]
ds_read_b64_tr_b16 a[184:185], v200 offset:256
ds_read_b64_tr_b16 a[186:187], v200 offset:2304
v_mfma_f32_16x16x32_bf16 v[100:103], a[188:191], a[200:203], v[100:103]
v_mfma_f32_16x16x32_bf16 v[132:135], a[188:191], a[204:207], v[132:135]
s_waitcnt lgkmcnt(8)
ds_read_b64_tr_b16 a[188:189], v201 offset:256
ds_read_b64_tr_b16 a[190:191], v201 offset:2304
s_bitcmp1_b32 s40, 1
s_cbranch_scc1 K_XP1
K_XP1D:
v_mfma_f32_16x16x32_bf16 v[8:11], a[128:131], a[192:195], v[8:11]
buffer_load_dwordx4 v147, s[24:27], s43 offen offset:1024 lds
v_mfma_f32_16x16x32_bf16 v[40:43], a[128:131], a[196:199], v[40:43]
s_cmp_eq_u32 s74, 5
s_cselect_b32 s72, s73, 128
ds_read_b128 a[200:203], v203 offset:0
ds_read_b128 a[204:207], v203 offset:2048
v_mfma_f32_16x16x32_bf16 v[12:15], a[132:135], a[192:195], v[12:15]
s_add_u32 s43, s43, s72
v_mfma_f32_16x16x32_bf16 v[44:47], a[132:135], a[196:199], v[44:47]
s_add_u32 m0, s44, 0
v_smfmac_f32_16x16x64_bf16 a[248:251], a[208:211], a[128:135], v235
buffer_load_dwordx4 v136, s[16:19], s42 offen offset:0 lds
v_mfma_f32_16x16x32_bf16 v[72:75], a[160:163], a[192:195], v[72:75]
ds_read_b64_tr_b16 a[128:129], v194 offset:16384
ds_read_b64_tr_b16 a[130:131], v194 offset:18432
v_mfma_f32_16x16x32_bf16 v[104:107], a[160:163], a[196:199], v[104:107]
ds_read_b64_tr_b16 a[132:133], v195 offset:16384
ds_read_b64_tr_b16 a[134:135], v195 offset:18432
v_mfma_f32_16x16x32_bf16 v[76:79], a[164:167], a[192:195], v[76:79]
v_mfma_f32_16x16x32_bf16 v[108:111], a[164:167], a[196:199], v[108:111]
buffer_load_dwordx4 v137, s[16:19], s42 offen offset:1024 lds
v_smfmac_f32_16x16x64_bf16 a[252:255], a[208:211], a[160:167], v235
ds_read_b64_tr_b16 a[160:161], v194 offset:16640
ds_read_b64_tr_b16 a[162:163], v194 offset:18688
v_mfma_f32_16x16x32_bf16 v[16:19], a[136:139], a[192:195], v[16:19]
ds_read_b64_tr_b16 a[164:165], v195 offset:16640
ds_read_b64_tr_b16 a[166:167], v195 offset:18688
v_mfma_f32_16x16x32_bf16 v[48:51], a[136:139], a[196:199], v[48:51]
ds_read_b64_tr_b16 a[136:137], v196 offset:16384
ds_read_b64_tr_b16 a[138:139], v196 offset:18432
v_mfma_f32_16x16x32_bf16 v[20:23], a[140:143], a[192:195], v[20:23]
buffer_load_dwordx4 v138, s[16:19], s42 offen offset:2048 lds
v_mfma_f32_16x16x32_bf16 v[52:55], a[140:143], a[196:199], v[52:55]
ds_read_b64_tr_b16 a[140:141], v197 offset:16384
ds_read_b64_tr_b16 a[142:143], v197 offset:18432
v_mfma_f32_16x16x32_bf16 v[24:27], a[144:147], a[192:195], v[24:27]
v_mfma_f32_16x16x32_bf16 v[56:59], a[144:147], a[196:199], v[56:59]
ds_read_b64_tr_b16 a[144:145], v198 offset:16384
ds_read_b64_tr_b16 a[146:147], v198 offset:18432
v_mfma_f32_16x16x32_bf16 v[28:31], a[148:151], a[192:195], v[28:31]
buffer_load_dwordx4 v139, s[16:19], s42 offen offset:3072 lds
v_mfma_f32_16x16x32_bf16 v[60:63], a[148:151], a[196:199], v[60:63]
ds_read_b64_tr_b16 a[148:149], v199 offset:16384
ds_read_b64_tr_b16 a[150:151], v199 offset:18432
v_mfma_f32_16x16x32_bf16 v[32:35], a[152:155], a[192:195], v[32:35]
v_mfma_f32_16x16x32_bf16 v[64:67], a[152:155], a[196:199], v[64:67]
ds_read_b64_tr_b16 a[152:153], v200 offset:16384
ds_read_b64_tr_b16 a[154:155], v200 offset:18432
v_mfma_f32_16x16x32_bf16 v[36:39], a[156:159], a[192:195], v[36:39]
s_add_u32 m0, s44, 4096
v_mfma_f32_16x16x32_bf16 v[68:71], a[156:159], a[196:199], v[68:71]
buffer_load_dwordx4 v140, s[16:19], s42 offen offset:0 lds
v_mfma_f32_16x16x32_bf16 v[80:83], a[168:171], a[192:195], v[80:83]
ds_read_b64_tr_b16 a[156:157], v201 offset:16384
ds_read_b64_tr_b16 a[158:159], v201 offset:18432
v_mfma_f32_16x16x32_bf16 v[112:115], a[168:171], a[196:199], v[112:115]
s_waitcnt lgkmcnt(8)
ds_read_b64_tr_b16 a[168:169], v196 offset:16640
ds_read_b64_tr_b16 a[170:171], v196 offset:18688
v_mfma_f32_16x16x32_bf16 v[84:87], a[172:175], a[192:195], v[84:87]
v_mfma_f32_16x16x32_bf16 v[116:119], a[172:175], a[196:199], v[116:119]
buffer_load_dwordx4 v141, s[16:19], s42 offen offset:1024 lds
v_mfma_f32_16x16x32_bf16 v[88:91], a[176:179], a[192:195], v[88:91]
ds_read_b64_tr_b16 a[172:173], v197 offset:16640
ds_read_b64_tr_b16 a[174:175], v197 offset:18688
v_mfma_f32_16x16x32_bf16 v[120:123], a[176:179], a[196:199], v[120:123]
ds_read_b64_tr_b16 a[176:177], v198 offset:16640
ds_read_b64_tr_b16 a[178:179], v198 offset:18688
v_mfma_f32_16x16x32_bf16 v[92:95], a[180:183], a[192:195], v[92:95]
v_mfma_f32_16x16x32_bf16 v[124:127], a[180:183], a[196:199], v[124:127]
buffer_load_dwordx4 v142, s[16:19], s42 offen offset:2048 lds
v_mfma_f32_16x16x32_bf16 v[96:99], a[184:187], a[192:195], v[96:99]
ds_read_b64_tr_b16 a[180:181], v199 offset:16640
ds_read_b64_tr_b16 a[182:183], v199 offset:18688
v_mfma_f32_16x16x32_bf16 v[128:131], a[184:187], a[196:199], v[128:131]
ds_read_b64_tr_b16 a[184:185], v200 offset:16640
ds_read_b64_tr_b16 a[186:187], v200 offset:18688
v_mfma_f32_16x16x32_bf16 v[100:103], a[188:191], a[192:195], v[100:103]
v_mfma_f32_16x16x32_bf16 v[132:135], a[188:191], a[196:199], v[132:135]
ds_read_b64_tr_b16 a[188:189], v201 offset:16640
ds_read_b64_tr_b16 a[190:191], v201 offset:18688
v_mfma_f32_16x16x32_bf16 v[8:11], a[128:131], a[200:203], v[8:11]
buffer_load_dwordx4 v143, s[16:19], s42 offen offset:3072 lds
v_mfma_f32_16x16x32_bf16 v[40:43], a[128:131], a[204:207], v[40:43]
v_mfma_f32_16x16x32_bf16 v[12:15], a[132:135], a[200:203], v[12:15]
s_lshl_b32 s72, s72, 12
v_mfma_f32_16x16x32_bf16 v[44:47], a[132:135], a[204:207], v[44:47]
s_add_u32 s42, s42, s72
v_smfmac_f32_16x16x64_bf16 a[248:251], a[208:211], a[128:135], v235
v_mfma_f32_16x16x32_bf16 v[72:75], a[160:163], a[200:203], v[72:75]
v_mfma_f32_16x16x32_bf16 v[104:107], a[160:163], a[204:207], v[104:107]
s_waitcnt vmcnt(12) lgkmcnt(0)
s_barrier
s_cmp_lg_u32 s32, 0
s_cbranch_scc1 K_W0_3
s_lshl_b32 s48, s34, 4
s_mov_b64 exec, 1
buffer_atomic_add v255, v234, s[28:31], s48 offen sc1
s_mov_b64 exec, -1
K_W0_3:
v_mfma_f32_16x16x32_bf16 v[76:79], a[164:167], a[200:203], v[76:79]
s_add_u32 m0, s45, 131072
ds_read_b128 a[192:195], v212 offset:0
ds_read_b128 a[196:199], v212 offset:2048
v_mfma_f32_16x16x32_bf16 v[108:111], a[164:167], a[204:207], v[108:111]
buffer_load_dwordx4 v144, s[24:27], s43 offen offset:0 lds
v_smfmac_f32_16x16x64_bf16 a[252:255], a[208:211], a[160:167], v235
ds_read_b64_tr_b16 a[128:129], v204 offset:0
ds_read_b64_tr_b16 a[130:131], v204 offset:2048
v_mfma_f32_16x16x32_bf16 v[16:19], a[136:139], a[200:203], v[16:19]
ds_read_b64_tr_b16 a[132:133], v205 offset:0
ds_read_b64_tr_b16 a[134:135], v205 offset:2048
v_mfma_f32_16x16x32_bf16 v[48:51], a[136:139], a[204:207], v[48:51]
ds_read_b64_tr_b16 a[160:161], v204 offset:256
ds_read_b64_tr_b16 a[162:163], v204 offset:2304
v_mfma_f32_16x16x32_bf16 v[20:23], a[140:143], a[200:203], v[20:23]
ds_read_b64_tr_b16 a[164:165], v205 offset:256
ds_read_b64_tr_b16 a[166:167], v205 offset:2304
v_mfma_f32_16x16x32_bf16 v[52:55], a[140:143], a[204:207], v[52:55]
buffer_load_dwordx4 v145, s[24:27], s43 offen offset:1024 lds
v_mfma_f32_16x16x32_bf16 v[24:27], a[144:147], a[200:203], v[24:27]
ds_read_b64_tr_b16 a[136:137], v206 offset:0
ds_read_b64_tr_b16 a[138:139], v206 offset:2048
v_mfma_f32_16x16x32_bf16 v[56:59], a[144:147], a[204:207], v[56:59]
ds_read_b64_tr_b16 a[140:141], v207 offset:0
ds_read_b64_tr_b16 a[142:143], v207 offset:2048
v_mfma_f32_16x16x32_bf16 v[28:31], a[148:151], a[200:203], v[28:31]
s_add_u32 m0, s85, 131072
ds_read_b64_tr_b16 a[144:145], v208 offset:0
ds_read_b64_tr_b16 a[146:147], v208 offset:2048
v_mfma_f32_16x16x32_bf16 v[60:63], a[148:151], a[204:207], v[60:63]
buffer_load_dwordx4 v146, s[24:27], s43 offen offset:0 lds
v_mfma_f32_16x16x32_bf16 v[32:35], a[152:155], a[200:203], v[32:35]
ds_read_b64_tr_b16 a[148:149], v209 offset:0
ds_read_b64_tr_b16 a[150:151], v209 offset:2048
v_mfma_f32_16x16x32_bf16 v[64:67], a[152:155], a[204:207], v[64:67]
ds_read_b64_tr_b16 a[152:153], v210 offset:0
ds_read_b64_tr_b16 a[154:155], v210 offset:2048
v_mfma_f32_16x16x32_bf16 v[36:39], a[156:159], a[200:203], v[36:39]
v_mfma_f32_16x16x32_bf16 v[68:71], a[156:159], a[204:207], v[68:71]
buffer_load_dwordx4 v147, s[24:27], s43 offen offset:1024 lds
v_mfma_f32_16x16x32_bf16 v[80:83], a[168:171], a[200:203], v[80:83]
s_cmp_eq_u32 s74, 4
s_cselect_b32 s72, s73, 128
ds_read_b64_tr_b16 a[156:157], v211 offset:0
ds_read_b64_tr_b16 a[158:159], v211 offset:2048
v_mfma_f32_16x16x32_bf16 v[112:115], a[168:171], a[204:207], v[112:115]
s_add_u32 s43, s43, s72
ds_read_b64_tr_b16 a[168:169], v206 offset:256
ds_read_b64_tr_b16 a[170:171], v206 offset:2304
v_mfma_f32_16x16x32_bf16 v[84:87], a[172:175], a[200:203], v[84:87]
s_add_u32 m0, s44, 98304
v_mfma_f32_16x16x32_bf16 v[116:119], a[172:175], a[204:207], v[116:119]
buffer_load_dwordx4 v136, s[16:19], s42 offen offset:0 lds
v_mfma_f32_16x16x32_bf16 v[88:91], a[176:179], a[200:203], v[88:91]
ds_read_b64_tr_b16 a[172:173], v207 offset:256
ds_read_b64_tr_b16 a[174:175], v207 offset:2304
v_mfma_f32_16x16x32_bf16 v[120:123], a[176:179], a[204:207], v[120:123]
ds_read_b64_tr_b16 a[176:177], v208 offset:256
ds_read_b64_tr_b16 a[178:179], v208 offset:2304
v_mfma_f32_16x16x32_bf16 v[92:95], a[180:183], a[200:203], v[92:95]
v_mfma_f32_16x16x32_bf16 v[124:127], a[180:183], a[204:207], v[124:127]
buffer_load_dwordx4 v137, s[16:19], s42 offen offset:1024 lds
v_mfma_f32_16x16x32_bf16 v[96:99], a[184:187], a[200:203], v[96:99]
ds_read_b64_tr_b16 a[180:181], v209 offset:256
ds_read_b64_tr_b16 a[182:183], v209 offset:2304
v_mfma_f32_16x16x32_bf16 v[128:131], a[184:187], a[204:207], v[128:131]
ds_read_b64_tr_b16 a[184:185], v210 offset:256
ds_read_b64_tr_b16 a[186:187], v210 offset:2304
v_mfma_f32_16x16x32_bf16 v[100:103], a[188:191], a[200:203], v[100:103]
v_mfma_f32_16x16x32_bf16 v[132:135], a[188:191], a[204:207], v[132:135]
s_waitcnt lgkmcnt(8)
ds_read_b64_tr_b16 a[188:189], v211 offset:256
ds_read_b64_tr_b16 a[190:191], v211 offset:2304
s_bitcmp1_b32 s40, 2
s_cbranch_scc1 K_XP2
K_XP2D:
v_mfma_f32_16x16x32_bf16 v[8:11], a[128:131], a[192:195], v[8:11]
buffer_load_dwordx4 v138, s[16:19], s42 offen offset:2048 lds
v_mfma_f32_16x16x32_bf16 v[40:43], a[128:131], a[196:199], v[40:43]
ds_read_b128 a[200:203], v213 offset:0
ds_read_b128 a[204:207], v213 offset:2048
v_mfma_f32_16x16x32_bf16 v[12:15], a[132:135], a[192:195], v[12:15]
v_accvgpr_write_b32 a0, 0
v_accvgpr_write_b32 a1, 0
v_mfma_f32_16x16x32_bf16 v[44:47], a[132:135], a[196:199], v[44:47]
v_accvgpr_write_b32 a2, 0
v_accvgpr_write_b32 a3, 0
v_smfmac_f32_16x16x64_bf16 a[248:251], a[208:211], a[128:135], v235
buffer_load_dwordx4 v139, s[16:19], s42 offen offset:3072 lds
v_mfma_f32_16x16x32_bf16 v[72:75], a[160:163], a[192:195], v[72:75]
ds_read_b64_tr_b16 a[128:129], v204 offset:16384
ds_read_b64_tr_b16 a[130:131], v204 offset:18432
v_mfma_f32_16x16x32_bf16 v[104:107], a[160:163], a[196:199], v[104:107]
ds_read_b64_tr_b16 a[132:133], v205 offset:16384
ds_read_b64_tr_b16 a[134:135], v205 offset:18432
v_mfma_f32_16x16x32_bf16 v[76:79], a[164:167], a[192:195], v[76:79]
s_add_u32 m0, s44, 102400
v_accvgpr_write_b32 a4, 0
v_accvgpr_write_b32 a5, 0
v_mfma_f32_16x16x32_bf16 v[108:111], a[164:167], a[196:199], v[108:111]
buffer_load_dwordx4 v140, s[16:19], s42 offen offset:0 lds
v_smfmac_f32_16x16x64_bf16 a[252:255], a[208:211], a[160:167], v235
ds_read_b64_tr_b16 a[160:161], v204 offset:16640
ds_read_b64_tr_b16 a[162:163], v204 offset:18688
v_mfma_f32_16x16x32_bf16 v[16:19], a[136:139], a[192:195], v[16:19]
ds_read_b64_tr_b16 a[164:165], v205 offset:16640
ds_read_b64_tr_b16 a[166:167], v205 offset:18688
v_mfma_f32_16x16x32_bf16 v[48:51], a[136:139], a[196:199], v[48:51]
ds_read_b64_tr_b16 a[136:137], v206 offset:16384
ds_read_b64_tr_b16 a[138:139], v206 offset:18432
v_mfma_f32_16x16x32_bf16 v[20:23], a[140:143], a[192:195], v[20:23]
buffer_load_dwordx4 v141, s[16:19], s42 offen offset:1024 lds
v_mfma_f32_16x16x32_bf16 v[52:55], a[140:143], a[196:199], v[52:55]
ds_read_b64_tr_b16 a[140:141], v207 offset:16384
ds_read_b64_tr_b16 a[142:143], v207 offset:18432
v_mfma_f32_16x16x32_bf16 v[24:27], a[144:147], a[192:195], v[24:27]
v_accvgpr_write_b32 a6, 0
v_accvgpr_write_b32 a7, 0
v_mfma_f32_16x16x32_bf16 v[56:59], a[144:147], a[196:199], v[56:59]
ds_read_b64_tr_b16 a[144:145], v208 offset:16384
ds_read_b64_tr_b16 a[146:147], v208 offset:18432
v_mfma_f32_16x16x32_bf16 v[28:31], a[148:151], a[192:195], v[28:31]
buffer_load_dwordx4 v142, s[16:19], s42 offen offset:2048 lds
v_mfma_f32_16x16x32_bf16 v[60:63], a[148:151], a[196:199], v[60:63]
ds_read_b64_tr_b16 a[148:149], v209 offset:16384
ds_read_b64_tr_b16 a[150:151], v209 offset:18432
v_mfma_f32_16x16x32_bf16 v[32:35], a[152:155], a[192:195], v[32:35]
v_accvgpr_write_b32 a8, 0
v_accvgpr_write_b32 a9, 0
v_mfma_f32_16x16x32_bf16 v[64:67], a[152:155], a[196:199], v[64:67]
ds_read_b64_tr_b16 a[152:153], v210 offset:16384
ds_read_b64_tr_b16 a[154:155], v210 offset:18432
v_mfma_f32_16x16x32_bf16 v[36:39], a[156:159], a[192:195], v[36:39]
v_accvgpr_write_b32 a10, 0
v_accvgpr_write_b32 a11, 0
v_mfma_f32_16x16x32_bf16 v[68:71], a[156:159], a[196:199], v[68:71]
buffer_load_dwordx4 v143, s[16:19], s42 offen offset:3072 lds
v_mfma_f32_16x16x32_bf16 v[80:83], a[168:171], a[192:195], v[80:83]
s_waitcnt lgkmcnt(8)
ds_read_b64_tr_b16 a[156:157], v211 offset:16384
ds_read_b64_tr_b16 a[158:159], v211 offset:18432
v_mfma_f32_16x16x32_bf16 v[112:115], a[168:171], a[196:199], v[112:115]
s_lshl_b32 s72, s72, 12
ds_read_b64_tr_b16 a[168:169], v206 offset:16640
ds_read_b64_tr_b16 a[170:171], v206 offset:18688
v_mfma_f32_16x16x32_bf16 v[84:87], a[172:175], a[192:195], v[84:87]
s_add_u32 s42, s42, s72
v_accvgpr_write_b32 a12, 0
v_accvgpr_write_b32 a13, 0
v_mfma_f32_16x16x32_bf16 v[116:119], a[172:175], a[196:199], v[116:119]
ds_read_b64_tr_b16 a[172:173], v207 offset:16640
ds_read_b64_tr_b16 a[174:175], v207 offset:18688
v_mfma_f32_16x16x32_bf16 v[88:91], a[176:179], a[192:195], v[88:91]
v_accvgpr_write_b32 a14, 0
v_accvgpr_write_b32 a15, 0
v_mfma_f32_16x16x32_bf16 v[120:123], a[176:179], a[196:199], v[120:123]
ds_read_b64_tr_b16 a[176:177], v208 offset:16640
ds_read_b64_tr_b16 a[178:179], v208 offset:18688
v_mfma_f32_16x16x32_bf16 v[92:95], a[180:183], a[192:195], v[92:95]
v_mfma_f32_16x16x32_bf16 v[124:127], a[180:183], a[196:199], v[124:127]
ds_read_b64_tr_b16 a[180:181], v209 offset:16640
ds_read_b64_tr_b16 a[182:183], v209 offset:18688
v_mfma_f32_16x16x32_bf16 v[96:99], a[184:187], a[192:195], v[96:99]
v_mfma_f32_16x16x32_bf16 v[128:131], a[184:187], a[196:199], v[128:131]
ds_read_b64_tr_b16 a[184:185], v210 offset:16640
ds_read_b64_tr_b16 a[186:187], v210 offset:18688
v_mfma_f32_16x16x32_bf16 v[100:103], a[188:191], a[192:195], v[100:103]
v_mfma_f32_16x16x32_bf16 v[132:135], a[188:191], a[196:199], v[132:135]
ds_read_b64_tr_b16 a[188:189], v211 offset:16640
ds_read_b64_tr_b16 a[190:191], v211 offset:18688
v_mfma_f32_16x16x32_bf16 v[8:11], a[128:131], a[200:203], v[8:11]
v_mfma_f32_16x16x32_bf16 v[40:43], a[128:131], a[204:207], v[40:43]
v_mfma_f32_16x16x32_bf16 v[12:15], a[132:135], a[200:203], v[12:15]
v_mfma_f32_16x16x32_bf16 v[44:47], a[132:135], a[204:207], v[44:47]
v_smfmac_f32_16x16x64_bf16 a[248:251], a[208:211], a[128:135], v235
v_mfma_f32_16x16x32_bf16 v[72:75], a[160:163], a[200:203], v[72:75]
v_mfma_f32_16x16x32_bf16 v[104:107], a[160:163], a[204:207], v[104:107]
s_waitcnt vmcnt(12) lgkmcnt(0)
s_barrier
v_mfma_f32_16x16x32_bf16 v[76:79], a[164:167], a[200:203], v[76:79]
s_add_u32 m0, s45, 81920
ds_read_b128 a[192:195], v192 offset:0
ds_read_b128 a[196:199], v192 offset:2048
v_mfma_f32_16x16x32_bf16 v[108:111], a[164:167], a[204:207], v[108:111]
buffer_load_dwordx4 v144, s[24:27], s43 offen offset:0 lds
v_smfmac_f32_16x16x64_bf16 a[252:255], a[208:211], a[160:167], v235
ds_read_b64_tr_b16 a[128:129], v184 offset:0
ds_read_b64_tr_b16 a[130:131], v184 offset:2048
v_mfma_f32_16x16x32_bf16 v[16:19], a[136:139], a[200:203], v[16:19]
ds_read_b64_tr_b16 a[132:133], v185 offset:0
ds_read_b64_tr_b16 a[134:135], v185 offset:2048
v_mfma_f32_16x16x32_bf16 v[48:51], a[136:139], a[204:207], v[48:51]
ds_read_b64_tr_b16 a[160:161], v184 offset:256
ds_read_b64_tr_b16 a[162:163], v184 offset:2304
v_mfma_f32_16x16x32_bf16 v[20:23], a[140:143], a[200:203], v[20:23]
buffer_load_dwordx4 v145, s[24:27], s43 offen offset:1024 lds
v_mfma_f32_16x16x32_bf16 v[52:55], a[140:143], a[204:207], v[52:55]
ds_read_b64_tr_b16 a[164:165], v185 offset:256
ds_read_b64_tr_b16 a[166:167], v185 offset:2304
v_mfma_f32_16x16x32_bf16 v[24:27], a[144:147], a[200:203], v[24:27]
ds_read_b64_tr_b16 a[136:137], v186 offset:0
ds_read_b64_tr_b16 a[138:139], v186 offset:2048
v_mfma_f32_16x16x32_bf16 v[56:59], a[144:147], a[204:207], v[56:59]
s_add_u32 m0, s85, 81920
ds_read_b64_tr_b16 a[140:141], v187 offset:0
ds_read_b64_tr_b16 a[142:143], v187 offset:2048
v_mfma_f32_16x16x32_bf16 v[28:31], a[148:151], a[200:203], v[28:31]
buffer_load_dwordx4 v146, s[24:27], s43 offen offset:0 lds
v_mfma_f32_16x16x32_bf16 v[60:63], a[148:151], a[204:207], v[60:63]
ds_read_b64_tr_b16 a[144:145], v188 offset:0
ds_read_b64_tr_b16 a[146:147], v188 offset:2048
v_mfma_f32_16x16x32_bf16 v[32:35], a[152:155], a[200:203], v[32:35]
ds_read_b64_tr_b16 a[148:149], v189 offset:0
ds_read_b64_tr_b16 a[150:151], v189 offset:2048
v_mfma_f32_16x16x32_bf16 v[64:67], a[152:155], a[204:207], v[64:67]
ds_read_b64_tr_b16 a[152:153], v190 offset:0
ds_read_b64_tr_b16 a[154:155], v190 offset:2048
v_mfma_f32_16x16x32_bf16 v[36:39], a[156:159], a[200:203], v[36:39]
buffer_load_dwordx4 v147, s[24:27], s43 offen offset:1024 lds
v_mfma_f32_16x16x32_bf16 v[68:71], a[156:159], a[204:207], v[68:71]
ds_read_b64_tr_b16 a[156:157], v191 offset:0
ds_read_b64_tr_b16 a[158:159], v191 offset:2048
v_mfma_f32_16x16x32_bf16 v[80:83], a[168:171], a[200:203], v[80:83]
s_cmp_eq_u32 s74, 3
s_cselect_b32 s72, s73, 128
v_mfma_f32_16x16x32_bf16 v[112:115], a[168:171], a[204:207], v[112:115]
s_add_u32 s43, s43, s72
ds_read_b64_tr_b16 a[168:169], v186 offset:256
ds_read_b64_tr_b16 a[170:171], v186 offset:2304
v_mfma_f32_16x16x32_bf16 v[84:87], a[172:175], a[200:203], v[84:87]
s_add_u32 m0, s44, 49152
v_mfma_f32_16x16x32_bf16 v[116:119], a[172:175], a[204:207], v[116:119]
buffer_load_dwordx4 v136, s[16:19], s42 offen offset:0 lds
v_mfma_f32_16x16x32_bf16 v[88:91], a[176:179], a[200:203], v[88:91]
ds_read_b64_tr_b16 a[172:173], v187 offset:256
ds_read_b64_tr_b16 a[174:175], v187 offset:2304
v_mfma_f32_16x16x32_bf16 v[120:123], a[176:179], a[204:207], v[120:123]
ds_read_b64_tr_b16 a[176:177], v188 offset:256
ds_read_b64_tr_b16 a[178:179], v188 offset:2304
v_mfma_f32_16x16x32_bf16 v[92:95], a[180:183], a[200:203], v[92:95]
v_mfma_f32_16x16x32_bf16 v[124:127], a[180:183], a[204:207], v[124:127]
buffer_load_dwordx4 v137, s[16:19], s42 offen offset:1024 lds
v_mfma_f32_16x16x32_bf16 v[96:99], a[184:187], a[200:203], v[96:99]
ds_read_b64_tr_b16 a[180:181], v189 offset:256
ds_read_b64_tr_b16 a[182:183], v189 offset:2304
v_mfma_f32_16x16x32_bf16 v[128:131], a[184:187], a[204:207], v[128:131]
ds_read_b64_tr_b16 a[184:185], v190 offset:256
ds_read_b64_tr_b16 a[186:187], v190 offset:2304
v_mfma_f32_16x16x32_bf16 v[100:103], a[188:191], a[200:203], v[100:103]
v_mfma_f32_16x16x32_bf16 v[132:135], a[188:191], a[204:207], v[132:135]
s_waitcnt lgkmcnt(8)
ds_read_b64_tr_b16 a[188:189], v191 offset:256
ds_read_b64_tr_b16 a[190:191], v191 offset:2304
s_bitcmp1_b32 s40, 3
s_cbranch_scc1 K_XP3
K_XP3D:
v_mfma_f32_16x16x32_bf16 v[8:11], a[128:131], a[192:195], v[8:11]
buffer_load_dwordx4 v138, s[16:19], s42 offen offset:2048 lds
v_mfma_f32_16x16x32_bf16 v[40:43], a[128:131], a[196:199], v[40:43]
ds_read_b128 a[200:203], v193 offset:0
ds_read_b128 a[204:207], v193 offset:2048
v_mfma_f32_16x16x32_bf16 v[12:15], a[132:135], a[192:195], v[12:15]
v_mfma_f32_16x16x32_bf16 v[44:47], a[132:135], a[196:199], v[44:47]
v_smfmac_f32_16x16x64_bf16 a[248:251], a[208:211], a[128:135], v235
buffer_load_dwordx4 v139, s[16:19], s42 offen offset:3072 lds
v_mfma_f32_16x16x32_bf16 v[72:75], a[160:163], a[192:195], v[72:75]
ds_read_b64_tr_b16 a[128:129], v184 offset:16384
ds_read_b64_tr_b16 a[130:131], v184 offset:18432
v_mfma_f32_16x16x32_bf16 v[104:107], a[160:163], a[196:199], v[104:107]
ds_read_b64_tr_b16 a[132:133], v185 offset:16384
ds_read_b64_tr_b16 a[134:135], v185 offset:18432
v_mfma_f32_16x16x32_bf16 v[76:79], a[164:167], a[192:195], v[76:79]
s_add_u32 m0, s44, 53248
v_mfma_f32_16x16x32_bf16 v[108:111], a[164:167], a[196:199], v[108:111]
buffer_load_dwordx4 v140, s[16:19], s42 offen offset:0 lds
v_smfmac_f32_16x16x64_bf16 a[252:255], a[208:211], a[160:167], v235
ds_read_b64_tr_b16 a[160:161], v184 offset:16640
ds_read_b64_tr_b16 a[162:163], v184 offset:18688
v_mfma_f32_16x16x32_bf16 v[16:19], a[136:139], a[192:195], v[16:19]
ds_read_b64_tr_b16 a[164:165], v185 offset:16640
ds_read_b64_tr_b16 a[166:167], v185 offset:18688
v_mfma_f32_16x16x32_bf16 v[48:51], a[136:139], a[196:199], v[48:51]
ds_read_b64_tr_b16 a[136:137], v186 offset:16384
ds_read_b64_tr_b16 a[138:139], v186 offset:18432
v_mfma_f32_16x16x32_bf16 v[20:23], a[140:143], a[192:195], v[20:23]
v_mfma_f32_16x16x32_bf16 v[52:55], a[140:143], a[196:199], v[52:55]
buffer_load_dwordx4 v141, s[16:19], s42 offen offset:1024 lds
v_mfma_f32_16x16x32_bf16 v[24:27], a[144:147], a[192:195], v[24:27]
ds_read_b64_tr_b16 a[140:141], v187 offset:16384
ds_read_b64_tr_b16 a[142:143], v187 offset:18432
v_mfma_f32_16x16x32_bf16 v[56:59], a[144:147], a[196:199], v[56:59]
ds_read_b64_tr_b16 a[144:145], v188 offset:16384
ds_read_b64_tr_b16 a[146:147], v188 offset:18432
v_mfma_f32_16x16x32_bf16 v[28:31], a[148:151], a[192:195], v[28:31]
v_mfma_f32_16x16x32_bf16 v[60:63], a[148:151], a[196:199], v[60:63]
buffer_load_dwordx4 v142, s[16:19], s42 offen offset:2048 lds
v_mfma_f32_16x16x32_bf16 v[32:35], a[152:155], a[192:195], v[32:35]
ds_read_b64_tr_b16 a[148:149], v189 offset:16384
ds_read_b64_tr_b16 a[150:151], v189 offset:18432
v_mfma_f32_16x16x32_bf16 v[64:67], a[152:155], a[196:199], v[64:67]
ds_read_b64_tr_b16 a[152:153], v190 offset:16384
ds_read_b64_tr_b16 a[154:155], v190 offset:18432
v_mfma_f32_16x16x32_bf16 v[36:39], a[156:159], a[192:195], v[36:39]
v_mfma_f32_16x16x32_bf16 v[68:71], a[156:159], a[196:199], v[68:71]
buffer_load_dwordx4 v143, s[16:19], s42 offen offset:3072 lds
v_mfma_f32_16x16x32_bf16 v[80:83], a[168:171], a[192:195], v[80:83]
s_waitcnt lgkmcnt(8)
ds_read_b64_tr_b16 a[156:157], v191 offset:16384
ds_read_b64_tr_b16 a[158:159], v191 offset:18432
v_mfma_f32_16x16x32_bf16 v[112:115], a[168:171], a[196:199], v[112:115]
s_lshl_b32 s72, s72, 12
ds_read_b64_tr_b16 a[168:169], v186 offset:16640
ds_read_b64_tr_b16 a[170:171], v186 offset:18688
v_mfma_f32_16x16x32_bf16 v[84:87], a[172:175], a[192:195], v[84:87]
s_add_u32 s42, s42, s72
v_mfma_f32_16x16x32_bf16 v[116:119], a[172:175], a[196:199], v[116:119]
ds_read_b64_tr_b16 a[172:173], v187 offset:16640
ds_read_b64_tr_b16 a[174:175], v187 offset:18688
v_mfma_f32_16x16x32_bf16 v[88:91], a[176:179], a[192:195], v[88:91]
v_mfma_f32_16x16x32_bf16 v[120:123], a[176:179], a[196:199], v[120:123]
ds_read_b64_tr_b16 a[176:177], v188 offset:16640
ds_read_b64_tr_b16 a[178:179], v188 offset:18688
v_mfma_f32_16x16x32_bf16 v[92:95], a[180:183], a[192:195], v[92:95]
v_mfma_f32_16x16x32_bf16 v[124:127], a[180:183], a[196:199], v[124:127]
ds_read_b64_tr_b16 a[180:181], v189 offset:16640
ds_read_b64_tr_b16 a[182:183], v189 offset:18688
v_mfma_f32_16x16x32_bf16 v[96:99], a[184:187], a[192:195], v[96:99]
v_mfma_f32_16x16x32_bf16 v[128:131], a[184:187], a[196:199], v[128:131]
ds_read_b64_tr_b16 a[184:185], v190 offset:16640
ds_read_b64_tr_b16 a[186:187], v190 offset:18688
v_mfma_f32_16x16x32_bf16 v[100:103], a[188:191], a[192:195], v[100:103]
v_mfma_f32_16x16x32_bf16 v[132:135], a[188:191], a[196:199], v[132:135]
ds_read_b64_tr_b16 a[188:189], v191 offset:16640
ds_read_b64_tr_b16 a[190:191], v191 offset:18688
v_mfma_f32_16x16x32_bf16 v[8:11], a[128:131], a[200:203], v[8:11]
v_mfma_f32_16x16x32_bf16 v[40:43], a[128:131], a[204:207], v[40:43]
v_mfma_f32_16x16x32_bf16 v[12:15], a[132:135], a[200:203], v[12:15]
v_mfma_f32_16x16x32_bf16 v[44:47], a[132:135], a[204:207], v[44:47]
v_smfmac_f32_16x16x64_bf16 a[248:251], a[208:211], a[128:135], v235
v_mfma_f32_16x16x32_bf16 v[72:75], a[160:163], a[200:203], v[72:75]
v_mfma_f32_16x16x32_bf16 v[104:107], a[160:163], a[204:207], v[104:107]
s_waitcnt vmcnt(12) lgkmcnt(0)
s_barrier
v_mfma_f32_16x16x32_bf16 v[76:79], a[164:167], a[200:203], v[76:79]
s_add_u32 m0, s45, 32768
ds_read_b128 a[192:195], v202 offset:0
ds_read_b128 a[196:199], v202 offset:2048
v_mfma_f32_16x16x32_bf16 v[108:111], a[164:167], a[204:207], v[108:111]
buffer_load_dwordx4 v144, s[24:27], s43 offen offset:0 lds
v_smfmac_f32_16x16x64_bf16 a[252:255], a[208:211], a[160:167], v235
ds_read_b64_tr_b16 a[128:129], v194 offset:0
ds_read_b64_tr_b16 a[130:131], v194 offset:2048
v_mfma_f32_16x16x32_bf16 v[16:19], a[136:139], a[200:203], v[16:19]
ds_read_b64_tr_b16 a[132:133], v195 offset:0
ds_read_b64_tr_b16 a[134:135], v195 offset:2048
v_mfma_f32_16x16x32_bf16 v[48:51], a[136:139], a[204:207], v[48:51]
ds_read_b64_tr_b16 a[160:161], v194 offset:256
ds_read_b64_tr_b16 a[162:163], v194 offset:2304
v_mfma_f32_16x16x32_bf16 v[20:23], a[140:143], a[200:203], v[20:23]
buffer_load_dwordx4 v145, s[24:27], s43 offen offset:1024 lds
v_mfma_f32_16x16x32_bf16 v[52:55], a[140:143], a[204:207], v[52:55]
ds_read_b64_tr_b16 a[164:165], v195 offset:256
ds_read_b64_tr_b16 a[166:167], v195 offset:2304
v_mfma_f32_16x16x32_bf16 v[24:27], a[144:147], a[200:203], v[24:27]
ds_read_b64_tr_b16 a[136:137], v196 offset:0
ds_read_b64_tr_b16 a[138:139], v196 offset:2048
v_mfma_f32_16x16x32_bf16 v[56:59], a[144:147], a[204:207], v[56:59]
ds_read_b64_tr_b16 a[140:141], v197 offset:0
ds_read_b64_tr_b16 a[142:143], v197 offset:2048
v_mfma_f32_16x16x32_bf16 v[28:31], a[148:151], a[200:203], v[28:31]
s_add_u32 m0, s85, 32768
ds_read_b64_tr_b16 a[144:145], v198 offset:0
ds_read_b64_tr_b16 a[146:147], v198 offset:2048
v_mfma_f32_16x16x32_bf16 v[60:63], a[148:151], a[204:207], v[60:63]
buffer_load_dwordx4 v146, s[24:27], s43 offen offset:0 lds
v_mfma_f32_16x16x32_bf16 v[32:35], a[152:155], a[200:203], v[32:35]
ds_read_b64_tr_b16 a[148:149], v199 offset:0
ds_read_b64_tr_b16 a[150:151], v199 offset:2048
v_mfma_f32_16x16x32_bf16 v[64:67], a[152:155], a[204:207], v[64:67]
ds_read_b64_tr_b16 a[152:153], v200 offset:0
ds_read_b64_tr_b16 a[154:155], v200 offset:2048
v_mfma_f32_16x16x32_bf16 v[36:39], a[156:159], a[200:203], v[36:39]
v_mfma_f32_16x16x32_bf16 v[68:71], a[156:159], a[204:207], v[68:71]
buffer_load_dwordx4 v147, s[24:27], s43 offen offset:1024 lds
v_mfma_f32_16x16x32_bf16 v[80:83], a[168:171], a[200:203], v[80:83]
s_cmp_eq_u32 s74, 2
s_cselect_b32 s72, s73, 128
ds_read_b64_tr_b16 a[156:157], v201 offset:0
ds_read_b64_tr_b16 a[158:159], v201 offset:2048
v_mfma_f32_16x16x32_bf16 v[112:115], a[168:171], a[204:207], v[112:115]
s_add_u32 s43, s43, s72
ds_read_b64_tr_b16 a[168:169], v196 offset:256
ds_read_b64_tr_b16 a[170:171], v196 offset:2304
v_mfma_f32_16x16x32_bf16 v[84:87], a[172:175], a[200:203], v[84:87]
s_add_u32 m0, s44, 0
v_mfma_f32_16x16x32_bf16 v[116:119], a[172:175], a[204:207], v[116:119]
buffer_load_dwordx4 v136, s[16:19], s42 offen offset:0 lds
v_mfma_f32_16x16x32_bf16 v[88:91], a[176:179], a[200:203], v[88:91]
ds_read_b64_tr_b16 a[172:173], v197 offset:256
ds_read_b64_tr_b16 a[174:175], v197 offset:2304
v_mfma_f32_16x16x32_bf16 v[120:123], a[176:179], a[204:207], v[120:123]
ds_read_b64_tr_b16 a[176:177], v198 offset:256
ds_read_b64_tr_b16 a[178:179], v198 offset:2304
v_mfma_f32_16x16x32_bf16 v[92:95], a[180:183], a[200:203], v[92:95]
v_mfma_f32_16x16x32_bf16 v[124:127], a[180:183], a[204:207], v[124:127]
buffer_load_dwordx4 v137, s[16:19], s42 offen offset:1024 lds
v_mfma_f32_16x16x32_bf16 v[96:99], a[184:187], a[200:203], v[96:99]
ds_read_b64_tr_b16 a[180:181], v199 offset:256
ds_read_b64_tr_b16 a[182:183], v199 offset:2304
v_mfma_f32_16x16x32_bf16 v[128:131], a[184:187], a[204:207], v[128:131]
ds_read_b64_tr_b16 a[184:185], v200 offset:256
ds_read_b64_tr_b16 a[186:187], v200 offset:2304
v_mfma_f32_16x16x32_bf16 v[100:103], a[188:191], a[200:203], v[100:103]
v_mfma_f32_16x16x32_bf16 v[132:135], a[188:191], a[204:207], v[132:135]
s_waitcnt lgkmcnt(8)
ds_read_b64_tr_b16 a[188:189], v201 offset:256
ds_read_b64_tr_b16 a[190:191], v201 offset:2304
s_bitcmp1_b32 s40, 4
s_cbranch_scc1 K_XP4
K_XP4D:
v_mfma_f32_16x16x32_bf16 v[8:11], a[128:131], a[192:195], v[8:11]
buffer_load_dwordx4 v138, s[16:19], s42 offen offset:2048 lds
v_mfma_f32_16x16x32_bf16 v[40:43], a[128:131], a[196:199], v[40:43]
ds_read_b128 a[200:203], v203 offset:0
ds_read_b128 a[204:207], v203 offset:2048
v_mfma_f32_16x16x32_bf16 v[12:15], a[132:135], a[192:195], v[12:15]
v_mfma_f32_16x16x32_bf16 v[44:47], a[132:135], a[196:199], v[44:47]
v_smfmac_f32_16x16x64_bf16 a[248:251], a[208:211], a[128:135], v235
ds_read_b64_tr_b16 a[128:129], v194 offset:16384
ds_read_b64_tr_b16 a[130:131], v194 offset:18432
v_mfma_f32_16x16x32_bf16 v[72:75], a[160:163], a[192:195], v[72:75]
buffer_load_dwordx4 v139, s[16:19], s42 offen offset:3072 lds
v_mfma_f32_16x16x32_bf16 v[104:107], a[160:163], a[196:199], v[104:107]
ds_read_b64_tr_b16 a[132:133], v195 offset:16384
ds_read_b64_tr_b16 a[134:135], v195 offset:18432
v_mfma_f32_16x16x32_bf16 v[76:79], a[164:167], a[192:195], v[76:79]
v_mfma_f32_16x16x32_bf16 v[108:111], a[164:167], a[196:199], v[108:111]
s_add_u32 m0, s44, 4096
v_smfmac_f32_16x16x64_bf16 a[252:255], a[208:211], a[160:167], v235
buffer_load_dwordx4 v140, s[16:19], s42 offen offset:0 lds
v_mfma_f32_16x16x32_bf16 v[16:19], a[136:139], a[192:195], v[16:19]
ds_read_b64_tr_b16 a[160:161], v194 offset:16640
ds_read_b64_tr_b16 a[162:163], v194 offset:18688
v_mfma_f32_16x16x32_bf16 v[48:51], a[136:139], a[196:199], v[48:51]
ds_read_b64_tr_b16 a[164:165], v195 offset:16640
ds_read_b64_tr_b16 a[166:167], v195 offset:18688
v_mfma_f32_16x16x32_bf16 v[20:23], a[140:143], a[192:195], v[20:23]
ds_read_b64_tr_b16 a[136:137], v196 offset:16384
ds_read_b64_tr_b16 a[138:139], v196 offset:18432
v_mfma_f32_16x16x32_bf16 v[52:55], a[140:143], a[196:199], v[52:55]
buffer_load_dwordx4 v141, s[16:19], s42 offen offset:1024 lds
v_mfma_f32_16x16x32_bf16 v[24:27], a[144:147], a[192:195], v[24:27]
ds_read_b64_tr_b16 a[140:141], v197 offset:16384
ds_read_b64_tr_b16 a[142:143], v197 offset:18432
v_mfma_f32_16x16x32_bf16 v[56:59], a[144:147], a[196:199], v[56:59]
ds_read_b64_tr_b16 a[144:145], v198 offset:16384
ds_read_b64_tr_b16 a[146:147], v198 offset:18432
v_mfma_f32_16x16x32_bf16 v[28:31], a[148:151], a[192:195], v[28:31]
v_mfma_f32_16x16x32_bf16 v[60:63], a[148:151], a[196:199], v[60:63]
buffer_load_dwordx4 v142, s[16:19], s42 offen offset:2048 lds
v_mfma_f32_16x16x32_bf16 v[32:35], a[152:155], a[192:195], v[32:35]
ds_read_b64_tr_b16 a[148:149], v199 offset:16384
ds_read_b64_tr_b16 a[150:151], v199 offset:18432
v_mfma_f32_16x16x32_bf16 v[64:67], a[152:155], a[196:199], v[64:67]
ds_read_b64_tr_b16 a[152:153], v200 offset:16384
ds_read_b64_tr_b16 a[154:155], v200 offset:18432
v_mfma_f32_16x16x32_bf16 v[36:39], a[156:159], a[192:195], v[36:39]
v_mfma_f32_16x16x32_bf16 v[68:71], a[156:159], a[196:199], v[68:71]
buffer_load_dwordx4 v143, s[16:19], s42 offen offset:3072 lds
v_mfma_f32_16x16x32_bf16 v[80:83], a[168:171], a[192:195], v[80:83]
s_lshl_b32 s72, s72, 12
ds_read_b64_tr_b16 a[156:157], v201 offset:16384
ds_read_b64_tr_b16 a[158:159], v201 offset:18432
v_mfma_f32_16x16x32_bf16 v[112:115], a[168:171], a[196:199], v[112:115]
s_waitcnt lgkmcnt(10)
s_add_u32 s42, s42, s72
ds_read_b64_tr_b16 a[168:169], v196 offset:16640
ds_read_b64_tr_b16 a[170:171], v196 offset:18688
v_mfma_f32_16x16x32_bf16 v[84:87], a[172:175], a[192:195], v[84:87]
s_lshr_b32 s48, s2, 5
v_mfma_f32_16x16x32_bf16 v[116:119], a[172:175], a[196:199], v[116:119]
s_lshl_b32 s48, s48, 13
ds_read_b64_tr_b16 a[172:173], v197 offset:16640
v_lshlrev_b32 v254, 5, v0
v_mfma_f32_16x16x32_bf16 v[88:91], a[176:179], a[192:195], v[88:91]
buffer_load_dword v252, v254, s[8:11], s48 offen
v_mfma_f32_16x16x32_bf16 v[120:123], a[176:179], a[196:199], v[120:123]
ds_read_b64_tr_b16 a[174:175], v197 offset:18688
ds_read_b64_tr_b16 a[176:177], v198 offset:16640
v_mfma_f32_16x16x32_bf16 v[92:95], a[180:183], a[192:195], v[92:95]
ds_read_b64_tr_b16 a[178:179], v198 offset:18688
v_mfma_f32_16x16x32_bf16 v[124:127], a[180:183], a[196:199], v[124:127]
ds_read_b64_tr_b16 a[180:181], v199 offset:16640
ds_read_b64_tr_b16 a[182:183], v199 offset:18688
v_mfma_f32_16x16x32_bf16 v[96:99], a[184:187], a[192:195], v[96:99]
buffer_load_dword v253, v254, s[12:15], s48 offen
v_mfma_f32_16x16x32_bf16 v[128:131], a[184:187], a[196:199], v[128:131]
ds_read_b64_tr_b16 a[184:185], v200 offset:16640
ds_read_b64_tr_b16 a[186:187], v200 offset:18688
v_mfma_f32_16x16x32_bf16 v[100:103], a[188:191], a[192:195], v[100:103]
v_mfma_f32_16x16x32_bf16 v[132:135], a[188:191], a[196:199], v[132:135]
ds_read_b64_tr_b16 a[188:189], v201 offset:16640
ds_read_b64_tr_b16 a[190:191], v201 offset:18688
v_mfma_f32_16x16x32_bf16 v[8:11], a[128:131], a[200:203], v[8:11]
v_mfma_f32_16x16x32_bf16 v[40:43], a[128:131], a[204:207], v[40:43]
v_mfma_f32_16x16x32_bf16 v[12:15], a[132:135], a[200:203], v[12:15]
v_mfma_f32_16x16x32_bf16 v[44:47], a[132:135], a[204:207], v[44:47]
v_smfmac_f32_16x16x64_bf16 a[248:251], a[208:211], a[128:135], v235
v_mfma_f32_16x16x32_bf16 v[72:75], a[160:163], a[200:203], v[72:75]
v_mfma_f32_16x16x32_bf16 v[104:107], a[160:163], a[204:207], v[104:107]
s_waitcnt vmcnt(14) lgkmcnt(0)
s_barrier
v_mfma_f32_16x16x32_bf16 v[76:79], a[164:167], a[200:203], v[76:79]
s_add_u32 m0, s45, 131072
ds_read_b128 a[192:195], v212 offset:0
ds_read_b128 a[196:199], v212 offset:2048
v_mfma_f32_16x16x32_bf16 v[108:111], a[164:167], a[204:207], v[108:111]
buffer_load_dwordx4 v144, s[24:27], s43 offen offset:0 lds
v_smfmac_f32_16x16x64_bf16 a[252:255], a[208:211], a[160:167], v235
ds_read_b64_tr_b16 a[128:129], v204 offset:0
ds_read_b64_tr_b16 a[130:131], v204 offset:2048
v_mfma_f32_16x16x32_bf16 v[16:19], a[136:139], a[200:203], v[16:19]
ds_read_b64_tr_b16 a[132:133], v205 offset:0
ds_read_b64_tr_b16 a[134:135], v205 offset:2048
v_mfma_f32_16x16x32_bf16 v[48:51], a[136:139], a[204:207], v[48:51]
ds_read_b64_tr_b16 a[160:161], v204 offset:256
ds_read_b64_tr_b16 a[162:163], v204 offset:2304
v_mfma_f32_16x16x32_bf16 v[20:23], a[140:143], a[200:203], v[20:23]
buffer_load_dwordx4 v145, s[24:27], s43 offen offset:1024 lds
v_mfma_f32_16x16x32_bf16 v[52:55], a[140:143], a[204:207], v[52:55]
ds_read_b64_tr_b16 a[164:165], v205 offset:256
ds_read_b64_tr_b16 a[166:167], v205 offset:2304
v_mfma_f32_16x16x32_bf16 v[24:27], a[144:147], a[200:203], v[24:27]
ds_read_b64_tr_b16 a[136:137], v206 offset:0
ds_read_b64_tr_b16 a[138:139], v206 offset:2048
v_mfma_f32_16x16x32_bf16 v[56:59], a[144:147], a[204:207], v[56:59]
s_add_u32 m0, s85, 131072
ds_read_b64_tr_b16 a[140:141], v207 offset:0
ds_read_b64_tr_b16 a[142:143], v207 offset:2048
v_mfma_f32_16x16x32_bf16 v[28:31], a[148:151], a[200:203], v[28:31]
buffer_load_dwordx4 v146, s[24:27], s43 offen offset:0 lds
v_mfma_f32_16x16x32_bf16 v[60:63], a[148:151], a[204:207], v[60:63]
ds_read_b64_tr_b16 a[144:145], v208 offset:0
ds_read_b64_tr_b16 a[146:147], v208 offset:2048
v_mfma_f32_16x16x32_bf16 v[32:35], a[152:155], a[200:203], v[32:35]
ds_read_b64_tr_b16 a[148:149], v209 offset:0
ds_read_b64_tr_b16 a[150:151], v209 offset:2048
v_mfma_f32_16x16x32_bf16 v[64:67], a[152:155], a[204:207], v[64:67]
ds_read_b64_tr_b16 a[152:153], v210 offset:0
ds_read_b64_tr_b16 a[154:155], v210 offset:2048
v_mfma_f32_16x16x32_bf16 v[36:39], a[156:159], a[200:203], v[36:39]
v_mfma_f32_16x16x32_bf16 v[68:71], a[156:159], a[204:207], v[68:71]
buffer_load_dwordx4 v147, s[24:27], s43 offen offset:1024 lds
v_mfma_f32_16x16x32_bf16 v[80:83], a[168:171], a[200:203], v[80:83]
s_cmp_eq_u32 s74, 1
s_cselect_b32 s72, s73, 128
ds_read_b64_tr_b16 a[156:157], v211 offset:0
ds_read_b64_tr_b16 a[158:159], v211 offset:2048
v_mfma_f32_16x16x32_bf16 v[112:115], a[168:171], a[204:207], v[112:115]
s_add_u32 s43, s43, s72
ds_read_b64_tr_b16 a[168:169], v206 offset:256
ds_read_b64_tr_b16 a[170:171], v206 offset:2304
v_mfma_f32_16x16x32_bf16 v[84:87], a[172:175], a[200:203], v[84:87]
s_add_u32 m0, s44, 98304
v_mfma_f32_16x16x32_bf16 v[116:119], a[172:175], a[204:207], v[116:119]
buffer_load_dwordx4 v136, s[16:19], s42 offen offset:0 lds
v_mfma_f32_16x16x32_bf16 v[88:91], a[176:179], a[200:203], v[88:91]
ds_read_b64_tr_b16 a[172:173], v207 offset:256
ds_read_b64_tr_b16 a[174:175], v207 offset:2304
v_mfma_f32_16x16x32_bf16 v[120:123], a[176:179], a[204:207], v[120:123]
ds_read_b64_tr_b16 a[176:177], v208 offset:256
ds_read_b64_tr_b16 a[178:179], v208 offset:2304
v_mfma_f32_16x16x32_bf16 v[92:95], a[180:183], a[200:203], v[92:95]
v_mfma_f32_16x16x32_bf16 v[124:127], a[180:183], a[204:207], v[124:127]
buffer_load_dwordx4 v137, s[16:19], s42 offen offset:1024 lds
v_mfma_f32_16x16x32_bf16 v[96:99], a[184:187], a[200:203], v[96:99]
ds_read_b64_tr_b16 a[180:181], v209 offset:256
ds_read_b64_tr_b16 a[182:183], v209 offset:2304
v_mfma_f32_16x16x32_bf16 v[128:131], a[184:187], a[204:207], v[128:131]
ds_read_b64_tr_b16 a[184:185], v210 offset:256
ds_read_b64_tr_b16 a[186:187], v210 offset:2304
v_mfma_f32_16x16x32_bf16 v[100:103], a[188:191], a[200:203], v[100:103]
v_mfma_f32_16x16x32_bf16 v[132:135], a[188:191], a[204:207], v[132:135]
s_waitcnt lgkmcnt(8)
ds_read_b64_tr_b16 a[188:189], v211 offset:256
ds_read_b64_tr_b16 a[190:191], v211 offset:2304
s_bitcmp1_b32 s40, 5
s_cbranch_scc1 K_XP5
K_XP5D:
v_mfma_f32_16x16x32_bf16 v[8:11], a[128:131], a[192:195], v[8:11]
buffer_load_dwordx4 v138, s[16:19], s42 offen offset:2048 lds
v_mfma_f32_16x16x32_bf16 v[40:43], a[128:131], a[196:199], v[40:43]
ds_read_b128 a[200:203], v213 offset:0
ds_read_b128 a[204:207], v213 offset:2048
v_mfma_f32_16x16x32_bf16 v[12:15], a[132:135], a[192:195], v[12:15]
v_mfma_f32_16x16x32_bf16 v[44:47], a[132:135], a[196:199], v[44:47]
v_smfmac_f32_16x16x64_bf16 a[248:251], a[208:211], a[128:135], v235
buffer_load_dwordx4 v139, s[16:19], s42 offen offset:3072 lds
v_mfma_f32_16x16x32_bf16 v[72:75], a[160:163], a[192:195], v[72:75]
ds_read_b64_tr_b16 a[128:129], v204 offset:16384
ds_read_b64_tr_b16 a[130:131], v204 offset:18432
v_mfma_f32_16x16x32_bf16 v[104:107], a[160:163], a[196:199], v[104:107]
ds_read_b64_tr_b16 a[132:133], v205 offset:16384
ds_read_b64_tr_b16 a[134:135], v205 offset:18432
v_mfma_f32_16x16x32_bf16 v[76:79], a[164:167], a[192:195], v[76:79]
v_mfma_f32_16x16x32_bf16 v[108:111], a[164:167], a[196:199], v[108:111]
s_add_u32 m0, s44, 102400
v_smfmac_f32_16x16x64_bf16 a[252:255], a[208:211], a[160:167], v235
buffer_load_dwordx4 v140, s[16:19], s42 offen offset:0 lds
v_mfma_f32_16x16x32_bf16 v[16:19], a[136:139], a[192:195], v[16:19]
ds_read_b64_tr_b16 a[160:161], v204 offset:16640
ds_read_b64_tr_b16 a[162:163], v204 offset:18688
v_mfma_f32_16x16x32_bf16 v[48:51], a[136:139], a[196:199], v[48:51]
ds_read_b64_tr_b16 a[164:165], v205 offset:16640
ds_read_b64_tr_b16 a[166:167], v205 offset:18688
v_mfma_f32_16x16x32_bf16 v[20:23], a[140:143], a[192:195], v[20:23]
ds_read_b64_tr_b16 a[136:137], v206 offset:16384
ds_read_b64_tr_b16 a[138:139], v206 offset:18432
v_mfma_f32_16x16x32_bf16 v[52:55], a[140:143], a[196:199], v[52:55]
buffer_load_dwordx4 v141, s[16:19], s42 offen offset:1024 lds
v_mfma_f32_16x16x32_bf16 v[24:27], a[144:147], a[192:195], v[24:27]
ds_read_b64_tr_b16 a[140:141], v207 offset:16384
ds_read_b64_tr_b16 a[142:143], v207 offset:18432
v_mfma_f32_16x16x32_bf16 v[56:59], a[144:147], a[196:199], v[56:59]
ds_read_b64_tr_b16 a[144:145], v208 offset:16384
ds_read_b64_tr_b16 a[146:147], v208 offset:18432
v_mfma_f32_16x16x32_bf16 v[28:31], a[148:151], a[192:195], v[28:31]
v_mfma_f32_16x16x32_bf16 v[60:63], a[148:151], a[196:199], v[60:63]
buffer_load_dwordx4 v142, s[16:19], s42 offen offset:2048 lds
v_mfma_f32_16x16x32_bf16 v[32:35], a[152:155], a[192:195], v[32:35]
ds_read_b64_tr_b16 a[148:149], v209 offset:16384
ds_read_b64_tr_b16 a[150:151], v209 offset:18432
v_mfma_f32_16x16x32_bf16 v[64:67], a[152:155], a[196:199], v[64:67]
ds_read_b64_tr_b16 a[152:153], v210 offset:16384
ds_read_b64_tr_b16 a[154:155], v210 offset:18432
v_mfma_f32_16x16x32_bf16 v[36:39], a[156:159], a[192:195], v[36:39]
v_mfma_f32_16x16x32_bf16 v[68:71], a[156:159], a[196:199], v[68:71]
buffer_load_dwordx4 v143, s[16:19], s42 offen offset:3072 lds
v_mfma_f32_16x16x32_bf16 v[80:83], a[168:171], a[192:195], v[80:83]
s_waitcnt lgkmcnt(8)
ds_read_b64_tr_b16 a[156:157], v211 offset:16384
ds_read_b64_tr_b16 a[158:159], v211 offset:18432
v_mfma_f32_16x16x32_bf16 v[112:115], a[168:171], a[196:199], v[112:115]
s_lshl_b32 s72, s72, 12
ds_read_b64_tr_b16 a[168:169], v206 offset:16640
ds_read_b64_tr_b16 a[170:171], v206 offset:18688
v_mfma_f32_16x16x32_bf16 v[84:87], a[172:175], a[192:195], v[84:87]
s_add_u32 s42, s42, s72
v_mfma_f32_16x16x32_bf16 v[116:119], a[172:175], a[196:199], v[116:119]
ds_read_b64_tr_b16 a[172:173], v207 offset:16640
ds_read_b64_tr_b16 a[174:175], v207 offset:18688
v_mfma_f32_16x16x32_bf16 v[88:91], a[176:179], a[192:195], v[88:91]
v_mfma_f32_16x16x32_bf16 v[120:123], a[176:179], a[196:199], v[120:123]
ds_read_b64_tr_b16 a[176:177], v208 offset:16640
ds_read_b64_tr_b16 a[178:179], v208 offset:18688
v_mfma_f32_16x16x32_bf16 v[92:95], a[180:183], a[192:195], v[92:95]
v_mfma_f32_16x16x32_bf16 v[124:127], a[180:183], a[196:199], v[124:127]
ds_read_b64_tr_b16 a[180:181], v209 offset:16640
ds_read_b64_tr_b16 a[182:183], v209 offset:18688
v_mfma_f32_16x16x32_bf16 v[96:99], a[184:187], a[192:195], v[96:99]
v_mfma_f32_16x16x32_bf16 v[128:131], a[184:187], a[196:199], v[128:131]
ds_read_b64_tr_b16 a[184:185], v210 offset:16640
ds_read_b64_tr_b16 a[186:187], v210 offset:18688
v_mfma_f32_16x16x32_bf16 v[100:103], a[188:191], a[192:195], v[100:103]
v_mfma_f32_16x16x32_bf16 v[132:135], a[188:191], a[196:199], v[132:135]
ds_read_b64_tr_b16 a[188:189], v211 offset:16640
ds_read_b64_tr_b16 a[190:191], v211 offset:18688
v_mfma_f32_16x16x32_bf16 v[8:11], a[128:131], a[200:203], v[8:11]
v_mfma_f32_16x16x32_bf16 v[40:43], a[128:131], a[204:207], v[40:43]
v_mfma_f32_16x16x32_bf16 v[12:15], a[132:135], a[200:203], v[12:15]
v_mfma_f32_16x16x32_bf16 v[44:47], a[132:135], a[204:207], v[44:47]
v_smfmac_f32_16x16x64_bf16 a[248:251], a[208:211], a[128:135], v235
v_mfma_f32_16x16x32_bf16 v[72:75], a[160:163], a[200:203], v[72:75]
v_mfma_f32_16x16x32_bf16 v[104:107], a[160:163], a[204:207], v[104:107]
s_waitcnt vmcnt(14) lgkmcnt(0)
s_barrier
s_cmp_lg_u32 s32, 0
s_cbranch_scc1 K_W0_11
v_lshlrev_b32 v255, 4, v3
buffer_load_dword v254, v255, s[28:31], 0 offen sc0 sc1
K_W0_11:
v_mfma_f32_16x16x32_bf16 v[76:79], a[164:167], a[200:203], v[76:79]
s_add_u32 m0, s45, 81920
ds_read_b128 a[192:195], v192 offset:0
ds_read_b128 a[196:199], v192 offset:2048
v_mfma_f32_16x16x32_bf16 v[108:111], a[164:167], a[204:207], v[108:111]
buffer_load_dwordx4 v144, s[24:27], s43 offen offset:0 lds
v_smfmac_f32_16x16x64_bf16 a[252:255], a[208:211], a[160:167], v235
ds_read_b64_tr_b16 a[128:129], v184 offset:0
ds_read_b64_tr_b16 a[130:131], v184 offset:2048
v_mfma_f32_16x16x32_bf16 v[16:19], a[136:139], a[200:203], v[16:19]
ds_read_b64_tr_b16 a[132:133], v185 offset:0
ds_read_b64_tr_b16 a[134:135], v185 offset:2048
v_mfma_f32_16x16x32_bf16 v[48:51], a[136:139], a[204:207], v[48:51]
ds_read_b64_tr_b16 a[160:161], v184 offset:256
ds_read_b64_tr_b16 a[162:163], v184 offset:2304
v_mfma_f32_16x16x32_bf16 v[20:23], a[140:143], a[200:203], v[20:23]
ds_read_b64_tr_b16 a[164:165], v185 offset:256
ds_read_b64_tr_b16 a[166:167], v185 offset:2304
v_mfma_f32_16x16x32_bf16 v[52:55], a[140:143], a[204:207], v[52:55]
buffer_load_dwordx4 v145, s[24:27], s43 offen offset:1024 lds
v_mfma_f32_16x16x32_bf16 v[24:27], a[144:147], a[200:203], v[24:27]
ds_read_b64_tr_b16 a[136:137], v186 offset:0
ds_read_b64_tr_b16 a[138:139], v186 offset:2048
v_mfma_f32_16x16x32_bf16 v[56:59], a[144:147], a[204:207], v[56:59]
ds_read_b64_tr_b16 a[140:141], v187 offset:0
ds_read_b64_tr_b16 a[142:143], v187 offset:2048
v_mfma_f32_16x16x32_bf16 v[28:31], a[148:151], a[200:203], v[28:31]
s_add_u32 m0, s85, 81920
ds_read_b64_tr_b16 a[144:145], v188 offset:0
ds_read_b64_tr_b16 a[146:147], v188 offset:2048
v_mfma_f32_16x16x32_bf16 v[60:63], a[148:151], a[204:207], v[60:63]
buffer_load_dwordx4 v146, s[24:27], s43 offen offset:0 lds
v_mfma_f32_16x16x32_bf16 v[32:35], a[152:155], a[200:203], v[32:35]
ds_read_b64_tr_b16 a[148:149], v189 offset:0
ds_read_b64_tr_b16 a[150:151], v189 offset:2048
v_mfma_f32_16x16x32_bf16 v[64:67], a[152:155], a[204:207], v[64:67]
ds_read_b64_tr_b16 a[152:153], v190 offset:0
ds_read_b64_tr_b16 a[154:155], v190 offset:2048
v_mfma_f32_16x16x32_bf16 v[36:39], a[156:159], a[200:203], v[36:39]
v_mfma_f32_16x16x32_bf16 v[68:71], a[156:159], a[204:207], v[68:71]
buffer_load_dwordx4 v147, s[24:27], s43 offen offset:1024 lds
v_mfma_f32_16x16x32_bf16 v[80:83], a[168:171], a[200:203], v[80:83]
s_cmp_eq_u32 s74, 0
s_cselect_b32 s72, s73, 128
ds_read_b64_tr_b16 a[156:157], v191 offset:0
ds_read_b64_tr_b16 a[158:159], v191 offset:2048
v_mfma_f32_16x16x32_bf16 v[112:115], a[168:171], a[204:207], v[112:115]
s_add_u32 s43, s43, s72
ds_read_b64_tr_b16 a[168:169], v186 offset:256
ds_read_b64_tr_b16 a[170:171], v186 offset:2304
v_mfma_f32_16x16x32_bf16 v[84:87], a[172:175], a[200:203], v[84:87]
s_add_u32 m0, s44, 49152
v_mfma_f32_16x16x32_bf16 v[116:119], a[172:175], a[204:207], v[116:119]
buffer_load_dwordx4 v136, s[16:19], s42 offen offset:0 lds
v_mfma_f32_16x16x32_bf16 v[88:91], a[176:179], a[200:203], v[88:91]
ds_read_b64_tr_b16 a[172:173], v187 offset:256
ds_read_b64_tr_b16 a[174:175], v187 offset:2304
v_mfma_f32_16x16x32_bf16 v[120:123], a[176:179], a[204:207], v[120:123]
ds_read_b64_tr_b16 a[176:177], v188 offset:256
ds_read_b64_tr_b16 a[178:179], v188 offset:2304
v_mfma_f32_16x16x32_bf16 v[92:95], a[180:183], a[200:203], v[92:95]
v_mfma_f32_16x16x32_bf16 v[124:127], a[180:183], a[204:207], v[124:127]
buffer_load_dwordx4 v137, s[16:19], s42 offen offset:1024 lds
v_mfma_f32_16x16x32_bf16 v[96:99], a[184:187], a[200:203], v[96:99]
ds_read_b64_tr_b16 a[180:181], v189 offset:256
ds_read_b64_tr_b16 a[182:183], v189 offset:2304
v_mfma_f32_16x16x32_bf16 v[128:131], a[184:187], a[204:207], v[128:131]
ds_read_b64_tr_b16 a[184:185], v190 offset:256
ds_read_b64_tr_b16 a[186:187], v190 offset:2304
v_mfma_f32_16x16x32_bf16 v[100:103], a[188:191], a[200:203], v[100:103]
v_mfma_f32_16x16x32_bf16 v[132:135], a[188:191], a[204:207], v[132:135]
s_waitcnt lgkmcnt(8)
ds_read_b64_tr_b16 a[188:189], v191 offset:256
ds_read_b64_tr_b16 a[190:191], v191 offset:2304
s_bitcmp1_b32 s40, 6
s_cbranch_scc1 K_XP6
K_XP6D:
v_mfma_f32_16x16x32_bf16 v[8:11], a[128:131], a[192:195], v[8:11]
buffer_load_dwordx4 v138, s[16:19], s42 offen offset:2048 lds
v_mfma_f32_16x16x32_bf16 v[40:43], a[128:131], a[196:199], v[40:43]
ds_read_b128 a[200:203], v193 offset:0
ds_read_b128 a[204:207], v193 offset:2048
v_mfma_f32_16x16x32_bf16 v[12:15], a[132:135], a[192:195], v[12:15]
v_mfma_f32_16x16x32_bf16 v[44:47], a[132:135], a[196:199], v[44:47]
v_smfmac_f32_16x16x64_bf16 a[248:251], a[208:211], a[128:135], v235
buffer_load_dwordx4 v139, s[16:19], s42 offen offset:3072 lds
v_mfma_f32_16x16x32_bf16 v[72:75], a[160:163], a[192:195], v[72:75]
ds_read_b64_tr_b16 a[128:129], v184 offset:16384
ds_read_b64_tr_b16 a[130:131], v184 offset:18432
v_mfma_f32_16x16x32_bf16 v[104:107], a[160:163], a[196:199], v[104:107]
ds_read_b64_tr_b16 a[132:133], v185 offset:16384
ds_read_b64_tr_b16 a[134:135], v185 offset:18432
v_mfma_f32_16x16x32_bf16 v[76:79], a[164:167], a[192:195], v[76:79]
s_add_u32 m0, s44, 53248
v_mfma_f32_16x16x32_bf16 v[108:111], a[164:167], a[196:199], v[108:111]
buffer_load_dwordx4 v140, s[16:19], s42 offen offset:0 lds
v_smfmac_f32_16x16x64_bf16 a[252:255], a[208:211], a[160:167], v235
ds_read_b64_tr_b16 a[160:161], v184 offset:16640
ds_read_b64_tr_b16 a[162:163], v184 offset:18688
v_mfma_f32_16x16x32_bf16 v[16:19], a[136:139], a[192:195], v[16:19]
ds_read_b64_tr_b16 a[164:165], v185 offset:16640
ds_read_b64_tr_b16 a[166:167], v185 offset:18688
v_mfma_f32_16x16x32_bf16 v[48:51], a[136:139], a[196:199], v[48:51]
ds_read_b64_tr_b16 a[136:137], v186 offset:16384
ds_read_b64_tr_b16 a[138:139], v186 offset:18432
v_mfma_f32_16x16x32_bf16 v[20:23], a[140:143], a[192:195], v[20:23]
buffer_load_dwordx4 v141, s[16:19], s42 offen offset:1024 lds
v_mfma_f32_16x16x32_bf16 v[52:55], a[140:143], a[196:199], v[52:55]
ds_read_b64_tr_b16 a[140:141], v187 offset:16384
ds_read_b64_tr_b16 a[142:143], v187 offset:18432
v_mfma_f32_16x16x32_bf16 v[24:27], a[144:147], a[192:195], v[24:27]
v_mfma_f32_16x16x32_bf16 v[56:59], a[144:147], a[196:199], v[56:59]
ds_read_b64_tr_b16 a[144:145], v188 offset:16384
ds_read_b64_tr_b16 a[146:147], v188 offset:18432
v_mfma_f32_16x16x32_bf16 v[28:31], a[148:151], a[192:195], v[28:31]
buffer_load_dwordx4 v142, s[16:19], s42 offen offset:2048 lds
v_mfma_f32_16x16x32_bf16 v[60:63], a[148:151], a[196:199], v[60:63]
ds_read_b64_tr_b16 a[148:149], v189 offset:16384
ds_read_b64_tr_b16 a[150:151], v189 offset:18432
v_mfma_f32_16x16x32_bf16 v[32:35], a[152:155], a[192:195], v[32:35]
v_mfma_f32_16x16x32_bf16 v[64:67], a[152:155], a[196:199], v[64:67]
ds_read_b64_tr_b16 a[152:153], v190 offset:16384
ds_read_b64_tr_b16 a[154:155], v190 offset:18432
v_mfma_f32_16x16x32_bf16 v[36:39], a[156:159], a[192:195], v[36:39]
v_mfma_f32_16x16x32_bf16 v[68:71], a[156:159], a[196:199], v[68:71]
buffer_load_dwordx4 v143, s[16:19], s42 offen offset:3072 lds
v_mfma_f32_16x16x32_bf16 v[80:83], a[168:171], a[192:195], v[80:83]
s_waitcnt lgkmcnt(8)
ds_read_b64_tr_b16 a[156:157], v191 offset:16384
ds_read_b64_tr_b16 a[158:159], v191 offset:18432
v_mfma_f32_16x16x32_bf16 v[112:115], a[168:171], a[196:199], v[112:115]
s_lshl_b32 s72, s72, 12
ds_read_b64_tr_b16 a[168:169], v186 offset:16640
ds_read_b64_tr_b16 a[170:171], v186 offset:18688
v_mfma_f32_16x16x32_bf16 v[84:87], a[172:175], a[192:195], v[84:87]
s_add_u32 s42, s42, s72
v_mfma_f32_16x16x32_bf16 v[116:119], a[172:175], a[196:199], v[116:119]
ds_read_b64_tr_b16 a[172:173], v187 offset:16640
ds_read_b64_tr_b16 a[174:175], v187 offset:18688
v_mfma_f32_16x16x32_bf16 v[88:91], a[176:179], a[192:195], v[88:91]
v_mfma_f32_16x16x32_bf16 v[120:123], a[176:179], a[196:199], v[120:123]
ds_read_b64_tr_b16 a[176:177], v188 offset:16640
ds_read_b64_tr_b16 a[178:179], v188 offset:18688
v_mfma_f32_16x16x32_bf16 v[92:95], a[180:183], a[192:195], v[92:95]
v_mfma_f32_16x16x32_bf16 v[124:127], a[180:183], a[196:199], v[124:127]
ds_read_b64_tr_b16 a[180:181], v189 offset:16640
ds_read_b64_tr_b16 a[182:183], v189 offset:18688
v_mfma_f32_16x16x32_bf16 v[96:99], a[184:187], a[192:195], v[96:99]
v_mfma_f32_16x16x32_bf16 v[128:131], a[184:187], a[196:199], v[128:131]
ds_read_b64_tr_b16 a[184:185], v190 offset:16640
ds_read_b64_tr_b16 a[186:187], v190 offset:18688
v_mfma_f32_16x16x32_bf16 v[100:103], a[188:191], a[192:195], v[100:103]
v_mfma_f32_16x16x32_bf16 v[132:135], a[188:191], a[196:199], v[132:135]
ds_read_b64_tr_b16 a[188:189], v191 offset:16640
ds_read_b64_tr_b16 a[190:191], v191 offset:18688
v_mfma_f32_16x16x32_bf16 v[8:11], a[128:131], a[200:203], v[8:11]
v_mfma_f32_16x16x32_bf16 v[40:43], a[128:131], a[204:207], v[40:43]
v_mfma_f32_16x16x32_bf16 v[12:15], a[132:135], a[200:203], v[12:15]
v_mfma_f32_16x16x32_bf16 v[44:47], a[132:135], a[204:207], v[44:47]
v_smfmac_f32_16x16x64_bf16 a[248:251], a[208:211], a[128:135], v235
v_mfma_f32_16x16x32_bf16 v[72:75], a[160:163], a[200:203], v[72:75]
v_mfma_f32_16x16x32_bf16 v[104:107], a[160:163], a[204:207], v[104:107]
s_cmp_lg_u32 s32, 0
s_cbranch_scc1 K_CNTOK
s_waitcnt vmcnt(12)
v_cmp_gt_u32 vcc, 16, v254
s_cbranch_vccz K_CNTOK
K_CNTSPIN:
s_sleep 2
s_add_u32 s100, s100, 1
s_bitcmp1_b32 s100, 19
s_cbranch_scc1 K_END
buffer_load_dword v254, v255, s[28:31], 0 offen sc0 sc1
s_waitcnt vmcnt(0)
v_cmp_gt_u32 vcc, 16, v254
s_cbranch_vccnz K_CNTSPIN
K_CNTOK:
s_waitcnt vmcnt(12) lgkmcnt(0)
s_barrier
v_mfma_f32_16x16x32_bf16 v[76:79], a[164:167], a[200:203], v[76:79]
s_mov_b32 s38, 0
ds_read_b128 a[192:195], v202 offset:0
ds_read_b128 a[196:199], v202 offset:2048
v_mfma_f32_16x16x32_bf16 v[108:111], a[164:167], a[204:207], v[108:111]
s_add_u32 m0, s37, 32768
ds_read_b64_tr_b16 a[128:129], v194 offset:0
ds_read_b64_tr_b16 a[130:131], v194 offset:2048
v_smfmac_f32_16x16x64_bf16 a[252:255], a[208:211], a[160:167], v235
buffer_load_dwordx4 v228, s[8:11], s38 offen offset:0 lds
v_mfma_f32_16x16x32_bf16 v[16:19], a[136:139], a[200:203], v[16:19]
ds_read_b64_tr_b16 a[132:133], v195 offset:0
ds_read_b64_tr_b16 a[134:135], v195 offset:2048
v_mfma_f32_16x16x32_bf16 v[48:51], a[136:139], a[204:207], v[48:51]
ds_read_b64_tr_b16 a[160:161], v194 offset:256
ds_read_b64_tr_b16 a[162:163], v194 offset:2304
v_mfma_f32_16x16x32_bf16 v[20:23], a[140:143], a[200:203], v[20:23]
ds_read_b64_tr_b16 a[164:165], v195 offset:256
ds_read_b64_tr_b16 a[166:167], v195 offset:2304
v_mfma_f32_16x16x32_bf16 v[52:55], a[140:143], a[204:207], v[52:55]
buffer_load_dwordx4 v229, s[8:11], s38 offen offset:1024 lds
v_mfma_f32_16x16x32_bf16 v[24:27], a[144:147], a[200:203], v[24:27]
ds_read_b64_tr_b16 a[136:137], v196 offset:0
ds_read_b64_tr_b16 a[138:139], v196 offset:2048
v_mfma_f32_16x16x32_bf16 v[56:59], a[144:147], a[204:207], v[56:59]
ds_read_b64_tr_b16 a[140:141], v197 offset:0
ds_read_b64_tr_b16 a[142:143], v197 offset:2048
v_mfma_f32_16x16x32_bf16 v[28:31], a[148:151], a[200:203], v[28:31]
ds_read_b64_tr_b16 a[144:145], v198 offset:0
ds_read_b64_tr_b16 a[146:147], v198 offset:2048
v_mfma_f32_16x16x32_bf16 v[60:63], a[148:151], a[204:207], v[60:63]
buffer_load_dwordx4 v230, s[8:11], s38 offen offset:2048 lds
v_mfma_f32_16x16x32_bf16 v[32:35], a[152:155], a[200:203], v[32:35]
ds_read_b64_tr_b16 a[148:149], v199 offset:0
ds_read_b64_tr_b16 a[150:151], v199 offset:2048
v_mfma_f32_16x16x32_bf16 v[64:67], a[152:155], a[204:207], v[64:67]
ds_read_b64_tr_b16 a[152:153], v200 offset:0
ds_read_b64_tr_b16 a[154:155], v200 offset:2048
v_mfma_f32_16x16x32_bf16 v[36:39], a[156:159], a[200:203], v[36:39]
v_mfma_f32_16x16x32_bf16 v[68:71], a[156:159], a[204:207], v[68:71]
buffer_load_dwordx4 v231, s[8:11], s38 offen offset:3072 lds
v_mfma_f32_16x16x32_bf16 v[80:83], a[168:171], a[200:203], v[80:83]
ds_read_b64_tr_b16 a[156:157], v201 offset:0
ds_read_b64_tr_b16 a[158:159], v201 offset:2048
v_mfma_f32_16x16x32_bf16 v[112:115], a[168:171], a[204:207], v[112:115]
ds_read_b64_tr_b16 a[168:169], v196 offset:256
ds_read_b64_tr_b16 a[170:171], v196 offset:2304
v_mfma_f32_16x16x32_bf16 v[84:87], a[172:175], a[200:203], v[84:87]
s_add_u32 s38, s38, 16384
v_mfma_f32_16x16x32_bf16 v[116:119], a[172:175], a[204:207], v[116:119]
s_add_u32 m0, s37, 16384
ds_read_b64_tr_b16 a[172:173], v197 offset:256
ds_read_b64_tr_b16 a[174:175], v197 offset:2304
v_mfma_f32_16x16x32_bf16 v[88:91], a[176:179], a[200:203], v[88:91]
buffer_load_dwordx4 v228, s[8:11], s38 offen offset:0 lds
v_mfma_f32_16x16x32_bf16 v[120:123], a[176:179], a[204:207], v[120:123]
ds_read_b64_tr_b16 a[176:177], v198 offset:256
ds_read_b64_tr_b16 a[178:179], v198 offset:2304
v_mfma_f32_16x16x32_bf16 v[92:95], a[180:183], a[200:203], v[92:95]
v_mfma_f32_16x16x32_bf16 v[124:127], a[180:183], a[204:207], v[124:127]
ds_read_b64_tr_b16 a[180:181], v199 offset:256
ds_read_b64_tr_b16 a[182:183], v199 offset:2304
v_mfma_f32_16x16x32_bf16 v[96:99], a[184:187], a[200:203], v[96:99]
buffer_load_dwordx4 v229, s[8:11], s38 offen offset:1024 lds
v_mfma_f32_16x16x32_bf16 v[128:131], a[184:187], a[204:207], v[128:131]
ds_read_b64_tr_b16 a[184:185], v200 offset:256
ds_read_b64_tr_b16 a[186:187], v200 offset:2304
v_mfma_f32_16x16x32_bf16 v[100:103], a[188:191], a[200:203], v[100:103]
v_mfma_f32_16x16x32_bf16 v[132:135], a[188:191], a[204:207], v[132:135]
s_waitcnt lgkmcnt(8)
ds_read_b64_tr_b16 a[188:189], v201 offset:256
ds_read_b64_tr_b16 a[190:191], v201 offset:2304
s_bitcmp1_b32 s40, 7
s_cbranch_scc1 K_XP7
K_XP7D:
v_mfma_f32_16x16x32_bf16 v[8:11], a[128:131], a[192:195], v[8:11]
buffer_load_dwordx4 v230, s[8:11], s38 offen offset:2048 lds
v_mfma_f32_16x16x32_bf16 v[40:43], a[128:131], a[196:199], v[40:43]
ds_read_b128 a[200:203], v203 offset:0
ds_read_b128 a[204:207], v203 offset:2048
v_mfma_f32_16x16x32_bf16 v[12:15], a[132:135], a[192:195], v[12:15]
v_mfma_f32_16x16x32_bf16 v[44:47], a[132:135], a[196:199], v[44:47]
v_smfmac_f32_16x16x64_bf16 a[248:251], a[208:211], a[128:135], v235
buffer_load_dwordx4 v231, s[8:11], s38 offen offset:3072 lds
v_mfma_f32_16x16x32_bf16 v[72:75], a[160:163], a[192:195], v[72:75]
ds_read_b64_tr_b16 a[128:129], v194 offset:16384
ds_read_b64_tr_b16 a[130:131], v194 offset:18432
v_mfma_f32_16x16x32_bf16 v[104:107], a[160:163], a[196:199], v[104:107]
s_add_u32 s38, s38, 16384
ds_read_b64_tr_b16 a[132:133], v195 offset:16384
ds_read_b64_tr_b16 a[134:135], v195 offset:18432
v_mfma_f32_16x16x32_bf16 v[76:79], a[164:167], a[192:195], v[76:79]
s_add_u32 m0, s37, 0
v_mfma_f32_16x16x32_bf16 v[108:111], a[164:167], a[196:199], v[108:111]
buffer_load_dwordx4 v228, s[8:11], s38 offen offset:0 lds
v_smfmac_f32_16x16x64_bf16 a[252:255], a[208:211], a[160:167], v235
ds_read_b64_tr_b16 a[160:161], v194 offset:16640
ds_read_b64_tr_b16 a[162:163], v194 offset:18688
v_mfma_f32_16x16x32_bf16 v[16:19], a[136:139], a[192:195], v[16:19]
ds_read_b64_tr_b16 a[164:165], v195 offset:16640
ds_read_b64_tr_b16 a[166:167], v195 offset:18688
v_mfma_f32_16x16x32_bf16 v[48:51], a[136:139], a[196:199], v[48:51]
ds_read_b64_tr_b16 a[136:137], v196 offset:16384
ds_read_b64_tr_b16 a[138:139], v196 offset:18432
v_mfma_f32_16x16x32_bf16 v[20:23], a[140:143], a[192:195], v[20:23]
v_mfma_f32_16x16x32_bf16 v[52:55], a[140:143], a[196:199], v[52:55]
buffer_load_dwordx4 v229, s[8:11], s38 offen offset:1024 lds
v_mfma_f32_16x16x32_bf16 v[24:27], a[144:147], a[192:195], v[24:27]
ds_read_b64_tr_b16 a[140:141], v197 offset:16384
ds_read_b64_tr_b16 a[142:143], v197 offset:18432
v_mfma_f32_16x16x32_bf16 v[56:59], a[144:147], a[196:199], v[56:59]
ds_read_b64_tr_b16 a[144:145], v198 offset:16384
ds_read_b64_tr_b16 a[146:147], v198 offset:18432
v_mfma_f32_16x16x32_bf16 v[28:31], a[148:151], a[192:195], v[28:31]
v_mfma_f32_16x16x32_bf16 v[60:63], a[148:151], a[196:199], v[60:63]
buffer_load_dwordx4 v230, s[8:11], s38 offen offset:2048 lds
v_mfma_f32_16x16x32_bf16 v[32:35], a[152:155], a[192:195], v[32:35]
ds_read_b64_tr_b16 a[148:149], v199 offset:16384
ds_read_b64_tr_b16 a[150:151], v199 offset:18432
v_mfma_f32_16x16x32_bf16 v[64:67], a[152:155], a[196:199], v[64:67]
ds_read_b64_tr_b16 a[152:153], v200 offset:16384
ds_read_b64_tr_b16 a[154:155], v200 offset:18432
v_mfma_f32_16x16x32_bf16 v[36:39], a[156:159], a[192:195], v[36:39]
v_mfma_f32_16x16x32_bf16 v[68:71], a[156:159], a[196:199], v[68:71]
buffer_load_dwordx4 v231, s[8:11], s38 offen offset:3072 lds
v_mfma_f32_16x16x32_bf16 v[80:83], a[168:171], a[192:195], v[80:83]
s_add_u32 s38, s38, 16384
ds_read_b64_tr_b16 a[156:157], v201 offset:16384
v_lshlrev_b32 v255, 3, v3
v_mfma_f32_16x16x32_bf16 v[112:115], a[168:171], a[196:199], v[112:115]
s_waitcnt lgkmcnt(9)
s_lshl_b32 s48, s55, 3
ds_read_b64_tr_b16 a[158:159], v201 offset:18432
ds_read_b64_tr_b16 a[168:169], v196 offset:16640
v_mfma_f32_16x16x32_bf16 v[84:87], a[172:175], a[192:195], v[84:87]
s_add_u32 s48, s48, 0x240000
ds_read_b64_tr_b16 a[170:171], v196 offset:18688
v_mfma_f32_16x16x32_bf16 v[116:119], a[172:175], a[196:199], v[116:119]
buffer_load_dwordx2 v[148:149], v255, s[20:23], s48 offen sc0 sc1
v_mfma_f32_16x16x32_bf16 v[88:91], a[176:179], a[192:195], v[88:91]
ds_read_b64_tr_b16 a[172:173], v197 offset:16640
ds_read_b64_tr_b16 a[174:175], v197 offset:18688
v_mfma_f32_16x16x32_bf16 v[120:123], a[176:179], a[196:199], v[120:123]
ds_read_b64_tr_b16 a[176:177], v198 offset:16640
ds_read_b64_tr_b16 a[178:179], v198 offset:18688
v_mfma_f32_16x16x32_bf16 v[92:95], a[180:183], a[192:195], v[92:95]
s_xor_b32 s48, s48, 128
v_mfma_f32_16x16x32_bf16 v[124:127], a[180:183], a[196:199], v[124:127]
buffer_load_dwordx2 v[150:151], v255, s[20:23], s48 offen sc0 sc1
v_mfma_f32_16x16x32_bf16 v[96:99], a[184:187], a[192:195], v[96:99]
ds_read_b64_tr_b16 a[180:181], v199 offset:16640
ds_read_b64_tr_b16 a[182:183], v199 offset:18688
v_mfma_f32_16x16x32_bf16 v[128:131], a[184:187], a[196:199], v[128:131]
ds_read_b64_tr_b16 a[184:185], v200 offset:16640
ds_read_b64_tr_b16 a[186:187], v200 offset:18688
v_mfma_f32_16x16x32_bf16 v[100:103], a[188:191], a[192:195], v[100:103]
v_mfma_f32_16x16x32_bf16 v[132:135], a[188:191], a[196:199], v[132:135]
ds_read_b64_tr_b16 a[188:189], v201 offset:16640
ds_read_b64_tr_b16 a[190:191], v201 offset:18688
v_mfma_f32_16x16x32_bf16 v[8:11], a[128:131], a[200:203], v[8:11]
v_mfma_f32_16x16x32_bf16 v[40:43], a[128:131], a[204:207], v[40:43]
v_mfma_f32_16x16x32_bf16 v[12:15], a[132:135], a[200:203], v[12:15]
v_mfma_f32_16x16x32_bf16 v[44:47], a[132:135], a[204:207], v[44:47]
v_smfmac_f32_16x16x64_bf16 a[248:251], a[208:211], a[128:135], v235
v_mfma_f32_16x16x32_bf16 v[72:75], a[160:163], a[200:203], v[72:75]
v_mfma_f32_16x16x32_bf16 v[104:107], a[160:163], a[204:207], v[104:107]
s_waitcnt vmcnt(2) lgkmcnt(0)
s_barrier
v_mfma_f32_16x16x32_bf16 v[76:79], a[164:167], a[200:203], v[76:79]
s_mov_b32 s39, 0
ds_read_b128 a[192:195], v212 offset:0
ds_read_b128 a[196:199], v212 offset:2048
v_mfma_f32_16x16x32_bf16 v[108:111], a[164:167], a[204:207], v[108:111]
s_add_u32 m0, s37, 98304
ds_read_b64_tr_b16 a[128:129], v204 offset:0
ds_read_b64_tr_b16 a[130:131], v204 offset:2048
v_smfmac_f32_16x16x64_bf16 a[252:255], a[208:211], a[160:167], v235
buffer_load_dwordx4 v232, s[12:15], s39 offen offset:0 lds
v_mfma_f32_16x16x32_bf16 v[16:19], a[136:139], a[200:203], v[16:19]
ds_read_b64_tr_b16 a[132:133], v205 offset:0
ds_read_b64_tr_b16 a[134:135], v205 offset:2048
v_mfma_f32_16x16x32_bf16 v[48:51], a[136:139], a[204:207], v[48:51]
ds_read_b64_tr_b16 a[160:161], v204 offset:256
ds_read_b64_tr_b16 a[162:163], v204 offset:2304
v_mfma_f32_16x16x32_bf16 v[20:23], a[140:143], a[200:203], v[20:23]
ds_read_b64_tr_b16 a[164:165], v205 offset:256
ds_read_b64_tr_b16 a[166:167], v205 offset:2304
v_mfma_f32_16x16x32_bf16 v[52:55], a[140:143], a[204:207], v[52:55]
buffer_load_dwordx4 v233, s[12:15], s39 offen offset:1024 lds
v_mfma_f32_16x16x32_bf16 v[24:27], a[144:147], a[200:203], v[24:27]
ds_read_b64_tr_b16 a[136:137], v206 offset:0
ds_read_b64_tr_b16 a[138:139], v206 offset:2048
v_mfma_f32_16x16x32_bf16 v[56:59], a[144:147], a[204:207], v[56:59]
ds_read_b64_tr_b16 a[140:141], v207 offset:0
ds_read_b64_tr_b16 a[142:143], v207 offset:2048
v_mfma_f32_16x16x32_bf16 v[28:31], a[148:151], a[200:203], v[28:31]
ds_read_b64_tr_b16 a[144:145], v208 offset:0
ds_read_b64_tr_b16 a[146:147], v208 offset:2048
v_mfma_f32_16x16x32_bf16 v[60:63], a[148:151], a[204:207], v[60:63]
buffer_load_dwordx4 v232, s[12:15], s39 offen offset:2048 lds
v_mfma_f32_16x16x32_bf16 v[32:35], a[152:155], a[200:203], v[32:35]
ds_read_b64_tr_b16 a[148:149], v209 offset:0
ds_read_b64_tr_b16 a[150:151], v209 offset:2048
v_mfma_f32_16x16x32_bf16 v[64:67], a[152:155], a[204:207], v[64:67]
ds_read_b64_tr_b16 a[152:153], v210 offset:0
ds_read_b64_tr_b16 a[154:155], v210 offset:2048
v_mfma_f32_16x16x32_bf16 v[36:39], a[156:159], a[200:203], v[36:39]
v_mfma_f32_16x16x32_bf16 v[68:71], a[156:159], a[204:207], v[68:71]
buffer_load_dwordx4 v233, s[12:15], s39 offen offset:3072 lds
v_mfma_f32_16x16x32_bf16 v[80:83], a[168:171], a[200:203], v[80:83]
ds_read_b64_tr_b16 a[156:157], v211 offset:0
ds_read_b64_tr_b16 a[158:159], v211 offset:2048
v_mfma_f32_16x16x32_bf16 v[112:115], a[168:171], a[204:207], v[112:115]
s_add_u32 s39, s39, 16384
ds_read_b64_tr_b16 a[168:169], v206 offset:256
ds_read_b64_tr_b16 a[170:171], v206 offset:2304
v_mfma_f32_16x16x32_bf16 v[84:87], a[172:175], a[200:203], v[84:87]
s_add_u32 m0, s37, 114688
v_mfma_f32_16x16x32_bf16 v[116:119], a[172:175], a[204:207], v[116:119]
buffer_load_dwordx4 v232, s[12:15], s39 offen offset:0 lds
v_mfma_f32_16x16x32_bf16 v[88:91], a[176:179], a[200:203], v[88:91]
ds_read_b64_tr_b16 a[172:173], v207 offset:256
ds_read_b64_tr_b16 a[174:175], v207 offset:2304
v_mfma_f32_16x16x32_bf16 v[120:123], a[176:179], a[204:207], v[120:123]
ds_read_b64_tr_b16 a[176:177], v208 offset:256
ds_read_b64_tr_b16 a[178:179], v208 offset:2304
v_mfma_f32_16x16x32_bf16 v[92:95], a[180:183], a[200:203], v[92:95]
v_mfma_f32_16x16x32_bf16 v[124:127], a[180:183], a[204:207], v[124:127]
ds_read_b64_tr_b16 a[180:181], v209 offset:256
ds_read_b64_tr_b16 a[182:183], v209 offset:2304
v_mfma_f32_16x16x32_bf16 v[96:99], a[184:187], a[200:203], v[96:99]
buffer_load_dwordx4 v233, s[12:15], s39 offen offset:1024 lds
v_mfma_f32_16x16x32_bf16 v[128:131], a[184:187], a[204:207], v[128:131]
ds_read_b64_tr_b16 a[184:185], v210 offset:256
ds_read_b64_tr_b16 a[186:187], v210 offset:2304
v_mfma_f32_16x16x32_bf16 v[100:103], a[188:191], a[200:203], v[100:103]
v_mfma_f32_16x16x32_bf16 v[132:135], a[188:191], a[204:207], v[132:135]
s_waitcnt lgkmcnt(8)
ds_read_b64_tr_b16 a[188:189], v211 offset:256
ds_read_b64_tr_b16 a[190:191], v211 offset:2304
s_bitcmp1_b32 s40, 8
s_cbranch_scc1 K_XP8
K_XP8D:
v_mfma_f32_16x16x32_bf16 v[8:11], a[128:131], a[192:195], v[8:11]
s_lshl_b32 s46, s32, 7
buffer_load_dwordx4 v232, s[12:15], s39 offen offset:2048 lds
v_mfma_f32_16x16x32_bf16 v[40:43], a[128:131], a[196:199], v[40:43]
s_add_u32 s46, s46, 147456
ds_read_b128 a[200:203], v213 offset:0
ds_read_b128 a[204:207], v213 offset:2048
v_mfma_f32_16x16x32_bf16 v[12:15], a[132:135], a[192:195], v[12:15]
v_lshl_add_u32 v144, v3, 2, s46
v_lshl_add_u32 v5, v4, 4, s46
v_mfma_f32_16x16x32_bf16 v[44:47], a[132:135], a[196:199], v[44:47]
v_xor_b32 v6, 128, v5
v_xor_b32 v7, 256, v5
v_smfmac_f32_16x16x64_bf16 a[248:251], a[208:211], a[128:135], v235
buffer_load_dwordx4 v233, s[12:15], s39 offen offset:3072 lds
v_mfma_f32_16x16x32_bf16 v[72:75], a[160:163], a[192:195], v[72:75]
ds_read_b64_tr_b16 a[128:129], v204 offset:16384
ds_read_b64_tr_b16 a[130:131], v204 offset:18432
v_mfma_f32_16x16x32_bf16 v[104:107], a[160:163], a[196:199], v[104:107]
ds_read_b64_tr_b16 a[132:133], v205 offset:16384
ds_read_b64_tr_b16 a[134:135], v205 offset:18432
v_mfma_f32_16x16x32_bf16 v[76:79], a[164:167], a[192:195], v[76:79]
s_add_u32 s39, s39, 16384
v_xor_b32 v254, 384, v5
v_readlane_b32 s92, v214, 0
v_mfma_f32_16x16x32_bf16 v[108:111], a[164:167], a[196:199], v[108:111]
v_readlane_b32 s93, v214, 32
v_smfmac_f32_16x16x64_bf16 a[252:255], a[208:211], a[160:167], v235
ds_read_b64_tr_b16 a[160:161], v204 offset:16640
ds_read_b64_tr_b16 a[162:163], v204 offset:18688
v_mfma_f32_16x16x32_bf16 v[16:19], a[136:139], a[192:195], v[16:19]
ds_read_b64_tr_b16 a[164:165], v205 offset:16640
ds_read_b64_tr_b16 a[166:167], v205 offset:18688
v_mfma_f32_16x16x32_bf16 v[48:51], a[136:139], a[196:199], v[48:51]
ds_read_b64_tr_b16 a[136:137], v206 offset:16384
ds_read_b64_tr_b16 a[138:139], v206 offset:18432
v_mfma_f32_16x16x32_bf16 v[20:23], a[140:143], a[192:195], v[20:23]
v_mfma_f32_16x16x32_bf16 v[52:55], a[140:143], a[196:199], v[52:55]
ds_read_b64_tr_b16 a[140:141], v207 offset:16384
ds_read_b64_tr_b16 a[142:143], v207 offset:18432
v_mfma_f32_16x16x32_bf16 v[24:27], a[144:147], a[192:195], v[24:27]
v_mfma_f32_16x16x32_bf16 v[56:59], a[144:147], a[196:199], v[56:59]
ds_read_b64_tr_b16 a[144:145], v208 offset:16384
ds_read_b64_tr_b16 a[146:147], v208 offset:18432
v_mfma_f32_16x16x32_bf16 v[28:31], a[148:151], a[192:195], v[28:31]
v_mfma_f32_16x16x32_bf16 v[60:63], a[148:151], a[196:199], v[60:63]
ds_read_b64_tr_b16 a[148:149], v209 offset:16384
ds_read_b64_tr_b16 a[150:151], v209 offset:18432
v_mfma_f32_16x16x32_bf16 v[32:35], a[152:155], a[192:195], v[32:35]
v_mfma_f32_16x16x32_bf16 v[64:67], a[152:155], a[196:199], v[64:67]
ds_read_b64_tr_b16 a[152:153], v210 offset:16384
ds_read_b64_tr_b16 a[154:155], v210 offset:18432
v_mfma_f32_16x16x32_bf16 v[36:39], a[156:159], a[192:195], v[36:39]
v_mfma_f32_16x16x32_bf16 v[68:71], a[156:159], a[196:199], v[68:71]
ds_read_b64_tr_b16 a[156:157], v211 offset:16384
ds_read_b64_tr_b16 a[158:159], v211 offset:18432
v_mfma_f32_16x16x32_bf16 v[80:83], a[168:171], a[192:195], v[80:83]
v_mfma_f32_16x16x32_bf16 v[112:115], a[168:171], a[196:199], v[112:115]
s_waitcnt lgkmcnt(8)
ds_read_b64_tr_b16 a[168:169], v206 offset:16640
ds_read_b64_tr_b16 a[170:171], v206 offset:18688
v_mfma_f32_16x16x32_bf16 v[84:87], a[172:175], a[192:195], v[84:87]
v_mfma_f32_16x16x32_bf16 v[116:119], a[172:175], a[196:199], v[116:119]
ds_read_b64_tr_b16 a[172:173], v207 offset:16640
ds_read_b64_tr_b16 a[174:175], v207 offset:18688
v_mfma_f32_16x16x32_bf16 v[88:91], a[176:179], a[192:195], v[88:91]
v_mfma_f32_16x16x32_bf16 v[120:123], a[176:179], a[196:199], v[120:123]
ds_read_b64_tr_b16 a[176:177], v208 offset:16640
ds_read_b64_tr_b16 a[178:179], v208 offset:18688
v_mfma_f32_16x16x32_bf16 v[92:95], a[180:183], a[192:195], v[92:95]
v_mfma_f32_16x16x32_bf16 v[124:127], a[180:183], a[196:199], v[124:127]
ds_read_b64_tr_b16 a[180:181], v209 offset:16640
ds_read_b64_tr_b16 a[182:183], v209 offset:18688
v_mfma_f32_16x16x32_bf16 v[96:99], a[184:187], a[192:195], v[96:99]
v_mfma_f32_16x16x32_bf16 v[128:131], a[184:187], a[196:199], v[128:131]
ds_read_b64_tr_b16 a[184:185], v210 offset:16640
ds_read_b64_tr_b16 a[186:187], v210 offset:18688
v_mfma_f32_16x16x32_bf16 v[100:103], a[188:191], a[192:195], v[100:103]
v_mfma_f32_16x16x32_bf16 v[132:135], a[188:191], a[196:199], v[132:135]
ds_read_b64_tr_b16 a[188:189], v211 offset:16640
ds_read_b64_tr_b16 a[190:191], v211 offset:18688
v_mfma_f32_16x16x32_bf16 v[8:11], a[128:131], a[200:203], v[8:11]
v_mfma_f32_16x16x32_bf16 v[40:43], a[128:131], a[204:207], v[40:43]
v_mfma_f32_16x16x32_bf16 v[12:15], a[132:135], a[200:203], v[12:15]
v_mfma_f32_16x16x32_bf16 v[44:47], a[132:135], a[204:207], v[44:47]
v_smfmac_f32_16x16x64_bf16 a[248:251], a[208:211], a[128:135], v235
ds_read_b128 a[128:131], v216 offset:32768
ds_read_b128 a[132:135], v217 offset:32768
v_mfma_f32_16x16x32_bf16 v[72:75], a[160:163], a[200:203], v[72:75]
v_mfma_f32_16x16x32_bf16 v[104:107], a[160:163], a[204:207], v[104:107]
v_mfma_f32_16x16x32_bf16 v[76:79], a[164:167], a[200:203], v[76:79]
v_mfma_f32_16x16x32_bf16 v[108:111], a[164:167], a[204:207], v[108:111]
v_smfmac_f32_16x16x64_bf16 a[252:255], a[208:211], a[160:167], v235
v_mfma_f32_16x16x32_bf16 v[16:19], a[136:139], a[200:203], v[16:19]
v_accvgpr_read_b32 v136, a248
v_accvgpr_read_b32 v137, a249
v_mfma_f32_16x16x32_bf16 v[48:51], a[136:139], a[204:207], v[48:51]
v_accvgpr_read_b32 v138, a250
v_accvgpr_read_b32 v139, a251
v_mfma_f32_16x16x32_bf16 v[20:23], a[140:143], a[200:203], v[20:23]
ds_read_b128 a[136:139], v218 offset:32768
v_mfma_f32_16x16x32_bf16 v[52:55], a[140:143], a[204:207], v[52:55]
s_waitcnt lgkmcnt(3)
ds_read_b128 a[140:143], v219 offset:32768
v_mfma_f32_16x16x32_bf16 v[24:27], a[144:147], a[200:203], v[24:27]
v_mfma_f32_16x16x32_bf16 v[56:59], a[144:147], a[204:207], v[56:59]
v_accvgpr_read_b32 v140, a252
v_accvgpr_read_b32 v141, a253
v_mfma_f32_16x16x32_bf16 v[28:31], a[148:151], a[200:203], v[28:31]
v_accvgpr_read_b32 v142, a254
v_accvgpr_read_b32 v143, a255
v_mfma_f32_16x16x32_bf16 v[60:63], a[148:151], a[204:207], v[60:63]
v_add_f32 v136, v136, v137
v_add_f32 v138, v138, v139
v_mfma_f32_16x16x32_bf16 v[32:35], a[152:155], a[200:203], v[32:35]
v_add_f32 v140, v140, v141
v_add_f32 v142, v142, v143
v_mfma_f32_16x16x32_bf16 v[64:67], a[152:155], a[204:207], v[64:67]
ds_write_b32 v144, v136 offset:0
ds_write_b32 v144, v138 offset:64
v_mfma_f32_16x16x32_bf16 v[36:39], a[156:159], a[200:203], v[36:39]
ds_write_b32 v144, v140 offset:512
ds_write_b32 v144, v142 offset:576
v_mfma_f32_16x16x32_bf16 v[68:71], a[156:159], a[204:207], v[68:71]
s_waitcnt vmcnt(8)
s_nop 0
ds_read_b128 a[144:147], v216 offset:36864
ds_read_b128 a[148:151], v217 offset:36864
v_mfma_f32_16x16x32_bf16 v[80:83], a[168:171], a[200:203], v[80:83]
ds_read_b128 a[152:155], v218 offset:36864
ds_read_b128 a[156:159], v219 offset:36864
v_mfma_f32_16x16x32_bf16 v[112:115], a[168:171], a[204:207], v[112:115]
v_accvgpr_write_b32 a246, v148
v_accvgpr_write_b32 a247, v149
v_mfma_f32_16x16x32_bf16 v[84:87], a[172:175], a[200:203], v[84:87]
v_rcp_f32 v149, v149
v_mfma_f32_16x16x32_bf16 v[116:119], a[172:175], a[204:207], v[116:119]
s_waitcnt lgkmcnt(0)
s_barrier
v_mfma_f32_16x16x32_bf16 v[88:91], a[176:179], a[200:203], v[88:91]
ds_read_b128 v[184:187], v5 offset:0
ds_read_b128 v[188:191], v5 offset:64
v_mfma_f32_16x16x32_bf16 v[120:123], a[176:179], a[204:207], v[120:123]
ds_read_b128 v[192:195], v6 offset:0
ds_read_b128 v[196:199], v6 offset:64
v_mfma_f32_16x16x32_bf16 v[92:95], a[180:183], a[200:203], v[92:95]
ds_read_b128 v[200:203], v7 offset:0
ds_read_b128 v[204:207], v7 offset:64
v_mfma_f32_16x16x32_bf16 v[124:127], a[180:183], a[204:207], v[124:127]
ds_read_b128 v[208:211], v254 offset:0
ds_read_b128 v[212:215], v254 offset:64
v_mfma_f32_16x16x32_bf16 v[96:99], a[184:187], a[200:203], v[96:99]
v_rcp_f32 v151, v151
v_mfma_f32_16x16x32_bf16 v[128:131], a[184:187], a[204:207], v[128:131]
v_sub_f32 v148, 0, v148
v_sub_f32 v150, 0, v150
v_mfma_f32_16x16x32_bf16 v[100:103], a[188:191], a[200:203], v[100:103]
v_mul_f32 v149, 0x3e0293ee, v149
v_mul_f32 v151, 0x3e0293ee, v151
v_mfma_f32_16x16x32_bf16 v[132:135], a[188:191], a[204:207], v[132:135]
v_accvgpr_write_b32 a248, 0
v_accvgpr_write_b32 a249, 0
v_accvgpr_write_b32 a250, 0
v_accvgpr_write_b32 a251, 0
v_accvgpr_write_b32 a252, 0
v_accvgpr_write_b32 a253, 0
v_accvgpr_write_b32 a254, 0
v_accvgpr_write_b32 a255, 0
s_waitcnt lgkmcnt(0)
v_pk_fma_f32 v[8:9], v[184:185], v[148:149], v[8:9] op_sel:[0,0,0] op_sel_hi:[1,0,1]
v_pk_fma_f32 v[10:11], v[186:187], v[148:149], v[10:11] op_sel:[0,0,0] op_sel_hi:[1,0,1]
v_pk_mul_f32 v[8:9], v[8:9], v[148:149] op_sel:[0,1] op_sel_hi:[1,1]
v_pk_mul_f32 v[10:11], v[10:11], v[148:149] op_sel:[0,1] op_sel_hi:[1,1]
v_pk_fma_f32 v[12:13], v[188:189], v[148:149], v[12:13] op_sel:[0,0,0] op_sel_hi:[1,0,1]
v_pk_fma_f32 v[14:15], v[190:191], v[148:149], v[14:15] op_sel:[0,0,0] op_sel_hi:[1,0,1]
v_pk_mul_f32 v[12:13], v[12:13], v[148:149] op_sel:[0,1] op_sel_hi:[1,1]
v_pk_mul_f32 v[14:15], v[14:15], v[148:149] op_sel:[0,1] op_sel_hi:[1,1]
v_pk_fma_f32 v[16:17], v[192:193], v[148:149], v[16:17] op_sel:[0,0,0] op_sel_hi:[1,0,1]
v_pk_fma_f32 v[18:19], v[194:195], v[148:149], v[18:19] op_sel:[0,0,0] op_sel_hi:[1,0,1]
v_pk_mul_f32 v[16:17], v[16:17], v[148:149] op_sel:[0,1] op_sel_hi:[1,1]
v_pk_mul_f32 v[18:19], v[18:19], v[148:149] op_sel:[0,1] op_sel_hi:[1,1]
v_pk_fma_f32 v[20:21], v[196:197], v[148:149], v[20:21] op_sel:[0,0,0] op_sel_hi:[1,0,1]
v_pk_fma_f32 v[22:23], v[198:199], v[148:149], v[22:23] op_sel:[0,0,0] op_sel_hi:[1,0,1]
v_pk_mul_f32 v[20:21], v[20:21], v[148:149] op_sel:[0,1] op_sel_hi:[1,1]
v_pk_mul_f32 v[22:23], v[22:23], v[148:149] op_sel:[0,1] op_sel_hi:[1,1]
v_pk_fma_f32 v[24:25], v[200:201], v[148:149], v[24:25] op_sel:[0,0,0] op_sel_hi:[1,0,1]
v_pk_fma_f32 v[26:27], v[202:203], v[148:149], v[26:27] op_sel:[0,0,0] op_sel_hi:[1,0,1]
v_pk_mul_f32 v[24:25], v[24:25], v[148:149] op_sel:[0,1] op_sel_hi:[1,1]
v_pk_mul_f32 v[26:27], v[26:27], v[148:149] op_sel:[0,1] op_sel_hi:[1,1]
v_pk_fma_f32 v[28:29], v[204:205], v[148:149], v[28:29] op_sel:[0,0,0] op_sel_hi:[1,0,1]
v_pk_fma_f32 v[30:31], v[206:207], v[148:149], v[30:31] op_sel:[0,0,0] op_sel_hi:[1,0,1]
v_pk_mul_f32 v[28:29], v[28:29], v[148:149] op_sel:[0,1] op_sel_hi:[1,1]
v_pk_mul_f32 v[30:31], v[30:31], v[148:149] op_sel:[0,1] op_sel_hi:[1,1]
v_pk_fma_f32 v[32:33], v[208:209], v[148:149], v[32:33] op_sel:[0,0,0] op_sel_hi:[1,0,1]
v_pk_fma_f32 v[34:35], v[210:211], v[148:149], v[34:35] op_sel:[0,0,0] op_sel_hi:[1,0,1]
v_pk_mul_f32 v[32:33], v[32:33], v[148:149] op_sel:[0,1] op_sel_hi:[1,1]
v_pk_mul_f32 v[34:35], v[34:35], v[148:149] op_sel:[0,1] op_sel_hi:[1,1]
v_pk_fma_f32 v[36:37], v[212:213], v[148:149], v[36:37] op_sel:[0,0,0] op_sel_hi:[1,0,1]
v_pk_fma_f32 v[38:39], v[214:215], v[148:149], v[38:39] op_sel:[0,0,0] op_sel_hi:[1,0,1]
v_pk_mul_f32 v[36:37], v[36:37], v[148:149] op_sel:[0,1] op_sel_hi:[1,1]
v_pk_mul_f32 v[38:39], v[38:39], v[148:149] op_sel:[0,1] op_sel_hi:[1,1]
v_cvt_pk_bf16_f32 v152, v8, v9
v_cvt_pk_bf16_f32 v153, v10, v11
v_cvt_pk_bf16_f32 v154, v12, v13
v_cvt_pk_bf16_f32 v155, v14, v15
v_cvt_pk_bf16_f32 v156, v16, v17
v_cvt_pk_bf16_f32 v157, v18, v19
v_cvt_pk_bf16_f32 v158, v20, v21
v_cvt_pk_bf16_f32 v159, v22, v23
v_cvt_pk_bf16_f32 v160, v24, v25
v_cvt_pk_bf16_f32 v161, v26, v27
v_cvt_pk_bf16_f32 v162, v28, v29
v_cvt_pk_bf16_f32 v163, v30, v31
v_cvt_pk_bf16_f32 v164, v32, v33
v_cvt_pk_bf16_f32 v165, v34, v35
v_cvt_pk_bf16_f32 v166, v36, v37
v_cvt_pk_bf16_f32 v167, v38, v39
v_permlane16_swap_b32 v152, v154
v_permlane16_swap_b32 v153, v155
v_permlane16_swap_b32 v156, v158
v_permlane16_swap_b32 v157, v159
v_permlane16_swap_b32 v160, v162
v_permlane16_swap_b32 v161, v163
v_permlane16_swap_b32 v164, v166
v_permlane16_swap_b32 v165, v167
v_pk_fma_f32 v[40:41], v[184:185], v[150:151], v[40:41] op_sel:[0,0,0] op_sel_hi:[1,0,1]
v_pk_fma_f32 v[42:43], v[186:187], v[150:151], v[42:43] op_sel:[0,0,0] op_sel_hi:[1,0,1]
v_pk_mul_f32 v[40:41], v[40:41], v[150:151] op_sel:[0,1] op_sel_hi:[1,1]
v_pk_mul_f32 v[42:43], v[42:43], v[150:151] op_sel:[0,1] op_sel_hi:[1,1]
v_pk_fma_f32 v[44:45], v[188:189], v[150:151], v[44:45] op_sel:[0,0,0] op_sel_hi:[1,0,1]
v_pk_fma_f32 v[46:47], v[190:191], v[150:151], v[46:47] op_sel:[0,0,0] op_sel_hi:[1,0,1]
v_pk_mul_f32 v[44:45], v[44:45], v[150:151] op_sel:[0,1] op_sel_hi:[1,1]
v_pk_mul_f32 v[46:47], v[46:47], v[150:151] op_sel:[0,1] op_sel_hi:[1,1]
v_pk_fma_f32 v[48:49], v[192:193], v[150:151], v[48:49] op_sel:[0,0,0] op_sel_hi:[1,0,1]
v_pk_fma_f32 v[50:51], v[194:195], v[150:151], v[50:51] op_sel:[0,0,0] op_sel_hi:[1,0,1]
v_pk_mul_f32 v[48:49], v[48:49], v[150:151] op_sel:[0,1] op_sel_hi:[1,1]
v_pk_mul_f32 v[50:51], v[50:51], v[150:151] op_sel:[0,1] op_sel_hi:[1,1]
v_pk_fma_f32 v[52:53], v[196:197], v[150:151], v[52:53] op_sel:[0,0,0] op_sel_hi:[1,0,1]
v_pk_fma_f32 v[54:55], v[198:199], v[150:151], v[54:55] op_sel:[0,0,0] op_sel_hi:[1,0,1]
v_pk_mul_f32 v[52:53], v[52:53], v[150:151] op_sel:[0,1] op_sel_hi:[1,1]
v_pk_mul_f32 v[54:55], v[54:55], v[150:151] op_sel:[0,1] op_sel_hi:[1,1]
v_pk_fma_f32 v[56:57], v[200:201], v[150:151], v[56:57] op_sel:[0,0,0] op_sel_hi:[1,0,1]
v_pk_fma_f32 v[58:59], v[202:203], v[150:151], v[58:59] op_sel:[0,0,0] op_sel_hi:[1,0,1]
v_pk_mul_f32 v[56:57], v[56:57], v[150:151] op_sel:[0,1] op_sel_hi:[1,1]
v_pk_mul_f32 v[58:59], v[58:59], v[150:151] op_sel:[0,1] op_sel_hi:[1,1]
v_pk_fma_f32 v[60:61], v[204:205], v[150:151], v[60:61] op_sel:[0,0,0] op_sel_hi:[1,0,1]
v_pk_fma_f32 v[62:63], v[206:207], v[150:151], v[62:63] op_sel:[0,0,0] op_sel_hi:[1,0,1]
v_pk_mul_f32 v[60:61], v[60:61], v[150:151] op_sel:[0,1] op_sel_hi:[1,1]
v_pk_mul_f32 v[62:63], v[62:63], v[150:151] op_sel:[0,1] op_sel_hi:[1,1]
v_pk_fma_f32 v[64:65], v[208:209], v[150:151], v[64:65] op_sel:[0,0,0] op_sel_hi:[1,0,1]
v_pk_fma_f32 v[66:67], v[210:211], v[150:151], v[66:67] op_sel:[0,0,0] op_sel_hi:[1,0,1]
v_pk_mul_f32 v[64:65], v[64:65], v[150:151] op_sel:[0,1] op_sel_hi:[1,1]
v_pk_mul_f32 v[66:67], v[66:67], v[150:151] op_sel:[0,1] op_sel_hi:[1,1]
v_pk_fma_f32 v[68:69], v[212:213], v[150:151], v[68:69] op_sel:[0,0,0] op_sel_hi:[1,0,1]
v_pk_fma_f32 v[70:71], v[214:215], v[150:151], v[70:71] op_sel:[0,0,0] op_sel_hi:[1,0,1]
v_pk_mul_f32 v[68:69], v[68:69], v[150:151] op_sel:[0,1] op_sel_hi:[1,1]
v_pk_mul_f32 v[70:71], v[70:71], v[150:151] op_sel:[0,1] op_sel_hi:[1,1]
v_mfma_f32_16x16x32_bf16 v[8:11], a[128:131], v[152:155], 0
ds_read_b128 v[24:27], v5 offset:512
v_cvt_pk_bf16_f32 v168, v40, v41
v_mfma_f32_16x16x32_bf16 v[8:11], a[132:135], v[156:159], v[8:11]
ds_read_b128 v[28:31], v5 offset:576
v_cvt_pk_bf16_f32 v169, v42, v43
v_mfma_f32_16x16x32_bf16 v[8:11], a[136:139], v[160:163], v[8:11]
ds_read_b128 v[32:35], v6 offset:512
v_cvt_pk_bf16_f32 v170, v44, v45
v_mfma_f32_16x16x32_bf16 v[8:11], a[140:143], v[164:167], v[8:11]
ds_read_b128 v[36:39], v6 offset:576
v_cvt_pk_bf16_f32 v171, v46, v47
v_mfma_f32_16x16x32_bf16 v[12:15], a[144:147], v[152:155], 0
ds_read_b128 v[136:139], v7 offset:512
v_cvt_pk_bf16_f32 v172, v48, v49
v_mfma_f32_16x16x32_bf16 v[12:15], a[148:151], v[156:159], v[12:15]
ds_read_b128 v[140:143], v7 offset:576
v_cvt_pk_bf16_f32 v173, v50, v51
v_mfma_f32_16x16x32_bf16 v[12:15], a[152:155], v[160:163], v[12:15]
ds_read_b128 v[144:147], v254 offset:512
v_cvt_pk_bf16_f32 v174, v52, v53
v_mfma_f32_16x16x32_bf16 v[12:15], a[156:159], v[164:167], v[12:15]
ds_read_b128 v[244:247], v254 offset:576
v_cvt_pk_bf16_f32 v175, v54, v55
v_cvt_pk_bf16_f32 v176, v56, v57
v_cvt_pk_bf16_f32 v177, v58, v59
v_cvt_pk_bf16_f32 v178, v60, v61
v_cvt_pk_bf16_f32 v179, v62, v63
v_cvt_pk_bf16_f32 v180, v64, v65
v_cvt_pk_bf16_f32 v181, v66, v67
v_cvt_pk_bf16_f32 v182, v68, v69
v_cvt_pk_bf16_f32 v183, v70, v71
v_permlane16_swap_b32 v168, v170
v_permlane16_swap_b32 v169, v171
v_permlane16_swap_b32 v172, v174
v_permlane16_swap_b32 v173, v175
v_permlane16_swap_b32 v176, v178
v_permlane16_swap_b32 v177, v179
v_permlane16_swap_b32 v180, v182
v_permlane16_swap_b32 v181, v183
s_waitcnt lgkmcnt(0)
v_pk_fma_f32 v[72:73], v[24:25], v[148:149], v[72:73] op_sel:[0,0,0] op_sel_hi:[1,0,1]
v_pk_fma_f32 v[74:75], v[26:27], v[148:149], v[74:75] op_sel:[0,0,0] op_sel_hi:[1,0,1]
v_pk_mul_f32 v[72:73], v[72:73], v[148:149] op_sel:[0,1] op_sel_hi:[1,1]
v_pk_mul_f32 v[74:75], v[74:75], v[148:149] op_sel:[0,1] op_sel_hi:[1,1]
v_pk_fma_f32 v[76:77], v[28:29], v[148:149], v[76:77] op_sel:[0,0,0] op_sel_hi:[1,0,1]
v_pk_fma_f32 v[78:79], v[30:31], v[148:149], v[78:79] op_sel:[0,0,0] op_sel_hi:[1,0,1]
v_pk_mul_f32 v[76:77], v[76:77], v[148:149] op_sel:[0,1] op_sel_hi:[1,1]
v_pk_mul_f32 v[78:79], v[78:79], v[148:149] op_sel:[0,1] op_sel_hi:[1,1]
v_pk_fma_f32 v[80:81], v[32:33], v[148:149], v[80:81] op_sel:[0,0,0] op_sel_hi:[1,0,1]
v_pk_fma_f32 v[82:83], v[34:35], v[148:149], v[82:83] op_sel:[0,0,0] op_sel_hi:[1,0,1]
v_pk_mul_f32 v[80:81], v[80:81], v[148:149] op_sel:[0,1] op_sel_hi:[1,1]
v_pk_mul_f32 v[82:83], v[82:83], v[148:149] op_sel:[0,1] op_sel_hi:[1,1]
v_pk_fma_f32 v[84:85], v[36:37], v[148:149], v[84:85] op_sel:[0,0,0] op_sel_hi:[1,0,1]
v_pk_fma_f32 v[86:87], v[38:39], v[148:149], v[86:87] op_sel:[0,0,0] op_sel_hi:[1,0,1]
v_pk_mul_f32 v[84:85], v[84:85], v[148:149] op_sel:[0,1] op_sel_hi:[1,1]
v_pk_mul_f32 v[86:87], v[86:87], v[148:149] op_sel:[0,1] op_sel_hi:[1,1]
v_pk_fma_f32 v[88:89], v[136:137], v[148:149], v[88:89] op_sel:[0,0,0] op_sel_hi:[1,0,1]
v_pk_fma_f32 v[90:91], v[138:139], v[148:149], v[90:91] op_sel:[0,0,0] op_sel_hi:[1,0,1]
v_pk_mul_f32 v[88:89], v[88:89], v[148:149] op_sel:[0,1] op_sel_hi:[1,1]
v_pk_mul_f32 v[90:91], v[90:91], v[148:149] op_sel:[0,1] op_sel_hi:[1,1]
v_pk_fma_f32 v[92:93], v[140:141], v[148:149], v[92:93] op_sel:[0,0,0] op_sel_hi:[1,0,1]
v_pk_fma_f32 v[94:95], v[142:143], v[148:149], v[94:95] op_sel:[0,0,0] op_sel_hi:[1,0,1]
v_pk_mul_f32 v[92:93], v[92:93], v[148:149] op_sel:[0,1] op_sel_hi:[1,1]
v_pk_mul_f32 v[94:95], v[94:95], v[148:149] op_sel:[0,1] op_sel_hi:[1,1]
v_pk_fma_f32 v[96:97], v[144:145], v[148:149], v[96:97] op_sel:[0,0,0] op_sel_hi:[1,0,1]
v_pk_fma_f32 v[98:99], v[146:147], v[148:149], v[98:99] op_sel:[0,0,0] op_sel_hi:[1,0,1]
v_pk_mul_f32 v[96:97], v[96:97], v[148:149] op_sel:[0,1] op_sel_hi:[1,1]
v_pk_mul_f32 v[98:99], v[98:99], v[148:149] op_sel:[0,1] op_sel_hi:[1,1]
v_pk_fma_f32 v[100:101], v[244:245], v[148:149], v[100:101] op_sel:[0,0,0] op_sel_hi:[1,0,1]
v_pk_fma_f32 v[102:103], v[246:247], v[148:149], v[102:103] op_sel:[0,0,0] op_sel_hi:[1,0,1]
v_pk_mul_f32 v[100:101], v[100:101], v[148:149] op_sel:[0,1] op_sel_hi:[1,1]
v_pk_mul_f32 v[102:103], v[102:103], v[148:149] op_sel:[0,1] op_sel_hi:[1,1]
v_mfma_f32_16x16x32_bf16 v[16:19], a[128:131], v[168:171], 0
v_cvt_pk_bf16_f32 v184, v72, v73
v_cvt_pk_bf16_f32 v185, v74, v75
v_mfma_f32_16x16x32_bf16 v[16:19], a[132:135], v[172:175], v[16:19]
v_cvt_pk_bf16_f32 v186, v76, v77
v_cvt_pk_bf16_f32 v187, v78, v79
v_mfma_f32_16x16x32_bf16 v[16:19], a[136:139], v[176:179], v[16:19]
v_cvt_pk_bf16_f32 v188, v80, v81
v_cvt_pk_bf16_f32 v189, v82, v83
v_mfma_f32_16x16x32_bf16 v[16:19], a[140:143], v[180:183], v[16:19]
v_cvt_pk_bf16_f32 v190, v84, v85
v_cvt_pk_bf16_f32 v191, v86, v87
v_mfma_f32_16x16x32_bf16 v[20:23], a[144:147], v[168:171], 0
v_cvt_pk_bf16_f32 v192, v88, v89
v_cvt_pk_bf16_f32 v193, v90, v91
v_mfma_f32_16x16x32_bf16 v[20:23], a[148:151], v[172:175], v[20:23]
v_cvt_pk_bf16_f32 v194, v92, v93
v_cvt_pk_bf16_f32 v195, v94, v95
v_mfma_f32_16x16x32_bf16 v[20:23], a[152:155], v[176:179], v[20:23]
v_cvt_pk_bf16_f32 v196, v96, v97
v_cvt_pk_bf16_f32 v197, v98, v99
v_mfma_f32_16x16x32_bf16 v[20:23], a[156:159], v[180:183], v[20:23]
v_cvt_pk_bf16_f32 v198, v100, v101
v_cvt_pk_bf16_f32 v199, v102, v103
v_permlane16_swap_b32 v184, v186
v_permlane16_swap_b32 v185, v187
v_permlane16_swap_b32 v188, v190
v_permlane16_swap_b32 v189, v191
v_permlane16_swap_b32 v192, v194
v_permlane16_swap_b32 v193, v195
v_permlane16_swap_b32 v196, v198
v_permlane16_swap_b32 v197, v199
v_pk_fma_f32 v[104:105], v[24:25], v[150:151], v[104:105] op_sel:[0,0,0] op_sel_hi:[1,0,1]
v_pk_fma_f32 v[106:107], v[26:27], v[150:151], v[106:107] op_sel:[0,0,0] op_sel_hi:[1,0,1]
v_pk_mul_f32 v[104:105], v[104:105], v[150:151] op_sel:[0,1] op_sel_hi:[1,1]
v_pk_mul_f32 v[106:107], v[106:107], v[150:151] op_sel:[0,1] op_sel_hi:[1,1]
v_pk_fma_f32 v[108:109], v[28:29], v[150:151], v[108:109] op_sel:[0,0,0] op_sel_hi:[1,0,1]
v_pk_fma_f32 v[110:111], v[30:31], v[150:151], v[110:111] op_sel:[0,0,0] op_sel_hi:[1,0,1]
v_pk_mul_f32 v[108:109], v[108:109], v[150:151] op_sel:[0,1] op_sel_hi:[1,1]
v_pk_mul_f32 v[110:111], v[110:111], v[150:151] op_sel:[0,1] op_sel_hi:[1,1]
v_pk_fma_f32 v[112:113], v[32:33], v[150:151], v[112:113] op_sel:[0,0,0] op_sel_hi:[1,0,1]
v_pk_fma_f32 v[114:115], v[34:35], v[150:151], v[114:115] op_sel:[0,0,0] op_sel_hi:[1,0,1]
v_pk_mul_f32 v[112:113], v[112:113], v[150:151] op_sel:[0,1] op_sel_hi:[1,1]
v_pk_mul_f32 v[114:115], v[114:115], v[150:151] op_sel:[0,1] op_sel_hi:[1,1]
v_pk_fma_f32 v[116:117], v[36:37], v[150:151], v[116:117] op_sel:[0,0,0] op_sel_hi:[1,0,1]
v_pk_fma_f32 v[118:119], v[38:39], v[150:151], v[118:119] op_sel:[0,0,0] op_sel_hi:[1,0,1]
v_pk_mul_f32 v[116:117], v[116:117], v[150:151] op_sel:[0,1] op_sel_hi:[1,1]
v_pk_mul_f32 v[118:119], v[118:119], v[150:151] op_sel:[0,1] op_sel_hi:[1,1]
v_pk_fma_f32 v[120:121], v[136:137], v[150:151], v[120:121] op_sel:[0,0,0] op_sel_hi:[1,0,1]
v_pk_fma_f32 v[122:123], v[138:139], v[150:151], v[122:123] op_sel:[0,0,0] op_sel_hi:[1,0,1]
v_pk_mul_f32 v[120:121], v[120:121], v[150:151] op_sel:[0,1] op_sel_hi:[1,1]
v_pk_mul_f32 v[122:123], v[122:123], v[150:151] op_sel:[0,1] op_sel_hi:[1,1]
v_pk_fma_f32 v[124:125], v[140:141], v[150:151], v[124:125] op_sel:[0,0,0] op_sel_hi:[1,0,1]
v_pk_fma_f32 v[126:127], v[142:143], v[150:151], v[126:127] op_sel:[0,0,0] op_sel_hi:[1,0,1]
v_pk_mul_f32 v[124:125], v[124:125], v[150:151] op_sel:[0,1] op_sel_hi:[1,1]
v_pk_mul_f32 v[126:127], v[126:127], v[150:151] op_sel:[0,1] op_sel_hi:[1,1]
v_pk_fma_f32 v[128:129], v[144:145], v[150:151], v[128:129] op_sel:[0,0,0] op_sel_hi:[1,0,1]
v_pk_fma_f32 v[130:131], v[146:147], v[150:151], v[130:131] op_sel:[0,0,0] op_sel_hi:[1,0,1]
v_pk_mul_f32 v[128:129], v[128:129], v[150:151] op_sel:[0,1] op_sel_hi:[1,1]
v_pk_mul_f32 v[130:131], v[130:131], v[150:151] op_sel:[0,1] op_sel_hi:[1,1]
v_pk_fma_f32 v[132:133], v[244:245], v[150:151], v[132:133] op_sel:[0,0,0] op_sel_hi:[1,0,1]
v_pk_fma_f32 v[134:135], v[246:247], v[150:151], v[134:135] op_sel:[0,0,0] op_sel_hi:[1,0,1]
v_pk_mul_f32 v[132:133], v[132:133], v[150:151] op_sel:[0,1] op_sel_hi:[1,1]
v_pk_mul_f32 v[134:135], v[134:135], v[150:151] op_sel:[0,1] op_sel_hi:[1,1]
v_mfma_f32_16x16x32_bf16 v[24:27], a[128:131], v[184:187], 0
v_cvt_pk_bf16_f32 v200, v104, v105
v_cvt_pk_bf16_f32 v201, v106, v107
v_mfma_f32_16x16x32_bf16 v[24:27], a[132:135], v[188:191], v[24:27]
v_cvt_pk_bf16_f32 v202, v108, v109
v_cvt_pk_bf16_f32 v203, v110, v111
v_mfma_f32_16x16x32_bf16 v[24:27], a[136:139], v[192:195], v[24:27]
v_cvt_pk_bf16_f32 v204, v112, v113
v_cvt_pk_bf16_f32 v205, v114, v115
v_mfma_f32_16x16x32_bf16 v[24:27], a[140:143], v[196:199], v[24:27]
v_cvt_pk_bf16_f32 v206, v116, v117
v_cvt_pk_bf16_f32 v207, v118, v119
v_mfma_f32_16x16x32_bf16 v[28:31], a[144:147], v[184:187], 0
v_cvt_pk_bf16_f32 v208, v120, v121
v_cvt_pk_bf16_f32 v209, v122, v123
v_mfma_f32_16x16x32_bf16 v[28:31], a[148:151], v[188:191], v[28:31]
v_cvt_pk_bf16_f32 v210, v124, v125
v_cvt_pk_bf16_f32 v211, v126, v127
v_mfma_f32_16x16x32_bf16 v[28:31], a[152:155], v[192:195], v[28:31]
v_cvt_pk_bf16_f32 v212, v128, v129
v_cvt_pk_bf16_f32 v213, v130, v131
v_mfma_f32_16x16x32_bf16 v[28:31], a[156:159], v[196:199], v[28:31]
v_cvt_pk_bf16_f32 v214, v132, v133
v_cvt_pk_bf16_f32 v215, v134, v135
v_permlane16_swap_b32 v200, v202
v_permlane16_swap_b32 v201, v203
v_permlane16_swap_b32 v204, v206
v_permlane16_swap_b32 v205, v207
v_permlane16_swap_b32 v208, v210
v_permlane16_swap_b32 v209, v211
v_permlane16_swap_b32 v212, v214
v_permlane16_swap_b32 v213, v215
v_max3_f32 v136, v8, v9, v10
v_max3_f32 v136, v136, v11, v12
v_mfma_f32_16x16x32_bf16 v[32:35], a[128:131], v[200:203], 0
ds_read_b128 a[128:131], v216 offset:40960
v_max3_f32 v136, v136, v13, v14
v_mfma_f32_16x16x32_bf16 v[32:35], a[132:135], v[204:207], v[32:35]
ds_read_b128 a[132:135], v217 offset:40960
v_max_f32 v136, v136, v15
v_mfma_f32_16x16x32_bf16 v[32:35], a[136:139], v[208:211], v[32:35]
ds_read_b128 a[136:139], v218 offset:40960
v_mov_b32 v137, v136
v_mfma_f32_16x16x32_bf16 v[32:35], a[140:143], v[212:215], v[32:35]
ds_read_b128 a[140:143], v219 offset:40960
v_max3_f32 v140, v16, v17, v18
v_mfma_f32_16x16x32_bf16 v[36:39], a[144:147], v[200:203], 0
ds_read_b128 a[144:147], v216 offset:45056
v_max3_f32 v140, v140, v19, v20
v_mfma_f32_16x16x32_bf16 v[36:39], a[148:151], v[204:207], v[36:39]
ds_read_b128 a[148:151], v217 offset:45056
v_max3_f32 v140, v140, v21, v22
v_mfma_f32_16x16x32_bf16 v[36:39], a[152:155], v[208:211], v[36:39]
ds_read_b128 a[152:155], v218 offset:45056
v_max_f32 v140, v140, v23
v_mfma_f32_16x16x32_bf16 v[36:39], a[156:159], v[212:215], v[36:39]
ds_read_b128 a[156:159], v219 offset:45056
v_mov_b32 v141, v140
s_mov_b32 s48, 0x244000
buffer_load_dwordx4 v[104:107], v234, s[20:23], s48 offen offset:0 sc0 sc1
buffer_load_dwordx4 v[108:111], v234, s[20:23], s48 offen offset:1024 sc0 sc1
buffer_load_dwordx4 v[112:115], v234, s[20:23], s48 offen offset:2048 sc0 sc1
buffer_load_dwordx4 v[116:119], v234, s[20:23], s48 offen offset:3072 sc0 sc1
v_max3_f32 v144, v24, v25, v26
v_max3_f32 v144, v144, v27, v28
v_max3_f32 v144, v144, v29, v30
v_max_f32 v144, v144, v31
v_mov_b32 v145, v144
s_mov_b32 s48, 0x245000
buffer_load_dwordx4 v[120:123], v234, s[20:23], s48 offen offset:0 sc0 sc1
buffer_load_dwordx4 v[124:127], v234, s[20:23], s48 offen offset:1024 sc0 sc1
buffer_load_dwordx4 v[128:131], v234, s[20:23], s48 offen offset:2048 sc0 sc1
buffer_load_dwordx4 v[132:135], v234, s[20:23], s48 offen offset:3072 sc0 sc1
v_max3_f32 v148, v32, v33, v34
v_max3_f32 v148, v148, v35, v36
v_max3_f32 v148, v148, v37, v38
v_max_f32 v148, v148, v39
v_mov_b32 v149, v148
v_permlane16_swap_b32 v136, v137
v_permlane16_swap_b32 v140, v141
v_permlane16_swap_b32 v144, v145
v_permlane16_swap_b32 v148, v149
v_max_f32 v136, v136, v137
v_mov_b32 v137, v136
v_max_f32 v140, v140, v141
v_mov_b32 v141, v140
v_max_f32 v144, v144, v145
v_mov_b32 v145, v144
v_max_f32 v148, v148, v149
v_mov_b32 v149, v148
v_permlane32_swap_b32 v136, v137
v_permlane32_swap_b32 v140, v141
v_permlane32_swap_b32 v144, v145
v_permlane32_swap_b32 v148, v149
v_max_f32 v136, v136, v137
v_max_f32 v140, v140, v141
v_max_f32 v144, v144, v145
v_max_f32 v148, v148, v149
v_sub_f32 v139, 0, v136
v_sub_f32 v138, 0, v136
v_sub_f32 v137, 0, v136
v_sub_f32 v136, 0, v136
v_sub_f32 v143, 0, v140
v_sub_f32 v142, 0, v140
v_sub_f32 v141, 0, v140
v_sub_f32 v140, 0, v140
v_sub_f32 v147, 0, v144
v_sub_f32 v146, 0, v144
v_sub_f32 v145, 0, v144
v_sub_f32 v144, 0, v144
v_sub_f32 v151, 0, v148
v_sub_f32 v150, 0, v148
v_sub_f32 v149, 0, v148
v_sub_f32 v148, 0, v148
K_HAVEMAX:
v_pk_add_f32 v[8:9], v[8:9], v[136:137]
v_pk_add_f32 v[10:11], v[10:11], v[136:137]
v_pk_add_f32 v[12:13], v[12:13], v[136:137]
v_pk_add_f32 v[14:15], v[14:15], v[136:137]
v_pk_add_f32 v[16:17], v[16:17], v[140:141]
v_pk_add_f32 v[18:19], v[18:19], v[140:141]
v_pk_add_f32 v[20:21], v[20:21], v[140:141]
v_pk_add_f32 v[22:23], v[22:23], v[140:141]
v_pk_add_f32 v[24:25], v[24:25], v[144:145]
v_pk_add_f32 v[26:27], v[26:27], v[144:145]
v_pk_add_f32 v[28:29], v[28:29], v[144:145]
v_pk_add_f32 v[30:31], v[30:31], v[144:145]
v_pk_add_f32 v[32:33], v[32:33], v[148:149]
v_pk_add_f32 v[34:35], v[34:35], v[148:149]
v_pk_add_f32 v[36:37], v[36:37], v[148:149]
v_pk_add_f32 v[38:39], v[38:39], v[148:149]
s_waitcnt lgkmcnt(7)
v_mfma_f32_16x16x32_bf16 v[40:43], a[128:131], v[152:155], v[136:139]
s_waitcnt lgkmcnt(6)
v_exp_f32 v8, v8
v_exp_f32 v9, v9
v_mfma_f32_16x16x32_bf16 v[40:43], a[132:135], v[156:159], v[40:43]
s_waitcnt lgkmcnt(5)
v_cvt_pk_bf16_f32 v72, v8, v9
v_exp_f32 v10, v10
v_mfma_f32_16x16x32_bf16 v[40:43], a[136:139], v[160:163], v[40:43]
s_waitcnt lgkmcnt(4)
v_exp_f32 v11, v11
v_mfma_f32_16x16x32_bf16 v[40:43], a[140:143], v[164:167], v[40:43]
v_cvt_pk_bf16_f32 v73, v10, v11
v_exp_f32 v12, v12
v_mfma_f32_16x16x32_bf16 v[48:51], a[128:131], v[168:171], v[140:143]
v_exp_f32 v13, v13
v_mfma_f32_16x16x32_bf16 v[48:51], a[132:135], v[172:175], v[48:51]
v_cvt_pk_bf16_f32 v74, v12, v13
v_exp_f32 v14, v14
s_waitcnt vmcnt(8) lgkmcnt(0)
s_barrier
v_mfma_f32_16x16x32_bf16 v[48:51], a[136:139], v[176:179], v[48:51]
ds_read_b64_tr_b16 a[160:161], v220 offset:32768
ds_read_b64_tr_b16 a[162:163], v220 offset:36864
v_exp_f32 v15, v15
v_mfma_f32_16x16x32_bf16 v[48:51], a[140:143], v[180:183], v[48:51]
s_add_u32 m0, s37, 65536
v_exp_f32 v16, v16
v_exp_f32 v17, v17
v_mfma_f32_16x16x32_bf16 v[56:59], a[128:131], v[184:187], v[144:147]
buffer_load_dwordx4 v232, s[12:15], s39 offen offset:0 lds
v_exp_f32 v18, v18
v_mfma_f32_16x16x32_bf16 v[56:59], a[132:135], v[188:191], v[56:59]
ds_read_b64_tr_b16 a[164:165], v221 offset:32768
ds_read_b64_tr_b16 a[166:167], v221 offset:36864
v_exp_f32 v19, v19
v_mfma_f32_16x16x32_bf16 v[56:59], a[136:139], v[192:195], v[56:59]
buffer_load_dwordx4 v233, s[12:15], s39 offen offset:1024 lds
v_exp_f32 v20, v20
v_mfma_f32_16x16x32_bf16 v[56:59], a[140:143], v[196:199], v[56:59]
ds_read_b64_tr_b16 a[168:169], v222 offset:32768
ds_read_b64_tr_b16 a[170:171], v222 offset:36864
v_exp_f32 v21, v21
v_mfma_f32_16x16x32_bf16 v[64:67], a[128:131], v[200:203], v[148:151]
ds_read_b64_tr_b16 a[172:173], v223 offset:32768
ds_read_b64_tr_b16 a[174:175], v223 offset:36864
v_exp_f32 v22, v22
v_mfma_f32_16x16x32_bf16 v[64:67], a[132:135], v[204:207], v[64:67]
ds_read_b128 a[128:131], v216 offset:16384
ds_read_b64_tr_b16 a[176:177], v224 offset:32768
v_exp_f32 v23, v23
v_mfma_f32_16x16x32_bf16 v[64:67], a[136:139], v[208:211], v[64:67]
v_exp_f32 v24, v24
v_exp_f32 v25, v25
v_mfma_f32_16x16x32_bf16 v[64:67], a[140:143], v[212:215], v[64:67]
buffer_load_dwordx4 v232, s[12:15], s39 offen offset:2048 lds
v_exp_f32 v26, v26
v_mfma_f32_16x16x32_bf16 v[44:47], a[144:147], v[152:155], v[136:139]
ds_read_b64_tr_b16 a[178:179], v224 offset:36864
ds_read_b128 a[132:135], v217 offset:16384
v_exp_f32 v27, v27
v_mfma_f32_16x16x32_bf16 v[44:47], a[148:151], v[156:159], v[44:47]
ds_read_b128 a[136:139], v218 offset:16384
ds_read_b128 a[140:143], v219 offset:16384
v_exp_f32 v28, v28
v_mfma_f32_16x16x32_bf16 v[44:47], a[152:155], v[160:163], v[44:47]
buffer_load_dwordx4 v233, s[12:15], s39 offen offset:3072 lds
v_exp_f32 v29, v29
v_mfma_f32_16x16x32_bf16 v[44:47], a[156:159], v[164:167], v[44:47]
ds_read_b64_tr_b16 a[180:181], v225 offset:32768
ds_read_b64_tr_b16 a[182:183], v225 offset:36864
v_exp_f32 v30, v30
v_mfma_f32_16x16x32_bf16 v[52:55], a[144:147], v[168:171], v[140:143]
ds_read_b64_tr_b16 a[184:185], v226 offset:32768
ds_read_b64_tr_b16 a[186:187], v226 offset:36864
v_exp_f32 v31, v31
v_mfma_f32_16x16x32_bf16 v[52:55], a[148:151], v[172:175], v[52:55]
s_add_u32 s39, s39, 16384
v_exp_f32 v32, v32
v_exp_f32 v33, v33
v_mfma_f32_16x16x32_bf16 v[52:55], a[152:155], v[176:179], v[52:55]
s_add_u32 m0, s37, 49152
ds_read_b64_tr_b16 a[188:189], v227 offset:32768
ds_read_b64_tr_b16 a[190:191], v227 offset:36864
v_exp_f32 v34, v34
v_mfma_f32_16x16x32_bf16 v[52:55], a[156:159], v[180:183], v[52:55]
buffer_load_dwordx4 v228, s[8:11], s38 offen offset:0 lds
v_exp_f32 v35, v35
v_mfma_f32_16x16x32_bf16 v[60:63], a[144:147], v[184:187], v[144:147]
v_cvt_pk_bf16_f32 v75, v14, v15
v_cvt_pk_bf16_f32 v76, v16, v17
v_exp_f32 v36, v36
v_mfma_f32_16x16x32_bf16 v[60:63], a[148:151], v[188:191], v[60:63]
buffer_load_dwordx4 v229, s[8:11], s38 offen offset:1024 lds
v_exp_f32 v37, v37
v_mfma_f32_16x16x32_bf16 v[60:63], a[152:155], v[192:195], v[60:63]
v_cvt_pk_bf16_f32 v77, v18, v19
v_cvt_pk_bf16_f32 v78, v20, v21
v_exp_f32 v38, v38
v_mfma_f32_16x16x32_bf16 v[60:63], a[156:159], v[196:199], v[60:63]
v_cvt_pk_bf16_f32 v79, v22, v23
v_cvt_pk_bf16_f32 v80, v24, v25
v_exp_f32 v39, v39
v_mfma_f32_16x16x32_bf16 v[68:71], a[144:147], v[200:203], v[148:151]
ds_read_b128 a[144:147], v216 offset:20480
v_cvt_pk_bf16_f32 v81, v26, v27
v_cvt_pk_bf16_f32 v82, v28, v29
v_cvt_pk_bf16_f32 v83, v30, v31
v_mfma_f32_16x16x32_bf16 v[68:71], a[148:151], v[204:207], v[68:71]
ds_read_b128 a[148:151], v217 offset:20480
v_cvt_pk_bf16_f32 v84, v32, v33
v_cvt_pk_bf16_f32 v85, v34, v35
v_cvt_pk_bf16_f32 v86, v36, v37
v_mfma_f32_16x16x32_bf16 v[68:71], a[152:155], v[208:211], v[68:71]
ds_read_b128 a[152:155], v218 offset:20480
v_cvt_pk_bf16_f32 v87, v38, v39
v_mfma_f32_16x16x32_bf16 v[68:71], a[156:159], v[212:215], v[68:71]
ds_read_b128 a[156:159], v219 offset:20480
s_cmp_lg_u32 s41, 0
s_cbranch_scc1 K_RANKED
s_waitcnt vmcnt(6)
v_max3_u32 v255, v104, v105, v106
s_max_u32 s48, s92, s93
v_max3_u32 v255, v255, v107, v108
v_max3_u32 v255, v255, v109, v110
v_max3_u32 v255, v255, v111, v112
v_max3_u32 v255, v255, v113, v114
v_max3_u32 v255, v255, v115, v116
v_max3_u32 v255, v255, v117, v118
v_max3_u32 v255, v255, v119, v120
v_max3_u32 v255, v255, v121, v122
v_max3_u32 v255, v255, v123, v124
v_max3_u32 v255, v255, v125, v126
v_max3_u32 v255, v255, v127, v128
v_max3_u32 v255, v255, v129, v130
v_max3_u32 v255, v255, v131, v132
v_max3_u32 v255, v255, v133, v134
v_max_u32 v255, v255, v135
v_cmp_lt_u32 vcc, s48, v255
s_bcnt1_i32_b64 s48, vcc
s_cmp_lt_u32 s48, 8
s_cbranch_scc1 K_RANK
K_RANKED:
s_memrealtime s[94:95]
s_waitcnt lgkmcnt(0)
s_mov_b32 s40, 0
s_add_u32 s76, s6, 0x270000
s_addc_u32 s77, s7, 0
s_and_b32 s77, s77, 0xffff
s_mov_b32 s78, 0x200
s_mov_b32 s79, 0x00020000
s_mov_b32 s16, s86
s_and_b32 s17, s87, 0xffff
s_mov_b32 s18, 0x480000
s_mov_b32 s19, 0x00020000
s_mul_i32 s47, s35, 1179648
s_add_u32 s28, s86, s47
s_addc_u32 s29, s87, 0
s_and_b32 s29, s29, 0xffff
s_mov_b32 s30, 0x120000
s_mov_b32 s31, 0x00020000
s_mov_b32 s42, 0xffc00000
s_mov_b32 s43, 0x100000
s_lshr_b32 s46, s2, 3
s_lshl_b32 s46, s46, 2
s_add_u32 s46, s46, s32
s_mul_i32 s45, s46, 4608
s_sub_u32 s45, s45, 6488064
s_add_u32 s24, s6, s53
s_addc_u32 s25, s7, 0
s_and_b32 s25, s25, 0xffff
s_mov_b32 s26, 0x0
s_mov_b32 s27, 0x00020000
s_mov_b32 s44, 0x0
v_lshlrev_b32 v0, 7, v1
s_getpc_b64 s[72:73]
PC_c:
s_add_u32 s72, s72, K_LAST-PC_c
s_addc_u32 s73, s73, 0
s_min_u32 s46, s46, (K_CODE_END-K_LAST)>>10
s_lshl_b32 s46, s46, 10
v_add_u32 v242, s46, v234
s_or_b32 s46, s32, s36
s_cselect_b32 s74, 8, 12
s_cmp_lg_u32 s41, 0
s_cselect_b32 s74, 0, s74
s_bitset1_b32 s74, 8
.p2align 6
K_LOOP:
v_mfma_f32_16x16x32_bf16 v[8:11], a[128:131], v[152:155], v[136:139]
v_exp_f32 v40, v40
v_mfma_f32_16x16x32_bf16 v[8:11], a[132:135], v[156:159], v[8:11]
v_exp_f32 v41, v41
v_mfma_f32_16x16x32_bf16 v[8:11], a[136:139], v[160:163], v[8:11]
buffer_load_dwordx4 v230, s[8:11], s38 offen offset:2048 lds
v_mfma_f32_16x16x32_bf16 v[8:11], a[140:143], v[164:167], v[8:11]
v_exp_f32 v42, v42
v_mfma_f32_16x16x32_bf16 a[0:3], a[160:163], v[72:75], a[0:3]
v_cvt_pk_bf16_f32 v88, v40, v41
v_mfma_f32_16x16x32_bf16 a[32:35], a[160:163], v[76:79], a[32:35]
v_exp_f32 v43, v43
v_mfma_f32_16x16x32_bf16 a[64:67], a[160:163], v[80:83], a[64:67]
v_cvt_pk_bf16_f32 v89, v42, v43
v_mfma_f32_16x16x32_bf16 a[96:99], a[160:163], v[84:87], a[96:99]
v_exp_f32 v44, v44
v_mfma_f32_16x16x32_bf16 v[16:19], a[128:131], v[168:171], v[140:143]
ds_read_b64_tr_b16 a[160:161], v220 offset:40960
ds_read_b64_tr_b16 a[162:163], v220 offset:45056
v_mfma_f32_16x16x32_bf16 v[16:19], a[132:135], v[172:175], v[16:19]
v_exp_f32 v45, v45
v_mfma_f32_16x16x32_bf16 v[16:19], a[136:139], v[176:179], v[16:19]
v_cvt_pk_bf16_f32 v90, v44, v45
v_mfma_f32_16x16x32_bf16 v[16:19], a[140:143], v[180:183], v[16:19]
v_exp_f32 v46, v46
v_mfma_f32_16x16x32_bf16 a[4:7], a[164:167], v[72:75], a[4:7]
v_mfma_f32_16x16x32_bf16 a[36:39], a[164:167], v[76:79], a[36:39]
v_exp_f32 v47, v47
v_mfma_f32_16x16x32_bf16 a[68:71], a[164:167], v[80:83], a[68:71]
buffer_load_dwordx4 v231, s[8:11], s38 offen offset:3072 lds
v_mfma_f32_16x16x32_bf16 a[100:103], a[164:167], v[84:87], a[100:103]
v_exp_f32 v48, v48
v_smfmac_f32_16x16x64_bf16 a[248:251], a[208:211], v[72:79], v235
ds_read_b64_tr_b16 a[164:165], v221 offset:40960
ds_read_b64_tr_b16 a[166:167], v221 offset:45056
v_mfma_f32_16x16x32_bf16 v[24:27], a[128:131], v[184:187], v[144:147]
v_exp_f32 v49, v49
v_mfma_f32_16x16x32_bf16 v[24:27], a[132:135], v[188:191], v[24:27]
v_cvt_pk_bf16_f32 v91, v46, v47
v_cvt_pk_bf16_f32 v92, v48, v49
v_mfma_f32_16x16x32_bf16 v[24:27], a[136:139], v[192:195], v[24:27]
v_exp_f32 v50, v50
v_mfma_f32_16x16x32_bf16 v[24:27], a[140:143], v[196:199], v[24:27]
v_mfma_f32_16x16x32_bf16 a[8:11], a[168:171], v[72:75], a[8:11]
v_exp_f32 v51, v51
v_mfma_f32_16x16x32_bf16 a[40:43], a[168:171], v[76:79], a[40:43]
v_cvt_pk_bf16_f32 v93, v50, v51
v_mfma_f32_16x16x32_bf16 a[72:75], a[168:171], v[80:83], a[72:75]
v_exp_f32 v52, v52
v_mfma_f32_16x16x32_bf16 a[104:107], a[168:171], v[84:87], a[104:107]
ds_read_b64_tr_b16 a[168:169], v222 offset:40960
ds_read_b64_tr_b16 a[170:171], v222 offset:45056
v_mfma_f32_16x16x32_bf16 v[32:35], a[128:131], v[200:203], v[148:151]
s_add_u32 s38, s38, 16384
v_exp_f32 v53, v53
v_mfma_f32_16x16x32_bf16 v[32:35], a[132:135], v[204:207], v[32:35]
s_add_u32 m0, s37, 81920
ds_read_b128 a[128:131], v216 offset:24576
ds_read_b128 a[132:135], v217 offset:24576
v_mfma_f32_16x16x32_bf16 v[32:35], a[136:139], v[208:211], v[32:35]
v_exp_f32 v54, v54
v_mfma_f32_16x16x32_bf16 v[32:35], a[140:143], v[212:215], v[32:35]
buffer_load_dwordx4 v232, s[12:15], s39 offen offset:0 lds
v_mfma_f32_16x16x32_bf16 a[12:15], a[172:175], v[72:75], a[12:15]
v_exp_f32 v55, v55
v_mfma_f32_16x16x32_bf16 a[44:47], a[172:175], v[76:79], a[44:47]
ds_read_b128 a[136:139], v218 offset:24576
ds_read_b128 a[140:143], v219 offset:24576
v_mfma_f32_16x16x32_bf16 a[76:79], a[172:175], v[80:83], a[76:79]
v_exp_f32 v56, v56
v_mfma_f32_16x16x32_bf16 a[108:111], a[172:175], v[84:87], a[108:111]
s_waitcnt lgkmcnt(6)
v_exp_f32 v57, v57
v_mfma_f32_16x16x32_bf16 v[12:15], a[144:147], v[152:155], v[136:139]
ds_read_b64_tr_b16 a[172:173], v223 offset:40960
ds_read_b64_tr_b16 a[174:175], v223 offset:45056
v_mfma_f32_16x16x32_bf16 v[12:15], a[148:151], v[156:159], v[12:15]
v_exp_f32 v58, v58
v_mfma_f32_16x16x32_bf16 v[12:15], a[152:155], v[160:163], v[12:15]
v_cvt_pk_bf16_f32 v94, v52, v53
v_cvt_pk_bf16_f32 v95, v54, v55
v_mfma_f32_16x16x32_bf16 v[12:15], a[156:159], v[164:167], v[12:15]
v_exp_f32 v59, v59
v_mfma_f32_16x16x32_bf16 a[16:19], a[176:179], v[72:75], a[16:19]
v_cvt_pk_bf16_f32 v96, v56, v57
v_cvt_pk_bf16_f32 v97, v58, v59
v_mfma_f32_16x16x32_bf16 a[48:51], a[176:179], v[76:79], a[48:51]
v_exp_f32 v60, v60
v_mfma_f32_16x16x32_bf16 a[80:83], a[176:179], v[80:83], a[80:83]
buffer_load_dwordx4 v233, s[12:15], s39 offen offset:1024 lds
v_mfma_f32_16x16x32_bf16 a[112:115], a[176:179], v[84:87], a[112:115]
v_exp_f32 v61, v61
v_mfma_f32_16x16x32_bf16 v[20:23], a[144:147], v[168:171], v[140:143]
ds_read_b64_tr_b16 a[176:177], v224 offset:40960
ds_read_b64_tr_b16 a[178:179], v224 offset:45056
v_mfma_f32_16x16x32_bf16 v[20:23], a[148:151], v[172:175], v[20:23]
v_exp_f32 v62, v62
v_mfma_f32_16x16x32_bf16 v[20:23], a[152:155], v[176:179], v[20:23]
v_cvt_pk_bf16_f32 v98, v60, v61
v_mfma_f32_16x16x32_bf16 v[20:23], a[156:159], v[180:183], v[20:23]
v_exp_f32 v63, v63
v_mfma_f32_16x16x32_bf16 a[20:23], a[180:183], v[72:75], a[20:23]
v_cvt_pk_bf16_f32 v99, v62, v63
v_mfma_f32_16x16x32_bf16 a[52:55], a[180:183], v[76:79], a[52:55]
v_exp_f32 v64, v64
v_mfma_f32_16x16x32_bf16 a[84:87], a[180:183], v[80:83], a[84:87]
v_mfma_f32_16x16x32_bf16 a[116:119], a[180:183], v[84:87], a[116:119]
v_exp_f32 v65, v65
v_smfmac_f32_16x16x64_bf16 a[252:255], a[208:211], v[80:87], v235
ds_read_b64_tr_b16 a[180:181], v225 offset:40960
ds_read_b64_tr_b16 a[182:183], v225 offset:45056
v_mfma_f32_16x16x32_bf16 v[28:31], a[144:147], v[184:187], v[144:147]
v_exp_f32 v66, v66
v_mfma_f32_16x16x32_bf16 v[28:31], a[148:151], v[188:191], v[28:31]
buffer_load_dwordx4 v232, s[12:15], s39 offen offset:2048 lds
v_mfma_f32_16x16x32_bf16 v[28:31], a[152:155], v[192:195], v[28:31]
v_exp_f32 v67, v67
v_mfma_f32_16x16x32_bf16 v[28:31], a[156:159], v[196:199], v[28:31]
v_cvt_pk_bf16_f32 v100, v64, v65
v_cvt_pk_bf16_f32 v101, v66, v67
v_mfma_f32_16x16x32_bf16 a[24:27], a[184:187], v[72:75], a[24:27]
v_exp_f32 v68, v68
v_mfma_f32_16x16x32_bf16 a[56:59], a[184:187], v[76:79], a[56:59]
v_mfma_f32_16x16x32_bf16 a[88:91], a[184:187], v[80:83], a[88:91]
v_exp_f32 v69, v69
v_mfma_f32_16x16x32_bf16 a[120:123], a[184:187], v[84:87], a[120:123]
ds_read_b64_tr_b16 a[184:185], v226 offset:40960
ds_read_b64_tr_b16 a[186:187], v226 offset:45056
v_mfma_f32_16x16x32_bf16 v[36:39], a[144:147], v[200:203], v[148:151]
v_exp_f32 v70, v70
v_mfma_f32_16x16x32_bf16 v[36:39], a[148:151], v[204:207], v[36:39]
ds_read_b128 a[144:147], v216 offset:28672
ds_read_b128 a[148:151], v217 offset:28672
v_mfma_f32_16x16x32_bf16 v[36:39], a[152:155], v[208:211], v[36:39]
v_exp_f32 v71, v71
v_mfma_f32_16x16x32_bf16 v[36:39], a[156:159], v[212:215], v[36:39]
ds_read_b128 a[152:155], v218 offset:28672
ds_read_b128 a[156:159], v219 offset:28672
v_mfma_f32_16x16x32_bf16 a[28:31], a[188:191], v[72:75], a[28:31]
v_cvt_pk_bf16_f32 v102, v68, v69
v_cvt_pk_bf16_f32 v103, v70, v71
v_mfma_f32_16x16x32_bf16 a[60:63], a[188:191], v[76:79], a[60:63]
v_mfma_f32_16x16x32_bf16 a[92:95], a[188:191], v[80:83], a[92:95]
v_mfma_f32_16x16x32_bf16 a[124:127], a[188:191], v[84:87], a[124:127]
s_waitcnt lgkmcnt(6)
ds_read_b64_tr_b16 a[188:189], v227 offset:40960
ds_read_b64_tr_b16 a[190:191], v227 offset:45056
v_mfma_f32_16x16x32_bf16 v[40:43], a[128:131], v[152:155], v[136:139]
v_exp_f32 v8, v8
v_mfma_f32_16x16x32_bf16 v[40:43], a[132:135], v[156:159], v[40:43]
v_exp_f32 v9, v9
v_mfma_f32_16x16x32_bf16 v[40:43], a[136:139], v[160:163], v[40:43]
buffer_load_dwordx4 v233, s[12:15], s39 offen offset:3072 lds
v_mfma_f32_16x16x32_bf16 v[40:43], a[140:143], v[164:167], v[40:43]
v_exp_f32 v10, v10
v_mfma_f32_16x16x32_bf16 a[0:3], a[160:163], v[88:91], a[0:3]
v_cvt_pk_bf16_f32 v72, v8, v9
v_mfma_f32_16x16x32_bf16 a[32:35], a[160:163], v[92:95], a[32:35]
v_exp_f32 v11, v11
v_mfma_f32_16x16x32_bf16 a[64:67], a[160:163], v[96:99], a[64:67]
v_cvt_pk_bf16_f32 v73, v10, v11
v_mfma_f32_16x16x32_bf16 a[96:99], a[160:163], v[100:103], a[96:99]
v_exp_f32 v12, v12
v_mfma_f32_16x16x32_bf16 v[48:51], a[128:131], v[168:171], v[140:143]
ds_read_b64_tr_b16 a[160:161], v220 offset:49152
ds_read_b64_tr_b16 a[162:163], v220 offset:53248
v_mfma_f32_16x16x32_bf16 v[48:51], a[132:135], v[172:175], v[48:51]
v_exp_f32 v13, v13
v_mfma_f32_16x16x32_bf16 v[48:51], a[136:139], v[176:179], v[48:51]
v_cvt_pk_bf16_f32 v74, v12, v13
v_mfma_f32_16x16x32_bf16 v[48:51], a[140:143], v[180:183], v[48:51]
v_exp_f32 v14, v14
v_mfma_f32_16x16x32_bf16 a[4:7], a[164:167], v[88:91], a[4:7]
v_mfma_f32_16x16x32_bf16 a[36:39], a[164:167], v[92:95], a[36:39]
s_add_u32 s39, s39, 16384
v_exp_f32 v15, v15
v_mfma_f32_16x16x32_bf16 a[68:71], a[164:167], v[96:99], a[68:71]
s_add_u32 m0, s37, 32768
v_cvt_pk_bf16_f32 v75, v14, v15
v_mfma_f32_16x16x32_bf16 a[100:103], a[164:167], v[100:103], a[100:103]
v_exp_f32 v16, v16
v_smfmac_f32_16x16x64_bf16 a[248:251], a[208:211], v[88:95], v235
buffer_load_dwordx4 v228, s[8:11], s38 offen offset:0 lds
v_mfma_f32_16x16x32_bf16 v[56:59], a[128:131], v[184:187], v[144:147]
v_exp_f32 v17, v17
v_mfma_f32_16x16x32_bf16 v[56:59], a[132:135], v[188:191], v[56:59]
ds_read_b64_tr_b16 a[164:165], v221 offset:49152
ds_read_b64_tr_b16 a[166:167], v221 offset:53248
v_mfma_f32_16x16x32_bf16 v[56:59], a[136:139], v[192:195], v[56:59]
v_exp_f32 v18, v18
v_mfma_f32_16x16x32_bf16 v[56:59], a[140:143], v[196:199], v[56:59]
v_cvt_pk_bf16_f32 v76, v16, v17
v_mfma_f32_16x16x32_bf16 a[8:11], a[168:171], v[88:91], a[8:11]
v_exp_f32 v19, v19
v_mfma_f32_16x16x32_bf16 a[40:43], a[168:171], v[92:95], a[40:43]
v_cvt_pk_bf16_f32 v77, v18, v19
v_mfma_f32_16x16x32_bf16 a[72:75], a[168:171], v[96:99], a[72:75]
v_exp_f32 v20, v20
v_mfma_f32_16x16x32_bf16 a[104:107], a[168:171], v[100:103], a[104:107]
ds_read_b64_tr_b16 a[168:169], v222 offset:49152
ds_read_b64_tr_b16 a[170:171], v222 offset:53248
v_mfma_f32_16x16x32_bf16 v[64:67], a[128:131], v[200:203], v[148:151]
v_exp_f32 v21, v21
v_mfma_f32_16x16x32_bf16 v[64:67], a[132:135], v[204:207], v[64:67]
buffer_load_dwordx4 v229, s[8:11], s38 offen offset:1024 lds
v_mfma_f32_16x16x32_bf16 v[64:67], a[136:139], v[208:211], v[64:67]
v_exp_f32 v22, v22
v_mfma_f32_16x16x32_bf16 v[64:67], a[140:143], v[212:215], v[64:67]
ds_read_b128 a[128:131], v216 offset:0
ds_read_b128 a[132:135], v217 offset:0
v_mfma_f32_16x16x32_bf16 a[12:15], a[172:175], v[88:91], a[12:15]
v_exp_f32 v23, v23
v_mfma_f32_16x16x32_bf16 a[44:47], a[172:175], v[92:95], a[44:47]
ds_read_b128 a[136:139], v218 offset:0
ds_read_b128 a[140:143], v219 offset:0
v_mfma_f32_16x16x32_bf16 a[76:79], a[172:175], v[96:99], a[76:79]
v_exp_f32 v24, v24
v_mfma_f32_16x16x32_bf16 a[108:111], a[172:175], v[100:103], a[108:111]
s_waitcnt lgkmcnt(6)
v_exp_f32 v25, v25
v_mfma_f32_16x16x32_bf16 v[44:47], a[144:147], v[152:155], v[136:139]
ds_read_b64_tr_b16 a[172:173], v223 offset:49152
ds_read_b64_tr_b16 a[174:175], v223 offset:53248
v_mfma_f32_16x16x32_bf16 v[44:47], a[148:151], v[156:159], v[44:47]
v_exp_f32 v26, v26
v_mfma_f32_16x16x32_bf16 v[44:47], a[152:155], v[160:163], v[44:47]
v_cvt_pk_bf16_f32 v78, v20, v21
v_cvt_pk_bf16_f32 v79, v22, v23
v_mfma_f32_16x16x32_bf16 v[44:47], a[156:159], v[164:167], v[44:47]
v_exp_f32 v27, v27
v_mfma_f32_16x16x32_bf16 a[16:19], a[176:179], v[88:91], a[16:19]
v_cvt_pk_bf16_f32 v80, v24, v25
v_cvt_pk_bf16_f32 v81, v26, v27
v_mfma_f32_16x16x32_bf16 a[48:51], a[176:179], v[92:95], a[48:51]
v_exp_f32 v28, v28
v_mfma_f32_16x16x32_bf16 a[80:83], a[176:179], v[96:99], a[80:83]
buffer_load_dwordx4 v230, s[8:11], s38 offen offset:2048 lds
v_mfma_f32_16x16x32_bf16 a[112:115], a[176:179], v[100:103], a[112:115]
v_exp_f32 v29, v29
v_mfma_f32_16x16x32_bf16 v[52:55], a[144:147], v[168:171], v[140:143]
ds_read_b64_tr_b16 a[176:177], v224 offset:49152
ds_read_b64_tr_b16 a[178:179], v224 offset:53248
v_mfma_f32_16x16x32_bf16 v[52:55], a[148:151], v[172:175], v[52:55]
v_exp_f32 v30, v30
v_mfma_f32_16x16x32_bf16 v[52:55], a[152:155], v[176:179], v[52:55]
v_cvt_pk_bf16_f32 v82, v28, v29
v_mfma_f32_16x16x32_bf16 v[52:55], a[156:159], v[180:183], v[52:55]
v_exp_f32 v31, v31
v_mfma_f32_16x16x32_bf16 a[20:23], a[180:183], v[88:91], a[20:23]
v_cvt_pk_bf16_f32 v83, v30, v31
v_mfma_f32_16x16x32_bf16 a[52:55], a[180:183], v[92:95], a[52:55]
v_exp_f32 v32, v32
v_mfma_f32_16x16x32_bf16 a[84:87], a[180:183], v[96:99], a[84:87]
v_mfma_f32_16x16x32_bf16 a[116:119], a[180:183], v[100:103], a[116:119]
v_exp_f32 v33, v33
v_smfmac_f32_16x16x64_bf16 a[252:255], a[208:211], v[96:103], v235
ds_read_b64_tr_b16 a[180:181], v225 offset:49152
ds_read_b64_tr_b16 a[182:183], v225 offset:53248
v_mfma_f32_16x16x32_bf16 v[60:63], a[144:147], v[184:187], v[144:147]
v_exp_f32 v34, v34
v_mfma_f32_16x16x32_bf16 v[60:63], a[148:151], v[188:191], v[60:63]
buffer_load_dwordx4 v231, s[8:11], s38 offen offset:3072 lds
v_mfma_f32_16x16x32_bf16 v[60:63], a[152:155], v[192:195], v[60:63]
v_exp_f32 v35, v35
v_mfma_f32_16x16x32_bf16 v[60:63], a[156:159], v[196:199], v[60:63]
v_cvt_pk_bf16_f32 v84, v32, v33
v_cvt_pk_bf16_f32 v85, v34, v35
v_mfma_f32_16x16x32_bf16 a[24:27], a[184:187], v[88:91], a[24:27]
v_exp_f32 v36, v36
v_mfma_f32_16x16x32_bf16 a[56:59], a[184:187], v[92:95], a[56:59]
v_mfma_f32_16x16x32_bf16 a[88:91], a[184:187], v[96:99], a[88:91]
v_exp_f32 v37, v37
v_mfma_f32_16x16x32_bf16 a[120:123], a[184:187], v[100:103], a[120:123]
ds_read_b64_tr_b16 a[184:185], v226 offset:49152
ds_read_b64_tr_b16 a[186:187], v226 offset:53248
v_mfma_f32_16x16x32_bf16 v[68:71], a[144:147], v[200:203], v[148:151]
v_exp_f32 v38, v38
v_mfma_f32_16x16x32_bf16 v[68:71], a[148:151], v[204:207], v[68:71]
ds_read_b128 a[144:147], v216 offset:4096
ds_read_b128 a[148:151], v217 offset:4096
v_mfma_f32_16x16x32_bf16 v[68:71], a[152:155], v[208:211], v[68:71]
v_exp_f32 v39, v39
v_mfma_f32_16x16x32_bf16 v[68:71], a[156:159], v[212:215], v[68:71]
ds_read_b128 a[152:155], v218 offset:4096
ds_read_b128 a[156:159], v219 offset:4096
v_mfma_f32_16x16x32_bf16 a[28:31], a[188:191], v[88:91], a[28:31]
v_cvt_pk_bf16_f32 v86, v36, v37
v_cvt_pk_bf16_f32 v87, v38, v39
v_mfma_f32_16x16x32_bf16 a[60:63], a[188:191], v[92:95], a[60:63]
s_add_u32 s38, s38, 16384
v_mfma_f32_16x16x32_bf16 a[92:95], a[188:191], v[96:99], a[92:95]
v_mfma_f32_16x16x32_bf16 a[124:127], a[188:191], v[100:103], a[124:127]
s_waitcnt lgkmcnt(6)
ds_read_b64_tr_b16 a[188:189], v227 offset:49152
ds_read_b64_tr_b16 a[190:191], v227 offset:53248
v_mfma_f32_16x16x32_bf16 v[8:11], a[128:131], v[152:155], v[136:139]
v_exp_f32 v40, v40
v_mfma_f32_16x16x32_bf16 v[8:11], a[132:135], v[156:159], v[8:11]
v_exp_f32 v41, v41
v_mfma_f32_16x16x32_bf16 v[8:11], a[136:139], v[160:163], v[8:11]
buffer_load_dwordx2 v[252:253], v251, s[76:79], s42 offen sc1
v_mfma_f32_16x16x32_bf16 v[8:11], a[140:143], v[164:167], v[8:11]
v_exp_f32 v42, v42
v_mfma_f32_16x16x32_bf16 a[0:3], a[160:163], v[72:75], a[0:3]
v_cvt_pk_bf16_f32 v88, v40, v41
v_mfma_f32_16x16x32_bf16 a[32:35], a[160:163], v[76:79], a[32:35]
v_exp_f32 v43, v43
v_mfma_f32_16x16x32_bf16 a[64:67], a[160:163], v[80:83], a[64:67]
v_cvt_pk_bf16_f32 v89, v42, v43
v_mfma_f32_16x16x32_bf16 a[96:99], a[160:163], v[84:87], a[96:99]
v_exp_f32 v44, v44
v_mfma_f32_16x16x32_bf16 v[16:19], a[128:131], v[168:171], v[140:143]
ds_read_b64_tr_b16 a[160:161], v220 offset:57344
ds_read_b64_tr_b16 a[162:163], v220 offset:61440
v_mfma_f32_16x16x32_bf16 v[16:19], a[132:135], v[172:175], v[16:19]
v_exp_f32 v45, v45
v_mfma_f32_16x16x32_bf16 v[16:19], a[136:139], v[176:179], v[16:19]
s_add_u32 s42, s42, s43
buffer_load_dword v255, v243, s[28:31], s45 offen
v_mfma_f32_16x16x32_bf16 v[16:19], a[140:143], v[180:183], v[16:19]
v_exp_f32 v46, v46
v_mfma_f32_16x16x32_bf16 a[4:7], a[164:167], v[72:75], a[4:7]
v_cvt_pk_bf16_f32 v90, v44, v45
v_mfma_f32_16x16x32_bf16 a[36:39], a[164:167], v[76:79], a[36:39]
v_exp_f32 v47, v47
v_mfma_f32_16x16x32_bf16 a[68:71], a[164:167], v[80:83], a[68:71]
v_cvt_pk_bf16_f32 v91, v46, v47
v_mfma_f32_16x16x32_bf16 a[100:103], a[164:167], v[84:87], a[100:103]
v_exp_f32 v48, v48
v_smfmac_f32_16x16x64_bf16 a[248:251], a[208:211], v[72:79], v235
ds_read_b64_tr_b16 a[164:165], v221 offset:57344
ds_read_b64_tr_b16 a[166:167], v221 offset:61440
v_mfma_f32_16x16x32_bf16 v[24:27], a[128:131], v[184:187], v[144:147]
v_exp_f32 v49, v49
v_mfma_f32_16x16x32_bf16 v[24:27], a[132:135], v[188:191], v[24:27]
v_cvt_pk_bf16_f32 v92, v48, v49
v_mfma_f32_16x16x32_bf16 v[24:27], a[136:139], v[192:195], v[24:27]
s_add_u32 s45, s45, 589824
v_exp_f32 v50, v50
v_mfma_f32_16x16x32_bf16 v[24:27], a[140:143], v[196:199], v[24:27]
global_load_dword v255, v242, s[72:73]
v_mfma_f32_16x16x32_bf16 a[8:11], a[168:171], v[72:75], a[8:11]
v_exp_f32 v51, v51
v_mfma_f32_16x16x32_bf16 a[40:43], a[168:171], v[76:79], a[40:43]
v_cvt_pk_bf16_f32 v93, v50, v51
v_mfma_f32_16x16x32_bf16 a[72:75], a[168:171], v[80:83], a[72:75]
v_exp_f32 v52, v52
v_mfma_f32_16x16x32_bf16 a[104:107], a[168:171], v[84:87], a[104:107]
ds_read_b64_tr_b16 a[168:169], v222 offset:57344
ds_read_b64_tr_b16 a[170:171], v222 offset:61440
v_mfma_f32_16x16x32_bf16 v[32:35], a[128:131], v[200:203], v[148:151]
v_exp_f32 v53, v53
v_mfma_f32_16x16x32_bf16 v[32:35], a[132:135], v[204:207], v[32:35]
ds_read_b128 a[128:131], v216 offset:8192
ds_read_b128 a[132:135], v217 offset:8192
v_mfma_f32_16x16x32_bf16 v[32:35], a[136:139], v[208:211], v[32:35]
v_exp_f32 v54, v54
v_mfma_f32_16x16x32_bf16 v[32:35], a[140:143], v[212:215], v[32:35]
buffer_load_dword v255, v0, s[24:27], s44 offen sc1
v_mfma_f32_16x16x32_bf16 a[12:15], a[172:175], v[72:75], a[12:15]
v_exp_f32 v55, v55
v_mfma_f32_16x16x32_bf16 a[44:47], a[172:175], v[76:79], a[44:47]
ds_read_b128 a[136:139], v218 offset:8192
ds_read_b128 a[140:143], v219 offset:8192
v_mfma_f32_16x16x32_bf16 a[76:79], a[172:175], v[80:83], a[76:79]
v_exp_f32 v56, v56
v_mfma_f32_16x16x32_bf16 a[108:111], a[172:175], v[84:87], a[108:111]
s_waitcnt lgkmcnt(6)
v_exp_f32 v57, v57
v_mfma_f32_16x16x32_bf16 v[12:15], a[144:147], v[152:155], v[136:139]
ds_read_b64_tr_b16 a[172:173], v223 offset:57344
ds_read_b64_tr_b16 a[174:175], v223 offset:61440
v_mfma_f32_16x16x32_bf16 v[12:15], a[148:151], v[156:159], v[12:15]
v_exp_f32 v58, v58
v_mfma_f32_16x16x32_bf16 v[12:15], a[152:155], v[160:163], v[12:15]
v_cvt_pk_bf16_f32 v94, v52, v53
v_cvt_pk_bf16_f32 v95, v54, v55
v_mfma_f32_16x16x32_bf16 v[12:15], a[156:159], v[164:167], v[12:15]
v_exp_f32 v59, v59
v_mfma_f32_16x16x32_bf16 a[16:19], a[176:179], v[72:75], a[16:19]
s_add_u32 s44, s44, 8192
v_cvt_pk_bf16_f32 v96, v56, v57
v_cvt_pk_bf16_f32 v97, v58, v59
v_mfma_f32_16x16x32_bf16 a[48:51], a[176:179], v[76:79], a[48:51]
v_exp_f32 v60, v60
v_mfma_f32_16x16x32_bf16 a[80:83], a[176:179], v[80:83], a[80:83]
v_mfma_f32_16x16x32_bf16 a[112:115], a[176:179], v[84:87], a[112:115]
v_exp_f32 v61, v61
v_mfma_f32_16x16x32_bf16 v[20:23], a[144:147], v[168:171], v[140:143]
ds_read_b64_tr_b16 a[176:177], v224 offset:57344
ds_read_b64_tr_b16 a[178:179], v224 offset:61440
v_mfma_f32_16x16x32_bf16 v[20:23], a[148:151], v[172:175], v[20:23]
v_exp_f32 v62, v62
v_mfma_f32_16x16x32_bf16 v[20:23], a[152:155], v[176:179], v[20:23]
v_cvt_pk_bf16_f32 v98, v60, v61
v_mfma_f32_16x16x32_bf16 v[20:23], a[156:159], v[180:183], v[20:23]
v_exp_f32 v63, v63
v_mfma_f32_16x16x32_bf16 a[20:23], a[180:183], v[72:75], a[20:23]
v_cvt_pk_bf16_f32 v99, v62, v63
v_mfma_f32_16x16x32_bf16 a[52:55], a[180:183], v[76:79], a[52:55]
v_exp_f32 v64, v64
v_mfma_f32_16x16x32_bf16 a[84:87], a[180:183], v[80:83], a[84:87]
v_mfma_f32_16x16x32_bf16 a[116:119], a[180:183], v[84:87], a[116:119]
v_exp_f32 v65, v65
v_smfmac_f32_16x16x64_bf16 a[252:255], a[208:211], v[80:87], v235
ds_read_b64_tr_b16 a[180:181], v225 offset:57344
ds_read_b64_tr_b16 a[182:183], v225 offset:61440
v_mfma_f32_16x16x32_bf16 v[28:31], a[144:147], v[184:187], v[144:147]
v_exp_f32 v66, v66
v_mfma_f32_16x16x32_bf16 v[28:31], a[148:151], v[188:191], v[28:31]
v_cvt_pk_bf16_f32 v100, v64, v65
v_mfma_f32_16x16x32_bf16 v[28:31], a[152:155], v[192:195], v[28:31]
v_exp_f32 v67, v67
v_mfma_f32_16x16x32_bf16 v[28:31], a[156:159], v[196:199], v[28:31]
v_cvt_pk_bf16_f32 v101, v66, v67
v_mfma_f32_16x16x32_bf16 a[24:27], a[184:187], v[72:75], a[24:27]
v_exp_f32 v68, v68
v_mfma_f32_16x16x32_bf16 a[56:59], a[184:187], v[76:79], a[56:59]
v_mfma_f32_16x16x32_bf16 a[88:91], a[184:187], v[80:83], a[88:91]
v_exp_f32 v69, v69
v_mfma_f32_16x16x32_bf16 a[120:123], a[184:187], v[84:87], a[120:123]
ds_read_b64_tr_b16 a[184:185], v226 offset:57344
ds_read_b64_tr_b16 a[186:187], v226 offset:61440
v_mfma_f32_16x16x32_bf16 v[36:39], a[144:147], v[200:203], v[148:151]
v_exp_f32 v70, v70
v_mfma_f32_16x16x32_bf16 v[36:39], a[148:151], v[204:207], v[36:39]
ds_read_b128 a[144:147], v216 offset:12288
ds_read_b128 a[148:151], v217 offset:12288
v_mfma_f32_16x16x32_bf16 v[36:39], a[152:155], v[208:211], v[36:39]
v_exp_f32 v71, v71
v_mfma_f32_16x16x32_bf16 v[36:39], a[156:159], v[212:215], v[36:39]
ds_read_b128 a[152:155], v218 offset:12288
ds_read_b128 a[156:159], v219 offset:12288
v_mfma_f32_16x16x32_bf16 a[28:31], a[188:191], v[72:75], a[28:31]
s_add_u32 s40, s40, 1
v_cvt_pk_bf16_f32 v102, v68, v69
v_cvt_pk_bf16_f32 v103, v70, v71
v_mfma_f32_16x16x32_bf16 a[60:63], a[188:191], v[76:79], a[60:63]
s_bitcmp1_b32 s74, s40
v_mfma_f32_16x16x32_bf16 a[92:95], a[188:191], v[80:83], a[92:95]
v_mfma_f32_16x16x32_bf16 a[124:127], a[188:191], v[84:87], a[124:127]
s_waitcnt lgkmcnt(6)
ds_read_b64_tr_b16 a[188:189], v227 offset:57344
ds_read_b64_tr_b16 a[190:191], v227 offset:61440
s_cbranch_scc1 K_EXIT
K_B4:
v_mfma_f32_16x16x32_bf16 v[40:43], a[128:131], v[152:155], v[136:139]
v_exp_f32 v8, v8
v_mfma_f32_16x16x32_bf16 v[40:43], a[132:135], v[156:159], v[40:43]
v_exp_f32 v9, v9
v_mfma_f32_16x16x32_bf16 v[40:43], a[136:139], v[160:163], v[40:43]
v_cvt_pk_bf16_f32 v72, v8, v9
v_mfma_f32_16x16x32_bf16 v[40:43], a[140:143], v[164:167], v[40:43]
v_exp_f32 v10, v10
v_mfma_f32_16x16x32_bf16 a[0:3], a[160:163], v[88:91], a[0:3]
v_mfma_f32_16x16x32_bf16 a[32:35], a[160:163], v[92:95], a[32:35]
v_exp_f32 v11, v11
s_waitcnt vmcnt(4) lgkmcnt(0)
s_barrier
v_mfma_f32_16x16x32_bf16 a[64:67], a[160:163], v[96:99], a[64:67]
v_cvt_pk_bf16_f32 v73, v10, v11
v_mfma_f32_16x16x32_bf16 a[96:99], a[160:163], v[100:103], a[96:99]
s_add_u32 m0, s37, 98304
v_exp_f32 v12, v12
v_mfma_f32_16x16x32_bf16 v[48:51], a[128:131], v[168:171], v[140:143]
buffer_load_dwordx4 v232, s[12:15], s39 offen offset:0 lds
v_mfma_f32_16x16x32_bf16 v[48:51], a[132:135], v[172:175], v[48:51]
v_exp_f32 v13, v13
v_mfma_f32_16x16x32_bf16 v[48:51], a[136:139], v[176:179], v[48:51]
ds_read_b64_tr_b16 a[160:161], v220 offset:0
ds_read_b64_tr_b16 a[162:163], v220 offset:4096
v_mfma_f32_16x16x32_bf16 v[48:51], a[140:143], v[180:183], v[48:51]
v_exp_f32 v14, v14
v_mfma_f32_16x16x32_bf16 a[4:7], a[164:167], v[88:91], a[4:7]
v_cvt_pk_bf16_f32 v74, v12, v13
v_mfma_f32_16x16x32_bf16 a[36:39], a[164:167], v[92:95], a[36:39]
v_exp_f32 v15, v15
v_mfma_f32_16x16x32_bf16 a[68:71], a[164:167], v[96:99], a[68:71]
v_cvt_pk_bf16_f32 v75, v14, v15
v_mfma_f32_16x16x32_bf16 a[100:103], a[164:167], v[100:103], a[100:103]
v_exp_f32 v16, v16
v_smfmac_f32_16x16x64_bf16 a[248:251], a[208:211], v[88:95], v235
buffer_load_dwordx4 v233, s[12:15], s39 offen offset:1024 lds
v_mfma_f32_16x16x32_bf16 v[56:59], a[128:131], v[184:187], v[144:147]
v_exp_f32 v17, v17
v_mfma_f32_16x16x32_bf16 v[56:59], a[132:135], v[188:191], v[56:59]
ds_read_b64_tr_b16 a[164:165], v221 offset:0
ds_read_b64_tr_b16 a[166:167], v221 offset:4096
v_mfma_f32_16x16x32_bf16 v[56:59], a[136:139], v[192:195], v[56:59]
v_exp_f32 v18, v18
v_mfma_f32_16x16x32_bf16 v[56:59], a[140:143], v[196:199], v[56:59]
v_cvt_pk_bf16_f32 v76, v16, v17
v_mfma_f32_16x16x32_bf16 a[8:11], a[168:171], v[88:91], a[8:11]
v_exp_f32 v19, v19
v_mfma_f32_16x16x32_bf16 a[40:43], a[168:171], v[92:95], a[40:43]
v_cvt_pk_bf16_f32 v77, v18, v19
v_mfma_f32_16x16x32_bf16 a[72:75], a[168:171], v[96:99], a[72:75]
v_exp_f32 v20, v20
v_mfma_f32_16x16x32_bf16 a[104:107], a[168:171], v[100:103], a[104:107]
ds_read_b64_tr_b16 a[168:169], v222 offset:0
ds_read_b64_tr_b16 a[170:171], v222 offset:4096
v_mfma_f32_16x16x32_bf16 v[64:67], a[128:131], v[200:203], v[148:151]
v_exp_f32 v21, v21
v_mfma_f32_16x16x32_bf16 v[64:67], a[132:135], v[204:207], v[64:67]
buffer_load_dwordx4 v232, s[12:15], s39 offen offset:2048 lds
v_mfma_f32_16x16x32_bf16 v[64:67], a[136:139], v[208:211], v[64:67]
v_exp_f32 v22, v22
v_mfma_f32_16x16x32_bf16 v[64:67], a[140:143], v[212:215], v[64:67]
ds_read_b128 a[128:131], v216 offset:49152
ds_read_b128 a[132:135], v217 offset:49152
v_mfma_f32_16x16x32_bf16 a[12:15], a[172:175], v[88:91], a[12:15]
v_exp_f32 v23, v23
v_mfma_f32_16x16x32_bf16 a[44:47], a[172:175], v[92:95], a[44:47]
ds_read_b128 a[136:139], v218 offset:49152
ds_read_b128 a[140:143], v219 offset:49152
v_mfma_f32_16x16x32_bf16 a[76:79], a[172:175], v[96:99], a[76:79]
v_exp_f32 v24, v24
v_mfma_f32_16x16x32_bf16 a[108:111], a[172:175], v[100:103], a[108:111]
v_exp_f32 v25, v25
v_mfma_f32_16x16x32_bf16 v[44:47], a[144:147], v[152:155], v[136:139]
ds_read_b64_tr_b16 a[172:173], v223 offset:0
ds_read_b64_tr_b16 a[174:175], v223 offset:4096
v_mfma_f32_16x16x32_bf16 v[44:47], a[148:151], v[156:159], v[44:47]
v_exp_f32 v26, v26
v_mfma_f32_16x16x32_bf16 v[44:47], a[152:155], v[160:163], v[44:47]
buffer_load_dwordx4 v233, s[12:15], s39 offen offset:3072 lds
v_mfma_f32_16x16x32_bf16 v[44:47], a[156:159], v[164:167], v[44:47]
v_exp_f32 v27, v27
v_mfma_f32_16x16x32_bf16 a[16:19], a[176:179], v[88:91], a[16:19]
v_cvt_pk_bf16_f32 v78, v20, v21
v_cvt_pk_bf16_f32 v79, v22, v23
v_mfma_f32_16x16x32_bf16 a[48:51], a[176:179], v[92:95], a[48:51]
v_exp_f32 v28, v28
v_mfma_f32_16x16x32_bf16 a[80:83], a[176:179], v[96:99], a[80:83]
v_cvt_pk_bf16_f32 v80, v24, v25
v_cvt_pk_bf16_f32 v81, v26, v27
v_mfma_f32_16x16x32_bf16 a[112:115], a[176:179], v[100:103], a[112:115]
v_exp_f32 v29, v29
v_mfma_f32_16x16x32_bf16 v[52:55], a[144:147], v[168:171], v[140:143]
ds_read_b64_tr_b16 a[176:177], v224 offset:0
ds_read_b64_tr_b16 a[178:179], v224 offset:4096
v_mfma_f32_16x16x32_bf16 v[52:55], a[148:151], v[172:175], v[52:55]
v_exp_f32 v30, v30
v_mfma_f32_16x16x32_bf16 v[52:55], a[152:155], v[176:179], v[52:55]
v_cvt_pk_bf16_f32 v82, v28, v29
v_mfma_f32_16x16x32_bf16 v[52:55], a[156:159], v[180:183], v[52:55]
s_add_u32 s39, s39, 16384
v_exp_f32 v31, v31
v_mfma_f32_16x16x32_bf16 a[20:23], a[180:183], v[88:91], a[20:23]
s_add_u32 m0, s37, 16384
v_cvt_pk_bf16_f32 v83, v30, v31
v_mfma_f32_16x16x32_bf16 a[52:55], a[180:183], v[92:95], a[52:55]
v_exp_f32 v32, v32
v_mfma_f32_16x16x32_bf16 a[84:87], a[180:183], v[96:99], a[84:87]
buffer_load_dwordx4 v228, s[8:11], s38 offen offset:0 lds
v_mfma_f32_16x16x32_bf16 a[116:119], a[180:183], v[100:103], a[116:119]
v_exp_f32 v33, v33
v_smfmac_f32_16x16x64_bf16 a[252:255], a[208:211], v[96:103], v235
ds_read_b64_tr_b16 a[180:181], v225 offset:0
ds_read_b64_tr_b16 a[182:183], v225 offset:4096
v_mfma_f32_16x16x32_bf16 v[60:63], a[144:147], v[184:187], v[144:147]
v_exp_f32 v34, v34
v_mfma_f32_16x16x32_bf16 v[60:63], a[148:151], v[188:191], v[60:63]
v_cvt_pk_bf16_f32 v84, v32, v33
v_mfma_f32_16x16x32_bf16 v[60:63], a[152:155], v[192:195], v[60:63]
v_exp_f32 v35, v35
v_mfma_f32_16x16x32_bf16 v[60:63], a[156:159], v[196:199], v[60:63]
buffer_load_dwordx4 v229, s[8:11], s38 offen offset:1024 lds
v_mfma_f32_16x16x32_bf16 a[24:27], a[184:187], v[88:91], a[24:27]
v_exp_f32 v36, v36
v_mfma_f32_16x16x32_bf16 a[56:59], a[184:187], v[92:95], a[56:59]
v_cvt_pk_bf16_f32 v85, v34, v35
v_mfma_f32_16x16x32_bf16 a[88:91], a[184:187], v[96:99], a[88:91]
v_exp_f32 v37, v37
v_mfma_f32_16x16x32_bf16 a[120:123], a[184:187], v[100:103], a[120:123]
ds_read_b64_tr_b16 a[184:185], v226 offset:0
ds_read_b64_tr_b16 a[186:187], v226 offset:4096
v_mfma_f32_16x16x32_bf16 v[68:71], a[144:147], v[200:203], v[148:151]
v_exp_f32 v38, v38
v_mfma_f32_16x16x32_bf16 v[68:71], a[148:151], v[204:207], v[68:71]
ds_read_b128 a[144:147], v216 offset:53248
ds_read_b128 a[148:151], v217 offset:53248
v_mfma_f32_16x16x32_bf16 v[68:71], a[152:155], v[208:211], v[68:71]
v_exp_f32 v39, v39
v_mfma_f32_16x16x32_bf16 v[68:71], a[156:159], v[212:215], v[68:71]
ds_read_b128 a[152:155], v218 offset:53248
ds_read_b128 a[156:159], v219 offset:53248
v_mfma_f32_16x16x32_bf16 a[28:31], a[188:191], v[88:91], a[28:31]
v_cvt_pk_bf16_f32 v86, v36, v37
v_cvt_pk_bf16_f32 v87, v38, v39
v_mfma_f32_16x16x32_bf16 a[60:63], a[188:191], v[92:95], a[60:63]
v_mfma_f32_16x16x32_bf16 a[92:95], a[188:191], v[96:99], a[92:95]
v_mfma_f32_16x16x32_bf16 a[124:127], a[188:191], v[100:103], a[124:127]
s_waitcnt lgkmcnt(6)
ds_read_b64_tr_b16 a[188:189], v227 offset:0
ds_read_b64_tr_b16 a[190:191], v227 offset:4096
K_B5:
v_mfma_f32_16x16x32_bf16 v[8:11], a[128:131], v[152:155], v[136:139]
v_exp_f32 v40, v40
v_mfma_f32_16x16x32_bf16 v[8:11], a[132:135], v[156:159], v[8:11]
v_exp_f32 v41, v41
v_mfma_f32_16x16x32_bf16 v[8:11], a[136:139], v[160:163], v[8:11]
buffer_load_dwordx4 v230, s[8:11], s38 offen offset:2048 lds
v_mfma_f32_16x16x32_bf16 v[8:11], a[140:143], v[164:167], v[8:11]
v_exp_f32 v42, v42
v_mfma_f32_16x16x32_bf16 a[0:3], a[160:163], v[72:75], a[0:3]
v_cvt_pk_bf16_f32 v88, v40, v41
v_mfma_f32_16x16x32_bf16 a[32:35], a[160:163], v[76:79], a[32:35]
v_exp_f32 v43, v43
v_mfma_f32_16x16x32_bf16 a[64:67], a[160:163], v[80:83], a[64:67]
v_cvt_pk_bf16_f32 v89, v42, v43
v_mfma_f32_16x16x32_bf16 a[96:99], a[160:163], v[84:87], a[96:99]
v_exp_f32 v44, v44
v_mfma_f32_16x16x32_bf16 v[16:19], a[128:131], v[168:171], v[140:143]
ds_read_b64_tr_b16 a[160:161], v220 offset:8192
ds_read_b64_tr_b16 a[162:163], v220 offset:12288
v_mfma_f32_16x16x32_bf16 v[16:19], a[132:135], v[172:175], v[16:19]
v_exp_f32 v45, v45
v_mfma_f32_16x16x32_bf16 v[16:19], a[136:139], v[176:179], v[16:19]
v_cvt_pk_bf16_f32 v90, v44, v45
v_mfma_f32_16x16x32_bf16 v[16:19], a[140:143], v[180:183], v[16:19]
v_exp_f32 v46, v46
v_mfma_f32_16x16x32_bf16 a[4:7], a[164:167], v[72:75], a[4:7]
v_mfma_f32_16x16x32_bf16 a[36:39], a[164:167], v[76:79], a[36:39]
v_exp_f32 v47, v47
v_mfma_f32_16x16x32_bf16 a[68:71], a[164:167], v[80:83], a[68:71]
buffer_load_dwordx4 v231, s[8:11], s38 offen offset:3072 lds
v_mfma_f32_16x16x32_bf16 a[100:103], a[164:167], v[84:87], a[100:103]
v_exp_f32 v48, v48
v_smfmac_f32_16x16x64_bf16 a[248:251], a[208:211], v[72:79], v235
ds_read_b64_tr_b16 a[164:165], v221 offset:8192
ds_read_b64_tr_b16 a[166:167], v221 offset:12288
v_mfma_f32_16x16x32_bf16 v[24:27], a[128:131], v[184:187], v[144:147]
v_exp_f32 v49, v49
v_mfma_f32_16x16x32_bf16 v[24:27], a[132:135], v[188:191], v[24:27]
v_cvt_pk_bf16_f32 v91, v46, v47
v_cvt_pk_bf16_f32 v92, v48, v49
v_mfma_f32_16x16x32_bf16 v[24:27], a[136:139], v[192:195], v[24:27]
v_exp_f32 v50, v50
v_mfma_f32_16x16x32_bf16 v[24:27], a[140:143], v[196:199], v[24:27]
v_mfma_f32_16x16x32_bf16 a[8:11], a[168:171], v[72:75], a[8:11]
v_exp_f32 v51, v51
v_mfma_f32_16x16x32_bf16 a[40:43], a[168:171], v[76:79], a[40:43]
v_cvt_pk_bf16_f32 v93, v50, v51
v_mfma_f32_16x16x32_bf16 a[72:75], a[168:171], v[80:83], a[72:75]
v_exp_f32 v52, v52
v_mfma_f32_16x16x32_bf16 a[104:107], a[168:171], v[84:87], a[104:107]
ds_read_b64_tr_b16 a[168:169], v222 offset:8192
ds_read_b64_tr_b16 a[170:171], v222 offset:12288
v_mfma_f32_16x16x32_bf16 v[32:35], a[128:131], v[200:203], v[148:151]
s_add_u32 s38, s38, 16384
v_exp_f32 v53, v53
v_mfma_f32_16x16x32_bf16 v[32:35], a[132:135], v[204:207], v[32:35]
s_add_u32 m0, s37, 114688
ds_read_b128 a[128:131], v216 offset:57344
ds_read_b128 a[132:135], v217 offset:57344
v_mfma_f32_16x16x32_bf16 v[32:35], a[136:139], v[208:211], v[32:35]
v_exp_f32 v54, v54
v_mfma_f32_16x16x32_bf16 v[32:35], a[140:143], v[212:215], v[32:35]
buffer_load_dwordx4 v232, s[12:15], s39 offen offset:0 lds
v_mfma_f32_16x16x32_bf16 a[12:15], a[172:175], v[72:75], a[12:15]
v_exp_f32 v55, v55
v_mfma_f32_16x16x32_bf16 a[44:47], a[172:175], v[76:79], a[44:47]
ds_read_b128 a[136:139], v218 offset:57344
ds_read_b128 a[140:143], v219 offset:57344
v_mfma_f32_16x16x32_bf16 a[76:79], a[172:175], v[80:83], a[76:79]
v_exp_f32 v56, v56
v_mfma_f32_16x16x32_bf16 a[108:111], a[172:175], v[84:87], a[108:111]
s_waitcnt lgkmcnt(6)
v_exp_f32 v57, v57
v_mfma_f32_16x16x32_bf16 v[12:15], a[144:147], v[152:155], v[136:139]
ds_read_b64_tr_b16 a[172:173], v223 offset:8192
ds_read_b64_tr_b16 a[174:175], v223 offset:12288
v_mfma_f32_16x16x32_bf16 v[12:15], a[148:151], v[156:159], v[12:15]
v_exp_f32 v58, v58
v_mfma_f32_16x16x32_bf16 v[12:15], a[152:155], v[160:163], v[12:15]
v_cvt_pk_bf16_f32 v94, v52, v53
v_cvt_pk_bf16_f32 v95, v54, v55
v_mfma_f32_16x16x32_bf16 v[12:15], a[156:159], v[164:167], v[12:15]
v_exp_f32 v59, v59
v_mfma_f32_16x16x32_bf16 a[16:19], a[176:179], v[72:75], a[16:19]
v_cvt_pk_bf16_f32 v96, v56, v57
v_cvt_pk_bf16_f32 v97, v58, v59
v_mfma_f32_16x16x32_bf16 a[48:51], a[176:179], v[76:79], a[48:51]
v_exp_f32 v60, v60
v_mfma_f32_16x16x32_bf16 a[80:83], a[176:179], v[80:83], a[80:83]
buffer_load_dwordx4 v233, s[12:15], s39 offen offset:1024 lds
v_mfma_f32_16x16x32_bf16 a[112:115], a[176:179], v[84:87], a[112:115]
v_exp_f32 v61, v61
v_mfma_f32_16x16x32_bf16 v[20:23], a[144:147], v[168:171], v[140:143]
ds_read_b64_tr_b16 a[176:177], v224 offset:8192
ds_read_b64_tr_b16 a[178:179], v224 offset:12288
v_mfma_f32_16x16x32_bf16 v[20:23], a[148:151], v[172:175], v[20:23]
v_exp_f32 v62, v62
v_mfma_f32_16x16x32_bf16 v[20:23], a[152:155], v[176:179], v[20:23]
v_cvt_pk_bf16_f32 v98, v60, v61
v_mfma_f32_16x16x32_bf16 v[20:23], a[156:159], v[180:183], v[20:23]
v_exp_f32 v63, v63
v_mfma_f32_16x16x32_bf16 a[20:23], a[180:183], v[72:75], a[20:23]
v_cvt_pk_bf16_f32 v99, v62, v63
v_mfma_f32_16x16x32_bf16 a[52:55], a[180:183], v[76:79], a[52:55]
v_exp_f32 v64, v64
v_mfma_f32_16x16x32_bf16 a[84:87], a[180:183], v[80:83], a[84:87]
v_mfma_f32_16x16x32_bf16 a[116:119], a[180:183], v[84:87], a[116:119]
v_exp_f32 v65, v65
v_smfmac_f32_16x16x64_bf16 a[252:255], a[208:211], v[80:87], v235
ds_read_b64_tr_b16 a[180:181], v225 offset:8192
ds_read_b64_tr_b16 a[182:183], v225 offset:12288
v_mfma_f32_16x16x32_bf16 v[28:31], a[144:147], v[184:187], v[144:147]
v_exp_f32 v66, v66
v_mfma_f32_16x16x32_bf16 v[28:31], a[148:151], v[188:191], v[28:31]
buffer_load_dwordx4 v232, s[12:15], s39 offen offset:2048 lds
v_mfma_f32_16x16x32_bf16 v[28:31], a[152:155], v[192:195], v[28:31]
v_exp_f32 v67, v67
v_mfma_f32_16x16x32_bf16 v[28:31], a[156:159], v[196:199], v[28:31]
v_cvt_pk_bf16_f32 v100, v64, v65
v_cvt_pk_bf16_f32 v101, v66, v67
v_mfma_f32_16x16x32_bf16 a[24:27], a[184:187], v[72:75], a[24:27]
v_exp_f32 v68, v68
v_mfma_f32_16x16x32_bf16 a[56:59], a[184:187], v[76:79], a[56:59]
v_mfma_f32_16x16x32_bf16 a[88:91], a[184:187], v[80:83], a[88:91]
v_exp_f32 v69, v69
v_mfma_f32_16x16x32_bf16 a[120:123], a[184:187], v[84:87], a[120:123]
ds_read_b64_tr_b16 a[184:185], v226 offset:8192
ds_read_b64_tr_b16 a[186:187], v226 offset:12288
v_mfma_f32_16x16x32_bf16 v[36:39], a[144:147], v[200:203], v[148:151]
v_exp_f32 v70, v70
v_mfma_f32_16x16x32_bf16 v[36:39], a[148:151], v[204:207], v[36:39]
ds_read_b128 a[144:147], v216 offset:61440
ds_read_b128 a[148:151], v217 offset:61440
v_mfma_f32_16x16x32_bf16 v[36:39], a[152:155], v[208:211], v[36:39]
v_exp_f32 v71, v71
v_mfma_f32_16x16x32_bf16 v[36:39], a[156:159], v[212:215], v[36:39]
ds_read_b128 a[152:155], v218 offset:61440
ds_read_b128 a[156:159], v219 offset:61440
v_mfma_f32_16x16x32_bf16 a[28:31], a[188:191], v[72:75], a[28:31]
v_cvt_pk_bf16_f32 v102, v68, v69
v_cvt_pk_bf16_f32 v103, v70, v71
v_mfma_f32_16x16x32_bf16 a[60:63], a[188:191], v[76:79], a[60:63]
v_mfma_f32_16x16x32_bf16 a[92:95], a[188:191], v[80:83], a[92:95]
v_mfma_f32_16x16x32_bf16 a[124:127], a[188:191], v[84:87], a[124:127]
s_waitcnt lgkmcnt(6)
ds_read_b64_tr_b16 a[188:189], v227 offset:8192
ds_read_b64_tr_b16 a[190:191], v227 offset:12288
v_mfma_f32_16x16x32_bf16 v[40:43], a[128:131], v[152:155], v[136:139]
v_exp_f32 v8, v8
v_mfma_f32_16x16x32_bf16 v[40:43], a[132:135], v[156:159], v[40:43]
v_exp_f32 v9, v9
v_mfma_f32_16x16x32_bf16 v[40:43], a[136:139], v[160:163], v[40:43]
buffer_load_dwordx4 v233, s[12:15], s39 offen offset:3072 lds
v_mfma_f32_16x16x32_bf16 v[40:43], a[140:143], v[164:167], v[40:43]
v_exp_f32 v10, v10
v_mfma_f32_16x16x32_bf16 a[0:3], a[160:163], v[88:91], a[0:3]
v_cvt_pk_bf16_f32 v72, v8, v9
v_mfma_f32_16x16x32_bf16 a[32:35], a[160:163], v[92:95], a[32:35]
v_exp_f32 v11, v11
v_mfma_f32_16x16x32_bf16 a[64:67], a[160:163], v[96:99], a[64:67]
v_cvt_pk_bf16_f32 v73, v10, v11
v_mfma_f32_16x16x32_bf16 a[96:99], a[160:163], v[100:103], a[96:99]
v_exp_f32 v12, v12
v_mfma_f32_16x16x32_bf16 v[48:51], a[128:131], v[168:171], v[140:143]
ds_read_b64_tr_b16 a[160:161], v220 offset:16384
ds_read_b64_tr_b16 a[162:163], v220 offset:20480
v_mfma_f32_16x16x32_bf16 v[48:51], a[132:135], v[172:175], v[48:51]
v_exp_f32 v13, v13
v_mfma_f32_16x16x32_bf16 v[48:51], a[136:139], v[176:179], v[48:51]
v_cvt_pk_bf16_f32 v74, v12, v13
v_mfma_f32_16x16x32_bf16 v[48:51], a[140:143], v[180:183], v[48:51]
v_exp_f32 v14, v14
v_mfma_f32_16x16x32_bf16 a[4:7], a[164:167], v[88:91], a[4:7]
v_mfma_f32_16x16x32_bf16 a[36:39], a[164:167], v[92:95], a[36:39]
s_add_u32 s39, s39, 16384
v_exp_f32 v15, v15
v_mfma_f32_16x16x32_bf16 a[68:71], a[164:167], v[96:99], a[68:71]
s_add_u32 m0, s37, 0
v_cvt_pk_bf16_f32 v75, v14, v15
v_mfma_f32_16x16x32_bf16 a[100:103], a[164:167], v[100:103], a[100:103]
v_exp_f32 v16, v16
v_smfmac_f32_16x16x64_bf16 a[248:251], a[208:211], v[88:95], v235
buffer_load_dwordx4 v228, s[8:11], s38 offen offset:0 lds
v_mfma_f32_16x16x32_bf16 v[56:59], a[128:131], v[184:187], v[144:147]
v_exp_f32 v17, v17
v_mfma_f32_16x16x32_bf16 v[56:59], a[132:135], v[188:191], v[56:59]
ds_read_b64_tr_b16 a[164:165], v221 offset:16384
ds_read_b64_tr_b16 a[166:167], v221 offset:20480
v_mfma_f32_16x16x32_bf16 v[56:59], a[136:139], v[192:195], v[56:59]
v_exp_f32 v18, v18
v_mfma_f32_16x16x32_bf16 v[56:59], a[140:143], v[196:199], v[56:59]
v_cvt_pk_bf16_f32 v76, v16, v17
v_mfma_f32_16x16x32_bf16 a[8:11], a[168:171], v[88:91], a[8:11]
v_exp_f32 v19, v19
v_mfma_f32_16x16x32_bf16 a[40:43], a[168:171], v[92:95], a[40:43]
v_cvt_pk_bf16_f32 v77, v18, v19
v_mfma_f32_16x16x32_bf16 a[72:75], a[168:171], v[96:99], a[72:75]
v_exp_f32 v20, v20
v_mfma_f32_16x16x32_bf16 a[104:107], a[168:171], v[100:103], a[104:107]
ds_read_b64_tr_b16 a[168:169], v222 offset:16384
ds_read_b64_tr_b16 a[170:171], v222 offset:20480
v_mfma_f32_16x16x32_bf16 v[64:67], a[128:131], v[200:203], v[148:151]
v_exp_f32 v21, v21
v_mfma_f32_16x16x32_bf16 v[64:67], a[132:135], v[204:207], v[64:67]
buffer_load_dwordx4 v229, s[8:11], s38 offen offset:1024 lds
v_mfma_f32_16x16x32_bf16 v[64:67], a[136:139], v[208:211], v[64:67]
v_exp_f32 v22, v22
v_mfma_f32_16x16x32_bf16 v[64:67], a[140:143], v[212:215], v[64:67]
ds_read_b128 a[128:131], v216 offset:32768
ds_read_b128 a[132:135], v217 offset:32768
v_mfma_f32_16x16x32_bf16 a[12:15], a[172:175], v[88:91], a[12:15]
v_exp_f32 v23, v23
v_mfma_f32_16x16x32_bf16 a[44:47], a[172:175], v[92:95], a[44:47]
ds_read_b128 a[136:139], v218 offset:32768
ds_read_b128 a[140:143], v219 offset:32768
v_mfma_f32_16x16x32_bf16 a[76:79], a[172:175], v[96:99], a[76:79]
v_exp_f32 v24, v24
v_mfma_f32_16x16x32_bf16 a[108:111], a[172:175], v[100:103], a[108:111]
s_waitcnt lgkmcnt(6)
v_exp_f32 v25, v25
v_mfma_f32_16x16x32_bf16 v[44:47], a[144:147], v[152:155], v[136:139]
ds_read_b64_tr_b16 a[172:173], v223 offset:16384
ds_read_b64_tr_b16 a[174:175], v223 offset:20480
v_mfma_f32_16x16x32_bf16 v[44:47], a[148:151], v[156:159], v[44:47]
v_exp_f32 v26, v26
v_mfma_f32_16x16x32_bf16 v[44:47], a[152:155], v[160:163], v[44:47]
v_cvt_pk_bf16_f32 v78, v20, v21
v_cvt_pk_bf16_f32 v79, v22, v23
v_mfma_f32_16x16x32_bf16 v[44:47], a[156:159], v[164:167], v[44:47]
v_exp_f32 v27, v27
v_mfma_f32_16x16x32_bf16 a[16:19], a[176:179], v[88:91], a[16:19]
v_cvt_pk_bf16_f32 v80, v24, v25
v_cvt_pk_bf16_f32 v81, v26, v27
v_mfma_f32_16x16x32_bf16 a[48:51], a[176:179], v[92:95], a[48:51]
v_exp_f32 v28, v28
v_mfma_f32_16x16x32_bf16 a[80:83], a[176:179], v[96:99], a[80:83]
buffer_load_dwordx4 v230, s[8:11], s38 offen offset:2048 lds
v_mfma_f32_16x16x32_bf16 a[112:115], a[176:179], v[100:103], a[112:115]
v_exp_f32 v29, v29
v_mfma_f32_16x16x32_bf16 v[52:55], a[144:147], v[168:171], v[140:143]
ds_read_b64_tr_b16 a[176:177], v224 offset:16384
ds_read_b64_tr_b16 a[178:179], v224 offset:20480
v_mfma_f32_16x16x32_bf16 v[52:55], a[148:151], v[172:175], v[52:55]
v_exp_f32 v30, v30
v_mfma_f32_16x16x32_bf16 v[52:55], a[152:155], v[176:179], v[52:55]
v_cvt_pk_bf16_f32 v82, v28, v29
v_mfma_f32_16x16x32_bf16 v[52:55], a[156:159], v[180:183], v[52:55]
v_exp_f32 v31, v31
v_mfma_f32_16x16x32_bf16 a[20:23], a[180:183], v[88:91], a[20:23]
v_cvt_pk_bf16_f32 v83, v30, v31
v_mfma_f32_16x16x32_bf16 a[52:55], a[180:183], v[92:95], a[52:55]
v_exp_f32 v32, v32
v_mfma_f32_16x16x32_bf16 a[84:87], a[180:183], v[96:99], a[84:87]
v_mfma_f32_16x16x32_bf16 a[116:119], a[180:183], v[100:103], a[116:119]
v_exp_f32 v33, v33
v_smfmac_f32_16x16x64_bf16 a[252:255], a[208:211], v[96:103], v235
ds_read_b64_tr_b16 a[180:181], v225 offset:16384
ds_read_b64_tr_b16 a[182:183], v225 offset:20480
v_mfma_f32_16x16x32_bf16 v[60:63], a[144:147], v[184:187], v[144:147]
v_exp_f32 v34, v34
v_mfma_f32_16x16x32_bf16 v[60:63], a[148:151], v[188:191], v[60:63]
buffer_load_dwordx4 v231, s[8:11], s38 offen offset:3072 lds
v_mfma_f32_16x16x32_bf16 v[60:63], a[152:155], v[192:195], v[60:63]
v_exp_f32 v35, v35
v_mfma_f32_16x16x32_bf16 v[60:63], a[156:159], v[196:199], v[60:63]
v_cvt_pk_bf16_f32 v84, v32, v33
v_cvt_pk_bf16_f32 v85, v34, v35
v_mfma_f32_16x16x32_bf16 a[24:27], a[184:187], v[88:91], a[24:27]
v_exp_f32 v36, v36
v_mfma_f32_16x16x32_bf16 a[56:59], a[184:187], v[92:95], a[56:59]
v_mfma_f32_16x16x32_bf16 a[88:91], a[184:187], v[96:99], a[88:91]
v_exp_f32 v37, v37
v_mfma_f32_16x16x32_bf16 a[120:123], a[184:187], v[100:103], a[120:123]
ds_read_b64_tr_b16 a[184:185], v226 offset:16384
ds_read_b64_tr_b16 a[186:187], v226 offset:20480
v_mfma_f32_16x16x32_bf16 v[68:71], a[144:147], v[200:203], v[148:151]
v_exp_f32 v38, v38
v_mfma_f32_16x16x32_bf16 v[68:71], a[148:151], v[204:207], v[68:71]
ds_read_b128 a[144:147], v216 offset:36864
ds_read_b128 a[148:151], v217 offset:36864
v_mfma_f32_16x16x32_bf16 v[68:71], a[152:155], v[208:211], v[68:71]
v_exp_f32 v39, v39
v_mfma_f32_16x16x32_bf16 v[68:71], a[156:159], v[212:215], v[68:71]
ds_read_b128 a[152:155], v218 offset:36864
ds_read_b128 a[156:159], v219 offset:36864
v_mfma_f32_16x16x32_bf16 a[28:31], a[188:191], v[88:91], a[28:31]
v_cvt_pk_bf16_f32 v86, v36, v37
v_cvt_pk_bf16_f32 v87, v38, v39
v_mfma_f32_16x16x32_bf16 a[60:63], a[188:191], v[92:95], a[60:63]
s_add_u32 s38, s38, 16384
v_mfma_f32_16x16x32_bf16 a[92:95], a[188:191], v[96:99], a[92:95]
v_mfma_f32_16x16x32_bf16 a[124:127], a[188:191], v[100:103], a[124:127]
s_waitcnt lgkmcnt(6)
ds_read_b64_tr_b16 a[188:189], v227 offset:16384
ds_read_b64_tr_b16 a[190:191], v227 offset:20480
v_mfma_f32_16x16x32_bf16 v[8:11], a[128:131], v[152:155], v[136:139]
v_exp_f32 v40, v40
v_mfma_f32_16x16x32_bf16 v[8:11], a[132:135], v[156:159], v[8:11]
v_exp_f32 v41, v41
v_mfma_f32_16x16x32_bf16 v[8:11], a[136:139], v[160:163], v[8:11]
buffer_load_dwordx2 v[252:253], v251, s[76:79], s42 offen sc1
v_mfma_f32_16x16x32_bf16 v[8:11], a[140:143], v[164:167], v[8:11]
v_exp_f32 v42, v42
v_mfma_f32_16x16x32_bf16 a[0:3], a[160:163], v[72:75], a[0:3]
v_cvt_pk_bf16_f32 v88, v40, v41
v_mfma_f32_16x16x32_bf16 a[32:35], a[160:163], v[76:79], a[32:35]
v_exp_f32 v43, v43
v_mfma_f32_16x16x32_bf16 a[64:67], a[160:163], v[80:83], a[64:67]
v_cvt_pk_bf16_f32 v89, v42, v43
v_mfma_f32_16x16x32_bf16 a[96:99], a[160:163], v[84:87], a[96:99]
v_exp_f32 v44, v44
v_mfma_f32_16x16x32_bf16 v[16:19], a[128:131], v[168:171], v[140:143]
ds_read_b64_tr_b16 a[160:161], v220 offset:24576
ds_read_b64_tr_b16 a[162:163], v220 offset:28672
v_mfma_f32_16x16x32_bf16 v[16:19], a[132:135], v[172:175], v[16:19]
v_exp_f32 v45, v45
v_mfma_f32_16x16x32_bf16 v[16:19], a[136:139], v[176:179], v[16:19]
s_add_u32 s42, s42, s43
buffer_load_dword v255, v243, s[28:31], s45 offen
v_mfma_f32_16x16x32_bf16 v[16:19], a[140:143], v[180:183], v[16:19]
v_exp_f32 v46, v46
v_mfma_f32_16x16x32_bf16 a[4:7], a[164:167], v[72:75], a[4:7]
v_cvt_pk_bf16_f32 v90, v44, v45
v_mfma_f32_16x16x32_bf16 a[36:39], a[164:167], v[76:79], a[36:39]
v_exp_f32 v47, v47
v_mfma_f32_16x16x32_bf16 a[68:71], a[164:167], v[80:83], a[68:71]
v_cvt_pk_bf16_f32 v91, v46, v47
v_mfma_f32_16x16x32_bf16 a[100:103], a[164:167], v[84:87], a[100:103]
v_exp_f32 v48, v48
v_smfmac_f32_16x16x64_bf16 a[248:251], a[208:211], v[72:79], v235
ds_read_b64_tr_b16 a[164:165], v221 offset:24576
ds_read_b64_tr_b16 a[166:167], v221 offset:28672
v_mfma_f32_16x16x32_bf16 v[24:27], a[128:131], v[184:187], v[144:147]
v_exp_f32 v49, v49
v_mfma_f32_16x16x32_bf16 v[24:27], a[132:135], v[188:191], v[24:27]
v_cvt_pk_bf16_f32 v92, v48, v49
v_mfma_f32_16x16x32_bf16 v[24:27], a[136:139], v[192:195], v[24:27]
s_add_u32 s45, s45, 589824
v_exp_f32 v50, v50
v_mfma_f32_16x16x32_bf16 v[24:27], a[140:143], v[196:199], v[24:27]
global_load_dword v255, v242, s[72:73]
v_mfma_f32_16x16x32_bf16 a[8:11], a[168:171], v[72:75], a[8:11]
v_exp_f32 v51, v51
v_mfma_f32_16x16x32_bf16 a[40:43], a[168:171], v[76:79], a[40:43]
v_cvt_pk_bf16_f32 v93, v50, v51
v_mfma_f32_16x16x32_bf16 a[72:75], a[168:171], v[80:83], a[72:75]
v_exp_f32 v52, v52
v_mfma_f32_16x16x32_bf16 a[104:107], a[168:171], v[84:87], a[104:107]
ds_read_b64_tr_b16 a[168:169], v222 offset:24576
ds_read_b64_tr_b16 a[170:171], v222 offset:28672
v_mfma_f32_16x16x32_bf16 v[32:35], a[128:131], v[200:203], v[148:151]
v_exp_f32 v53, v53
v_mfma_f32_16x16x32_bf16 v[32:35], a[132:135], v[204:207], v[32:35]
ds_read_b128 a[128:131], v216 offset:40960
ds_read_b128 a[132:135], v217 offset:40960
v_mfma_f32_16x16x32_bf16 v[32:35], a[136:139], v[208:211], v[32:35]
v_exp_f32 v54, v54
v_mfma_f32_16x16x32_bf16 v[32:35], a[140:143], v[212:215], v[32:35]
buffer_load_dword v255, v0, s[24:27], s44 offen sc1
v_mfma_f32_16x16x32_bf16 a[12:15], a[172:175], v[72:75], a[12:15]
v_exp_f32 v55, v55
v_mfma_f32_16x16x32_bf16 a[44:47], a[172:175], v[76:79], a[44:47]
ds_read_b128 a[136:139], v218 offset:40960
ds_read_b128 a[140:143], v219 offset:40960
v_mfma_f32_16x16x32_bf16 a[76:79], a[172:175], v[80:83], a[76:79]
v_exp_f32 v56, v56
v_mfma_f32_16x16x32_bf16 a[108:111], a[172:175], v[84:87], a[108:111]
s_waitcnt lgkmcnt(6)
v_exp_f32 v57, v57
v_mfma_f32_16x16x32_bf16 v[12:15], a[144:147], v[152:155], v[136:139]
ds_read_b64_tr_b16 a[172:173], v223 offset:24576
ds_read_b64_tr_b16 a[174:175], v223 offset:28672
v_mfma_f32_16x16x32_bf16 v[12:15], a[148:151], v[156:159], v[12:15]
v_exp_f32 v58, v58
v_mfma_f32_16x16x32_bf16 v[12:15], a[152:155], v[160:163], v[12:15]
v_cvt_pk_bf16_f32 v94, v52, v53
v_cvt_pk_bf16_f32 v95, v54, v55
v_mfma_f32_16x16x32_bf16 v[12:15], a[156:159], v[164:167], v[12:15]
v_exp_f32 v59, v59
v_mfma_f32_16x16x32_bf16 a[16:19], a[176:179], v[72:75], a[16:19]
s_add_u32 s44, s44, 8192
v_cvt_pk_bf16_f32 v96, v56, v57
v_cvt_pk_bf16_f32 v97, v58, v59
v_mfma_f32_16x16x32_bf16 a[48:51], a[176:179], v[76:79], a[48:51]
v_exp_f32 v60, v60
v_mfma_f32_16x16x32_bf16 a[80:83], a[176:179], v[80:83], a[80:83]
v_mfma_f32_16x16x32_bf16 a[112:115], a[176:179], v[84:87], a[112:115]
v_exp_f32 v61, v61
v_mfma_f32_16x16x32_bf16 v[20:23], a[144:147], v[168:171], v[140:143]
ds_read_b64_tr_b16 a[176:177], v224 offset:24576
ds_read_b64_tr_b16 a[178:179], v224 offset:28672
v_mfma_f32_16x16x32_bf16 v[20:23], a[148:151], v[172:175], v[20:23]
v_exp_f32 v62, v62
v_mfma_f32_16x16x32_bf16 v[20:23], a[152:155], v[176:179], v[20:23]
v_cvt_pk_bf16_f32 v98, v60, v61
v_mfma_f32_16x16x32_bf16 v[20:23], a[156:159], v[180:183], v[20:23]
v_exp_f32 v63, v63
v_mfma_f32_16x16x32_bf16 a[20:23], a[180:183], v[72:75], a[20:23]
v_cvt_pk_bf16_f32 v99, v62, v63
v_mfma_f32_16x16x32_bf16 a[52:55], a[180:183], v[76:79], a[52:55]
v_exp_f32 v64, v64
v_mfma_f32_16x16x32_bf16 a[84:87], a[180:183], v[80:83], a[84:87]
v_mfma_f32_16x16x32_bf16 a[116:119], a[180:183], v[84:87], a[116:119]
v_exp_f32 v65, v65
v_smfmac_f32_16x16x64_bf16 a[252:255], a[208:211], v[80:87], v235
ds_read_b64_tr_b16 a[180:181], v225 offset:24576
ds_read_b64_tr_b16 a[182:183], v225 offset:28672
v_mfma_f32_16x16x32_bf16 v[28:31], a[144:147], v[184:187], v[144:147]
v_exp_f32 v66, v66
v_mfma_f32_16x16x32_bf16 v[28:31], a[148:151], v[188:191], v[28:31]
v_cvt_pk_bf16_f32 v100, v64, v65
v_mfma_f32_16x16x32_bf16 v[28:31], a[152:155], v[192:195], v[28:31]
v_exp_f32 v67, v67
v_mfma_f32_16x16x32_bf16 v[28:31], a[156:159], v[196:199], v[28:31]
v_cvt_pk_bf16_f32 v101, v66, v67
v_mfma_f32_16x16x32_bf16 a[24:27], a[184:187], v[72:75], a[24:27]
v_exp_f32 v68, v68
v_mfma_f32_16x16x32_bf16 a[56:59], a[184:187], v[76:79], a[56:59]
v_mfma_f32_16x16x32_bf16 a[88:91], a[184:187], v[80:83], a[88:91]
v_exp_f32 v69, v69
v_mfma_f32_16x16x32_bf16 a[120:123], a[184:187], v[84:87], a[120:123]
ds_read_b64_tr_b16 a[184:185], v226 offset:24576
ds_read_b64_tr_b16 a[186:187], v226 offset:28672
v_mfma_f32_16x16x32_bf16 v[36:39], a[144:147], v[200:203], v[148:151]
v_exp_f32 v70, v70
v_mfma_f32_16x16x32_bf16 v[36:39], a[148:151], v[204:207], v[36:39]
ds_read_b128 a[144:147], v216 offset:45056
ds_read_b128 a[148:151], v217 offset:45056
v_mfma_f32_16x16x32_bf16 v[36:39], a[152:155], v[208:211], v[36:39]
v_exp_f32 v71, v71
v_mfma_f32_16x16x32_bf16 v[36:39], a[156:159], v[212:215], v[36:39]
ds_read_b128 a[152:155], v218 offset:45056
ds_read_b128 a[156:159], v219 offset:45056
v_mfma_f32_16x16x32_bf16 a[28:31], a[188:191], v[72:75], a[28:31]
v_cvt_pk_bf16_f32 v102, v68, v69
v_cvt_pk_bf16_f32 v103, v70, v71
v_mfma_f32_16x16x32_bf16 a[60:63], a[188:191], v[76:79], a[60:63]
v_mfma_f32_16x16x32_bf16 a[92:95], a[188:191], v[80:83], a[92:95]
v_mfma_f32_16x16x32_bf16 a[124:127], a[188:191], v[84:87], a[124:127]
s_waitcnt lgkmcnt(6)
ds_read_b64_tr_b16 a[188:189], v227 offset:24576
ds_read_b64_tr_b16 a[190:191], v227 offset:28672
v_mfma_f32_16x16x32_bf16 v[40:43], a[128:131], v[152:155], v[136:139]
v_exp_f32 v8, v8
v_mfma_f32_16x16x32_bf16 v[40:43], a[132:135], v[156:159], v[40:43]
v_exp_f32 v9, v9
v_mfma_f32_16x16x32_bf16 v[40:43], a[136:139], v[160:163], v[40:43]
v_cvt_pk_bf16_f32 v72, v8, v9
v_mfma_f32_16x16x32_bf16 v[40:43], a[140:143], v[164:167], v[40:43]
v_exp_f32 v10, v10
v_mfma_f32_16x16x32_bf16 a[0:3], a[160:163], v[88:91], a[0:3]
v_mfma_f32_16x16x32_bf16 a[32:35], a[160:163], v[92:95], a[32:35]
v_exp_f32 v11, v11
s_waitcnt vmcnt(4) lgkmcnt(0)
s_barrier
v_mfma_f32_16x16x32_bf16 a[64:67], a[160:163], v[96:99], a[64:67]
v_cvt_pk_bf16_f32 v73, v10, v11
v_mfma_f32_16x16x32_bf16 a[96:99], a[160:163], v[100:103], a[96:99]
s_add_u32 m0, s37, 65536
v_exp_f32 v12, v12
v_mfma_f32_16x16x32_bf16 v[48:51], a[128:131], v[168:171], v[140:143]
buffer_load_dwordx4 v232, s[12:15], s39 offen offset:0 lds
v_mfma_f32_16x16x32_bf16 v[48:51], a[132:135], v[172:175], v[48:51]
v_exp_f32 v13, v13
v_mfma_f32_16x16x32_bf16 v[48:51], a[136:139], v[176:179], v[48:51]
ds_read_b64_tr_b16 a[160:161], v220 offset:32768
ds_read_b64_tr_b16 a[162:163], v220 offset:36864
v_mfma_f32_16x16x32_bf16 v[48:51], a[140:143], v[180:183], v[48:51]
v_exp_f32 v14, v14
v_mfma_f32_16x16x32_bf16 a[4:7], a[164:167], v[88:91], a[4:7]
v_cvt_pk_bf16_f32 v74, v12, v13
v_mfma_f32_16x16x32_bf16 a[36:39], a[164:167], v[92:95], a[36:39]
v_exp_f32 v15, v15
v_mfma_f32_16x16x32_bf16 a[68:71], a[164:167], v[96:99], a[68:71]
v_cvt_pk_bf16_f32 v75, v14, v15
v_mfma_f32_16x16x32_bf16 a[100:103], a[164:167], v[100:103], a[100:103]
v_exp_f32 v16, v16
v_smfmac_f32_16x16x64_bf16 a[248:251], a[208:211], v[88:95], v235
buffer_load_dwordx4 v233, s[12:15], s39 offen offset:1024 lds
v_mfma_f32_16x16x32_bf16 v[56:59], a[128:131], v[184:187], v[144:147]
v_exp_f32 v17, v17
v_mfma_f32_16x16x32_bf16 v[56:59], a[132:135], v[188:191], v[56:59]
ds_read_b64_tr_b16 a[164:165], v221 offset:32768
ds_read_b64_tr_b16 a[166:167], v221 offset:36864
v_mfma_f32_16x16x32_bf16 v[56:59], a[136:139], v[192:195], v[56:59]
v_exp_f32 v18, v18
v_mfma_f32_16x16x32_bf16 v[56:59], a[140:143], v[196:199], v[56:59]
v_cvt_pk_bf16_f32 v76, v16, v17
v_mfma_f32_16x16x32_bf16 a[8:11], a[168:171], v[88:91], a[8:11]
v_exp_f32 v19, v19
v_mfma_f32_16x16x32_bf16 a[40:43], a[168:171], v[92:95], a[40:43]
v_cvt_pk_bf16_f32 v77, v18, v19
v_mfma_f32_16x16x32_bf16 a[72:75], a[168:171], v[96:99], a[72:75]
v_exp_f32 v20, v20
v_mfma_f32_16x16x32_bf16 a[104:107], a[168:171], v[100:103], a[104:107]
ds_read_b64_tr_b16 a[168:169], v222 offset:32768
ds_read_b64_tr_b16 a[170:171], v222 offset:36864
v_mfma_f32_16x16x32_bf16 v[64:67], a[128:131], v[200:203], v[148:151]
v_exp_f32 v21, v21
v_mfma_f32_16x16x32_bf16 v[64:67], a[132:135], v[204:207], v[64:67]
buffer_load_dwordx4 v232, s[12:15], s39 offen offset:2048 lds
v_mfma_f32_16x16x32_bf16 v[64:67], a[136:139], v[208:211], v[64:67]
v_exp_f32 v22, v22
v_mfma_f32_16x16x32_bf16 v[64:67], a[140:143], v[212:215], v[64:67]
ds_read_b128 a[128:131], v216 offset:16384
ds_read_b128 a[132:135], v217 offset:16384
v_mfma_f32_16x16x32_bf16 a[12:15], a[172:175], v[88:91], a[12:15]
v_exp_f32 v23, v23
v_mfma_f32_16x16x32_bf16 a[44:47], a[172:175], v[92:95], a[44:47]
ds_read_b128 a[136:139], v218 offset:16384
ds_read_b128 a[140:143], v219 offset:16384
v_mfma_f32_16x16x32_bf16 a[76:79], a[172:175], v[96:99], a[76:79]
v_exp_f32 v24, v24
v_mfma_f32_16x16x32_bf16 a[108:111], a[172:175], v[100:103], a[108:111]
v_exp_f32 v25, v25
v_mfma_f32_16x16x32_bf16 v[44:47], a[144:147], v[152:155], v[136:139]
ds_read_b64_tr_b16 a[172:173], v223 offset:32768
ds_read_b64_tr_b16 a[174:175], v223 offset:36864
v_mfma_f32_16x16x32_bf16 v[44:47], a[148:151], v[156:159], v[44:47]
v_exp_f32 v26, v26
v_mfma_f32_16x16x32_bf16 v[44:47], a[152:155], v[160:163], v[44:47]
buffer_load_dwordx4 v233, s[12:15], s39 offen offset:3072 lds
v_mfma_f32_16x16x32_bf16 v[44:47], a[156:159], v[164:167], v[44:47]
v_exp_f32 v27, v27
v_mfma_f32_16x16x32_bf16 a[16:19], a[176:179], v[88:91], a[16:19]
v_cvt_pk_bf16_f32 v78, v20, v21
v_cvt_pk_bf16_f32 v79, v22, v23
v_mfma_f32_16x16x32_bf16 a[48:51], a[176:179], v[92:95], a[48:51]
v_exp_f32 v28, v28
v_mfma_f32_16x16x32_bf16 a[80:83], a[176:179], v[96:99], a[80:83]
v_cvt_pk_bf16_f32 v80, v24, v25
v_cvt_pk_bf16_f32 v81, v26, v27
v_mfma_f32_16x16x32_bf16 a[112:115], a[176:179], v[100:103], a[112:115]
v_exp_f32 v29, v29
v_mfma_f32_16x16x32_bf16 v[52:55], a[144:147], v[168:171], v[140:143]
ds_read_b64_tr_b16 a[176:177], v224 offset:32768
ds_read_b64_tr_b16 a[178:179], v224 offset:36864
v_mfma_f32_16x16x32_bf16 v[52:55], a[148:151], v[172:175], v[52:55]
v_exp_f32 v30, v30
v_mfma_f32_16x16x32_bf16 v[52:55], a[152:155], v[176:179], v[52:55]
v_cvt_pk_bf16_f32 v82, v28, v29
v_mfma_f32_16x16x32_bf16 v[52:55], a[156:159], v[180:183], v[52:55]
s_add_u32 s39, s39, 16384
v_exp_f32 v31, v31
v_mfma_f32_16x16x32_bf16 a[20:23], a[180:183], v[88:91], a[20:23]
s_add_u32 m0, s37, 49152
v_cvt_pk_bf16_f32 v83, v30, v31
v_mfma_f32_16x16x32_bf16 a[52:55], a[180:183], v[92:95], a[52:55]
v_exp_f32 v32, v32
v_mfma_f32_16x16x32_bf16 a[84:87], a[180:183], v[96:99], a[84:87]
buffer_load_dwordx4 v228, s[8:11], s38 offen offset:0 lds
v_mfma_f32_16x16x32_bf16 a[116:119], a[180:183], v[100:103], a[116:119]
v_exp_f32 v33, v33
v_smfmac_f32_16x16x64_bf16 a[252:255], a[208:211], v[96:103], v235
ds_read_b64_tr_b16 a[180:181], v225 offset:32768
ds_read_b64_tr_b16 a[182:183], v225 offset:36864
v_mfma_f32_16x16x32_bf16 v[60:63], a[144:147], v[184:187], v[144:147]
v_exp_f32 v34, v34
v_mfma_f32_16x16x32_bf16 v[60:63], a[148:151], v[188:191], v[60:63]
v_cvt_pk_bf16_f32 v84, v32, v33
v_mfma_f32_16x16x32_bf16 v[60:63], a[152:155], v[192:195], v[60:63]
v_exp_f32 v35, v35
v_mfma_f32_16x16x32_bf16 v[60:63], a[156:159], v[196:199], v[60:63]
buffer_load_dwordx4 v229, s[8:11], s38 offen offset:1024 lds
v_mfma_f32_16x16x32_bf16 a[24:27], a[184:187], v[88:91], a[24:27]
v_exp_f32 v36, v36
v_mfma_f32_16x16x32_bf16 a[56:59], a[184:187], v[92:95], a[56:59]
v_cvt_pk_bf16_f32 v85, v34, v35
v_mfma_f32_16x16x32_bf16 a[88:91], a[184:187], v[96:99], a[88:91]
v_exp_f32 v37, v37
v_mfma_f32_16x16x32_bf16 a[120:123], a[184:187], v[100:103], a[120:123]
ds_read_b64_tr_b16 a[184:185], v226 offset:32768
ds_read_b64_tr_b16 a[186:187], v226 offset:36864
v_mfma_f32_16x16x32_bf16 v[68:71], a[144:147], v[200:203], v[148:151]
v_exp_f32 v38, v38
v_mfma_f32_16x16x32_bf16 v[68:71], a[148:151], v[204:207], v[68:71]
ds_read_b128 a[144:147], v216 offset:20480
ds_read_b128 a[148:151], v217 offset:20480
v_mfma_f32_16x16x32_bf16 v[68:71], a[152:155], v[208:211], v[68:71]
v_exp_f32 v39, v39
v_mfma_f32_16x16x32_bf16 v[68:71], a[156:159], v[212:215], v[68:71]
ds_read_b128 a[152:155], v218 offset:20480
ds_read_b128 a[156:159], v219 offset:20480
v_mfma_f32_16x16x32_bf16 a[28:31], a[188:191], v[88:91], a[28:31]
v_cvt_pk_bf16_f32 v86, v36, v37
v_cvt_pk_bf16_f32 v87, v38, v39
v_mfma_f32_16x16x32_bf16 a[60:63], a[188:191], v[92:95], a[60:63]
v_mfma_f32_16x16x32_bf16 a[92:95], a[188:191], v[96:99], a[92:95]
v_mfma_f32_16x16x32_bf16 a[124:127], a[188:191], v[100:103], a[124:127]
s_waitcnt lgkmcnt(6)
ds_read_b64_tr_b16 a[188:189], v227 offset:32768
ds_read_b64_tr_b16 a[190:191], v227 offset:36864
s_branch K_LOOP
K_EXIT:
s_cmp_lg_u32 s40, 8
s_cbranch_scc1 K_HOOK
K_LAST:
v_mfma_f32_16x16x32_bf16 v[40:43], a[128:131], v[152:155], v[136:139]
s_add_u32 s46, s36, 1
v_exp_f32 v8, v8
v_mfma_f32_16x16x32_bf16 v[40:43], a[132:135], v[156:159], v[40:43]
s_and_b32 s46, s46, 3
v_exp_f32 v9, v9
v_mfma_f32_16x16x32_bf16 v[40:43], a[136:139], v[160:163], v[40:43]
s_mul_i32 s42, s46, 294912
v_cvt_pk_bf16_f32 v72, v8, v9
v_mfma_f32_16x16x32_bf16 v[40:43], a[140:143], v[164:167], v[40:43]
s_add_u32 s42, s42, s84
v_exp_f32 v10, v10
v_mfma_f32_16x16x32_bf16 a[0:3], a[160:163], v[88:91], a[0:3]
s_add_u32 s46, s36, 2
v_mfma_f32_16x16x32_bf16 a[32:35], a[160:163], v[92:95], a[32:35]
s_and_b32 s46, s46, 3
v_exp_f32 v11, v11
s_waitcnt vmcnt(4) lgkmcnt(0)
s_barrier
v_mfma_f32_16x16x32_bf16 a[64:67], a[160:163], v[96:99], a[64:67]
s_mul_i32 s43, s46, 294912
v_cvt_pk_bf16_f32 v73, v10, v11
v_mfma_f32_16x16x32_bf16 a[96:99], a[160:163], v[100:103], a[96:99]
s_add_u32 m0, s3, 98304
v_exp_f32 v12, v12
v_mfma_f32_16x16x32_bf16 v[48:51], a[128:131], v[168:171], v[140:143]
s_add_u32 s48, s51, 0
buffer_load_dwordx4 v236, s[16:19], s48 offen lds
v_mfma_f32_16x16x32_bf16 v[48:51], a[132:135], v[172:175], v[48:51]
s_add_u32 s43, s43, s84
v_exp_f32 v13, v13
v_mfma_f32_16x16x32_bf16 v[48:51], a[136:139], v[176:179], v[48:51]
s_add_u32 s46, s36, 3
ds_read_b64_tr_b16 a[160:161], v220 offset:0
ds_read_b64_tr_b16 a[162:163], v220 offset:4096
v_mfma_f32_16x16x32_bf16 v[48:51], a[140:143], v[180:183], v[48:51]
s_and_b32 s46, s46, 3
v_exp_f32 v14, v14
v_mfma_f32_16x16x32_bf16 a[4:7], a[164:167], v[88:91], a[4:7]
s_add_u32 m0, s3, 102400
v_cvt_pk_bf16_f32 v74, v12, v13
v_mfma_f32_16x16x32_bf16 a[36:39], a[164:167], v[92:95], a[36:39]
s_add_u32 s48, s51, 18432
v_exp_f32 v15, v15
v_mfma_f32_16x16x32_bf16 a[68:71], a[164:167], v[96:99], a[68:71]
s_mul_i32 s44, s46, 294912
buffer_load_dwordx4 v236, s[16:19], s48 offen lds
v_mfma_f32_16x16x32_bf16 a[100:103], a[164:167], v[100:103], a[100:103]
s_add_u32 s44, s44, s84
v_exp_f32 v16, v16
v_smfmac_f32_16x16x64_bf16 a[248:251], a[208:211], v[88:95], v235
s_cmp_eq_u32 s32, s36
s_cselect_b32 s83, s52, 0
ds_read_b64_tr_b16 a[164:165], v221 offset:0
ds_read_b64_tr_b16 a[166:167], v221 offset:4096
v_mfma_f32_16x16x32_bf16 v[56:59], a[128:131], v[184:187], v[144:147]
s_cmp_lg_u32 s83, 0
s_cselect_b32 s47, 0, 0x7f000000
v_exp_f32 v17, v17
v_mfma_f32_16x16x32_bf16 v[56:59], a[132:135], v[188:191], v[56:59]
s_add_u32 m0, s3, 106496
v_cvt_pk_bf16_f32 v75, v14, v15
v_cvt_pk_bf16_f32 v76, v16, v17
v_mfma_f32_16x16x32_bf16 v[56:59], a[136:139], v[192:195], v[56:59]
s_add_u32 s48, s51, 36864
v_exp_f32 v18, v18
v_mfma_f32_16x16x32_bf16 v[56:59], a[140:143], v[196:199], v[56:59]
buffer_load_dwordx4 v236, s[16:19], s48 offen lds
v_mfma_f32_16x16x32_bf16 a[8:11], a[168:171], v[88:91], a[8:11]
v_exp_f32 v19, v19
v_mfma_f32_16x16x32_bf16 a[40:43], a[168:171], v[92:95], a[40:43]
v_cvt_pk_bf16_f32 v77, v18, v19
v_lshlrev_b32 v7, 7, v3
v_mfma_f32_16x16x32_bf16 a[72:75], a[168:171], v[96:99], a[72:75]
s_add_u32 m0, s3, 110592
v_exp_f32 v20, v20
v_mfma_f32_16x16x32_bf16 a[104:107], a[168:171], v[100:103], a[104:107]
s_add_u32 s48, s51, 55296
buffer_load_dwordx4 v236, s[16:19], s48 offen lds
v_mfma_f32_16x16x32_bf16 v[64:67], a[128:131], v[200:203], v[148:151]
v_exp_f32 v21, v21
v_mfma_f32_16x16x32_bf16 v[64:67], a[132:135], v[204:207], v[64:67]
ds_read_b64_tr_b16 a[168:169], v222 offset:0
ds_read_b64_tr_b16 a[170:171], v222 offset:4096
v_mfma_f32_16x16x32_bf16 v[64:67], a[136:139], v[208:211], v[64:67]
v_exp_f32 v22, v22
v_mfma_f32_16x16x32_bf16 v[64:67], a[140:143], v[212:215], v[64:67]
ds_read_b128 a[128:131], v216 offset:49152
ds_read_b128 a[132:135], v217 offset:49152
v_mfma_f32_16x16x32_bf16 a[12:15], a[172:175], v[88:91], a[12:15]
s_add_u32 m0, s3, 114688
v_exp_f32 v23, v23
v_mfma_f32_16x16x32_bf16 a[44:47], a[172:175], v[92:95], a[44:47]
s_add_u32 s48, s51, 73728
buffer_load_dwordx4 v236, s[16:19], s48 offen lds
v_mfma_f32_16x16x32_bf16 a[76:79], a[172:175], v[96:99], a[76:79]
v_exp_f32 v24, v24
v_mfma_f32_16x16x32_bf16 a[108:111], a[172:175], v[100:103], a[108:111]
v_exp_f32 v25, v25
v_mfma_f32_16x16x32_bf16 v[44:47], a[144:147], v[152:155], v[136:139]
ds_read_b128 a[136:139], v218 offset:49152
ds_read_b128 a[140:143], v219 offset:49152
v_mfma_f32_16x16x32_bf16 v[44:47], a[148:151], v[156:159], v[44:47]
v_exp_f32 v26, v26
v_mfma_f32_16x16x32_bf16 v[44:47], a[152:155], v[160:163], v[44:47]
s_add_u32 m0, s3, 118784
ds_read_b64_tr_b16 a[172:173], v223 offset:0
ds_read_b64_tr_b16 a[174:175], v223 offset:4096
v_mfma_f32_16x16x32_bf16 v[44:47], a[156:159], v[164:167], v[44:47]
s_add_u32 s48, s51, 92160
v_exp_f32 v27, v27
v_mfma_f32_16x16x32_bf16 a[16:19], a[176:179], v[88:91], a[16:19]
buffer_load_dwordx4 v236, s[16:19], s48 offen lds
v_mfma_f32_16x16x32_bf16 a[48:51], a[176:179], v[92:95], a[48:51]
v_exp_f32 v28, v28
v_mfma_f32_16x16x32_bf16 a[80:83], a[176:179], v[96:99], a[80:83]
v_cvt_pk_bf16_f32 v78, v20, v21
v_cvt_pk_bf16_f32 v79, v22, v23
v_mfma_f32_16x16x32_bf16 a[112:115], a[176:179], v[100:103], a[112:115]
s_add_u32 m0, s3, 122880
v_exp_f32 v29, v29
v_mfma_f32_16x16x32_bf16 v[52:55], a[144:147], v[168:171], v[140:143]
s_add_u32 s48, s51, 110592
buffer_load_dwordx4 v236, s[16:19], s48 offen lds
v_mfma_f32_16x16x32_bf16 v[52:55], a[148:151], v[172:175], v[52:55]
v_exp_f32 v30, v30
v_mfma_f32_16x16x32_bf16 v[52:55], a[152:155], v[176:179], v[52:55]
ds_read_b64_tr_b16 a[176:177], v224 offset:0
ds_read_b64_tr_b16 a[178:179], v224 offset:4096
v_mfma_f32_16x16x32_bf16 v[52:55], a[156:159], v[180:183], v[52:55]
v_exp_f32 v31, v31
v_mfma_f32_16x16x32_bf16 a[20:23], a[180:183], v[88:91], a[20:23]
v_cvt_pk_bf16_f32 v80, v24, v25
v_cvt_pk_bf16_f32 v81, v26, v27
v_mfma_f32_16x16x32_bf16 a[52:55], a[180:183], v[92:95], a[52:55]
s_add_u32 m0, s3, 126976
v_exp_f32 v32, v32
v_mfma_f32_16x16x32_bf16 a[84:87], a[180:183], v[96:99], a[84:87]
s_add_u32 s48, s51, 129024
buffer_load_dwordx4 v236, s[16:19], s48 offen lds
v_mfma_f32_16x16x32_bf16 a[116:119], a[180:183], v[100:103], a[116:119]
v_exp_f32 v33, v33
v_smfmac_f32_16x16x64_bf16 a[252:255], a[208:211], v[96:103], v235
ds_read_b64_tr_b16 a[180:181], v225 offset:0
ds_read_b64_tr_b16 a[182:183], v225 offset:4096
v_mfma_f32_16x16x32_bf16 v[60:63], a[144:147], v[184:187], v[144:147]
v_exp_f32 v34, v34
v_mfma_f32_16x16x32_bf16 v[60:63], a[148:151], v[188:191], v[60:63]
s_add_u32 m0, s3, 0
v_cvt_pk_bf16_f32 v82, v28, v29
v_cvt_pk_bf16_f32 v83, v30, v31
v_mfma_f32_16x16x32_bf16 v[60:63], a[152:155], v[192:195], v[60:63]
s_add_u32 s48, s75, 0
v_exp_f32 v35, v35
v_mfma_f32_16x16x32_bf16 v[60:63], a[156:159], v[196:199], v[60:63]
buffer_load_dwordx4 v237, s[16:19], s48 offen lds
v_mfma_f32_16x16x32_bf16 a[24:27], a[184:187], v[88:91], a[24:27]
v_exp_f32 v36, v36
v_mfma_f32_16x16x32_bf16 a[56:59], a[184:187], v[92:95], a[56:59]
v_cvt_pk_bf16_f32 v84, v32, v33
v_cvt_pk_bf16_f32 v85, v34, v35
v_mfma_f32_16x16x32_bf16 a[88:91], a[184:187], v[96:99], a[88:91]
v_exp_f32 v37, v37
v_mfma_f32_16x16x32_bf16 a[120:123], a[184:187], v[100:103], a[120:123]
s_add_u32 m0, s3, 4096
ds_read_b64_tr_b16 a[184:185], v226 offset:0
ds_read_b64_tr_b16 a[186:187], v226 offset:4096
v_mfma_f32_16x16x32_bf16 v[68:71], a[144:147], v[200:203], v[148:151]
s_add_u32 s48, s75, 36864
v_exp_f32 v38, v38
v_mfma_f32_16x16x32_bf16 v[68:71], a[148:151], v[204:207], v[68:71]
buffer_load_dwordx4 v237, s[16:19], s48 offen lds
v_mfma_f32_16x16x32_bf16 v[68:71], a[152:155], v[208:211], v[68:71]
v_exp_f32 v39, v39
v_mfma_f32_16x16x32_bf16 v[68:71], a[156:159], v[212:215], v[68:71]
ds_read_b128 a[144:147], v216 offset:53248
ds_read_b128 a[148:151], v217 offset:53248
v_mfma_f32_16x16x32_bf16 a[28:31], a[188:191], v[88:91], a[28:31]
ds_read_b128 a[152:155], v218 offset:53248
ds_read_b128 a[156:159], v219 offset:53248
v_mfma_f32_16x16x32_bf16 a[60:63], a[188:191], v[92:95], a[60:63]
v_cvt_pk_bf16_f32 v86, v36, v37
v_cvt_pk_bf16_f32 v87, v38, v39
v_mfma_f32_16x16x32_bf16 a[92:95], a[188:191], v[96:99], a[92:95]
v_add_u32 v7, 0x272000, v7
v_mfma_f32_16x16x32_bf16 a[124:127], a[188:191], v[100:103], a[124:127]
s_waitcnt lgkmcnt(6)
ds_read_b64_tr_b16 a[188:189], v227 offset:0
ds_read_b64_tr_b16 a[190:191], v227 offset:4096
v_mfma_f32_16x16x32_bf16 v[8:11], a[128:131], v[152:155], v[136:139]
v_exp_f32 v40, v40
v_mfma_f32_16x16x32_bf16 v[8:11], a[132:135], v[156:159], v[8:11]
s_add_u32 m0, s3, 8192
v_exp_f32 v41, v41
v_mfma_f32_16x16x32_bf16 v[8:11], a[136:139], v[160:163], v[8:11]
s_add_u32 s48, s75, 73728
buffer_load_dwordx4 v237, s[16:19], s48 offen lds
v_mfma_f32_16x16x32_bf16 v[8:11], a[140:143], v[164:167], v[8:11]
v_exp_f32 v42, v42
v_mfma_f32_16x16x32_bf16 a[0:3], a[160:163], v[72:75], a[0:3]
v_cvt_pk_bf16_f32 v88, v40, v41
v_mfma_f32_16x16x32_bf16 a[32:35], a[160:163], v[76:79], a[32:35]
v_exp_f32 v43, v43
v_mfma_f32_16x16x32_bf16 a[64:67], a[160:163], v[80:83], a[64:67]
s_add_u32 m0, s3, 12288
v_cvt_pk_bf16_f32 v89, v42, v43
v_mfma_f32_16x16x32_bf16 a[96:99], a[160:163], v[84:87], a[96:99]
s_add_u32 s48, s75, 110592
v_exp_f32 v44, v44
v_mfma_f32_16x16x32_bf16 v[16:19], a[128:131], v[168:171], v[140:143]
buffer_load_dwordx4 v237, s[16:19], s48 offen lds
v_mfma_f32_16x16x32_bf16 v[16:19], a[132:135], v[172:175], v[16:19]
v_exp_f32 v45, v45
v_mfma_f32_16x16x32_bf16 v[16:19], a[136:139], v[176:179], v[16:19]
ds_read_b64_tr_b16 a[160:161], v220 offset:8192
ds_read_b64_tr_b16 a[162:163], v220 offset:12288
v_mfma_f32_16x16x32_bf16 v[16:19], a[140:143], v[180:183], v[16:19]
s_add_u32 m0, s3, 16384
v_exp_f32 v46, v46
v_mfma_f32_16x16x32_bf16 a[4:7], a[164:167], v[72:75], a[4:7]
s_add_u32 s48, s75, 147456
buffer_load_dwordx4 v237, s[16:19], s48 offen lds
v_mfma_f32_16x16x32_bf16 a[36:39], a[164:167], v[76:79], a[36:39]
v_exp_f32 v47, v47
v_mfma_f32_16x16x32_bf16 a[68:71], a[164:167], v[80:83], a[68:71]
v_cvt_pk_bf16_f32 v90, v44, v45
v_cvt_pk_bf16_f32 v91, v46, v47
v_mfma_f32_16x16x32_bf16 a[100:103], a[164:167], v[84:87], a[100:103]
v_exp_f32 v48, v48
v_smfmac_f32_16x16x64_bf16 a[248:251], a[208:211], v[72:79], v235
s_add_u32 m0, s3, 20480
ds_read_b64_tr_b16 a[164:165], v221 offset:8192
ds_read_b64_tr_b16 a[166:167], v221 offset:12288
v_mfma_f32_16x16x32_bf16 v[24:27], a[128:131], v[184:187], v[144:147]
s_add_u32 s48, s75, 184320
v_exp_f32 v49, v49
v_mfma_f32_16x16x32_bf16 v[24:27], a[132:135], v[188:191], v[24:27]
buffer_load_dwordx4 v237, s[16:19], s48 offen lds
v_mfma_f32_16x16x32_bf16 v[24:27], a[136:139], v[192:195], v[24:27]
v_exp_f32 v50, v50
v_mfma_f32_16x16x32_bf16 v[24:27], a[140:143], v[196:199], v[24:27]
v_cvt_pk_bf16_f32 v92, v48, v49
v_mfma_f32_16x16x32_bf16 a[8:11], a[168:171], v[72:75], a[8:11]
s_add_u32 m0, s3, 24576
v_exp_f32 v51, v51
v_mfma_f32_16x16x32_bf16 a[40:43], a[168:171], v[76:79], a[40:43]
s_add_u32 s48, s75, 221184
buffer_load_dwordx4 v237, s[16:19], s48 offen lds
v_mfma_f32_16x16x32_bf16 a[72:75], a[168:171], v[80:83], a[72:75]
v_exp_f32 v52, v52
v_mfma_f32_16x16x32_bf16 a[104:107], a[168:171], v[84:87], a[104:107]
ds_read_b64_tr_b16 a[168:169], v222 offset:8192
ds_read_b64_tr_b16 a[170:171], v222 offset:12288
v_mfma_f32_16x16x32_bf16 v[32:35], a[128:131], v[200:203], v[148:151]
v_exp_f32 v53, v53
v_mfma_f32_16x16x32_bf16 v[32:35], a[132:135], v[204:207], v[32:35]
s_add_u32 m0, s3, 28672
ds_read_b128 a[128:131], v216 offset:57344
ds_read_b128 a[132:135], v217 offset:57344
v_mfma_f32_16x16x32_bf16 v[32:35], a[136:139], v[208:211], v[32:35]
s_add_u32 s48, s75, 258048
v_exp_f32 v54, v54
v_mfma_f32_16x16x32_bf16 v[32:35], a[140:143], v[212:215], v[32:35]
buffer_load_dwordx4 v237, s[16:19], s48 offen lds
v_mfma_f32_16x16x32_bf16 a[12:15], a[172:175], v[72:75], a[12:15]
v_exp_f32 v55, v55
v_mfma_f32_16x16x32_bf16 a[44:47], a[172:175], v[76:79], a[44:47]
ds_read_b128 a[136:139], v218 offset:57344
ds_read_b128 a[140:143], v219 offset:57344
v_mfma_f32_16x16x32_bf16 a[76:79], a[172:175], v[80:83], a[76:79]
s_waitcnt lgkmcnt(6)
v_exp_f32 v56, v56
v_mfma_f32_16x16x32_bf16 a[108:111], a[172:175], v[84:87], a[108:111]
s_add_u32 m0, s3, 131072
v_exp_f32 v57, v57
v_mfma_f32_16x16x32_bf16 v[12:15], a[144:147], v[152:155], v[136:139]
s_add_u32 s48, s51, 147456
buffer_load_dwordx4 v236, s[16:19], s48 offen lds
v_mfma_f32_16x16x32_bf16 v[12:15], a[148:151], v[156:159], v[12:15]
v_exp_f32 v58, v58
v_mfma_f32_16x16x32_bf16 v[12:15], a[152:155], v[160:163], v[12:15]
ds_read_b64_tr_b16 a[172:173], v223 offset:8192
ds_read_b64_tr_b16 a[174:175], v223 offset:12288
v_mfma_f32_16x16x32_bf16 v[12:15], a[156:159], v[164:167], v[12:15]
v_exp_f32 v59, v59
v_mfma_f32_16x16x32_bf16 a[16:19], a[176:179], v[72:75], a[16:19]
s_add_u32 m0, s3, 135168
v_cvt_pk_bf16_f32 v93, v50, v51
v_cvt_pk_bf16_f32 v94, v52, v53
v_mfma_f32_16x16x32_bf16 a[48:51], a[176:179], v[76:79], a[48:51]
s_add_u32 s48, s51, 165888
v_exp_f32 v60, v60
v_mfma_f32_16x16x32_bf16 a[80:83], a[176:179], v[80:83], a[80:83]
buffer_load_dwordx4 v236, s[16:19], s48 offen lds
v_mfma_f32_16x16x32_bf16 a[112:115], a[176:179], v[84:87], a[112:115]
v_exp_f32 v61, v61
v_mfma_f32_16x16x32_bf16 v[20:23], a[144:147], v[168:171], v[140:143]
ds_read_b64_tr_b16 a[176:177], v224 offset:8192
ds_read_b64_tr_b16 a[178:179], v224 offset:12288
v_mfma_f32_16x16x32_bf16 v[20:23], a[148:151], v[172:175], v[20:23]
s_add_u32 m0, s3, 139264
v_exp_f32 v62, v62
v_mfma_f32_16x16x32_bf16 v[20:23], a[152:155], v[176:179], v[20:23]
s_add_u32 s48, s51, 184320
buffer_load_dwordx4 v236, s[16:19], s48 offen lds
v_mfma_f32_16x16x32_bf16 v[20:23], a[156:159], v[180:183], v[20:23]
v_exp_f32 v63, v63
v_mfma_f32_16x16x32_bf16 a[20:23], a[180:183], v[72:75], a[20:23]
v_cvt_pk_bf16_f32 v95, v54, v55
v_cvt_pk_bf16_f32 v96, v56, v57
v_mfma_f32_16x16x32_bf16 a[52:55], a[180:183], v[76:79], a[52:55]
v_exp_f32 v64, v64
v_mfma_f32_16x16x32_bf16 a[84:87], a[180:183], v[80:83], a[84:87]
s_add_u32 m0, s3, 143360
v_cvt_pk_bf16_f32 v97, v58, v59
v_cvt_pk_bf16_f32 v98, v60, v61
v_mfma_f32_16x16x32_bf16 a[116:119], a[180:183], v[84:87], a[116:119]
s_add_u32 s48, s51, 202752
v_exp_f32 v65, v65
v_smfmac_f32_16x16x64_bf16 a[252:255], a[208:211], v[80:87], v235
buffer_load_dwordx4 v236, s[16:19], s48 offen lds
v_mfma_f32_16x16x32_bf16 v[28:31], a[144:147], v[184:187], v[144:147]
v_exp_f32 v66, v66
v_mfma_f32_16x16x32_bf16 v[28:31], a[148:151], v[188:191], v[28:31]
ds_read_b64_tr_b16 a[180:181], v225 offset:8192
ds_read_b64_tr_b16 a[182:183], v225 offset:12288
v_mfma_f32_16x16x32_bf16 v[28:31], a[152:155], v[192:195], v[28:31]
s_add_u32 m0, s3, 147456
v_exp_f32 v67, v67
v_mfma_f32_16x16x32_bf16 v[28:31], a[156:159], v[196:199], v[28:31]
s_add_u32 s48, s51, 221184
buffer_load_dwordx4 v236, s[16:19], s48 offen lds
v_mfma_f32_16x16x32_bf16 a[24:27], a[184:187], v[72:75], a[24:27]
v_exp_f32 v68, v68
v_mfma_f32_16x16x32_bf16 a[56:59], a[184:187], v[76:79], a[56:59]
v_cvt_pk_bf16_f32 v99, v62, v63
v_cvt_pk_bf16_f32 v100, v64, v65
v_mfma_f32_16x16x32_bf16 a[88:91], a[184:187], v[80:83], a[88:91]
v_exp_f32 v69, v69
v_mfma_f32_16x16x32_bf16 a[120:123], a[184:187], v[84:87], a[120:123]
s_add_u32 m0, s3, 151552
ds_read_b64_tr_b16 a[184:185], v226 offset:8192
ds_read_b64_tr_b16 a[186:187], v226 offset:12288
v_mfma_f32_16x16x32_bf16 v[36:39], a[144:147], v[200:203], v[148:151]
s_add_u32 s48, s51, 239616
v_exp_f32 v70, v70
v_mfma_f32_16x16x32_bf16 v[36:39], a[148:151], v[204:207], v[36:39]
buffer_load_dwordx4 v236, s[16:19], s48 offen lds
v_mfma_f32_16x16x32_bf16 v[36:39], a[152:155], v[208:211], v[36:39]
v_exp_f32 v71, v71
v_mfma_f32_16x16x32_bf16 v[36:39], a[156:159], v[212:215], v[36:39]
ds_read_b128 a[144:147], v216 offset:61440
ds_read_b128 a[148:151], v217 offset:61440
v_mfma_f32_16x16x32_bf16 a[28:31], a[188:191], v[72:75], a[28:31]
ds_read_b128 a[152:155], v218 offset:61440
ds_read_b128 a[156:159], v219 offset:61440
v_mfma_f32_16x16x32_bf16 a[60:63], a[188:191], v[76:79], a[60:63]
v_cvt_pk_bf16_f32 v101, v66, v67
v_cvt_pk_bf16_f32 v102, v68, v69
v_mfma_f32_16x16x32_bf16 a[92:95], a[188:191], v[80:83], a[92:95]
v_cvt_pk_bf16_f32 v103, v70, v71
v_mfma_f32_16x16x32_bf16 a[124:127], a[188:191], v[84:87], a[124:127]
s_waitcnt lgkmcnt(6)
ds_read_b64_tr_b16 a[188:189], v227 offset:8192
ds_read_b64_tr_b16 a[190:191], v227 offset:12288
v_mfma_f32_16x16x32_bf16 v[40:43], a[128:131], v[152:155], v[136:139]
v_exp_f32 v8, v8
v_mfma_f32_16x16x32_bf16 v[40:43], a[132:135], v[156:159], v[40:43]
v_exp_f32 v9, v9
v_mfma_f32_16x16x32_bf16 v[40:43], a[136:139], v[160:163], v[40:43]
v_cvt_pk_bf16_f32 v72, v8, v9
v_mfma_f32_16x16x32_bf16 v[40:43], a[140:143], v[164:167], v[40:43]
v_exp_f32 v10, v10
v_mfma_f32_16x16x32_bf16 a[0:3], a[160:163], v[88:91], a[0:3]
v_mfma_f32_16x16x32_bf16 a[32:35], a[160:163], v[92:95], a[32:35]
v_exp_f32 v11, v11
s_waitcnt lgkmcnt(0)
s_barrier
v_mfma_f32_16x16x32_bf16 a[64:67], a[160:163], v[96:99], a[64:67]
v_cvt_pk_bf16_f32 v73, v10, v11
v_mfma_f32_16x16x32_bf16 a[96:99], a[160:163], v[100:103], a[96:99]
s_add_u32 m0, s3, 155648
v_exp_f32 v12, v12
v_mfma_f32_16x16x32_bf16 v[48:51], a[128:131], v[168:171], v[140:143]
s_add_u32 s48, s51, 258048
buffer_load_dwordx4 v236, s[16:19], s48 offen lds
v_mfma_f32_16x16x32_bf16 v[48:51], a[132:135], v[172:175], v[48:51]
v_exp_f32 v13, v13
v_mfma_f32_16x16x32_bf16 v[48:51], a[136:139], v[176:179], v[48:51]
ds_read_b64_tr_b16 a[160:161], v220 offset:16384
ds_read_b64_tr_b16 a[162:163], v220 offset:20480
v_mfma_f32_16x16x32_bf16 v[48:51], a[140:143], v[180:183], v[48:51]
s_add_u32 m0, s3, 159744
v_exp_f32 v14, v14
v_mfma_f32_16x16x32_bf16 a[4:7], a[164:167], v[88:91], a[4:7]
s_add_u32 s48, s51, 276480
buffer_load_dwordx4 v236, s[16:19], s48 offen lds
v_mfma_f32_16x16x32_bf16 a[36:39], a[164:167], v[92:95], a[36:39]
v_exp_f32 v15, v15
v_mfma_f32_16x16x32_bf16 a[68:71], a[164:167], v[96:99], a[68:71]
v_cvt_pk_bf16_f32 v74, v12, v13
v_cvt_pk_bf16_f32 v75, v14, v15
v_mfma_f32_16x16x32_bf16 a[100:103], a[164:167], v[100:103], a[100:103]
s_add_u32 m0, s3, 32768
v_exp_f32 v16, v16
v_smfmac_f32_16x16x64_bf16 a[248:251], a[208:211], v[88:95], v235
s_add_u32 s48, s42, 0
buffer_load_dwordx4 v236, s[16:19], s48 offen lds
v_mfma_f32_16x16x32_bf16 v[56:59], a[128:131], v[184:187], v[144:147]
v_exp_f32 v17, v17
v_mfma_f32_16x16x32_bf16 v[56:59], a[132:135], v[188:191], v[56:59]
ds_read_b64_tr_b16 a[164:165], v221 offset:16384
ds_read_b64_tr_b16 a[166:167], v221 offset:20480
v_mfma_f32_16x16x32_bf16 v[56:59], a[136:139], v[192:195], v[56:59]
s_add_u32 m0, s3, 36864
v_exp_f32 v18, v18
v_mfma_f32_16x16x32_bf16 v[56:59], a[140:143], v[196:199], v[56:59]
s_add_u32 s48, s42, 18432
buffer_load_dwordx4 v236, s[16:19], s48 offen lds
v_mfma_f32_16x16x32_bf16 a[8:11], a[168:171], v[88:91], a[8:11]
v_exp_f32 v19, v19
v_mfma_f32_16x16x32_bf16 a[40:43], a[168:171], v[92:95], a[40:43]
v_cvt_pk_bf16_f32 v76, v16, v17
v_cvt_pk_bf16_f32 v77, v18, v19
v_mfma_f32_16x16x32_bf16 a[72:75], a[168:171], v[96:99], a[72:75]
s_add_u32 m0, s3, 40960
v_exp_f32 v20, v20
v_mfma_f32_16x16x32_bf16 a[104:107], a[168:171], v[100:103], a[104:107]
s_add_u32 s48, s42, 36864
buffer_load_dwordx4 v236, s[16:19], s48 offen lds
v_mfma_f32_16x16x32_bf16 v[64:67], a[128:131], v[200:203], v[148:151]
v_exp_f32 v21, v21
v_mfma_f32_16x16x32_bf16 v[64:67], a[132:135], v[204:207], v[64:67]
ds_read_b64_tr_b16 a[168:169], v222 offset:16384
ds_read_b64_tr_b16 a[170:171], v222 offset:20480
v_mfma_f32_16x16x32_bf16 v[64:67], a[136:139], v[208:211], v[64:67]
s_add_u32 m0, s3, 45056
v_exp_f32 v22, v22
v_mfma_f32_16x16x32_bf16 v[64:67], a[140:143], v[212:215], v[64:67]
s_add_u32 s48, s42, 55296
buffer_load_dwordx4 v236, s[16:19], s48 offen lds
v_mfma_f32_16x16x32_bf16 a[12:15], a[172:175], v[88:91], a[12:15]
v_exp_f32 v23, v23
v_mfma_f32_16x16x32_bf16 a[44:47], a[172:175], v[92:95], a[44:47]
v_cvt_pk_bf16_f32 v78, v20, v21
v_cvt_pk_bf16_f32 v79, v22, v23
v_mfma_f32_16x16x32_bf16 a[76:79], a[172:175], v[96:99], a[76:79]
s_add_u32 m0, s3, 49152
v_exp_f32 v24, v24
v_mfma_f32_16x16x32_bf16 a[108:111], a[172:175], v[100:103], a[108:111]
s_add_u32 s48, s42, 73728
v_exp_f32 v25, v25
v_mfma_f32_16x16x32_bf16 v[44:47], a[144:147], v[152:155], v[136:139]
buffer_load_dwordx4 v236, s[16:19], s48 offen lds
v_mfma_f32_16x16x32_bf16 v[44:47], a[148:151], v[156:159], v[44:47]
v_exp_f32 v26, v26
v_mfma_f32_16x16x32_bf16 v[44:47], a[152:155], v[160:163], v[44:47]
s_add_u32 m0, s3, 53248
ds_read_b64_tr_b16 a[172:173], v223 offset:16384
ds_read_b64_tr_b16 a[174:175], v223 offset:20480
v_mfma_f32_16x16x32_bf16 v[44:47], a[156:159], v[164:167], v[44:47]
s_add_u32 s48, s42, 92160
v_exp_f32 v27, v27
v_mfma_f32_16x16x32_bf16 a[16:19], a[176:179], v[88:91], a[16:19]
buffer_load_dwordx4 v236, s[16:19], s48 offen lds
v_mfma_f32_16x16x32_bf16 a[48:51], a[176:179], v[92:95], a[48:51]
v_exp_f32 v28, v28
v_mfma_f32_16x16x32_bf16 a[80:83], a[176:179], v[96:99], a[80:83]
s_add_u32 m0, s3, 57344
v_cvt_pk_bf16_f32 v80, v24, v25
v_cvt_pk_bf16_f32 v81, v26, v27
v_mfma_f32_16x16x32_bf16 a[112:115], a[176:179], v[100:103], a[112:115]
s_add_u32 s48, s42, 110592
v_exp_f32 v29, v29
v_mfma_f32_16x16x32_bf16 v[52:55], a[144:147], v[168:171], v[140:143]
buffer_load_dwordx4 v236, s[16:19], s48 offen lds
v_mfma_f32_16x16x32_bf16 v[52:55], a[148:151], v[172:175], v[52:55]
v_exp_f32 v30, v30
v_mfma_f32_16x16x32_bf16 v[52:55], a[152:155], v[176:179], v[52:55]
s_add_u32 m0, s3, 61440
ds_read_b64_tr_b16 a[176:177], v224 offset:16384
ds_read_b64_tr_b16 a[178:179], v224 offset:20480
v_mfma_f32_16x16x32_bf16 v[52:55], a[156:159], v[180:183], v[52:55]
s_add_u32 s48, s42, 129024
v_exp_f32 v31, v31
v_mfma_f32_16x16x32_bf16 a[20:23], a[180:183], v[88:91], a[20:23]
buffer_load_dwordx4 v236, s[16:19], s48 offen lds
v_mfma_f32_16x16x32_bf16 a[52:55], a[180:183], v[92:95], a[52:55]
v_exp_f32 v32, v32
v_mfma_f32_16x16x32_bf16 a[84:87], a[180:183], v[96:99], a[84:87]
s_add_u32 m0, s3, 65536
v_cvt_pk_bf16_f32 v82, v28, v29
v_cvt_pk_bf16_f32 v83, v30, v31
v_mfma_f32_16x16x32_bf16 a[116:119], a[180:183], v[100:103], a[116:119]
s_add_u32 s48, s43, 0
v_exp_f32 v33, v33
v_smfmac_f32_16x16x64_bf16 a[252:255], a[208:211], v[96:103], v235
buffer_load_dwordx4 v236, s[16:19], s48 offen lds
v_mfma_f32_16x16x32_bf16 v[60:63], a[144:147], v[184:187], v[144:147]
v_exp_f32 v34, v34
v_mfma_f32_16x16x32_bf16 v[60:63], a[148:151], v[188:191], v[60:63]
s_add_u32 m0, s3, 69632
ds_read_b64_tr_b16 a[180:181], v225 offset:16384
ds_read_b64_tr_b16 a[182:183], v225 offset:20480
v_mfma_f32_16x16x32_bf16 v[60:63], a[152:155], v[192:195], v[60:63]
s_add_u32 s48, s43, 18432
v_exp_f32 v35, v35
v_mfma_f32_16x16x32_bf16 v[60:63], a[156:159], v[196:199], v[60:63]
buffer_load_dwordx4 v236, s[16:19], s48 offen lds
v_mfma_f32_16x16x32_bf16 a[24:27], a[184:187], v[88:91], a[24:27]
v_exp_f32 v36, v36
v_mfma_f32_16x16x32_bf16 a[56:59], a[184:187], v[92:95], a[56:59]
s_add_u32 m0, s3, 73728
v_cvt_pk_bf16_f32 v84, v32, v33
v_cvt_pk_bf16_f32 v85, v34, v35
v_mfma_f32_16x16x32_bf16 a[88:91], a[184:187], v[96:99], a[88:91]
s_add_u32 s48, s43, 36864
v_exp_f32 v37, v37
v_mfma_f32_16x16x32_bf16 a[120:123], a[184:187], v[100:103], a[120:123]
buffer_load_dwordx4 v236, s[16:19], s48 offen lds
v_mfma_f32_16x16x32_bf16 v[68:71], a[144:147], v[200:203], v[148:151]
v_exp_f32 v38, v38
v_mfma_f32_16x16x32_bf16 v[68:71], a[148:151], v[204:207], v[68:71]
buffer_load_dword v247, v7, s[20:23], s47 offen sc0 sc1
v_mfma_f32_16x16x32_bf16 v[68:71], a[152:155], v[208:211], v[68:71]
v_exp_f32 v39, v39
v_mfma_f32_16x16x32_bf16 v[68:71], a[156:159], v[212:215], v[68:71]
ds_read_b64_tr_b16 a[184:185], v226 offset:16384
ds_read_b64_tr_b16 a[186:187], v226 offset:20480
v_mfma_f32_16x16x32_bf16 a[28:31], a[188:191], v[88:91], a[28:31]
v_cvt_pk_bf16_f32 v86, v36, v37
v_cvt_pk_bf16_f32 v87, v38, v39
v_mfma_f32_16x16x32_bf16 a[60:63], a[188:191], v[92:95], a[60:63]
v_mfma_f32_16x16x32_bf16 a[92:95], a[188:191], v[96:99], a[92:95]
v_mfma_f32_16x16x32_bf16 a[124:127], a[188:191], v[100:103], a[124:127]
ds_read_b64_tr_b16 a[188:189], v227 offset:16384
ds_read_b64_tr_b16 a[190:191], v227 offset:20480
s_waitcnt lgkmcnt(4)
v_mfma_f32_16x16x32_bf16 a[0:3], a[160:163], v[72:75], a[0:3]
v_exp_f32 v40, v40
v_exp_f32 v41, v41
v_mfma_f32_16x16x32_bf16 a[32:35], a[160:163], v[76:79], a[32:35]
v_cvt_pk_bf16_f32 v88, v40, v41
v_exp_f32 v42, v42
v_mfma_f32_16x16x32_bf16 a[64:67], a[160:163], v[80:83], a[64:67]
v_exp_f32 v43, v43
v_mfma_f32_16x16x32_bf16 a[96:99], a[160:163], v[84:87], a[96:99]
ds_read_b64_tr_b16 a[160:161], v220 offset:24576
ds_read_b64_tr_b16 a[162:163], v220 offset:28672
v_exp_f32 v44, v44
v_mfma_f32_16x16x32_bf16 a[4:7], a[164:167], v[72:75], a[4:7]
v_cvt_pk_bf16_f32 v89, v42, v43
v_exp_f32 v45, v45
v_mfma_f32_16x16x32_bf16 a[36:39], a[164:167], v[76:79], a[36:39]
v_cvt_pk_bf16_f32 v90, v44, v45
v_exp_f32 v46, v46
v_mfma_f32_16x16x32_bf16 a[68:71], a[164:167], v[80:83], a[68:71]
v_exp_f32 v47, v47
v_mfma_f32_16x16x32_bf16 a[100:103], a[164:167], v[84:87], a[100:103]
ds_read_b64_tr_b16 a[164:165], v221 offset:24576
ds_read_b64_tr_b16 a[166:167], v221 offset:28672
v_exp_f32 v48, v48
v_smfmac_f32_16x16x64_bf16 a[248:251], a[208:211], v[72:79], v235
v_cvt_pk_bf16_f32 v91, v46, v47
v_exp_f32 v49, v49
v_mfma_f32_16x16x32_bf16 a[8:11], a[168:171], v[72:75], a[8:11]
v_cvt_pk_bf16_f32 v92, v48, v49
v_exp_f32 v50, v50
v_mfma_f32_16x16x32_bf16 a[40:43], a[168:171], v[76:79], a[40:43]
v_exp_f32 v51, v51
v_mfma_f32_16x16x32_bf16 a[72:75], a[168:171], v[80:83], a[72:75]
v_cvt_pk_bf16_f32 v93, v50, v51
v_exp_f32 v52, v52
v_mfma_f32_16x16x32_bf16 a[104:107], a[168:171], v[84:87], a[104:107]
ds_read_b64_tr_b16 a[168:169], v222 offset:24576
ds_read_b64_tr_b16 a[170:171], v222 offset:28672
v_exp_f32 v53, v53
v_mfma_f32_16x16x32_bf16 a[12:15], a[172:175], v[72:75], a[12:15]
v_cvt_pk_bf16_f32 v94, v52, v53
v_exp_f32 v54, v54
v_mfma_f32_16x16x32_bf16 a[44:47], a[172:175], v[76:79], a[44:47]
v_exp_f32 v55, v55
v_mfma_f32_16x16x32_bf16 a[76:79], a[172:175], v[80:83], a[76:79]
v_exp_f32 v56, v56
v_exp_f32 v57, v57
v_mfma_f32_16x16x32_bf16 a[108:111], a[172:175], v[84:87], a[108:111]
ds_read_b64_tr_b16 a[172:173], v223 offset:24576
ds_read_b64_tr_b16 a[174:175], v223 offset:28672
v_exp_f32 v58, v58
v_mfma_f32_16x16x32_bf16 a[16:19], a[176:179], v[72:75], a[16:19]
v_cvt_pk_bf16_f32 v95, v54, v55
v_cvt_pk_bf16_f32 v96, v56, v57
v_exp_f32 v59, v59
v_mfma_f32_16x16x32_bf16 a[48:51], a[176:179], v[76:79], a[48:51]
v_cvt_pk_bf16_f32 v97, v58, v59
v_exp_f32 v60, v60
v_mfma_f32_16x16x32_bf16 a[80:83], a[176:179], v[80:83], a[80:83]
v_exp_f32 v61, v61
v_mfma_f32_16x16x32_bf16 a[112:115], a[176:179], v[84:87], a[112:115]
ds_read_b64_tr_b16 a[176:177], v224 offset:24576
ds_read_b64_tr_b16 a[178:179], v224 offset:28672
v_exp_f32 v62, v62
v_mfma_f32_16x16x32_bf16 a[20:23], a[180:183], v[72:75], a[20:23]
v_cvt_pk_bf16_f32 v98, v60, v61
v_exp_f32 v63, v63
v_mfma_f32_16x16x32_bf16 a[52:55], a[180:183], v[76:79], a[52:55]
v_cvt_pk_bf16_f32 v99, v62, v63
v_exp_f32 v64, v64
v_mfma_f32_16x16x32_bf16 a[84:87], a[180:183], v[80:83], a[84:87]
v_exp_f32 v65, v65
v_mfma_f32_16x16x32_bf16 a[116:119], a[180:183], v[84:87], a[116:119]
ds_read_b64_tr_b16 a[180:181], v225 offset:24576
ds_read_b64_tr_b16 a[182:183], v225 offset:28672
v_exp_f32 v66, v66
v_smfmac_f32_16x16x64_bf16 a[252:255], a[208:211], v[80:87], v235
s_waitcnt lgkmcnt(6)
v_cvt_pk_bf16_f32 v100, v64, v65
v_exp_f32 v67, v67
v_mfma_f32_16x16x32_bf16 a[24:27], a[184:187], v[72:75], a[24:27]
v_cvt_pk_bf16_f32 v101, v66, v67
v_exp_f32 v68, v68
v_mfma_f32_16x16x32_bf16 a[56:59], a[184:187], v[76:79], a[56:59]
v_exp_f32 v69, v69
v_mfma_f32_16x16x32_bf16 a[88:91], a[184:187], v[80:83], a[88:91]
v_cvt_pk_bf16_f32 v102, v68, v69
v_exp_f32 v70, v70
v_mfma_f32_16x16x32_bf16 a[120:123], a[184:187], v[84:87], a[120:123]
ds_read_b64_tr_b16 a[184:185], v226 offset:24576
ds_read_b64_tr_b16 a[186:187], v226 offset:28672
v_exp_f32 v71, v71
v_mfma_f32_16x16x32_bf16 a[28:31], a[188:191], v[72:75], a[28:31]
v_cvt_pk_bf16_f32 v103, v70, v71
v_mfma_f32_16x16x32_bf16 a[60:63], a[188:191], v[76:79], a[60:63]
v_mfma_f32_16x16x32_bf16 a[92:95], a[188:191], v[80:83], a[92:95]
v_mfma_f32_16x16x32_bf16 a[124:127], a[188:191], v[84:87], a[124:127]
ds_read_b64_tr_b16 a[188:189], v227 offset:24576
ds_read_b64_tr_b16 a[190:191], v227 offset:28672
v_smfmac_f32_16x16x64_bf16 a[248:251], a[208:211], v[88:95], v235
s_lshl_b32 s46, s32, 2
v_and_b32 v138, 3, v1
v_smfmac_f32_16x16x64_bf16 a[252:255], a[208:211], v[96:103], v235
s_add_u32 s46, s46, 77824
v_lshlrev_b32 v138, 10, v138
v_mfma_f32_16x16x32_bf16 a[0:3], a[160:163], v[88:91], a[0:3]
s_add_u32 s47, s3, 77824
v_add_u32 v138, s46, v138
v_mfma_f32_16x16x32_bf16 a[4:7], a[164:167], v[88:91], a[4:7]
v_mov_b32 v139, s47
v_mfma_f32_16x16x32_bf16 a[8:11], a[168:171], v[88:91], a[8:11]
s_nop 0
s_nop 0
s_waitcnt lgkmcnt(4)
v_mfma_f32_16x16x32_bf16 a[12:15], a[172:175], v[88:91], a[12:15]
v_accvgpr_read_b32 v104, a248
v_accvgpr_read_b32 v105, a249
v_mfma_f32_16x16x32_bf16 a[16:19], a[176:179], v[88:91], a[16:19]
v_accvgpr_read_b32 v106, a250
v_accvgpr_read_b32 v107, a251
v_mfma_f32_16x16x32_bf16 a[20:23], a[180:183], v[88:91], a[20:23]
v_accvgpr_read_b32 v108, a252
v_accvgpr_read_b32 v109, a253
s_waitcnt lgkmcnt(2)
v_mfma_f32_16x16x32_bf16 a[24:27], a[184:187], v[88:91], a[24:27]
v_accvgpr_read_b32 v110, a254
v_accvgpr_read_b32 v111, a255
s_waitcnt lgkmcnt(0)
v_mfma_f32_16x16x32_bf16 a[28:31], a[188:191], v[88:91], a[28:31]
v_add_f32 v104, v104, v105
v_add_f32 v106, v106, v107
v_mfma_f32_16x16x32_bf16 a[32:35], a[160:163], v[92:95], a[32:35]
v_add_f32 v108, v108, v109
v_add_f32 v110, v110, v111
v_mfma_f32_16x16x32_bf16 a[36:39], a[164:167], v[92:95], a[36:39]
v_max3_f32 v136, v104, v106, v108
v_add_f32 v137, v104, v106
v_mfma_f32_16x16x32_bf16 a[40:43], a[168:171], v[92:95], a[40:43]
v_max_f32 v136, v136, v110
v_add_f32 v137, v137, v108
v_mfma_f32_16x16x32_bf16 a[44:47], a[172:175], v[92:95], a[44:47]
v_cmp_nge_f32 vcc, 0x5f800000, v136
v_add_f32 v137, v137, v110
v_mfma_f32_16x16x32_bf16 a[48:51], a[176:179], v[92:95], a[48:51]
v_cmp_u_f32 s[94:95], v137, v137
v_mfma_f32_16x16x32_bf16 a[52:55], a[180:183], v[92:95], a[52:55]
v_mfma_f32_16x16x32_bf16 a[56:59], a[184:187], v[92:95], a[56:59]
v_mfma_f32_16x16x32_bf16 a[60:63], a[188:191], v[92:95], a[60:63]
s_or_b64 vcc, vcc, s[94:95]
s_cmp_lg_u64 vcc, 0
s_cselect_b32 s48, 1, 0
v_mov_b32 v136, s48
ds_write_b32 v138, v136
v_rcp_f32 v104, v104
v_rcp_f32 v106, v106
v_rcp_f32 v108, v108
v_rcp_f32 v110, v110
s_waitcnt vmcnt(0) lgkmcnt(0)
s_barrier
ds_read_b128 v[140:143], v139
v_mfma_f32_16x16x32_bf16 a[64:67], a[160:163], v[96:99], a[64:67]
v_accvgpr_read_b32 v40, a0
v_accvgpr_read_b32 v41, a1
v_mfma_f32_16x16x32_bf16 a[68:71], a[164:167], v[96:99], a[68:71]
v_accvgpr_read_b32 v42, a2
v_accvgpr_read_b32 v43, a3
v_mfma_f32_16x16x32_bf16 a[72:75], a[168:171], v[96:99], a[72:75]
v_accvgpr_read_b32 v44, a4
v_accvgpr_read_b32 v45, a5
v_mfma_f32_16x16x32_bf16 a[76:79], a[172:175], v[96:99], a[76:79]
v_accvgpr_read_b32 v46, a6
v_accvgpr_read_b32 v47, a7
v_mfma_f32_16x16x32_bf16 a[80:83], a[176:179], v[96:99], a[80:83]
v_accvgpr_read_b32 v48, a8
v_accvgpr_read_b32 v49, a9
v_mfma_f32_16x16x32_bf16 a[84:87], a[180:183], v[96:99], a[84:87]
v_accvgpr_read_b32 v50, a10
v_accvgpr_read_b32 v51, a11
v_mfma_f32_16x16x32_bf16 a[88:91], a[184:187], v[96:99], a[88:91]
v_accvgpr_read_b32 v52, a12
v_accvgpr_read_b32 v53, a13
v_mfma_f32_16x16x32_bf16 a[92:95], a[188:191], v[96:99], a[92:95]
v_accvgpr_read_b32 v54, a14
v_accvgpr_read_b32 v55, a15
v_mfma_f32_16x16x32_bf16 a[96:99], a[160:163], v[100:103], a[96:99]
v_accvgpr_read_b32 v56, a16
v_accvgpr_read_b32 v57, a17
v_mfma_f32_16x16x32_bf16 a[100:103], a[164:167], v[100:103], a[100:103]
v_accvgpr_read_b32 v58, a18
v_accvgpr_read_b32 v59, a19
v_mfma_f32_16x16x32_bf16 a[104:107], a[168:171], v[100:103], a[104:107]
v_accvgpr_read_b32 v60, a20
v_accvgpr_read_b32 v61, a21
v_mfma_f32_16x16x32_bf16 a[108:111], a[172:175], v[100:103], a[108:111]
v_accvgpr_read_b32 v62, a22
v_accvgpr_read_b32 v63, a23
v_mfma_f32_16x16x32_bf16 a[112:115], a[176:179], v[100:103], a[112:115]
v_accvgpr_read_b32 v64, a24
v_accvgpr_read_b32 v65, a25
v_mfma_f32_16x16x32_bf16 a[116:119], a[180:183], v[100:103], a[116:119]
v_accvgpr_read_b32 v66, a26
v_accvgpr_read_b32 v67, a27
v_mfma_f32_16x16x32_bf16 a[120:123], a[184:187], v[100:103], a[120:123]
v_accvgpr_read_b32 v68, a28
v_accvgpr_read_b32 v69, a29
v_mfma_f32_16x16x32_bf16 a[124:127], a[188:191], v[100:103], a[124:127]
v_accvgpr_read_b32 v70, a30
v_accvgpr_read_b32 v71, a31
v_pk_mul_f32 v[40:41], v[40:41], v[104:105] op_sel_hi:[1,0]
v_pk_mul_f32 v[42:43], v[42:43], v[104:105] op_sel_hi:[1,0]
v_pk_mul_f32 v[44:45], v[44:45], v[104:105] op_sel_hi:[1,0]
v_pk_mul_f32 v[46:47], v[46:47], v[104:105] op_sel_hi:[1,0]
v_cvt_pk_bf16_f32 v8, v40, v41
v_cvt_pk_bf16_f32 v9, v42, v43
v_cvt_pk_bf16_f32 v10, v44, v45
v_cvt_pk_bf16_f32 v11, v46, v47
s_add_u32 s94, s53, 0
buffer_store_dwordx4 v[8:11], v234, s[20:23], s94 offen offset:0 sc0 sc1
v_pk_mul_f32 v[48:49], v[48:49], v[104:105] op_sel_hi:[1,0]
v_pk_mul_f32 v[50:51], v[50:51], v[104:105] op_sel_hi:[1,0]
v_pk_mul_f32 v[52:53], v[52:53], v[104:105] op_sel_hi:[1,0]
v_pk_mul_f32 v[54:55], v[54:55], v[104:105] op_sel_hi:[1,0]
v_cvt_pk_bf16_f32 v16, v48, v49
v_cvt_pk_bf16_f32 v17, v50, v51
v_cvt_pk_bf16_f32 v18, v52, v53
v_cvt_pk_bf16_f32 v19, v54, v55
s_add_u32 s94, s53, 0
buffer_store_dwordx4 v[16:19], v234, s[20:23], s94 offen offset:2048 sc0 sc1
v_pk_mul_f32 v[56:57], v[56:57], v[104:105] op_sel_hi:[1,0]
v_pk_mul_f32 v[58:59], v[58:59], v[104:105] op_sel_hi:[1,0]
v_pk_mul_f32 v[60:61], v[60:61], v[104:105] op_sel_hi:[1,0]
v_pk_mul_f32 v[62:63], v[62:63], v[104:105] op_sel_hi:[1,0]
v_cvt_pk_bf16_f32 v24, v56, v57
v_cvt_pk_bf16_f32 v25, v58, v59
v_cvt_pk_bf16_f32 v26, v60, v61
v_cvt_pk_bf16_f32 v27, v62, v63
s_add_u32 s94, s53, 4096
buffer_store_dwordx4 v[24:27], v234, s[20:23], s94 offen offset:0 sc0 sc1
v_pk_mul_f32 v[64:65], v[64:65], v[104:105] op_sel_hi:[1,0]
v_pk_mul_f32 v[66:67], v[66:67], v[104:105] op_sel_hi:[1,0]
v_pk_mul_f32 v[68:69], v[68:69], v[104:105] op_sel_hi:[1,0]
v_pk_mul_f32 v[70:71], v[70:71], v[104:105] op_sel_hi:[1,0]
v_cvt_pk_bf16_f32 v32, v64, v65
v_cvt_pk_bf16_f32 v33, v66, v67
v_cvt_pk_bf16_f32 v34, v68, v69
v_cvt_pk_bf16_f32 v35, v70, v71
s_add_u32 s94, s53, 4096
buffer_store_dwordx4 v[32:35], v234, s[20:23], s94 offen offset:2048 sc0 sc1
v_accvgpr_read_b32 v72, a32
v_accvgpr_read_b32 v73, a33
v_accvgpr_read_b32 v74, a34
v_accvgpr_read_b32 v75, a35
v_accvgpr_read_b32 v76, a36
v_accvgpr_read_b32 v77, a37
v_accvgpr_read_b32 v78, a38
v_accvgpr_read_b32 v79, a39
v_accvgpr_read_b32 v80, a40
v_accvgpr_read_b32 v81, a41
v_accvgpr_read_b32 v82, a42
v_accvgpr_read_b32 v83, a43
v_accvgpr_read_b32 v84, a44
v_accvgpr_read_b32 v85, a45
v_accvgpr_read_b32 v86, a46
v_accvgpr_read_b32 v87, a47
v_accvgpr_read_b32 v88, a48
v_accvgpr_read_b32 v89, a49
v_accvgpr_read_b32 v90, a50
v_accvgpr_read_b32 v91, a51
v_accvgpr_read_b32 v92, a52
v_accvgpr_read_b32 v93, a53
v_accvgpr_read_b32 v94, a54
v_accvgpr_read_b32 v95, a55
v_accvgpr_read_b32 v96, a56
v_accvgpr_read_b32 v97, a57
v_accvgpr_read_b32 v98, a58
v_accvgpr_read_b32 v99, a59
v_accvgpr_read_b32 v100, a60
v_accvgpr_read_b32 v101, a61
v_accvgpr_read_b32 v102, a62
v_accvgpr_read_b32 v103, a63
v_pk_mul_f32 v[72:73], v[72:73], v[106:107] op_sel_hi:[1,0]
v_pk_mul_f32 v[74:75], v[74:75], v[106:107] op_sel_hi:[1,0]
v_pk_mul_f32 v[76:77], v[76:77], v[106:107] op_sel_hi:[1,0]
v_pk_mul_f32 v[78:79], v[78:79], v[106:107] op_sel_hi:[1,0]
v_cvt_pk_bf16_f32 v12, v72, v73
v_cvt_pk_bf16_f32 v13, v74, v75
v_cvt_pk_bf16_f32 v14, v76, v77
v_cvt_pk_bf16_f32 v15, v78, v79
s_add_u32 s94, s53, 0
buffer_store_dwordx4 v[12:15], v234, s[20:23], s94 offen offset:1024 sc0 sc1
v_pk_mul_f32 v[80:81], v[80:81], v[106:107] op_sel_hi:[1,0]
v_pk_mul_f32 v[82:83], v[82:83], v[106:107] op_sel_hi:[1,0]
v_pk_mul_f32 v[84:85], v[84:85], v[106:107] op_sel_hi:[1,0]
v_pk_mul_f32 v[86:87], v[86:87], v[106:107] op_sel_hi:[1,0]
v_cvt_pk_bf16_f32 v20, v80, v81
v_cvt_pk_bf16_f32 v21, v82, v83
v_cvt_pk_bf16_f32 v22, v84, v85
v_cvt_pk_bf16_f32 v23, v86, v87
s_add_u32 s94, s53, 0
buffer_store_dwordx4 v[20:23], v234, s[20:23], s94 offen offset:3072 sc0 sc1
v_pk_mul_f32 v[88:89], v[88:89], v[106:107] op_sel_hi:[1,0]
v_pk_mul_f32 v[90:91], v[90:91], v[106:107] op_sel_hi:[1,0]
v_pk_mul_f32 v[92:93], v[92:93], v[106:107] op_sel_hi:[1,0]
v_pk_mul_f32 v[94:95], v[94:95], v[106:107] op_sel_hi:[1,0]
v_cvt_pk_bf16_f32 v28, v88, v89
v_cvt_pk_bf16_f32 v29, v90, v91
v_cvt_pk_bf16_f32 v30, v92, v93
v_cvt_pk_bf16_f32 v31, v94, v95
s_add_u32 s94, s53, 4096
buffer_store_dwordx4 v[28:31], v234, s[20:23], s94 offen offset:1024 sc0 sc1
v_pk_mul_f32 v[96:97], v[96:97], v[106:107] op_sel_hi:[1,0]
v_pk_mul_f32 v[98:99], v[98:99], v[106:107] op_sel_hi:[1,0]
v_pk_mul_f32 v[100:101], v[100:101], v[106:107] op_sel_hi:[1,0]
v_pk_mul_f32 v[102:103], v[102:103], v[106:107] op_sel_hi:[1,0]
v_cvt_pk_bf16_f32 v36, v96, v97
v_cvt_pk_bf16_f32 v37, v98, v99
v_cvt_pk_bf16_f32 v38, v100, v101
v_cvt_pk_bf16_f32 v39, v102, v103
s_add_u32 s94, s53, 4096
buffer_store_dwordx4 v[36:39], v234, s[20:23], s94 offen offset:3072 sc0 sc1
s_waitcnt lgkmcnt(0)
v_or3_b32 v140, v140, v141, v142
v_or_b32 v140, v140, v143
s_nop 0
v_readfirstlane_b32 s46, v140
s_andn2_b32 s46, s46, s41
s_cbranch_scc1 K_FB
s_cmp_lg_u32 s83, 0
s_cbranch_scc1 K_YR0
K_YR0D:
v_accvgpr_read_b32 v120, a236
v_accvgpr_read_b32 v121, a237
v_accvgpr_read_b32 v122, a238
v_accvgpr_read_b32 v123, a239
v_accvgpr_read_b32 v124, a240
v_accvgpr_read_b32 v125, a241
v_accvgpr_read_b32 v126, a242
v_accvgpr_read_b32 v127, a243
v_accvgpr_read_b32 v128, a244
v_accvgpr_read_b32 v129, a245
v_accvgpr_read_b32 v130, a246
v_accvgpr_read_b32 v131, a247
v_xor_b32 v220, s82, v220
v_xor_b32 v221, s82, v221
v_xor_b32 v222, s82, v222
v_xor_b32 v223, s82, v223
v_xor_b32 v224, s82, v224
v_xor_b32 v225, s82, v225
v_xor_b32 v226, s82, v226
v_xor_b32 v227, s82, v227
v_bfe_u32 v5, v1, 2, 2
v_lshl_add_u32 v5, v4, 2, v5
v_bfe_u32 v6, v5, 1, 2
v_lshlrev_b32 v6, 5, v6
v_lshl_add_u32 v6, v5, 7, v6
v_and_b32 v5, 3, v1
v_lshl_add_u32 v216, v5, 3, v6
v_xor_b32 v217, 32, v216
v_xor_b32 v218, 64, v216
v_xor_b32 v219, 96, v216
ds_read_b64_tr_b16 a[192:193], v220 offset:32768
ds_read_b64_tr_b16 a[194:195], v220 offset:36864
ds_read_b64_tr_b16 a[196:197], v221 offset:32768
ds_read_b64_tr_b16 a[198:199], v221 offset:36864
ds_read_b64_tr_b16 a[200:201], v222 offset:32768
ds_read_b64_tr_b16 a[202:203], v222 offset:36864
ds_read_b64_tr_b16 a[204:205], v223 offset:32768
ds_read_b64_tr_b16 a[206:207], v223 offset:36864
ds_read_b64_tr_b16 a[208:209], v224 offset:32768
ds_read_b64_tr_b16 a[210:211], v224 offset:36864
ds_read_b64_tr_b16 a[212:213], v225 offset:32768
ds_read_b64_tr_b16 a[214:215], v225 offset:36864
ds_read_b64_tr_b16 a[216:217], v226 offset:32768
ds_read_b64_tr_b16 a[218:219], v226 offset:36864
ds_read_b64_tr_b16 a[220:221], v227 offset:32768
ds_read_b64_tr_b16 a[222:223], v227 offset:36864
ds_read_b64_tr_b16 a[224:225], v216 offset:0
ds_read_b64_tr_b16 a[226:227], v216 offset:2048
ds_read_b64_tr_b16 a[228:229], v217 offset:0
ds_read_b64_tr_b16 a[230:231], v217 offset:2048
ds_read_b64_tr_b16 a[232:233], v218 offset:0
ds_read_b64_tr_b16 a[234:235], v218 offset:2048
ds_read_b64_tr_b16 a[236:237], v219 offset:0
ds_read_b64_tr_b16 a[238:239], v219 offset:2048
v_accvgpr_read_b32 v112, a64
v_accvgpr_read_b32 v113, a65
v_accvgpr_read_b32 v114, a66
v_accvgpr_read_b32 v115, a67
v_accvgpr_read_b32 v116, a68
v_accvgpr_read_b32 v117, a69
v_accvgpr_read_b32 v118, a70
v_accvgpr_read_b32 v119, a71
v_pk_mul_f32 v[112:113], v[112:113], v[108:109] op_sel_hi:[1,0]
v_pk_mul_f32 v[114:115], v[114:115], v[108:109] op_sel_hi:[1,0]
v_pk_mul_f32 v[116:117], v[116:117], v[108:109] op_sel_hi:[1,0]
v_pk_mul_f32 v[118:119], v[118:119], v[108:109] op_sel_hi:[1,0]
v_cvt_pk_bf16_f32 v40, v112, v113
v_cvt_pk_bf16_f32 v41, v114, v115
v_cvt_pk_bf16_f32 v42, v116, v117
v_cvt_pk_bf16_f32 v43, v118, v119
v_accvgpr_read_b32 v112, a96
v_accvgpr_read_b32 v113, a97
v_accvgpr_read_b32 v114, a98
v_accvgpr_read_b32 v115, a99
v_accvgpr_read_b32 v116, a100
v_accvgpr_read_b32 v117, a101
v_accvgpr_read_b32 v118, a102
v_accvgpr_read_b32 v119, a103
v_pk_mul_f32 v[112:113], v[112:113], v[110:111] op_sel_hi:[1,0]
v_pk_mul_f32 v[114:115], v[114:115], v[110:111] op_sel_hi:[1,0]
v_pk_mul_f32 v[116:117], v[116:117], v[110:111] op_sel_hi:[1,0]
v_pk_mul_f32 v[118:119], v[118:119], v[110:111] op_sel_hi:[1,0]
v_cvt_pk_bf16_f32 v44, v112, v113
v_cvt_pk_bf16_f32 v45, v114, v115
v_cvt_pk_bf16_f32 v46, v116, v117
v_cvt_pk_bf16_f32 v47, v118, v119
v_accvgpr_read_b32 v112, a72
v_accvgpr_read_b32 v113, a73
v_accvgpr_read_b32 v114, a74
v_accvgpr_read_b32 v115, a75
v_accvgpr_read_b32 v116, a76
v_accvgpr_read_b32 v117, a77
v_accvgpr_read_b32 v118, a78
v_accvgpr_read_b32 v119, a79
v_pk_mul_f32 v[112:113], v[112:113], v[108:109] op_sel_hi:[1,0]
v_pk_mul_f32 v[114:115], v[114:115], v[108:109] op_sel_hi:[1,0]
v_pk_mul_f32 v[116:117], v[116:117], v[108:109] op_sel_hi:[1,0]
v_pk_mul_f32 v[118:119], v[118:119], v[108:109] op_sel_hi:[1,0]
v_cvt_pk_bf16_f32 v48, v112, v113
v_cvt_pk_bf16_f32 v49, v114, v115
v_cvt_pk_bf16_f32 v50, v116, v117
v_cvt_pk_bf16_f32 v51, v118, v119
v_accvgpr_read_b32 v112, a104
v_accvgpr_read_b32 v113, a105
v_accvgpr_read_b32 v114, a106
v_accvgpr_read_b32 v115, a107
v_accvgpr_read_b32 v116, a108
v_accvgpr_read_b32 v117, a109
v_accvgpr_read_b32 v118, a110
v_accvgpr_read_b32 v119, a111
v_pk_mul_f32 v[112:113], v[112:113], v[110:111] op_sel_hi:[1,0]
v_pk_mul_f32 v[114:115], v[114:115], v[110:111] op_sel_hi:[1,0]
v_pk_mul_f32 v[116:117], v[116:117], v[110:111] op_sel_hi:[1,0]
v_pk_mul_f32 v[118:119], v[118:119], v[110:111] op_sel_hi:[1,0]
v_cvt_pk_bf16_f32 v52, v112, v113
v_cvt_pk_bf16_f32 v53, v114, v115
v_cvt_pk_bf16_f32 v54, v116, v117
v_cvt_pk_bf16_f32 v55, v118, v119
v_accvgpr_read_b32 v112, a80
v_accvgpr_read_b32 v113, a81
v_accvgpr_read_b32 v114, a82
v_accvgpr_read_b32 v115, a83
v_accvgpr_read_b32 v116, a84
v_accvgpr_read_b32 v117, a85
v_accvgpr_read_b32 v118, a86
v_accvgpr_read_b32 v119, a87
v_pk_mul_f32 v[112:113], v[112:113], v[108:109] op_sel_hi:[1,0]
v_pk_mul_f32 v[114:115], v[114:115], v[108:109] op_sel_hi:[1,0]
v_pk_mul_f32 v[116:117], v[116:117], v[108:109] op_sel_hi:[1,0]
v_pk_mul_f32 v[118:119], v[118:119], v[108:109] op_sel_hi:[1,0]
v_cvt_pk_bf16_f32 v56, v112, v113
v_cvt_pk_bf16_f32 v57, v114, v115
v_cvt_pk_bf16_f32 v58, v116, v117
v_cvt_pk_bf16_f32 v59, v118, v119
v_accvgpr_read_b32 v112, a112
v_accvgpr_read_b32 v113, a113
v_accvgpr_read_b32 v114, a114
v_accvgpr_read_b32 v115, a115
v_accvgpr_read_b32 v116, a116
v_accvgpr_read_b32 v117, a117
v_accvgpr_read_b32 v118, a118
v_accvgpr_read_b32 v119, a119
v_pk_mul_f32 v[112:113], v[112:113], v[110:111] op_sel_hi:[1,0]
v_pk_mul_f32 v[114:115], v[114:115], v[110:111] op_sel_hi:[1,0]
v_pk_mul_f32 v[116:117], v[116:117], v[110:111] op_sel_hi:[1,0]
v_pk_mul_f32 v[118:119], v[118:119], v[110:111] op_sel_hi:[1,0]
v_cvt_pk_bf16_f32 v60, v112, v113
v_cvt_pk_bf16_f32 v61, v114, v115
v_cvt_pk_bf16_f32 v62, v116, v117
v_cvt_pk_bf16_f32 v63, v118, v119
v_accvgpr_read_b32 v112, a88
v_accvgpr_read_b32 v113, a89
v_accvgpr_read_b32 v114, a90
v_accvgpr_read_b32 v115, a91
v_accvgpr_read_b32 v116, a92
v_accvgpr_read_b32 v117, a93
v_accvgpr_read_b32 v118, a94
v_accvgpr_read_b32 v119, a95
v_pk_mul_f32 v[112:113], v[112:113], v[108:109] op_sel_hi:[1,0]
v_pk_mul_f32 v[114:115], v[114:115], v[108:109] op_sel_hi:[1,0]
v_pk_mul_f32 v[116:117], v[116:117], v[108:109] op_sel_hi:[1,0]
v_pk_mul_f32 v[118:119], v[118:119], v[108:109] op_sel_hi:[1,0]
v_cvt_pk_bf16_f32 v64, v112, v113
v_cvt_pk_bf16_f32 v65, v114, v115
v_cvt_pk_bf16_f32 v66, v116, v117
v_cvt_pk_bf16_f32 v67, v118, v119
v_accvgpr_read_b32 v112, a120
v_accvgpr_read_b32 v113, a121
v_accvgpr_read_b32 v114, a122
v_accvgpr_read_b32 v115, a123
v_accvgpr_read_b32 v116, a124
v_accvgpr_read_b32 v117, a125
v_accvgpr_read_b32 v118, a126
v_accvgpr_read_b32 v119, a127
v_pk_mul_f32 v[112:113], v[112:113], v[110:111] op_sel_hi:[1,0]
v_pk_mul_f32 v[114:115], v[114:115], v[110:111] op_sel_hi:[1,0]
v_pk_mul_f32 v[116:117], v[116:117], v[110:111] op_sel_hi:[1,0]
v_pk_mul_f32 v[118:119], v[118:119], v[110:111] op_sel_hi:[1,0]
v_cvt_pk_bf16_f32 v68, v112, v113
v_cvt_pk_bf16_f32 v69, v114, v115
v_cvt_pk_bf16_f32 v70, v116, v117
v_cvt_pk_bf16_f32 v71, v118, v119
s_lshl_b32 s95, s36, 3
v_mov_b32 v5, 1
v_and_b32 v6, 7, v1
s_add_u32 s95, s95, s54
v_lshlrev_b32 v6, 2, v6
v_lshlrev_b32 v250, 3, v1
s_waitcnt lgkmcnt(15)
v_mfma_f32_16x16x32_bf16 v[136:139], a[192:195], v[8:11], 0
s_add_u32 s67, s36, 1
v_add_u32 v208, 0x10000, v220
v_add_u32 v209, 0x10000, v221
v_mfma_f32_16x16x32_bf16 v[168:171], a[192:195], v[12:15], 0
s_and_b32 s67, s67, 3
ds_read_b64_tr_b16 a[192:193], v220 offset:40960
ds_read_b64_tr_b16 a[194:195], v220 offset:45056
v_mfma_f32_16x16x32_bf16 v[140:143], a[196:199], v[8:11], 0
s_sub_u32 s67, s67, s36
v_add_u32 v210, 0x10000, v222
v_add_u32 v211, 0x10000, v223
v_mfma_f32_16x16x32_bf16 v[172:175], a[196:199], v[12:15], 0
s_lshl_b32 s67, s67, 16
ds_read_b64_tr_b16 a[196:197], v221 offset:40960
ds_read_b64_tr_b16 a[198:199], v221 offset:45056
v_mfma_f32_16x16x32_bf16 v[144:147], a[200:203], v[8:11], 0
s_add_u32 s90, s53, s67
v_add_u32 v212, 0x10000, v224
v_add_u32 v213, 0x10000, v225
v_mfma_f32_16x16x32_bf16 v[176:179], a[200:203], v[12:15], 0
s_add_u32 s67, s36, 2
ds_read_b64_tr_b16 a[200:201], v222 offset:40960
ds_read_b64_tr_b16 a[202:203], v222 offset:45056
v_mfma_f32_16x16x32_bf16 v[148:151], a[204:207], v[8:11], 0
s_add_u32 m0, s3, 77824
v_add_u32 v214, 0x10000, v226
v_add_u32 v215, 0x10000, v227
v_mfma_f32_16x16x32_bf16 v[180:183], a[204:207], v[12:15], 0
s_waitcnt lgkmcnt(15)
s_add_u32 s48, s43, 55296
ds_read_b64_tr_b16 a[204:205], v223 offset:40960
ds_read_b64_tr_b16 a[206:207], v223 offset:45056
v_mfma_f32_16x16x32_bf16 v[152:155], a[208:211], v[8:11], 0
s_and_b32 s67, s67, 3
buffer_load_dwordx4 v236, s[16:19], s48 offen lds
v_mfma_f32_16x16x32_bf16 v[184:187], a[208:211], v[12:15], 0
s_sub_u32 s67, s67, s36
ds_read_b64_tr_b16 a[208:209], v224 offset:40960
ds_read_b64_tr_b16 a[210:211], v224 offset:45056
v_mfma_f32_16x16x32_bf16 v[156:159], a[212:215], v[8:11], 0
s_add_u32 m0, s3, 81920
v_subrev_u32 v200, 0x10000, v220
v_subrev_u32 v201, 0x10000, v221
v_mfma_f32_16x16x32_bf16 v[188:191], a[212:215], v[12:15], 0
s_add_u32 s48, s43, 73728
ds_read_b64_tr_b16 a[212:213], v225 offset:40960
ds_read_b64_tr_b16 a[214:215], v225 offset:45056
v_mfma_f32_16x16x32_bf16 v[160:163], a[216:219], v[8:11], 0
s_lshl_b32 s67, s67, 16
buffer_load_dwordx4 v236, s[16:19], s48 offen lds
v_mfma_f32_16x16x32_bf16 v[192:195], a[216:219], v[12:15], 0
s_waitcnt lgkmcnt(8)
s_add_u32 s91, s53, s67
ds_read_b64_tr_b16 a[216:217], v226 offset:40960
ds_read_b64_tr_b16 a[218:219], v226 offset:45056
v_mfma_f32_16x16x32_bf16 v[164:167], a[220:223], v[8:11], 0
s_add_u32 m0, s3, 86016
v_subrev_u32 v202, 0x10000, v222
v_subrev_u32 v203, 0x10000, v223
v_mfma_f32_16x16x32_bf16 v[196:199], a[220:223], v[12:15], 0
s_add_u32 s48, s43, 92160
ds_read_b64_tr_b16 a[220:221], v227 offset:40960
ds_read_b64_tr_b16 a[222:223], v227 offset:45056
v_mfma_f32_16x16x32_bf16 v[72:75], a[224:227], v[8:11], 0
s_add_u32 s67, s36, 3
buffer_load_dwordx4 v236, s[16:19], s48 offen lds
v_mfma_f32_16x16x32_bf16 v[88:91], a[224:227], v[12:15], 0
s_and_b32 s67, s67, 3
ds_read_b64_tr_b16 a[224:225], v216 offset:4096
ds_read_b64_tr_b16 a[226:227], v216 offset:6144
v_mfma_f32_16x16x32_bf16 v[76:79], a[228:231], v[8:11], 0
s_add_u32 m0, s3, 90112
v_subrev_u32 v204, 0x10000, v224
v_subrev_u32 v205, 0x10000, v225
v_mfma_f32_16x16x32_bf16 v[92:95], a[228:231], v[12:15], 0
s_add_u32 s48, s43, 110592
ds_read_b64_tr_b16 a[228:229], v217 offset:4096
ds_read_b64_tr_b16 a[230:231], v217 offset:6144
v_mfma_f32_16x16x32_bf16 v[80:83], a[232:235], v[8:11], 0
s_sub_u32 s67, s67, s36
buffer_load_dwordx4 v236, s[16:19], s48 offen lds
v_mfma_f32_16x16x32_bf16 v[96:99], a[232:235], v[12:15], 0
ds_read_b64_tr_b16 a[232:233], v218 offset:4096
ds_read_b64_tr_b16 a[234:235], v218 offset:6144
v_mfma_f32_16x16x32_bf16 v[84:87], a[236:239], v[8:11], 0
v_subrev_u32 v206, 0x10000, v226
v_mfma_f32_16x16x32_bf16 v[100:103], a[236:239], v[12:15], 0
ds_read_b64_tr_b16 a[236:237], v219 offset:4096
ds_read_b64_tr_b16 a[238:239], v219 offset:6144
s_waitcnt vmcnt(4)
s_mov_b64 exec, 1
buffer_store_dword v5, v234, s[20:23], s95 offen offset:0 sc0 sc1
s_mov_b64 exec, -1
v_mfma_f32_16x16x32_bf16 v[136:139], a[192:195], v[16:19], v[136:139]
s_add_u32 m0, s3, 94208
v_subrev_u32 v207, 0x10000, v227
v_mfma_f32_16x16x32_bf16 v[168:171], a[192:195], v[20:23], v[168:171]
s_add_u32 s48, s43, 129024
ds_read_b64_tr_b16 a[192:193], v220 offset:49152
ds_read_b64_tr_b16 a[194:195], v220 offset:53248
v_mfma_f32_16x16x32_bf16 v[140:143], a[196:199], v[16:19], v[140:143]
s_lshl_b32 s67, s67, 16
buffer_load_dwordx4 v236, s[16:19], s48 offen lds
v_mfma_f32_16x16x32_bf16 v[172:175], a[196:199], v[20:23], v[172:175]
s_waitcnt lgkmcnt(8)
s_add_u32 s92, s53, s67
ds_read_b64_tr_b16 a[196:197], v221 offset:49152
ds_read_b64_tr_b16 a[198:199], v221 offset:53248
v_mfma_f32_16x16x32_bf16 v[144:147], a[200:203], v[16:19], v[144:147]
s_lshl_b32 s67, s34, 2
v_mfma_f32_16x16x32_bf16 v[176:179], a[200:203], v[20:23], v[176:179]
s_add_u32 s94, s53, 8192
ds_read_b64_tr_b16 a[200:201], v222 offset:49152
ds_read_b64_tr_b16 a[202:203], v222 offset:53248
v_mfma_f32_16x16x32_bf16 v[148:151], a[204:207], v[16:19], v[148:151]
s_add_u32 s67, s67, s32
buffer_store_dwordx4 v[40:43], v234, s[20:23], s94 offen offset:0 sc0 sc1
v_mfma_f32_16x16x32_bf16 v[180:183], a[204:207], v[20:23], v[180:183]
s_lshl_b32 s86, s67, 7
ds_read_b64_tr_b16 a[204:205], v223 offset:49152
ds_read_b64_tr_b16 a[206:207], v223 offset:53248
v_mfma_f32_16x16x32_bf16 v[152:155], a[208:211], v[16:19], v[152:155]
s_add_u32 s86, s86, 0x260000
v_mfma_f32_16x16x32_bf16 v[184:187], a[208:211], v[20:23], v[184:187]
s_lshl_b32 s67, s67, 1
ds_read_b64_tr_b16 a[208:209], v224 offset:49152
ds_read_b64_tr_b16 a[210:211], v224 offset:53248
v_mfma_f32_16x16x32_bf16 v[156:159], a[212:215], v[16:19], v[156:159]
s_lshr_b32 s47, s35, 1
v_mfma_f32_16x16x32_bf16 v[188:191], a[212:215], v[20:23], v[188:191]
s_add_u32 s67, s67, s47
ds_read_b64_tr_b16 a[212:213], v225 offset:49152
ds_read_b64_tr_b16 a[214:215], v225 offset:53248
v_mfma_f32_16x16x32_bf16 v[160:163], a[216:219], v[16:19], v[160:163]
s_lshl_b32 s87, s67, 15
v_mfma_f32_16x16x32_bf16 v[192:195], a[216:219], v[20:23], v[192:195]
s_add_u32 s87, s87, 0x2000000
ds_read_b64_tr_b16 a[216:217], v226 offset:49152
ds_read_b64_tr_b16 a[218:219], v226 offset:53248
v_mfma_f32_16x16x32_bf16 v[164:167], a[220:223], v[16:19], v[164:167]
s_lshl_b32 s67, s33, 9
v_mfma_f32_16x16x32_bf16 v[196:199], a[220:223], v[20:23], v[196:199]
s_add_u32 s88, s87, s67
ds_read_b64_tr_b16 a[220:221], v227 offset:49152
ds_read_b64_tr_b16 a[222:223], v227 offset:53248
v_mfma_f32_16x16x32_bf16 v[72:75], a[224:227], v[16:19], v[72:75]
s_xor_b32 s89, s88, 0x8000
v_mfma_f32_16x16x32_bf16 v[88:91], a[224:227], v[20:23], v[88:91]
s_waitcnt lgkmcnt(8)
s_add_u32 s94, s53, 8192
ds_read_b64_tr_b16 a[224:225], v216 offset:8192
ds_read_b64_tr_b16 a[226:227], v216 offset:10240
v_mfma_f32_16x16x32_bf16 v[76:79], a[228:231], v[16:19], v[76:79]
s_lshl_b32 s47, s34, 2
buffer_store_dwordx4 v[44:47], v234, s[20:23], s94 offen offset:1024 sc0 sc1
v_mfma_f32_16x16x32_bf16 v[92:95], a[228:231], v[20:23], v[92:95]
s_add_u32 s47, s47, s36
ds_read_b64_tr_b16 a[228:229], v217 offset:8192
ds_read_b64_tr_b16 a[230:231], v217 offset:10240
v_mfma_f32_16x16x32_bf16 v[80:83], a[232:235], v[16:19], v[80:83]
s_lshl_b32 s63, s47, 2
v_mfma_f32_16x16x32_bf16 v[96:99], a[232:235], v[20:23], v[96:99]
ds_read_b64_tr_b16 a[232:233], v218 offset:8192
ds_read_b64_tr_b16 a[234:235], v218 offset:10240
v_mfma_f32_16x16x32_bf16 v[84:87], a[236:239], v[16:19], v[84:87]
v_mfma_f32_16x16x32_bf16 v[100:103], a[236:239], v[20:23], v[100:103]
ds_read_b64_tr_b16 a[236:237], v219 offset:8192
ds_read_b64_tr_b16 a[238:239], v219 offset:10240
v_mfma_f32_16x16x32_bf16 v[136:139], a[192:195], v[24:27], v[136:139]
s_add_u32 s63, s63, s32
v_mfma_f32_16x16x32_bf16 v[168:171], a[192:195], v[28:31], v[168:171]
s_lshl_b32 s63, s63, 9
ds_read_b64_tr_b16 a[192:193], v220 offset:57344
ds_read_b64_tr_b16 a[194:195], v220 offset:61440
v_mfma_f32_16x16x32_bf16 v[140:143], a[196:199], v[24:27], v[140:143]
s_add_u32 s63, s63, 0x280000
v_mfma_f32_16x16x32_bf16 v[172:175], a[196:199], v[28:31], v[172:175]
s_lshl_b32 s47, s47, 6
ds_read_b64_tr_b16 a[196:197], v221 offset:57344
ds_read_b64_tr_b16 a[198:199], v221 offset:61440
v_mfma_f32_16x16x32_bf16 v[144:147], a[200:203], v[24:27], v[144:147]
s_add_u32 s47, s47, s32
v_mfma_f32_16x16x32_bf16 v[176:179], a[200:203], v[28:31], v[176:179]
s_add_u32 s94, s53, 8192
ds_read_b64_tr_b16 a[200:201], v222 offset:57344
ds_read_b64_tr_b16 a[202:203], v222 offset:61440
v_mfma_f32_16x16x32_bf16 v[148:151], a[204:207], v[24:27], v[148:151]
s_lshl_b32 s47, s47, 11
buffer_store_dwordx4 v[48:51], v234, s[20:23], s94 offen offset:2048 sc0 sc1
v_mfma_f32_16x16x32_bf16 v[180:183], a[204:207], v[28:31], v[180:183]
s_waitcnt lgkmcnt(8)
s_mul_i32 s67, s35, 40960
ds_read_b64_tr_b16 a[204:205], v223 offset:57344
ds_read_b64_tr_b16 a[206:207], v223 offset:61440
v_mfma_f32_16x16x32_bf16 v[152:155], a[208:211], v[24:27], v[152:155]
s_add_u32 s67, s67, s47
v_mfma_f32_16x16x32_bf16 v[184:187], a[208:211], v[28:31], v[184:187]
s_add_u32 s67, s67, 0x1400000
ds_read_b64_tr_b16 a[208:209], v224 offset:57344
ds_read_b64_tr_b16 a[210:211], v224 offset:61440
v_mfma_f32_16x16x32_bf16 v[156:159], a[212:215], v[24:27], v[156:159]
s_mov_b32 s57, 0xbfb8aa3b
v_mfma_f32_16x16x32_bf16 v[188:191], a[212:215], v[28:31], v[188:191]
s_mov_b32 s56, 0xffff0000
ds_read_b64_tr_b16 a[212:213], v225 offset:57344
ds_read_b64_tr_b16 a[214:215], v225 offset:61440
v_mfma_f32_16x16x32_bf16 v[160:163], a[216:219], v[24:27], v[160:163]
s_mov_b32 s58, 0x00003f80
v_mfma_f32_16x16x32_bf16 v[192:195], a[216:219], v[28:31], v[192:195]
s_mov_b32 s59, 0x3f800000
ds_read_b64_tr_b16 a[216:217], v226 offset:57344
ds_read_b64_tr_b16 a[218:219], v226 offset:61440
v_mfma_f32_16x16x32_bf16 v[164:167], a[220:223], v[24:27], v[164:167]
s_lshl_b32 s47, s36, 13
v_mfma_f32_16x16x32_bf16 v[196:199], a[220:223], v[28:31], v[196:199]
s_add_u32 s87, s87, s47
ds_read_b64_tr_b16 a[220:221], v227 offset:57344
ds_read_b64_tr_b16 a[222:223], v227 offset:61440
v_mfma_f32_16x16x32_bf16 v[72:75], a[224:227], v[24:27], v[72:75]
s_mov_b32 s38, 15
v_mfma_f32_16x16x32_bf16 v[88:91], a[224:227], v[28:31], v[88:91]
s_add_u32 s94, s53, 8192
ds_read_b64_tr_b16 a[224:225], v216 offset:12288
ds_read_b64_tr_b16 a[226:227], v216 offset:14336
v_mfma_f32_16x16x32_bf16 v[76:79], a[228:231], v[24:27], v[76:79]
s_bitset0_b32 s38, s35
buffer_store_dwordx4 v[52:55], v234, s[20:23], s94 offen offset:3072 sc0 sc1
v_mfma_f32_16x16x32_bf16 v[92:95], a[228:231], v[28:31], v[92:95]
s_xor_b32 s60, s67, 8192
ds_read_b64_tr_b16 a[228:229], v217 offset:12288
ds_read_b64_tr_b16 a[230:231], v217 offset:14336
v_mfma_f32_16x16x32_bf16 v[80:83], a[232:235], v[24:27], v[80:83]
s_xor_b32 s64, s67, 32768
v_mfma_f32_16x16x32_bf16 v[96:99], a[232:235], v[28:31], v[96:99]
s_waitcnt lgkmcnt(8)
ds_read_b64_tr_b16 a[232:233], v218 offset:12288
ds_read_b64_tr_b16 a[234:235], v218 offset:14336
v_mfma_f32_16x16x32_bf16 v[84:87], a[236:239], v[24:27], v[84:87]
v_mfma_f32_16x16x32_bf16 v[100:103], a[236:239], v[28:31], v[100:103]
ds_read_b64_tr_b16 a[236:237], v219 offset:12288
ds_read_b64_tr_b16 a[238:239], v219 offset:14336
v_mfma_f32_16x16x32_bf16 v[136:139], a[192:195], v[32:35], v[136:139]
v_mfma_f32_16x16x32_bf16 v[168:171], a[192:195], v[36:39], v[168:171]
v_mfma_f32_16x16x32_bf16 v[140:143], a[196:199], v[32:35], v[140:143]
v_mfma_f32_16x16x32_bf16 v[172:175], a[196:199], v[36:39], v[172:175]
v_mfma_f32_16x16x32_bf16 v[144:147], a[200:203], v[32:35], v[144:147]
s_waitcnt lgkmcnt(0)
s_barrier
v_mfma_f32_16x16x32_bf16 v[176:179], a[200:203], v[36:39], v[176:179]
s_xor_b32 s61, s67, 16384
ds_read_b64_tr_b16 a[192:193], v208 offset:0
ds_read_b64_tr_b16 a[194:195], v208 offset:4096
v_mfma_f32_16x16x32_bf16 v[148:151], a[204:207], v[32:35], v[148:151]
s_add_u32 s94, s53, 12288
ds_read_b64_tr_b16 a[196:197], v209 offset:0
ds_read_b64_tr_b16 a[198:199], v209 offset:4096
v_mfma_f32_16x16x32_bf16 v[180:183], a[204:207], v[36:39], v[180:183]
s_xor_b32 s65, s67, 65536
buffer_store_dwordx4 v[56:59], v234, s[20:23], s94 offen offset:0 sc0 sc1
v_mfma_f32_16x16x32_bf16 v[152:155], a[208:211], v[32:35], v[152:155]
s_xor_b32 s62, s67, 24576
ds_read_b64_tr_b16 a[200:201], v210 offset:0
ds_read_b64_tr_b16 a[202:203], v210 offset:4096
v_mfma_f32_16x16x32_bf16 v[184:187], a[208:211], v[36:39], v[184:187]
s_xor_b32 s66, s67, 98304
ds_read_b64_tr_b16 a[204:205], v211 offset:0
ds_read_b64_tr_b16 a[206:207], v211 offset:4096
v_mfma_f32_16x16x32_bf16 v[156:159], a[212:215], v[32:35], v[156:159]
ds_read_b64_tr_b16 a[208:209], v212 offset:0
ds_read_b64_tr_b16 a[210:211], v212 offset:4096
v_mfma_f32_16x16x32_bf16 v[188:191], a[212:215], v[36:39], v[188:191]
ds_read_b64_tr_b16 a[212:213], v213 offset:0
ds_read_b64_tr_b16 a[214:215], v213 offset:4096
v_mfma_f32_16x16x32_bf16 v[160:163], a[216:219], v[32:35], v[160:163]
v_mfma_f32_16x16x32_bf16 v[192:195], a[216:219], v[36:39], v[192:195]
ds_read_b64_tr_b16 a[216:217], v214 offset:0
ds_read_b64_tr_b16 a[218:219], v214 offset:4096
v_mfma_f32_16x16x32_bf16 v[164:167], a[220:223], v[32:35], v[164:167]
v_mfma_f32_16x16x32_bf16 v[196:199], a[220:223], v[36:39], v[196:199]
ds_read_b64_tr_b16 a[220:221], v215 offset:0
ds_read_b64_tr_b16 a[222:223], v215 offset:4096
v_mfma_f32_16x16x32_bf16 v[72:75], a[224:227], v[32:35], v[72:75]
v_mfma_f32_16x16x32_bf16 v[88:91], a[224:227], v[36:39], v[88:91]
ds_read_b64_tr_b16 a[224:225], v216 offset:16384
ds_read_b64_tr_b16 a[226:227], v216 offset:18432
v_mfma_f32_16x16x32_bf16 v[76:79], a[228:231], v[32:35], v[76:79]
s_add_u32 s94, s53, 12288
v_mfma_f32_16x16x32_bf16 v[92:95], a[228:231], v[36:39], v[92:95]
buffer_store_dwordx4 v[60:63], v234, s[20:23], s94 offen offset:1024 sc0 sc1
v_mfma_f32_16x16x32_bf16 v[80:83], a[232:235], v[32:35], v[80:83]
ds_read_b64_tr_b16 a[228:229], v217 offset:16384
ds_read_b64_tr_b16 a[230:231], v217 offset:18432
v_mfma_f32_16x16x32_bf16 v[96:99], a[232:235], v[36:39], v[96:99]
ds_read_b64_tr_b16 a[232:233], v218 offset:16384
ds_read_b64_tr_b16 a[234:235], v218 offset:18432
v_mfma_f32_16x16x32_bf16 v[84:87], a[236:239], v[32:35], v[84:87]
v_mfma_f32_16x16x32_bf16 v[100:103], a[236:239], v[36:39], v[100:103]
s_waitcnt lgkmcnt(8)
ds_read_b64_tr_b16 a[236:237], v219 offset:16384
ds_read_b64_tr_b16 a[238:239], v219 offset:18432
buffer_load_dword v246, v6, s[20:23], s54 offen sc0 sc1
v_mfma_f32_16x16x32_bf16 v[136:139], a[192:195], v[40:43], v[136:139]
v_mfma_f32_16x16x32_bf16 v[168:171], a[192:195], v[44:47], v[168:171]
ds_read_b64_tr_b16 a[192:193], v208 offset:8192
ds_read_b64_tr_b16 a[194:195], v208 offset:12288
v_mfma_f32_16x16x32_bf16 v[140:143], a[196:199], v[40:43], v[140:143]
v_mfma_f32_16x16x32_bf16 v[172:175], a[196:199], v[44:47], v[172:175]
ds_read_b64_tr_b16 a[196:197], v209 offset:8192
ds_read_b64_tr_b16 a[198:199], v209 offset:12288
v_mfma_f32_16x16x32_bf16 v[144:147], a[200:203], v[40:43], v[144:147]
v_mfma_f32_16x16x32_bf16 v[176:179], a[200:203], v[44:47], v[176:179]
ds_read_b64_tr_b16 a[200:201], v210 offset:8192
ds_read_b64_tr_b16 a[202:203], v210 offset:12288
v_mfma_f32_16x16x32_bf16 v[148:151], a[204:207], v[40:43], v[148:151]
s_add_u32 s94, s53, 12288
v_mfma_f32_16x16x32_bf16 v[180:183], a[204:207], v[44:47], v[180:183]
buffer_store_dwordx4 v[64:67], v234, s[20:23], s94 offen offset:2048 sc0 sc1
v_mfma_f32_16x16x32_bf16 v[152:155], a[208:211], v[40:43], v[152:155]
ds_read_b64_tr_b16 a[204:205], v211 offset:8192
ds_read_b64_tr_b16 a[206:207], v211 offset:12288
v_mfma_f32_16x16x32_bf16 v[184:187], a[208:211], v[44:47], v[184:187]
ds_read_b64_tr_b16 a[208:209], v212 offset:8192
ds_read_b64_tr_b16 a[210:211], v212 offset:12288
v_mfma_f32_16x16x32_bf16 v[156:159], a[212:215], v[40:43], v[156:159]
v_mfma_f32_16x16x32_bf16 v[188:191], a[212:215], v[44:47], v[188:191]
ds_read_b64_tr_b16 a[212:213], v213 offset:8192
ds_read_b64_tr_b16 a[214:215], v213 offset:12288
v_mfma_f32_16x16x32_bf16 v[160:163], a[216:219], v[40:43], v[160:163]
v_mfma_f32_16x16x32_bf16 v[192:195], a[216:219], v[44:47], v[192:195]
s_waitcnt lgkmcnt(8)
ds_read_b64_tr_b16 a[216:217], v214 offset:8192
ds_read_b64_tr_b16 a[218:219], v214 offset:12288
v_mfma_f32_16x16x32_bf16 v[164:167], a[220:223], v[40:43], v[164:167]
v_mfma_f32_16x16x32_bf16 v[196:199], a[220:223], v[44:47], v[196:199]
ds_read_b64_tr_b16 a[220:221], v215 offset:8192
ds_read_b64_tr_b16 a[222:223], v215 offset:12288
v_mfma_f32_16x16x32_bf16 v[72:75], a[224:227], v[40:43], v[72:75]
v_mfma_f32_16x16x32_bf16 v[88:91], a[224:227], v[44:47], v[88:91]
ds_read_b64_tr_b16 a[224:225], v216 offset:20480
ds_read_b64_tr_b16 a[226:227], v216 offset:22528
v_mfma_f32_16x16x32_bf16 v[76:79], a[228:231], v[40:43], v[76:79]
s_add_u32 s94, s53, 12288
v_mfma_f32_16x16x32_bf16 v[92:95], a[228:231], v[44:47], v[92:95]
buffer_store_dwordx4 v[68:71], v234, s[20:23], s94 offen offset:3072 sc0 sc1
v_mfma_f32_16x16x32_bf16 v[80:83], a[232:235], v[40:43], v[80:83]
ds_read_b64_tr_b16 a[228:229], v217 offset:20480
ds_read_b64_tr_b16 a[230:231], v217 offset:22528
v_mfma_f32_16x16x32_bf16 v[96:99], a[232:235], v[44:47], v[96:99]
ds_read_b64_tr_b16 a[232:233], v218 offset:20480
ds_read_b64_tr_b16 a[234:235], v218 offset:22528
v_mfma_f32_16x16x32_bf16 v[84:87], a[236:239], v[40:43], v[84:87]
v_mfma_f32_16x16x32_bf16 v[100:103], a[236:239], v[44:47], v[100:103]
ds_read_b64_tr_b16 a[236:237], v219 offset:20480
ds_read_b64_tr_b16 a[238:239], v219 offset:22528
v_mfma_f32_16x16x32_bf16 v[136:139], a[192:195], v[48:51], v[136:139]
v_mfma_f32_16x16x32_bf16 v[168:171], a[192:195], v[52:55], v[168:171]
ds_read_b64_tr_b16 a[192:193], v208 offset:16384
ds_read_b64_tr_b16 a[194:195], v208 offset:20480
v_mfma_f32_16x16x32_bf16 v[140:143], a[196:199], v[48:51], v[140:143]
v_mfma_f32_16x16x32_bf16 v[172:175], a[196:199], v[52:55], v[172:175]
s_waitcnt lgkmcnt(8)
ds_read_b64_tr_b16 a[196:197], v209 offset:16384
ds_read_b64_tr_b16 a[198:199], v209 offset:20480
v_mfma_f32_16x16x32_bf16 v[144:147], a[200:203], v[48:51], v[144:147]
v_mfma_f32_16x16x32_bf16 v[176:179], a[200:203], v[52:55], v[176:179]
s_add_u32 m0, s3, 98304
ds_read_b64_tr_b16 a[200:201], v210 offset:16384
ds_read_b64_tr_b16 a[202:203], v210 offset:20480
v_mfma_f32_16x16x32_bf16 v[148:151], a[204:207], v[48:51], v[148:151]
s_add_u32 s48, s44, 0
v_mfma_f32_16x16x32_bf16 v[180:183], a[204:207], v[52:55], v[180:183]
buffer_load_dwordx4 v236, s[16:19], s48 offen lds
v_mfma_f32_16x16x32_bf16 v[152:155], a[208:211], v[48:51], v[152:155]
ds_read_b64_tr_b16 a[204:205], v211 offset:16384
ds_read_b64_tr_b16 a[206:207], v211 offset:20480
v_mfma_f32_16x16x32_bf16 v[184:187], a[208:211], v[52:55], v[184:187]
s_add_u32 m0, s3, 102400
ds_read_b64_tr_b16 a[208:209], v212 offset:16384
ds_read_b64_tr_b16 a[210:211], v212 offset:20480
v_mfma_f32_16x16x32_bf16 v[156:159], a[212:215], v[48:51], v[156:159]
s_add_u32 s48, s44, 18432
v_mfma_f32_16x16x32_bf16 v[188:191], a[212:215], v[52:55], v[188:191]
buffer_load_dwordx4 v236, s[16:19], s48 offen lds
v_mfma_f32_16x16x32_bf16 v[160:163], a[216:219], v[48:51], v[160:163]
ds_read_b64_tr_b16 a[212:213], v213 offset:16384
ds_read_b64_tr_b16 a[214:215], v213 offset:20480
v_mfma_f32_16x16x32_bf16 v[192:195], a[216:219], v[52:55], v[192:195]
s_add_u32 m0, s3, 106496
ds_read_b64_tr_b16 a[216:217], v214 offset:16384
ds_read_b64_tr_b16 a[218:219], v214 offset:20480
v_mfma_f32_16x16x32_bf16 v[164:167], a[220:223], v[48:51], v[164:167]
s_add_u32 s48, s44, 36864
v_mfma_f32_16x16x32_bf16 v[196:199], a[220:223], v[52:55], v[196:199]
buffer_load_dwordx4 v236, s[16:19], s48 offen lds
v_mfma_f32_16x16x32_bf16 v[72:75], a[224:227], v[48:51], v[72:75]
s_waitcnt lgkmcnt(8)
ds_read_b64_tr_b16 a[220:221], v215 offset:16384
ds_read_b64_tr_b16 a[222:223], v215 offset:20480
v_mfma_f32_16x16x32_bf16 v[88:91], a[224:227], v[52:55], v[88:91]
s_add_u32 m0, s3, 110592
ds_read_b64_tr_b16 a[224:225], v216 offset:24576
ds_read_b64_tr_b16 a[226:227], v216 offset:26624
v_mfma_f32_16x16x32_bf16 v[76:79], a[228:231], v[48:51], v[76:79]
s_add_u32 s48, s44, 55296
v_mfma_f32_16x16x32_bf16 v[92:95], a[228:231], v[52:55], v[92:95]
buffer_load_dwordx4 v236, s[16:19], s48 offen lds
v_mfma_f32_16x16x32_bf16 v[80:83], a[232:235], v[48:51], v[80:83]
ds_read_b64_tr_b16 a[228:229], v217 offset:24576
ds_read_b64_tr_b16 a[230:231], v217 offset:26624
v_mfma_f32_16x16x32_bf16 v[96:99], a[232:235], v[52:55], v[96:99]
ds_read_b64_tr_b16 a[232:233], v218 offset:24576
ds_read_b64_tr_b16 a[234:235], v218 offset:26624
v_mfma_f32_16x16x32_bf16 v[84:87], a[236:239], v[48:51], v[84:87]
v_mfma_f32_16x16x32_bf16 v[100:103], a[236:239], v[52:55], v[100:103]
ds_read_b64_tr_b16 a[236:237], v219 offset:24576
ds_read_b64_tr_b16 a[238:239], v219 offset:26624
v_rcp_f32 v132, v131
s_waitcnt vmcnt(6)
v_cmp_ne_u32 vcc, 1, v246
s_and_b32 s46, vcc_lo, 85
s_cbranch_scc0 K_F0_OK
K_F0:
s_sleep 1
s_add_u32 s100, s100, 1
s_bitcmp1_b32 s100, 19
s_cbranch_scc1 K_END
buffer_load_dword v246, v6, s[20:23], s54 offen sc0 sc1
s_waitcnt vmcnt(0)
v_cmp_ne_u32 vcc, 1, v246
s_and_b32 s46, vcc_lo, 85
s_cbranch_scc1 K_F0
K_F0_OK:
v_mfma_f32_16x16x32_bf16 v[136:139], a[192:195], v[56:59], v[136:139]
s_add_u32 s94, s90, 0
v_mfma_f32_16x16x32_bf16 v[168:171], a[192:195], v[60:63], v[168:171]
buffer_load_dwordx4 a[0:3], v234, s[20:23], s94 offen offset:0 sc0 sc1
v_mfma_f32_16x16x32_bf16 v[140:143], a[196:199], v[56:59], v[140:143]
ds_read_b64_tr_b16 a[192:193], v208 offset:24576
ds_read_b64_tr_b16 a[194:195], v208 offset:28672
v_mfma_f32_16x16x32_bf16 v[172:175], a[196:199], v[60:63], v[172:175]
s_add_u32 s94, s90, 0
ds_read_b64_tr_b16 a[196:197], v209 offset:24576
ds_read_b64_tr_b16 a[198:199], v209 offset:28672
v_mfma_f32_16x16x32_bf16 v[144:147], a[200:203], v[56:59], v[144:147]
buffer_load_dwordx4 a[4:7], v234, s[20:23], s94 offen offset:1024 sc0 sc1
v_mfma_f32_16x16x32_bf16 v[176:179], a[200:203], v[60:63], v[176:179]
s_waitcnt lgkmcnt(10)
ds_read_b64_tr_b16 a[200:201], v210 offset:24576
ds_read_b64_tr_b16 a[202:203], v210 offset:28672
v_mfma_f32_16x16x32_bf16 v[148:151], a[204:207], v[56:59], v[148:151]
s_add_u32 s94, s90, 0
v_mfma_f32_16x16x32_bf16 v[180:183], a[204:207], v[60:63], v[180:183]
buffer_load_dwordx4 a[8:11], v234, s[20:23], s94 offen offset:2048 sc0 sc1
v_mfma_f32_16x16x32_bf16 v[152:155], a[208:211], v[56:59], v[152:155]
ds_read_b64_tr_b16 a[204:205], v211 offset:24576
ds_read_b64_tr_b16 a[206:207], v211 offset:28672
v_mfma_f32_16x16x32_bf16 v[184:187], a[208:211], v[60:63], v[184:187]
s_add_u32 s94, s90, 0
ds_read_b64_tr_b16 a[208:209], v212 offset:24576
ds_read_b64_tr_b16 a[210:211], v212 offset:28672
v_mfma_f32_16x16x32_bf16 v[156:159], a[212:215], v[56:59], v[156:159]
buffer_load_dwordx4 a[12:15], v234, s[20:23], s94 offen offset:3072 sc0 sc1
v_mfma_f32_16x16x32_bf16 v[188:191], a[212:215], v[60:63], v[188:191]
ds_read_b64_tr_b16 a[212:213], v213 offset:24576
ds_read_b64_tr_b16 a[214:215], v213 offset:28672
v_mfma_f32_16x16x32_bf16 v[160:163], a[216:219], v[56:59], v[160:163]
s_add_u32 s94, s90, 4096
v_mfma_f32_16x16x32_bf16 v[192:195], a[216:219], v[60:63], v[192:195]
buffer_load_dwordx4 a[16:19], v234, s[20:23], s94 offen offset:0 sc0 sc1
v_mfma_f32_16x16x32_bf16 v[164:167], a[220:223], v[56:59], v[164:167]
ds_read_b64_tr_b16 a[216:217], v214 offset:24576
ds_read_b64_tr_b16 a[218:219], v214 offset:28672
v_mfma_f32_16x16x32_bf16 v[196:199], a[220:223], v[60:63], v[196:199]
s_add_u32 s94, s90, 4096
ds_read_b64_tr_b16 a[220:221], v215 offset:24576
ds_read_b64_tr_b16 a[222:223], v215 offset:28672
v_mfma_f32_16x16x32_bf16 v[72:75], a[224:227], v[56:59], v[72:75]
buffer_load_dwordx4 a[20:23], v234, s[20:23], s94 offen offset:1024 sc0 sc1
v_mfma_f32_16x16x32_bf16 v[88:91], a[224:227], v[60:63], v[88:91]
s_waitcnt lgkmcnt(10)
ds_read_b64_tr_b16 a[224:225], v216 offset:28672
ds_read_b64_tr_b16 a[226:227], v216 offset:30720
v_mfma_f32_16x16x32_bf16 v[76:79], a[228:231], v[56:59], v[76:79]
s_add_u32 s94, s90, 4096
v_mfma_f32_16x16x32_bf16 v[92:95], a[228:231], v[60:63], v[92:95]
buffer_load_dwordx4 a[24:27], v234, s[20:23], s94 offen offset:2048 sc0 sc1
v_mfma_f32_16x16x32_bf16 v[80:83], a[232:235], v[56:59], v[80:83]
ds_read_b64_tr_b16 a[228:229], v217 offset:28672
ds_read_b64_tr_b16 a[230:231], v217 offset:30720
v_mfma_f32_16x16x32_bf16 v[96:99], a[232:235], v[60:63], v[96:99]
s_add_u32 s94, s90, 4096
ds_read_b64_tr_b16 a[232:233], v218 offset:28672
ds_read_b64_tr_b16 a[234:235], v218 offset:30720
v_mfma_f32_16x16x32_bf16 v[84:87], a[236:239], v[56:59], v[84:87]
buffer_load_dwordx4 a[28:31], v234, s[20:23], s94 offen offset:3072 sc0 sc1
v_mfma_f32_16x16x32_bf16 v[100:103], a[236:239], v[60:63], v[100:103]
ds_read_b64_tr_b16 a[236:237], v219 offset:28672
ds_read_b64_tr_b16 a[238:239], v219 offset:30720
s_waitcnt vmcnt(12)
s_mov_b64 exec, 1
buffer_store_dword v5, v234, s[20:23], s95 offen offset:4 sc0 sc1
s_mov_b64 exec, -1
v_mfma_f32_16x16x32_bf16 v[136:139], a[192:195], v[64:67], v[136:139]
v_mfma_f32_16x16x32_bf16 v[168:171], a[192:195], v[68:71], v[168:171]
v_mfma_f32_16x16x32_bf16 v[140:143], a[196:199], v[64:67], v[140:143]
v_mfma_f32_16x16x32_bf16 v[172:175], a[196:199], v[68:71], v[172:175]
v_mfma_f32_16x16x32_bf16 v[144:147], a[200:203], v[64:67], v[144:147]
s_waitcnt vmcnt(22) lgkmcnt(0)
s_barrier
v_mfma_f32_16x16x32_bf16 v[176:179], a[200:203], v[68:71], v[176:179]
ds_read_b64_tr_b16 a[192:193], v200 offset:32768
ds_read_b64_tr_b16 a[194:195], v200 offset:36864
v_mfma_f32_16x16x32_bf16 v[148:151], a[204:207], v[64:67], v[148:151]
s_add_u32 s94, s91, 0
ds_read_b64_tr_b16 a[196:197], v201 offset:32768
ds_read_b64_tr_b16 a[198:199], v201 offset:36864
v_mfma_f32_16x16x32_bf16 v[180:183], a[204:207], v[68:71], v[180:183]
buffer_load_dwordx4 a[32:35], v234, s[20:23], s94 offen offset:0 sc0 sc1
v_mfma_f32_16x16x32_bf16 v[152:155], a[208:211], v[64:67], v[152:155]
ds_read_b64_tr_b16 a[200:201], v202 offset:32768
ds_read_b64_tr_b16 a[202:203], v202 offset:36864
v_mfma_f32_16x16x32_bf16 v[184:187], a[208:211], v[68:71], v[184:187]
ds_read_b64_tr_b16 a[204:205], v203 offset:32768
ds_read_b64_tr_b16 a[206:207], v203 offset:36864
v_mfma_f32_16x16x32_bf16 v[156:159], a[212:215], v[64:67], v[156:159]
s_add_u32 s94, s91, 0
ds_read_b64_tr_b16 a[208:209], v204 offset:32768
ds_read_b64_tr_b16 a[210:211], v204 offset:36864
v_mfma_f32_16x16x32_bf16 v[188:191], a[212:215], v[68:71], v[188:191]
buffer_load_dwordx4 a[36:39], v234, s[20:23], s94 offen offset:1024 sc0 sc1
v_mfma_f32_16x16x32_bf16 v[160:163], a[216:219], v[64:67], v[160:163]
ds_read_b64_tr_b16 a[212:213], v205 offset:32768
ds_read_b64_tr_b16 a[214:215], v205 offset:36864
v_mfma_f32_16x16x32_bf16 v[192:195], a[216:219], v[68:71], v[192:195]
ds_read_b64_tr_b16 a[216:217], v206 offset:32768
ds_read_b64_tr_b16 a[218:219], v206 offset:36864
v_mfma_f32_16x16x32_bf16 v[164:167], a[220:223], v[64:67], v[164:167]
s_add_u32 s94, s91, 0
v_mfma_f32_16x16x32_bf16 v[196:199], a[220:223], v[68:71], v[196:199]
buffer_load_dwordx4 a[40:43], v234, s[20:23], s94 offen offset:2048 sc0 sc1
v_mfma_f32_16x16x32_bf16 v[72:75], a[224:227], v[64:67], v[72:75]
ds_read_b64_tr_b16 a[220:221], v207 offset:32768
ds_read_b64_tr_b16 a[222:223], v207 offset:36864
v_mfma_f32_16x16x32_bf16 v[88:91], a[224:227], v[68:71], v[88:91]
v_mfma_f32_16x16x32_bf16 v[76:79], a[228:231], v[64:67], v[76:79]
s_add_u32 s94, s91, 0
v_mfma_f32_16x16x32_bf16 v[92:95], a[228:231], v[68:71], v[92:95]
buffer_load_dwordx4 a[44:47], v234, s[20:23], s94 offen offset:3072 sc0 sc1
v_mfma_f32_16x16x32_bf16 v[80:83], a[232:235], v[64:67], v[80:83]
v_mfma_f32_16x16x32_bf16 v[96:99], a[232:235], v[68:71], v[96:99]
v_mfma_f32_16x16x32_bf16 v[84:87], a[236:239], v[64:67], v[84:87]
v_mfma_f32_16x16x32_bf16 v[100:103], a[236:239], v[68:71], v[100:103]
s_waitcnt lgkmcnt(2)
s_cmp_lg_u32 s83, 0
s_cbranch_scc1 K_YR1
K_YR1D:
s_waitcnt vmcnt(5)
v_mfma_f32_16x16x32_bf16 v[136:139], a[192:195], a[0:3], v[136:139]
s_add_u32 s94, s91, 4096
v_mfma_f32_16x16x32_bf16 v[168:171], a[192:195], a[4:7], v[168:171]
buffer_load_dwordx4 a[48:51], v234, s[20:23], s94 offen offset:0 sc0 sc1
v_mfma_f32_16x16x32_bf16 v[140:143], a[196:199], a[0:3], v[140:143]
ds_read_b64_tr_b16 a[192:193], v200 offset:40960
ds_read_b64_tr_b16 a[194:195], v200 offset:45056
v_mfma_f32_16x16x32_bf16 v[172:175], a[196:199], a[4:7], v[172:175]
ds_read_b64_tr_b16 a[196:197], v201 offset:40960
ds_read_b64_tr_b16 a[198:199], v201 offset:45056
v_mfma_f32_16x16x32_bf16 v[144:147], a[200:203], a[0:3], v[144:147]
s_add_u32 s94, s91, 4096
v_cvt_pk_bf16_f32 v72, v72, v73
v_cvt_pk_bf16_f32 v73, v74, v75
v_mfma_f32_16x16x32_bf16 v[176:179], a[200:203], a[4:7], v[176:179]
buffer_load_dwordx4 a[52:55], v234, s[20:23], s94 offen offset:1024 sc0 sc1
v_mfma_f32_16x16x32_bf16 v[148:151], a[204:207], a[0:3], v[148:151]
ds_read_b64_tr_b16 a[200:201], v202 offset:40960
ds_read_b64_tr_b16 a[202:203], v202 offset:45056
v_mfma_f32_16x16x32_bf16 v[180:183], a[204:207], a[4:7], v[180:183]
ds_read_b64_tr_b16 a[204:205], v203 offset:40960
ds_read_b64_tr_b16 a[206:207], v203 offset:45056
v_mfma_f32_16x16x32_bf16 v[152:155], a[208:211], a[0:3], v[152:155]
s_add_u32 s94, s91, 4096
v_cvt_pk_bf16_f32 v76, v76, v77
v_cvt_pk_bf16_f32 v77, v78, v79
v_mfma_f32_16x16x32_bf16 v[184:187], a[208:211], a[4:7], v[184:187]
buffer_load_dwordx4 a[56:59], v234, s[20:23], s94 offen offset:2048 sc0 sc1
v_mfma_f32_16x16x32_bf16 v[156:159], a[212:215], a[0:3], v[156:159]
ds_read_b64_tr_b16 a[208:209], v204 offset:40960
ds_read_b64_tr_b16 a[210:211], v204 offset:45056
v_mfma_f32_16x16x32_bf16 v[188:191], a[212:215], a[4:7], v[188:191]
ds_read_b64_tr_b16 a[212:213], v205 offset:40960
ds_read_b64_tr_b16 a[214:215], v205 offset:45056
v_mfma_f32_16x16x32_bf16 v[160:163], a[216:219], a[0:3], v[160:163]
s_add_u32 s94, s91, 4096
v_cvt_pk_bf16_f32 v80, v80, v81
v_cvt_pk_bf16_f32 v81, v82, v83
v_mfma_f32_16x16x32_bf16 v[192:195], a[216:219], a[4:7], v[192:195]
s_waitcnt lgkmcnt(8)
buffer_load_dwordx4 a[60:63], v234, s[20:23], s94 offen offset:3072 sc0 sc1
v_mfma_f32_16x16x32_bf16 v[164:167], a[220:223], a[0:3], v[164:167]
ds_read_b64_tr_b16 a[216:217], v206 offset:40960
ds_read_b64_tr_b16 a[218:219], v206 offset:45056
v_mfma_f32_16x16x32_bf16 v[196:199], a[220:223], a[4:7], v[196:199]
ds_read_b64_tr_b16 a[220:221], v207 offset:40960
ds_read_b64_tr_b16 a[222:223], v207 offset:45056
v_mfma_f32_16x16x32_bf16 v[136:139], a[192:195], a[8:11], v[136:139]
s_add_u32 m0, s3, 114688
v_cvt_pk_bf16_f32 v84, v84, v85
v_cvt_pk_bf16_f32 v85, v86, v87
v_mfma_f32_16x16x32_bf16 v[168:171], a[192:195], a[12:15], v[168:171]
s_add_u32 s48, s44, 73728
ds_read_b64_tr_b16 a[192:193], v200 offset:49152
ds_read_b64_tr_b16 a[194:195], v200 offset:53248
v_mfma_f32_16x16x32_bf16 v[140:143], a[196:199], a[8:11], v[140:143]
buffer_load_dwordx4 v236, s[16:19], s48 offen lds
v_mfma_f32_16x16x32_bf16 v[172:175], a[196:199], a[12:15], v[172:175]
s_waitcnt lgkmcnt(10)
ds_read_b64_tr_b16 a[196:197], v201 offset:49152
ds_read_b64_tr_b16 a[198:199], v201 offset:53248
v_mfma_f32_16x16x32_bf16 v[144:147], a[200:203], a[8:11], v[144:147]
s_add_u32 m0, s3, 118784
v_cvt_pk_bf16_f32 v88, v88, v89
v_cvt_pk_bf16_f32 v89, v90, v91
v_mfma_f32_16x16x32_bf16 v[176:179], a[200:203], a[12:15], v[176:179]
s_add_u32 s48, s44, 92160
ds_read_b64_tr_b16 a[200:201], v202 offset:49152
ds_read_b64_tr_b16 a[202:203], v202 offset:53248
v_mfma_f32_16x16x32_bf16 v[148:151], a[204:207], a[8:11], v[148:151]
buffer_load_dwordx4 v236, s[16:19], s48 offen lds
v_mfma_f32_16x16x32_bf16 v[180:183], a[204:207], a[12:15], v[180:183]
s_waitcnt lgkmcnt(10)
ds_read_b64_tr_b16 a[204:205], v203 offset:49152
ds_read_b64_tr_b16 a[206:207], v203 offset:53248
v_mfma_f32_16x16x32_bf16 v[152:155], a[208:211], a[8:11], v[152:155]
s_add_u32 m0, s3, 122880
v_cvt_pk_bf16_f32 v92, v92, v93
v_cvt_pk_bf16_f32 v93, v94, v95
v_mfma_f32_16x16x32_bf16 v[184:187], a[208:211], a[12:15], v[184:187]
s_add_u32 s48, s44, 110592
ds_read_b64_tr_b16 a[208:209], v204 offset:49152
ds_read_b64_tr_b16 a[210:211], v204 offset:53248
v_mfma_f32_16x16x32_bf16 v[156:159], a[212:215], a[8:11], v[156:159]
buffer_load_dwordx4 v236, s[16:19], s48 offen lds
v_mfma_f32_16x16x32_bf16 v[188:191], a[212:215], a[12:15], v[188:191]
s_waitcnt lgkmcnt(8)
ds_read_b64_tr_b16 a[212:213], v205 offset:49152
ds_read_b64_tr_b16 a[214:215], v205 offset:53248
v_mfma_f32_16x16x32_bf16 v[160:163], a[216:219], a[8:11], v[160:163]
s_add_u32 m0, s3, 126976
v_cvt_pk_bf16_f32 v96, v96, v97
v_mfma_f32_16x16x32_bf16 v[192:195], a[216:219], a[12:15], v[192:195]
s_add_u32 s48, s44, 129024
ds_read_b64_tr_b16 a[216:217], v206 offset:49152
ds_read_b64_tr_b16 a[218:219], v206 offset:53248
v_mfma_f32_16x16x32_bf16 v[164:167], a[220:223], a[8:11], v[164:167]
buffer_load_dwordx4 v236, s[16:19], s48 offen lds
v_mfma_f32_16x16x32_bf16 v[196:199], a[220:223], a[12:15], v[196:199]
ds_read_b64_tr_b16 a[220:221], v207 offset:49152
ds_read_b64_tr_b16 a[222:223], v207 offset:53248
v_mfma_f32_16x16x32_bf16 v[136:139], a[192:195], a[16:19], v[136:139]
s_waitcnt lgkmcnt(10)
v_cvt_pk_bf16_f32 v97, v98, v99
v_cvt_pk_bf16_f32 v100, v100, v101
v_mfma_f32_16x16x32_bf16 v[168:171], a[192:195], a[20:23], v[168:171]
s_add_u32 s94, s92, 0
ds_read_b64_tr_b16 a[192:193], v200 offset:57344
ds_read_b64_tr_b16 a[194:195], v200 offset:61440
v_mfma_f32_16x16x32_bf16 v[140:143], a[196:199], a[16:19], v[140:143]
buffer_load_dwordx4 a[64:67], v234, s[20:23], s94 offen offset:0 sc0 sc1
v_mfma_f32_16x16x32_bf16 v[172:175], a[196:199], a[20:23], v[172:175]
ds_read_b64_tr_b16 a[196:197], v201 offset:57344
ds_read_b64_tr_b16 a[198:199], v201 offset:61440
v_mfma_f32_16x16x32_bf16 v[144:147], a[200:203], a[16:19], v[144:147]
s_waitcnt lgkmcnt(10)
v_cvt_pk_bf16_f32 v101, v102, v103
v_lshlrev_b32 v249, 7, v1
v_mfma_f32_16x16x32_bf16 v[176:179], a[200:203], a[20:23], v[176:179]
s_add_u32 s94, s92, 0
ds_read_b64_tr_b16 a[200:201], v202 offset:57344
ds_read_b64_tr_b16 a[202:203], v202 offset:61440
v_mfma_f32_16x16x32_bf16 v[148:151], a[204:207], a[16:19], v[148:151]
buffer_load_dwordx4 a[68:71], v234, s[20:23], s94 offen offset:1024 sc0 sc1
v_mfma_f32_16x16x32_bf16 v[180:183], a[204:207], a[20:23], v[180:183]
ds_read_b64_tr_b16 a[204:205], v203 offset:57344
ds_read_b64_tr_b16 a[206:207], v203 offset:61440
v_mfma_f32_16x16x32_bf16 v[152:155], a[208:211], a[16:19], v[152:155]
s_waitcnt lgkmcnt(10)
v_lshlrev_b32 v7, 2, v3
v_subrev_u32 v248, s55, v254
v_mfma_f32_16x16x32_bf16 v[184:187], a[208:211], a[20:23], v[184:187]
s_add_u32 s94, s92, 0
ds_read_b64_tr_b16 a[208:209], v204 offset:57344
ds_read_b64_tr_b16 a[210:211], v204 offset:61440
v_mfma_f32_16x16x32_bf16 v[156:159], a[212:215], a[16:19], v[156:159]
buffer_load_dwordx4 a[72:75], v234, s[20:23], s94 offen offset:2048 sc0 sc1
v_mfma_f32_16x16x32_bf16 v[188:191], a[212:215], a[20:23], v[188:191]
ds_read_b64_tr_b16 a[212:213], v205 offset:57344
ds_read_b64_tr_b16 a[214:215], v205 offset:61440
v_mfma_f32_16x16x32_bf16 v[160:163], a[216:219], a[16:19], v[160:163]
s_waitcnt lgkmcnt(10)
v_subrev_u32 v248, 1, v248
v_mfma_f32_16x16x32_bf16 v[192:195], a[216:219], a[20:23], v[192:195]
s_add_u32 s94, s92, 0
ds_read_b64_tr_b16 a[216:217], v206 offset:57344
ds_read_b64_tr_b16 a[218:219], v206 offset:61440
v_mfma_f32_16x16x32_bf16 v[164:167], a[220:223], a[16:19], v[164:167]
buffer_load_dwordx4 a[76:79], v234, s[20:23], s94 offen offset:3072 sc0 sc1
v_mfma_f32_16x16x32_bf16 v[196:199], a[220:223], a[20:23], v[196:199]
ds_read_b64_tr_b16 a[220:221], v207 offset:57344
ds_read_b64_tr_b16 a[222:223], v207 offset:61440
buffer_load_dword v246, v6, s[20:23], s54 offen sc0 sc1
v_mfma_f32_16x16x32_bf16 v[136:139], a[192:195], a[24:27], v[136:139]
s_waitcnt lgkmcnt(10)
v_add_u32 v241, s37, v241
v_add_u32 v241, 65536, v241
v_mfma_f32_16x16x32_bf16 v[168:171], a[192:195], a[28:31], v[168:171]
s_add_u32 s94, s92, 4096
ds_read_b64_tr_b16 a[192:193], v220 offset:0
ds_read_b64_tr_b16 a[194:195], v220 offset:4096
v_mfma_f32_16x16x32_bf16 v[140:143], a[196:199], a[24:27], v[140:143]
buffer_load_dwordx4 a[80:83], v234, s[20:23], s94 offen offset:0 sc0 sc1
v_mfma_f32_16x16x32_bf16 v[172:175], a[196:199], a[28:31], v[172:175]
ds_read_b64_tr_b16 a[196:197], v221 offset:0
ds_read_b64_tr_b16 a[198:199], v221 offset:4096
v_mfma_f32_16x16x32_bf16 v[144:147], a[200:203], a[24:27], v[144:147]
s_waitcnt lgkmcnt(10)
v_xor_b32 v242, 32, v241
v_xor_b32 v243, 64, v241
v_mfma_f32_16x16x32_bf16 v[176:179], a[200:203], a[28:31], v[176:179]
s_add_u32 s94, s92, 4096
ds_read_b64_tr_b16 a[200:201], v222 offset:0
ds_read_b64_tr_b16 a[202:203], v222 offset:4096
v_mfma_f32_16x16x32_bf16 v[148:151], a[204:207], a[24:27], v[148:151]
buffer_load_dwordx4 a[84:87], v234, s[20:23], s94 offen offset:1024 sc0 sc1
v_mfma_f32_16x16x32_bf16 v[180:183], a[204:207], a[28:31], v[180:183]
ds_read_b64_tr_b16 a[204:205], v223 offset:0
ds_read_b64_tr_b16 a[206:207], v223 offset:4096
v_mfma_f32_16x16x32_bf16 v[152:155], a[208:211], a[24:27], v[152:155]
s_waitcnt lgkmcnt(10)
v_xor_b32 v244, 96, v241
v_mfma_f32_16x16x32_bf16 v[184:187], a[208:211], a[28:31], v[184:187]
s_add_u32 s94, s92, 4096
ds_read_b64_tr_b16 a[208:209], v224 offset:0
ds_read_b64_tr_b16 a[210:211], v224 offset:4096
v_mfma_f32_16x16x32_bf16 v[156:159], a[212:215], a[24:27], v[156:159]
buffer_load_dwordx4 a[88:91], v234, s[20:23], s94 offen offset:2048 sc0 sc1
v_mfma_f32_16x16x32_bf16 v[188:191], a[212:215], a[28:31], v[188:191]
ds_read_b64_tr_b16 a[212:213], v225 offset:0
ds_read_b64_tr_b16 a[214:215], v225 offset:4096
v_mfma_f32_16x16x32_bf16 v[160:163], a[216:219], a[24:27], v[160:163]
s_waitcnt lgkmcnt(10)
v_mfma_f32_16x16x32_bf16 v[192:195], a[216:219], a[28:31], v[192:195]
s_add_u32 s94, s92, 4096
ds_read_b64_tr_b16 a[216:217], v226 offset:0
ds_read_b64_tr_b16 a[218:219], v226 offset:4096
v_mfma_f32_16x16x32_bf16 v[164:167], a[220:223], a[24:27], v[164:167]
buffer_load_dwordx4 a[92:95], v234, s[20:23], s94 offen offset:3072 sc0 sc1
v_mfma_f32_16x16x32_bf16 v[196:199], a[220:223], a[28:31], v[196:199]
ds_read_b64_tr_b16 a[220:221], v227 offset:0
ds_read_b64_tr_b16 a[222:223], v227 offset:4096
s_cmp_lg_u32 s83, 0
s_cbranch_scc1 K_YR2
K_YR2D:
s_waitcnt vmcnt(13)
v_mfma_f32_16x16x32_bf16 v[136:139], a[192:195], a[32:35], v[136:139]
s_add_u32 m0, s3, 131072
v_mfma_f32_16x16x32_bf16 v[168:171], a[192:195], a[36:39], v[168:171]
s_waitcnt lgkmcnt(8)
s_add_u32 s48, s42, 147456
ds_read_b64_tr_b16 a[192:193], v220 offset:8192
ds_read_b64_tr_b16 a[194:195], v220 offset:12288
v_mfma_f32_16x16x32_bf16 v[140:143], a[196:199], a[32:35], v[140:143]
buffer_load_dwordx4 v236, s[16:19], s48 offen lds
v_mfma_f32_16x16x32_bf16 v[172:175], a[196:199], a[36:39], v[172:175]
ds_read_b64_tr_b16 a[196:197], v221 offset:8192
ds_read_b64_tr_b16 a[198:199], v221 offset:12288
v_mfma_f32_16x16x32_bf16 v[144:147], a[200:203], a[32:35], v[144:147]
s_add_u32 m0, s3, 135168
v_mfma_f32_16x16x32_bf16 v[176:179], a[200:203], a[36:39], v[176:179]
s_add_u32 s48, s42, 165888
ds_read_b64_tr_b16 a[200:201], v222 offset:8192
ds_read_b64_tr_b16 a[202:203], v222 offset:12288
v_mfma_f32_16x16x32_bf16 v[148:151], a[204:207], a[32:35], v[148:151]
buffer_load_dwordx4 v236, s[16:19], s48 offen lds
v_mfma_f32_16x16x32_bf16 v[180:183], a[204:207], a[36:39], v[180:183]
s_waitcnt lgkmcnt(8)
ds_read_b64_tr_b16 a[204:205], v223 offset:8192
ds_read_b64_tr_b16 a[206:207], v223 offset:12288
v_mfma_f32_16x16x32_bf16 v[152:155], a[208:211], a[32:35], v[152:155]
s_add_u32 m0, s3, 139264
v_mfma_f32_16x16x32_bf16 v[184:187], a[208:211], a[36:39], v[184:187]
s_add_u32 s48, s42, 184320
ds_read_b64_tr_b16 a[208:209], v224 offset:8192
ds_read_b64_tr_b16 a[210:211], v224 offset:12288
v_mfma_f32_16x16x32_bf16 v[156:159], a[212:215], a[32:35], v[156:159]
buffer_load_dwordx4 v236, s[16:19], s48 offen lds
v_mfma_f32_16x16x32_bf16 v[188:191], a[212:215], a[36:39], v[188:191]
ds_read_b64_tr_b16 a[212:213], v225 offset:8192
ds_read_b64_tr_b16 a[214:215], v225 offset:12288
v_mfma_f32_16x16x32_bf16 v[160:163], a[216:219], a[32:35], v[160:163]
s_add_u32 m0, s3, 143360
v_mfma_f32_16x16x32_bf16 v[192:195], a[216:219], a[36:39], v[192:195]
s_waitcnt lgkmcnt(8)
s_add_u32 s48, s42, 202752
ds_read_b64_tr_b16 a[216:217], v226 offset:8192
ds_read_b64_tr_b16 a[218:219], v226 offset:12288
v_mfma_f32_16x16x32_bf16 v[164:167], a[220:223], a[32:35], v[164:167]
buffer_load_dwordx4 v236, s[16:19], s48 offen lds
v_mfma_f32_16x16x32_bf16 v[196:199], a[220:223], a[36:39], v[196:199]
ds_read_b64_tr_b16 a[220:221], v227 offset:8192
ds_read_b64_tr_b16 a[222:223], v227 offset:12288
v_mfma_f32_16x16x32_bf16 v[136:139], a[192:195], a[40:43], v[136:139]
s_add_u32 m0, s3, 147456
v_mfma_f32_16x16x32_bf16 v[168:171], a[192:195], a[44:47], v[168:171]
s_add_u32 s48, s42, 221184
ds_read_b64_tr_b16 a[192:193], v220 offset:16384
ds_read_b64_tr_b16 a[194:195], v220 offset:20480
v_mfma_f32_16x16x32_bf16 v[140:143], a[196:199], a[40:43], v[140:143]
buffer_load_dwordx4 v236, s[16:19], s48 offen lds
v_mfma_f32_16x16x32_bf16 v[172:175], a[196:199], a[44:47], v[172:175]
s_waitcnt lgkmcnt(8)
ds_read_b64_tr_b16 a[196:197], v221 offset:16384
ds_read_b64_tr_b16 a[198:199], v221 offset:20480
v_mfma_f32_16x16x32_bf16 v[144:147], a[200:203], a[40:43], v[144:147]
s_add_u32 m0, s3, 151552
v_mfma_f32_16x16x32_bf16 v[176:179], a[200:203], a[44:47], v[176:179]
s_add_u32 s48, s42, 239616
ds_read_b64_tr_b16 a[200:201], v222 offset:16384
ds_read_b64_tr_b16 a[202:203], v222 offset:20480
v_mfma_f32_16x16x32_bf16 v[148:151], a[204:207], a[40:43], v[148:151]
buffer_load_dwordx4 v236, s[16:19], s48 offen lds
v_mfma_f32_16x16x32_bf16 v[180:183], a[204:207], a[44:47], v[180:183]
ds_read_b64_tr_b16 a[204:205], v223 offset:16384
ds_read_b64_tr_b16 a[206:207], v223 offset:20480
v_mfma_f32_16x16x32_bf16 v[152:155], a[208:211], a[40:43], v[152:155]
s_add_u32 m0, s3, 155648
v_mfma_f32_16x16x32_bf16 v[184:187], a[208:211], a[44:47], v[184:187]
s_waitcnt lgkmcnt(8)
s_add_u32 s48, s42, 258048
ds_read_b64_tr_b16 a[208:209], v224 offset:16384
ds_read_b64_tr_b16 a[210:211], v224 offset:20480
v_mfma_f32_16x16x32_bf16 v[156:159], a[212:215], a[40:43], v[156:159]
buffer_load_dwordx4 v236, s[16:19], s48 offen lds
v_mfma_f32_16x16x32_bf16 v[188:191], a[212:215], a[44:47], v[188:191]
ds_read_b64_tr_b16 a[212:213], v225 offset:16384
ds_read_b64_tr_b16 a[214:215], v225 offset:20480
v_mfma_f32_16x16x32_bf16 v[160:163], a[216:219], a[40:43], v[160:163]
s_add_u32 m0, s3, 159744
v_mfma_f32_16x16x32_bf16 v[192:195], a[216:219], a[44:47], v[192:195]
s_add_u32 s48, s42, 276480
ds_read_b64_tr_b16 a[216:217], v226 offset:16384
ds_read_b64_tr_b16 a[218:219], v226 offset:20480
v_mfma_f32_16x16x32_bf16 v[164:167], a[220:223], a[40:43], v[164:167]
buffer_load_dwordx4 v236, s[16:19], s48 offen lds
v_mfma_f32_16x16x32_bf16 v[196:199], a[220:223], a[44:47], v[196:199]
s_waitcnt lgkmcnt(8)
ds_read_b64_tr_b16 a[220:221], v227 offset:16384
ds_read_b64_tr_b16 a[222:223], v227 offset:20480
s_waitcnt vmcnt(12)
v_cmp_ne_u32 vcc, 1, v246
s_and_b32 s46, vcc_lo, 170
s_cbranch_scc0 K_F1_OK
K_F1:
s_sleep 1
s_add_u32 s100, s100, 1
s_bitcmp1_b32 s100, 19
s_cbranch_scc1 K_END
buffer_load_dword v246, v6, s[20:23], s54 offen sc0 sc1
s_waitcnt vmcnt(0)
v_cmp_ne_u32 vcc, 1, v246
s_and_b32 s46, vcc_lo, 170
s_cbranch_scc1 K_F1
K_F1_OK:
v_mfma_f32_16x16x32_bf16 v[136:139], a[192:195], a[48:51], v[136:139]
v_mfma_f32_16x16x32_bf16 v[168:171], a[192:195], a[52:55], v[168:171]
s_add_u32 s94, s90, 8192
ds_read_b64_tr_b16 a[192:193], v220 offset:24576
ds_read_b64_tr_b16 a[194:195], v220 offset:28672
v_mfma_f32_16x16x32_bf16 v[140:143], a[196:199], a[48:51], v[140:143]
buffer_load_dwordx4 a[96:99], v234, s[20:23], s94 offen offset:0 sc0 sc1
v_mfma_f32_16x16x32_bf16 v[172:175], a[196:199], a[52:55], v[172:175]
ds_read_b64_tr_b16 a[196:197], v221 offset:24576
ds_read_b64_tr_b16 a[198:199], v221 offset:28672
v_mfma_f32_16x16x32_bf16 v[144:147], a[200:203], a[48:51], v[144:147]
s_add_u32 s94, s90, 8192
v_mfma_f32_16x16x32_bf16 v[176:179], a[200:203], a[52:55], v[176:179]
s_waitcnt lgkmcnt(8)
buffer_load_dwordx4 a[100:103], v234, s[20:23], s94 offen offset:1024 sc0 sc1
v_mfma_f32_16x16x32_bf16 v[148:151], a[204:207], a[48:51], v[148:151]
ds_read_b64_tr_b16 a[200:201], v222 offset:24576
ds_read_b64_tr_b16 a[202:203], v222 offset:28672
v_mfma_f32_16x16x32_bf16 v[180:183], a[204:207], a[52:55], v[180:183]
ds_read_b64_tr_b16 a[204:205], v223 offset:24576
ds_read_b64_tr_b16 a[206:207], v223 offset:28672
v_mfma_f32_16x16x32_bf16 v[152:155], a[208:211], a[48:51], v[152:155]
s_add_u32 s94, s90, 8192
v_mfma_f32_16x16x32_bf16 v[184:187], a[208:211], a[52:55], v[184:187]
buffer_load_dwordx4 a[104:107], v234, s[20:23], s94 offen offset:2048 sc0 sc1
v_mfma_f32_16x16x32_bf16 v[156:159], a[212:215], a[48:51], v[156:159]
s_waitcnt lgkmcnt(8)
ds_read_b64_tr_b16 a[208:209], v224 offset:24576
ds_read_b64_tr_b16 a[210:211], v224 offset:28672
v_mfma_f32_16x16x32_bf16 v[188:191], a[212:215], a[52:55], v[188:191]
s_add_u32 s94, s90, 8192
ds_read_b64_tr_b16 a[212:213], v225 offset:24576
ds_read_b64_tr_b16 a[214:215], v225 offset:28672
v_mfma_f32_16x16x32_bf16 v[160:163], a[216:219], a[48:51], v[160:163]
buffer_load_dwordx4 a[108:111], v234, s[20:23], s94 offen offset:3072 sc0 sc1
v_mfma_f32_16x16x32_bf16 v[192:195], a[216:219], a[52:55], v[192:195]
ds_read_b64_tr_b16 a[216:217], v226 offset:24576
ds_read_b64_tr_b16 a[218:219], v226 offset:28672
v_mfma_f32_16x16x32_bf16 v[164:167], a[220:223], a[48:51], v[164:167]
v_mfma_f32_16x16x32_bf16 v[196:199], a[220:223], a[52:55], v[196:199]
s_waitcnt lgkmcnt(10)
ds_read_b64_tr_b16 a[220:221], v227 offset:24576
ds_read_b64_tr_b16 a[222:223], v227 offset:28672
v_mfma_f32_16x16x32_bf16 v[136:139], a[192:195], a[56:59], v[136:139]
v_mfma_f32_16x16x32_bf16 v[168:171], a[192:195], a[60:63], v[168:171]
v_mfma_f32_16x16x32_bf16 v[140:143], a[196:199], a[56:59], v[140:143]
v_mfma_f32_16x16x32_bf16 v[172:175], a[196:199], a[60:63], v[172:175]
s_waitcnt lgkmcnt(8)
v_mfma_f32_16x16x32_bf16 v[144:147], a[200:203], a[56:59], v[144:147]
s_waitcnt vmcnt(21) lgkmcnt(0)
s_barrier
v_mfma_f32_16x16x32_bf16 v[176:179], a[200:203], a[60:63], v[176:179]
ds_read_b64_tr_b16 a[192:193], v220 offset:32768
ds_read_b64_tr_b16 a[194:195], v220 offset:36864
v_mfma_f32_16x16x32_bf16 v[148:151], a[204:207], a[56:59], v[148:151]
s_add_u32 s94, s90, 12288
ds_read_b64_tr_b16 a[196:197], v221 offset:32768
ds_read_b64_tr_b16 a[198:199], v221 offset:36864
v_mfma_f32_16x16x32_bf16 v[180:183], a[204:207], a[60:63], v[180:183]
buffer_load_dwordx4 a[112:115], v234, s[20:23], s94 offen offset:0 sc0 sc1
v_mfma_f32_16x16x32_bf16 v[152:155], a[208:211], a[56:59], v[152:155]
ds_read_b64_tr_b16 a[200:201], v222 offset:32768
ds_read_b64_tr_b16 a[202:203], v222 offset:36864
v_mfma_f32_16x16x32_bf16 v[184:187], a[208:211], a[60:63], v[184:187]
s_add_u32 s94, s90, 12288
ds_read_b64_tr_b16 a[204:205], v223 offset:32768
ds_read_b64_tr_b16 a[206:207], v223 offset:36864
v_mfma_f32_16x16x32_bf16 v[156:159], a[212:215], a[56:59], v[156:159]
buffer_load_dwordx4 a[116:119], v234, s[20:23], s94 offen offset:1024 sc0 sc1
v_mfma_f32_16x16x32_bf16 v[188:191], a[212:215], a[60:63], v[188:191]
ds_read_b64_tr_b16 a[208:209], v224 offset:32768
ds_read_b64_tr_b16 a[210:211], v224 offset:36864
v_mfma_f32_16x16x32_bf16 v[160:163], a[216:219], a[56:59], v[160:163]
ds_read_b64_tr_b16 a[212:213], v225 offset:32768
ds_read_b64_tr_b16 a[214:215], v225 offset:36864
v_mfma_f32_16x16x32_bf16 v[192:195], a[216:219], a[60:63], v[192:195]
s_add_u32 s94, s90, 12288
ds_read_b64_tr_b16 a[216:217], v226 offset:32768
ds_read_b64_tr_b16 a[218:219], v226 offset:36864
v_mfma_f32_16x16x32_bf16 v[164:167], a[220:223], a[56:59], v[164:167]
buffer_load_dwordx4 a[120:123], v234, s[20:23], s94 offen offset:2048 sc0 sc1
v_mfma_f32_16x16x32_bf16 v[196:199], a[220:223], a[60:63], v[196:199]
s_waitcnt lgkmcnt(12)
ds_read_b64_tr_b16 a[220:221], v227 offset:32768
ds_read_b64_tr_b16 a[222:223], v227 offset:36864
s_waitcnt vmcnt(15)
v_mfma_f32_16x16x32_bf16 v[136:139], a[192:195], a[64:67], v[136:139]
s_add_u32 s94, s90, 12288
v_mfma_f32_16x16x32_bf16 v[168:171], a[192:195], a[68:71], v[168:171]
s_waitcnt lgkmcnt(12)
buffer_load_dwordx4 a[124:127], v234, s[20:23], s94 offen offset:3072 sc0 sc1
v_mfma_f32_16x16x32_bf16 v[140:143], a[196:199], a[64:67], v[140:143]
s_waitcnt lgkmcnt(10)
ds_read_b64_tr_b16 a[192:193], v220 offset:40960
ds_read_b64_tr_b16 a[194:195], v220 offset:45056
v_mfma_f32_16x16x32_bf16 v[172:175], a[196:199], a[68:71], v[172:175]
s_add_u32 m0, s3, 0
ds_read_b64_tr_b16 a[196:197], v221 offset:40960
ds_read_b64_tr_b16 a[198:199], v221 offset:45056
v_mfma_f32_16x16x32_bf16 v[144:147], a[200:203], a[64:67], v[144:147]
s_add_u32 s48, s43, 147456
v_mfma_f32_16x16x32_bf16 v[176:179], a[200:203], a[68:71], v[176:179]
s_waitcnt lgkmcnt(10)
buffer_load_dwordx4 v236, s[16:19], s48 offen lds
v_mfma_f32_16x16x32_bf16 v[148:151], a[204:207], a[64:67], v[148:151]
s_add_u32 m0, s3, 4096
ds_read_b64_tr_b16 a[200:201], v222 offset:40960
ds_read_b64_tr_b16 a[202:203], v222 offset:45056
v_mfma_f32_16x16x32_bf16 v[180:183], a[204:207], a[68:71], v[180:183]
s_add_u32 s48, s43, 165888
ds_read_b64_tr_b16 a[204:205], v223 offset:40960
ds_read_b64_tr_b16 a[206:207], v223 offset:45056
v_mfma_f32_16x16x32_bf16 v[152:155], a[208:211], a[64:67], v[152:155]
s_waitcnt lgkmcnt(10)
buffer_load_dwordx4 v236, s[16:19], s48 offen lds
v_mfma_f32_16x16x32_bf16 v[184:187], a[208:211], a[68:71], v[184:187]
s_add_u32 m0, s3, 8192
ds_read_b64_tr_b16 a[208:209], v224 offset:40960
ds_read_b64_tr_b16 a[210:211], v224 offset:45056
v_mfma_f32_16x16x32_bf16 v[156:159], a[212:215], a[64:67], v[156:159]
s_add_u32 s48, s43, 184320
v_mfma_f32_16x16x32_bf16 v[188:191], a[212:215], a[68:71], v[188:191]
buffer_load_dwordx4 v236, s[16:19], s48 offen lds
v_mfma_f32_16x16x32_bf16 v[160:163], a[216:219], a[64:67], v[160:163]
ds_read_b64_tr_b16 a[212:213], v225 offset:40960
ds_read_b64_tr_b16 a[214:215], v225 offset:45056
v_mfma_f32_16x16x32_bf16 v[192:195], a[216:219], a[68:71], v[192:195]
s_waitcnt lgkmcnt(8)
ds_read_b64_tr_b16 a[216:217], v226 offset:40960
ds_read_b64_tr_b16 a[218:219], v226 offset:45056
v_mfma_f32_16x16x32_bf16 v[164:167], a[220:223], a[64:67], v[164:167]
v_mfma_f32_16x16x32_bf16 v[196:199], a[220:223], a[68:71], v[196:199]
ds_read_b64_tr_b16 a[220:221], v227 offset:40960
ds_read_b64_tr_b16 a[222:223], v227 offset:45056
v_mfma_f32_16x16x32_bf16 v[136:139], a[192:195], a[72:75], v[136:139]
s_add_u32 m0, s3, 12288
v_mfma_f32_16x16x32_bf16 v[168:171], a[192:195], a[76:79], v[168:171]
s_add_u32 s48, s43, 202752
ds_read_b64_tr_b16 a[192:193], v220 offset:49152
ds_read_b64_tr_b16 a[194:195], v220 offset:53248
v_mfma_f32_16x16x32_bf16 v[140:143], a[196:199], a[72:75], v[140:143]
s_waitcnt lgkmcnt(10)
buffer_load_dwordx4 v236, s[16:19], s48 offen lds
v_mfma_f32_16x16x32_bf16 v[172:175], a[196:199], a[76:79], v[172:175]
s_add_u32 m0, s3, 16384
ds_read_b64_tr_b16 a[196:197], v221 offset:49152
ds_read_b64_tr_b16 a[198:199], v221 offset:53248
v_mfma_f32_16x16x32_bf16 v[144:147], a[200:203], a[72:75], v[144:147]
s_add_u32 s48, s43, 221184
v_mfma_f32_16x16x32_bf16 v[176:179], a[200:203], a[76:79], v[176:179]
buffer_load_dwordx4 v236, s[16:19], s48 offen lds
v_mfma_f32_16x16x32_bf16 v[148:151], a[204:207], a[72:75], v[148:151]
s_add_u32 m0, s3, 20480
ds_read_b64_tr_b16 a[200:201], v222 offset:49152
ds_read_b64_tr_b16 a[202:203], v222 offset:53248
v_mfma_f32_16x16x32_bf16 v[180:183], a[204:207], a[76:79], v[180:183]
s_waitcnt lgkmcnt(8)
s_add_u32 s48, s43, 239616
ds_read_b64_tr_b16 a[204:205], v223 offset:49152
ds_read_b64_tr_b16 a[206:207], v223 offset:53248
v_mfma_f32_16x16x32_bf16 v[152:155], a[208:211], a[72:75], v[152:155]
buffer_load_dwordx4 v236, s[16:19], s48 offen lds
v_mfma_f32_16x16x32_bf16 v[184:187], a[208:211], a[76:79], v[184:187]
ds_read_b64_tr_b16 a[208:209], v224 offset:49152
ds_read_b64_tr_b16 a[210:211], v224 offset:53248
v_mfma_f32_16x16x32_bf16 v[156:159], a[212:215], a[72:75], v[156:159]
s_add_u32 m0, s3, 24576
v_mfma_f32_16x16x32_bf16 v[188:191], a[212:215], a[76:79], v[188:191]
s_add_u32 s48, s43, 258048
ds_read_b64_tr_b16 a[212:213], v225 offset:49152
ds_read_b64_tr_b16 a[214:215], v225 offset:53248
v_mfma_f32_16x16x32_bf16 v[160:163], a[216:219], a[72:75], v[160:163]
buffer_load_dwordx4 v236, s[16:19], s48 offen lds
v_mfma_f32_16x16x32_bf16 v[192:195], a[216:219], a[76:79], v[192:195]
s_waitcnt lgkmcnt(8)
ds_read_b64_tr_b16 a[216:217], v226 offset:49152
ds_read_b64_tr_b16 a[218:219], v226 offset:53248
v_mfma_f32_16x16x32_bf16 v[164:167], a[220:223], a[72:75], v[164:167]
v_mfma_f32_16x16x32_bf16 v[196:199], a[220:223], a[76:79], v[196:199]
ds_read_b64_tr_b16 a[220:221], v227 offset:49152
ds_read_b64_tr_b16 a[222:223], v227 offset:53248
v_mfma_f32_16x16x32_bf16 v[136:139], a[192:195], a[80:83], v[136:139]
s_add_u32 m0, s3, 28672
v_mfma_f32_16x16x32_bf16 v[168:171], a[192:195], a[84:87], v[168:171]
s_add_u32 s48, s43, 276480
ds_read_b64_tr_b16 a[192:193], v220 offset:57344
ds_read_b64_tr_b16 a[194:195], v220 offset:61440
v_mfma_f32_16x16x32_bf16 v[140:143], a[196:199], a[80:83], v[140:143]
buffer_load_dwordx4 v236, s[16:19], s48 offen lds
v_mfma_f32_16x16x32_bf16 v[172:175], a[196:199], a[84:87], v[172:175]
s_waitcnt lgkmcnt(8)
ds_read_b64_tr_b16 a[196:197], v221 offset:57344
ds_read_b64_tr_b16 a[198:199], v221 offset:61440
v_mfma_f32_16x16x32_bf16 v[144:147], a[200:203], a[80:83], v[144:147]
s_add_u32 s94, s88, 0
v_mfma_f32_16x16x32_bf16 v[176:179], a[200:203], a[84:87], v[176:179]
buffer_store_dwordx2 v[72:73], v250, s[20:23], s94 offen sc0 sc1
v_mfma_f32_16x16x32_bf16 v[148:151], a[204:207], a[80:83], v[148:151]
ds_read_b64_tr_b16 a[200:201], v222 offset:57344
ds_read_b64_tr_b16 a[202:203], v222 offset:61440
v_mfma_f32_16x16x32_bf16 v[180:183], a[204:207], a[84:87], v[180:183]
ds_read_b64_tr_b16 a[204:205], v223 offset:57344
ds_read_b64_tr_b16 a[206:207], v223 offset:61440
v_mfma_f32_16x16x32_bf16 v[152:155], a[208:211], a[80:83], v[152:155]
s_waitcnt lgkmcnt(10)
v_mfma_f32_16x16x32_bf16 v[184:187], a[208:211], a[84:87], v[184:187]
s_add_u32 s94, s88, 8192
ds_read_b64_tr_b16 a[208:209], v224 offset:57344
ds_read_b64_tr_b16 a[210:211], v224 offset:61440
v_mfma_f32_16x16x32_bf16 v[156:159], a[212:215], a[80:83], v[156:159]
buffer_store_dwordx2 v[76:77], v250, s[20:23], s94 offen sc0 sc1
v_mfma_f32_16x16x32_bf16 v[188:191], a[212:215], a[84:87], v[188:191]
ds_read_b64_tr_b16 a[212:213], v225 offset:57344
ds_read_b64_tr_b16 a[214:215], v225 offset:61440
v_mfma_f32_16x16x32_bf16 v[160:163], a[216:219], a[80:83], v[160:163]
s_waitcnt lgkmcnt(10)
v_mfma_f32_16x16x32_bf16 v[192:195], a[216:219], a[84:87], v[192:195]
s_add_u32 s94, s88, 16384
ds_read_b64_tr_b16 a[216:217], v226 offset:57344
ds_read_b64_tr_b16 a[218:219], v226 offset:61440
v_mfma_f32_16x16x32_bf16 v[164:167], a[220:223], a[80:83], v[164:167]
buffer_store_dwordx2 v[80:81], v250, s[20:23], s94 offen sc0 sc1
v_mfma_f32_16x16x32_bf16 v[196:199], a[220:223], a[84:87], v[196:199]
ds_read_b64_tr_b16 a[220:221], v227 offset:57344
ds_read_b64_tr_b16 a[222:223], v227 offset:61440
v_mfma_f32_16x16x32_bf16 v[136:139], a[192:195], a[88:91], v[136:139]
v_mfma_f32_16x16x32_bf16 v[168:171], a[192:195], a[92:95], v[168:171]
s_waitcnt lgkmcnt(8)
v_mfma_f32_16x16x32_bf16 v[140:143], a[196:199], a[88:91], v[140:143]
v_mfma_f32_16x16x32_bf16 v[172:175], a[196:199], a[92:95], v[172:175]
v_mfma_f32_16x16x32_bf16 v[144:147], a[200:203], a[88:91], v[144:147]
s_waitcnt vmcnt(19) lgkmcnt(0)
s_barrier
v_mfma_f32_16x16x32_bf16 v[176:179], a[200:203], a[92:95], v[176:179]
ds_read_b64_tr_b16 a[192:193], v208 offset:0
ds_read_b64_tr_b16 a[194:195], v208 offset:4096
v_mfma_f32_16x16x32_bf16 v[148:151], a[204:207], a[88:91], v[148:151]
s_add_u32 s94, s88, 24576
ds_read_b64_tr_b16 a[196:197], v209 offset:0
ds_read_b64_tr_b16 a[198:199], v209 offset:4096
v_mfma_f32_16x16x32_bf16 v[180:183], a[204:207], a[92:95], v[180:183]
buffer_store_dwordx2 v[84:85], v250, s[20:23], s94 offen sc0 sc1
v_mfma_f32_16x16x32_bf16 v[152:155], a[208:211], a[88:91], v[152:155]
ds_read_b64_tr_b16 a[200:201], v210 offset:0
ds_read_b64_tr_b16 a[202:203], v210 offset:4096
v_mfma_f32_16x16x32_bf16 v[184:187], a[208:211], a[92:95], v[184:187]
ds_read_b64_tr_b16 a[204:205], v211 offset:0
ds_read_b64_tr_b16 a[206:207], v211 offset:4096
v_mfma_f32_16x16x32_bf16 v[156:159], a[212:215], a[88:91], v[156:159]
s_add_u32 s94, s89, 0
ds_read_b64_tr_b16 a[208:209], v212 offset:0
ds_read_b64_tr_b16 a[210:211], v212 offset:4096
v_mfma_f32_16x16x32_bf16 v[188:191], a[212:215], a[92:95], v[188:191]
buffer_store_dwordx2 v[88:89], v250, s[20:23], s94 offen sc0 sc1
v_mfma_f32_16x16x32_bf16 v[160:163], a[216:219], a[88:91], v[160:163]
ds_read_b64_tr_b16 a[212:213], v213 offset:0
ds_read_b64_tr_b16 a[214:215], v213 offset:4096
v_mfma_f32_16x16x32_bf16 v[192:195], a[216:219], a[92:95], v[192:195]
ds_read_b64_tr_b16 a[216:217], v214 offset:0
ds_read_b64_tr_b16 a[218:219], v214 offset:4096
v_mfma_f32_16x16x32_bf16 v[164:167], a[220:223], a[88:91], v[164:167]
v_mfma_f32_16x16x32_bf16 v[196:199], a[220:223], a[92:95], v[196:199]
s_waitcnt lgkmcnt(12)
ds_read_b64_tr_b16 a[220:221], v215 offset:0
ds_read_b64_tr_b16 a[222:223], v215 offset:4096
s_waitcnt vmcnt(13)
v_mfma_f32_16x16x32_bf16 v[136:139], a[192:195], a[96:99], v[136:139]
s_add_u32 s94, s89, 8192
v_mfma_f32_16x16x32_bf16 v[168:171], a[192:195], a[100:103], v[168:171]
s_waitcnt lgkmcnt(12)
buffer_store_dwordx2 v[92:93], v250, s[20:23], s94 offen sc0 sc1
v_mfma_f32_16x16x32_bf16 v[140:143], a[196:199], a[96:99], v[140:143]
ds_read_b64_tr_b16 a[192:193], v208 offset:8192
ds_read_b64_tr_b16 a[194:195], v208 offset:12288
v_mfma_f32_16x16x32_bf16 v[172:175], a[196:199], a[100:103], v[172:175]
s_waitcnt lgkmcnt(10)
ds_read_b64_tr_b16 a[196:197], v209 offset:8192
ds_read_b64_tr_b16 a[198:199], v209 offset:12288
v_mfma_f32_16x16x32_bf16 v[144:147], a[200:203], a[96:99], v[144:147]
s_add_u32 s94, s89, 16384
v_mfma_f32_16x16x32_bf16 v[176:179], a[200:203], a[100:103], v[176:179]
buffer_store_dwordx2 v[96:97], v250, s[20:23], s94 offen sc0 sc1
v_mfma_f32_16x16x32_bf16 v[148:151], a[204:207], a[96:99], v[148:151]
ds_read_b64_tr_b16 a[200:201], v210 offset:8192
ds_read_b64_tr_b16 a[202:203], v210 offset:12288
v_mfma_f32_16x16x32_bf16 v[180:183], a[204:207], a[100:103], v[180:183]
s_waitcnt lgkmcnt(8)
ds_read_b64_tr_b16 a[204:205], v211 offset:8192
ds_read_b64_tr_b16 a[206:207], v211 offset:12288
v_mfma_f32_16x16x32_bf16 v[152:155], a[208:211], a[96:99], v[152:155]
s_add_u32 s94, s89, 24576
v_mfma_f32_16x16x32_bf16 v[184:187], a[208:211], a[100:103], v[184:187]
buffer_store_dwordx2 v[100:101], v250, s[20:23], s94 offen sc0 sc1
v_mfma_f32_16x16x32_bf16 v[156:159], a[212:215], a[96:99], v[156:159]
ds_read_b64_tr_b16 a[208:209], v212 offset:8192
ds_read_b64_tr_b16 a[210:211], v212 offset:12288
v_mfma_f32_16x16x32_bf16 v[188:191], a[212:215], a[100:103], v[188:191]
ds_read_b64_tr_b16 a[212:213], v213 offset:8192
ds_read_b64_tr_b16 a[214:215], v213 offset:12288
v_mfma_f32_16x16x32_bf16 v[160:163], a[216:219], a[96:99], v[160:163]
s_add_u32 s94, s91, 8192
v_mfma_f32_16x16x32_bf16 v[192:195], a[216:219], a[100:103], v[192:195]
s_waitcnt lgkmcnt(8)
buffer_load_dwordx4 a[128:131], v234, s[20:23], s94 offen offset:0 sc0 sc1
v_mfma_f32_16x16x32_bf16 v[164:167], a[220:223], a[96:99], v[164:167]
ds_read_b64_tr_b16 a[216:217], v214 offset:8192
ds_read_b64_tr_b16 a[218:219], v214 offset:12288
v_mfma_f32_16x16x32_bf16 v[196:199], a[220:223], a[100:103], v[196:199]
ds_read_b64_tr_b16 a[220:221], v215 offset:8192
ds_read_b64_tr_b16 a[222:223], v215 offset:12288
v_mfma_f32_16x16x32_bf16 v[136:139], a[192:195], a[104:107], v[136:139]
s_add_u32 s94, s91, 8192
v_mfma_f32_16x16x32_bf16 v[168:171], a[192:195], a[108:111], v[168:171]
buffer_load_dwordx4 a[132:135], v234, s[20:23], s94 offen offset:1024 sc0 sc1
v_mfma_f32_16x16x32_bf16 v[140:143], a[196:199], a[104:107], v[140:143]
s_waitcnt lgkmcnt(8)
ds_read_b64_tr_b16 a[192:193], v208 offset:16384
ds_read_b64_tr_b16 a[194:195], v208 offset:20480
v_mfma_f32_16x16x32_bf16 v[172:175], a[196:199], a[108:111], v[172:175]
s_add_u32 s94, s91, 8192
ds_read_b64_tr_b16 a[196:197], v209 offset:16384
ds_read_b64_tr_b16 a[198:199], v209 offset:20480
v_mfma_f32_16x16x32_bf16 v[144:147], a[200:203], a[104:107], v[144:147]
buffer_load_dwordx4 a[136:139], v234, s[20:23], s94 offen offset:2048 sc0 sc1
v_mfma_f32_16x16x32_bf16 v[176:179], a[200:203], a[108:111], v[176:179]
s_add_u32 s94, s91, 8192
ds_read_b64_tr_b16 a[200:201], v210 offset:16384
ds_read_b64_tr_b16 a[202:203], v210 offset:20480
v_mfma_f32_16x16x32_bf16 v[148:151], a[204:207], a[104:107], v[148:151]
s_waitcnt lgkmcnt(10)
buffer_load_dwordx4 a[140:143], v234, s[20:23], s94 offen offset:3072 sc0 sc1
v_mfma_f32_16x16x32_bf16 v[180:183], a[204:207], a[108:111], v[180:183]
s_add_u32 s94, s91, 12288
ds_read_b64_tr_b16 a[204:205], v211 offset:16384
ds_read_b64_tr_b16 a[206:207], v211 offset:20480
v_mfma_f32_16x16x32_bf16 v[152:155], a[208:211], a[104:107], v[152:155]
buffer_load_dwordx4 a[144:147], v234, s[20:23], s94 offen offset:0 sc0 sc1
v_mfma_f32_16x16x32_bf16 v[184:187], a[208:211], a[108:111], v[184:187]
ds_read_b64_tr_b16 a[208:209], v212 offset:16384
ds_read_b64_tr_b16 a[210:211], v212 offset:20480
v_mfma_f32_16x16x32_bf16 v[156:159], a[212:215], a[104:107], v[156:159]
s_add_u32 s94, s91, 12288
v_mfma_f32_16x16x32_bf16 v[188:191], a[212:215], a[108:111], v[188:191]
s_waitcnt lgkmcnt(10)
buffer_load_dwordx4 a[148:151], v234, s[20:23], s94 offen offset:1024 sc0 sc1
v_mfma_f32_16x16x32_bf16 v[160:163], a[216:219], a[104:107], v[160:163]
s_add_u32 s94, s91, 12288
ds_read_b64_tr_b16 a[212:213], v213 offset:16384
ds_read_b64_tr_b16 a[214:215], v213 offset:20480
v_mfma_f32_16x16x32_bf16 v[192:195], a[216:219], a[108:111], v[192:195]
buffer_load_dwordx4 a[152:155], v234, s[20:23], s94 offen offset:2048 sc0 sc1
v_mfma_f32_16x16x32_bf16 v[164:167], a[220:223], a[104:107], v[164:167]
ds_read_b64_tr_b16 a[216:217], v214 offset:16384
ds_read_b64_tr_b16 a[218:219], v214 offset:20480
v_mfma_f32_16x16x32_bf16 v[196:199], a[220:223], a[108:111], v[196:199]
s_waitcnt lgkmcnt(8)
ds_read_b64_tr_b16 a[220:221], v215 offset:16384
ds_read_b64_tr_b16 a[222:223], v215 offset:20480
v_mfma_f32_16x16x32_bf16 v[136:139], a[192:195], a[112:115], v[136:139]
s_add_u32 s94, s91, 12288
v_mfma_f32_16x16x32_bf16 v[168:171], a[192:195], a[116:119], v[168:171]
buffer_load_dwordx4 a[156:159], v234, s[20:23], s94 offen offset:3072 sc0 sc1
v_mfma_f32_16x16x32_bf16 v[140:143], a[196:199], a[112:115], v[140:143]
ds_read_b64_tr_b16 a[192:193], v208 offset:24576
ds_read_b64_tr_b16 a[194:195], v208 offset:28672
v_mfma_f32_16x16x32_bf16 v[172:175], a[196:199], a[116:119], v[172:175]
s_add_u32 m0, s3, 32768
ds_read_b64_tr_b16 a[196:197], v209 offset:24576
ds_read_b64_tr_b16 a[198:199], v209 offset:28672
v_mfma_f32_16x16x32_bf16 v[144:147], a[200:203], a[112:115], v[144:147]
s_add_u32 s48, s44, 147456
v_mfma_f32_16x16x32_bf16 v[176:179], a[200:203], a[116:119], v[176:179]
s_waitcnt lgkmcnt(10)
buffer_load_dwordx4 v236, s[16:19], s48 offen lds
v_mfma_f32_16x16x32_bf16 v[148:151], a[204:207], a[112:115], v[148:151]
ds_read_b64_tr_b16 a[200:201], v210 offset:24576
ds_read_b64_tr_b16 a[202:203], v210 offset:28672
v_mfma_f32_16x16x32_bf16 v[180:183], a[204:207], a[116:119], v[180:183]
s_add_u32 m0, s3, 36864
ds_read_b64_tr_b16 a[204:205], v211 offset:24576
ds_read_b64_tr_b16 a[206:207], v211 offset:28672
v_mfma_f32_16x16x32_bf16 v[152:155], a[208:211], a[112:115], v[152:155]
s_add_u32 s48, s44, 165888
v_mfma_f32_16x16x32_bf16 v[184:187], a[208:211], a[116:119], v[184:187]
s_waitcnt lgkmcnt(8)
buffer_load_dwordx4 v236, s[16:19], s48 offen lds
v_mfma_f32_16x16x32_bf16 v[156:159], a[212:215], a[112:115], v[156:159]
ds_read_b64_tr_b16 a[208:209], v212 offset:24576
ds_read_b64_tr_b16 a[210:211], v212 offset:28672
v_mfma_f32_16x16x32_bf16 v[188:191], a[212:215], a[116:119], v[188:191]
s_add_u32 m0, s3, 40960
ds_read_b64_tr_b16 a[212:213], v213 offset:24576
ds_read_b64_tr_b16 a[214:215], v213 offset:28672
v_mfma_f32_16x16x32_bf16 v[160:163], a[216:219], a[112:115], v[160:163]
s_add_u32 s48, s44, 184320
v_mfma_f32_16x16x32_bf16 v[192:195], a[216:219], a[116:119], v[192:195]
buffer_load_dwordx4 v236, s[16:19], s48 offen lds
v_mfma_f32_16x16x32_bf16 v[164:167], a[220:223], a[112:115], v[164:167]
ds_read_b64_tr_b16 a[216:217], v214 offset:24576
ds_read_b64_tr_b16 a[218:219], v214 offset:28672
v_mfma_f32_16x16x32_bf16 v[196:199], a[220:223], a[116:119], v[196:199]
s_waitcnt lgkmcnt(10)
ds_read_b64_tr_b16 a[220:221], v215 offset:24576
ds_read_b64_tr_b16 a[222:223], v215 offset:28672
v_mfma_f32_16x16x32_bf16 v[136:139], a[192:195], a[120:123], v[136:139]
v_mfma_f32_16x16x32_bf16 v[168:171], a[192:195], a[124:127], v[168:171]
v_mfma_f32_16x16x32_bf16 v[140:143], a[196:199], a[120:123], v[140:143]
v_mfma_f32_16x16x32_bf16 v[172:175], a[196:199], a[124:127], v[172:175]
s_waitcnt lgkmcnt(8)
v_mfma_f32_16x16x32_bf16 v[144:147], a[200:203], a[120:123], v[144:147]
s_waitcnt vmcnt(19) lgkmcnt(0)
s_barrier
v_mfma_f32_16x16x32_bf16 v[176:179], a[200:203], a[124:127], v[176:179]
s_add_u32 m0, s3, 45056
ds_read_b64_tr_b16 a[192:193], v200 offset:0
ds_read_b64_tr_b16 a[194:195], v200 offset:4096
v_mfma_f32_16x16x32_bf16 v[148:151], a[204:207], a[120:123], v[148:151]
s_add_u32 s48, s44, 202752
ds_read_b64_tr_b16 a[196:197], v201 offset:0
ds_read_b64_tr_b16 a[198:199], v201 offset:4096
v_mfma_f32_16x16x32_bf16 v[180:183], a[204:207], a[124:127], v[180:183]
buffer_load_dwordx4 v236, s[16:19], s48 offen lds
v_mfma_f32_16x16x32_bf16 v[152:155], a[208:211], a[120:123], v[152:155]
s_add_u32 m0, s3, 49152
ds_read_b64_tr_b16 a[200:201], v202 offset:0
ds_read_b64_tr_b16 a[202:203], v202 offset:4096
v_mfma_f32_16x16x32_bf16 v[184:187], a[208:211], a[124:127], v[184:187]
s_add_u32 s48, s44, 221184
ds_read_b64_tr_b16 a[204:205], v203 offset:0
ds_read_b64_tr_b16 a[206:207], v203 offset:4096
v_mfma_f32_16x16x32_bf16 v[156:159], a[212:215], a[120:123], v[156:159]
buffer_load_dwordx4 v236, s[16:19], s48 offen lds
v_mfma_f32_16x16x32_bf16 v[188:191], a[212:215], a[124:127], v[188:191]
ds_read_b64_tr_b16 a[208:209], v204 offset:0
ds_read_b64_tr_b16 a[210:211], v204 offset:4096
v_mfma_f32_16x16x32_bf16 v[160:163], a[216:219], a[120:123], v[160:163]
s_add_u32 m0, s3, 53248
ds_read_b64_tr_b16 a[212:213], v205 offset:0
ds_read_b64_tr_b16 a[214:215], v205 offset:4096
v_mfma_f32_16x16x32_bf16 v[192:195], a[216:219], a[124:127], v[192:195]
s_add_u32 s48, s44, 239616
ds_read_b64_tr_b16 a[216:217], v206 offset:0
ds_read_b64_tr_b16 a[218:219], v206 offset:4096
v_mfma_f32_16x16x32_bf16 v[164:167], a[220:223], a[120:123], v[164:167]
buffer_load_dwordx4 v236, s[16:19], s48 offen lds
v_mfma_f32_16x16x32_bf16 v[196:199], a[220:223], a[124:127], v[196:199]
s_waitcnt lgkmcnt(12)
ds_read_b64_tr_b16 a[220:221], v207 offset:0
ds_read_b64_tr_b16 a[222:223], v207 offset:4096
s_waitcnt vmcnt(6)
s_waitcnt vmcnt(14)
s_lshl_b32 s46, s33, 2
s_add_u32 s46, s46, s86
s_mov_b64 exec, 1
buffer_store_dword v5, v234, s[20:23], s46 offen sc0 sc1
s_mov_b64 exec, -1
v_mfma_f32_16x16x32_bf16 v[136:139], a[192:195], a[128:131], v[136:139]
s_add_u32 m0, s3, 57344
v_mfma_f32_16x16x32_bf16 v[168:171], a[192:195], a[132:135], v[168:171]
s_waitcnt lgkmcnt(12)
s_add_u32 s48, s44, 258048
ds_read_b64_tr_b16 a[192:193], v200 offset:8192
ds_read_b64_tr_b16 a[194:195], v200 offset:12288
v_mfma_f32_16x16x32_bf16 v[140:143], a[196:199], a[128:131], v[140:143]
s_waitcnt lgkmcnt(12)
buffer_load_dwordx4 v236, s[16:19], s48 offen lds
v_mfma_f32_16x16x32_bf16 v[172:175], a[196:199], a[132:135], v[172:175]
s_add_u32 m0, s3, 61440
ds_read_b64_tr_b16 a[196:197], v201 offset:8192
ds_read_b64_tr_b16 a[198:199], v201 offset:12288
v_mfma_f32_16x16x32_bf16 v[144:147], a[200:203], a[128:131], v[144:147]
s_add_u32 s48, s44, 276480
v_mfma_f32_16x16x32_bf16 v[176:179], a[200:203], a[132:135], v[176:179]
s_waitcnt lgkmcnt(10)
buffer_load_dwordx4 v236, s[16:19], s48 offen lds
v_mfma_f32_16x16x32_bf16 v[148:151], a[204:207], a[128:131], v[148:151]
ds_read_b64_tr_b16 a[200:201], v202 offset:8192
ds_read_b64_tr_b16 a[202:203], v202 offset:12288
v_mfma_f32_16x16x32_bf16 v[180:183], a[204:207], a[132:135], v[180:183]
s_add_u32 s94, s92, 8192
ds_read_b64_tr_b16 a[204:205], v203 offset:8192
ds_read_b64_tr_b16 a[206:207], v203 offset:12288
v_mfma_f32_16x16x32_bf16 v[152:155], a[208:211], a[128:131], v[152:155]
buffer_load_dwordx4 a[160:163], v234, s[20:23], s94 offen offset:0 sc0 sc1
v_mfma_f32_16x16x32_bf16 v[184:187], a[208:211], a[132:135], v[184:187]
s_waitcnt lgkmcnt(8)
ds_read_b64_tr_b16 a[208:209], v204 offset:8192
ds_read_b64_tr_b16 a[210:211], v204 offset:12288
v_mfma_f32_16x16x32_bf16 v[156:159], a[212:215], a[128:131], v[156:159]
s_add_u32 s94, s92, 8192
v_mfma_f32_16x16x32_bf16 v[188:191], a[212:215], a[132:135], v[188:191]
buffer_load_dwordx4 a[164:167], v234, s[20:23], s94 offen offset:1024 sc0 sc1
v_mfma_f32_16x16x32_bf16 v[160:163], a[216:219], a[128:131], v[160:163]
ds_read_b64_tr_b16 a[212:213], v205 offset:8192
ds_read_b64_tr_b16 a[214:215], v205 offset:12288
v_mfma_f32_16x16x32_bf16 v[192:195], a[216:219], a[132:135], v[192:195]
ds_read_b64_tr_b16 a[216:217], v206 offset:8192
ds_read_b64_tr_b16 a[218:219], v206 offset:12288
v_mfma_f32_16x16x32_bf16 v[164:167], a[220:223], a[128:131], v[164:167]
v_mfma_f32_16x16x32_bf16 v[196:199], a[220:223], a[132:135], v[196:199]
s_waitcnt lgkmcnt(10)
ds_read_b64_tr_b16 a[220:221], v207 offset:8192
ds_read_b64_tr_b16 a[222:223], v207 offset:12288
v_mfma_f32_16x16x32_bf16 v[136:139], a[192:195], a[136:139], v[136:139]
s_add_u32 s94, s92, 8192
v_mfma_f32_16x16x32_bf16 v[168:171], a[192:195], a[140:143], v[168:171]
buffer_load_dwordx4 a[168:171], v234, s[20:23], s94 offen offset:2048 sc0 sc1
v_mfma_f32_16x16x32_bf16 v[140:143], a[196:199], a[136:139], v[140:143]
s_add_u32 s94, s92, 8192
ds_read_b64_tr_b16 a[192:193], v200 offset:16384
ds_read_b64_tr_b16 a[194:195], v200 offset:20480
v_mfma_f32_16x16x32_bf16 v[172:175], a[196:199], a[140:143], v[172:175]
s_waitcnt lgkmcnt(8)
buffer_load_dwordx4 a[172:175], v234, s[20:23], s94 offen offset:3072 sc0 sc1
v_mfma_f32_16x16x32_bf16 v[144:147], a[200:203], a[136:139], v[144:147]
ds_read_b64_tr_b16 a[196:197], v201 offset:16384
ds_read_b64_tr_b16 a[198:199], v201 offset:20480
v_mfma_f32_16x16x32_bf16 v[176:179], a[200:203], a[140:143], v[176:179]
s_add_u32 s94, s92, 12288
ds_read_b64_tr_b16 a[200:201], v202 offset:16384
ds_read_b64_tr_b16 a[202:203], v202 offset:20480
v_mfma_f32_16x16x32_bf16 v[148:151], a[204:207], a[136:139], v[148:151]
buffer_load_dwordx4 a[176:179], v234, s[20:23], s94 offen offset:0 sc0 sc1
v_mfma_f32_16x16x32_bf16 v[180:183], a[204:207], a[140:143], v[180:183]
ds_read_b64_tr_b16 a[204:205], v203 offset:16384
ds_read_b64_tr_b16 a[206:207], v203 offset:20480
v_mfma_f32_16x16x32_bf16 v[152:155], a[208:211], a[136:139], v[152:155]
s_add_u32 s94, s92, 12288
v_mfma_f32_16x16x32_bf16 v[184:187], a[208:211], a[140:143], v[184:187]
s_waitcnt lgkmcnt(8)
buffer_load_dwordx4 a[180:183], v234, s[20:23], s94 offen offset:1024 sc0 sc1
v_mfma_f32_16x16x32_bf16 v[156:159], a[212:215], a[136:139], v[156:159]
ds_read_b64_tr_b16 a[208:209], v204 offset:16384
ds_read_b64_tr_b16 a[210:211], v204 offset:20480
v_mfma_f32_16x16x32_bf16 v[188:191], a[212:215], a[140:143], v[188:191]
s_add_u32 s94, s92, 12288
ds_read_b64_tr_b16 a[212:213], v205 offset:16384
ds_read_b64_tr_b16 a[214:215], v205 offset:20480
v_mfma_f32_16x16x32_bf16 v[160:163], a[216:219], a[136:139], v[160:163]
buffer_load_dwordx4 a[184:187], v234, s[20:23], s94 offen offset:2048 sc0 sc1
v_mfma_f32_16x16x32_bf16 v[192:195], a[216:219], a[140:143], v[192:195]
ds_read_b64_tr_b16 a[216:217], v206 offset:16384
ds_read_b64_tr_b16 a[218:219], v206 offset:20480
v_mfma_f32_16x16x32_bf16 v[164:167], a[220:223], a[136:139], v[164:167]
v_mfma_f32_16x16x32_bf16 v[196:199], a[220:223], a[140:143], v[196:199]
s_waitcnt lgkmcnt(8)
ds_read_b64_tr_b16 a[220:221], v207 offset:16384
ds_read_b64_tr_b16 a[222:223], v207 offset:20480
v_mfma_f32_16x16x32_bf16 v[136:139], a[192:195], a[144:147], v[136:139]
s_add_u32 s94, s92, 12288
v_mfma_f32_16x16x32_bf16 v[168:171], a[192:195], a[148:151], v[168:171]
buffer_load_dwordx4 a[188:191], v234, s[20:23], s94 offen offset:3072 sc0 sc1
v_mfma_f32_16x16x32_bf16 v[140:143], a[196:199], a[144:147], v[140:143]
ds_read_b64_tr_b16 a[192:193], v200 offset:24576
ds_read_b64_tr_b16 a[194:195], v200 offset:28672
v_mfma_f32_16x16x32_bf16 v[172:175], a[196:199], a[148:151], v[172:175]
ds_read_b64_tr_b16 a[196:197], v201 offset:24576
ds_read_b64_tr_b16 a[198:199], v201 offset:28672
v_mfma_f32_16x16x32_bf16 v[144:147], a[200:203], a[144:147], v[144:147]
v_mfma_f32_16x16x32_bf16 v[176:179], a[200:203], a[148:151], v[176:179]
s_waitcnt lgkmcnt(8)
ds_read_b64_tr_b16 a[200:201], v202 offset:24576
ds_read_b64_tr_b16 a[202:203], v202 offset:28672
v_mfma_f32_16x16x32_bf16 v[148:151], a[204:207], a[144:147], v[148:151]
v_mfma_f32_16x16x32_bf16 v[180:183], a[204:207], a[148:151], v[180:183]
ds_read_b64_tr_b16 a[204:205], v203 offset:24576
ds_read_b64_tr_b16 a[206:207], v203 offset:28672
v_mfma_f32_16x16x32_bf16 v[152:155], a[208:211], a[144:147], v[152:155]
v_mfma_f32_16x16x32_bf16 v[184:187], a[208:211], a[148:151], v[184:187]
ds_read_b64_tr_b16 a[208:209], v204 offset:24576
ds_read_b64_tr_b16 a[210:211], v204 offset:28672
v_mfma_f32_16x16x32_bf16 v[156:159], a[212:215], a[144:147], v[156:159]
v_mfma_f32_16x16x32_bf16 v[188:191], a[212:215], a[148:151], v[188:191]
s_waitcnt lgkmcnt(10)
ds_read_b64_tr_b16 a[212:213], v205 offset:24576
ds_read_b64_tr_b16 a[214:215], v205 offset:28672
v_mfma_f32_16x16x32_bf16 v[160:163], a[216:219], a[144:147], v[160:163]
v_mfma_f32_16x16x32_bf16 v[192:195], a[216:219], a[148:151], v[192:195]
ds_read_b64_tr_b16 a[216:217], v206 offset:24576
ds_read_b64_tr_b16 a[218:219], v206 offset:28672
v_mfma_f32_16x16x32_bf16 v[164:167], a[220:223], a[144:147], v[164:167]
v_mfma_f32_16x16x32_bf16 v[196:199], a[220:223], a[148:151], v[196:199]
s_waitcnt lgkmcnt(8)
ds_read_b64_tr_b16 a[220:221], v207 offset:24576
ds_read_b64_tr_b16 a[222:223], v207 offset:28672
v_mfma_f32_16x16x32_bf16 v[136:139], a[192:195], a[152:155], v[136:139]
v_mfma_f32_16x16x32_bf16 v[168:171], a[192:195], a[156:159], v[168:171]
v_mfma_f32_16x16x32_bf16 v[140:143], a[196:199], a[152:155], v[140:143]
v_mfma_f32_16x16x32_bf16 v[172:175], a[196:199], a[156:159], v[172:175]
v_mfma_f32_16x16x32_bf16 v[144:147], a[200:203], a[152:155], v[144:147]
s_waitcnt vmcnt(8) lgkmcnt(0)
s_barrier
v_mfma_f32_16x16x32_bf16 v[176:179], a[200:203], a[156:159], v[176:179]
ds_read_b64_tr_b16 a[192:193], v200 offset:32768
ds_read_b64_tr_b16 a[194:195], v200 offset:36864
v_mfma_f32_16x16x32_bf16 v[148:151], a[204:207], a[152:155], v[148:151]
ds_read_b64_tr_b16 a[196:197], v201 offset:32768
ds_read_b64_tr_b16 a[198:199], v201 offset:36864
v_mfma_f32_16x16x32_bf16 v[180:183], a[204:207], a[156:159], v[180:183]
ds_read_b64_tr_b16 a[200:201], v202 offset:32768
ds_read_b64_tr_b16 a[202:203], v202 offset:36864
v_mfma_f32_16x16x32_bf16 v[152:155], a[208:211], a[152:155], v[152:155]
ds_read_b64_tr_b16 a[204:205], v203 offset:32768
ds_read_b64_tr_b16 a[206:207], v203 offset:36864
v_mfma_f32_16x16x32_bf16 v[184:187], a[208:211], a[156:159], v[184:187]
ds_read_b64_tr_b16 a[208:209], v204 offset:32768
ds_read_b64_tr_b16 a[210:211], v204 offset:36864
v_mfma_f32_16x16x32_bf16 v[156:159], a[212:215], a[152:155], v[156:159]
v_mfma_f32_16x16x32_bf16 v[188:191], a[212:215], a[156:159], v[188:191]
ds_read_b64_tr_b16 a[212:213], v205 offset:32768
ds_read_b64_tr_b16 a[214:215], v205 offset:36864
v_mfma_f32_16x16x32_bf16 v[160:163], a[216:219], a[152:155], v[160:163]
v_mfma_f32_16x16x32_bf16 v[192:195], a[216:219], a[156:159], v[192:195]
ds_read_b64_tr_b16 a[216:217], v206 offset:32768
ds_read_b64_tr_b16 a[218:219], v206 offset:36864
v_mfma_f32_16x16x32_bf16 v[164:167], a[220:223], a[152:155], v[164:167]
v_mfma_f32_16x16x32_bf16 v[196:199], a[220:223], a[156:159], v[196:199]
s_waitcnt lgkmcnt(12)
ds_read_b64_tr_b16 a[220:221], v207 offset:32768
ds_read_b64_tr_b16 a[222:223], v207 offset:36864
s_waitcnt vmcnt(0)
v_mfma_f32_16x16x32_bf16 v[136:139], a[192:195], a[160:163], v[136:139]
v_mfma_f32_16x16x32_bf16 v[168:171], a[192:195], a[164:167], v[168:171]
s_waitcnt lgkmcnt(10)
ds_read_b64_tr_b16 a[192:193], v200 offset:40960
ds_read_b64_tr_b16 a[194:195], v200 offset:45056
v_mfma_f32_16x16x32_bf16 v[140:143], a[196:199], a[160:163], v[140:143]
v_mfma_f32_16x16x32_bf16 v[172:175], a[196:199], a[164:167], v[172:175]
ds_read_b64_tr_b16 a[196:197], v201 offset:40960
ds_read_b64_tr_b16 a[198:199], v201 offset:45056
v_mfma_f32_16x16x32_bf16 v[144:147], a[200:203], a[160:163], v[144:147]
v_mfma_f32_16x16x32_bf16 v[176:179], a[200:203], a[164:167], v[176:179]
s_waitcnt lgkmcnt(8)
ds_read_b64_tr_b16 a[200:201], v202 offset:40960
ds_read_b64_tr_b16 a[202:203], v202 offset:45056
v_mfma_f32_16x16x32_bf16 v[148:151], a[204:207], a[160:163], v[148:151]
v_mfma_f32_16x16x32_bf16 v[180:183], a[204:207], a[164:167], v[180:183]
ds_read_b64_tr_b16 a[204:205], v203 offset:40960
ds_read_b64_tr_b16 a[206:207], v203 offset:45056
v_mfma_f32_16x16x32_bf16 v[152:155], a[208:211], a[160:163], v[152:155]
v_mfma_f32_16x16x32_bf16 v[184:187], a[208:211], a[164:167], v[184:187]
ds_read_b64_tr_b16 a[208:209], v204 offset:40960
ds_read_b64_tr_b16 a[210:211], v204 offset:45056
v_mfma_f32_16x16x32_bf16 v[156:159], a[212:215], a[160:163], v[156:159]
v_mfma_f32_16x16x32_bf16 v[188:191], a[212:215], a[164:167], v[188:191]
s_waitcnt lgkmcnt(8)
ds_read_b64_tr_b16 a[212:213], v205 offset:40960
ds_read_b64_tr_b16 a[214:215], v205 offset:45056
v_mfma_f32_16x16x32_bf16 v[160:163], a[216:219], a[160:163], v[160:163]
v_mfma_f32_16x16x32_bf16 v[192:195], a[216:219], a[164:167], v[192:195]
ds_read_b64_tr_b16 a[216:217], v206 offset:40960
ds_read_b64_tr_b16 a[218:219], v206 offset:45056
v_mfma_f32_16x16x32_bf16 v[164:167], a[220:223], a[160:163], v[164:167]
v_mfma_f32_16x16x32_bf16 v[196:199], a[220:223], a[164:167], v[196:199]
ds_read_b64_tr_b16 a[220:221], v207 offset:40960
ds_read_b64_tr_b16 a[222:223], v207 offset:45056
v_cmp_gt_u32 vcc, 16, v248
v_lshlrev_b32 v6, 7, v3
v_add_u32 v6, 0x272800, v6
s_and_b32 s93, vcc_lo, 0xff
s_cselect_b32 s47, 0, 0x7f000000
v_mfma_f32_16x16x32_bf16 v[136:139], a[192:195], a[168:171], v[136:139]
buffer_load_dword v246, v7, s[20:23], s86 offen sc0 sc1
v_mfma_f32_16x16x32_bf16 v[168:171], a[192:195], a[172:175], v[168:171]
s_waitcnt lgkmcnt(8)
ds_read_b64_tr_b16 a[192:193], v200 offset:49152
ds_read_b64_tr_b16 a[194:195], v200 offset:53248
v_mfma_f32_16x16x32_bf16 v[140:143], a[196:199], a[168:171], v[140:143]
v_mfma_f32_16x16x32_bf16 v[172:175], a[196:199], a[172:175], v[172:175]
ds_read_b64_tr_b16 a[196:197], v201 offset:49152
ds_read_b64_tr_b16 a[198:199], v201 offset:53248
v_mfma_f32_16x16x32_bf16 v[144:147], a[200:203], a[168:171], v[144:147]
buffer_load_dword v247, v6, s[20:23], s47 offen sc0 sc1
v_mfma_f32_16x16x32_bf16 v[176:179], a[200:203], a[172:175], v[176:179]
ds_read_b64_tr_b16 a[200:201], v202 offset:49152
ds_read_b64_tr_b16 a[202:203], v202 offset:53248
v_mfma_f32_16x16x32_bf16 v[148:151], a[204:207], a[168:171], v[148:151]
v_mfma_f32_16x16x32_bf16 v[180:183], a[204:207], a[172:175], v[180:183]
s_waitcnt lgkmcnt(8)
ds_read_b64_tr_b16 a[204:205], v203 offset:49152
ds_read_b64_tr_b16 a[206:207], v203 offset:53248
v_mfma_f32_16x16x32_bf16 v[152:155], a[208:211], a[168:171], v[152:155]
v_mfma_f32_16x16x32_bf16 v[184:187], a[208:211], a[172:175], v[184:187]
ds_read_b64_tr_b16 a[208:209], v204 offset:49152
ds_read_b64_tr_b16 a[210:211], v204 offset:53248
v_mfma_f32_16x16x32_bf16 v[156:159], a[212:215], a[168:171], v[156:159]
v_mfma_f32_16x16x32_bf16 v[188:191], a[212:215], a[172:175], v[188:191]
ds_read_b64_tr_b16 a[212:213], v205 offset:49152
ds_read_b64_tr_b16 a[214:215], v205 offset:53248
v_mfma_f32_16x16x32_bf16 v[160:163], a[216:219], a[168:171], v[160:163]
v_mfma_f32_16x16x32_bf16 v[192:195], a[216:219], a[172:175], v[192:195]
s_waitcnt lgkmcnt(8)
ds_read_b64_tr_b16 a[216:217], v206 offset:49152
ds_read_b64_tr_b16 a[218:219], v206 offset:53248
v_mfma_f32_16x16x32_bf16 v[164:167], a[220:223], a[168:171], v[164:167]
v_mfma_f32_16x16x32_bf16 v[196:199], a[220:223], a[172:175], v[196:199]
ds_read_b64_tr_b16 a[220:221], v207 offset:49152
ds_read_b64_tr_b16 a[222:223], v207 offset:53248
v_mfma_f32_16x16x32_bf16 v[136:139], a[192:195], a[176:179], v[136:139]
v_mfma_f32_16x16x32_bf16 v[168:171], a[192:195], a[180:183], v[168:171]
ds_read_b64_tr_b16 a[192:193], v200 offset:57344
ds_read_b64_tr_b16 a[194:195], v200 offset:61440
v_mfma_f32_16x16x32_bf16 v[140:143], a[196:199], a[176:179], v[140:143]
v_mfma_f32_16x16x32_bf16 v[172:175], a[196:199], a[180:183], v[172:175]
s_waitcnt lgkmcnt(8)
ds_read_b64_tr_b16 a[196:197], v201 offset:57344
ds_read_b64_tr_b16 a[198:199], v201 offset:61440
v_mfma_f32_16x16x32_bf16 v[144:147], a[200:203], a[176:179], v[144:147]
v_mfma_f32_16x16x32_bf16 v[176:179], a[200:203], a[180:183], v[176:179]
ds_read_b64_tr_b16 a[200:201], v202 offset:57344
ds_read_b64_tr_b16 a[202:203], v202 offset:61440
v_mfma_f32_16x16x32_bf16 v[148:151], a[204:207], a[176:179], v[148:151]
v_mfma_f32_16x16x32_bf16 v[180:183], a[204:207], a[180:183], v[180:183]
ds_read_b64_tr_b16 a[204:205], v203 offset:57344
ds_read_b64_tr_b16 a[206:207], v203 offset:61440
v_mfma_f32_16x16x32_bf16 v[152:155], a[208:211], a[176:179], v[152:155]
v_mfma_f32_16x16x32_bf16 v[184:187], a[208:211], a[180:183], v[184:187]
s_waitcnt lgkmcnt(8)
ds_read_b64_tr_b16 a[208:209], v204 offset:57344
ds_read_b64_tr_b16 a[210:211], v204 offset:61440
v_mfma_f32_16x16x32_bf16 v[156:159], a[212:215], a[176:179], v[156:159]
v_mfma_f32_16x16x32_bf16 v[188:191], a[212:215], a[180:183], v[188:191]
ds_read_b64_tr_b16 a[212:213], v205 offset:57344
ds_read_b64_tr_b16 a[214:215], v205 offset:61440
v_mfma_f32_16x16x32_bf16 v[160:163], a[216:219], a[176:179], v[160:163]
v_mfma_f32_16x16x32_bf16 v[192:195], a[216:219], a[180:183], v[192:195]
ds_read_b64_tr_b16 a[216:217], v206 offset:57344
ds_read_b64_tr_b16 a[218:219], v206 offset:61440
v_mfma_f32_16x16x32_bf16 v[164:167], a[220:223], a[176:179], v[164:167]
v_mfma_f32_16x16x32_bf16 v[196:199], a[220:223], a[180:183], v[196:199]
s_waitcnt lgkmcnt(8)
ds_read_b64_tr_b16 a[220:221], v207 offset:57344
ds_read_b64_tr_b16 a[222:223], v207 offset:61440
v_mfma_f32_16x16x32_bf16 v[136:139], a[192:195], a[184:187], v[136:139]
v_mfma_f32_16x16x32_bf16 v[168:171], a[192:195], a[188:191], v[168:171]
v_mfma_f32_16x16x32_bf16 v[140:143], a[196:199], a[184:187], v[140:143]
v_mfma_f32_16x16x32_bf16 v[172:175], a[196:199], a[188:191], v[172:175]
v_mfma_f32_16x16x32_bf16 v[144:147], a[200:203], a[184:187], v[144:147]
v_mfma_f32_16x16x32_bf16 v[176:179], a[200:203], a[188:191], v[176:179]
s_waitcnt lgkmcnt(4)
v_mfma_f32_16x16x32_bf16 v[148:151], a[204:207], a[184:187], v[148:151]
v_mfma_f32_16x16x32_bf16 v[180:183], a[204:207], a[188:191], v[180:183]
v_mfma_f32_16x16x32_bf16 v[152:155], a[208:211], a[184:187], v[152:155]
v_mfma_f32_16x16x32_bf16 v[184:187], a[208:211], a[188:191], v[184:187]
v_mfma_f32_16x16x32_bf16 v[156:159], a[212:215], a[184:187], v[156:159]
v_mfma_f32_16x16x32_bf16 v[188:191], a[212:215], a[188:191], v[188:191]
s_waitcnt lgkmcnt(0)
v_mfma_f32_16x16x32_bf16 v[160:163], a[216:219], a[184:187], v[160:163]
v_mfma_f32_16x16x32_bf16 v[192:195], a[216:219], a[188:191], v[192:195]
v_mfma_f32_16x16x32_bf16 v[164:167], a[220:223], a[184:187], v[164:167]
v_mfma_f32_16x16x32_bf16 v[196:199], a[220:223], a[188:191], v[196:199]
s_lshl_b32 s95, s35, 2
s_add_u32 s95, s95, s63
s_lshl_b32 s46, s35, 7
s_add_u32 s63, s63, s46
v_cvt_pk_bf16_f32 v200, v168, v169
v_cvt_pk_bf16_f32 v201, v170, v171
v_cvt_pk_bf16_f32 v202, v172, v173
v_cvt_pk_bf16_f32 v203, v174, v175
buffer_store_dwordx4 v[200:203], v234, s[20:23], s65 offen offset:0 sc0 sc1
v_cvt_pk_bf16_f32 v204, v176, v177
v_cvt_pk_bf16_f32 v205, v178, v179
v_cvt_pk_bf16_f32 v206, v180, v181
v_cvt_pk_bf16_f32 v207, v182, v183
buffer_store_dwordx4 v[204:207], v234, s[20:23], s65 offen offset:1024 sc0 sc1
v_cvt_pk_bf16_f32 v208, v152, v153
v_cvt_pk_bf16_f32 v209, v154, v155
v_cvt_pk_bf16_f32 v210, v156, v157
v_cvt_pk_bf16_f32 v211, v158, v159
buffer_store_dwordx4 v[208:211], v234, s[20:23], s64 offen offset:0 sc0 sc1
v_cvt_pk_bf16_f32 v212, v160, v161
v_cvt_pk_bf16_f32 v213, v162, v163
v_cvt_pk_bf16_f32 v214, v164, v165
v_cvt_pk_bf16_f32 v215, v166, v167
buffer_store_dwordx4 v[212:215], v234, s[20:23], s64 offen offset:1024 sc0 sc1
v_cvt_pk_bf16_f32 v216, v184, v185
v_cvt_pk_bf16_f32 v217, v186, v187
v_cvt_pk_bf16_f32 v218, v188, v189
v_cvt_pk_bf16_f32 v219, v190, v191
buffer_store_dwordx4 v[216:219], v234, s[20:23], s66 offen offset:0 sc0 sc1
v_cvt_pk_bf16_f32 v220, v192, v193
v_cvt_pk_bf16_f32 v221, v194, v195
v_cvt_pk_bf16_f32 v222, v196, v197
v_cvt_pk_bf16_f32 v223, v198, v199
buffer_store_dwordx4 v[220:223], v234, s[20:23], s66 offen offset:1024 sc0 sc1
s_waitcnt vmcnt(6)
v_cmp_ne_u32 vcc, 1, v246
s_and_b32 s46, s35, 1
s_or_b32 s46, s46, vcc_lo
s_cselect_b32 s67, 0, 1
s_cbranch_scc1 K_NOER
s_add_u32 s48, s87, 4096
buffer_load_dwordx2 v[40:41], v250, s[20:23], s87 offen offset:0 sc0 sc1
buffer_load_dwordx2 v[42:43], v250, s[20:23], s87 offen offset:512 sc0 sc1
buffer_load_dwordx2 v[44:45], v250, s[20:23], s87 offen offset:1024 sc0 sc1
buffer_load_dwordx2 v[46:47], v250, s[20:23], s87 offen offset:1536 sc0 sc1
buffer_load_dwordx2 v[48:49], v250, s[20:23], s87 offen offset:2048 sc0 sc1
buffer_load_dwordx2 v[50:51], v250, s[20:23], s87 offen offset:2560 sc0 sc1
buffer_load_dwordx2 v[52:53], v250, s[20:23], s87 offen offset:3072 sc0 sc1
buffer_load_dwordx2 v[54:55], v250, s[20:23], s87 offen offset:3584 sc0 sc1
buffer_load_dwordx2 v[56:57], v250, s[20:23], s48 offen offset:0 sc0 sc1
buffer_load_dwordx2 v[58:59], v250, s[20:23], s48 offen offset:512 sc0 sc1
buffer_load_dwordx2 v[60:61], v250, s[20:23], s48 offen offset:1024 sc0 sc1
buffer_load_dwordx2 v[62:63], v250, s[20:23], s48 offen offset:1536 sc0 sc1
buffer_load_dwordx2 v[64:65], v250, s[20:23], s48 offen offset:2048 sc0 sc1
buffer_load_dwordx2 v[66:67], v250, s[20:23], s48 offen offset:2560 sc0 sc1
buffer_load_dwordx2 v[68:69], v250, s[20:23], s48 offen offset:3072 sc0 sc1
buffer_load_dwordx2 v[70:71], v250, s[20:23], s48 offen offset:3584 sc0 sc1
K_NOER:
v_lshlrev_b32 v30, 16, v120
v_and_b32 v31, s56, v120
v_lshlrev_b32 v32, 16, v121
v_and_b32 v33, s56, v121
v_pk_add_f32 v[30:31], v[30:31], v[130:131] op_sel_hi:[1,0] neg_lo:[0,1] neg_hi:[0,1]
v_pk_add_f32 v[32:33], v[32:33], v[130:131] op_sel_hi:[1,0] neg_lo:[0,1] neg_hi:[0,1]
v_cvt_pk_bf16_f32 v28, v30, v31
v_cvt_pk_bf16_f32 v29, v32, v33
v_lshlrev_b32 v30, 16, v28
v_and_b32 v31, s56, v28
v_lshlrev_b32 v32, 16, v29
v_and_b32 v33, s56, v29
v_pk_mul_f32 v[8:9], v[30:31], v[132:133] op_sel_hi:[1,0]
v_pk_mul_f32 v[10:11], v[32:33], v[132:133] op_sel_hi:[1,0]
v_pk_fma_f32 v[30:31], v[8:9], v[130:131], v[30:31] op_sel:[0,1,0] op_sel_hi:[1,1,1] neg_lo:[1,0,0] neg_hi:[1,0,0]
v_pk_fma_f32 v[32:33], v[10:11], v[130:131], v[32:33] op_sel:[0,1,0] op_sel_hi:[1,1,1] neg_lo:[1,0,0] neg_hi:[1,0,0]
v_pk_fma_f32 v[8:9], v[30:31], v[132:133], v[8:9] op_sel_hi:[1,0,1]
v_pk_fma_f32 v[10:11], v[32:33], v[132:133], v[10:11] op_sel_hi:[1,0,1]
v_cvt_pk_bf16_f32 v28, v8, v9
v_cvt_pk_bf16_f32 v29, v10, v11
v_lshlrev_b32 v8, 16, v28
v_and_b32 v9, s56, v28
v_lshlrev_b32 v10, 16, v29
v_and_b32 v11, s56, v29
v_mul_f32 v30, s57, v8
v_mul_f32 v31, s57, v9
v_mul_f32 v32, s57, v10
v_mul_f32 v33, s57, v11
v_exp_f32 v30, v30
v_exp_f32 v31, v31
v_exp_f32 v32, v32
v_exp_f32 v33, v33
s_nop 0
v_add_f32 v30, 1.0, v30
v_add_f32 v31, 1.0, v31
v_add_f32 v32, 1.0, v32
v_add_f32 v33, 1.0, v33
v_rcp_f32 v30, v30
v_rcp_f32 v31, v31
v_rcp_f32 v32, v32
v_rcp_f32 v33, v33
s_nop 0
v_pk_mul_f32 v[8:9], v[8:9], v[30:31]
v_pk_mul_f32 v[10:11], v[10:11], v[32:33]
v_cvt_pk_bf16_f32 v28, v8, v9
v_cvt_pk_bf16_f32 v29, v10, v11
v_lshlrev_b32 v8, 16, v28
v_and_b32 v9, s56, v28
v_lshlrev_b32 v10, 16, v29
v_and_b32 v11, s56, v29
v_lshlrev_b32 v30, 16, v122
v_and_b32 v31, s56, v122
v_lshlrev_b32 v32, 16, v123
v_and_b32 v33, s56, v123
v_pk_add_f32 v[30:31], v[30:31], v[130:131] op_sel_hi:[1,0] neg_lo:[0,1] neg_hi:[0,1]
v_pk_add_f32 v[32:33], v[32:33], v[130:131] op_sel_hi:[1,0] neg_lo:[0,1] neg_hi:[0,1]
v_cvt_pk_bf16_f32 v28, v30, v31
v_cvt_pk_bf16_f32 v29, v32, v33
v_lshlrev_b32 v30, 16, v28
v_and_b32 v31, s56, v28
v_lshlrev_b32 v32, 16, v29
v_and_b32 v33, s56, v29
v_pk_mul_f32 v[12:13], v[30:31], v[132:133] op_sel_hi:[1,0]
v_pk_mul_f32 v[14:15], v[32:33], v[132:133] op_sel_hi:[1,0]
v_pk_fma_f32 v[30:31], v[12:13], v[130:131], v[30:31] op_sel:[0,1,0] op_sel_hi:[1,1,1] neg_lo:[1,0,0] neg_hi:[1,0,0]
v_pk_fma_f32 v[32:33], v[14:15], v[130:131], v[32:33] op_sel:[0,1,0] op_sel_hi:[1,1,1] neg_lo:[1,0,0] neg_hi:[1,0,0]
v_pk_fma_f32 v[12:13], v[30:31], v[132:133], v[12:13] op_sel_hi:[1,0,1]
v_pk_fma_f32 v[14:15], v[32:33], v[132:133], v[14:15] op_sel_hi:[1,0,1]
v_cvt_pk_bf16_f32 v28, v12, v13
v_cvt_pk_bf16_f32 v29, v14, v15
v_lshlrev_b32 v12, 16, v28
v_and_b32 v13, s56, v28
v_lshlrev_b32 v14, 16, v29
v_and_b32 v15, s56, v29
v_mul_f32 v30, s57, v12
v_mul_f32 v31, s57, v13
v_mul_f32 v32, s57, v14
v_mul_f32 v33, s57, v15
v_exp_f32 v30, v30
v_exp_f32 v31, v31
v_exp_f32 v32, v32
v_exp_f32 v33, v33
s_nop 0
v_add_f32 v30, 1.0, v30
v_add_f32 v31, 1.0, v31
v_add_f32 v32, 1.0, v32
v_add_f32 v33, 1.0, v33
v_rcp_f32 v30, v30
v_rcp_f32 v31, v31
v_rcp_f32 v32, v32
v_rcp_f32 v33, v33
s_nop 0
v_pk_mul_f32 v[12:13], v[12:13], v[30:31]
v_pk_mul_f32 v[14:15], v[14:15], v[32:33]
v_cvt_pk_bf16_f32 v28, v12, v13
v_cvt_pk_bf16_f32 v29, v14, v15
v_lshlrev_b32 v12, 16, v28
v_and_b32 v13, s56, v28
v_lshlrev_b32 v14, 16, v29
v_and_b32 v15, s56, v29
s_mov_b32 s47, s67
s_and_b32 s46, s35, 1
s_or_b32 s67, s67, s46
s_cselect_b32 s46, 0, 16
v_and_b32 v153, 3, v1
v_lshl_add_u32 v153, v153, 2, s63
v_add_u32 v7, s86, v7
v_cmp_gt_u32 vcc, s46, v1
s_add_u32 s48, s35, 16
s_nop 0
v_cndmask_b32 v152, v153, v7, vcc
s_waitcnt vmcnt(16)
s_cmp_lg_u32 s47, 0
s_cbranch_scc1 K_FLAGGED
s_waitcnt vmcnt(0)
K_FLAGGED:
buffer_load_dword v246, v152, s[20:23], 0 offen sc0 sc1
s_mov_b32 exec_lo, s38
s_mov_b32 exec_hi, 0
buffer_store_dword v5, v249, s[20:23], s95 offen sc0 sc1
s_mov_b64 exec, -1
v_lshlrev_b32 v30, 16, v124
v_and_b32 v31, s56, v124
v_lshlrev_b32 v32, 16, v125
v_and_b32 v33, s56, v125
v_pk_add_f32 v[30:31], v[30:31], v[130:131] op_sel_hi:[1,0] neg_lo:[0,1] neg_hi:[0,1]
v_pk_add_f32 v[32:33], v[32:33], v[130:131] op_sel_hi:[1,0] neg_lo:[0,1] neg_hi:[0,1]
v_cvt_pk_bf16_f32 v28, v30, v31
v_cvt_pk_bf16_f32 v29, v32, v33
v_lshlrev_b32 v30, 16, v28
v_and_b32 v31, s56, v28
v_lshlrev_b32 v32, 16, v29
v_and_b32 v33, s56, v29
v_pk_mul_f32 v[16:17], v[30:31], v[132:133] op_sel_hi:[1,0]
v_pk_mul_f32 v[18:19], v[32:33], v[132:133] op_sel_hi:[1,0]
v_pk_fma_f32 v[30:31], v[16:17], v[130:131], v[30:31] op_sel:[0,1,0] op_sel_hi:[1,1,1] neg_lo:[1,0,0] neg_hi:[1,0,0]
v_pk_fma_f32 v[32:33], v[18:19], v[130:131], v[32:33] op_sel:[0,1,0] op_sel_hi:[1,1,1] neg_lo:[1,0,0] neg_hi:[1,0,0]
v_pk_fma_f32 v[16:17], v[30:31], v[132:133], v[16:17] op_sel_hi:[1,0,1]
v_pk_fma_f32 v[18:19], v[32:33], v[132:133], v[18:19] op_sel_hi:[1,0,1]
v_cvt_pk_bf16_f32 v28, v16, v17
v_cvt_pk_bf16_f32 v29, v18, v19
v_lshlrev_b32 v16, 16, v28
v_and_b32 v17, s56, v28
v_lshlrev_b32 v18, 16, v29
v_and_b32 v19, s56, v29
v_mul_f32 v30, s57, v16
v_mul_f32 v31, s57, v17
v_mul_f32 v32, s57, v18
v_mul_f32 v33, s57, v19
v_exp_f32 v30, v30
v_exp_f32 v31, v31
v_exp_f32 v32, v32
v_exp_f32 v33, v33
s_nop 0
v_add_f32 v30, 1.0, v30
v_add_f32 v31, 1.0, v31
v_add_f32 v32, 1.0, v32
v_add_f32 v33, 1.0, v33
v_rcp_f32 v30, v30
v_rcp_f32 v31, v31
v_rcp_f32 v32, v32
v_rcp_f32 v33, v33
s_nop 0
v_pk_mul_f32 v[16:17], v[16:17], v[30:31]
v_pk_mul_f32 v[18:19], v[18:19], v[32:33]
v_cvt_pk_bf16_f32 v28, v16, v17
v_cvt_pk_bf16_f32 v29, v18, v19
v_lshlrev_b32 v16, 16, v28
v_and_b32 v17, s56, v28
v_lshlrev_b32 v18, 16, v29
v_and_b32 v19, s56, v29
v_lshlrev_b32 v30, 16, v126
v_and_b32 v31, s56, v126
v_lshlrev_b32 v32, 16, v127
v_and_b32 v33, s56, v127
v_pk_add_f32 v[30:31], v[30:31], v[130:131] op_sel_hi:[1,0] neg_lo:[0,1] neg_hi:[0,1]
v_pk_add_f32 v[32:33], v[32:33], v[130:131] op_sel_hi:[1,0] neg_lo:[0,1] neg_hi:[0,1]
v_cvt_pk_bf16_f32 v28, v30, v31
v_cvt_pk_bf16_f32 v29, v32, v33
v_lshlrev_b32 v30, 16, v28
v_and_b32 v31, s56, v28
v_lshlrev_b32 v32, 16, v29
v_and_b32 v33, s56, v29
v_pk_mul_f32 v[20:21], v[30:31], v[132:133] op_sel_hi:[1,0]
v_pk_mul_f32 v[22:23], v[32:33], v[132:133] op_sel_hi:[1,0]
v_pk_fma_f32 v[30:31], v[20:21], v[130:131], v[30:31] op_sel:[0,1,0] op_sel_hi:[1,1,1] neg_lo:[1,0,0] neg_hi:[1,0,0]
v_pk_fma_f32 v[32:33], v[22:23], v[130:131], v[32:33] op_sel:[0,1,0] op_sel_hi:[1,1,1] neg_lo:[1,0,0] neg_hi:[1,0,0]
v_pk_fma_f32 v[20:21], v[30:31], v[132:133], v[20:21] op_sel_hi:[1,0,1]
v_pk_fma_f32 v[22:23], v[32:33], v[132:133], v[22:23] op_sel_hi:[1,0,1]
v_cvt_pk_bf16_f32 v28, v20, v21
v_cvt_pk_bf16_f32 v29, v22, v23
v_lshlrev_b32 v20, 16, v28
v_and_b32 v21, s56, v28
v_lshlrev_b32 v22, 16, v29
v_and_b32 v23, s56, v29
v_mul_f32 v30, s57, v20
v_mul_f32 v31, s57, v21
v_mul_f32 v32, s57, v22
v_mul_f32 v33, s57, v23
v_exp_f32 v30, v30
v_exp_f32 v31, v31
v_exp_f32 v32, v32
v_exp_f32 v33, v33
s_nop 0
v_add_f32 v30, 1.0, v30
v_add_f32 v31, 1.0, v31
v_add_f32 v32, 1.0, v32
v_add_f32 v33, 1.0, v33
v_rcp_f32 v30, v30
v_rcp_f32 v31, v31
v_rcp_f32 v32, v32
v_rcp_f32 v33, v33
s_nop 0
v_pk_mul_f32 v[20:21], v[20:21], v[30:31]
v_pk_mul_f32 v[22:23], v[22:23], v[32:33]
v_cvt_pk_bf16_f32 v28, v20, v21
v_cvt_pk_bf16_f32 v29, v22, v23
v_lshlrev_b32 v20, 16, v28
v_and_b32 v21, s56, v28
v_lshlrev_b32 v22, 16, v29
v_and_b32 v23, s56, v29
v_lshlrev_b32 v30, 16, v128
v_and_b32 v31, s56, v128
v_lshlrev_b32 v32, 16, v129
v_and_b32 v33, s56, v129
v_pk_add_f32 v[30:31], v[30:31], v[130:131] op_sel_hi:[1,0] neg_lo:[0,1] neg_hi:[0,1]
v_pk_add_f32 v[32:33], v[32:33], v[130:131] op_sel_hi:[1,0] neg_lo:[0,1] neg_hi:[0,1]
v_cvt_pk_bf16_f32 v28, v30, v31
v_cvt_pk_bf16_f32 v29, v32, v33
v_lshlrev_b32 v30, 16, v28
v_and_b32 v31, s56, v28
v_lshlrev_b32 v32, 16, v29
v_and_b32 v33, s56, v29
v_pk_mul_f32 v[24:25], v[30:31], v[132:133] op_sel_hi:[1,0]
v_pk_mul_f32 v[26:27], v[32:33], v[132:133] op_sel_hi:[1,0]
v_pk_fma_f32 v[30:31], v[24:25], v[130:131], v[30:31] op_sel:[0,1,0] op_sel_hi:[1,1,1] neg_lo:[1,0,0] neg_hi:[1,0,0]
v_pk_fma_f32 v[32:33], v[26:27], v[130:131], v[32:33] op_sel:[0,1,0] op_sel_hi:[1,1,1] neg_lo:[1,0,0] neg_hi:[1,0,0]
v_pk_fma_f32 v[24:25], v[30:31], v[132:133], v[24:25] op_sel_hi:[1,0,1]
v_pk_fma_f32 v[26:27], v[32:33], v[132:133], v[26:27] op_sel_hi:[1,0,1]
v_cvt_pk_bf16_f32 v28, v24, v25
v_cvt_pk_bf16_f32 v29, v26, v27
v_lshlrev_b32 v24, 16, v28
v_and_b32 v25, s56, v28
v_lshlrev_b32 v26, 16, v29
v_and_b32 v27, s56, v29
v_mul_f32 v30, s57, v24
v_mul_f32 v31, s57, v25
v_mul_f32 v32, s57, v26
v_mul_f32 v33, s57, v27
v_exp_f32 v30, v30
v_exp_f32 v31, v31
v_exp_f32 v32, v32
v_exp_f32 v33, v33
s_nop 0
v_add_f32 v30, 1.0, v30
v_add_f32 v31, 1.0, v31
v_add_f32 v32, 1.0, v32
v_add_f32 v33, 1.0, v33
v_rcp_f32 v30, v30
v_rcp_f32 v31, v31
v_rcp_f32 v32, v32
v_rcp_f32 v33, v33
s_nop 0
v_pk_mul_f32 v[24:25], v[24:25], v[30:31]
v_pk_mul_f32 v[26:27], v[26:27], v[32:33]
v_cvt_pk_bf16_f32 v28, v24, v25
v_cvt_pk_bf16_f32 v29, v26, v27
v_lshlrev_b32 v24, 16, v28
v_and_b32 v25, s56, v28
v_lshlrev_b32 v26, 16, v29
v_and_b32 v27, s56, v29
s_waitcnt vmcnt(2)
v_lshlrev_b32 v36, 16, v40
v_and_b32 v37, s56, v40
v_lshlrev_b32 v38, 16, v41
v_and_b32 v39, s56, v41
v_dot2_f32_bf16 v36, v42, s58, v36
v_dot2_f32_bf16 v37, v42, s59, v37
v_dot2_f32_bf16 v38, v43, s58, v38
v_dot2_f32_bf16 v39, v43, s59, v39
v_dot2_f32_bf16 v36, v44, s58, v36
v_dot2_f32_bf16 v37, v44, s59, v37
v_dot2_f32_bf16 v38, v45, s58, v38
v_dot2_f32_bf16 v39, v45, s59, v39
v_dot2_f32_bf16 v36, v46, s58, v36
v_dot2_f32_bf16 v37, v46, s59, v37
v_dot2_f32_bf16 v38, v47, s58, v38
v_dot2_f32_bf16 v39, v47, s59, v39
v_dot2_f32_bf16 v36, v48, s58, v36
v_dot2_f32_bf16 v37, v48, s59, v37
v_dot2_f32_bf16 v38, v49, s58, v38
v_dot2_f32_bf16 v39, v49, s59, v39
v_dot2_f32_bf16 v36, v50, s58, v36
v_dot2_f32_bf16 v37, v50, s59, v37
v_dot2_f32_bf16 v38, v51, s58, v38
v_dot2_f32_bf16 v39, v51, s59, v39
v_dot2_f32_bf16 v36, v52, s58, v36
v_dot2_f32_bf16 v37, v52, s59, v37
v_dot2_f32_bf16 v38, v53, s58, v38
v_dot2_f32_bf16 v39, v53, s59, v39
v_dot2_f32_bf16 v36, v54, s58, v36
v_dot2_f32_bf16 v37, v54, s59, v37
v_dot2_f32_bf16 v38, v55, s58, v38
v_dot2_f32_bf16 v39, v55, s59, v39
v_dot2_f32_bf16 v36, v56, s58, v36
v_dot2_f32_bf16 v37, v56, s59, v37
v_dot2_f32_bf16 v38, v57, s58, v38
v_dot2_f32_bf16 v39, v57, s59, v39
v_dot2_f32_bf16 v36, v58, s58, v36
v_dot2_f32_bf16 v37, v58, s59, v37
v_dot2_f32_bf16 v38, v59, s58, v38
v_dot2_f32_bf16 v39, v59, s59, v39
v_dot2_f32_bf16 v36, v60, s58, v36
v_dot2_f32_bf16 v37, v60, s59, v37
v_dot2_f32_bf16 v38, v61, s58, v38
v_dot2_f32_bf16 v39, v61, s59, v39
v_dot2_f32_bf16 v36, v62, s58, v36
v_dot2_f32_bf16 v37, v62, s59, v37
v_dot2_f32_bf16 v38, v63, s58, v38
v_dot2_f32_bf16 v39, v63, s59, v39
v_dot2_f32_bf16 v36, v64, s58, v36
v_dot2_f32_bf16 v37, v64, s59, v37
v_dot2_f32_bf16 v38, v65, s58, v38
v_dot2_f32_bf16 v39, v65, s59, v39
v_dot2_f32_bf16 v36, v66, s58, v36
v_dot2_f32_bf16 v37, v66, s59, v37
v_dot2_f32_bf16 v38, v67, s58, v38
v_dot2_f32_bf16 v39, v67, s59, v39
v_dot2_f32_bf16 v36, v68, s58, v36
v_dot2_f32_bf16 v37, v68, s59, v37
v_dot2_f32_bf16 v38, v69, s58, v38
v_dot2_f32_bf16 v39, v69, s59, v39
v_dot2_f32_bf16 v36, v70, s58, v36
v_dot2_f32_bf16 v37, v70, s59, v37
v_dot2_f32_bf16 v38, v71, s58, v38
v_dot2_f32_bf16 v39, v71, s59, v39
s_cmp_lg_u32 s93, 0
s_cbranch_scc1 K_YG
K_YGD:
s_waitcnt vmcnt(1)
s_branch K_XW
K_XPOLL:
s_sleep 2
s_add_u32 s100, s100, 1
s_bitcmp1_b32 s100, 19
s_cbranch_scc1 K_END
buffer_load_dword v246, v152, s[20:23], 0 offen sc0 sc1
s_waitcnt vmcnt(0)
K_XW:
v_writelane_b32 v246, 1, s48
v_cmp_ne_u32 vcc, 1, v246
s_cmp_lg_u32 s67, 0
s_cbranch_scc1 K_XW2
s_and_b32 s46, vcc_lo, 0xffff
s_cbranch_scc1 K_XPOLL
s_add_u32 s46, s87, 4096
s_mov_b32 s67, 2
v_mov_b32 v152, v153
buffer_load_dwordx2 v[40:41], v250, s[20:23], s87 offen offset:0 sc0 sc1
buffer_load_dwordx2 v[42:43], v250, s[20:23], s87 offen offset:512 sc0 sc1
buffer_load_dwordx2 v[44:45], v250, s[20:23], s87 offen offset:1024 sc0 sc1
buffer_load_dwordx2 v[46:47], v250, s[20:23], s87 offen offset:1536 sc0 sc1
buffer_load_dwordx2 v[48:49], v250, s[20:23], s87 offen offset:2048 sc0 sc1
buffer_load_dwordx2 v[50:51], v250, s[20:23], s87 offen offset:2560 sc0 sc1
buffer_load_dwordx2 v[52:53], v250, s[20:23], s87 offen offset:3072 sc0 sc1
buffer_load_dwordx2 v[54:55], v250, s[20:23], s87 offen offset:3584 sc0 sc1
buffer_load_dwordx2 v[56:57], v250, s[20:23], s46 offen offset:0 sc0 sc1
buffer_load_dwordx2 v[58:59], v250, s[20:23], s46 offen offset:512 sc0 sc1
buffer_load_dwordx2 v[60:61], v250, s[20:23], s46 offen offset:1024 sc0 sc1
buffer_load_dwordx2 v[62:63], v250, s[20:23], s46 offen offset:1536 sc0 sc1
buffer_load_dwordx2 v[64:65], v250, s[20:23], s46 offen offset:2048 sc0 sc1
buffer_load_dwordx2 v[66:67], v250, s[20:23], s46 offen offset:2560 sc0 sc1
buffer_load_dwordx2 v[68:69], v250, s[20:23], s46 offen offset:3072 sc0 sc1
buffer_load_dwordx2 v[70:71], v250, s[20:23], s46 offen offset:3584 sc0 sc1
K_XW2:
s_and_b32 s46, vcc_lo, 0xf0000
s_cbranch_scc1 K_XPOLL
buffer_load_dwordx4 v[96:99], v234, s[20:23], s60 offen offset:0 sc0 sc1
buffer_load_dwordx4 v[104:107], v234, s[20:23], s61 offen offset:0 sc0 sc1
buffer_load_dwordx4 v[112:115], v234, s[20:23], s62 offen offset:0 sc0 sc1
buffer_load_dwordx4 v[100:103], v234, s[20:23], s60 offen offset:1024 sc0 sc1
buffer_load_dwordx4 v[108:111], v234, s[20:23], s61 offen offset:1024 sc0 sc1
buffer_load_dwordx4 v[116:119], v234, s[20:23], s62 offen offset:1024 sc0 sc1
v_lshlrev_b32 v72, 16, v120
v_and_b32 v73, s56, v120
v_lshlrev_b32 v74, 16, v121
v_and_b32 v75, s56, v121
v_lshlrev_b32 v76, 16, v122
v_and_b32 v77, s56, v122
v_lshlrev_b32 v78, 16, v123
v_and_b32 v79, s56, v123
v_lshlrev_b32 v80, 16, v124
v_and_b32 v81, s56, v124
v_lshlrev_b32 v82, 16, v125
v_and_b32 v83, s56, v125
v_lshlrev_b32 v84, 16, v126
v_and_b32 v85, s56, v126
v_lshlrev_b32 v86, 16, v127
v_and_b32 v87, s56, v127
v_lshlrev_b32 v88, 16, v128
v_and_b32 v89, s56, v128
v_lshlrev_b32 v90, 16, v129
v_and_b32 v91, s56, v129
s_cmp_lg_u32 s67, 2
s_cbranch_scc1 K_EFIN
s_waitcnt vmcnt(6)
v_lshlrev_b32 v36, 16, v40
v_and_b32 v37, s56, v40
v_lshlrev_b32 v38, 16, v41
v_and_b32 v39, s56, v41
v_dot2_f32_bf16 v36, v42, s58, v36
v_dot2_f32_bf16 v37, v42, s59, v37
v_dot2_f32_bf16 v38, v43, s58, v38
v_dot2_f32_bf16 v39, v43, s59, v39
v_dot2_f32_bf16 v36, v44, s58, v36
v_dot2_f32_bf16 v37, v44, s59, v37
v_dot2_f32_bf16 v38, v45, s58, v38
v_dot2_f32_bf16 v39, v45, s59, v39
v_dot2_f32_bf16 v36, v46, s58, v36
v_dot2_f32_bf16 v37, v46, s59, v37
v_dot2_f32_bf16 v38, v47, s58, v38
v_dot2_f32_bf16 v39, v47, s59, v39
v_dot2_f32_bf16 v36, v48, s58, v36
v_dot2_f32_bf16 v37, v48, s59, v37
v_dot2_f32_bf16 v38, v49, s58, v38
v_dot2_f32_bf16 v39, v49, s59, v39
v_dot2_f32_bf16 v36, v50, s58, v36
v_dot2_f32_bf16 v37, v50, s59, v37
v_dot2_f32_bf16 v38, v51, s58, v38
v_dot2_f32_bf16 v39, v51, s59, v39
v_dot2_f32_bf16 v36, v52, s58, v36
v_dot2_f32_bf16 v37, v52, s59, v37
v_dot2_f32_bf16 v38, v53, s58, v38
v_dot2_f32_bf16 v39, v53, s59, v39
v_dot2_f32_bf16 v36, v54, s58, v36
v_dot2_f32_bf16 v37, v54, s59, v37
v_dot2_f32_bf16 v38, v55, s58, v38
v_dot2_f32_bf16 v39, v55, s59, v39
v_dot2_f32_bf16 v36, v56, s58, v36
v_dot2_f32_bf16 v37, v56, s59, v37
v_dot2_f32_bf16 v38, v57, s58, v38
v_dot2_f32_bf16 v39, v57, s59, v39
v_dot2_f32_bf16 v36, v58, s58, v36
v_dot2_f32_bf16 v37, v58, s59, v37
v_dot2_f32_bf16 v38, v59, s58, v38
v_dot2_f32_bf16 v39, v59, s59, v39
v_dot2_f32_bf16 v36, v60, s58, v36
v_dot2_f32_bf16 v37, v60, s59, v37
v_dot2_f32_bf16 v38, v61, s58, v38
v_dot2_f32_bf16 v39, v61, s59, v39
v_dot2_f32_bf16 v36, v62, s58, v36
v_dot2_f32_bf16 v37, v62, s59, v37
v_dot2_f32_bf16 v38, v63, s58, v38
v_dot2_f32_bf16 v39, v63, s59, v39
v_dot2_f32_bf16 v36, v64, s58, v36
v_dot2_f32_bf16 v37, v64, s59, v37
v_dot2_f32_bf16 v38, v65, s58, v38
v_dot2_f32_bf16 v39, v65, s59, v39
v_dot2_f32_bf16 v36, v66, s58, v36
v_dot2_f32_bf16 v37, v66, s59, v37
v_dot2_f32_bf16 v38, v67, s58, v38
v_dot2_f32_bf16 v39, v67, s59, v39
v_dot2_f32_bf16 v36, v68, s58, v36
v_dot2_f32_bf16 v37, v68, s59, v37
v_dot2_f32_bf16 v38, v69, s58, v38
v_dot2_f32_bf16 v39, v69, s59, v39
v_dot2_f32_bf16 v36, v70, s58, v36
v_dot2_f32_bf16 v37, v70, s59, v37
v_dot2_f32_bf16 v38, v71, s58, v38
v_dot2_f32_bf16 v39, v71, s59, v39
s_nop 1
K_EFIN:
v_cvt_pk_bf16_f32 v28, v36, v37
v_cvt_pk_bf16_f32 v29, v38, v39
v_lshlrev_b32 v36, 16, v28
v_and_b32 v37, s56, v28
v_lshlrev_b32 v38, 16, v29
v_and_b32 v39, s56, v29
v_pk_mul_f32 v[36:37], v[36:37], v[24:25]
v_pk_mul_f32 v[38:39], v[38:39], v[26:27]
v_cvt_pk_bf16_f32 v28, v36, v37
v_cvt_pk_bf16_f32 v29, v38, v39
v_lshlrev_b32 v36, 16, v28
v_and_b32 v37, s56, v28
v_lshlrev_b32 v38, 16, v29
v_and_b32 v39, s56, v29
v_pk_add_f32 v[36:37], v[36:37], v[88:89]
v_pk_add_f32 v[38:39], v[38:39], v[90:91]
v_cvt_pk_bf16_f32 v36, v36, v37
v_cvt_pk_bf16_f32 v37, v38, v39
buffer_store_dwordx2 v[36:37], v240, s[68:71], s81 offen
s_add_u32 s46, s37, 65536
v_add_u32 v5, s46, v234
s_add_u32 s46, s80, 9216
s_waitcnt vmcnt(4)
v_dot2_f32_bf16 v136, v96, s58, v136
v_dot2_f32_bf16 v137, v96, s59, v137
v_dot2_f32_bf16 v138, v97, s58, v138
v_dot2_f32_bf16 v139, v97, s59, v139
v_dot2_f32_bf16 v140, v98, s58, v140
v_dot2_f32_bf16 v141, v98, s59, v141
v_dot2_f32_bf16 v142, v99, s58, v142
v_dot2_f32_bf16 v143, v99, s59, v143
v_dot2_f32_bf16 v136, v104, s58, v136
v_dot2_f32_bf16 v137, v104, s59, v137
v_dot2_f32_bf16 v138, v105, s58, v138
v_dot2_f32_bf16 v139, v105, s59, v139
v_dot2_f32_bf16 v140, v106, s58, v140
v_dot2_f32_bf16 v141, v106, s59, v141
v_dot2_f32_bf16 v142, v107, s58, v142
v_dot2_f32_bf16 v143, v107, s59, v143
v_dot2_f32_bf16 v136, v112, s58, v136
v_dot2_f32_bf16 v137, v112, s59, v137
v_dot2_f32_bf16 v138, v113, s58, v138
v_dot2_f32_bf16 v139, v113, s59, v139
v_dot2_f32_bf16 v140, v114, s58, v140
v_dot2_f32_bf16 v141, v114, s59, v141
v_dot2_f32_bf16 v142, v115, s58, v142
v_dot2_f32_bf16 v143, v115, s59, v143
v_cvt_pk_bf16_f32 v28, v136, v137
v_cvt_pk_bf16_f32 v29, v138, v139
v_lshlrev_b32 v136, 16, v28
v_and_b32 v137, s56, v28
v_lshlrev_b32 v138, 16, v29
v_and_b32 v139, s56, v29
v_pk_mul_f32 v[136:137], v[136:137], v[8:9]
v_pk_mul_f32 v[138:139], v[138:139], v[10:11]
v_cvt_pk_bf16_f32 v28, v136, v137
v_cvt_pk_bf16_f32 v29, v138, v139
v_lshlrev_b32 v136, 16, v28
v_and_b32 v137, s56, v28
v_lshlrev_b32 v138, 16, v29
v_and_b32 v139, s56, v29
v_pk_add_f32 v[136:137], v[136:137], v[72:73]
v_pk_add_f32 v[138:139], v[138:139], v[74:75]
v_cvt_pk_bf16_f32 v136, v136, v137
v_cvt_pk_bf16_f32 v137, v138, v139
ds_write_b64 v241, v[136:137]
v_cvt_pk_bf16_f32 v28, v140, v141
v_cvt_pk_bf16_f32 v29, v142, v143
v_lshlrev_b32 v140, 16, v28
v_and_b32 v141, s56, v28
v_lshlrev_b32 v142, 16, v29
v_and_b32 v143, s56, v29
v_pk_mul_f32 v[140:141], v[140:141], v[12:13]
v_pk_mul_f32 v[142:143], v[142:143], v[14:15]
v_cvt_pk_bf16_f32 v28, v140, v141
v_cvt_pk_bf16_f32 v29, v142, v143
v_lshlrev_b32 v140, 16, v28
v_and_b32 v141, s56, v28
v_lshlrev_b32 v142, 16, v29
v_and_b32 v143, s56, v29
v_pk_add_f32 v[140:141], v[140:141], v[76:77]
v_pk_add_f32 v[142:143], v[142:143], v[78:79]
v_cvt_pk_bf16_f32 v140, v140, v141
v_cvt_pk_bf16_f32 v141, v142, v143
ds_write_b64 v242, v[140:141]
s_waitcnt vmcnt(1)
v_dot2_f32_bf16 v144, v100, s58, v144
v_dot2_f32_bf16 v145, v100, s59, v145
v_dot2_f32_bf16 v146, v101, s58, v146
v_dot2_f32_bf16 v147, v101, s59, v147
v_dot2_f32_bf16 v148, v102, s58, v148
v_dot2_f32_bf16 v149, v102, s59, v149
v_dot2_f32_bf16 v150, v103, s58, v150
v_dot2_f32_bf16 v151, v103, s59, v151
v_dot2_f32_bf16 v144, v108, s58, v144
v_dot2_f32_bf16 v145, v108, s59, v145
v_dot2_f32_bf16 v146, v109, s58, v146
v_dot2_f32_bf16 v147, v109, s59, v147
v_dot2_f32_bf16 v148, v110, s58, v148
v_dot2_f32_bf16 v149, v110, s59, v149
v_dot2_f32_bf16 v150, v111, s58, v150
v_dot2_f32_bf16 v151, v111, s59, v151
v_dot2_f32_bf16 v144, v116, s58, v144
v_dot2_f32_bf16 v145, v116, s59, v145
v_dot2_f32_bf16 v146, v117, s58, v146
v_dot2_f32_bf16 v147, v117, s59, v147
v_dot2_f32_bf16 v148, v118, s58, v148
v_dot2_f32_bf16 v149, v118, s59, v149
v_dot2_f32_bf16 v150, v119, s58, v150
v_dot2_f32_bf16 v151, v119, s59, v151
v_cvt_pk_bf16_f32 v28, v144, v145
v_cvt_pk_bf16_f32 v29, v146, v147
v_lshlrev_b32 v144, 16, v28
v_and_b32 v145, s56, v28
v_lshlrev_b32 v146, 16, v29
v_and_b32 v147, s56, v29
v_pk_mul_f32 v[144:145], v[144:145], v[16:17]
v_pk_mul_f32 v[146:147], v[146:147], v[18:19]
v_cvt_pk_bf16_f32 v28, v144, v145
v_cvt_pk_bf16_f32 v29, v146, v147
v_lshlrev_b32 v144, 16, v28
v_and_b32 v145, s56, v28
v_lshlrev_b32 v146, 16, v29
v_and_b32 v147, s56, v29
v_pk_add_f32 v[144:145], v[144:145], v[80:81]
v_pk_add_f32 v[146:147], v[146:147], v[82:83]
v_cvt_pk_bf16_f32 v144, v144, v145
v_cvt_pk_bf16_f32 v145, v146, v147
ds_write_b64 v243, v[144:145]
v_cvt_pk_bf16_f32 v28, v148, v149
v_cvt_pk_bf16_f32 v29, v150, v151
v_lshlrev_b32 v148, 16, v28
v_and_b32 v149, s56, v28
v_lshlrev_b32 v150, 16, v29
v_and_b32 v151, s56, v29
v_pk_mul_f32 v[148:149], v[148:149], v[20:21]
v_pk_mul_f32 v[150:151], v[150:151], v[22:23]
v_cvt_pk_bf16_f32 v28, v148, v149
v_cvt_pk_bf16_f32 v29, v150, v151
v_lshlrev_b32 v148, 16, v28
v_and_b32 v149, s56, v28
v_lshlrev_b32 v150, 16, v29
v_and_b32 v151, s56, v29
v_pk_add_f32 v[148:149], v[148:149], v[84:85]
v_pk_add_f32 v[150:151], v[150:151], v[86:87]
v_cvt_pk_bf16_f32 v148, v148, v149
v_cvt_pk_bf16_f32 v149, v150, v151
ds_write_b64 v244, v[148:149]
ds_read_b128 v[40:43], v5
ds_read_b128 v[44:47], v5 offset:1024
s_waitcnt lgkmcnt(1)
buffer_store_dwordx4 v[40:43], v239, s[68:71], s80 offen
s_waitcnt lgkmcnt(0)
buffer_store_dwordx4 v[44:47], v239, s[68:71], s46 offen
K_END:
s_endpgm
K_YSPIN:
s_sleep 4
s_add_u32 s100, s100, 1
s_bitcmp1_b32 s100, 19
s_cbranch_scc1 K_END
buffer_load_dword v247, v7, s[20:23], 0 offen sc0 sc1
s_waitcnt vmcnt(0)
K_YR0:
v_cmp_gt_u32 vcc, 9, v247
s_cbranch_vccnz K_YSPIN
s_sub_u32 s46, s83, 1
s_mul_i32 s48, s46, 18560
s_add_u32 s48, s48, 0x2400000
s_lshl_b32 s50, s46, 3
v_subrev_u32 v245, 1, v254
v_and_b32 v245, 0x7ff, v245
v_mul_u32_u24 v245, 0x480, v245
buffer_load_dwordx4 a[128:131], v234, s[20:23], s48 offen offset:0 sc0 sc1
buffer_load_dwordx4 a[132:135], v234, s[20:23], s48 offen offset:1024 sc0 sc1
buffer_load_dwordx4 a[136:139], v234, s[20:23], s48 offen offset:2048 sc0 sc1
buffer_load_dwordx4 a[140:143], v234, s[20:23], s48 offen offset:3072 sc0 sc1
s_add_u32 s48, s48, 4096
buffer_load_dwordx4 a[144:147], v234, s[20:23], s48 offen offset:0 sc0 sc1
buffer_load_dwordx4 a[148:151], v234, s[20:23], s48 offen offset:1024 sc0 sc1
buffer_load_dwordx4 a[152:155], v234, s[20:23], s48 offen offset:2048 sc0 sc1
buffer_load_dwordx4 a[156:159], v234, s[20:23], s48 offen offset:3072 sc0 sc1
s_add_u32 s48, s48, 4096
buffer_load_dwordx4 a[160:163], v234, s[20:23], s48 offen offset:0 sc0 sc1
buffer_load_dwordx4 a[164:167], v234, s[20:23], s48 offen offset:1024 sc0 sc1
buffer_load_dwordx4 a[168:171], v234, s[20:23], s48 offen offset:2048 sc0 sc1
buffer_load_dwordx4 a[172:175], v234, s[20:23], s48 offen offset:3072 sc0 sc1
s_add_u32 s48, s48, 4096
buffer_load_dwordx4 a[176:179], v234, s[20:23], s48 offen offset:0 sc0 sc1
buffer_load_dwordx4 a[180:183], v234, s[20:23], s48 offen offset:1024 sc0 sc1
buffer_load_dwordx4 a[184:187], v234, s[20:23], s48 offen offset:2048 sc0 sc1
buffer_load_dwordx4 a[188:191], v234, s[20:23], s48 offen offset:3072 sc0 sc1
s_add_u32 s48, s48, 4096
buffer_load_dwordx4 a[248:251], v234, s[20:23], s48 offen offset:0 sc0 sc1
buffer_load_dwordx4 a[252:255], v234, s[20:23], s48 offen offset:1024 sc0 sc1
s_mov_b64 exec, 0xff
buffer_load_dwordx2 v[134:135], v245, s[20:23], s50 offen sc0 sc1
s_mov_b64 exec, -1
s_branch K_YR0D
K_YR1:
v_accvgpr_read_b32 v112, a128
v_accvgpr_read_b32 v113, a129
v_accvgpr_read_b32 v114, a130
v_accvgpr_read_b32 v115, a131
v_accvgpr_read_b32 v116, a132
v_accvgpr_read_b32 v117, a133
v_accvgpr_read_b32 v118, a134
v_accvgpr_read_b32 v119, a135
v_pk_add_f32 v[112:113], v[112:113], v[116:117]
v_pk_add_f32 v[114:115], v[114:115], v[118:119]
v_accvgpr_read_b32 v116, a136
v_accvgpr_read_b32 v117, a137
v_accvgpr_read_b32 v118, a138
v_accvgpr_read_b32 v119, a139
v_pk_add_f32 v[112:113], v[112:113], v[116:117]
v_pk_add_f32 v[114:115], v[114:115], v[118:119]
v_accvgpr_read_b32 v116, a140
v_accvgpr_read_b32 v117, a141
v_accvgpr_read_b32 v118, a142
v_accvgpr_read_b32 v119, a143
v_pk_add_f32 v[112:113], v[112:113], v[116:117]
v_pk_add_f32 v[114:115], v[114:115], v[118:119]
v_accvgpr_read_b32 v116, a144
v_accvgpr_read_b32 v117, a145
v_accvgpr_read_b32 v118, a146
v_accvgpr_read_b32 v119, a147
v_pk_add_f32 v[112:113], v[112:113], v[116:117]
v_pk_add_f32 v[114:115], v[114:115], v[118:119]
v_accvgpr_read_b32 v116, a148
v_accvgpr_read_b32 v117, a149
v_accvgpr_read_b32 v118, a150
v_accvgpr_read_b32 v119, a151
v_pk_add_f32 v[112:113], v[112:113], v[116:117]
v_pk_add_f32 v[114:115], v[114:115], v[118:119]
v_accvgpr_read_b32 v116, a152
v_accvgpr_read_b32 v117, a153
v_accvgpr_read_b32 v118, a154
v_accvgpr_read_b32 v119, a155
v_pk_add_f32 v[112:113], v[112:113], v[116:117]
v_pk_add_f32 v[114:115], v[114:115], v[118:119]
v_accvgpr_read_b32 v116, a156
v_accvgpr_read_b32 v117, a157
v_accvgpr_read_b32 v118, a158
v_accvgpr_read_b32 v119, a159
v_pk_add_f32 v[112:113], v[112:113], v[116:117]
v_pk_add_f32 v[114:115], v[114:115], v[118:119]
v_accvgpr_read_b32 v116, a160
v_accvgpr_read_b32 v117, a161
v_accvgpr_read_b32 v118, a162
v_accvgpr_read_b32 v119, a163
v_pk_add_f32 v[112:113], v[112:113], v[116:117]
v_pk_add_f32 v[114:115], v[114:115], v[118:119]
v_accvgpr_read_b32 v116, a164
v_accvgpr_read_b32 v117, a165
v_accvgpr_read_b32 v118, a166
v_accvgpr_read_b32 v119, a167
v_pk_add_f32 v[112:113], v[112:113], v[116:117]
v_pk_add_f32 v[114:115], v[114:115], v[118:119]
v_accvgpr_read_b32 v116, a168
v_accvgpr_read_b32 v117, a169
v_accvgpr_read_b32 v118, a170
v_accvgpr_read_b32 v119, a171
v_pk_add_f32 v[112:113], v[112:113], v[116:117]
v_pk_add_f32 v[114:115], v[114:115], v[118:119]
v_accvgpr_read_b32 v116, a172
v_accvgpr_read_b32 v117, a173
v_accvgpr_read_b32 v118, a174
v_accvgpr_read_b32 v119, a175
v_pk_add_f32 v[112:113], v[112:113], v[116:117]
v_pk_add_f32 v[114:115], v[114:115], v[118:119]
v_accvgpr_read_b32 v116, a176
v_accvgpr_read_b32 v117, a177
v_accvgpr_read_b32 v118, a178
v_accvgpr_read_b32 v119, a179
v_pk_add_f32 v[112:113], v[112:113], v[116:117]
v_pk_add_f32 v[114:115], v[114:115], v[118:119]
v_accvgpr_read_b32 v116, a180
v_accvgpr_read_b32 v117, a181
v_accvgpr_read_b32 v118, a182
v_accvgpr_read_b32 v119, a183
v_pk_add_f32 v[112:113], v[112:113], v[116:117]
v_pk_add_f32 v[114:115], v[114:115], v[118:119]
v_accvgpr_read_b32 v116, a184
v_accvgpr_read_b32 v117, a185
v_accvgpr_read_b32 v118, a186
v_accvgpr_read_b32 v119, a187
v_pk_add_f32 v[112:113], v[112:113], v[116:117]
v_pk_add_f32 v[114:115], v[114:115], v[118:119]
v_accvgpr_read_b32 v116, a188
v_accvgpr_read_b32 v117, a189
v_accvgpr_read_b32 v118, a190
v_accvgpr_read_b32 v119, a191
v_pk_add_f32 v[112:113], v[112:113], v[116:117]
v_pk_add_f32 v[114:115], v[114:115], v[118:119]
v_accvgpr_read_b32 v116, a248
v_accvgpr_read_b32 v117, a249
v_accvgpr_read_b32 v118, a250
v_accvgpr_read_b32 v119, a251
v_pk_add_f32 v[112:113], v[112:113], v[116:117]
v_pk_add_f32 v[114:115], v[114:115], v[118:119]
v_accvgpr_read_b32 v116, a252
v_accvgpr_read_b32 v117, a253
v_accvgpr_read_b32 v118, a254
v_accvgpr_read_b32 v119, a255
v_pk_add_f32 v[112:113], v[112:113], v[116:117]
v_pk_add_f32 v[114:115], v[114:115], v[118:119]
v_mov_b32_dpp v34, v254 row_ror:8 row_mask:0xf bank_mask:0xf
v_mul_u32_u24 v245, 0x480, v1
v_add_f32_dpp v112, v112, v112 row_ror:8 row_mask:0xf bank_mask:0xf
v_add_f32_dpp v113, v113, v113 row_ror:8 row_mask:0xf bank_mask:0xf
v_add_f32_dpp v114, v114, v114 row_ror:8 row_mask:0xf bank_mask:0xf
v_add_f32_dpp v115, v115, v115 row_ror:8 row_mask:0xf bank_mask:0xf
v_and_b32 v34, s56, v34
v_mov_b32 v116, v112
v_mov_b32 v117, v113
v_mov_b32 v118, v114
v_mov_b32 v119, v115
v_permlane16_swap_b32 v112, v116
v_permlane16_swap_b32 v113, v117
v_permlane16_swap_b32 v114, v118
v_permlane16_swap_b32 v115, v119
v_pk_add_f32 v[112:113], v[112:113], v[116:117]
v_pk_add_f32 v[114:115], v[114:115], v[118:119]
v_mov_b32 v116, v112
v_mov_b32 v117, v113
v_mov_b32 v118, v114
v_mov_b32 v119, v115
v_permlane32_swap_b32 v112, v116
v_permlane32_swap_b32 v113, v117
v_permlane32_swap_b32 v114, v118
v_permlane32_swap_b32 v115, v119
v_pk_add_f32 v[112:113], v[112:113], v[116:117]
v_pk_add_f32 v[114:115], v[114:115], v[118:119]
v_cvt_pk_bf16_f32 v28, v112, v113
v_cvt_pk_bf16_f32 v29, v114, v115
v_lshlrev_b32 v112, 16, v28
v_and_b32 v113, s56, v28
v_lshlrev_b32 v114, 16, v29
v_and_b32 v115, s56, v29
v_mul_f32 v112, v34, v112
v_mul_f32 v113, v34, v113
v_mul_f32 v114, v34, v114
v_mul_f32 v115, v34, v115
v_cvt_pk_bf16_f32 v28, v112, v113
v_cvt_pk_bf16_f32 v29, v114, v115
v_lshlrev_b32 v112, 16, v28
v_and_b32 v113, s56, v28
v_lshlrev_b32 v114, 16, v29
v_and_b32 v115, s56, v29
v_lshlrev_b32 v116, 16, v134
v_and_b32 v117, 0xffff0000, v134
v_lshlrev_b32 v118, 16, v135
v_and_b32 v119, 0xffff0000, v135
v_pk_add_f32 v[112:113], v[112:113], v[116:117]
v_pk_add_f32 v[114:115], v[114:115], v[118:119]
v_cvt_pk_bf16_f32 v28, v112, v113
v_cvt_pk_bf16_f32 v29, v114, v115
v_lshlrev_b32 v112, 16, v28
v_and_b32 v113, s56, v28
v_lshlrev_b32 v114, 16, v29
v_and_b32 v115, s56, v29
v_mul_f32 v116, s57, v112
v_mul_f32 v117, s57, v113
v_mul_f32 v118, s57, v114
v_mul_f32 v119, s57, v115
v_exp_f32 v116, v116
v_exp_f32 v117, v117
v_exp_f32 v118, v118
v_exp_f32 v119, v119
s_nop 0
v_add_f32 v116, 1.0, v116
v_add_f32 v117, 1.0, v117
v_add_f32 v118, 1.0, v118
v_add_f32 v119, 1.0, v119
v_rcp_f32 v116, v116
v_rcp_f32 v117, v117
v_rcp_f32 v118, v118
v_rcp_f32 v119, v119
s_add_u32 s46, s50, 0x274000
v_pk_mul_f32 v[112:113], v[112:113], v[116:117]
v_pk_mul_f32 v[114:115], v[114:115], v[118:119]
v_cvt_pk_bf16_f32 v134, v112, v113
v_cvt_pk_bf16_f32 v135, v114, v115
s_mov_b64 exec, 0xff
buffer_store_dwordx2 v[134:135], v245, s[20:23], s46 offen sc0 sc1
s_mov_b64 exec, -1
s_branch K_YR1D
K_YR2:
s_waitcnt vmcnt(17)
s_and_b32 s46, s83, 15
s_lshl_b32 s46, s46, 7
s_add_u32 s46, s46, 0x272800
s_mov_b64 exec, 1
buffer_atomic_add v5, v234, s[20:23], s46 offen sc1
s_mov_b64 exec, -1
s_branch K_YR2D
K_YG:
v_mov_b32 v157, -1
K_YG1:
s_ff1_i32_b32 s46, s93
s_bitset0_b32 s93, s46
v_readlane_b32 s47, v248, s46
v_mov_b32 v158, s46
s_nop 0
v_cmp_eq_u32 vcc, s47, v3
s_cmp_lg_u32 s93, 0
s_nop 0
v_cndmask_b32 v157, v157, v158, vcc
s_cbranch_scc1 K_YG1
v_mul_u32_u24 v158, 0x480, v157
v_lshl_add_u32 v158, v4, 3, v158
s_lshl_b32 s46, s36, 8
s_add_u32 s46, s46, s82
s_add_u32 s46, s46, 0x274000
s_lshl_b32 s47, s36, 5
s_add_u32 s47, s47, 0x274400
s_branch K_YG3
K_YG2:
s_sleep 2
s_add_u32 s100, s100, 1
s_bitcmp1_b32 s100, 19
s_cbranch_scc1 K_END
buffer_load_dword v247, v6, s[20:23], 0 offen sc0 sc1
s_waitcnt vmcnt(0)
K_YG3:
v_cmp_gt_u32 vcc, 9, v247
s_cbranch_vccnz K_YG2
v_cmp_gt_u32 vcc, 8, v157
s_nop 1
s_mov_b64 exec, vcc
buffer_load_dwordx2 v[160:161], v158, s[20:23], s46 offen offset:0 sc0 sc1
buffer_load_dwordx2 v[162:163], v158, s[20:23], s46 offen offset:32 sc0 sc1
buffer_load_dwordx2 v[164:165], v158, s[20:23], s46 offen offset:64 sc0 sc1
buffer_load_dwordx2 v[166:167], v158, s[20:23], s46 offen offset:96 sc0 sc1
buffer_load_dwordx2 v[168:169], v158, s[20:23], s47 offen offset:0 sc0 sc1
s_waitcnt vmcnt(0)
v_lshlrev_b32 v8, 16, v160
v_and_b32 v9, s56, v160
v_lshlrev_b32 v10, 16, v161
v_and_b32 v11, s56, v161
v_lshlrev_b32 v12, 16, v162
v_and_b32 v13, s56, v162
v_lshlrev_b32 v14, 16, v163
v_and_b32 v15, s56, v163
v_lshlrev_b32 v16, 16, v164
v_and_b32 v17, s56, v164
v_lshlrev_b32 v18, 16, v165
v_and_b32 v19, s56, v165
v_lshlrev_b32 v20, 16, v166
v_and_b32 v21, s56, v166
v_lshlrev_b32 v22, 16, v167
v_and_b32 v23, s56, v167
v_lshlrev_b32 v24, 16, v168
v_and_b32 v25, s56, v168
v_lshlrev_b32 v26, 16, v169
v_and_b32 v27, s56, v169
s_mov_b64 exec, -1
s_branch K_YGD
K_TAIL_END:
K_HOOK:
s_lshl_b32 s48, s34, 2
s_add_u32 s48, s48, s35
s_cmp_eq_u32 s40, 3
s_cbranch_scc1 K_QTW
s_cmp_eq_u32 s40, 7
s_cbranch_scc1 K_PUB
s_memrealtime s[46:47]
s_waitcnt lgkmcnt(0)
s_sub_u32 s47, s46, s94
s_mul_i32 s47, s47, 20
s_lshr_b32 s47, s47, 2
s_add_u32 s46, s46, s47
s_lshl_b32 s46, s46, 6
s_or_b32 s46, s46, s48
s_bitset1_b32 s46, 31
v_mov_b32 v6, s46
s_lshl_b32 s48, s48, 3
s_mov_b64 exec, 1
buffer_store_dword v6, v234, s[76:79], s48 offen sc0 sc1
s_mov_b64 exec, -1
s_branch K_B4
K_QTSPIN:
s_sleep 4
s_add_u32 s100, s100, 1
s_bitcmp1_b32 s100, 19
s_cbranch_scc1 K_END
buffer_load_dwordx2 v[252:253], v251, s[76:79], 0 offen sc0 sc1
s_waitcnt vmcnt(0)
K_QTW:
s_waitcnt vmcnt(3)
v_cmp_eq_u32 vcc, 0, v252
v_cmp_eq_u32 s[88:89], 0, v253
v_readlane_b32 s46, v252, s48
v_mov_b32 v254, v253
s_and_b32 s88, s88, 0xffff
s_or_b32 s88, s88, vcc_lo
s_or_b32 s88, s88, vcc_hi
v_cmp_gt_u32 vcc, s46, v252
s_cbranch_scc1 K_QTSPIN
s_bcnt1_i32_b64 s46, vcc
s_cmp_ge_u32 s46, 36
s_cbranch_scc1 K_B4
s_lshl_b32 s52, s46, 2
s_add_u32 s52, s52, s36
s_lshl_b32 s50, s52, 6
s_mul_i32 s90, s32, 294912
s_add_u32 s90, s90, s50
v_mfma_f32_16x16x32_bf16 v[40:43], a[128:131], v[152:155], v[136:139]
v_exp_f32 v8, v8
v_mfma_f32_16x16x32_bf16 v[40:43], a[132:135], v[156:159], v[40:43]
v_exp_f32 v9, v9
v_mfma_f32_16x16x32_bf16 v[40:43], a[136:139], v[160:163], v[40:43]
v_cvt_pk_bf16_f32 v72, v8, v9
v_lshlrev_b32 v5, 2, v4
v_mfma_f32_16x16x32_bf16 v[40:43], a[140:143], v[164:167], v[40:43]
v_exp_f32 v10, v10
v_mfma_f32_16x16x32_bf16 a[0:3], a[160:163], v[88:91], a[0:3]
v_add_u32 v6, 16, v5
v_and_b32 v7, 28, v1
v_mfma_f32_16x16x32_bf16 a[32:35], a[160:163], v[92:95], a[32:35]
v_exp_f32 v11, v11
s_waitcnt vmcnt(4) lgkmcnt(0)
s_barrier
v_mfma_f32_16x16x32_bf16 a[64:67], a[160:163], v[96:99], a[64:67]
ds_bpermute_b32 v5, v5, v254
v_cvt_pk_bf16_f32 v73, v10, v11
v_mfma_f32_16x16x32_bf16 a[96:99], a[160:163], v[100:103], a[96:99]
s_add_u32 m0, s37, 98304
v_exp_f32 v12, v12
v_mfma_f32_16x16x32_bf16 v[48:51], a[128:131], v[168:171], v[140:143]
buffer_load_dwordx4 v232, s[12:15], s39 offen offset:0 lds
v_mfma_f32_16x16x32_bf16 v[48:51], a[132:135], v[172:175], v[48:51]
v_exp_f32 v13, v13
v_mfma_f32_16x16x32_bf16 v[48:51], a[136:139], v[176:179], v[48:51]
ds_read_b64_tr_b16 a[160:161], v220 offset:0
ds_read_b64_tr_b16 a[162:163], v220 offset:4096
v_mfma_f32_16x16x32_bf16 v[48:51], a[140:143], v[180:183], v[48:51]
v_exp_f32 v14, v14
v_mfma_f32_16x16x32_bf16 a[4:7], a[164:167], v[88:91], a[4:7]
s_add_u32 m0, s49, 4096
ds_bpermute_b32 v6, v6, v254
v_cvt_pk_bf16_f32 v74, v12, v13
v_mfma_f32_16x16x32_bf16 a[36:39], a[164:167], v[92:95], a[36:39]
s_add_u32 s48, s90, 4718592
v_exp_f32 v15, v15
v_mfma_f32_16x16x32_bf16 a[68:71], a[164:167], v[96:99], a[68:71]
buffer_load_dwordx4 v238, s[56:59], s48 offen  lds
v_mfma_f32_16x16x32_bf16 a[100:103], a[164:167], v[100:103], a[100:103]
v_exp_f32 v16, v16
v_smfmac_f32_16x16x64_bf16 a[248:251], a[208:211], v[88:95], v235
ds_read_b64_tr_b16 a[164:165], v221 offset:0
ds_read_b64_tr_b16 a[166:167], v221 offset:4096
v_mfma_f32_16x16x32_bf16 v[56:59], a[128:131], v[184:187], v[144:147]
v_exp_f32 v17, v17
v_mfma_f32_16x16x32_bf16 v[56:59], a[132:135], v[188:191], v[56:59]
s_add_u32 m0, s37, 98304
v_cvt_pk_bf16_f32 v75, v14, v15
v_cvt_pk_bf16_f32 v76, v16, v17
v_mfma_f32_16x16x32_bf16 v[56:59], a[136:139], v[192:195], v[56:59]
v_exp_f32 v18, v18
v_mfma_f32_16x16x32_bf16 v[56:59], a[140:143], v[196:199], v[56:59]
buffer_load_dwordx4 v233, s[12:15], s39 offen offset:1024 lds
v_mfma_f32_16x16x32_bf16 a[8:11], a[168:171], v[88:91], a[8:11]
v_exp_f32 v19, v19
v_mfma_f32_16x16x32_bf16 a[40:43], a[168:171], v[92:95], a[40:43]
ds_bpermute_b32 v7, v7, v254
v_cvt_pk_bf16_f32 v77, v18, v19
v_mfma_f32_16x16x32_bf16 a[72:75], a[168:171], v[96:99], a[72:75]
s_add_u32 m0, s49, 5120
v_exp_f32 v20, v20
v_mfma_f32_16x16x32_bf16 a[104:107], a[168:171], v[100:103], a[104:107]
s_add_u32 s48, s90, 4866048
buffer_load_dwordx4 v238, s[56:59], s48 offen  lds
v_mfma_f32_16x16x32_bf16 v[64:67], a[128:131], v[200:203], v[148:151]
s_mul_i32 s91, s52, 36864
v_exp_f32 v21, v21
v_mfma_f32_16x16x32_bf16 v[64:67], a[132:135], v[204:207], v[64:67]
s_lshl_b32 s46, s32, 5
ds_read_b64_tr_b16 a[168:169], v222 offset:0
ds_read_b64_tr_b16 a[170:171], v222 offset:4096
v_mfma_f32_16x16x32_bf16 v[64:67], a[136:139], v[208:211], v[64:67]
s_add_u32 s92, s91, s46
v_exp_f32 v22, v22
v_mfma_f32_16x16x32_bf16 v[64:67], a[140:143], v[212:215], v[64:67]
s_mul_i32 s46, s32, 1179648
ds_read_b128 a[128:131], v216 offset:49152
ds_read_b128 a[132:135], v217 offset:49152
v_mfma_f32_16x16x32_bf16 a[12:15], a[172:175], v[88:91], a[12:15]
s_add_u32 m0, s37, 98304
v_exp_f32 v23, v23
v_mfma_f32_16x16x32_bf16 a[44:47], a[172:175], v[92:95], a[44:47]
s_add_u32 s50, s50, s46
buffer_load_dwordx4 v232, s[12:15], s39 offen offset:2048 lds
v_mfma_f32_16x16x32_bf16 a[76:79], a[172:175], v[96:99], a[76:79]
s_lshl_b32 s46, s32, 8
v_exp_f32 v24, v24
v_mfma_f32_16x16x32_bf16 a[108:111], a[172:175], v[100:103], a[108:111]
s_add_u32 s91, s91, s46
v_exp_f32 v25, v25
v_mfma_f32_16x16x32_bf16 v[44:47], a[144:147], v[152:155], v[136:139]
s_and_b32 s47, s32, 1
ds_read_b128 a[136:139], v218 offset:49152
ds_read_b128 a[140:143], v219 offset:49152
v_mfma_f32_16x16x32_bf16 v[44:47], a[148:151], v[156:159], v[44:47]
s_lshl_b32 s47, s47, 6
v_exp_f32 v26, v26
v_mfma_f32_16x16x32_bf16 v[44:47], a[152:155], v[160:163], v[44:47]
s_add_u32 m0, s49, 6144
ds_read_b64_tr_b16 a[172:173], v223 offset:0
ds_read_b64_tr_b16 a[174:175], v223 offset:4096
v_mfma_f32_16x16x32_bf16 v[44:47], a[156:159], v[164:167], v[44:47]
s_add_u32 s48, s90, 4718592
v_exp_f32 v27, v27
v_mfma_f32_16x16x32_bf16 a[16:19], a[176:179], v[88:91], a[16:19]
s_add_u32 s47, s47, 1024
buffer_load_dwordx4 v238, s[60:63], s48 offen  lds
v_mfma_f32_16x16x32_bf16 a[48:51], a[176:179], v[92:95], a[48:51]
s_mov_b32 s88, 0x480
v_exp_f32 v28, v28
v_mfma_f32_16x16x32_bf16 a[80:83], a[176:179], v[96:99], a[80:83]
v_cvt_pk_bf16_f32 v78, v20, v21
v_cvt_pk_bf16_f32 v79, v22, v23
v_mfma_f32_16x16x32_bf16 a[112:115], a[176:179], v[100:103], a[112:115]
s_add_u32 m0, s37, 98304
v_exp_f32 v29, v29
v_mfma_f32_16x16x32_bf16 v[52:55], a[144:147], v[168:171], v[140:143]
buffer_load_dwordx4 v233, s[12:15], s39 offen offset:3072 lds
v_mfma_f32_16x16x32_bf16 v[52:55], a[148:151], v[172:175], v[52:55]
v_exp_f32 v30, v30
v_mfma_f32_16x16x32_bf16 v[52:55], a[152:155], v[176:179], v[52:55]
ds_read_b64_tr_b16 a[176:177], v224 offset:0
ds_read_b64_tr_b16 a[178:179], v224 offset:4096
v_mfma_f32_16x16x32_bf16 v[52:55], a[156:159], v[180:183], v[52:55]
v_exp_f32 v31, v31
v_mfma_f32_16x16x32_bf16 a[20:23], a[180:183], v[88:91], a[20:23]
v_cvt_pk_bf16_f32 v80, v24, v25
v_cvt_pk_bf16_f32 v81, v26, v27
v_mfma_f32_16x16x32_bf16 a[52:55], a[180:183], v[92:95], a[52:55]
s_add_u32 m0, s49, 7168
v_exp_f32 v32, v32
v_mfma_f32_16x16x32_bf16 a[84:87], a[180:183], v[96:99], a[84:87]
s_add_u32 s48, s90, 4866048
buffer_load_dwordx4 v238, s[60:63], s48 offen  lds
v_mfma_f32_16x16x32_bf16 a[116:119], a[180:183], v[100:103], a[116:119]
v_exp_f32 v33, v33
v_smfmac_f32_16x16x64_bf16 a[252:255], a[208:211], v[96:103], v235
ds_read_b64_tr_b16 a[180:181], v225 offset:0
ds_read_b64_tr_b16 a[182:183], v225 offset:4096
v_mfma_f32_16x16x32_bf16 v[60:63], a[144:147], v[184:187], v[144:147]
v_exp_f32 v34, v34
v_mfma_f32_16x16x32_bf16 v[60:63], a[148:151], v[188:191], v[60:63]
s_add_u32 s39, s39, 16384
v_cvt_pk_bf16_f32 v82, v28, v29
v_cvt_pk_bf16_f32 v83, v30, v31
v_mfma_f32_16x16x32_bf16 v[60:63], a[152:155], v[192:195], v[60:63]
s_add_u32 m0, s37, 16384
v_exp_f32 v35, v35
v_mfma_f32_16x16x32_bf16 v[60:63], a[156:159], v[196:199], v[60:63]
buffer_load_dwordx4 v228, s[8:11], s38 offen offset:0 lds
v_mfma_f32_16x16x32_bf16 a[24:27], a[184:187], v[88:91], a[24:27]
v_exp_f32 v36, v36
v_mfma_f32_16x16x32_bf16 a[56:59], a[184:187], v[92:95], a[56:59]
v_cvt_pk_bf16_f32 v84, v32, v33
v_cvt_pk_bf16_f32 v85, v34, v35
v_mfma_f32_16x16x32_bf16 a[88:91], a[184:187], v[96:99], a[88:91]
v_exp_f32 v37, v37
v_mfma_f32_16x16x32_bf16 a[120:123], a[184:187], v[100:103], a[120:123]
buffer_load_dwordx4 v229, s[8:11], s38 offen offset:1024 lds
v_mfma_f32_16x16x32_bf16 v[68:71], a[144:147], v[200:203], v[148:151]
v_exp_f32 v38, v38
v_mfma_f32_16x16x32_bf16 v[68:71], a[148:151], v[204:207], v[68:71]
ds_read_b64_tr_b16 a[184:185], v226 offset:0
ds_read_b64_tr_b16 a[186:187], v226 offset:4096
v_mfma_f32_16x16x32_bf16 v[68:71], a[152:155], v[208:211], v[68:71]
v_exp_f32 v39, v39
v_mfma_f32_16x16x32_bf16 v[68:71], a[156:159], v[212:215], v[68:71]
ds_read_b128 a[144:147], v216 offset:53248
ds_read_b128 a[148:151], v217 offset:53248
v_mfma_f32_16x16x32_bf16 a[28:31], a[188:191], v[88:91], a[28:31]
ds_read_b128 a[152:155], v218 offset:53248
ds_read_b128 a[156:159], v219 offset:53248
v_mfma_f32_16x16x32_bf16 a[60:63], a[188:191], v[92:95], a[60:63]
v_cvt_pk_bf16_f32 v86, v36, v37
v_cvt_pk_bf16_f32 v87, v38, v39
v_mfma_f32_16x16x32_bf16 a[92:95], a[188:191], v[96:99], a[92:95]
v_and_b32 v250, 3, v1
v_mfma_f32_16x16x32_bf16 a[124:127], a[188:191], v[100:103], a[124:127]
s_waitcnt lgkmcnt(6)
ds_read_b64_tr_b16 a[188:189], v227 offset:0
ds_read_b64_tr_b16 a[190:191], v227 offset:4096
v_mfma_f32_16x16x32_bf16 v[8:11], a[128:131], v[152:155], v[136:139]
v_exp_f32 v40, v40
v_mfma_f32_16x16x32_bf16 v[8:11], a[132:135], v[156:159], v[8:11]
v_exp_f32 v41, v41
v_mfma_f32_16x16x32_bf16 v[8:11], a[136:139], v[160:163], v[8:11]
buffer_load_dwordx4 v230, s[8:11], s38 offen offset:2048 lds
v_mfma_f32_16x16x32_bf16 v[8:11], a[140:143], v[164:167], v[8:11]
v_exp_f32 v42, v42
v_mfma_f32_16x16x32_bf16 a[0:3], a[160:163], v[72:75], a[0:3]
v_cvt_pk_bf16_f32 v88, v40, v41
v_lshlrev_b32 v244, 1, v4
v_mfma_f32_16x16x32_bf16 a[32:35], a[160:163], v[76:79], a[32:35]
v_exp_f32 v43, v43
v_mfma_f32_16x16x32_bf16 a[64:67], a[160:163], v[80:83], a[64:67]
v_cvt_pk_bf16_f32 v89, v42, v43
v_xor_b32 v244, v244, v3
v_mfma_f32_16x16x32_bf16 a[96:99], a[160:163], v[84:87], a[96:99]
v_exp_f32 v44, v44
v_mfma_f32_16x16x32_bf16 v[16:19], a[128:131], v[168:171], v[140:143]
ds_read_b64_tr_b16 a[160:161], v220 offset:8192
ds_read_b64_tr_b16 a[162:163], v220 offset:12288
v_mfma_f32_16x16x32_bf16 v[16:19], a[132:135], v[172:175], v[16:19]
v_exp_f32 v45, v45
v_mfma_f32_16x16x32_bf16 v[16:19], a[136:139], v[176:179], v[16:19]
v_cvt_pk_bf16_f32 v90, v44, v45
v_lshlrev_b32 v244, 4, v244
v_mfma_f32_16x16x32_bf16 v[16:19], a[140:143], v[180:183], v[16:19]
v_exp_f32 v46, v46
v_mfma_f32_16x16x32_bf16 a[4:7], a[164:167], v[72:75], a[4:7]
v_xor_b32 v245, 128, v244
v_subrev_u32 v244, 0x480, v244
v_mfma_f32_16x16x32_bf16 a[36:39], a[164:167], v[76:79], a[36:39]
v_exp_f32 v47, v47
v_mfma_f32_16x16x32_bf16 a[68:71], a[164:167], v[80:83], a[68:71]
buffer_load_dwordx4 v231, s[8:11], s38 offen offset:3072 lds
v_mfma_f32_16x16x32_bf16 a[100:103], a[164:167], v[84:87], a[100:103]
v_exp_f32 v48, v48
v_smfmac_f32_16x16x64_bf16 a[248:251], a[208:211], v[72:79], v235
ds_read_b64_tr_b16 a[164:165], v221 offset:8192
ds_read_b64_tr_b16 a[166:167], v221 offset:12288
v_mfma_f32_16x16x32_bf16 v[24:27], a[128:131], v[184:187], v[144:147]
v_exp_f32 v49, v49
v_mfma_f32_16x16x32_bf16 v[24:27], a[132:135], v[188:191], v[24:27]
v_cvt_pk_bf16_f32 v91, v46, v47
v_cvt_pk_bf16_f32 v92, v48, v49
v_mfma_f32_16x16x32_bf16 v[24:27], a[136:139], v[192:195], v[24:27]
v_exp_f32 v50, v50
v_mfma_f32_16x16x32_bf16 v[24:27], a[140:143], v[196:199], v[24:27]
v_subrev_u32 v245, 0x480, v245
v_lshlrev_b32 v246, 4, v250
v_mfma_f32_16x16x32_bf16 a[8:11], a[168:171], v[72:75], a[8:11]
v_exp_f32 v51, v51
v_mfma_f32_16x16x32_bf16 a[40:43], a[168:171], v[76:79], a[40:43]
v_cvt_pk_bf16_f32 v93, v50, v51
v_subrev_u32 v246, 0x480, v246
v_mfma_f32_16x16x32_bf16 a[72:75], a[168:171], v[80:83], a[72:75]
v_exp_f32 v52, v52
v_mfma_f32_16x16x32_bf16 a[104:107], a[168:171], v[84:87], a[104:107]
ds_read_b64_tr_b16 a[168:169], v222 offset:8192
ds_read_b64_tr_b16 a[170:171], v222 offset:12288
v_mfma_f32_16x16x32_bf16 v[32:35], a[128:131], v[200:203], v[148:151]
s_add_u32 s38, s38, 16384
v_exp_f32 v53, v53
v_mfma_f32_16x16x32_bf16 v[32:35], a[132:135], v[204:207], v[32:35]
s_add_u32 m0, s37, 114688
ds_read_b128 a[128:131], v216 offset:57344
ds_read_b128 a[132:135], v217 offset:57344
v_mfma_f32_16x16x32_bf16 v[32:35], a[136:139], v[208:211], v[32:35]
v_exp_f32 v54, v54
v_mfma_f32_16x16x32_bf16 v[32:35], a[140:143], v[212:215], v[32:35]
buffer_load_dwordx4 v232, s[12:15], s39 offen offset:0 lds
v_mfma_f32_16x16x32_bf16 a[12:15], a[172:175], v[72:75], a[12:15]
v_exp_f32 v55, v55
v_mfma_f32_16x16x32_bf16 a[44:47], a[172:175], v[76:79], a[44:47]
ds_read_b128 a[136:139], v218 offset:57344
ds_read_b128 a[140:143], v219 offset:57344
v_mfma_f32_16x16x32_bf16 a[76:79], a[172:175], v[80:83], a[76:79]
v_exp_f32 v56, v56
v_mfma_f32_16x16x32_bf16 a[108:111], a[172:175], v[84:87], a[108:111]
s_waitcnt lgkmcnt(6)
v_exp_f32 v57, v57
v_mfma_f32_16x16x32_bf16 v[12:15], a[144:147], v[152:155], v[136:139]
ds_read_b64_tr_b16 a[172:173], v223 offset:8192
ds_read_b64_tr_b16 a[174:175], v223 offset:12288
v_mfma_f32_16x16x32_bf16 v[12:15], a[148:151], v[156:159], v[12:15]
v_exp_f32 v58, v58
v_mfma_f32_16x16x32_bf16 v[12:15], a[152:155], v[160:163], v[12:15]
v_cvt_pk_bf16_f32 v94, v52, v53
v_cvt_pk_bf16_f32 v95, v54, v55
v_mfma_f32_16x16x32_bf16 v[12:15], a[156:159], v[164:167], v[12:15]
v_exp_f32 v59, v59
v_mfma_f32_16x16x32_bf16 a[16:19], a[176:179], v[72:75], a[16:19]
v_cvt_pk_bf16_f32 v96, v56, v57
v_cvt_pk_bf16_f32 v97, v58, v59
v_mfma_f32_16x16x32_bf16 a[48:51], a[176:179], v[76:79], a[48:51]
v_exp_f32 v60, v60
v_mfma_f32_16x16x32_bf16 a[80:83], a[176:179], v[80:83], a[80:83]
buffer_load_dwordx4 v233, s[12:15], s39 offen offset:1024 lds
v_mfma_f32_16x16x32_bf16 a[112:115], a[176:179], v[84:87], a[112:115]
v_exp_f32 v61, v61
v_mfma_f32_16x16x32_bf16 v[20:23], a[144:147], v[168:171], v[140:143]
ds_read_b64_tr_b16 a[176:177], v224 offset:8192
ds_read_b64_tr_b16 a[178:179], v224 offset:12288
v_mfma_f32_16x16x32_bf16 v[20:23], a[148:151], v[172:175], v[20:23]
v_exp_f32 v62, v62
v_mfma_f32_16x16x32_bf16 v[20:23], a[152:155], v[176:179], v[20:23]
v_cvt_pk_bf16_f32 v98, v60, v61
v_mad_u32_u24 v5, v5, s88, v244
v_mfma_f32_16x16x32_bf16 v[20:23], a[156:159], v[180:183], v[20:23]
v_exp_f32 v63, v63
v_mfma_f32_16x16x32_bf16 a[20:23], a[180:183], v[72:75], a[20:23]
v_cvt_pk_bf16_f32 v99, v62, v63
v_mad_u32_u24 v6, v6, s88, v245
v_mfma_f32_16x16x32_bf16 a[52:55], a[180:183], v[76:79], a[52:55]
v_exp_f32 v64, v64
v_mfma_f32_16x16x32_bf16 a[84:87], a[180:183], v[80:83], a[84:87]
v_mad_u32_u24 v7, v7, s88, v246
v_lshrrev_b32 v249, 1, v1
v_mfma_f32_16x16x32_bf16 a[116:119], a[180:183], v[84:87], a[116:119]
v_exp_f32 v65, v65
v_smfmac_f32_16x16x64_bf16 a[252:255], a[208:211], v[80:87], v235
ds_read_b64_tr_b16 a[180:181], v225 offset:8192
ds_read_b64_tr_b16 a[182:183], v225 offset:12288
v_mfma_f32_16x16x32_bf16 v[28:31], a[144:147], v[184:187], v[144:147]
v_exp_f32 v66, v66
v_mfma_f32_16x16x32_bf16 v[28:31], a[148:151], v[188:191], v[28:31]
buffer_load_dwordx4 v232, s[12:15], s39 offen offset:2048 lds
v_mfma_f32_16x16x32_bf16 v[28:31], a[152:155], v[192:195], v[28:31]
v_exp_f32 v67, v67
v_mfma_f32_16x16x32_bf16 v[28:31], a[156:159], v[196:199], v[28:31]
v_cvt_pk_bf16_f32 v100, v64, v65
v_cvt_pk_bf16_f32 v101, v66, v67
v_mfma_f32_16x16x32_bf16 a[24:27], a[184:187], v[72:75], a[24:27]
v_exp_f32 v68, v68
v_mfma_f32_16x16x32_bf16 a[56:59], a[184:187], v[76:79], a[56:59]
v_mul_u32_u24 v249, 0x480, v249
v_and_b32 v248, 1, v1
v_mfma_f32_16x16x32_bf16 a[88:91], a[184:187], v[80:83], a[88:91]
v_exp_f32 v69, v69
v_mfma_f32_16x16x32_bf16 a[120:123], a[184:187], v[84:87], a[120:123]
ds_read_b64_tr_b16 a[184:185], v226 offset:8192
ds_read_b64_tr_b16 a[186:187], v226 offset:12288
v_mfma_f32_16x16x32_bf16 v[36:39], a[144:147], v[200:203], v[148:151]
v_exp_f32 v70, v70
v_mfma_f32_16x16x32_bf16 v[36:39], a[148:151], v[204:207], v[36:39]
ds_read_b128 a[144:147], v216 offset:61440
ds_read_b128 a[148:151], v217 offset:61440
v_mfma_f32_16x16x32_bf16 v[36:39], a[152:155], v[208:211], v[36:39]
v_exp_f32 v71, v71
v_mfma_f32_16x16x32_bf16 v[36:39], a[156:159], v[212:215], v[36:39]
ds_read_b128 a[152:155], v218 offset:61440
ds_read_b128 a[156:159], v219 offset:61440
v_mfma_f32_16x16x32_bf16 a[28:31], a[188:191], v[72:75], a[28:31]
v_cvt_pk_bf16_f32 v102, v68, v69
v_cvt_pk_bf16_f32 v103, v70, v71
v_mfma_f32_16x16x32_bf16 a[60:63], a[188:191], v[76:79], a[60:63]
v_lshl_add_u32 v249, v248, 4, v249
v_bfe_u32 v248, v1, 2, 2
v_mfma_f32_16x16x32_bf16 a[92:95], a[188:191], v[80:83], a[92:95]
v_lshl_add_u32 v248, v4, 3, v248
v_lshlrev_b32 v248, 6, v248
v_mfma_f32_16x16x32_bf16 a[124:127], a[188:191], v[84:87], a[124:127]
s_waitcnt lgkmcnt(6)
ds_read_b64_tr_b16 a[188:189], v227 offset:8192
ds_read_b64_tr_b16 a[190:191], v227 offset:12288
v_lshl_add_u32 v248, v250, 3, v248
v_mfma_f32_16x16x32_bf16 v[40:43], a[128:131], v[152:155], v[136:139]
v_exp_f32 v8, v8
v_mfma_f32_16x16x32_bf16 v[40:43], a[132:135], v[156:159], v[40:43]
s_add_u32 m0, s49, 0
v_exp_f32 v9, v9
v_mfma_f32_16x16x32_bf16 v[40:43], a[136:139], v[160:163], v[40:43]
buffer_load_dwordx4 v5, s[20:23], s46 offen sc0 sc1 lds
v_mfma_f32_16x16x32_bf16 v[40:43], a[140:143], v[164:167], v[40:43]
v_exp_f32 v10, v10
v_mfma_f32_16x16x32_bf16 a[0:3], a[160:163], v[88:91], a[0:3]
v_cvt_pk_bf16_f32 v72, v8, v9
v_add_u32 v248, s49, v248
v_mfma_f32_16x16x32_bf16 a[32:35], a[160:163], v[92:95], a[32:35]
v_exp_f32 v11, v11
v_mfma_f32_16x16x32_bf16 a[64:67], a[160:163], v[96:99], a[64:67]
v_cvt_pk_bf16_f32 v73, v10, v11
v_and_b32 v244, 7, v1
v_mfma_f32_16x16x32_bf16 a[96:99], a[160:163], v[100:103], a[96:99]
s_add_u32 m0, s49, 1024
v_exp_f32 v12, v12
v_mfma_f32_16x16x32_bf16 v[48:51], a[128:131], v[168:171], v[140:143]
buffer_load_dwordx4 v6, s[20:23], s46 offen sc0 sc1 lds
v_mfma_f32_16x16x32_bf16 v[48:51], a[132:135], v[172:175], v[48:51]
v_exp_f32 v13, v13
v_mfma_f32_16x16x32_bf16 v[48:51], a[136:139], v[176:179], v[48:51]
ds_read_b64_tr_b16 a[160:161], v220 offset:16384
ds_read_b64_tr_b16 a[162:163], v220 offset:20480
v_mfma_f32_16x16x32_bf16 v[48:51], a[140:143], v[180:183], v[48:51]
v_exp_f32 v14, v14
v_mfma_f32_16x16x32_bf16 a[4:7], a[164:167], v[88:91], a[4:7]
v_cvt_pk_bf16_f32 v74, v12, v13
v_lshlrev_b32 v245, 1, v244
v_mfma_f32_16x16x32_bf16 a[36:39], a[164:167], v[92:95], a[36:39]
v_exp_f32 v15, v15
v_mfma_f32_16x16x32_bf16 a[68:71], a[164:167], v[96:99], a[68:71]
s_add_u32 m0, s49, 2048
v_cvt_pk_bf16_f32 v75, v14, v15
v_xor_b32 v245, v245, v4
v_mfma_f32_16x16x32_bf16 a[100:103], a[164:167], v[100:103], a[100:103]
v_exp_f32 v16, v16
v_smfmac_f32_16x16x64_bf16 a[248:251], a[208:211], v[88:95], v235
buffer_load_dwordx4 v7, s[20:23], s47 offen sc0 sc1 lds
v_mfma_f32_16x16x32_bf16 v[56:59], a[128:131], v[184:187], v[144:147]
v_exp_f32 v17, v17
v_mfma_f32_16x16x32_bf16 v[56:59], a[132:135], v[188:191], v[56:59]
ds_read_b64_tr_b16 a[164:165], v221 offset:16384
ds_read_b64_tr_b16 a[166:167], v221 offset:20480
v_mfma_f32_16x16x32_bf16 v[56:59], a[136:139], v[192:195], v[56:59]
v_exp_f32 v18, v18
v_mfma_f32_16x16x32_bf16 v[56:59], a[140:143], v[196:199], v[56:59]
v_cvt_pk_bf16_f32 v76, v16, v17
v_lshlrev_b32 v245, 4, v245
v_mfma_f32_16x16x32_bf16 a[8:11], a[168:171], v[88:91], a[8:11]
s_add_u32 m0, s49, 3072
v_exp_f32 v19, v19
v_mfma_f32_16x16x32_bf16 a[40:43], a[168:171], v[92:95], a[40:43]
s_add_u32 s48, s92, 1024
buffer_load_dwordx4 v249, s[64:67], s48 offen  lds
v_mfma_f32_16x16x32_bf16 a[72:75], a[168:171], v[96:99], a[72:75]
v_exp_f32 v20, v20
v_mfma_f32_16x16x32_bf16 a[104:107], a[168:171], v[100:103], a[104:107]
ds_read_b64_tr_b16 a[168:169], v222 offset:16384
ds_read_b64_tr_b16 a[170:171], v222 offset:20480
v_mfma_f32_16x16x32_bf16 v[64:67], a[128:131], v[200:203], v[148:151]
v_exp_f32 v21, v21
v_mfma_f32_16x16x32_bf16 v[64:67], a[132:135], v[204:207], v[64:67]
ds_read_b128 a[128:131], v216 offset:32768
ds_read_b128 a[132:135], v217 offset:32768
v_mfma_f32_16x16x32_bf16 v[64:67], a[136:139], v[208:211], v[64:67]
v_exp_f32 v22, v22
v_mfma_f32_16x16x32_bf16 v[64:67], a[140:143], v[212:215], v[64:67]
s_add_u32 m0, s37, 114688
ds_read_b128 a[136:139], v218 offset:32768
ds_read_b128 a[140:143], v219 offset:32768
v_mfma_f32_16x16x32_bf16 a[12:15], a[172:175], v[88:91], a[12:15]
v_exp_f32 v23, v23
v_mfma_f32_16x16x32_bf16 a[44:47], a[172:175], v[92:95], a[44:47]
buffer_load_dwordx4 v233, s[12:15], s39 offen offset:3072 lds
v_mfma_f32_16x16x32_bf16 a[76:79], a[172:175], v[96:99], a[76:79]
v_exp_f32 v24, v24
v_mfma_f32_16x16x32_bf16 a[108:111], a[172:175], v[100:103], a[108:111]
s_waitcnt lgkmcnt(6)
v_exp_f32 v25, v25
v_mfma_f32_16x16x32_bf16 v[44:47], a[144:147], v[152:155], v[136:139]
ds_read_b64_tr_b16 a[172:173], v223 offset:16384
ds_read_b64_tr_b16 a[174:175], v223 offset:20480
v_mfma_f32_16x16x32_bf16 v[44:47], a[148:151], v[156:159], v[44:47]
v_exp_f32 v26, v26
v_mfma_f32_16x16x32_bf16 v[44:47], a[152:155], v[160:163], v[44:47]
s_add_u32 s39, s39, 16384
v_cvt_pk_bf16_f32 v77, v18, v19
v_cvt_pk_bf16_f32 v78, v20, v21
v_mfma_f32_16x16x32_bf16 v[44:47], a[156:159], v[164:167], v[44:47]
s_add_u32 m0, s37, 0
v_exp_f32 v27, v27
v_mfma_f32_16x16x32_bf16 a[16:19], a[176:179], v[88:91], a[16:19]
buffer_load_dwordx4 v228, s[8:11], s38 offen offset:0 lds
v_mfma_f32_16x16x32_bf16 a[48:51], a[176:179], v[92:95], a[48:51]
v_exp_f32 v28, v28
v_mfma_f32_16x16x32_bf16 a[80:83], a[176:179], v[96:99], a[80:83]
v_cvt_pk_bf16_f32 v79, v22, v23
v_cvt_pk_bf16_f32 v80, v24, v25
v_mfma_f32_16x16x32_bf16 a[112:115], a[176:179], v[100:103], a[112:115]
v_exp_f32 v29, v29
v_mfma_f32_16x16x32_bf16 v[52:55], a[144:147], v[168:171], v[140:143]
ds_read_b64_tr_b16 a[176:177], v224 offset:16384
ds_read_b64_tr_b16 a[178:179], v224 offset:20480
v_mfma_f32_16x16x32_bf16 v[52:55], a[148:151], v[172:175], v[52:55]
v_exp_f32 v30, v30
v_mfma_f32_16x16x32_bf16 v[52:55], a[152:155], v[176:179], v[52:55]
buffer_load_dwordx4 v229, s[8:11], s38 offen offset:1024 lds
v_mfma_f32_16x16x32_bf16 v[52:55], a[156:159], v[180:183], v[52:55]
v_exp_f32 v31, v31
v_mfma_f32_16x16x32_bf16 a[20:23], a[180:183], v[88:91], a[20:23]
v_cvt_pk_bf16_f32 v81, v26, v27
v_cvt_pk_bf16_f32 v82, v28, v29
v_mfma_f32_16x16x32_bf16 a[52:55], a[180:183], v[92:95], a[52:55]
v_exp_f32 v32, v32
v_mfma_f32_16x16x32_bf16 a[84:87], a[180:183], v[96:99], a[84:87]
v_cvt_pk_bf16_f32 v83, v30, v31
v_lshl_add_u32 v245, v244, 8, v245
v_mfma_f32_16x16x32_bf16 a[116:119], a[180:183], v[100:103], a[116:119]
v_exp_f32 v33, v33
v_smfmac_f32_16x16x64_bf16 a[252:255], a[208:211], v[96:103], v235
buffer_load_dwordx4 v230, s[8:11], s38 offen offset:2048 lds
v_mfma_f32_16x16x32_bf16 v[60:63], a[144:147], v[184:187], v[144:147]
v_exp_f32 v34, v34
v_mfma_f32_16x16x32_bf16 v[60:63], a[148:151], v[188:191], v[60:63]
ds_read_b64_tr_b16 a[180:181], v225 offset:16384
ds_read_b64_tr_b16 a[182:183], v225 offset:20480
v_mfma_f32_16x16x32_bf16 v[60:63], a[152:155], v[192:195], v[60:63]
v_exp_f32 v35, v35
v_mfma_f32_16x16x32_bf16 v[60:63], a[156:159], v[196:199], v[60:63]
v_cvt_pk_bf16_f32 v84, v32, v33
v_cvt_pk_bf16_f32 v85, v34, v35
v_mfma_f32_16x16x32_bf16 a[24:27], a[184:187], v[88:91], a[24:27]
v_exp_f32 v36, v36
v_mfma_f32_16x16x32_bf16 a[56:59], a[184:187], v[92:95], a[56:59]
v_add_u32 v245, s49, v245
v_lshlrev_b32 v246, 4, v4
v_mfma_f32_16x16x32_bf16 a[88:91], a[184:187], v[96:99], a[88:91]
v_exp_f32 v37, v37
v_mfma_f32_16x16x32_bf16 a[120:123], a[184:187], v[100:103], a[120:123]
buffer_load_dwordx4 v231, s[8:11], s38 offen offset:3072 lds
v_mfma_f32_16x16x32_bf16 v[68:71], a[144:147], v[200:203], v[148:151]
v_exp_f32 v38, v38
v_mfma_f32_16x16x32_bf16 v[68:71], a[148:151], v[204:207], v[68:71]
ds_read_b64_tr_b16 a[184:185], v226 offset:16384
ds_read_b64_tr_b16 a[186:187], v226 offset:20480
v_mfma_f32_16x16x32_bf16 v[68:71], a[152:155], v[208:211], v[68:71]
v_exp_f32 v39, v39
v_mfma_f32_16x16x32_bf16 v[68:71], a[156:159], v[212:215], v[68:71]
ds_read_b128 a[144:147], v216 offset:36864
ds_read_b128 a[148:151], v217 offset:36864
v_mfma_f32_16x16x32_bf16 a[28:31], a[188:191], v[88:91], a[28:31]
ds_read_b128 a[152:155], v218 offset:36864
ds_read_b128 a[156:159], v219 offset:36864
v_mfma_f32_16x16x32_bf16 a[60:63], a[188:191], v[92:95], a[60:63]
s_add_u32 s38, s38, 16384
v_cvt_pk_bf16_f32 v86, v36, v37
v_cvt_pk_bf16_f32 v87, v38, v39
v_mfma_f32_16x16x32_bf16 a[92:95], a[188:191], v[96:99], a[92:95]
v_lshl_add_u32 v246, v244, 6, v246
v_mfma_f32_16x16x32_bf16 a[124:127], a[188:191], v[100:103], a[124:127]
s_waitcnt lgkmcnt(6)
s_cmp_lt_u32 s32, 2
s_cselect_b64 s[88:89], -1, 0
ds_read_b64_tr_b16 a[188:189], v227 offset:16384
ds_read_b64_tr_b16 a[190:191], v227 offset:20480
v_mfma_f32_16x16x32_bf16 v[8:11], a[128:131], v[152:155], v[136:139]
v_exp_f32 v40, v40
v_mfma_f32_16x16x32_bf16 v[8:11], a[132:135], v[156:159], v[8:11]
v_exp_f32 v41, v41
v_mfma_f32_16x16x32_bf16 v[8:11], a[136:139], v[160:163], v[8:11]
buffer_load_dwordx2 v[252:253], v251, s[76:79], s42 offen sc1
v_mfma_f32_16x16x32_bf16 v[8:11], a[140:143], v[164:167], v[8:11]
v_exp_f32 v42, v42
v_mfma_f32_16x16x32_bf16 a[0:3], a[160:163], v[72:75], a[0:3]
v_cvt_pk_bf16_f32 v88, v40, v41
v_add_u32 v246, s49, v246
v_mfma_f32_16x16x32_bf16 a[32:35], a[160:163], v[76:79], a[32:35]
v_exp_f32 v43, v43
v_mfma_f32_16x16x32_bf16 a[64:67], a[160:163], v[80:83], a[64:67]
v_cvt_pk_bf16_f32 v89, v42, v43
v_xor_b32 v5, 64, v245
v_mfma_f32_16x16x32_bf16 a[96:99], a[160:163], v[84:87], a[96:99]
v_exp_f32 v44, v44
v_mfma_f32_16x16x32_bf16 v[16:19], a[128:131], v[168:171], v[140:143]
ds_read_b64_tr_b16 a[160:161], v220 offset:24576
ds_read_b64_tr_b16 a[162:163], v220 offset:28672
v_mfma_f32_16x16x32_bf16 v[16:19], a[132:135], v[172:175], v[16:19]
v_exp_f32 v45, v45
v_mfma_f32_16x16x32_bf16 v[16:19], a[136:139], v[176:179], v[16:19]
v_cvt_pk_bf16_f32 v90, v44, v45
v_xor_b32 v6, 128, v245
v_mfma_f32_16x16x32_bf16 v[16:19], a[140:143], v[180:183], v[16:19]
v_exp_f32 v46, v46
v_mfma_f32_16x16x32_bf16 a[4:7], a[164:167], v[72:75], a[4:7]
v_xor_b32 v7, 192, v245
v_lshrrev_b32 v249, 2, v1
v_mfma_f32_16x16x32_bf16 a[36:39], a[164:167], v[76:79], a[36:39]
v_exp_f32 v47, v47
v_mfma_f32_16x16x32_bf16 a[68:71], a[164:167], v[80:83], a[68:71]
v_cvt_pk_bf16_f32 v91, v46, v47
v_lshlrev_b32 v249, 5, v249
v_mfma_f32_16x16x32_bf16 a[100:103], a[164:167], v[84:87], a[100:103]
v_exp_f32 v48, v48
v_smfmac_f32_16x16x64_bf16 a[248:251], a[208:211], v[72:79], v235
s_add_u32 s42, s42, s43
buffer_load_dword v255, v243, s[28:31], s45 offen
v_mfma_f32_16x16x32_bf16 v[24:27], a[128:131], v[184:187], v[144:147]
v_exp_f32 v49, v49
v_mfma_f32_16x16x32_bf16 v[24:27], a[132:135], v[188:191], v[24:27]
ds_read_b64_tr_b16 a[164:165], v221 offset:24576
ds_read_b64_tr_b16 a[166:167], v221 offset:28672
v_mfma_f32_16x16x32_bf16 v[24:27], a[136:139], v[192:195], v[24:27]
v_exp_f32 v50, v50
v_mfma_f32_16x16x32_bf16 v[24:27], a[140:143], v[196:199], v[24:27]
v_cvt_pk_bf16_f32 v92, v48, v49
v_lshl_add_u32 v249, v250, 3, v249
v_mfma_f32_16x16x32_bf16 a[8:11], a[168:171], v[72:75], a[8:11]
v_exp_f32 v51, v51
v_mfma_f32_16x16x32_bf16 a[40:43], a[168:171], v[76:79], a[40:43]
v_cvt_pk_bf16_f32 v93, v50, v51
v_add_u32 v249, s49, v249
v_mfma_f32_16x16x32_bf16 a[72:75], a[168:171], v[80:83], a[72:75]
v_exp_f32 v52, v52
v_mfma_f32_16x16x32_bf16 a[104:107], a[168:171], v[84:87], a[104:107]
ds_read_b64_tr_b16 a[168:169], v222 offset:24576
ds_read_b64_tr_b16 a[170:171], v222 offset:28672
v_mfma_f32_16x16x32_bf16 v[32:35], a[128:131], v[200:203], v[148:151]
v_exp_f32 v53, v53
v_mfma_f32_16x16x32_bf16 v[32:35], a[132:135], v[204:207], v[32:35]
ds_read_b128 a[128:131], v216 offset:40960
ds_read_b128 a[132:135], v217 offset:40960
v_mfma_f32_16x16x32_bf16 v[32:35], a[136:139], v[208:211], v[32:35]
v_exp_f32 v54, v54
v_mfma_f32_16x16x32_bf16 v[32:35], a[140:143], v[212:215], v[32:35]
ds_read_b128 a[136:139], v218 offset:40960
ds_read_b128 a[140:143], v219 offset:40960
v_mfma_f32_16x16x32_bf16 a[12:15], a[172:175], v[72:75], a[12:15]
v_exp_f32 v55, v55
v_mfma_f32_16x16x32_bf16 a[44:47], a[172:175], v[76:79], a[44:47]
v_cvt_pk_bf16_f32 v94, v52, v53
v_cvt_pk_bf16_f32 v95, v54, v55
v_mfma_f32_16x16x32_bf16 a[76:79], a[172:175], v[80:83], a[76:79]
s_waitcnt lgkmcnt(6)
v_exp_f32 v56, v56
v_mfma_f32_16x16x32_bf16 a[108:111], a[172:175], v[84:87], a[108:111]
s_add_u32 s45, s45, 589824
v_exp_f32 v57, v57
v_mfma_f32_16x16x32_bf16 v[12:15], a[144:147], v[152:155], v[136:139]
global_load_dword v255, v242, s[72:73]
v_mfma_f32_16x16x32_bf16 v[12:15], a[148:151], v[156:159], v[12:15]
v_exp_f32 v58, v58
v_mfma_f32_16x16x32_bf16 v[12:15], a[152:155], v[160:163], v[12:15]
ds_read_b64_tr_b16 a[172:173], v223 offset:24576
ds_read_b64_tr_b16 a[174:175], v223 offset:28672
v_mfma_f32_16x16x32_bf16 v[12:15], a[156:159], v[164:167], v[12:15]
v_exp_f32 v59, v59
v_mfma_f32_16x16x32_bf16 a[16:19], a[176:179], v[72:75], a[16:19]
v_cvt_pk_bf16_f32 v96, v56, v57
v_cvt_pk_bf16_f32 v97, v58, v59
v_mfma_f32_16x16x32_bf16 a[48:51], a[176:179], v[76:79], a[48:51]
v_exp_f32 v60, v60
v_mfma_f32_16x16x32_bf16 a[80:83], a[176:179], v[80:83], a[80:83]
v_mfma_f32_16x16x32_bf16 a[112:115], a[176:179], v[84:87], a[112:115]
v_exp_f32 v61, v61
v_mfma_f32_16x16x32_bf16 v[20:23], a[144:147], v[168:171], v[140:143]
ds_read_b64_tr_b16 a[176:177], v224 offset:24576
ds_read_b64_tr_b16 a[178:179], v224 offset:28672
v_mfma_f32_16x16x32_bf16 v[20:23], a[148:151], v[172:175], v[20:23]
v_exp_f32 v62, v62
v_mfma_f32_16x16x32_bf16 v[20:23], a[152:155], v[176:179], v[20:23]
v_cvt_pk_bf16_f32 v98, v60, v61
v_mfma_f32_16x16x32_bf16 v[20:23], a[156:159], v[180:183], v[20:23]
v_exp_f32 v63, v63
v_mfma_f32_16x16x32_bf16 a[20:23], a[180:183], v[72:75], a[20:23]
v_cvt_pk_bf16_f32 v99, v62, v63
v_mfma_f32_16x16x32_bf16 a[52:55], a[180:183], v[76:79], a[52:55]
v_exp_f32 v64, v64
v_mfma_f32_16x16x32_bf16 a[84:87], a[180:183], v[80:83], a[84:87]
buffer_load_dword v255, v0, s[24:27], s44 offen sc1
v_mfma_f32_16x16x32_bf16 a[116:119], a[180:183], v[84:87], a[116:119]
v_exp_f32 v65, v65
v_smfmac_f32_16x16x64_bf16 a[252:255], a[208:211], v[80:87], v235
ds_read_b64_tr_b16 a[180:181], v225 offset:24576
ds_read_b64_tr_b16 a[182:183], v225 offset:28672
v_mfma_f32_16x16x32_bf16 v[28:31], a[144:147], v[184:187], v[144:147]
v_exp_f32 v66, v66
v_mfma_f32_16x16x32_bf16 v[28:31], a[148:151], v[188:191], v[28:31]
v_cvt_pk_bf16_f32 v100, v64, v65
v_mfma_f32_16x16x32_bf16 v[28:31], a[152:155], v[192:195], v[28:31]
v_exp_f32 v67, v67
v_mfma_f32_16x16x32_bf16 v[28:31], a[156:159], v[196:199], v[28:31]
v_cvt_pk_bf16_f32 v101, v66, v67
v_mfma_f32_16x16x32_bf16 a[24:27], a[184:187], v[72:75], a[24:27]
v_exp_f32 v68, v68
v_mfma_f32_16x16x32_bf16 a[56:59], a[184:187], v[76:79], a[56:59]
v_mfma_f32_16x16x32_bf16 a[88:91], a[184:187], v[80:83], a[88:91]
v_exp_f32 v69, v69
v_mfma_f32_16x16x32_bf16 a[120:123], a[184:187], v[84:87], a[120:123]
ds_read_b64_tr_b16 a[184:185], v226 offset:24576
ds_read_b64_tr_b16 a[186:187], v226 offset:28672
v_mfma_f32_16x16x32_bf16 v[36:39], a[144:147], v[200:203], v[148:151]
v_exp_f32 v70, v70
v_mfma_f32_16x16x32_bf16 v[36:39], a[148:151], v[204:207], v[36:39]
ds_read_b128 a[144:147], v216 offset:45056
ds_read_b128 a[148:151], v217 offset:45056
v_mfma_f32_16x16x32_bf16 v[36:39], a[152:155], v[208:211], v[36:39]
v_exp_f32 v71, v71
v_mfma_f32_16x16x32_bf16 v[36:39], a[156:159], v[212:215], v[36:39]
ds_read_b128 a[152:155], v218 offset:45056
ds_read_b128 a[156:159], v219 offset:45056
v_mfma_f32_16x16x32_bf16 a[28:31], a[188:191], v[72:75], a[28:31]
v_cvt_pk_bf16_f32 v102, v68, v69
v_cvt_pk_bf16_f32 v103, v70, v71
v_mfma_f32_16x16x32_bf16 a[60:63], a[188:191], v[76:79], a[60:63]
s_add_u32 s44, s44, 8192
v_mfma_f32_16x16x32_bf16 a[92:95], a[188:191], v[80:83], a[92:95]
v_mfma_f32_16x16x32_bf16 a[124:127], a[188:191], v[84:87], a[124:127]
s_waitcnt lgkmcnt(6)
ds_read_b64_tr_b16 a[188:189], v227 offset:24576
ds_read_b64_tr_b16 a[190:191], v227 offset:28672
v_mfma_f32_16x16x32_bf16 v[40:43], a[128:131], v[152:155], v[136:139]
v_exp_f32 v8, v8
v_mfma_f32_16x16x32_bf16 v[40:43], a[132:135], v[156:159], v[40:43]
v_exp_f32 v9, v9
v_mfma_f32_16x16x32_bf16 v[40:43], a[136:139], v[160:163], v[40:43]
v_cvt_pk_bf16_f32 v72, v8, v9
v_mfma_f32_16x16x32_bf16 v[40:43], a[140:143], v[164:167], v[40:43]
v_exp_f32 v10, v10
v_mfma_f32_16x16x32_bf16 a[0:3], a[160:163], v[88:91], a[0:3]
v_mfma_f32_16x16x32_bf16 a[32:35], a[160:163], v[92:95], a[32:35]
v_exp_f32 v11, v11
s_waitcnt vmcnt(4) lgkmcnt(0)
s_barrier
v_mfma_f32_16x16x32_bf16 a[64:67], a[160:163], v[96:99], a[64:67]
v_cvt_pk_bf16_f32 v73, v10, v11
v_mfma_f32_16x16x32_bf16 a[96:99], a[160:163], v[100:103], a[96:99]
s_add_u32 m0, s37, 65536
v_exp_f32 v12, v12
v_mfma_f32_16x16x32_bf16 v[48:51], a[128:131], v[168:171], v[140:143]
s_waitcnt vmcnt(9)
s_nop 0
buffer_load_dwordx4 v232, s[12:15], s39 offen offset:0 lds
v_mfma_f32_16x16x32_bf16 v[48:51], a[132:135], v[172:175], v[48:51]
v_exp_f32 v13, v13
v_mfma_f32_16x16x32_bf16 v[48:51], a[136:139], v[176:179], v[48:51]
ds_read_b64_tr_b16 a[160:161], v220 offset:32768
ds_read_b64_tr_b16 a[162:163], v220 offset:36864
v_mfma_f32_16x16x32_bf16 v[48:51], a[140:143], v[180:183], v[48:51]
v_exp_f32 v14, v14
v_mfma_f32_16x16x32_bf16 a[4:7], a[164:167], v[88:91], a[4:7]
ds_read_b64_tr_b16 a[192:193], v248 offset:4096
v_cvt_pk_bf16_f32 v74, v12, v13
v_mfma_f32_16x16x32_bf16 a[36:39], a[164:167], v[92:95], a[36:39]
v_exp_f32 v15, v15
v_mfma_f32_16x16x32_bf16 a[68:71], a[164:167], v[96:99], a[68:71]
ds_read_b64_tr_b16 a[194:195], v248 offset:4352
v_cvt_pk_bf16_f32 v75, v14, v15
v_mfma_f32_16x16x32_bf16 a[100:103], a[164:167], v[100:103], a[100:103]
v_exp_f32 v16, v16
v_smfmac_f32_16x16x64_bf16 a[248:251], a[208:211], v[88:95], v235
buffer_load_dwordx4 v233, s[12:15], s39 offen offset:1024 lds
v_mfma_f32_16x16x32_bf16 v[56:59], a[128:131], v[184:187], v[144:147]
v_exp_f32 v17, v17
v_mfma_f32_16x16x32_bf16 v[56:59], a[132:135], v[188:191], v[56:59]
ds_read_b64_tr_b16 a[164:165], v221 offset:32768
ds_read_b64_tr_b16 a[166:167], v221 offset:36864
v_mfma_f32_16x16x32_bf16 v[56:59], a[136:139], v[192:195], v[56:59]
v_exp_f32 v18, v18
v_mfma_f32_16x16x32_bf16 v[56:59], a[140:143], v[196:199], v[56:59]
ds_read_b64_tr_b16 a[196:197], v248 offset:4128
v_cvt_pk_bf16_f32 v76, v16, v17
v_mfma_f32_16x16x32_bf16 a[8:11], a[168:171], v[88:91], a[8:11]
v_exp_f32 v19, v19
v_mfma_f32_16x16x32_bf16 a[40:43], a[168:171], v[92:95], a[40:43]
ds_read_b64_tr_b16 a[198:199], v248 offset:4384
v_cvt_pk_bf16_f32 v77, v18, v19
v_mfma_f32_16x16x32_bf16 a[72:75], a[168:171], v[96:99], a[72:75]
v_exp_f32 v20, v20
v_mfma_f32_16x16x32_bf16 a[104:107], a[168:171], v[100:103], a[104:107]
ds_read_b64_tr_b16 a[168:169], v222 offset:32768
ds_read_b64_tr_b16 a[170:171], v222 offset:36864
v_mfma_f32_16x16x32_bf16 v[64:67], a[128:131], v[200:203], v[148:151]
v_exp_f32 v21, v21
v_mfma_f32_16x16x32_bf16 v[64:67], a[132:135], v[204:207], v[64:67]
buffer_load_dwordx4 v232, s[12:15], s39 offen offset:2048 lds
v_mfma_f32_16x16x32_bf16 v[64:67], a[136:139], v[208:211], v[64:67]
v_exp_f32 v22, v22
v_mfma_f32_16x16x32_bf16 v[64:67], a[140:143], v[212:215], v[64:67]
ds_read_b128 a[128:131], v216 offset:16384
ds_read_b128 a[132:135], v217 offset:16384
v_mfma_f32_16x16x32_bf16 a[12:15], a[172:175], v[88:91], a[12:15]
v_exp_f32 v23, v23
v_mfma_f32_16x16x32_bf16 a[44:47], a[172:175], v[92:95], a[44:47]
ds_read_b128 a[136:139], v218 offset:16384
ds_read_b128 a[140:143], v219 offset:16384
v_mfma_f32_16x16x32_bf16 a[76:79], a[172:175], v[96:99], a[76:79]
v_exp_f32 v24, v24
v_mfma_f32_16x16x32_bf16 a[108:111], a[172:175], v[100:103], a[108:111]
v_exp_f32 v25, v25
v_mfma_f32_16x16x32_bf16 v[44:47], a[144:147], v[152:155], v[136:139]
ds_read_b64_tr_b16 a[172:173], v223 offset:32768
ds_read_b64_tr_b16 a[174:175], v223 offset:36864
v_mfma_f32_16x16x32_bf16 v[44:47], a[148:151], v[156:159], v[44:47]
v_exp_f32 v26, v26
v_mfma_f32_16x16x32_bf16 v[44:47], a[152:155], v[160:163], v[44:47]
buffer_load_dwordx4 v233, s[12:15], s39 offen offset:3072 lds
v_mfma_f32_16x16x32_bf16 v[44:47], a[156:159], v[164:167], v[44:47]
v_exp_f32 v27, v27
v_mfma_f32_16x16x32_bf16 a[16:19], a[176:179], v[88:91], a[16:19]
v_cvt_pk_bf16_f32 v78, v20, v21
v_cvt_pk_bf16_f32 v79, v22, v23
v_mfma_f32_16x16x32_bf16 a[48:51], a[176:179], v[92:95], a[48:51]
v_exp_f32 v28, v28
v_mfma_f32_16x16x32_bf16 a[80:83], a[176:179], v[96:99], a[80:83]
v_cvt_pk_bf16_f32 v80, v24, v25
v_cvt_pk_bf16_f32 v81, v26, v27
v_mfma_f32_16x16x32_bf16 a[112:115], a[176:179], v[100:103], a[112:115]
v_exp_f32 v29, v29
v_mfma_f32_16x16x32_bf16 v[52:55], a[144:147], v[168:171], v[140:143]
ds_read_b64_tr_b16 a[176:177], v224 offset:32768
ds_read_b64_tr_b16 a[178:179], v224 offset:36864
v_mfma_f32_16x16x32_bf16 v[52:55], a[148:151], v[172:175], v[52:55]
v_exp_f32 v30, v30
v_mfma_f32_16x16x32_bf16 v[52:55], a[152:155], v[176:179], v[52:55]
ds_read_b64_tr_b16 a[200:201], v248 offset:6144
v_cvt_pk_bf16_f32 v82, v28, v29
v_mfma_f32_16x16x32_bf16 v[52:55], a[156:159], v[180:183], v[52:55]
s_add_u32 s39, s39, 16384
v_exp_f32 v31, v31
v_mfma_f32_16x16x32_bf16 a[20:23], a[180:183], v[88:91], a[20:23]
s_add_u32 m0, s37, 49152
ds_read_b64_tr_b16 a[202:203], v248 offset:6400
v_cvt_pk_bf16_f32 v83, v30, v31
v_mfma_f32_16x16x32_bf16 a[52:55], a[180:183], v[92:95], a[52:55]
v_exp_f32 v32, v32
v_mfma_f32_16x16x32_bf16 a[84:87], a[180:183], v[96:99], a[84:87]
buffer_load_dwordx4 v228, s[8:11], s38 offen offset:0 lds
v_mfma_f32_16x16x32_bf16 a[116:119], a[180:183], v[100:103], a[116:119]
v_exp_f32 v33, v33
v_smfmac_f32_16x16x64_bf16 a[252:255], a[208:211], v[96:103], v235
ds_read_b64_tr_b16 a[180:181], v225 offset:32768
ds_read_b64_tr_b16 a[182:183], v225 offset:36864
v_mfma_f32_16x16x32_bf16 v[60:63], a[144:147], v[184:187], v[144:147]
v_exp_f32 v34, v34
v_mfma_f32_16x16x32_bf16 v[60:63], a[148:151], v[188:191], v[60:63]
ds_read_b64_tr_b16 a[204:205], v248 offset:6176
v_cvt_pk_bf16_f32 v84, v32, v33
v_mfma_f32_16x16x32_bf16 v[60:63], a[152:155], v[192:195], v[60:63]
v_exp_f32 v35, v35
v_mfma_f32_16x16x32_bf16 v[60:63], a[156:159], v[196:199], v[60:63]
buffer_load_dwordx4 v229, s[8:11], s38 offen offset:1024 lds
v_mfma_f32_16x16x32_bf16 a[24:27], a[184:187], v[88:91], a[24:27]
v_exp_f32 v36, v36
v_mfma_f32_16x16x32_bf16 a[56:59], a[184:187], v[92:95], a[56:59]
ds_read_b64_tr_b16 a[206:207], v248 offset:6432
v_cvt_pk_bf16_f32 v85, v34, v35
v_mfma_f32_16x16x32_bf16 a[88:91], a[184:187], v[96:99], a[88:91]
v_exp_f32 v37, v37
v_mfma_f32_16x16x32_bf16 a[120:123], a[184:187], v[100:103], a[120:123]
ds_read_b64_tr_b16 a[184:185], v226 offset:32768
ds_read_b64_tr_b16 a[186:187], v226 offset:36864
v_mfma_f32_16x16x32_bf16 v[68:71], a[144:147], v[200:203], v[148:151]
v_exp_f32 v38, v38
v_mfma_f32_16x16x32_bf16 v[68:71], a[148:151], v[204:207], v[68:71]
ds_read_b128 a[144:147], v216 offset:20480
ds_read_b128 a[148:151], v217 offset:20480
v_mfma_f32_16x16x32_bf16 v[68:71], a[152:155], v[208:211], v[68:71]
v_exp_f32 v39, v39
v_mfma_f32_16x16x32_bf16 v[68:71], a[156:159], v[212:215], v[68:71]
ds_read_b128 a[152:155], v218 offset:20480
ds_read_b128 a[156:159], v219 offset:20480
v_mfma_f32_16x16x32_bf16 a[28:31], a[188:191], v[88:91], a[28:31]
v_cvt_pk_bf16_f32 v86, v36, v37
v_cvt_pk_bf16_f32 v87, v38, v39
v_mfma_f32_16x16x32_bf16 a[60:63], a[188:191], v[92:95], a[60:63]
ds_read_b128 a[228:231], v246 offset:2048
ds_read_b128 a[212:215], v245
v_mfma_f32_16x16x32_bf16 a[92:95], a[188:191], v[96:99], a[92:95]
ds_read_b128 a[216:219], v5
v_mfma_f32_16x16x32_bf16 a[124:127], a[188:191], v[100:103], a[124:127]
s_waitcnt lgkmcnt(9)
ds_read_b64_tr_b16 a[188:189], v227 offset:32768
ds_read_b64_tr_b16 a[190:191], v227 offset:36864
v_mfma_f32_16x16x32_bf16 v[8:11], a[128:131], v[152:155], v[136:139]
v_exp_f32 v40, v40
v_mfma_f32_16x16x32_bf16 v[8:11], a[132:135], v[156:159], v[8:11]
buffer_load_dwordx4 v230, s[8:11], s38 offen offset:2048 lds
v_mfma_f32_16x16x32_bf16 v[8:11], a[136:139], v[160:163], v[8:11]
v_exp_f32 v41, v41
v_mfma_f32_16x16x32_bf16 v[8:11], a[140:143], v[164:167], v[8:11]
ds_read_b128 a[220:223], v6
v_cvt_pk_bf16_f32 v88, v40, v41
v_mfma_f32_16x16x32_bf16 a[0:3], a[160:163], v[72:75], a[0:3]
v_exp_f32 v42, v42
v_mfma_f32_16x16x32_bf16 a[32:35], a[160:163], v[76:79], a[32:35]
ds_read_b128 a[224:227], v7
ds_read_b64_tr_b16 a[232:233], v249 offset:3072
v_mfma_f32_16x16x32_bf16 a[64:67], a[160:163], v[80:83], a[64:67]
v_exp_f32 v43, v43
v_mfma_f32_16x16x32_bf16 a[96:99], a[160:163], v[84:87], a[96:99]
ds_read_b64_tr_b16 a[160:161], v220 offset:40960
ds_read_b64_tr_b16 a[162:163], v220 offset:45056
v_mfma_f32_16x16x32_bf16 v[16:19], a[128:131], v[168:171], v[140:143]
v_exp_f32 v44, v44
v_mfma_f32_16x16x32_bf16 v[16:19], a[132:135], v[172:175], v[16:19]
s_add_u32 m0, s49, 4096
ds_read_b64_tr_b16 a[234:235], v249 offset:3584
v_cvt_pk_bf16_f32 v89, v42, v43
v_mfma_f32_16x16x32_bf16 v[16:19], a[136:139], v[176:179], v[16:19]
s_add_u32 s48, s50, 0
v_exp_f32 v45, v45
v_mfma_f32_16x16x32_bf16 v[16:19], a[140:143], v[180:183], v[16:19]
buffer_load_dwordx4 v238, s[60:63], s48 offen  lds
v_mfma_f32_16x16x32_bf16 a[4:7], a[164:167], v[72:75], a[4:7]
v_exp_f32 v46, v46
v_mfma_f32_16x16x32_bf16 a[36:39], a[164:167], v[76:79], a[36:39]
v_cvt_pk_bf16_f32 v90, v44, v45
v_mfma_f32_16x16x32_bf16 a[68:71], a[164:167], v[80:83], a[68:71]
v_exp_f32 v47, v47
v_mfma_f32_16x16x32_bf16 a[100:103], a[164:167], v[84:87], a[100:103]
ds_read_b64_tr_b16 a[164:165], v221 offset:40960
ds_read_b64_tr_b16 a[166:167], v221 offset:45056
v_smfmac_f32_16x16x64_bf16 a[248:251], a[208:211], v[72:79], v235
s_waitcnt lgkmcnt(5)
v_exp_f32 v48, v48
v_mfma_f32_16x16x32_bf16 v[104:107], a[192:195], a[228:231], 0
s_add_u32 m0, s37, 49152
v_cvt_pk_bf16_f32 v91, v46, v47
v_mfma_f32_16x16x32_bf16 v[24:27], a[128:131], v[184:187], v[144:147]
v_exp_f32 v49, v49
v_mfma_f32_16x16x32_bf16 v[24:27], a[132:135], v[188:191], v[24:27]
buffer_load_dwordx4 v231, s[8:11], s38 offen offset:3072 lds
v_mfma_f32_16x16x32_bf16 v[24:27], a[136:139], v[192:195], v[24:27]
v_exp_f32 v50, v50
v_mfma_f32_16x16x32_bf16 v[24:27], a[140:143], v[196:199], v[24:27]
v_cvt_pk_bf16_f32 v92, v48, v49
v_mfma_f32_16x16x32_bf16 a[8:11], a[168:171], v[72:75], a[8:11]
v_exp_f32 v51, v51
v_mfma_f32_16x16x32_bf16 a[40:43], a[168:171], v[76:79], a[40:43]
v_cvt_pk_bf16_f32 v93, v50, v51
v_mfma_f32_16x16x32_bf16 a[72:75], a[168:171], v[80:83], a[72:75]
v_exp_f32 v52, v52
v_mfma_f32_16x16x32_bf16 a[104:107], a[168:171], v[84:87], a[104:107]
s_add_u32 m0, s49, 5120
ds_read_b64_tr_b16 a[168:169], v222 offset:40960
ds_read_b64_tr_b16 a[170:171], v222 offset:45056
v_mfma_f32_16x16x32_bf16 v[32:35], a[128:131], v[200:203], v[148:151]
s_add_u32 s48, s50, 147456
v_exp_f32 v53, v53
v_mfma_f32_16x16x32_bf16 v[32:35], a[132:135], v[204:207], v[32:35]
buffer_load_dwordx4 v238, s[60:63], s48 offen  lds
v_mfma_f32_16x16x32_bf16 v[32:35], a[136:139], v[208:211], v[32:35]
v_exp_f32 v54, v54
v_mfma_f32_16x16x32_bf16 v[32:35], a[140:143], v[212:215], v[32:35]
ds_read_b128 a[128:131], v216 offset:24576
ds_read_b128 a[132:135], v217 offset:24576
v_mfma_f32_16x16x32_bf16 a[12:15], a[172:175], v[72:75], a[12:15]
v_exp_f32 v55, v55
v_mfma_f32_16x16x32_bf16 a[44:47], a[172:175], v[76:79], a[44:47]
ds_read_b128 a[136:139], v218 offset:24576
ds_read_b128 a[140:143], v219 offset:24576
v_mfma_f32_16x16x32_bf16 a[76:79], a[172:175], v[80:83], a[76:79]
v_cvt_pk_bf16_f32 v94, v52, v53
v_cvt_pk_bf16_f32 v95, v54, v55
v_mfma_f32_16x16x32_bf16 a[108:111], a[172:175], v[84:87], a[108:111]
v_exp_f32 v56, v56
v_mfma_f32_16x16x32_bf16 v[108:111], a[196:199], a[228:231], 0
s_add_u32 s38, s38, 16384
ds_read_b64_tr_b16 a[172:173], v223 offset:40960
ds_read_b64_tr_b16 a[174:175], v223 offset:45056
v_mfma_f32_16x16x32_bf16 v[12:15], a[144:147], v[152:155], v[136:139]
s_add_u32 m0, s37, 81920
v_exp_f32 v57, v57
v_mfma_f32_16x16x32_bf16 v[12:15], a[148:151], v[156:159], v[12:15]
buffer_load_dwordx4 v232, s[12:15], s39 offen offset:0 lds
v_mfma_f32_16x16x32_bf16 v[12:15], a[152:155], v[160:163], v[12:15]
v_exp_f32 v58, v58
v_mfma_f32_16x16x32_bf16 v[12:15], a[156:159], v[164:167], v[12:15]
v_cvt_pk_bf16_f32 v96, v56, v57
v_mfma_f32_16x16x32_bf16 a[16:19], a[176:179], v[72:75], a[16:19]
v_exp_f32 v59, v59
v_mfma_f32_16x16x32_bf16 a[48:51], a[176:179], v[76:79], a[48:51]
v_cvt_pk_bf16_f32 v97, v58, v59
v_mfma_f32_16x16x32_bf16 a[80:83], a[176:179], v[80:83], a[80:83]
v_exp_f32 v60, v60
v_mfma_f32_16x16x32_bf16 a[112:115], a[176:179], v[84:87], a[112:115]
s_add_u32 m0, s49, 6144
ds_read_b64_tr_b16 a[176:177], v224 offset:40960
ds_read_b64_tr_b16 a[178:179], v224 offset:45056
v_mfma_f32_16x16x32_bf16 v[20:23], a[144:147], v[168:171], v[140:143]
s_add_u32 s48, s50, 294912
v_exp_f32 v61, v61
v_mfma_f32_16x16x32_bf16 v[20:23], a[148:151], v[172:175], v[20:23]
buffer_load_dwordx4 v238, s[60:63], s48 offen  lds
v_mfma_f32_16x16x32_bf16 v[20:23], a[152:155], v[176:179], v[20:23]
v_exp_f32 v62, v62
v_mfma_f32_16x16x32_bf16 v[20:23], a[156:159], v[180:183], v[20:23]
v_cvt_pk_bf16_f32 v98, v60, v61
v_mfma_f32_16x16x32_bf16 a[20:23], a[180:183], v[72:75], a[20:23]
v_exp_f32 v63, v63
v_mfma_f32_16x16x32_bf16 a[52:55], a[180:183], v[76:79], a[52:55]
v_cvt_pk_bf16_f32 v99, v62, v63
v_mfma_f32_16x16x32_bf16 a[84:87], a[180:183], v[80:83], a[84:87]
v_exp_f32 v64, v64
v_mfma_f32_16x16x32_bf16 a[116:119], a[180:183], v[84:87], a[116:119]
s_add_u32 m0, s37, 81920
ds_read_b64_tr_b16 a[180:181], v225 offset:40960
ds_read_b64_tr_b16 a[182:183], v225 offset:45056
v_smfmac_f32_16x16x64_bf16 a[252:255], a[208:211], v[80:87], v235
v_exp_f32 v65, v65
v_mfma_f32_16x16x32_bf16 v[112:115], a[200:203], a[228:231], 0
buffer_load_dwordx4 v233, s[12:15], s39 offen offset:1024 lds
v_mfma_f32_16x16x32_bf16 v[28:31], a[144:147], v[184:187], v[144:147]
v_exp_f32 v66, v66
v_mfma_f32_16x16x32_bf16 v[28:31], a[148:151], v[188:191], v[28:31]
v_cvt_pk_bf16_f32 v100, v64, v65
v_mfma_f32_16x16x32_bf16 v[28:31], a[152:155], v[192:195], v[28:31]
v_exp_f32 v67, v67
v_mfma_f32_16x16x32_bf16 v[28:31], a[156:159], v[196:199], v[28:31]
v_cvt_pk_bf16_f32 v101, v66, v67
v_mfma_f32_16x16x32_bf16 a[24:27], a[184:187], v[72:75], a[24:27]
v_exp_f32 v68, v68
v_mfma_f32_16x16x32_bf16 a[56:59], a[184:187], v[76:79], a[56:59]
buffer_load_dwordx4 v232, s[12:15], s39 offen offset:2048 lds
v_mfma_f32_16x16x32_bf16 a[88:91], a[184:187], v[80:83], a[88:91]
v_exp_f32 v69, v69
v_mfma_f32_16x16x32_bf16 a[120:123], a[184:187], v[84:87], a[120:123]
ds_read_b64_tr_b16 a[184:185], v226 offset:40960
ds_read_b64_tr_b16 a[186:187], v226 offset:45056
v_mfma_f32_16x16x32_bf16 v[36:39], a[144:147], v[200:203], v[148:151]
v_exp_f32 v70, v70
v_mfma_f32_16x16x32_bf16 v[36:39], a[148:151], v[204:207], v[36:39]
ds_read_b128 a[144:147], v216 offset:28672
ds_read_b128 a[148:151], v217 offset:28672
v_mfma_f32_16x16x32_bf16 v[36:39], a[152:155], v[208:211], v[36:39]
v_exp_f32 v71, v71
v_mfma_f32_16x16x32_bf16 v[36:39], a[156:159], v[212:215], v[36:39]
ds_read_b128 a[152:155], v218 offset:28672
ds_read_b128 a[156:159], v219 offset:28672
v_mfma_f32_16x16x32_bf16 a[28:31], a[188:191], v[72:75], a[28:31]
v_cvt_pk_bf16_f32 v102, v68, v69
v_cvt_pk_bf16_f32 v103, v70, v71
v_mfma_f32_16x16x32_bf16 a[60:63], a[188:191], v[76:79], a[60:63]
v_mfma_f32_16x16x32_bf16 a[92:95], a[188:191], v[80:83], a[92:95]
v_mfma_f32_16x16x32_bf16 a[124:127], a[188:191], v[84:87], a[124:127]
ds_read_b64_tr_b16 a[188:189], v227 offset:40960
ds_read_b64_tr_b16 a[190:191], v227 offset:45056
v_mfma_f32_16x16x32_bf16 v[116:119], a[204:207], a[228:231], 0
s_waitcnt lgkmcnt(8)
v_mfma_f32_16x16x32_bf16 v[40:43], a[128:131], v[152:155], v[136:139]
v_exp_f32 v8, v8
v_mfma_f32_16x16x32_bf16 v[40:43], a[132:135], v[156:159], v[40:43]
v_exp_f32 v9, v9
v_mfma_f32_16x16x32_bf16 v[40:43], a[136:139], v[160:163], v[40:43]
buffer_load_dwordx4 v233, s[12:15], s39 offen offset:3072 lds
v_mfma_f32_16x16x32_bf16 v[40:43], a[140:143], v[164:167], v[40:43]
v_exp_f32 v10, v10
v_mfma_f32_16x16x32_bf16 a[0:3], a[160:163], v[88:91], a[0:3]
v_cvt_pk_bf16_f32 v72, v8, v9
v_mfma_f32_16x16x32_bf16 a[32:35], a[160:163], v[92:95], a[32:35]
v_exp_f32 v11, v11
v_mfma_f32_16x16x32_bf16 a[64:67], a[160:163], v[96:99], a[64:67]
v_cvt_pk_bf16_f32 v73, v10, v11
v_mfma_f32_16x16x32_bf16 a[96:99], a[160:163], v[100:103], a[96:99]
v_exp_f32 v12, v12
v_mfma_f32_16x16x32_bf16 v[48:51], a[128:131], v[168:171], v[140:143]
s_add_u32 m0, s49, 7168
ds_read_b64_tr_b16 a[160:161], v220 offset:49152
ds_read_b64_tr_b16 a[162:163], v220 offset:53248
v_mfma_f32_16x16x32_bf16 v[48:51], a[132:135], v[172:175], v[48:51]
s_add_u32 s48, s50, 442368
v_exp_f32 v13, v13
v_mfma_f32_16x16x32_bf16 v[48:51], a[136:139], v[176:179], v[48:51]
buffer_load_dwordx4 v238, s[60:63], s48 offen  lds
v_mfma_f32_16x16x32_bf16 v[48:51], a[140:143], v[180:183], v[48:51]
v_exp_f32 v14, v14
v_mfma_f32_16x16x32_bf16 a[4:7], a[164:167], v[88:91], a[4:7]
v_cvt_pk_bf16_f32 v74, v12, v13
v_mfma_f32_16x16x32_bf16 a[36:39], a[164:167], v[92:95], a[36:39]
v_exp_f32 v15, v15
v_mfma_f32_16x16x32_bf16 a[68:71], a[164:167], v[96:99], a[68:71]
v_cvt_pk_bf16_f32 v75, v14, v15
v_mfma_f32_16x16x32_bf16 a[100:103], a[164:167], v[100:103], a[100:103]
v_exp_f32 v16, v16
v_smfmac_f32_16x16x64_bf16 a[248:251], a[208:211], v[88:95], v235
s_add_u32 s39, s39, 16384
ds_read_b64_tr_b16 a[164:165], v221 offset:49152
ds_read_b64_tr_b16 a[166:167], v221 offset:53248
v_mfma_f32_16x16x32_bf16 v[56:59], a[128:131], v[184:187], v[144:147]
s_add_u32 m0, s37, 32768
v_exp_f32 v17, v17
v_mfma_f32_16x16x32_bf16 v[56:59], a[132:135], v[188:191], v[56:59]
buffer_load_dwordx4 v228, s[8:11], s38 offen offset:0 lds
v_mfma_f32_16x16x32_bf16 v[56:59], a[136:139], v[192:195], v[56:59]
v_exp_f32 v18, v18
v_mfma_f32_16x16x32_bf16 v[56:59], a[140:143], v[196:199], v[56:59]
v_cvt_pk_bf16_f32 v76, v16, v17
v_mfma_f32_16x16x32_bf16 a[8:11], a[168:171], v[88:91], a[8:11]
v_exp_f32 v19, v19
v_mfma_f32_16x16x32_bf16 a[40:43], a[168:171], v[92:95], a[40:43]
v_cvt_pk_bf16_f32 v77, v18, v19
v_mfma_f32_16x16x32_bf16 a[72:75], a[168:171], v[96:99], a[72:75]
v_exp_f32 v20, v20
v_mfma_f32_16x16x32_bf16 a[104:107], a[168:171], v[100:103], a[104:107]
s_add_u32 m0, s49, 0
ds_read_b64_tr_b16 a[168:169], v222 offset:49152
ds_read_b64_tr_b16 a[170:171], v222 offset:53248
v_mfma_f32_16x16x32_bf16 v[64:67], a[128:131], v[200:203], v[148:151]
s_add_u32 s48, s50, 0
v_exp_f32 v21, v21
v_mfma_f32_16x16x32_bf16 v[64:67], a[132:135], v[204:207], v[64:67]
buffer_load_dwordx4 v238, s[56:59], s48 offen  lds
v_mfma_f32_16x16x32_bf16 v[64:67], a[136:139], v[208:211], v[64:67]
v_exp_f32 v22, v22
v_mfma_f32_16x16x32_bf16 v[64:67], a[140:143], v[212:215], v[64:67]
ds_read_b128 a[128:131], v216 offset:0
ds_read_b128 a[132:135], v217 offset:0
v_mfma_f32_16x16x32_bf16 a[12:15], a[172:175], v[88:91], a[12:15]
v_exp_f32 v23, v23
v_mfma_f32_16x16x32_bf16 a[44:47], a[172:175], v[92:95], a[44:47]
ds_read_b128 a[136:139], v218 offset:0
ds_read_b128 a[140:143], v219 offset:0
v_mfma_f32_16x16x32_bf16 a[76:79], a[172:175], v[96:99], a[76:79]
s_waitcnt lgkmcnt(6)
v_exp_f32 v24, v24
v_mfma_f32_16x16x32_bf16 a[108:111], a[172:175], v[100:103], a[108:111]
s_add_u32 m0, s37, 32768
v_exp_f32 v25, v25
v_mfma_f32_16x16x32_bf16 v[44:47], a[144:147], v[152:155], v[136:139]
buffer_load_dwordx4 v229, s[8:11], s38 offen offset:1024 lds
v_mfma_f32_16x16x32_bf16 v[44:47], a[148:151], v[156:159], v[44:47]
v_exp_f32 v26, v26
v_mfma_f32_16x16x32_bf16 v[44:47], a[152:155], v[160:163], v[44:47]
ds_read_b64_tr_b16 a[172:173], v223 offset:49152
ds_read_b64_tr_b16 a[174:175], v223 offset:53248
v_mfma_f32_16x16x32_bf16 v[44:47], a[156:159], v[164:167], v[44:47]
v_exp_f32 v27, v27
v_mfma_f32_16x16x32_bf16 a[16:19], a[176:179], v[88:91], a[16:19]
v_cvt_pk_bf16_f32 v78, v20, v21
v_cvt_pk_bf16_f32 v79, v22, v23
v_mfma_f32_16x16x32_bf16 a[48:51], a[176:179], v[92:95], a[48:51]
v_exp_f32 v28, v28
v_mfma_f32_16x16x32_bf16 a[80:83], a[176:179], v[96:99], a[80:83]
s_add_u32 m0, s49, 1024
v_cvt_pk_bf16_f32 v80, v24, v25
v_cvt_pk_bf16_f32 v81, v26, v27
v_mfma_f32_16x16x32_bf16 a[112:115], a[176:179], v[100:103], a[112:115]
s_add_u32 s48, s50, 147456
v_exp_f32 v29, v29
v_mfma_f32_16x16x32_bf16 v[52:55], a[144:147], v[168:171], v[140:143]
buffer_load_dwordx4 v238, s[56:59], s48 offen  lds
v_mfma_f32_16x16x32_bf16 v[52:55], a[148:151], v[172:175], v[52:55]
v_exp_f32 v30, v30
v_mfma_f32_16x16x32_bf16 v[52:55], a[152:155], v[176:179], v[52:55]
ds_read_b64_tr_b16 a[176:177], v224 offset:49152
ds_read_b64_tr_b16 a[178:179], v224 offset:53248
v_mfma_f32_16x16x32_bf16 v[52:55], a[156:159], v[180:183], v[52:55]
v_exp_f32 v31, v31
v_mfma_f32_16x16x32_bf16 a[20:23], a[180:183], v[88:91], a[20:23]
v_cvt_pk_bf16_f32 v82, v28, v29
v_cvt_pk_bf16_f32 v83, v30, v31
v_mfma_f32_16x16x32_bf16 a[52:55], a[180:183], v[92:95], a[52:55]
v_exp_f32 v32, v32
v_mfma_f32_16x16x32_bf16 a[84:87], a[180:183], v[96:99], a[84:87]
s_add_u32 m0, s37, 32768
v_mfma_f32_16x16x32_bf16 a[116:119], a[180:183], v[100:103], a[116:119]
v_exp_f32 v33, v33
v_smfmac_f32_16x16x64_bf16 a[252:255], a[208:211], v[96:103], v235
buffer_load_dwordx4 v230, s[8:11], s38 offen offset:2048 lds
v_mfma_f32_16x16x32_bf16 v[60:63], a[144:147], v[184:187], v[144:147]
v_exp_f32 v34, v34
v_mfma_f32_16x16x32_bf16 v[60:63], a[148:151], v[188:191], v[60:63]
ds_read_b64_tr_b16 a[180:181], v225 offset:49152
ds_read_b64_tr_b16 a[182:183], v225 offset:53248
v_mfma_f32_16x16x32_bf16 v[60:63], a[152:155], v[192:195], v[60:63]
v_exp_f32 v35, v35
v_mfma_f32_16x16x32_bf16 v[60:63], a[156:159], v[196:199], v[60:63]
v_cvt_pk_bf16_f32 v84, v32, v33
v_cvt_pk_bf16_f32 v85, v34, v35
v_mfma_f32_16x16x32_bf16 a[24:27], a[184:187], v[88:91], a[24:27]
v_exp_f32 v36, v36
v_mfma_f32_16x16x32_bf16 a[56:59], a[184:187], v[92:95], a[56:59]
buffer_load_dwordx4 v231, s[8:11], s38 offen offset:3072 lds
v_mfma_f32_16x16x32_bf16 a[88:91], a[184:187], v[96:99], a[88:91]
v_exp_f32 v37, v37
v_mfma_f32_16x16x32_bf16 a[120:123], a[184:187], v[100:103], a[120:123]
ds_read_b64_tr_b16 a[184:185], v226 offset:49152
ds_read_b64_tr_b16 a[186:187], v226 offset:53248
v_mfma_f32_16x16x32_bf16 v[68:71], a[144:147], v[200:203], v[148:151]
v_exp_f32 v38, v38
v_mfma_f32_16x16x32_bf16 v[68:71], a[148:151], v[204:207], v[68:71]
ds_read_b128 a[144:147], v216 offset:4096
ds_read_b128 a[148:151], v217 offset:4096
v_mfma_f32_16x16x32_bf16 v[68:71], a[152:155], v[208:211], v[68:71]
v_exp_f32 v39, v39
v_mfma_f32_16x16x32_bf16 v[68:71], a[156:159], v[212:215], v[68:71]
ds_read_b128 a[152:155], v218 offset:4096
ds_read_b128 a[156:159], v219 offset:4096
v_mfma_f32_16x16x32_bf16 a[28:31], a[188:191], v[88:91], a[28:31]
v_cvt_pk_bf16_f32 v86, v36, v37
v_cvt_pk_bf16_f32 v87, v38, v39
v_mfma_f32_16x16x32_bf16 a[60:63], a[188:191], v[92:95], a[60:63]
s_add_u32 s38, s38, 16384
v_mfma_f32_16x16x32_bf16 a[92:95], a[188:191], v[96:99], a[92:95]
v_mfma_f32_16x16x32_bf16 a[124:127], a[188:191], v[100:103], a[124:127]
s_waitcnt lgkmcnt(6)
ds_read_b64_tr_b16 a[188:189], v227 offset:49152
ds_read_b64_tr_b16 a[190:191], v227 offset:53248
v_mfma_f32_16x16x32_bf16 v[8:11], a[128:131], v[152:155], v[136:139]
v_exp_f32 v40, v40
v_mfma_f32_16x16x32_bf16 v[8:11], a[132:135], v[156:159], v[8:11]
s_add_u32 m0, s49, 2048
v_exp_f32 v41, v41
v_mfma_f32_16x16x32_bf16 v[8:11], a[136:139], v[160:163], v[8:11]
s_add_u32 s48, s50, 294912
buffer_load_dwordx4 v238, s[56:59], s48 offen  lds
v_mfma_f32_16x16x32_bf16 v[8:11], a[140:143], v[164:167], v[8:11]
v_exp_f32 v42, v42
v_mfma_f32_16x16x32_bf16 a[0:3], a[160:163], v[72:75], a[0:3]
v_cvt_pk_bf16_f32 v88, v40, v41
v_mfma_f32_16x16x32_bf16 a[32:35], a[160:163], v[76:79], a[32:35]
v_exp_f32 v43, v43
v_mfma_f32_16x16x32_bf16 a[64:67], a[160:163], v[80:83], a[64:67]
v_cvt_pk_bf16_f32 v89, v42, v43
v_mfma_f32_16x16x32_bf16 a[96:99], a[160:163], v[84:87], a[96:99]
v_exp_f32 v44, v44
v_mfma_f32_16x16x32_bf16 v[16:19], a[128:131], v[168:171], v[140:143]
ds_read_b64_tr_b16 a[160:161], v220 offset:57344
ds_read_b64_tr_b16 a[162:163], v220 offset:61440
v_mfma_f32_16x16x32_bf16 v[16:19], a[132:135], v[172:175], v[16:19]
v_exp_f32 v45, v45
v_mfma_f32_16x16x32_bf16 v[16:19], a[136:139], v[176:179], v[16:19]
v_cvt_pk_bf16_f32 v90, v44, v45
v_mfma_f32_16x16x32_bf16 v[16:19], a[140:143], v[180:183], v[16:19]
s_add_u32 m0, s49, 3072
v_exp_f32 v46, v46
v_mfma_f32_16x16x32_bf16 a[4:7], a[164:167], v[72:75], a[4:7]
s_add_u32 s48, s50, 442368
buffer_load_dwordx4 v238, s[56:59], s48 offen  lds
v_mfma_f32_16x16x32_bf16 a[36:39], a[164:167], v[76:79], a[36:39]
v_exp_f32 v47, v47
v_mfma_f32_16x16x32_bf16 a[68:71], a[164:167], v[80:83], a[68:71]
v_cvt_pk_bf16_f32 v91, v46, v47
v_mfma_f32_16x16x32_bf16 a[100:103], a[164:167], v[84:87], a[100:103]
v_exp_f32 v48, v48
v_smfmac_f32_16x16x64_bf16 a[248:251], a[208:211], v[72:79], v235
ds_read_b64_tr_b16 a[164:165], v221 offset:57344
ds_read_b64_tr_b16 a[166:167], v221 offset:61440
v_mfma_f32_16x16x32_bf16 v[24:27], a[128:131], v[184:187], v[144:147]
v_exp_f32 v49, v49
v_mfma_f32_16x16x32_bf16 v[24:27], a[132:135], v[188:191], v[24:27]
v_cvt_pk_bf16_f32 v92, v48, v49
v_mfma_f32_16x16x32_bf16 v[24:27], a[136:139], v[192:195], v[24:27]
v_exp_f32 v50, v50
v_mfma_f32_16x16x32_bf16 v[24:27], a[140:143], v[196:199], v[24:27]
v_mfma_f32_16x16x32_bf16 a[8:11], a[168:171], v[72:75], a[8:11]
v_exp_f32 v51, v51
v_mfma_f32_16x16x32_bf16 a[40:43], a[168:171], v[76:79], a[40:43]
buffer_load_dwordx2 v[252:253], v251, s[76:79], s42 offen sc1
v_mfma_f32_16x16x32_bf16 a[72:75], a[168:171], v[80:83], a[72:75]
v_exp_f32 v52, v52
v_mfma_f32_16x16x32_bf16 a[104:107], a[168:171], v[84:87], a[104:107]
ds_read_b64_tr_b16 a[168:169], v222 offset:57344
ds_read_b64_tr_b16 a[170:171], v222 offset:61440
v_mfma_f32_16x16x32_bf16 v[32:35], a[128:131], v[200:203], v[148:151]
v_exp_f32 v53, v53
v_mfma_f32_16x16x32_bf16 v[32:35], a[132:135], v[204:207], v[32:35]
ds_read_b128 a[128:131], v216 offset:8192
ds_read_b128 a[132:135], v217 offset:8192
v_mfma_f32_16x16x32_bf16 v[32:35], a[136:139], v[208:211], v[32:35]
v_exp_f32 v54, v54
v_mfma_f32_16x16x32_bf16 v[32:35], a[140:143], v[212:215], v[32:35]
ds_read_b128 a[136:139], v218 offset:8192
ds_read_b128 a[140:143], v219 offset:8192
v_mfma_f32_16x16x32_bf16 a[12:15], a[172:175], v[72:75], a[12:15]
v_exp_f32 v55, v55
v_mfma_f32_16x16x32_bf16 a[44:47], a[172:175], v[76:79], a[44:47]
v_cvt_pk_bf16_f32 v93, v50, v51
v_cvt_pk_bf16_f32 v94, v52, v53
v_mfma_f32_16x16x32_bf16 a[76:79], a[172:175], v[80:83], a[76:79]
s_waitcnt lgkmcnt(6)
v_exp_f32 v56, v56
v_mfma_f32_16x16x32_bf16 a[108:111], a[172:175], v[84:87], a[108:111]
s_add_u32 s42, s42, s43
v_exp_f32 v57, v57
v_mfma_f32_16x16x32_bf16 v[12:15], a[144:147], v[152:155], v[136:139]
buffer_load_dword v255, v243, s[28:31], s45 offen
v_mfma_f32_16x16x32_bf16 v[12:15], a[148:151], v[156:159], v[12:15]
v_exp_f32 v58, v58
v_mfma_f32_16x16x32_bf16 v[12:15], a[152:155], v[160:163], v[12:15]
ds_read_b64_tr_b16 a[172:173], v223 offset:57344
ds_read_b64_tr_b16 a[174:175], v223 offset:61440
v_mfma_f32_16x16x32_bf16 v[12:15], a[156:159], v[164:167], v[12:15]
v_exp_f32 v59, v59
v_mfma_f32_16x16x32_bf16 a[16:19], a[176:179], v[72:75], a[16:19]
v_cvt_pk_bf16_f32 v95, v54, v55
v_cvt_pk_bf16_f32 v96, v56, v57
v_mfma_f32_16x16x32_bf16 a[48:51], a[176:179], v[76:79], a[48:51]
v_exp_f32 v60, v60
v_mfma_f32_16x16x32_bf16 a[80:83], a[176:179], v[80:83], a[80:83]
v_cvt_pk_bf16_f32 v97, v58, v59
v_mfma_f32_16x16x32_bf16 a[112:115], a[176:179], v[84:87], a[112:115]
v_exp_f32 v61, v61
v_mfma_f32_16x16x32_bf16 v[20:23], a[144:147], v[168:171], v[140:143]
ds_read_b64_tr_b16 a[176:177], v224 offset:57344
ds_read_b64_tr_b16 a[178:179], v224 offset:61440
v_mfma_f32_16x16x32_bf16 v[20:23], a[148:151], v[172:175], v[20:23]
s_add_u32 s45, s45, 589824
v_exp_f32 v62, v62
v_mfma_f32_16x16x32_bf16 v[20:23], a[152:155], v[176:179], v[20:23]
global_load_dword v255, v242, s[72:73]
v_mfma_f32_16x16x32_bf16 v[20:23], a[156:159], v[180:183], v[20:23]
v_exp_f32 v63, v63
v_mfma_f32_16x16x32_bf16 a[20:23], a[180:183], v[72:75], a[20:23]
v_cvt_pk_bf16_f32 v98, v60, v61
v_cvt_pk_bf16_f32 v99, v62, v63
v_mfma_f32_16x16x32_bf16 a[52:55], a[180:183], v[76:79], a[52:55]
v_exp_f32 v64, v64
v_mfma_f32_16x16x32_bf16 a[84:87], a[180:183], v[80:83], a[84:87]
v_mfma_f32_16x16x32_bf16 a[116:119], a[180:183], v[84:87], a[116:119]
v_exp_f32 v65, v65
v_smfmac_f32_16x16x64_bf16 a[252:255], a[208:211], v[80:87], v235
ds_read_b64_tr_b16 a[180:181], v225 offset:57344
ds_read_b64_tr_b16 a[182:183], v225 offset:61440
v_mfma_f32_16x16x32_bf16 v[28:31], a[144:147], v[184:187], v[144:147]
v_exp_f32 v66, v66
v_mfma_f32_16x16x32_bf16 v[28:31], a[148:151], v[188:191], v[28:31]
v_cvt_pk_bf16_f32 v100, v64, v65
v_mfma_f32_16x16x32_bf16 v[28:31], a[152:155], v[192:195], v[28:31]
v_exp_f32 v67, v67
v_mfma_f32_16x16x32_bf16 v[28:31], a[156:159], v[196:199], v[28:31]
buffer_load_dword v255, v0, s[24:27], s44 offen sc1
v_mfma_f32_16x16x32_bf16 a[24:27], a[184:187], v[72:75], a[24:27]
v_exp_f32 v68, v68
v_mfma_f32_16x16x32_bf16 a[56:59], a[184:187], v[76:79], a[56:59]
v_cvt_pk_bf16_f32 v101, v66, v67
v_mfma_f32_16x16x32_bf16 a[88:91], a[184:187], v[80:83], a[88:91]
v_exp_f32 v69, v69
v_mfma_f32_16x16x32_bf16 a[120:123], a[184:187], v[84:87], a[120:123]
ds_read_b64_tr_b16 a[184:185], v226 offset:57344
ds_read_b64_tr_b16 a[186:187], v226 offset:61440
v_mfma_f32_16x16x32_bf16 v[36:39], a[144:147], v[200:203], v[148:151]
v_exp_f32 v70, v70
v_mfma_f32_16x16x32_bf16 v[36:39], a[148:151], v[204:207], v[36:39]
ds_read_b128 a[144:147], v216 offset:12288
ds_read_b128 a[148:151], v217 offset:12288
v_mfma_f32_16x16x32_bf16 v[36:39], a[152:155], v[208:211], v[36:39]
v_exp_f32 v71, v71
v_mfma_f32_16x16x32_bf16 v[36:39], a[156:159], v[212:215], v[36:39]
ds_read_b128 a[152:155], v218 offset:12288
ds_read_b128 a[156:159], v219 offset:12288
v_mfma_f32_16x16x32_bf16 a[28:31], a[188:191], v[72:75], a[28:31]
v_cvt_pk_bf16_f32 v102, v68, v69
v_cvt_pk_bf16_f32 v103, v70, v71
v_mfma_f32_16x16x32_bf16 a[60:63], a[188:191], v[76:79], a[60:63]
s_add_u32 s44, s44, 8192
v_mfma_f32_16x16x32_bf16 a[92:95], a[188:191], v[80:83], a[92:95]
v_mfma_f32_16x16x32_bf16 a[124:127], a[188:191], v[84:87], a[124:127]
s_waitcnt lgkmcnt(6)
ds_read_b64_tr_b16 a[188:189], v227 offset:57344
ds_read_b64_tr_b16 a[190:191], v227 offset:61440
v_mfma_f32_16x16x32_bf16 v[40:43], a[128:131], v[152:155], v[136:139]
v_exp_f32 v8, v8
v_mfma_f32_16x16x32_bf16 v[40:43], a[132:135], v[156:159], v[40:43]
v_exp_f32 v9, v9
v_mfma_f32_16x16x32_bf16 v[40:43], a[136:139], v[160:163], v[40:43]
v_cvt_pk_bf16_f32 v72, v8, v9
v_add_u32 v5, s49, v234
v_mfma_f32_16x16x32_bf16 v[40:43], a[140:143], v[164:167], v[40:43]
s_add_u32 s46, s3, 131072
v_exp_f32 v10, v10
v_mfma_f32_16x16x32_bf16 a[0:3], a[160:163], v[88:91], a[0:3]
v_add_u32 v6, s46, v234
v_lshlrev_b32 v7, 1, v4
v_mfma_f32_16x16x32_bf16 a[32:35], a[160:163], v[92:95], a[32:35]
v_exp_f32 v11, v11
s_waitcnt vmcnt(6) lgkmcnt(0)
s_barrier
v_mfma_f32_16x16x32_bf16 a[64:67], a[160:163], v[96:99], a[64:67]
v_cvt_pk_bf16_f32 v73, v10, v11
v_xor_b32 v7, v7, v3
v_mfma_f32_16x16x32_bf16 a[96:99], a[160:163], v[100:103], a[96:99]
s_add_u32 m0, s37, 98304
v_exp_f32 v12, v12
v_mfma_f32_16x16x32_bf16 v[48:51], a[128:131], v[168:171], v[140:143]
buffer_load_dwordx4 v232, s[12:15], s39 offen offset:0 lds
v_mfma_f32_16x16x32_bf16 v[48:51], a[132:135], v[172:175], v[48:51]
v_exp_f32 v13, v13
v_mfma_f32_16x16x32_bf16 v[48:51], a[136:139], v[176:179], v[48:51]
ds_read_b64_tr_b16 a[160:161], v220 offset:0
ds_read_b64_tr_b16 a[162:163], v220 offset:4096
v_mfma_f32_16x16x32_bf16 v[48:51], a[140:143], v[180:183], v[48:51]
v_exp_f32 v14, v14
v_mfma_f32_16x16x32_bf16 a[4:7], a[164:167], v[88:91], a[4:7]
v_cvt_pk_bf16_f32 v74, v12, v13
v_mul_u32_u24 v249, 0x480, v4
v_mfma_f32_16x16x32_bf16 a[36:39], a[164:167], v[92:95], a[36:39]
v_exp_f32 v15, v15
v_mfma_f32_16x16x32_bf16 a[68:71], a[164:167], v[96:99], a[68:71]
v_cvt_pk_bf16_f32 v75, v14, v15
v_lshl_add_u32 v249, v7, 4, v249
v_mfma_f32_16x16x32_bf16 a[100:103], a[164:167], v[100:103], a[100:103]
v_exp_f32 v16, v16
v_smfmac_f32_16x16x64_bf16 a[248:251], a[208:211], v[88:95], v235
buffer_load_dwordx4 v233, s[12:15], s39 offen offset:1024 lds
v_mfma_f32_16x16x32_bf16 v[56:59], a[128:131], v[184:187], v[144:147]
v_exp_f32 v17, v17
v_mfma_f32_16x16x32_bf16 v[56:59], a[132:135], v[188:191], v[56:59]
ds_read_b64_tr_b16 a[164:165], v221 offset:0
ds_read_b64_tr_b16 a[166:167], v221 offset:4096
v_mfma_f32_16x16x32_bf16 v[56:59], a[136:139], v[192:195], v[56:59]
v_exp_f32 v18, v18
v_mfma_f32_16x16x32_bf16 v[56:59], a[140:143], v[196:199], v[56:59]
v_cvt_pk_bf16_f32 v76, v16, v17
v_and_b32 v7, 8, v7
v_mfma_f32_16x16x32_bf16 a[8:11], a[168:171], v[88:91], a[8:11]
v_exp_f32 v19, v19
v_mfma_f32_16x16x32_bf16 a[40:43], a[168:171], v[92:95], a[40:43]
v_cvt_pk_bf16_f32 v77, v18, v19
v_lshlrev_b32 v7, 5, v7
v_mfma_f32_16x16x32_bf16 a[72:75], a[168:171], v[96:99], a[72:75]
v_exp_f32 v20, v20
v_mfma_f32_16x16x32_bf16 a[104:107], a[168:171], v[100:103], a[104:107]
ds_read_b64_tr_b16 a[168:169], v222 offset:0
ds_read_b64_tr_b16 a[170:171], v222 offset:4096
v_mfma_f32_16x16x32_bf16 v[64:67], a[128:131], v[200:203], v[148:151]
v_exp_f32 v21, v21
v_mfma_f32_16x16x32_bf16 v[64:67], a[132:135], v[204:207], v[64:67]
buffer_load_dwordx4 v232, s[12:15], s39 offen offset:2048 lds
v_mfma_f32_16x16x32_bf16 v[64:67], a[136:139], v[208:211], v[64:67]
v_exp_f32 v22, v22
v_mfma_f32_16x16x32_bf16 v[64:67], a[140:143], v[212:215], v[64:67]
ds_read_b128 a[128:131], v216 offset:49152
ds_read_b128 a[132:135], v217 offset:49152
v_mfma_f32_16x16x32_bf16 a[12:15], a[172:175], v[88:91], a[12:15]
v_exp_f32 v23, v23
v_mfma_f32_16x16x32_bf16 a[44:47], a[172:175], v[92:95], a[44:47]
ds_read_b128 a[136:139], v218 offset:49152
ds_read_b128 a[140:143], v219 offset:49152
v_mfma_f32_16x16x32_bf16 a[76:79], a[172:175], v[96:99], a[76:79]
v_exp_f32 v24, v24
v_mfma_f32_16x16x32_bf16 a[108:111], a[172:175], v[100:103], a[108:111]
v_exp_f32 v25, v25
v_mfma_f32_16x16x32_bf16 v[44:47], a[144:147], v[152:155], v[136:139]
ds_read_b64_tr_b16 a[172:173], v223 offset:0
ds_read_b64_tr_b16 a[174:175], v223 offset:4096
v_mfma_f32_16x16x32_bf16 v[44:47], a[148:151], v[156:159], v[44:47]
v_exp_f32 v26, v26
v_mfma_f32_16x16x32_bf16 v[44:47], a[152:155], v[160:163], v[44:47]
buffer_load_dwordx4 v233, s[12:15], s39 offen offset:3072 lds
v_mfma_f32_16x16x32_bf16 v[44:47], a[156:159], v[164:167], v[44:47]
v_exp_f32 v27, v27
v_mfma_f32_16x16x32_bf16 a[16:19], a[176:179], v[88:91], a[16:19]
v_cvt_pk_bf16_f32 v78, v20, v21
v_cvt_pk_bf16_f32 v79, v22, v23
v_mfma_f32_16x16x32_bf16 a[48:51], a[176:179], v[92:95], a[48:51]
v_exp_f32 v28, v28
v_mfma_f32_16x16x32_bf16 a[80:83], a[176:179], v[96:99], a[80:83]
v_cvt_pk_bf16_f32 v80, v24, v25
v_cvt_pk_bf16_f32 v81, v26, v27
v_mfma_f32_16x16x32_bf16 a[112:115], a[176:179], v[100:103], a[112:115]
v_exp_f32 v29, v29
v_mfma_f32_16x16x32_bf16 v[52:55], a[144:147], v[168:171], v[140:143]
ds_read_b64_tr_b16 a[176:177], v224 offset:0
ds_read_b64_tr_b16 a[178:179], v224 offset:4096
v_mfma_f32_16x16x32_bf16 v[52:55], a[148:151], v[172:175], v[52:55]
v_exp_f32 v30, v30
v_mfma_f32_16x16x32_bf16 v[52:55], a[152:155], v[176:179], v[52:55]
v_cvt_pk_bf16_f32 v82, v28, v29
v_sub_u32 v250, v249, v7
v_mfma_f32_16x16x32_bf16 v[52:55], a[156:159], v[180:183], v[52:55]
s_add_u32 s39, s39, 16384
v_exp_f32 v31, v31
v_mfma_f32_16x16x32_bf16 a[20:23], a[180:183], v[88:91], a[20:23]
s_add_u32 m0, s37, 16384
v_cvt_pk_bf16_f32 v83, v30, v31
v_add_u32 v250, 128, v250
v_mfma_f32_16x16x32_bf16 a[52:55], a[180:183], v[92:95], a[52:55]
v_exp_f32 v32, v32
v_mfma_f32_16x16x32_bf16 a[84:87], a[180:183], v[96:99], a[84:87]
buffer_load_dwordx4 v228, s[8:11], s38 offen offset:0 lds
v_mfma_f32_16x16x32_bf16 a[116:119], a[180:183], v[100:103], a[116:119]
v_exp_f32 v33, v33
v_smfmac_f32_16x16x64_bf16 a[252:255], a[208:211], v[96:103], v235
ds_read_b64_tr_b16 a[180:181], v225 offset:0
ds_read_b64_tr_b16 a[182:183], v225 offset:4096
v_mfma_f32_16x16x32_bf16 v[60:63], a[144:147], v[184:187], v[144:147]
v_exp_f32 v34, v34
v_mfma_f32_16x16x32_bf16 v[60:63], a[148:151], v[188:191], v[60:63]
v_cvt_pk_bf16_f32 v84, v32, v33
v_mfma_f32_16x16x32_bf16 v[60:63], a[152:155], v[192:195], v[60:63]
v_exp_f32 v35, v35
v_mfma_f32_16x16x32_bf16 v[60:63], a[156:159], v[196:199], v[60:63]
buffer_load_dwordx4 v229, s[8:11], s38 offen offset:1024 lds
v_mfma_f32_16x16x32_bf16 a[24:27], a[184:187], v[88:91], a[24:27]
v_exp_f32 v36, v36
v_mfma_f32_16x16x32_bf16 a[56:59], a[184:187], v[92:95], a[56:59]
v_cvt_pk_bf16_f32 v85, v34, v35
v_mfma_f32_16x16x32_bf16 a[88:91], a[184:187], v[96:99], a[88:91]
v_exp_f32 v37, v37
v_mfma_f32_16x16x32_bf16 a[120:123], a[184:187], v[100:103], a[120:123]
ds_read_b64_tr_b16 a[184:185], v226 offset:0
ds_read_b64_tr_b16 a[186:187], v226 offset:4096
v_mfma_f32_16x16x32_bf16 v[68:71], a[144:147], v[200:203], v[148:151]
v_exp_f32 v38, v38
v_mfma_f32_16x16x32_bf16 v[68:71], a[148:151], v[204:207], v[68:71]
ds_read_b128 a[144:147], v216 offset:53248
ds_read_b128 a[148:151], v217 offset:53248
v_mfma_f32_16x16x32_bf16 v[68:71], a[152:155], v[208:211], v[68:71]
v_exp_f32 v39, v39
v_mfma_f32_16x16x32_bf16 v[68:71], a[156:159], v[212:215], v[68:71]
ds_read_b128 a[152:155], v218 offset:53248
ds_read_b128 a[156:159], v219 offset:53248
v_mfma_f32_16x16x32_bf16 a[28:31], a[188:191], v[88:91], a[28:31]
v_cvt_pk_bf16_f32 v86, v36, v37
v_cvt_pk_bf16_f32 v87, v38, v39
v_mfma_f32_16x16x32_bf16 a[60:63], a[188:191], v[92:95], a[60:63]
v_mfma_f32_16x16x32_bf16 a[92:95], a[188:191], v[96:99], a[92:95]
v_mfma_f32_16x16x32_bf16 a[124:127], a[188:191], v[100:103], a[124:127]
s_waitcnt lgkmcnt(6)
ds_read_b64_tr_b16 a[188:189], v227 offset:0
ds_read_b64_tr_b16 a[190:191], v227 offset:4096
v_mfma_f32_16x16x32_bf16 v[8:11], a[128:131], v[152:155], v[136:139]
s_waitcnt vmcnt(10)
s_nop 0
v_exp_f32 v40, v40
v_mfma_f32_16x16x32_bf16 v[8:11], a[132:135], v[156:159], v[8:11]
v_exp_f32 v41, v41
v_mfma_f32_16x16x32_bf16 v[8:11], a[136:139], v[160:163], v[8:11]
buffer_load_dwordx4 v230, s[8:11], s38 offen offset:2048 lds
v_mfma_f32_16x16x32_bf16 v[8:11], a[140:143], v[164:167], v[8:11]
v_exp_f32 v42, v42
v_mfma_f32_16x16x32_bf16 a[0:3], a[160:163], v[72:75], a[0:3]
ds_read_b64_tr_b16 a[192:193], v248 offset:0
v_cvt_pk_bf16_f32 v88, v40, v41
v_mfma_f32_16x16x32_bf16 a[32:35], a[160:163], v[76:79], a[32:35]
v_exp_f32 v43, v43
v_mfma_f32_16x16x32_bf16 a[64:67], a[160:163], v[80:83], a[64:67]
ds_read_b64_tr_b16 a[194:195], v248 offset:256
v_cvt_pk_bf16_f32 v89, v42, v43
v_mfma_f32_16x16x32_bf16 a[96:99], a[160:163], v[84:87], a[96:99]
v_exp_f32 v44, v44
v_mfma_f32_16x16x32_bf16 v[16:19], a[128:131], v[168:171], v[140:143]
ds_read_b64_tr_b16 a[160:161], v220 offset:8192
ds_read_b64_tr_b16 a[162:163], v220 offset:12288
v_mfma_f32_16x16x32_bf16 v[16:19], a[132:135], v[172:175], v[16:19]
v_exp_f32 v45, v45
v_mfma_f32_16x16x32_bf16 v[16:19], a[136:139], v[176:179], v[16:19]
ds_read_b64_tr_b16 a[196:197], v248 offset:32
v_cvt_pk_bf16_f32 v90, v44, v45
v_mfma_f32_16x16x32_bf16 v[16:19], a[140:143], v[180:183], v[16:19]
v_exp_f32 v46, v46
v_mfma_f32_16x16x32_bf16 a[4:7], a[164:167], v[72:75], a[4:7]
ds_read_b64_tr_b16 a[198:199], v248 offset:288
ds_read_b64_tr_b16 a[200:201], v248 offset:4096
v_mfma_f32_16x16x32_bf16 a[36:39], a[164:167], v[76:79], a[36:39]
v_exp_f32 v47, v47
v_mfma_f32_16x16x32_bf16 a[68:71], a[164:167], v[80:83], a[68:71]
buffer_load_dwordx4 v231, s[8:11], s38 offen offset:3072 lds
v_mfma_f32_16x16x32_bf16 a[100:103], a[164:167], v[84:87], a[100:103]
v_exp_f32 v48, v48
v_smfmac_f32_16x16x64_bf16 a[248:251], a[208:211], v[72:79], v235
ds_read_b64_tr_b16 a[164:165], v221 offset:8192
ds_read_b64_tr_b16 a[166:167], v221 offset:12288
v_mfma_f32_16x16x32_bf16 v[24:27], a[128:131], v[184:187], v[144:147]
v_exp_f32 v49, v49
v_mfma_f32_16x16x32_bf16 v[24:27], a[132:135], v[188:191], v[24:27]
v_cvt_pk_bf16_f32 v91, v46, v47
v_cvt_pk_bf16_f32 v92, v48, v49
v_mfma_f32_16x16x32_bf16 v[24:27], a[136:139], v[192:195], v[24:27]
v_exp_f32 v50, v50
v_mfma_f32_16x16x32_bf16 v[24:27], a[140:143], v[196:199], v[24:27]
ds_read_b64_tr_b16 a[202:203], v248 offset:4352
ds_read_b64_tr_b16 a[204:205], v248 offset:4128
v_mfma_f32_16x16x32_bf16 a[8:11], a[168:171], v[72:75], a[8:11]
v_exp_f32 v51, v51
v_mfma_f32_16x16x32_bf16 a[40:43], a[168:171], v[76:79], a[40:43]
ds_read_b64_tr_b16 a[206:207], v248 offset:4384
v_cvt_pk_bf16_f32 v93, v50, v51
v_mfma_f32_16x16x32_bf16 a[72:75], a[168:171], v[80:83], a[72:75]
v_exp_f32 v52, v52
v_mfma_f32_16x16x32_bf16 a[104:107], a[168:171], v[84:87], a[104:107]
ds_read_b64_tr_b16 a[168:169], v222 offset:8192
ds_read_b64_tr_b16 a[170:171], v222 offset:12288
v_mfma_f32_16x16x32_bf16 v[32:35], a[128:131], v[200:203], v[148:151]
s_add_u32 s38, s38, 16384
v_exp_f32 v53, v53
v_mfma_f32_16x16x32_bf16 v[32:35], a[132:135], v[204:207], v[32:35]
s_add_u32 m0, s37, 114688
ds_read_b128 a[128:131], v216 offset:57344
ds_read_b128 a[132:135], v217 offset:57344
v_mfma_f32_16x16x32_bf16 v[32:35], a[136:139], v[208:211], v[32:35]
v_exp_f32 v54, v54
v_mfma_f32_16x16x32_bf16 v[32:35], a[140:143], v[212:215], v[32:35]
buffer_load_dwordx4 v232, s[12:15], s39 offen offset:0 lds
v_mfma_f32_16x16x32_bf16 a[12:15], a[172:175], v[72:75], a[12:15]
v_exp_f32 v55, v55
v_mfma_f32_16x16x32_bf16 a[44:47], a[172:175], v[76:79], a[44:47]
ds_read_b128 a[136:139], v218 offset:57344
ds_read_b128 a[140:143], v219 offset:57344
v_mfma_f32_16x16x32_bf16 a[76:79], a[172:175], v[80:83], a[76:79]
v_exp_f32 v56, v56
v_mfma_f32_16x16x32_bf16 a[108:111], a[172:175], v[84:87], a[108:111]
s_waitcnt lgkmcnt(6)
v_exp_f32 v57, v57
v_mfma_f32_16x16x32_bf16 v[12:15], a[144:147], v[152:155], v[136:139]
ds_read_b64_tr_b16 a[172:173], v223 offset:8192
ds_read_b64_tr_b16 a[174:175], v223 offset:12288
v_mfma_f32_16x16x32_bf16 v[12:15], a[148:151], v[156:159], v[12:15]
v_exp_f32 v58, v58
v_mfma_f32_16x16x32_bf16 v[12:15], a[152:155], v[160:163], v[12:15]
v_cvt_pk_bf16_f32 v94, v52, v53
v_cvt_pk_bf16_f32 v95, v54, v55
v_mfma_f32_16x16x32_bf16 v[12:15], a[156:159], v[164:167], v[12:15]
v_exp_f32 v59, v59
v_mfma_f32_16x16x32_bf16 a[16:19], a[176:179], v[72:75], a[16:19]
v_cvt_pk_bf16_f32 v96, v56, v57
v_cvt_pk_bf16_f32 v97, v58, v59
v_mfma_f32_16x16x32_bf16 a[48:51], a[176:179], v[76:79], a[48:51]
v_exp_f32 v60, v60
v_mfma_f32_16x16x32_bf16 a[80:83], a[176:179], v[80:83], a[80:83]
buffer_load_dwordx4 v233, s[12:15], s39 offen offset:1024 lds
v_mfma_f32_16x16x32_bf16 a[112:115], a[176:179], v[84:87], a[112:115]
v_exp_f32 v61, v61
v_mfma_f32_16x16x32_bf16 v[20:23], a[144:147], v[168:171], v[140:143]
ds_read_b64_tr_b16 a[176:177], v224 offset:8192
ds_read_b64_tr_b16 a[178:179], v224 offset:12288
v_mfma_f32_16x16x32_bf16 v[20:23], a[148:151], v[172:175], v[20:23]
v_exp_f32 v62, v62
v_mfma_f32_16x16x32_bf16 v[20:23], a[152:155], v[176:179], v[20:23]
ds_read_b64_tr_b16 v[120:121], v248 offset:2048
v_cvt_pk_bf16_f32 v98, v60, v61
v_mfma_f32_16x16x32_bf16 v[20:23], a[156:159], v[180:183], v[20:23]
v_exp_f32 v63, v63
v_mfma_f32_16x16x32_bf16 a[20:23], a[180:183], v[72:75], a[20:23]
ds_read_b64_tr_b16 v[122:123], v248 offset:2304
v_cvt_pk_bf16_f32 v99, v62, v63
v_mfma_f32_16x16x32_bf16 a[52:55], a[180:183], v[76:79], a[52:55]
v_exp_f32 v64, v64
v_mfma_f32_16x16x32_bf16 a[84:87], a[180:183], v[80:83], a[84:87]
ds_read_b64_tr_b16 v[124:125], v248 offset:2080
ds_read_b64_tr_b16 v[126:127], v248 offset:2336
v_mfma_f32_16x16x32_bf16 a[116:119], a[180:183], v[84:87], a[116:119]
v_exp_f32 v65, v65
v_smfmac_f32_16x16x64_bf16 a[252:255], a[208:211], v[80:87], v235
ds_read_b64_tr_b16 a[180:181], v225 offset:8192
ds_read_b64_tr_b16 a[182:183], v225 offset:12288
v_mfma_f32_16x16x32_bf16 v[28:31], a[144:147], v[184:187], v[144:147]
v_exp_f32 v66, v66
v_mfma_f32_16x16x32_bf16 v[28:31], a[148:151], v[188:191], v[28:31]
buffer_load_dwordx4 v232, s[12:15], s39 offen offset:2048 lds
v_mfma_f32_16x16x32_bf16 v[28:31], a[152:155], v[192:195], v[28:31]
v_exp_f32 v67, v67
v_mfma_f32_16x16x32_bf16 v[28:31], a[156:159], v[196:199], v[28:31]
v_cvt_pk_bf16_f32 v100, v64, v65
v_cvt_pk_bf16_f32 v101, v66, v67
v_mfma_f32_16x16x32_bf16 a[24:27], a[184:187], v[72:75], a[24:27]
v_exp_f32 v68, v68
v_mfma_f32_16x16x32_bf16 a[56:59], a[184:187], v[76:79], a[56:59]
ds_read_b64_tr_b16 v[128:129], v248 offset:6144
ds_read_b64_tr_b16 v[130:131], v248 offset:6400
v_mfma_f32_16x16x32_bf16 a[88:91], a[184:187], v[80:83], a[88:91]
v_exp_f32 v69, v69
v_mfma_f32_16x16x32_bf16 a[120:123], a[184:187], v[84:87], a[120:123]
ds_read_b64_tr_b16 a[184:185], v226 offset:8192
ds_read_b64_tr_b16 a[186:187], v226 offset:12288
v_mfma_f32_16x16x32_bf16 v[36:39], a[144:147], v[200:203], v[148:151]
v_exp_f32 v70, v70
v_mfma_f32_16x16x32_bf16 v[36:39], a[148:151], v[204:207], v[36:39]
ds_read_b128 a[144:147], v216 offset:61440
ds_read_b128 a[148:151], v217 offset:61440
v_mfma_f32_16x16x32_bf16 v[36:39], a[152:155], v[208:211], v[36:39]
v_exp_f32 v71, v71
v_mfma_f32_16x16x32_bf16 v[36:39], a[156:159], v[212:215], v[36:39]
ds_read_b128 a[152:155], v218 offset:61440
ds_read_b128 a[156:159], v219 offset:61440
v_mfma_f32_16x16x32_bf16 a[28:31], a[188:191], v[72:75], a[28:31]
v_cvt_pk_bf16_f32 v102, v68, v69
v_cvt_pk_bf16_f32 v103, v70, v71
v_mfma_f32_16x16x32_bf16 a[60:63], a[188:191], v[76:79], a[60:63]
ds_read_b64_tr_b16 v[132:133], v248 offset:6176
ds_read_b64_tr_b16 v[134:135], v248 offset:6432
v_mfma_f32_16x16x32_bf16 a[92:95], a[188:191], v[80:83], a[92:95]
v_mfma_f32_16x16x32_bf16 a[124:127], a[188:191], v[84:87], a[124:127]
s_waitcnt lgkmcnt(8)
ds_read_b64_tr_b16 a[188:189], v227 offset:8192
ds_read_b64_tr_b16 a[190:191], v227 offset:12288
v_mfma_f32_16x16x32_bf16 v[40:43], a[128:131], v[152:155], v[136:139]
v_exp_f32 v8, v8
v_mfma_f32_16x16x32_bf16 v[40:43], a[132:135], v[156:159], v[40:43]
buffer_load_dwordx4 v233, s[12:15], s39 offen offset:3072 lds
v_mfma_f32_16x16x32_bf16 v[40:43], a[136:139], v[160:163], v[40:43]
v_exp_f32 v9, v9
v_mfma_f32_16x16x32_bf16 v[40:43], a[140:143], v[164:167], v[40:43]
v_cvt_pk_bf16_f32 v72, v8, v9
v_mfma_f32_16x16x32_bf16 a[0:3], a[160:163], v[88:91], a[0:3]
v_exp_f32 v10, v10
v_mfma_f32_16x16x32_bf16 a[32:35], a[160:163], v[92:95], a[32:35]
v_mfma_f32_16x16x32_bf16 a[64:67], a[160:163], v[96:99], a[64:67]
v_exp_f32 v11, v11
v_mfma_f32_16x16x32_bf16 a[96:99], a[160:163], v[100:103], a[96:99]
ds_read_b64_tr_b16 a[160:161], v220 offset:16384
ds_read_b64_tr_b16 a[162:163], v220 offset:20480
v_mfma_f32_16x16x32_bf16 v[104:107], a[192:195], a[212:215], v[104:107]
s_add_u32 m0, s49, 0
v_exp_f32 v12, v12
v_mfma_f32_16x16x32_bf16 v[48:51], a[128:131], v[168:171], v[140:143]
s_add_u32 s48, s50, 589824
s_waitcnt lgkmcnt(4)
buffer_load_dwordx4 v238, s[56:59], s48 offen  lds
v_mfma_f32_16x16x32_bf16 v[48:51], a[132:135], v[172:175], v[48:51]
v_exp_f32 v13, v13
v_mfma_f32_16x16x32_bf16 v[48:51], a[136:139], v[176:179], v[48:51]
v_cvt_pk_bf16_f32 v73, v10, v11
v_cvt_pk_bf16_f32 v74, v12, v13
v_mfma_f32_16x16x32_bf16 v[48:51], a[140:143], v[180:183], v[48:51]
v_mfma_f32_16x16x32_bf16 a[4:7], a[164:167], v[88:91], a[4:7]
v_exp_f32 v14, v14
v_mfma_f32_16x16x32_bf16 a[36:39], a[164:167], v[92:95], a[36:39]
v_mfma_f32_16x16x32_bf16 a[68:71], a[164:167], v[96:99], a[68:71]
v_exp_f32 v15, v15
v_mfma_f32_16x16x32_bf16 a[100:103], a[164:167], v[100:103], a[100:103]
s_add_u32 s39, s39, 16384
ds_read_b64_tr_b16 a[164:165], v221 offset:16384
ds_read_b64_tr_b16 a[166:167], v221 offset:20480
v_smfmac_f32_16x16x64_bf16 a[248:251], a[208:211], v[88:95], v235
s_add_u32 m0, s37, 0
v_exp_f32 v16, v16
v_mfma_f32_16x16x32_bf16 v[108:111], a[196:199], a[212:215], v[108:111]
buffer_load_dwordx4 v228, s[8:11], s38 offen offset:0 lds
v_mfma_f32_16x16x32_bf16 v[56:59], a[128:131], v[184:187], v[144:147]
v_exp_f32 v17, v17
v_mfma_f32_16x16x32_bf16 v[56:59], a[132:135], v[188:191], v[56:59]
v_cvt_pk_bf16_f32 v75, v14, v15
v_cvt_pk_bf16_f32 v76, v16, v17
v_mfma_f32_16x16x32_bf16 v[56:59], a[136:139], v[192:195], v[56:59]
v_exp_f32 v18, v18
v_mfma_f32_16x16x32_bf16 v[56:59], a[140:143], v[196:199], v[56:59]
v_mfma_f32_16x16x32_bf16 a[8:11], a[168:171], v[88:91], a[8:11]
v_mfma_f32_16x16x32_bf16 a[40:43], a[168:171], v[92:95], a[40:43]
s_add_u32 m0, s49, 1024
v_exp_f32 v19, v19
v_mfma_f32_16x16x32_bf16 a[72:75], a[168:171], v[96:99], a[72:75]
s_add_u32 s48, s50, 737280
buffer_load_dwordx4 v238, s[56:59], s48 offen  lds
v_mfma_f32_16x16x32_bf16 a[104:107], a[168:171], v[100:103], a[104:107]
v_exp_f32 v20, v20
v_mfma_f32_16x16x32_bf16 v[112:115], a[200:203], a[212:215], v[112:115]
ds_read_b64_tr_b16 a[168:169], v222 offset:16384
ds_read_b64_tr_b16 a[170:171], v222 offset:20480
v_mfma_f32_16x16x32_bf16 v[64:67], a[128:131], v[200:203], v[148:151]
v_exp_f32 v21, v21
v_mfma_f32_16x16x32_bf16 v[64:67], a[132:135], v[204:207], v[64:67]
ds_read_b128 a[128:131], v216 offset:32768
ds_read_b128 a[132:135], v217 offset:32768
v_mfma_f32_16x16x32_bf16 v[64:67], a[136:139], v[208:211], v[64:67]
v_exp_f32 v22, v22
v_mfma_f32_16x16x32_bf16 v[64:67], a[140:143], v[212:215], v[64:67]
ds_read_b128 a[136:139], v218 offset:32768
ds_read_b128 a[140:143], v219 offset:32768
v_mfma_f32_16x16x32_bf16 a[12:15], a[172:175], v[88:91], a[12:15]
s_add_u32 m0, s37, 0
v_exp_f32 v23, v23
v_mfma_f32_16x16x32_bf16 a[44:47], a[172:175], v[92:95], a[44:47]
buffer_load_dwordx4 v229, s[8:11], s38 offen offset:1024 lds
v_mfma_f32_16x16x32_bf16 a[76:79], a[172:175], v[96:99], a[76:79]
v_cvt_pk_bf16_f32 v77, v18, v19
v_cvt_pk_bf16_f32 v78, v20, v21
v_mfma_f32_16x16x32_bf16 a[108:111], a[172:175], v[100:103], a[108:111]
v_exp_f32 v24, v24
v_mfma_f32_16x16x32_bf16 v[116:119], a[204:207], a[212:215], v[116:119]
ds_read_b64_tr_b16 a[172:173], v223 offset:16384
ds_read_b64_tr_b16 a[174:175], v223 offset:20480
v_mfma_f32_16x16x32_bf16 v[44:47], a[144:147], v[152:155], v[136:139]
v_exp_f32 v25, v25
v_mfma_f32_16x16x32_bf16 v[44:47], a[148:151], v[156:159], v[44:47]
v_cvt_pk_bf16_f32 v79, v22, v23
v_cvt_pk_bf16_f32 v80, v24, v25
v_mfma_f32_16x16x32_bf16 v[44:47], a[152:155], v[160:163], v[44:47]
s_add_u32 m0, s49, 2048
v_exp_f32 v26, v26
v_mfma_f32_16x16x32_bf16 v[44:47], a[156:159], v[164:167], v[44:47]
s_add_u32 s48, s50, 884736
buffer_load_dwordx4 v238, s[56:59], s48 offen  lds
v_mfma_f32_16x16x32_bf16 a[16:19], a[176:179], v[88:91], a[16:19]
v_exp_f32 v27, v27
v_mfma_f32_16x16x32_bf16 a[48:51], a[176:179], v[92:95], a[48:51]
v_cvt_pk_bf16_f32 v81, v26, v27
v_mfma_f32_16x16x32_bf16 a[80:83], a[176:179], v[96:99], a[80:83]
v_exp_f32 v28, v28
v_mfma_f32_16x16x32_bf16 a[112:115], a[176:179], v[100:103], a[112:115]
ds_read_b64_tr_b16 a[176:177], v224 offset:16384
ds_read_b64_tr_b16 a[178:179], v224 offset:20480
v_mfma_f32_16x16x32_bf16 v[104:107], v[120:123], a[216:219], v[104:107]
v_exp_f32 v29, v29
v_mfma_f32_16x16x32_bf16 v[52:55], a[144:147], v[168:171], v[140:143]
v_cvt_pk_bf16_f32 v82, v28, v29
v_mfma_f32_16x16x32_bf16 v[52:55], a[148:151], v[172:175], v[52:55]
s_add_u32 m0, s37, 0
v_mfma_f32_16x16x32_bf16 v[52:55], a[152:155], v[176:179], v[52:55]
v_exp_f32 v30, v30
v_mfma_f32_16x16x32_bf16 v[52:55], a[156:159], v[180:183], v[52:55]
buffer_load_dwordx4 v230, s[8:11], s38 offen offset:2048 lds
v_mfma_f32_16x16x32_bf16 a[20:23], a[180:183], v[88:91], a[20:23]
v_exp_f32 v31, v31
v_mfma_f32_16x16x32_bf16 a[52:55], a[180:183], v[92:95], a[52:55]
v_cvt_pk_bf16_f32 v83, v30, v31
v_mfma_f32_16x16x32_bf16 a[84:87], a[180:183], v[96:99], a[84:87]
v_exp_f32 v32, v32
v_mfma_f32_16x16x32_bf16 a[116:119], a[180:183], v[100:103], a[116:119]
ds_read_b64_tr_b16 a[180:181], v225 offset:16384
ds_read_b64_tr_b16 a[182:183], v225 offset:20480
v_smfmac_f32_16x16x64_bf16 a[252:255], a[208:211], v[96:103], v235
v_exp_f32 v33, v33
v_mfma_f32_16x16x32_bf16 v[108:111], v[124:127], a[216:219], v[108:111]
s_add_u32 m0, s49, 3072
v_cvt_pk_bf16_f32 v84, v32, v33
v_mfma_f32_16x16x32_bf16 v[60:63], a[144:147], v[184:187], v[144:147]
s_add_u32 s48, s50, 1032192
v_exp_f32 v34, v34
v_mfma_f32_16x16x32_bf16 v[60:63], a[148:151], v[188:191], v[60:63]
buffer_load_dwordx4 v238, s[56:59], s48 offen  lds
v_mfma_f32_16x16x32_bf16 v[60:63], a[152:155], v[192:195], v[60:63]
v_mfma_f32_16x16x32_bf16 v[60:63], a[156:159], v[196:199], v[60:63]
v_exp_f32 v35, v35
v_mfma_f32_16x16x32_bf16 a[24:27], a[184:187], v[88:91], a[24:27]
v_cvt_pk_bf16_f32 v85, v34, v35
v_mfma_f32_16x16x32_bf16 a[56:59], a[184:187], v[92:95], a[56:59]
v_exp_f32 v36, v36
v_mfma_f32_16x16x32_bf16 a[88:91], a[184:187], v[96:99], a[88:91]
v_mfma_f32_16x16x32_bf16 a[120:123], a[184:187], v[100:103], a[120:123]
s_add_u32 m0, s37, 0
v_exp_f32 v37, v37
v_mfma_f32_16x16x32_bf16 v[112:115], v[128:131], a[216:219], v[112:115]
buffer_load_dwordx4 v231, s[8:11], s38 offen offset:3072 lds
v_mfma_f32_16x16x32_bf16 v[68:71], a[144:147], v[200:203], v[148:151]
v_exp_f32 v38, v38
v_mfma_f32_16x16x32_bf16 v[68:71], a[148:151], v[204:207], v[68:71]
ds_read_b64_tr_b16 a[184:185], v226 offset:16384
ds_read_b64_tr_b16 a[186:187], v226 offset:20480
v_mfma_f32_16x16x32_bf16 v[68:71], a[152:155], v[208:211], v[68:71]
v_exp_f32 v39, v39
v_mfma_f32_16x16x32_bf16 v[68:71], a[156:159], v[212:215], v[68:71]
s_waitcnt lgkmcnt(2)
ds_read_b128 a[144:147], v216 offset:36864
ds_read_b128 a[148:151], v217 offset:36864
v_mfma_f32_16x16x32_bf16 a[28:31], a[188:191], v[88:91], a[28:31]
ds_read_b128 a[152:155], v218 offset:36864
ds_read_b128 a[156:159], v219 offset:36864
v_mfma_f32_16x16x32_bf16 a[60:63], a[188:191], v[92:95], a[60:63]
v_cvt_pk_bf16_f32 v86, v36, v37
v_cvt_pk_bf16_f32 v87, v38, v39
v_mfma_f32_16x16x32_bf16 a[92:95], a[188:191], v[96:99], a[92:95]
s_add_u32 s38, s38, 16384
v_mfma_f32_16x16x32_bf16 a[124:127], a[188:191], v[100:103], a[124:127]
ds_read_b64_tr_b16 a[188:189], v227 offset:16384
ds_read_b64_tr_b16 a[190:191], v227 offset:20480
v_mfma_f32_16x16x32_bf16 v[116:119], v[132:135], a[216:219], v[116:119]
v_mfma_f32_16x16x32_bf16 v[8:11], a[128:131], v[152:155], v[136:139]
v_exp_f32 v40, v40
v_mfma_f32_16x16x32_bf16 v[8:11], a[132:135], v[156:159], v[8:11]
s_add_u32 m0, s49, 4096
v_exp_f32 v41, v41
v_mfma_f32_16x16x32_bf16 v[8:11], a[136:139], v[160:163], v[8:11]
s_add_u32 s48, s50, 589824
buffer_load_dwordx4 v238, s[60:63], s48 offen  lds
v_mfma_f32_16x16x32_bf16 v[8:11], a[140:143], v[164:167], v[8:11]
v_exp_f32 v42, v42
v_mfma_f32_16x16x32_bf16 a[0:3], a[160:163], v[72:75], a[0:3]
v_cvt_pk_bf16_f32 v88, v40, v41
v_mfma_f32_16x16x32_bf16 a[32:35], a[160:163], v[76:79], a[32:35]
v_exp_f32 v43, v43
v_mfma_f32_16x16x32_bf16 a[64:67], a[160:163], v[80:83], a[64:67]
v_cvt_pk_bf16_f32 v89, v42, v43
v_mfma_f32_16x16x32_bf16 a[96:99], a[160:163], v[84:87], a[96:99]
v_exp_f32 v44, v44
v_mfma_f32_16x16x32_bf16 v[16:19], a[128:131], v[168:171], v[140:143]
s_add_u32 m0, s49, 5120
ds_read_b64_tr_b16 a[160:161], v220 offset:24576
ds_read_b64_tr_b16 a[162:163], v220 offset:28672
v_mfma_f32_16x16x32_bf16 v[16:19], a[132:135], v[172:175], v[16:19]
s_add_u32 s48, s50, 737280
v_exp_f32 v45, v45
v_mfma_f32_16x16x32_bf16 v[16:19], a[136:139], v[176:179], v[16:19]
buffer_load_dwordx4 v238, s[60:63], s48 offen  lds
v_mfma_f32_16x16x32_bf16 v[16:19], a[140:143], v[180:183], v[16:19]
v_exp_f32 v46, v46
v_mfma_f32_16x16x32_bf16 a[4:7], a[164:167], v[72:75], a[4:7]
v_cvt_pk_bf16_f32 v90, v44, v45
v_mfma_f32_16x16x32_bf16 a[36:39], a[164:167], v[76:79], a[36:39]
v_exp_f32 v47, v47
v_mfma_f32_16x16x32_bf16 a[68:71], a[164:167], v[80:83], a[68:71]
v_cvt_pk_bf16_f32 v91, v46, v47
v_mfma_f32_16x16x32_bf16 a[100:103], a[164:167], v[84:87], a[100:103]
v_exp_f32 v48, v48
v_smfmac_f32_16x16x64_bf16 a[248:251], a[208:211], v[72:79], v235
s_add_u32 m0, s49, 6144
ds_read_b64_tr_b16 a[164:165], v221 offset:24576
ds_read_b64_tr_b16 a[166:167], v221 offset:28672
v_mfma_f32_16x16x32_bf16 v[24:27], a[128:131], v[184:187], v[144:147]
s_add_u32 s48, s50, 884736
v_exp_f32 v49, v49
v_mfma_f32_16x16x32_bf16 v[24:27], a[132:135], v[188:191], v[24:27]
buffer_load_dwordx4 v238, s[60:63], s48 offen  lds
v_mfma_f32_16x16x32_bf16 v[24:27], a[136:139], v[192:195], v[24:27]
v_exp_f32 v50, v50
v_mfma_f32_16x16x32_bf16 v[24:27], a[140:143], v[196:199], v[24:27]
v_cvt_pk_bf16_f32 v92, v48, v49
v_mfma_f32_16x16x32_bf16 a[8:11], a[168:171], v[72:75], a[8:11]
v_exp_f32 v51, v51
v_mfma_f32_16x16x32_bf16 a[40:43], a[168:171], v[76:79], a[40:43]
v_cvt_pk_bf16_f32 v93, v50, v51
v_mfma_f32_16x16x32_bf16 a[72:75], a[168:171], v[80:83], a[72:75]
v_exp_f32 v52, v52
v_mfma_f32_16x16x32_bf16 a[104:107], a[168:171], v[84:87], a[104:107]
s_add_u32 m0, s49, 7168
ds_read_b64_tr_b16 a[168:169], v222 offset:24576
ds_read_b64_tr_b16 a[170:171], v222 offset:28672
v_mfma_f32_16x16x32_bf16 v[32:35], a[128:131], v[200:203], v[148:151]
s_add_u32 s48, s50, 1032192
v_exp_f32 v53, v53
v_mfma_f32_16x16x32_bf16 v[32:35], a[132:135], v[204:207], v[32:35]
buffer_load_dwordx4 v238, s[60:63], s48 offen  lds
v_mfma_f32_16x16x32_bf16 v[32:35], a[136:139], v[208:211], v[32:35]
v_exp_f32 v54, v54
v_mfma_f32_16x16x32_bf16 v[32:35], a[140:143], v[212:215], v[32:35]
ds_read_b128 a[128:131], v216 offset:40960
ds_read_b128 a[132:135], v217 offset:40960
v_mfma_f32_16x16x32_bf16 a[12:15], a[172:175], v[72:75], a[12:15]
v_exp_f32 v55, v55
v_mfma_f32_16x16x32_bf16 a[44:47], a[172:175], v[76:79], a[44:47]
ds_read_b128 a[136:139], v218 offset:40960
ds_read_b128 a[140:143], v219 offset:40960
v_mfma_f32_16x16x32_bf16 a[76:79], a[172:175], v[80:83], a[76:79]
v_exp_f32 v56, v56
v_mfma_f32_16x16x32_bf16 a[108:111], a[172:175], v[84:87], a[108:111]
s_waitcnt lgkmcnt(6)
v_exp_f32 v57, v57
v_mfma_f32_16x16x32_bf16 v[12:15], a[144:147], v[152:155], v[136:139]
buffer_load_dwordx2 v[252:253], v251, s[76:79], s42 offen sc1
v_mfma_f32_16x16x32_bf16 v[12:15], a[148:151], v[156:159], v[12:15]
v_exp_f32 v58, v58
v_mfma_f32_16x16x32_bf16 v[12:15], a[152:155], v[160:163], v[12:15]
ds_read_b64_tr_b16 a[172:173], v223 offset:24576
ds_read_b64_tr_b16 a[174:175], v223 offset:28672
v_mfma_f32_16x16x32_bf16 v[12:15], a[156:159], v[164:167], v[12:15]
v_exp_f32 v59, v59
v_mfma_f32_16x16x32_bf16 a[16:19], a[176:179], v[72:75], a[16:19]
v_cvt_pk_bf16_f32 v94, v52, v53
v_cvt_pk_bf16_f32 v95, v54, v55
v_mfma_f32_16x16x32_bf16 a[48:51], a[176:179], v[76:79], a[48:51]
v_exp_f32 v60, v60
v_mfma_f32_16x16x32_bf16 a[80:83], a[176:179], v[80:83], a[80:83]
s_add_u32 s42, s42, s43
buffer_load_dword v255, v243, s[28:31], s45 offen
v_mfma_f32_16x16x32_bf16 a[112:115], a[176:179], v[84:87], a[112:115]
v_exp_f32 v61, v61
v_mfma_f32_16x16x32_bf16 v[20:23], a[144:147], v[168:171], v[140:143]
ds_read_b64_tr_b16 a[176:177], v224 offset:24576
ds_read_b64_tr_b16 a[178:179], v224 offset:28672
v_mfma_f32_16x16x32_bf16 v[20:23], a[148:151], v[172:175], v[20:23]
v_exp_f32 v62, v62
v_mfma_f32_16x16x32_bf16 v[20:23], a[152:155], v[176:179], v[20:23]
v_cvt_pk_bf16_f32 v96, v56, v57
v_cvt_pk_bf16_f32 v97, v58, v59
v_mfma_f32_16x16x32_bf16 v[20:23], a[156:159], v[180:183], v[20:23]
v_exp_f32 v63, v63
v_mfma_f32_16x16x32_bf16 a[20:23], a[180:183], v[72:75], a[20:23]
v_cvt_pk_bf16_f32 v98, v60, v61
v_cvt_pk_bf16_f32 v99, v62, v63
v_mfma_f32_16x16x32_bf16 a[52:55], a[180:183], v[76:79], a[52:55]
v_exp_f32 v64, v64
v_mfma_f32_16x16x32_bf16 a[84:87], a[180:183], v[80:83], a[84:87]
s_add_u32 s45, s45, 589824
global_load_dword v255, v242, s[72:73]
v_mfma_f32_16x16x32_bf16 a[116:119], a[180:183], v[84:87], a[116:119]
v_exp_f32 v65, v65
v_smfmac_f32_16x16x64_bf16 a[252:255], a[208:211], v[80:87], v235
ds_read_b64_tr_b16 a[180:181], v225 offset:24576
ds_read_b64_tr_b16 a[182:183], v225 offset:28672
v_mfma_f32_16x16x32_bf16 v[28:31], a[144:147], v[184:187], v[144:147]
v_exp_f32 v66, v66
v_mfma_f32_16x16x32_bf16 v[28:31], a[148:151], v[188:191], v[28:31]
v_cvt_pk_bf16_f32 v100, v64, v65
v_mfma_f32_16x16x32_bf16 v[28:31], a[152:155], v[192:195], v[28:31]
v_exp_f32 v67, v67
v_mfma_f32_16x16x32_bf16 v[28:31], a[156:159], v[196:199], v[28:31]
v_cvt_pk_bf16_f32 v101, v66, v67
v_mfma_f32_16x16x32_bf16 a[24:27], a[184:187], v[72:75], a[24:27]
v_exp_f32 v68, v68
v_mfma_f32_16x16x32_bf16 a[56:59], a[184:187], v[76:79], a[56:59]
buffer_load_dword v255, v0, s[24:27], s44 offen sc1
v_mfma_f32_16x16x32_bf16 a[88:91], a[184:187], v[80:83], a[88:91]
v_exp_f32 v69, v69
v_mfma_f32_16x16x32_bf16 a[120:123], a[184:187], v[84:87], a[120:123]
ds_read_b64_tr_b16 a[184:185], v226 offset:24576
ds_read_b64_tr_b16 a[186:187], v226 offset:28672
v_mfma_f32_16x16x32_bf16 v[36:39], a[144:147], v[200:203], v[148:151]
v_exp_f32 v70, v70
v_mfma_f32_16x16x32_bf16 v[36:39], a[148:151], v[204:207], v[36:39]
ds_read_b128 a[144:147], v216 offset:45056
ds_read_b128 a[148:151], v217 offset:45056
v_mfma_f32_16x16x32_bf16 v[36:39], a[152:155], v[208:211], v[36:39]
v_exp_f32 v71, v71
v_mfma_f32_16x16x32_bf16 v[36:39], a[156:159], v[212:215], v[36:39]
ds_read_b128 a[152:155], v218 offset:45056
ds_read_b128 a[156:159], v219 offset:45056
v_mfma_f32_16x16x32_bf16 a[28:31], a[188:191], v[72:75], a[28:31]
v_cvt_pk_bf16_f32 v102, v68, v69
v_cvt_pk_bf16_f32 v103, v70, v71
v_mfma_f32_16x16x32_bf16 a[60:63], a[188:191], v[76:79], a[60:63]
s_add_u32 s44, s44, 8192
v_mfma_f32_16x16x32_bf16 a[92:95], a[188:191], v[80:83], a[92:95]
v_mfma_f32_16x16x32_bf16 a[124:127], a[188:191], v[84:87], a[124:127]
s_waitcnt lgkmcnt(6)
ds_read_b64_tr_b16 a[188:189], v227 offset:24576
ds_read_b64_tr_b16 a[190:191], v227 offset:28672
v_mfma_f32_16x16x32_bf16 v[40:43], a[128:131], v[152:155], v[136:139]
v_exp_f32 v8, v8
v_mfma_f32_16x16x32_bf16 v[40:43], a[132:135], v[156:159], v[40:43]
v_exp_f32 v9, v9
v_mfma_f32_16x16x32_bf16 v[40:43], a[136:139], v[160:163], v[40:43]
v_cvt_pk_bf16_f32 v72, v8, v9
v_mfma_f32_16x16x32_bf16 v[40:43], a[140:143], v[164:167], v[40:43]
v_exp_f32 v10, v10
v_mfma_f32_16x16x32_bf16 a[0:3], a[160:163], v[88:91], a[0:3]
v_mfma_f32_16x16x32_bf16 a[32:35], a[160:163], v[92:95], a[32:35]
v_exp_f32 v11, v11
s_waitcnt vmcnt(8) lgkmcnt(0)
s_barrier
v_mfma_f32_16x16x32_bf16 a[64:67], a[160:163], v[96:99], a[64:67]
v_cvt_pk_bf16_f32 v73, v10, v11
v_mfma_f32_16x16x32_bf16 a[96:99], a[160:163], v[100:103], a[96:99]
s_add_u32 m0, s37, 65536
v_exp_f32 v12, v12
v_mfma_f32_16x16x32_bf16 v[48:51], a[128:131], v[168:171], v[140:143]
buffer_load_dwordx4 v232, s[12:15], s39 offen offset:0 lds
v_mfma_f32_16x16x32_bf16 v[48:51], a[132:135], v[172:175], v[48:51]
v_exp_f32 v13, v13
v_mfma_f32_16x16x32_bf16 v[48:51], a[136:139], v[176:179], v[48:51]
ds_read_b64_tr_b16 a[160:161], v220 offset:32768
ds_read_b64_tr_b16 a[162:163], v220 offset:36864
v_mfma_f32_16x16x32_bf16 v[48:51], a[140:143], v[180:183], v[48:51]
v_exp_f32 v14, v14
v_mfma_f32_16x16x32_bf16 a[4:7], a[164:167], v[88:91], a[4:7]
v_cvt_pk_bf16_f32 v74, v12, v13
v_mfma_f32_16x16x32_bf16 a[36:39], a[164:167], v[92:95], a[36:39]
v_exp_f32 v15, v15
v_mfma_f32_16x16x32_bf16 a[68:71], a[164:167], v[96:99], a[68:71]
v_cvt_pk_bf16_f32 v75, v14, v15
v_mfma_f32_16x16x32_bf16 a[100:103], a[164:167], v[100:103], a[100:103]
v_exp_f32 v16, v16
v_smfmac_f32_16x16x64_bf16 a[248:251], a[208:211], v[88:95], v235
buffer_load_dwordx4 v233, s[12:15], s39 offen offset:1024 lds
v_mfma_f32_16x16x32_bf16 v[56:59], a[128:131], v[184:187], v[144:147]
v_exp_f32 v17, v17
v_mfma_f32_16x16x32_bf16 v[56:59], a[132:135], v[188:191], v[56:59]
ds_read_b64_tr_b16 a[164:165], v221 offset:32768
ds_read_b64_tr_b16 a[166:167], v221 offset:36864
v_mfma_f32_16x16x32_bf16 v[56:59], a[136:139], v[192:195], v[56:59]
v_exp_f32 v18, v18
v_mfma_f32_16x16x32_bf16 v[56:59], a[140:143], v[196:199], v[56:59]
v_cvt_pk_bf16_f32 v76, v16, v17
v_mfma_f32_16x16x32_bf16 a[8:11], a[168:171], v[88:91], a[8:11]
v_exp_f32 v19, v19
v_mfma_f32_16x16x32_bf16 a[40:43], a[168:171], v[92:95], a[40:43]
v_cvt_pk_bf16_f32 v77, v18, v19
v_mfma_f32_16x16x32_bf16 a[72:75], a[168:171], v[96:99], a[72:75]
v_exp_f32 v20, v20
v_mfma_f32_16x16x32_bf16 a[104:107], a[168:171], v[100:103], a[104:107]
ds_read_b64_tr_b16 a[168:169], v222 offset:32768
ds_read_b64_tr_b16 a[170:171], v222 offset:36864
v_mfma_f32_16x16x32_bf16 v[64:67], a[128:131], v[200:203], v[148:151]
v_exp_f32 v21, v21
v_mfma_f32_16x16x32_bf16 v[64:67], a[132:135], v[204:207], v[64:67]
buffer_load_dwordx4 v232, s[12:15], s39 offen offset:2048 lds
v_mfma_f32_16x16x32_bf16 v[64:67], a[136:139], v[208:211], v[64:67]
v_exp_f32 v22, v22
v_mfma_f32_16x16x32_bf16 v[64:67], a[140:143], v[212:215], v[64:67]
ds_read_b128 a[128:131], v216 offset:16384
ds_read_b128 a[132:135], v217 offset:16384
v_mfma_f32_16x16x32_bf16 a[12:15], a[172:175], v[88:91], a[12:15]
v_exp_f32 v23, v23
v_mfma_f32_16x16x32_bf16 a[44:47], a[172:175], v[92:95], a[44:47]
ds_read_b128 a[136:139], v218 offset:16384
ds_read_b128 a[140:143], v219 offset:16384
v_mfma_f32_16x16x32_bf16 a[76:79], a[172:175], v[96:99], a[76:79]
v_exp_f32 v24, v24
v_mfma_f32_16x16x32_bf16 a[108:111], a[172:175], v[100:103], a[108:111]
v_exp_f32 v25, v25
v_mfma_f32_16x16x32_bf16 v[44:47], a[144:147], v[152:155], v[136:139]
ds_read_b64_tr_b16 a[172:173], v223 offset:32768
ds_read_b64_tr_b16 a[174:175], v223 offset:36864
v_mfma_f32_16x16x32_bf16 v[44:47], a[148:151], v[156:159], v[44:47]
v_exp_f32 v26, v26
v_mfma_f32_16x16x32_bf16 v[44:47], a[152:155], v[160:163], v[44:47]
buffer_load_dwordx4 v233, s[12:15], s39 offen offset:3072 lds
v_mfma_f32_16x16x32_bf16 v[44:47], a[156:159], v[164:167], v[44:47]
v_exp_f32 v27, v27
v_mfma_f32_16x16x32_bf16 a[16:19], a[176:179], v[88:91], a[16:19]
v_cvt_pk_bf16_f32 v78, v20, v21
v_cvt_pk_bf16_f32 v79, v22, v23
v_mfma_f32_16x16x32_bf16 a[48:51], a[176:179], v[92:95], a[48:51]
v_exp_f32 v28, v28
v_mfma_f32_16x16x32_bf16 a[80:83], a[176:179], v[96:99], a[80:83]
v_cvt_pk_bf16_f32 v80, v24, v25
v_cvt_pk_bf16_f32 v81, v26, v27
v_mfma_f32_16x16x32_bf16 a[112:115], a[176:179], v[100:103], a[112:115]
v_exp_f32 v29, v29
v_mfma_f32_16x16x32_bf16 v[52:55], a[144:147], v[168:171], v[140:143]
ds_read_b64_tr_b16 a[176:177], v224 offset:32768
ds_read_b64_tr_b16 a[178:179], v224 offset:36864
v_mfma_f32_16x16x32_bf16 v[52:55], a[148:151], v[172:175], v[52:55]
v_exp_f32 v30, v30
v_mfma_f32_16x16x32_bf16 v[52:55], a[152:155], v[176:179], v[52:55]
v_cvt_pk_bf16_f32 v82, v28, v29
v_mfma_f32_16x16x32_bf16 v[52:55], a[156:159], v[180:183], v[52:55]
s_add_u32 s39, s39, 16384
v_exp_f32 v31, v31
v_mfma_f32_16x16x32_bf16 a[20:23], a[180:183], v[88:91], a[20:23]
s_add_u32 m0, s37, 49152
v_cvt_pk_bf16_f32 v83, v30, v31
v_mfma_f32_16x16x32_bf16 a[52:55], a[180:183], v[92:95], a[52:55]
v_exp_f32 v32, v32
v_mfma_f32_16x16x32_bf16 a[84:87], a[180:183], v[96:99], a[84:87]
buffer_load_dwordx4 v228, s[8:11], s38 offen offset:0 lds
v_mfma_f32_16x16x32_bf16 a[116:119], a[180:183], v[100:103], a[116:119]
v_exp_f32 v33, v33
v_smfmac_f32_16x16x64_bf16 a[252:255], a[208:211], v[96:103], v235
ds_read_b64_tr_b16 a[180:181], v225 offset:32768
ds_read_b64_tr_b16 a[182:183], v225 offset:36864
v_mfma_f32_16x16x32_bf16 v[60:63], a[144:147], v[184:187], v[144:147]
v_exp_f32 v34, v34
v_mfma_f32_16x16x32_bf16 v[60:63], a[148:151], v[188:191], v[60:63]
v_cvt_pk_bf16_f32 v84, v32, v33
v_mfma_f32_16x16x32_bf16 v[60:63], a[152:155], v[192:195], v[60:63]
v_exp_f32 v35, v35
v_mfma_f32_16x16x32_bf16 v[60:63], a[156:159], v[196:199], v[60:63]
buffer_load_dwordx4 v229, s[8:11], s38 offen offset:1024 lds
v_mfma_f32_16x16x32_bf16 a[24:27], a[184:187], v[88:91], a[24:27]
v_exp_f32 v36, v36
v_mfma_f32_16x16x32_bf16 a[56:59], a[184:187], v[92:95], a[56:59]
v_cvt_pk_bf16_f32 v85, v34, v35
v_mfma_f32_16x16x32_bf16 a[88:91], a[184:187], v[96:99], a[88:91]
v_exp_f32 v37, v37
v_mfma_f32_16x16x32_bf16 a[120:123], a[184:187], v[100:103], a[120:123]
ds_read_b64_tr_b16 a[184:185], v226 offset:32768
ds_read_b64_tr_b16 a[186:187], v226 offset:36864
v_mfma_f32_16x16x32_bf16 v[68:71], a[144:147], v[200:203], v[148:151]
v_exp_f32 v38, v38
v_mfma_f32_16x16x32_bf16 v[68:71], a[148:151], v[204:207], v[68:71]
ds_read_b128 a[144:147], v216 offset:20480
ds_read_b128 a[148:151], v217 offset:20480
v_mfma_f32_16x16x32_bf16 v[68:71], a[152:155], v[208:211], v[68:71]
v_exp_f32 v39, v39
v_mfma_f32_16x16x32_bf16 v[68:71], a[156:159], v[212:215], v[68:71]
ds_read_b128 a[152:155], v218 offset:20480
ds_read_b128 a[156:159], v219 offset:20480
v_mfma_f32_16x16x32_bf16 a[28:31], a[188:191], v[88:91], a[28:31]
v_cvt_pk_bf16_f32 v86, v36, v37
v_cvt_pk_bf16_f32 v87, v38, v39
v_mfma_f32_16x16x32_bf16 a[60:63], a[188:191], v[92:95], a[60:63]
v_mfma_f32_16x16x32_bf16 a[92:95], a[188:191], v[96:99], a[92:95]
v_mfma_f32_16x16x32_bf16 a[124:127], a[188:191], v[100:103], a[124:127]
s_waitcnt lgkmcnt(6)
ds_read_b64_tr_b16 a[188:189], v227 offset:32768
ds_read_b64_tr_b16 a[190:191], v227 offset:36864
v_mfma_f32_16x16x32_bf16 v[8:11], a[128:131], v[152:155], v[136:139]
v_exp_f32 v40, v40
v_mfma_f32_16x16x32_bf16 v[8:11], a[132:135], v[156:159], v[8:11]
v_exp_f32 v41, v41
v_mfma_f32_16x16x32_bf16 v[8:11], a[136:139], v[160:163], v[8:11]
buffer_load_dwordx4 v230, s[8:11], s38 offen offset:2048 lds
v_mfma_f32_16x16x32_bf16 v[8:11], a[140:143], v[164:167], v[8:11]
v_exp_f32 v42, v42
v_mfma_f32_16x16x32_bf16 a[0:3], a[160:163], v[72:75], a[0:3]
v_cvt_pk_bf16_f32 v88, v40, v41
v_mfma_f32_16x16x32_bf16 a[32:35], a[160:163], v[76:79], a[32:35]
v_exp_f32 v43, v43
v_mfma_f32_16x16x32_bf16 a[64:67], a[160:163], v[80:83], a[64:67]
v_cvt_pk_bf16_f32 v89, v42, v43
v_mfma_f32_16x16x32_bf16 a[96:99], a[160:163], v[84:87], a[96:99]
v_exp_f32 v44, v44
v_mfma_f32_16x16x32_bf16 v[16:19], a[128:131], v[168:171], v[140:143]
ds_read_b64_tr_b16 a[160:161], v220 offset:40960
ds_read_b64_tr_b16 a[162:163], v220 offset:45056
v_mfma_f32_16x16x32_bf16 v[16:19], a[132:135], v[172:175], v[16:19]
v_exp_f32 v45, v45
v_mfma_f32_16x16x32_bf16 v[16:19], a[136:139], v[176:179], v[16:19]
v_cvt_pk_bf16_f32 v90, v44, v45
v_mfma_f32_16x16x32_bf16 v[16:19], a[140:143], v[180:183], v[16:19]
v_exp_f32 v46, v46
v_mfma_f32_16x16x32_bf16 a[4:7], a[164:167], v[72:75], a[4:7]
v_mfma_f32_16x16x32_bf16 a[36:39], a[164:167], v[76:79], a[36:39]
v_exp_f32 v47, v47
v_mfma_f32_16x16x32_bf16 a[68:71], a[164:167], v[80:83], a[68:71]
buffer_load_dwordx4 v231, s[8:11], s38 offen offset:3072 lds
v_mfma_f32_16x16x32_bf16 a[100:103], a[164:167], v[84:87], a[100:103]
v_exp_f32 v48, v48
v_smfmac_f32_16x16x64_bf16 a[248:251], a[208:211], v[72:79], v235
ds_read_b64_tr_b16 a[164:165], v221 offset:40960
ds_read_b64_tr_b16 a[166:167], v221 offset:45056
v_mfma_f32_16x16x32_bf16 v[24:27], a[128:131], v[184:187], v[144:147]
v_exp_f32 v49, v49
v_mfma_f32_16x16x32_bf16 v[24:27], a[132:135], v[188:191], v[24:27]
v_cvt_pk_bf16_f32 v91, v46, v47
v_cvt_pk_bf16_f32 v92, v48, v49
v_mfma_f32_16x16x32_bf16 v[24:27], a[136:139], v[192:195], v[24:27]
v_exp_f32 v50, v50
v_mfma_f32_16x16x32_bf16 v[24:27], a[140:143], v[196:199], v[24:27]
s_waitcnt vmcnt(12)
s_nop 0
ds_read_b64_tr_b16 a[192:193], v248 offset:0
ds_read_b64_tr_b16 a[194:195], v248 offset:256
v_mfma_f32_16x16x32_bf16 a[8:11], a[168:171], v[72:75], a[8:11]
v_exp_f32 v51, v51
v_mfma_f32_16x16x32_bf16 a[40:43], a[168:171], v[76:79], a[40:43]
ds_read_b64_tr_b16 a[196:197], v248 offset:32
v_cvt_pk_bf16_f32 v93, v50, v51
v_mfma_f32_16x16x32_bf16 a[72:75], a[168:171], v[80:83], a[72:75]
v_exp_f32 v52, v52
v_mfma_f32_16x16x32_bf16 a[104:107], a[168:171], v[84:87], a[104:107]
ds_read_b64_tr_b16 a[168:169], v222 offset:40960
ds_read_b64_tr_b16 a[170:171], v222 offset:45056
v_mfma_f32_16x16x32_bf16 v[32:35], a[128:131], v[200:203], v[148:151]
s_add_u32 s38, s38, 16384
v_exp_f32 v53, v53
v_mfma_f32_16x16x32_bf16 v[32:35], a[132:135], v[204:207], v[32:35]
s_add_u32 m0, s37, 81920
ds_read_b128 a[128:131], v216 offset:24576
ds_read_b128 a[132:135], v217 offset:24576
v_mfma_f32_16x16x32_bf16 v[32:35], a[136:139], v[208:211], v[32:35]
v_exp_f32 v54, v54
v_mfma_f32_16x16x32_bf16 v[32:35], a[140:143], v[212:215], v[32:35]
buffer_load_dwordx4 v232, s[12:15], s39 offen offset:0 lds
v_mfma_f32_16x16x32_bf16 a[12:15], a[172:175], v[72:75], a[12:15]
v_exp_f32 v55, v55
v_mfma_f32_16x16x32_bf16 a[44:47], a[172:175], v[76:79], a[44:47]
ds_read_b128 a[136:139], v218 offset:24576
ds_read_b128 a[140:143], v219 offset:24576
v_mfma_f32_16x16x32_bf16 a[76:79], a[172:175], v[80:83], a[76:79]
v_exp_f32 v56, v56
v_mfma_f32_16x16x32_bf16 a[108:111], a[172:175], v[84:87], a[108:111]
s_waitcnt lgkmcnt(6)
v_exp_f32 v57, v57
v_mfma_f32_16x16x32_bf16 v[12:15], a[144:147], v[152:155], v[136:139]
ds_read_b64_tr_b16 a[172:173], v223 offset:40960
ds_read_b64_tr_b16 a[174:175], v223 offset:45056
v_mfma_f32_16x16x32_bf16 v[12:15], a[148:151], v[156:159], v[12:15]
v_exp_f32 v58, v58
v_mfma_f32_16x16x32_bf16 v[12:15], a[152:155], v[160:163], v[12:15]
v_cvt_pk_bf16_f32 v94, v52, v53
v_cvt_pk_bf16_f32 v95, v54, v55
v_mfma_f32_16x16x32_bf16 v[12:15], a[156:159], v[164:167], v[12:15]
v_exp_f32 v59, v59
v_mfma_f32_16x16x32_bf16 a[16:19], a[176:179], v[72:75], a[16:19]
v_cvt_pk_bf16_f32 v96, v56, v57
v_cvt_pk_bf16_f32 v97, v58, v59
v_mfma_f32_16x16x32_bf16 a[48:51], a[176:179], v[76:79], a[48:51]
v_exp_f32 v60, v60
v_mfma_f32_16x16x32_bf16 a[80:83], a[176:179], v[80:83], a[80:83]
buffer_load_dwordx4 v233, s[12:15], s39 offen offset:1024 lds
v_mfma_f32_16x16x32_bf16 a[112:115], a[176:179], v[84:87], a[112:115]
v_exp_f32 v61, v61
v_mfma_f32_16x16x32_bf16 v[20:23], a[144:147], v[168:171], v[140:143]
ds_read_b64_tr_b16 a[176:177], v224 offset:40960
ds_read_b64_tr_b16 a[178:179], v224 offset:45056
v_mfma_f32_16x16x32_bf16 v[20:23], a[148:151], v[172:175], v[20:23]
v_exp_f32 v62, v62
v_mfma_f32_16x16x32_bf16 v[20:23], a[152:155], v[176:179], v[20:23]
ds_read_b64_tr_b16 a[198:199], v248 offset:288
v_cvt_pk_bf16_f32 v98, v60, v61
v_mfma_f32_16x16x32_bf16 v[20:23], a[156:159], v[180:183], v[20:23]
v_exp_f32 v63, v63
v_mfma_f32_16x16x32_bf16 a[20:23], a[180:183], v[72:75], a[20:23]
ds_read_b64_tr_b16 a[200:201], v248 offset:4096
v_cvt_pk_bf16_f32 v99, v62, v63
v_mfma_f32_16x16x32_bf16 a[52:55], a[180:183], v[76:79], a[52:55]
v_exp_f32 v64, v64
v_mfma_f32_16x16x32_bf16 a[84:87], a[180:183], v[80:83], a[84:87]
ds_read_b64_tr_b16 a[202:203], v248 offset:4352
ds_read_b64_tr_b16 a[204:205], v248 offset:4128
v_mfma_f32_16x16x32_bf16 a[116:119], a[180:183], v[84:87], a[116:119]
v_exp_f32 v65, v65
v_smfmac_f32_16x16x64_bf16 a[252:255], a[208:211], v[80:87], v235
ds_read_b64_tr_b16 a[180:181], v225 offset:40960
ds_read_b64_tr_b16 a[182:183], v225 offset:45056
v_mfma_f32_16x16x32_bf16 v[28:31], a[144:147], v[184:187], v[144:147]
v_exp_f32 v66, v66
v_mfma_f32_16x16x32_bf16 v[28:31], a[148:151], v[188:191], v[28:31]
buffer_load_dwordx4 v232, s[12:15], s39 offen offset:2048 lds
v_mfma_f32_16x16x32_bf16 v[28:31], a[152:155], v[192:195], v[28:31]
v_exp_f32 v67, v67
v_mfma_f32_16x16x32_bf16 v[28:31], a[156:159], v[196:199], v[28:31]
v_cvt_pk_bf16_f32 v100, v64, v65
v_cvt_pk_bf16_f32 v101, v66, v67
v_mfma_f32_16x16x32_bf16 a[24:27], a[184:187], v[72:75], a[24:27]
v_exp_f32 v68, v68
v_mfma_f32_16x16x32_bf16 a[56:59], a[184:187], v[76:79], a[56:59]
ds_read_b64_tr_b16 a[206:207], v248 offset:4384
ds_read_b64_tr_b16 v[120:121], v248 offset:2048
v_mfma_f32_16x16x32_bf16 a[88:91], a[184:187], v[80:83], a[88:91]
v_exp_f32 v69, v69
v_mfma_f32_16x16x32_bf16 a[120:123], a[184:187], v[84:87], a[120:123]
ds_read_b64_tr_b16 a[184:185], v226 offset:40960
ds_read_b64_tr_b16 a[186:187], v226 offset:45056
v_mfma_f32_16x16x32_bf16 v[36:39], a[144:147], v[200:203], v[148:151]
v_exp_f32 v70, v70
v_mfma_f32_16x16x32_bf16 v[36:39], a[148:151], v[204:207], v[36:39]
ds_read_b128 a[144:147], v216 offset:28672
ds_read_b128 a[148:151], v217 offset:28672
v_mfma_f32_16x16x32_bf16 v[36:39], a[152:155], v[208:211], v[36:39]
v_exp_f32 v71, v71
v_mfma_f32_16x16x32_bf16 v[36:39], a[156:159], v[212:215], v[36:39]
ds_read_b128 a[152:155], v218 offset:28672
ds_read_b128 a[156:159], v219 offset:28672
v_mfma_f32_16x16x32_bf16 a[28:31], a[188:191], v[72:75], a[28:31]
v_cvt_pk_bf16_f32 v102, v68, v69
v_cvt_pk_bf16_f32 v103, v70, v71
v_mfma_f32_16x16x32_bf16 a[60:63], a[188:191], v[76:79], a[60:63]
ds_read_b64_tr_b16 v[122:123], v248 offset:2304
v_mfma_f32_16x16x32_bf16 a[92:95], a[188:191], v[80:83], a[92:95]
v_mfma_f32_16x16x32_bf16 a[124:127], a[188:191], v[84:87], a[124:127]
s_waitcnt lgkmcnt(7)
ds_read_b64_tr_b16 a[188:189], v227 offset:40960
ds_read_b64_tr_b16 a[190:191], v227 offset:45056
v_mfma_f32_16x16x32_bf16 v[40:43], a[128:131], v[152:155], v[136:139]
s_sub_u32 s90, s49, 0xf000
v_exp_f32 v8, v8
v_mfma_f32_16x16x32_bf16 v[40:43], a[132:135], v[156:159], v[40:43]
buffer_load_dwordx4 v233, s[12:15], s39 offen offset:3072 lds
v_mfma_f32_16x16x32_bf16 v[40:43], a[136:139], v[160:163], v[40:43]
v_exp_f32 v9, v9
v_mfma_f32_16x16x32_bf16 v[40:43], a[140:143], v[164:167], v[40:43]
ds_read_b64_tr_b16 v[124:125], v248 offset:2080
v_cvt_pk_bf16_f32 v72, v8, v9
v_mfma_f32_16x16x32_bf16 a[0:3], a[160:163], v[88:91], a[0:3]
v_exp_f32 v10, v10
v_mfma_f32_16x16x32_bf16 a[32:35], a[160:163], v[92:95], a[32:35]
ds_read_b64_tr_b16 v[126:127], v248 offset:2336
ds_read_b64_tr_b16 v[128:129], v248 offset:6144
v_mfma_f32_16x16x32_bf16 a[64:67], a[160:163], v[96:99], a[64:67]
v_exp_f32 v11, v11
v_mfma_f32_16x16x32_bf16 a[96:99], a[160:163], v[100:103], a[96:99]
ds_read_b64_tr_b16 a[160:161], v220 offset:49152
ds_read_b64_tr_b16 a[162:163], v220 offset:53248
v_mfma_f32_16x16x32_bf16 v[104:107], a[192:195], a[220:223], v[104:107]
v_exp_f32 v12, v12
v_mfma_f32_16x16x32_bf16 v[48:51], a[128:131], v[168:171], v[140:143]
ds_read_b64_tr_b16 v[130:131], v248 offset:6400
v_cvt_pk_bf16_f32 v73, v10, v11
v_mfma_f32_16x16x32_bf16 v[48:51], a[132:135], v[172:175], v[48:51]
v_exp_f32 v13, v13
v_mfma_f32_16x16x32_bf16 v[48:51], a[136:139], v[176:179], v[48:51]
ds_read_b64_tr_b16 v[132:133], v248 offset:6176
v_cvt_pk_bf16_f32 v74, v12, v13
v_mfma_f32_16x16x32_bf16 v[48:51], a[140:143], v[180:183], v[48:51]
ds_read_b64_tr_b16 v[134:135], v248 offset:6432
v_mfma_f32_16x16x32_bf16 a[4:7], a[164:167], v[88:91], a[4:7]
v_exp_f32 v14, v14
v_mfma_f32_16x16x32_bf16 a[36:39], a[164:167], v[92:95], a[36:39]
v_mfma_f32_16x16x32_bf16 a[68:71], a[164:167], v[96:99], a[68:71]
s_add_u32 s39, s39, 16384
v_exp_f32 v15, v15
v_mfma_f32_16x16x32_bf16 a[100:103], a[164:167], v[100:103], a[100:103]
s_add_u32 m0, s37, 32768
ds_read_b64_tr_b16 a[164:165], v221 offset:49152
ds_read_b64_tr_b16 a[166:167], v221 offset:53248
v_smfmac_f32_16x16x64_bf16 a[248:251], a[208:211], v[88:95], v235
v_exp_f32 v16, v16
v_mfma_f32_16x16x32_bf16 v[108:111], a[196:199], a[220:223], v[108:111]
buffer_load_dwordx4 v228, s[8:11], s38 offen offset:0 lds
v_mfma_f32_16x16x32_bf16 v[56:59], a[128:131], v[184:187], v[144:147]
v_exp_f32 v17, v17
v_mfma_f32_16x16x32_bf16 v[56:59], a[132:135], v[188:191], v[56:59]
v_cvt_pk_bf16_f32 v75, v14, v15
v_cvt_pk_bf16_f32 v76, v16, v17
v_mfma_f32_16x16x32_bf16 v[56:59], a[136:139], v[192:195], v[56:59]
v_exp_f32 v18, v18
v_mfma_f32_16x16x32_bf16 v[56:59], a[140:143], v[196:199], v[56:59]
v_mfma_f32_16x16x32_bf16 a[8:11], a[168:171], v[88:91], a[8:11]
v_mfma_f32_16x16x32_bf16 a[40:43], a[168:171], v[92:95], a[40:43]
v_exp_f32 v19, v19
v_mfma_f32_16x16x32_bf16 a[72:75], a[168:171], v[96:99], a[72:75]
v_cvt_pk_bf16_f32 v77, v18, v19
v_mfma_f32_16x16x32_bf16 a[104:107], a[168:171], v[100:103], a[104:107]
v_exp_f32 v20, v20
v_mfma_f32_16x16x32_bf16 v[112:115], a[200:203], a[220:223], v[112:115]
ds_read_b64_tr_b16 a[168:169], v222 offset:49152
ds_read_b64_tr_b16 a[170:171], v222 offset:53248
v_mfma_f32_16x16x32_bf16 v[64:67], a[128:131], v[200:203], v[148:151]
v_exp_f32 v21, v21
v_mfma_f32_16x16x32_bf16 v[64:67], a[132:135], v[204:207], v[64:67]
buffer_load_dwordx4 v229, s[8:11], s38 offen offset:1024 lds
v_mfma_f32_16x16x32_bf16 v[64:67], a[136:139], v[208:211], v[64:67]
v_exp_f32 v22, v22
v_mfma_f32_16x16x32_bf16 v[64:67], a[140:143], v[212:215], v[64:67]
ds_read_b128 a[128:131], v216 offset:0
ds_read_b128 a[132:135], v217 offset:0
v_mfma_f32_16x16x32_bf16 a[12:15], a[172:175], v[88:91], a[12:15]
v_exp_f32 v23, v23
v_mfma_f32_16x16x32_bf16 a[44:47], a[172:175], v[92:95], a[44:47]
ds_read_b128 a[136:139], v218 offset:0
ds_read_b128 a[140:143], v219 offset:0
v_mfma_f32_16x16x32_bf16 a[76:79], a[172:175], v[96:99], a[76:79]
v_cvt_pk_bf16_f32 v78, v20, v21
v_cvt_pk_bf16_f32 v79, v22, v23
v_mfma_f32_16x16x32_bf16 a[108:111], a[172:175], v[100:103], a[108:111]
v_exp_f32 v24, v24
v_mfma_f32_16x16x32_bf16 v[116:119], a[204:207], a[220:223], v[116:119]
s_waitcnt lgkmcnt(6)
ds_read_b64_tr_b16 a[172:173], v223 offset:49152
ds_read_b64_tr_b16 a[174:175], v223 offset:53248
v_mfma_f32_16x16x32_bf16 v[44:47], a[144:147], v[152:155], v[136:139]
v_exp_f32 v25, v25
v_mfma_f32_16x16x32_bf16 v[44:47], a[148:151], v[156:159], v[44:47]
v_cvt_pk_bf16_f32 v80, v24, v25
v_mfma_f32_16x16x32_bf16 v[44:47], a[152:155], v[160:163], v[44:47]
v_exp_f32 v26, v26
v_mfma_f32_16x16x32_bf16 v[44:47], a[156:159], v[164:167], v[44:47]
v_mfma_f32_16x16x32_bf16 a[16:19], a[176:179], v[88:91], a[16:19]
v_exp_f32 v27, v27
v_mfma_f32_16x16x32_bf16 a[48:51], a[176:179], v[92:95], a[48:51]
v_cvt_pk_bf16_f32 v81, v26, v27
v_mfma_f32_16x16x32_bf16 a[80:83], a[176:179], v[96:99], a[80:83]
v_exp_f32 v28, v28
v_mfma_f32_16x16x32_bf16 a[112:115], a[176:179], v[100:103], a[112:115]
buffer_load_dwordx4 v230, s[8:11], s38 offen offset:2048 lds
v_mfma_f32_16x16x32_bf16 v[52:55], a[144:147], v[168:171], v[140:143]
v_exp_f32 v29, v29
v_mfma_f32_16x16x32_bf16 v[52:55], a[148:151], v[172:175], v[52:55]
ds_read_b64_tr_b16 a[176:177], v224 offset:49152
ds_read_b64_tr_b16 a[178:179], v224 offset:53248
v_mfma_f32_16x16x32_bf16 v[52:55], a[152:155], v[176:179], v[52:55]
v_cvt_pk_bf16_f32 v82, v28, v29
v_mfma_f32_16x16x32_bf16 v[52:55], a[156:159], v[180:183], v[52:55]
v_exp_f32 v30, v30
v_mfma_f32_16x16x32_bf16 a[20:23], a[180:183], v[88:91], a[20:23]
v_mfma_f32_16x16x32_bf16 a[52:55], a[180:183], v[92:95], a[52:55]
v_exp_f32 v31, v31
v_mfma_f32_16x16x32_bf16 a[84:87], a[180:183], v[96:99], a[84:87]
v_cvt_pk_bf16_f32 v83, v30, v31
v_mfma_f32_16x16x32_bf16 a[116:119], a[180:183], v[100:103], a[116:119]
v_exp_f32 v32, v32
v_smfmac_f32_16x16x64_bf16 a[252:255], a[208:211], v[96:103], v235
ds_read_b64_tr_b16 a[180:181], v225 offset:49152
ds_read_b64_tr_b16 a[182:183], v225 offset:53248
v_mfma_f32_16x16x32_bf16 v[104:107], v[120:123], a[224:227], v[104:107]
v_exp_f32 v33, v33
v_mfma_f32_16x16x32_bf16 v[60:63], a[144:147], v[184:187], v[144:147]
v_cvt_pk_bf16_f32 v84, v32, v33
v_mfma_f32_16x16x32_bf16 v[60:63], a[148:151], v[188:191], v[60:63]
v_exp_f32 v34, v34
v_mfma_f32_16x16x32_bf16 v[60:63], a[152:155], v[192:195], v[60:63]
buffer_load_dwordx4 v231, s[8:11], s38 offen offset:3072 lds
v_mfma_f32_16x16x32_bf16 v[60:63], a[156:159], v[196:199], v[60:63]
v_mfma_f32_16x16x32_bf16 a[24:27], a[184:187], v[88:91], a[24:27]
v_exp_f32 v35, v35
v_mfma_f32_16x16x32_bf16 a[56:59], a[184:187], v[92:95], a[56:59]
v_cvt_pk_bf16_f32 v85, v34, v35
v_mfma_f32_16x16x32_bf16 a[88:91], a[184:187], v[96:99], a[88:91]
v_exp_f32 v36, v36
v_mfma_f32_16x16x32_bf16 a[120:123], a[184:187], v[100:103], a[120:123]
ds_read_b64_tr_b16 a[184:185], v226 offset:49152
ds_read_b64_tr_b16 a[186:187], v226 offset:53248
v_mfma_f32_16x16x32_bf16 v[108:111], v[124:127], a[224:227], v[108:111]
v_exp_f32 v37, v37
v_mfma_f32_16x16x32_bf16 v[68:71], a[144:147], v[200:203], v[148:151]
ds_read_b128 a[144:147], v216 offset:4096
v_cvt_pk_bf16_f32 v86, v36, v37
v_mfma_f32_16x16x32_bf16 v[68:71], a[148:151], v[204:207], v[68:71]
v_exp_f32 v38, v38
v_mfma_f32_16x16x32_bf16 v[68:71], a[152:155], v[208:211], v[68:71]
ds_read_b128 a[148:151], v217 offset:4096
ds_read_b128 a[152:155], v218 offset:4096
v_mfma_f32_16x16x32_bf16 v[68:71], a[156:159], v[212:215], v[68:71]
v_exp_f32 v39, v39
v_mfma_f32_16x16x32_bf16 a[28:31], a[188:191], v[88:91], a[28:31]
ds_read_b128 a[156:159], v219 offset:4096
v_cvt_pk_bf16_f32 v87, v38, v39
v_mfma_f32_16x16x32_bf16 a[60:63], a[188:191], v[92:95], a[60:63]
v_mfma_f32_16x16x32_bf16 a[92:95], a[188:191], v[96:99], a[92:95]
v_mfma_f32_16x16x32_bf16 a[124:127], a[188:191], v[100:103], a[124:127]
s_add_u32 s38, s38, 16384
ds_read_b64_tr_b16 a[188:189], v227 offset:49152
ds_read_b64_tr_b16 a[190:191], v227 offset:53248
v_mfma_f32_16x16x32_bf16 v[112:115], v[128:131], a[224:227], v[112:115]
v_mfma_f32_16x16x32_bf16 v[116:119], v[132:135], a[224:227], v[116:119]
s_waitcnt lgkmcnt(6)
v_mfma_f32_16x16x32_bf16 v[8:11], a[128:131], v[152:155], v[136:139]
v_exp_f32 v40, v40
v_mfma_f32_16x16x32_bf16 v[8:11], a[132:135], v[156:159], v[8:11]
s_add_u32 m0, s49, 4096
v_exp_f32 v41, v41
v_mfma_f32_16x16x32_bf16 v[8:11], a[136:139], v[160:163], v[8:11]
s_add_u32 s48, s91, 0
buffer_load_dwordx4 v249, s[64:67], s48 offen  lds
v_mfma_f32_16x16x32_bf16 v[8:11], a[140:143], v[164:167], v[8:11]
v_exp_f32 v42, v42
v_mfma_f32_16x16x32_bf16 a[0:3], a[160:163], v[72:75], a[0:3]
v_cvt_pk_bf16_f32 v88, v40, v41
v_add_u32 v131, s90, v223
v_mfma_f32_16x16x32_bf16 a[32:35], a[160:163], v[76:79], a[32:35]
v_exp_f32 v43, v43
v_mfma_f32_16x16x32_bf16 a[64:67], a[160:163], v[80:83], a[64:67]
v_cvt_pk_bf16_f32 v89, v42, v43
v_add_u32 v132, s90, v224
v_mfma_f32_16x16x32_bf16 a[96:99], a[160:163], v[84:87], a[96:99]
v_exp_f32 v44, v44
v_mfma_f32_16x16x32_bf16 v[16:19], a[128:131], v[168:171], v[140:143]
s_add_u32 m0, s49, 5120
ds_read_b64_tr_b16 a[160:161], v220 offset:57344
ds_read_b64_tr_b16 a[162:163], v220 offset:61440
v_mfma_f32_16x16x32_bf16 v[16:19], a[132:135], v[172:175], v[16:19]
s_add_u32 s48, s91, 4608
v_exp_f32 v45, v45
v_mfma_f32_16x16x32_bf16 v[16:19], a[136:139], v[176:179], v[16:19]
buffer_load_dwordx4 v250, s[64:67], s48 offen  lds
v_mfma_f32_16x16x32_bf16 v[16:19], a[140:143], v[180:183], v[16:19]
v_exp_f32 v46, v46
v_mfma_f32_16x16x32_bf16 a[4:7], a[164:167], v[72:75], a[4:7]
v_cvt_pk_bf16_f32 v90, v44, v45
v_add_u32 v133, s90, v225
v_mfma_f32_16x16x32_bf16 a[36:39], a[164:167], v[76:79], a[36:39]
v_exp_f32 v47, v47
v_mfma_f32_16x16x32_bf16 a[68:71], a[164:167], v[80:83], a[68:71]
v_cvt_pk_bf16_f32 v91, v46, v47
v_add_u32 v134, s90, v226
v_mfma_f32_16x16x32_bf16 a[100:103], a[164:167], v[84:87], a[100:103]
v_exp_f32 v48, v48
v_smfmac_f32_16x16x64_bf16 a[248:251], a[208:211], v[72:79], v235
s_add_u32 m0, s49, 6144
ds_read_b64_tr_b16 a[164:165], v221 offset:57344
ds_read_b64_tr_b16 a[166:167], v221 offset:61440
v_mfma_f32_16x16x32_bf16 v[24:27], a[128:131], v[184:187], v[144:147]
s_add_u32 s48, s91, 9216
v_exp_f32 v49, v49
v_mfma_f32_16x16x32_bf16 v[24:27], a[132:135], v[188:191], v[24:27]
buffer_load_dwordx4 v249, s[64:67], s48 offen  lds
v_mfma_f32_16x16x32_bf16 v[24:27], a[136:139], v[192:195], v[24:27]
v_exp_f32 v50, v50
v_mfma_f32_16x16x32_bf16 v[24:27], a[140:143], v[196:199], v[24:27]
v_cvt_pk_bf16_f32 v92, v48, v49
v_add_u32 v135, s90, v227
v_mfma_f32_16x16x32_bf16 a[8:11], a[168:171], v[72:75], a[8:11]
v_exp_f32 v51, v51
v_mfma_f32_16x16x32_bf16 a[40:43], a[168:171], v[76:79], a[40:43]
v_cvt_pk_bf16_f32 v93, v50, v51
v_mfma_f32_16x16x32_bf16 a[72:75], a[168:171], v[80:83], a[72:75]
v_exp_f32 v52, v52
v_mfma_f32_16x16x32_bf16 a[104:107], a[168:171], v[84:87], a[104:107]
s_add_u32 m0, s49, 7168
ds_read_b64_tr_b16 a[168:169], v222 offset:57344
ds_read_b64_tr_b16 a[170:171], v222 offset:61440
v_mfma_f32_16x16x32_bf16 v[32:35], a[128:131], v[200:203], v[148:151]
s_add_u32 s48, s91, 13824
v_exp_f32 v53, v53
v_mfma_f32_16x16x32_bf16 v[32:35], a[132:135], v[204:207], v[32:35]
buffer_load_dwordx4 v250, s[64:67], s48 offen  lds
v_mfma_f32_16x16x32_bf16 v[32:35], a[136:139], v[208:211], v[32:35]
v_exp_f32 v54, v54
v_mfma_f32_16x16x32_bf16 v[32:35], a[140:143], v[212:215], v[32:35]
ds_read_b128 a[128:131], v216 offset:8192
ds_read_b128 a[132:135], v217 offset:8192
v_mfma_f32_16x16x32_bf16 a[12:15], a[172:175], v[72:75], a[12:15]
v_exp_f32 v55, v55
v_mfma_f32_16x16x32_bf16 a[44:47], a[172:175], v[76:79], a[44:47]
ds_read_b128 a[136:139], v218 offset:8192
ds_read_b128 a[140:143], v219 offset:8192
v_mfma_f32_16x16x32_bf16 a[76:79], a[172:175], v[80:83], a[76:79]
v_exp_f32 v56, v56
v_mfma_f32_16x16x32_bf16 a[108:111], a[172:175], v[84:87], a[108:111]
s_waitcnt lgkmcnt(6)
v_exp_f32 v57, v57
v_mfma_f32_16x16x32_bf16 v[12:15], a[144:147], v[152:155], v[136:139]
buffer_load_dwordx2 v[252:253], v251, s[76:79], s42 offen sc1
v_mfma_f32_16x16x32_bf16 v[12:15], a[148:151], v[156:159], v[12:15]
v_exp_f32 v58, v58
v_mfma_f32_16x16x32_bf16 v[12:15], a[152:155], v[160:163], v[12:15]
ds_read_b64_tr_b16 a[172:173], v223 offset:57344
ds_read_b64_tr_b16 a[174:175], v223 offset:61440
v_mfma_f32_16x16x32_bf16 v[12:15], a[156:159], v[164:167], v[12:15]
v_exp_f32 v59, v59
v_mfma_f32_16x16x32_bf16 a[16:19], a[176:179], v[72:75], a[16:19]
v_cvt_pk_bf16_f32 v94, v52, v53
v_cvt_pk_bf16_f32 v95, v54, v55
v_mfma_f32_16x16x32_bf16 a[48:51], a[176:179], v[76:79], a[48:51]
v_exp_f32 v60, v60
v_mfma_f32_16x16x32_bf16 a[80:83], a[176:179], v[80:83], a[80:83]
s_add_u32 s42, s42, s43
buffer_load_dword v255, v243, s[28:31], s45 offen
v_mfma_f32_16x16x32_bf16 a[112:115], a[176:179], v[84:87], a[112:115]
v_exp_f32 v61, v61
v_mfma_f32_16x16x32_bf16 v[20:23], a[144:147], v[168:171], v[140:143]
ds_read_b64_tr_b16 a[176:177], v224 offset:57344
ds_read_b64_tr_b16 a[178:179], v224 offset:61440
v_mfma_f32_16x16x32_bf16 v[20:23], a[148:151], v[172:175], v[20:23]
v_exp_f32 v62, v62
v_mfma_f32_16x16x32_bf16 v[20:23], a[152:155], v[176:179], v[20:23]
v_cvt_pk_bf16_f32 v96, v56, v57
v_cvt_pk_bf16_f32 v97, v58, v59
v_mfma_f32_16x16x32_bf16 v[20:23], a[156:159], v[180:183], v[20:23]
v_exp_f32 v63, v63
v_mfma_f32_16x16x32_bf16 a[20:23], a[180:183], v[72:75], a[20:23]
v_cvt_pk_bf16_f32 v98, v60, v61
v_cvt_pk_bf16_f32 v99, v62, v63
v_mfma_f32_16x16x32_bf16 a[52:55], a[180:183], v[76:79], a[52:55]
v_exp_f32 v64, v64
v_mfma_f32_16x16x32_bf16 a[84:87], a[180:183], v[80:83], a[84:87]
s_add_u32 s45, s45, 589824
global_load_dword v255, v242, s[72:73]
v_mfma_f32_16x16x32_bf16 a[116:119], a[180:183], v[84:87], a[116:119]
v_exp_f32 v65, v65
v_smfmac_f32_16x16x64_bf16 a[252:255], a[208:211], v[80:87], v235
ds_read_b64_tr_b16 a[180:181], v225 offset:57344
ds_read_b64_tr_b16 a[182:183], v225 offset:61440
v_mfma_f32_16x16x32_bf16 v[28:31], a[144:147], v[184:187], v[144:147]
v_exp_f32 v66, v66
v_mfma_f32_16x16x32_bf16 v[28:31], a[148:151], v[188:191], v[28:31]
v_cvt_pk_bf16_f32 v100, v64, v65
v_mfma_f32_16x16x32_bf16 v[28:31], a[152:155], v[192:195], v[28:31]
v_exp_f32 v67, v67
v_mfma_f32_16x16x32_bf16 v[28:31], a[156:159], v[196:199], v[28:31]
v_cvt_pk_bf16_f32 v101, v66, v67
v_mfma_f32_16x16x32_bf16 a[24:27], a[184:187], v[72:75], a[24:27]
v_exp_f32 v68, v68
v_mfma_f32_16x16x32_bf16 a[56:59], a[184:187], v[76:79], a[56:59]
buffer_load_dword v255, v0, s[24:27], s44 offen sc1
v_mfma_f32_16x16x32_bf16 a[88:91], a[184:187], v[80:83], a[88:91]
v_exp_f32 v69, v69
v_mfma_f32_16x16x32_bf16 a[120:123], a[184:187], v[84:87], a[120:123]
ds_read_b64_tr_b16 a[184:185], v226 offset:57344
ds_read_b64_tr_b16 a[186:187], v226 offset:61440
v_mfma_f32_16x16x32_bf16 v[36:39], a[144:147], v[200:203], v[148:151]
v_exp_f32 v70, v70
v_mfma_f32_16x16x32_bf16 v[36:39], a[148:151], v[204:207], v[36:39]
ds_read_b128 a[144:147], v216 offset:12288
ds_read_b128 a[148:151], v217 offset:12288
v_mfma_f32_16x16x32_bf16 v[36:39], a[152:155], v[208:211], v[36:39]
v_exp_f32 v71, v71
v_mfma_f32_16x16x32_bf16 v[36:39], a[156:159], v[212:215], v[36:39]
ds_read_b128 a[152:155], v218 offset:12288
ds_read_b128 a[156:159], v219 offset:12288
v_mfma_f32_16x16x32_bf16 a[28:31], a[188:191], v[72:75], a[28:31]
v_cvt_pk_bf16_f32 v102, v68, v69
v_cvt_pk_bf16_f32 v103, v70, v71
v_mfma_f32_16x16x32_bf16 a[60:63], a[188:191], v[76:79], a[60:63]
s_add_u32 s44, s44, 8192
ds_write_b128 v5, v[104:107] offset:0
v_mfma_f32_16x16x32_bf16 a[92:95], a[188:191], v[80:83], a[92:95]
ds_write_b128 v5, v[108:111] offset:1024
v_mfma_f32_16x16x32_bf16 a[124:127], a[188:191], v[84:87], a[124:127]
s_waitcnt lgkmcnt(8)
ds_read_b64_tr_b16 a[188:189], v227 offset:57344
ds_read_b64_tr_b16 a[190:191], v227 offset:61440
ds_write_b128 v5, v[112:115] offset:2048
ds_write_b128 v5, v[116:119] offset:3072
s_sub_u32 s46, s49, 0xf000
v_mfma_f32_16x16x32_bf16 v[40:43], a[128:131], v[152:155], v[136:139]
v_exp_f32 v8, v8
v_mfma_f32_16x16x32_bf16 v[40:43], a[132:135], v[156:159], v[40:43]
v_exp_f32 v9, v9
v_mfma_f32_16x16x32_bf16 v[40:43], a[136:139], v[160:163], v[40:43]
v_cvt_pk_bf16_f32 v72, v8, v9
v_add_u32 v128, s46, v220
v_mfma_f32_16x16x32_bf16 v[40:43], a[140:143], v[164:167], v[40:43]
v_exp_f32 v10, v10
v_mfma_f32_16x16x32_bf16 a[0:3], a[160:163], v[88:91], a[0:3]
v_add_u32 v129, s46, v221
v_add_u32 v130, s46, v222
v_mfma_f32_16x16x32_bf16 a[32:35], a[160:163], v[92:95], a[32:35]
v_exp_f32 v11, v11
s_waitcnt vmcnt(8) lgkmcnt(0)
s_barrier
v_mfma_f32_16x16x32_bf16 a[64:67], a[160:163], v[96:99], a[64:67]
ds_read_b128 v[104:107], v6 offset:0
v_cvt_pk_bf16_f32 v73, v10, v11
v_mfma_f32_16x16x32_bf16 a[96:99], a[160:163], v[100:103], a[96:99]
s_add_u32 m0, s37, 98304
v_exp_f32 v12, v12
v_mfma_f32_16x16x32_bf16 v[48:51], a[128:131], v[168:171], v[140:143]
buffer_load_dwordx4 v232, s[12:15], s39 offen offset:0 lds
v_mfma_f32_16x16x32_bf16 v[48:51], a[132:135], v[172:175], v[48:51]
v_exp_f32 v13, v13
v_mfma_f32_16x16x32_bf16 v[48:51], a[136:139], v[176:179], v[48:51]
ds_read_b64_tr_b16 a[160:161], v220 offset:0
ds_read_b64_tr_b16 a[162:163], v220 offset:4096
v_mfma_f32_16x16x32_bf16 v[48:51], a[140:143], v[180:183], v[48:51]
v_exp_f32 v14, v14
v_mfma_f32_16x16x32_bf16 a[4:7], a[164:167], v[88:91], a[4:7]
ds_read_b128 v[108:111], v6 offset:8192
v_cvt_pk_bf16_f32 v74, v12, v13
v_mfma_f32_16x16x32_bf16 a[36:39], a[164:167], v[92:95], a[36:39]
v_exp_f32 v15, v15
v_mfma_f32_16x16x32_bf16 a[68:71], a[164:167], v[96:99], a[68:71]
ds_read_b128 v[112:115], v6 offset:16384
v_cvt_pk_bf16_f32 v75, v14, v15
v_mfma_f32_16x16x32_bf16 a[100:103], a[164:167], v[100:103], a[100:103]
v_exp_f32 v16, v16
v_smfmac_f32_16x16x64_bf16 a[248:251], a[208:211], v[88:95], v235
buffer_load_dwordx4 v233, s[12:15], s39 offen offset:1024 lds
v_mfma_f32_16x16x32_bf16 v[56:59], a[128:131], v[184:187], v[144:147]
v_exp_f32 v17, v17
v_mfma_f32_16x16x32_bf16 v[56:59], a[132:135], v[188:191], v[56:59]
ds_read_b64_tr_b16 a[164:165], v221 offset:0
ds_read_b64_tr_b16 a[166:167], v221 offset:4096
v_mfma_f32_16x16x32_bf16 v[56:59], a[136:139], v[192:195], v[56:59]
v_exp_f32 v18, v18
v_mfma_f32_16x16x32_bf16 v[56:59], a[140:143], v[196:199], v[56:59]
ds_read_b128 v[116:119], v6 offset:24576
v_cvt_pk_bf16_f32 v76, v16, v17
v_mfma_f32_16x16x32_bf16 a[8:11], a[168:171], v[88:91], a[8:11]
v_exp_f32 v19, v19
v_mfma_f32_16x16x32_bf16 a[40:43], a[168:171], v[92:95], a[40:43]
v_cvt_pk_bf16_f32 v77, v18, v19
v_mfma_f32_16x16x32_bf16 a[72:75], a[168:171], v[96:99], a[72:75]
v_exp_f32 v20, v20
v_mfma_f32_16x16x32_bf16 a[104:107], a[168:171], v[100:103], a[104:107]
ds_read_b64_tr_b16 a[168:169], v222 offset:0
ds_read_b64_tr_b16 a[170:171], v222 offset:4096
v_mfma_f32_16x16x32_bf16 v[64:67], a[128:131], v[200:203], v[148:151]
v_exp_f32 v21, v21
v_mfma_f32_16x16x32_bf16 v[64:67], a[132:135], v[204:207], v[64:67]
buffer_load_dwordx4 v232, s[12:15], s39 offen offset:2048 lds
v_mfma_f32_16x16x32_bf16 v[64:67], a[136:139], v[208:211], v[64:67]
v_exp_f32 v22, v22
v_mfma_f32_16x16x32_bf16 v[64:67], a[140:143], v[212:215], v[64:67]
ds_read_b128 a[128:131], v216 offset:49152
ds_read_b128 a[132:135], v217 offset:49152
v_mfma_f32_16x16x32_bf16 a[12:15], a[172:175], v[88:91], a[12:15]
v_exp_f32 v23, v23
v_mfma_f32_16x16x32_bf16 a[44:47], a[172:175], v[92:95], a[44:47]
ds_read_b128 a[136:139], v218 offset:49152
ds_read_b128 a[140:143], v219 offset:49152
v_mfma_f32_16x16x32_bf16 a[76:79], a[172:175], v[96:99], a[76:79]
v_exp_f32 v24, v24
v_mfma_f32_16x16x32_bf16 a[108:111], a[172:175], v[100:103], a[108:111]
v_exp_f32 v25, v25
v_mfma_f32_16x16x32_bf16 v[44:47], a[144:147], v[152:155], v[136:139]
ds_read_b64_tr_b16 a[172:173], v223 offset:0
ds_read_b64_tr_b16 a[174:175], v223 offset:4096
v_mfma_f32_16x16x32_bf16 v[44:47], a[148:151], v[156:159], v[44:47]
v_exp_f32 v26, v26
v_mfma_f32_16x16x32_bf16 v[44:47], a[152:155], v[160:163], v[44:47]
buffer_load_dwordx4 v233, s[12:15], s39 offen offset:3072 lds
v_mfma_f32_16x16x32_bf16 v[44:47], a[156:159], v[164:167], v[44:47]
v_exp_f32 v27, v27
v_mfma_f32_16x16x32_bf16 a[16:19], a[176:179], v[88:91], a[16:19]
v_cvt_pk_bf16_f32 v78, v20, v21
v_cvt_pk_bf16_f32 v79, v22, v23
v_mfma_f32_16x16x32_bf16 a[48:51], a[176:179], v[92:95], a[48:51]
v_exp_f32 v28, v28
v_mfma_f32_16x16x32_bf16 a[80:83], a[176:179], v[96:99], a[80:83]
v_cvt_pk_bf16_f32 v80, v24, v25
v_cvt_pk_bf16_f32 v81, v26, v27
v_mfma_f32_16x16x32_bf16 a[112:115], a[176:179], v[100:103], a[112:115]
v_exp_f32 v29, v29
v_mfma_f32_16x16x32_bf16 v[52:55], a[144:147], v[168:171], v[140:143]
ds_read_b64_tr_b16 a[176:177], v224 offset:0
ds_read_b64_tr_b16 a[178:179], v224 offset:4096
v_mfma_f32_16x16x32_bf16 v[52:55], a[148:151], v[172:175], v[52:55]
v_exp_f32 v30, v30
v_mfma_f32_16x16x32_bf16 v[52:55], a[152:155], v[176:179], v[52:55]
v_cvt_pk_bf16_f32 v82, v28, v29
s_waitcnt lgkmcnt(2)
v_add_f32 v104, v104, v108
v_mfma_f32_16x16x32_bf16 v[52:55], a[156:159], v[180:183], v[52:55]
s_add_u32 s39, s39, 16384
v_exp_f32 v31, v31
v_mfma_f32_16x16x32_bf16 a[20:23], a[180:183], v[88:91], a[20:23]
s_add_u32 m0, s37, 16384
v_cvt_pk_bf16_f32 v83, v30, v31
v_add_f32 v112, v112, v116
v_mfma_f32_16x16x32_bf16 a[52:55], a[180:183], v[92:95], a[52:55]
v_exp_f32 v32, v32
v_mfma_f32_16x16x32_bf16 a[84:87], a[180:183], v[96:99], a[84:87]
buffer_load_dwordx4 v228, s[8:11], s38 offen offset:0 lds
v_mfma_f32_16x16x32_bf16 a[116:119], a[180:183], v[100:103], a[116:119]
v_exp_f32 v33, v33
v_smfmac_f32_16x16x64_bf16 a[252:255], a[208:211], v[96:103], v235
ds_read_b64_tr_b16 a[180:181], v225 offset:0
ds_read_b64_tr_b16 a[182:183], v225 offset:4096
v_mfma_f32_16x16x32_bf16 v[60:63], a[144:147], v[184:187], v[144:147]
v_exp_f32 v34, v34
v_mfma_f32_16x16x32_bf16 v[60:63], a[148:151], v[188:191], v[60:63]
v_cvt_pk_bf16_f32 v84, v32, v33
v_add_f32 v105, v105, v109
v_mfma_f32_16x16x32_bf16 v[60:63], a[152:155], v[192:195], v[60:63]
v_exp_f32 v35, v35
v_mfma_f32_16x16x32_bf16 v[60:63], a[156:159], v[196:199], v[60:63]
buffer_load_dwordx4 v229, s[8:11], s38 offen offset:1024 lds
v_mfma_f32_16x16x32_bf16 a[24:27], a[184:187], v[88:91], a[24:27]
v_exp_f32 v36, v36
v_mfma_f32_16x16x32_bf16 a[56:59], a[184:187], v[92:95], a[56:59]
v_cvt_pk_bf16_f32 v85, v34, v35
v_add_f32 v113, v113, v117
v_mfma_f32_16x16x32_bf16 a[88:91], a[184:187], v[96:99], a[88:91]
v_exp_f32 v37, v37
v_mfma_f32_16x16x32_bf16 a[120:123], a[184:187], v[100:103], a[120:123]
ds_read_b64_tr_b16 a[184:185], v226 offset:0
ds_read_b64_tr_b16 a[186:187], v226 offset:4096
v_mfma_f32_16x16x32_bf16 v[68:71], a[144:147], v[200:203], v[148:151]
v_exp_f32 v38, v38
v_mfma_f32_16x16x32_bf16 v[68:71], a[148:151], v[204:207], v[68:71]
ds_read_b128 a[144:147], v216 offset:53248
ds_read_b128 a[148:151], v217 offset:53248
v_mfma_f32_16x16x32_bf16 v[68:71], a[152:155], v[208:211], v[68:71]
v_exp_f32 v39, v39
v_mfma_f32_16x16x32_bf16 v[68:71], a[156:159], v[212:215], v[68:71]
ds_read_b128 a[152:155], v218 offset:53248
ds_read_b128 a[156:159], v219 offset:53248
v_mfma_f32_16x16x32_bf16 a[28:31], a[188:191], v[88:91], a[28:31]
v_cvt_pk_bf16_f32 v86, v36, v37
v_cvt_pk_bf16_f32 v87, v38, v39
v_mfma_f32_16x16x32_bf16 a[60:63], a[188:191], v[92:95], a[60:63]
v_add_f32 v106, v106, v110
v_add_f32 v114, v114, v118
v_mfma_f32_16x16x32_bf16 a[92:95], a[188:191], v[96:99], a[92:95]
v_add_f32 v107, v107, v111
v_add_f32 v115, v115, v119
v_mfma_f32_16x16x32_bf16 a[124:127], a[188:191], v[100:103], a[124:127]
ds_read_b64_tr_b16 a[188:189], v227 offset:0
ds_read_b64_tr_b16 a[190:191], v227 offset:4096
v_mfma_f32_16x16x32_bf16 v[8:11], a[128:131], v[152:155], v[136:139]
v_exp_f32 v40, v40
v_mfma_f32_16x16x32_bf16 v[8:11], a[132:135], v[156:159], v[8:11]
v_exp_f32 v41, v41
v_mfma_f32_16x16x32_bf16 v[8:11], a[136:139], v[160:163], v[8:11]
buffer_load_dwordx4 v230, s[8:11], s38 offen offset:2048 lds
v_mfma_f32_16x16x32_bf16 v[8:11], a[140:143], v[164:167], v[8:11]
v_exp_f32 v42, v42
v_mfma_f32_16x16x32_bf16 a[0:3], a[160:163], v[72:75], a[0:3]
v_cvt_pk_bf16_f32 v88, v40, v41
v_add_f32 v104, v104, v112
v_mfma_f32_16x16x32_bf16 a[32:35], a[160:163], v[76:79], a[32:35]
v_exp_f32 v43, v43
v_mfma_f32_16x16x32_bf16 a[64:67], a[160:163], v[80:83], a[64:67]
v_cvt_pk_bf16_f32 v89, v42, v43
v_add_f32 v105, v105, v113
v_mfma_f32_16x16x32_bf16 a[96:99], a[160:163], v[84:87], a[96:99]
v_exp_f32 v44, v44
v_mfma_f32_16x16x32_bf16 v[16:19], a[128:131], v[168:171], v[140:143]
ds_read_b64_tr_b16 a[160:161], v220 offset:8192
ds_read_b64_tr_b16 a[162:163], v220 offset:12288
v_mfma_f32_16x16x32_bf16 v[16:19], a[132:135], v[172:175], v[16:19]
v_exp_f32 v45, v45
v_mfma_f32_16x16x32_bf16 v[16:19], a[136:139], v[176:179], v[16:19]
v_cvt_pk_bf16_f32 v90, v44, v45
v_add_f32 v106, v106, v114
v_mfma_f32_16x16x32_bf16 v[16:19], a[140:143], v[180:183], v[16:19]
v_exp_f32 v46, v46
v_mfma_f32_16x16x32_bf16 a[4:7], a[164:167], v[72:75], a[4:7]
v_add_f32 v107, v107, v115
v_cvt_pk_bf16_f32 v244, v104, v105
v_mfma_f32_16x16x32_bf16 a[36:39], a[164:167], v[76:79], a[36:39]
v_exp_f32 v47, v47
v_mfma_f32_16x16x32_bf16 a[68:71], a[164:167], v[80:83], a[68:71]
buffer_load_dwordx4 v231, s[8:11], s38 offen offset:3072 lds
v_mfma_f32_16x16x32_bf16 a[100:103], a[164:167], v[84:87], a[100:103]
v_exp_f32 v48, v48
v_smfmac_f32_16x16x64_bf16 a[248:251], a[208:211], v[72:79], v235
ds_read_b64_tr_b16 a[164:165], v221 offset:8192
ds_read_b64_tr_b16 a[166:167], v221 offset:12288
v_mfma_f32_16x16x32_bf16 v[24:27], a[128:131], v[184:187], v[144:147]
v_exp_f32 v49, v49
v_mfma_f32_16x16x32_bf16 v[24:27], a[132:135], v[188:191], v[24:27]
v_cvt_pk_bf16_f32 v91, v46, v47
v_cvt_pk_bf16_f32 v92, v48, v49
v_mfma_f32_16x16x32_bf16 v[24:27], a[136:139], v[192:195], v[24:27]
v_exp_f32 v50, v50
v_mfma_f32_16x16x32_bf16 v[24:27], a[140:143], v[196:199], v[24:27]
v_cvt_pk_bf16_f32 v245, v106, v107
v_lshlrev_b32 v104, 16, v244
v_mfma_f32_16x16x32_bf16 a[8:11], a[168:171], v[72:75], a[8:11]
v_exp_f32 v51, v51
v_mfma_f32_16x16x32_bf16 a[40:43], a[168:171], v[76:79], a[40:43]
v_cvt_pk_bf16_f32 v93, v50, v51
v_and_b32 v105, 0xffff0000, v244
v_mfma_f32_16x16x32_bf16 a[72:75], a[168:171], v[80:83], a[72:75]
v_exp_f32 v52, v52
v_mfma_f32_16x16x32_bf16 a[104:107], a[168:171], v[84:87], a[104:107]
ds_read_b64_tr_b16 a[168:169], v222 offset:8192
ds_read_b64_tr_b16 a[170:171], v222 offset:12288
v_mfma_f32_16x16x32_bf16 v[32:35], a[128:131], v[200:203], v[148:151]
s_add_u32 s38, s38, 16384
v_exp_f32 v53, v53
v_mfma_f32_16x16x32_bf16 v[32:35], a[132:135], v[204:207], v[32:35]
s_add_u32 m0, s37, 114688
ds_read_b128 a[128:131], v216 offset:57344
ds_read_b128 a[132:135], v217 offset:57344
v_mfma_f32_16x16x32_bf16 v[32:35], a[136:139], v[208:211], v[32:35]
v_exp_f32 v54, v54
v_mfma_f32_16x16x32_bf16 v[32:35], a[140:143], v[212:215], v[32:35]
buffer_load_dwordx4 v232, s[12:15], s39 offen offset:0 lds
v_mfma_f32_16x16x32_bf16 a[12:15], a[172:175], v[72:75], a[12:15]
v_exp_f32 v55, v55
v_mfma_f32_16x16x32_bf16 a[44:47], a[172:175], v[76:79], a[44:47]
ds_read_b128 a[136:139], v218 offset:57344
ds_read_b128 a[140:143], v219 offset:57344
v_mfma_f32_16x16x32_bf16 a[76:79], a[172:175], v[80:83], a[76:79]
v_exp_f32 v56, v56
v_mfma_f32_16x16x32_bf16 a[108:111], a[172:175], v[84:87], a[108:111]
s_waitcnt lgkmcnt(6)
v_exp_f32 v57, v57
v_mfma_f32_16x16x32_bf16 v[12:15], a[144:147], v[152:155], v[136:139]
ds_read_b64_tr_b16 a[172:173], v223 offset:8192
ds_read_b64_tr_b16 a[174:175], v223 offset:12288
v_mfma_f32_16x16x32_bf16 v[12:15], a[148:151], v[156:159], v[12:15]
v_exp_f32 v58, v58
v_mfma_f32_16x16x32_bf16 v[12:15], a[152:155], v[160:163], v[12:15]
v_cvt_pk_bf16_f32 v94, v52, v53
v_cvt_pk_bf16_f32 v95, v54, v55
v_mfma_f32_16x16x32_bf16 v[12:15], a[156:159], v[164:167], v[12:15]
v_exp_f32 v59, v59
v_mfma_f32_16x16x32_bf16 a[16:19], a[176:179], v[72:75], a[16:19]
v_cvt_pk_bf16_f32 v96, v56, v57
v_cvt_pk_bf16_f32 v97, v58, v59
v_mfma_f32_16x16x32_bf16 a[48:51], a[176:179], v[76:79], a[48:51]
v_exp_f32 v60, v60
v_mfma_f32_16x16x32_bf16 a[80:83], a[176:179], v[80:83], a[80:83]
buffer_load_dwordx4 v233, s[12:15], s39 offen offset:1024 lds
v_mfma_f32_16x16x32_bf16 a[112:115], a[176:179], v[84:87], a[112:115]
v_exp_f32 v61, v61
v_mfma_f32_16x16x32_bf16 v[20:23], a[144:147], v[168:171], v[140:143]
ds_read_b64_tr_b16 a[176:177], v224 offset:8192
ds_read_b64_tr_b16 a[178:179], v224 offset:12288
v_mfma_f32_16x16x32_bf16 v[20:23], a[148:151], v[172:175], v[20:23]
v_exp_f32 v62, v62
v_mfma_f32_16x16x32_bf16 v[20:23], a[152:155], v[176:179], v[20:23]
v_cvt_pk_bf16_f32 v98, v60, v61
v_lshlrev_b32 v106, 16, v245
v_mfma_f32_16x16x32_bf16 v[20:23], a[156:159], v[180:183], v[20:23]
v_exp_f32 v63, v63
v_mfma_f32_16x16x32_bf16 a[20:23], a[180:183], v[72:75], a[20:23]
v_cvt_pk_bf16_f32 v99, v62, v63
v_and_b32 v107, 0xffff0000, v245
v_mfma_f32_16x16x32_bf16 a[52:55], a[180:183], v[76:79], a[52:55]
v_exp_f32 v64, v64
v_mfma_f32_16x16x32_bf16 a[84:87], a[180:183], v[80:83], a[84:87]
v_mul_f32 v120, 0xbfb8aa3b, v104
v_mul_f32 v121, 0xbfb8aa3b, v105
v_mfma_f32_16x16x32_bf16 a[116:119], a[180:183], v[84:87], a[116:119]
v_exp_f32 v65, v65
v_smfmac_f32_16x16x64_bf16 a[252:255], a[208:211], v[80:87], v235
ds_read_b64_tr_b16 a[180:181], v225 offset:8192
ds_read_b64_tr_b16 a[182:183], v225 offset:12288
v_mfma_f32_16x16x32_bf16 v[28:31], a[144:147], v[184:187], v[144:147]
v_exp_f32 v66, v66
v_mfma_f32_16x16x32_bf16 v[28:31], a[148:151], v[188:191], v[28:31]
buffer_load_dwordx4 v232, s[12:15], s39 offen offset:2048 lds
v_mfma_f32_16x16x32_bf16 v[28:31], a[152:155], v[192:195], v[28:31]
v_exp_f32 v67, v67
v_mfma_f32_16x16x32_bf16 v[28:31], a[156:159], v[196:199], v[28:31]
v_cvt_pk_bf16_f32 v100, v64, v65
v_cvt_pk_bf16_f32 v101, v66, v67
v_mfma_f32_16x16x32_bf16 a[24:27], a[184:187], v[72:75], a[24:27]
v_exp_f32 v68, v68
v_mfma_f32_16x16x32_bf16 a[56:59], a[184:187], v[76:79], a[56:59]
v_mul_f32 v122, 0xbfb8aa3b, v106
v_mul_f32 v123, 0xbfb8aa3b, v107
v_mfma_f32_16x16x32_bf16 a[88:91], a[184:187], v[80:83], a[88:91]
v_exp_f32 v69, v69
v_mfma_f32_16x16x32_bf16 a[120:123], a[184:187], v[84:87], a[120:123]
ds_read_b64_tr_b16 a[184:185], v226 offset:8192
ds_read_b64_tr_b16 a[186:187], v226 offset:12288
v_mfma_f32_16x16x32_bf16 v[36:39], a[144:147], v[200:203], v[148:151]
v_exp_f32 v70, v70
v_mfma_f32_16x16x32_bf16 v[36:39], a[148:151], v[204:207], v[36:39]
ds_read_b128 a[144:147], v216 offset:61440
ds_read_b128 a[148:151], v217 offset:61440
v_mfma_f32_16x16x32_bf16 v[36:39], a[152:155], v[208:211], v[36:39]
v_exp_f32 v71, v71
v_mfma_f32_16x16x32_bf16 v[36:39], a[156:159], v[212:215], v[36:39]
ds_read_b128 a[152:155], v218 offset:61440
ds_read_b128 a[156:159], v219 offset:61440
v_mfma_f32_16x16x32_bf16 a[28:31], a[188:191], v[72:75], a[28:31]
v_cvt_pk_bf16_f32 v102, v68, v69
v_cvt_pk_bf16_f32 v103, v70, v71
v_mfma_f32_16x16x32_bf16 a[60:63], a[188:191], v[76:79], a[60:63]
v_exp_f32 v120, v120
v_mfma_f32_16x16x32_bf16 a[92:95], a[188:191], v[80:83], a[92:95]
v_exp_f32 v121, v121
v_mfma_f32_16x16x32_bf16 a[124:127], a[188:191], v[84:87], a[124:127]
s_waitcnt lgkmcnt(6)
ds_read_b64_tr_b16 a[188:189], v227 offset:8192
ds_read_b64_tr_b16 a[190:191], v227 offset:12288
v_mfma_f32_16x16x32_bf16 v[40:43], a[128:131], v[152:155], v[136:139]
v_exp_f32 v8, v8
v_mfma_f32_16x16x32_bf16 v[40:43], a[132:135], v[156:159], v[40:43]
v_exp_f32 v9, v9
v_mfma_f32_16x16x32_bf16 v[40:43], a[136:139], v[160:163], v[40:43]
buffer_load_dwordx4 v233, s[12:15], s39 offen offset:3072 lds
v_mfma_f32_16x16x32_bf16 v[40:43], a[140:143], v[164:167], v[40:43]
v_exp_f32 v10, v10
v_mfma_f32_16x16x32_bf16 a[0:3], a[160:163], v[88:91], a[0:3]
s_waitcnt vmcnt(16)
ds_read_b64_tr_b16 a[192:193], v128
v_cvt_pk_bf16_f32 v72, v8, v9
v_mfma_f32_16x16x32_bf16 a[32:35], a[160:163], v[92:95], a[32:35]
v_exp_f32 v11, v11
v_mfma_f32_16x16x32_bf16 a[64:67], a[160:163], v[96:99], a[64:67]
ds_read_b64_tr_b16 a[196:197], v129
v_cvt_pk_bf16_f32 v73, v10, v11
v_mfma_f32_16x16x32_bf16 a[96:99], a[160:163], v[100:103], a[96:99]
v_exp_f32 v12, v12
v_mfma_f32_16x16x32_bf16 v[48:51], a[128:131], v[168:171], v[140:143]
ds_read_b64_tr_b16 a[160:161], v220 offset:16384
ds_read_b64_tr_b16 a[162:163], v220 offset:20480
v_mfma_f32_16x16x32_bf16 v[48:51], a[132:135], v[172:175], v[48:51]
v_exp_f32 v13, v13
v_mfma_f32_16x16x32_bf16 v[48:51], a[136:139], v[176:179], v[48:51]
ds_read_b64_tr_b16 a[200:201], v130
v_cvt_pk_bf16_f32 v74, v12, v13
v_mfma_f32_16x16x32_bf16 v[48:51], a[140:143], v[180:183], v[48:51]
v_exp_f32 v14, v14
v_mfma_f32_16x16x32_bf16 a[4:7], a[164:167], v[88:91], a[4:7]
v_exp_f32 v122, v122
v_mfma_f32_16x16x32_bf16 a[36:39], a[164:167], v[92:95], a[36:39]
s_add_u32 s39, s39, 16384
v_exp_f32 v15, v15
v_mfma_f32_16x16x32_bf16 a[68:71], a[164:167], v[96:99], a[68:71]
s_add_u32 m0, s37, 0
ds_read_b64_tr_b16 a[204:205], v131
v_cvt_pk_bf16_f32 v75, v14, v15
v_mfma_f32_16x16x32_bf16 a[100:103], a[164:167], v[100:103], a[100:103]
v_exp_f32 v16, v16
v_smfmac_f32_16x16x64_bf16 a[248:251], a[208:211], v[88:95], v235
buffer_load_dwordx4 v228, s[8:11], s38 offen offset:0 lds
v_mfma_f32_16x16x32_bf16 v[56:59], a[128:131], v[184:187], v[144:147]
v_exp_f32 v17, v17
v_mfma_f32_16x16x32_bf16 v[56:59], a[132:135], v[188:191], v[56:59]
ds_read_b64_tr_b16 a[164:165], v221 offset:16384
ds_read_b64_tr_b16 a[166:167], v221 offset:20480
v_mfma_f32_16x16x32_bf16 v[56:59], a[136:139], v[192:195], v[56:59]
v_exp_f32 v18, v18
v_mfma_f32_16x16x32_bf16 v[56:59], a[140:143], v[196:199], v[56:59]
v_cvt_pk_bf16_f32 v76, v16, v17
v_mfma_f32_16x16x32_bf16 a[8:11], a[168:171], v[88:91], a[8:11]
v_exp_f32 v19, v19
v_mfma_f32_16x16x32_bf16 a[40:43], a[168:171], v[92:95], a[40:43]
v_cvt_pk_bf16_f32 v77, v18, v19
v_mfma_f32_16x16x32_bf16 a[72:75], a[168:171], v[96:99], a[72:75]
v_exp_f32 v20, v20
v_mfma_f32_16x16x32_bf16 a[104:107], a[168:171], v[100:103], a[104:107]
ds_read_b64_tr_b16 a[168:169], v222 offset:16384
ds_read_b64_tr_b16 a[170:171], v222 offset:20480
v_mfma_f32_16x16x32_bf16 v[64:67], a[128:131], v[200:203], v[148:151]
v_exp_f32 v21, v21
v_mfma_f32_16x16x32_bf16 v[64:67], a[132:135], v[204:207], v[64:67]
buffer_load_dwordx4 v229, s[8:11], s38 offen offset:1024 lds
v_mfma_f32_16x16x32_bf16 v[64:67], a[136:139], v[208:211], v[64:67]
v_exp_f32 v22, v22
v_mfma_f32_16x16x32_bf16 v[64:67], a[140:143], v[212:215], v[64:67]
ds_read_b128 a[128:131], v216 offset:32768
ds_read_b128 a[132:135], v217 offset:32768
v_mfma_f32_16x16x32_bf16 a[12:15], a[172:175], v[88:91], a[12:15]
v_exp_f32 v23, v23
v_mfma_f32_16x16x32_bf16 a[44:47], a[172:175], v[92:95], a[44:47]
ds_read_b128 a[136:139], v218 offset:32768
ds_read_b128 a[140:143], v219 offset:32768
v_mfma_f32_16x16x32_bf16 a[76:79], a[172:175], v[96:99], a[76:79]
v_exp_f32 v24, v24
v_mfma_f32_16x16x32_bf16 a[108:111], a[172:175], v[100:103], a[108:111]
s_waitcnt lgkmcnt(6)
v_exp_f32 v25, v25
v_mfma_f32_16x16x32_bf16 v[44:47], a[144:147], v[152:155], v[136:139]
ds_read_b64_tr_b16 a[172:173], v223 offset:16384
ds_read_b64_tr_b16 a[174:175], v223 offset:20480
v_mfma_f32_16x16x32_bf16 v[44:47], a[148:151], v[156:159], v[44:47]
v_exp_f32 v26, v26
v_mfma_f32_16x16x32_bf16 v[44:47], a[152:155], v[160:163], v[44:47]
v_cvt_pk_bf16_f32 v78, v20, v21
v_cvt_pk_bf16_f32 v79, v22, v23
v_mfma_f32_16x16x32_bf16 v[44:47], a[156:159], v[164:167], v[44:47]
v_exp_f32 v27, v27
v_mfma_f32_16x16x32_bf16 a[16:19], a[176:179], v[88:91], a[16:19]
v_cvt_pk_bf16_f32 v80, v24, v25
v_cvt_pk_bf16_f32 v81, v26, v27
v_mfma_f32_16x16x32_bf16 a[48:51], a[176:179], v[92:95], a[48:51]
v_exp_f32 v28, v28
v_mfma_f32_16x16x32_bf16 a[80:83], a[176:179], v[96:99], a[80:83]
buffer_load_dwordx4 v230, s[8:11], s38 offen offset:2048 lds
v_mfma_f32_16x16x32_bf16 a[112:115], a[176:179], v[100:103], a[112:115]
v_exp_f32 v29, v29
v_mfma_f32_16x16x32_bf16 v[52:55], a[144:147], v[168:171], v[140:143]
ds_read_b64_tr_b16 a[176:177], v224 offset:16384
ds_read_b64_tr_b16 a[178:179], v224 offset:20480
v_mfma_f32_16x16x32_bf16 v[52:55], a[148:151], v[172:175], v[52:55]
v_exp_f32 v30, v30
v_mfma_f32_16x16x32_bf16 v[52:55], a[152:155], v[176:179], v[52:55]
v_cvt_pk_bf16_f32 v82, v28, v29
v_mfma_f32_16x16x32_bf16 v[52:55], a[156:159], v[180:183], v[52:55]
v_exp_f32 v31, v31
v_mfma_f32_16x16x32_bf16 a[20:23], a[180:183], v[88:91], a[20:23]
v_cvt_pk_bf16_f32 v83, v30, v31
v_mfma_f32_16x16x32_bf16 a[52:55], a[180:183], v[92:95], a[52:55]
v_exp_f32 v32, v32
v_mfma_f32_16x16x32_bf16 a[84:87], a[180:183], v[96:99], a[84:87]
v_exp_f32 v123, v123
v_mfma_f32_16x16x32_bf16 a[116:119], a[180:183], v[100:103], a[116:119]
v_exp_f32 v33, v33
v_smfmac_f32_16x16x64_bf16 a[252:255], a[208:211], v[96:103], v235
ds_read_b64_tr_b16 a[180:181], v225 offset:16384
ds_read_b64_tr_b16 a[182:183], v225 offset:20480
v_mfma_f32_16x16x32_bf16 v[60:63], a[144:147], v[184:187], v[144:147]
v_exp_f32 v34, v34
v_mfma_f32_16x16x32_bf16 v[60:63], a[148:151], v[188:191], v[60:63]
buffer_load_dwordx4 v231, s[8:11], s38 offen offset:3072 lds
v_mfma_f32_16x16x32_bf16 v[60:63], a[152:155], v[192:195], v[60:63]
v_exp_f32 v35, v35
v_mfma_f32_16x16x32_bf16 v[60:63], a[156:159], v[196:199], v[60:63]
v_cvt_pk_bf16_f32 v84, v32, v33
v_cvt_pk_bf16_f32 v85, v34, v35
v_mfma_f32_16x16x32_bf16 a[24:27], a[184:187], v[88:91], a[24:27]
v_exp_f32 v36, v36
v_mfma_f32_16x16x32_bf16 a[56:59], a[184:187], v[92:95], a[56:59]
v_add_f32 v120, 1.0, v120
v_add_f32 v121, 1.0, v121
v_mfma_f32_16x16x32_bf16 a[88:91], a[184:187], v[96:99], a[88:91]
v_exp_f32 v37, v37
v_mfma_f32_16x16x32_bf16 a[120:123], a[184:187], v[100:103], a[120:123]
ds_read_b64_tr_b16 a[184:185], v226 offset:16384
ds_read_b64_tr_b16 a[186:187], v226 offset:20480
v_mfma_f32_16x16x32_bf16 v[68:71], a[144:147], v[200:203], v[148:151]
v_exp_f32 v38, v38
v_mfma_f32_16x16x32_bf16 v[68:71], a[148:151], v[204:207], v[68:71]
ds_read_b128 a[144:147], v216 offset:36864
ds_read_b128 a[148:151], v217 offset:36864
v_mfma_f32_16x16x32_bf16 v[68:71], a[152:155], v[208:211], v[68:71]
v_exp_f32 v39, v39
v_mfma_f32_16x16x32_bf16 v[68:71], a[156:159], v[212:215], v[68:71]
ds_read_b128 a[152:155], v218 offset:36864
ds_read_b128 a[156:159], v219 offset:36864
v_mfma_f32_16x16x32_bf16 a[28:31], a[188:191], v[88:91], a[28:31]
v_cvt_pk_bf16_f32 v86, v36, v37
v_cvt_pk_bf16_f32 v87, v38, v39
v_mfma_f32_16x16x32_bf16 a[60:63], a[188:191], v[92:95], a[60:63]
s_add_u32 s38, s38, 16384
v_add_f32 v122, 1.0, v122
v_add_f32 v123, 1.0, v123
v_mfma_f32_16x16x32_bf16 a[92:95], a[188:191], v[96:99], a[92:95]
v_rcp_f32 v120, v120
v_mfma_f32_16x16x32_bf16 a[124:127], a[188:191], v[100:103], a[124:127]
s_waitcnt lgkmcnt(6)
ds_read_b64_tr_b16 a[188:189], v227 offset:16384
ds_read_b64_tr_b16 a[190:191], v227 offset:20480
v_rcp_f32 v121, v121
v_rcp_f32 v122, v122
v_mfma_f32_16x16x32_bf16 v[8:11], a[128:131], v[152:155], v[136:139]
v_exp_f32 v40, v40
v_mfma_f32_16x16x32_bf16 v[8:11], a[132:135], v[156:159], v[8:11]
v_exp_f32 v41, v41
v_mfma_f32_16x16x32_bf16 v[8:11], a[136:139], v[160:163], v[8:11]
buffer_load_dwordx2 v[252:253], v251, s[76:79], s42 offen sc1
v_mfma_f32_16x16x32_bf16 v[8:11], a[140:143], v[164:167], v[8:11]
v_exp_f32 v42, v42
v_mfma_f32_16x16x32_bf16 a[0:3], a[160:163], v[72:75], a[0:3]
ds_read_b64_tr_b16 a[212:213], v132
v_cvt_pk_bf16_f32 v88, v40, v41
v_mfma_f32_16x16x32_bf16 a[32:35], a[160:163], v[76:79], a[32:35]
v_exp_f32 v43, v43
v_mfma_f32_16x16x32_bf16 a[64:67], a[160:163], v[80:83], a[64:67]
ds_read_b64_tr_b16 a[216:217], v133
v_cvt_pk_bf16_f32 v89, v42, v43
v_mfma_f32_16x16x32_bf16 a[96:99], a[160:163], v[84:87], a[96:99]
v_exp_f32 v44, v44
v_mfma_f32_16x16x32_bf16 v[16:19], a[128:131], v[168:171], v[140:143]
ds_read_b64_tr_b16 a[160:161], v220 offset:24576
ds_read_b64_tr_b16 a[162:163], v220 offset:28672
v_mfma_f32_16x16x32_bf16 v[16:19], a[132:135], v[172:175], v[16:19]
v_exp_f32 v45, v45
v_mfma_f32_16x16x32_bf16 v[16:19], a[136:139], v[176:179], v[16:19]
ds_read_b64_tr_b16 a[220:221], v134
v_cvt_pk_bf16_f32 v90, v44, v45
v_mfma_f32_16x16x32_bf16 v[16:19], a[140:143], v[180:183], v[16:19]
v_exp_f32 v46, v46
v_mfma_f32_16x16x32_bf16 a[4:7], a[164:167], v[72:75], a[4:7]
v_rcp_f32 v123, v123
v_mfma_f32_16x16x32_bf16 a[36:39], a[164:167], v[76:79], a[36:39]
v_exp_f32 v47, v47
v_mfma_f32_16x16x32_bf16 a[68:71], a[164:167], v[80:83], a[68:71]
v_cvt_pk_bf16_f32 v91, v46, v47
v_mul_f32 v104, v104, v120
v_mfma_f32_16x16x32_bf16 a[100:103], a[164:167], v[84:87], a[100:103]
v_exp_f32 v48, v48
v_smfmac_f32_16x16x64_bf16 a[248:251], a[208:211], v[72:79], v235
s_add_u32 s42, s42, s43
buffer_load_dword v255, v243, s[28:31], s45 offen
v_mfma_f32_16x16x32_bf16 v[24:27], a[128:131], v[184:187], v[144:147]
v_exp_f32 v49, v49
v_mfma_f32_16x16x32_bf16 v[24:27], a[132:135], v[188:191], v[24:27]
ds_read_b64_tr_b16 a[164:165], v221 offset:24576
ds_read_b64_tr_b16 a[166:167], v221 offset:28672
v_mfma_f32_16x16x32_bf16 v[24:27], a[136:139], v[192:195], v[24:27]
v_exp_f32 v50, v50
v_mfma_f32_16x16x32_bf16 v[24:27], a[140:143], v[196:199], v[24:27]
v_cvt_pk_bf16_f32 v92, v48, v49
v_mul_f32 v105, v105, v121
v_mfma_f32_16x16x32_bf16 a[8:11], a[168:171], v[72:75], a[8:11]
v_exp_f32 v51, v51
v_mfma_f32_16x16x32_bf16 a[40:43], a[168:171], v[76:79], a[40:43]
v_cvt_pk_bf16_f32 v93, v50, v51
v_mul_f32 v106, v106, v122
v_mfma_f32_16x16x32_bf16 a[72:75], a[168:171], v[80:83], a[72:75]
v_exp_f32 v52, v52
v_mfma_f32_16x16x32_bf16 a[104:107], a[168:171], v[84:87], a[104:107]
ds_read_b64_tr_b16 a[168:169], v222 offset:24576
ds_read_b64_tr_b16 a[170:171], v222 offset:28672
v_mfma_f32_16x16x32_bf16 v[32:35], a[128:131], v[200:203], v[148:151]
v_exp_f32 v53, v53
v_mfma_f32_16x16x32_bf16 v[32:35], a[132:135], v[204:207], v[32:35]
ds_read_b128 a[128:131], v216 offset:40960
ds_read_b128 a[132:135], v217 offset:40960
v_mfma_f32_16x16x32_bf16 v[32:35], a[136:139], v[208:211], v[32:35]
v_exp_f32 v54, v54
v_mfma_f32_16x16x32_bf16 v[32:35], a[140:143], v[212:215], v[32:35]
ds_read_b128 a[136:139], v218 offset:40960
ds_read_b128 a[140:143], v219 offset:40960
v_mfma_f32_16x16x32_bf16 a[12:15], a[172:175], v[72:75], a[12:15]
v_exp_f32 v55, v55
v_mfma_f32_16x16x32_bf16 a[44:47], a[172:175], v[76:79], a[44:47]
v_cvt_pk_bf16_f32 v94, v52, v53
v_cvt_pk_bf16_f32 v95, v54, v55
v_mfma_f32_16x16x32_bf16 a[76:79], a[172:175], v[80:83], a[76:79]
s_waitcnt lgkmcnt(6)
v_exp_f32 v56, v56
v_mfma_f32_16x16x32_bf16 a[108:111], a[172:175], v[84:87], a[108:111]
s_add_u32 s45, s45, 589824
v_exp_f32 v57, v57
v_mfma_f32_16x16x32_bf16 v[12:15], a[144:147], v[152:155], v[136:139]
global_load_dword v255, v242, s[72:73]
v_mfma_f32_16x16x32_bf16 v[12:15], a[148:151], v[156:159], v[12:15]
v_exp_f32 v58, v58
v_mfma_f32_16x16x32_bf16 v[12:15], a[152:155], v[160:163], v[12:15]
ds_read_b64_tr_b16 a[172:173], v223 offset:24576
ds_read_b64_tr_b16 a[174:175], v223 offset:28672
v_mfma_f32_16x16x32_bf16 v[12:15], a[156:159], v[164:167], v[12:15]
v_exp_f32 v59, v59
v_mfma_f32_16x16x32_bf16 a[16:19], a[176:179], v[72:75], a[16:19]
v_cvt_pk_bf16_f32 v96, v56, v57
v_cvt_pk_bf16_f32 v97, v58, v59
v_mfma_f32_16x16x32_bf16 a[48:51], a[176:179], v[76:79], a[48:51]
v_exp_f32 v60, v60
v_mfma_f32_16x16x32_bf16 a[80:83], a[176:179], v[80:83], a[80:83]
v_mul_f32 v107, v107, v123
v_cvt_pk_bf16_f32 v120, v104, v105
v_mfma_f32_16x16x32_bf16 a[112:115], a[176:179], v[84:87], a[112:115]
v_exp_f32 v61, v61
v_mfma_f32_16x16x32_bf16 v[20:23], a[144:147], v[168:171], v[140:143]
ds_read_b64_tr_b16 a[176:177], v224 offset:24576
ds_read_b64_tr_b16 a[178:179], v224 offset:28672
v_mfma_f32_16x16x32_bf16 v[20:23], a[148:151], v[172:175], v[20:23]
v_exp_f32 v62, v62
v_mfma_f32_16x16x32_bf16 v[20:23], a[152:155], v[176:179], v[20:23]
v_cvt_pk_bf16_f32 v98, v60, v61
v_cvt_pk_bf16_f32 v121, v106, v107
v_mfma_f32_16x16x32_bf16 v[20:23], a[156:159], v[180:183], v[20:23]
v_exp_f32 v63, v63
v_mfma_f32_16x16x32_bf16 a[20:23], a[180:183], v[72:75], a[20:23]
v_cvt_pk_bf16_f32 v99, v62, v63
v_cndmask_b32 v244, v244, v120, s[88:89]
v_mfma_f32_16x16x32_bf16 a[52:55], a[180:183], v[76:79], a[52:55]
v_exp_f32 v64, v64
v_mfma_f32_16x16x32_bf16 a[84:87], a[180:183], v[80:83], a[84:87]
buffer_load_dword v255, v0, s[24:27], s44 offen sc1
v_mfma_f32_16x16x32_bf16 a[116:119], a[180:183], v[84:87], a[116:119]
v_exp_f32 v65, v65
v_smfmac_f32_16x16x64_bf16 a[252:255], a[208:211], v[80:87], v235
ds_read_b64_tr_b16 a[180:181], v225 offset:24576
ds_read_b64_tr_b16 a[182:183], v225 offset:28672
v_mfma_f32_16x16x32_bf16 v[28:31], a[144:147], v[184:187], v[144:147]
v_exp_f32 v66, v66
v_mfma_f32_16x16x32_bf16 v[28:31], a[148:151], v[188:191], v[28:31]
v_cvt_pk_bf16_f32 v100, v64, v65
v_cndmask_b32 v245, v245, v121, s[88:89]
v_mfma_f32_16x16x32_bf16 v[28:31], a[152:155], v[192:195], v[28:31]
v_exp_f32 v67, v67
v_mfma_f32_16x16x32_bf16 v[28:31], a[156:159], v[196:199], v[28:31]
ds_write_b64 v6, v[244:245] offset:0
v_cvt_pk_bf16_f32 v101, v66, v67
v_mfma_f32_16x16x32_bf16 a[24:27], a[184:187], v[72:75], a[24:27]
v_exp_f32 v68, v68
v_mfma_f32_16x16x32_bf16 a[56:59], a[184:187], v[76:79], a[56:59]
ds_write_b64 v6, v[244:245] offset:8192
ds_write_b64 v6, v[244:245] offset:16384
v_mfma_f32_16x16x32_bf16 a[88:91], a[184:187], v[80:83], a[88:91]
v_exp_f32 v69, v69
v_mfma_f32_16x16x32_bf16 a[120:123], a[184:187], v[84:87], a[120:123]
ds_read_b64_tr_b16 a[184:185], v226 offset:24576
ds_read_b64_tr_b16 a[186:187], v226 offset:28672
v_mfma_f32_16x16x32_bf16 v[36:39], a[144:147], v[200:203], v[148:151]
v_exp_f32 v70, v70
v_mfma_f32_16x16x32_bf16 v[36:39], a[148:151], v[204:207], v[36:39]
ds_read_b128 a[144:147], v216 offset:45056
ds_read_b128 a[148:151], v217 offset:45056
v_mfma_f32_16x16x32_bf16 v[36:39], a[152:155], v[208:211], v[36:39]
v_exp_f32 v71, v71
v_mfma_f32_16x16x32_bf16 v[36:39], a[156:159], v[212:215], v[36:39]
ds_read_b128 a[152:155], v218 offset:45056
ds_read_b128 a[156:159], v219 offset:45056
v_mfma_f32_16x16x32_bf16 a[28:31], a[188:191], v[72:75], a[28:31]
v_cvt_pk_bf16_f32 v102, v68, v69
v_cvt_pk_bf16_f32 v103, v70, v71
v_mfma_f32_16x16x32_bf16 a[60:63], a[188:191], v[76:79], a[60:63]
s_add_u32 s44, s44, 8192
ds_write_b64 v6, v[244:245] offset:24576
ds_read_b64_tr_b16 a[224:225], v135
v_mfma_f32_16x16x32_bf16 a[92:95], a[188:191], v[80:83], a[92:95]
v_mfma_f32_16x16x32_bf16 a[124:127], a[188:191], v[84:87], a[124:127]
s_waitcnt lgkmcnt(8)
ds_read_b64_tr_b16 a[188:189], v227 offset:24576
ds_read_b64_tr_b16 a[190:191], v227 offset:28672
v_mfma_f32_16x16x32_bf16 v[40:43], a[128:131], v[152:155], v[136:139]
s_lshl_b32 s90, s52, 7
v_exp_f32 v8, v8
v_mfma_f32_16x16x32_bf16 v[40:43], a[132:135], v[156:159], v[40:43]
s_add_u32 s90, s90, 0x2400000
v_exp_f32 v9, v9
v_mfma_f32_16x16x32_bf16 v[40:43], a[136:139], v[160:163], v[40:43]
s_add_u32 s47, s32, 32
v_cvt_pk_bf16_f32 v72, v8, v9
v_mfma_f32_16x16x32_bf16 v[40:43], a[140:143], v[164:167], v[40:43]
s_mul_i32 s92, s47, 74240
v_exp_f32 v10, v10
v_mfma_f32_16x16x32_bf16 a[0:3], a[160:163], v[88:91], a[0:3]
s_add_u32 s92, s92, s90
v_mfma_f32_16x16x32_bf16 a[32:35], a[160:163], v[92:95], a[32:35]
s_mul_i32 s47, s32, 593920
v_exp_f32 v11, v11
s_waitcnt vmcnt(4) lgkmcnt(0)
s_barrier
v_mfma_f32_16x16x32_bf16 a[64:67], a[160:163], v[96:99], a[64:67]
s_add_u32 s90, s90, s47
ds_read_b64 v[104:105], v5 offset:0
v_cvt_pk_bf16_f32 v73, v10, v11
v_mfma_f32_16x16x32_bf16 a[96:99], a[160:163], v[100:103], a[96:99]
s_add_u32 m0, s49, 4096
v_exp_f32 v12, v12
v_mfma_f32_16x16x32_bf16 v[48:51], a[128:131], v[168:171], v[140:143]
s_add_u32 s48, s91, 18432
buffer_load_dwordx4 v249, s[64:67], s48 offen  lds
v_mfma_f32_16x16x32_bf16 v[48:51], a[132:135], v[172:175], v[48:51]
v_exp_f32 v13, v13
v_mfma_f32_16x16x32_bf16 v[48:51], a[136:139], v[176:179], v[48:51]
ds_read_b64_tr_b16 a[160:161], v220 offset:32768
ds_read_b64_tr_b16 a[162:163], v220 offset:36864
v_mfma_f32_16x16x32_bf16 v[48:51], a[140:143], v[180:183], v[48:51]
v_exp_f32 v14, v14
v_mfma_f32_16x16x32_bf16 a[4:7], a[164:167], v[88:91], a[4:7]
s_add_u32 m0, s49, 5120
ds_read_b64 v[106:107], v5 offset:1024
v_cvt_pk_bf16_f32 v74, v12, v13
v_mfma_f32_16x16x32_bf16 a[36:39], a[164:167], v[92:95], a[36:39]
s_add_u32 s48, s91, 23040
v_exp_f32 v15, v15
v_mfma_f32_16x16x32_bf16 a[68:71], a[164:167], v[96:99], a[68:71]
buffer_load_dwordx4 v250, s[64:67], s48 offen  lds
v_mfma_f32_16x16x32_bf16 a[100:103], a[164:167], v[100:103], a[100:103]
v_exp_f32 v16, v16
v_smfmac_f32_16x16x64_bf16 a[248:251], a[208:211], v[88:95], v235
ds_read_b64_tr_b16 a[164:165], v221 offset:32768
ds_read_b64_tr_b16 a[166:167], v221 offset:36864
v_mfma_f32_16x16x32_bf16 v[56:59], a[128:131], v[184:187], v[144:147]
v_exp_f32 v17, v17
v_mfma_f32_16x16x32_bf16 v[56:59], a[132:135], v[188:191], v[56:59]
s_add_u32 m0, s49, 6144
v_cvt_pk_bf16_f32 v75, v14, v15
v_cvt_pk_bf16_f32 v76, v16, v17
v_mfma_f32_16x16x32_bf16 v[56:59], a[136:139], v[192:195], v[56:59]
s_add_u32 s48, s91, 27648
v_exp_f32 v18, v18
v_mfma_f32_16x16x32_bf16 v[56:59], a[140:143], v[196:199], v[56:59]
buffer_load_dwordx4 v249, s[64:67], s48 offen  lds
v_mfma_f32_16x16x32_bf16 a[8:11], a[168:171], v[88:91], a[8:11]
v_exp_f32 v19, v19
v_mfma_f32_16x16x32_bf16 a[40:43], a[168:171], v[92:95], a[40:43]
ds_read_b64 v[108:109], v5 offset:2048
v_cvt_pk_bf16_f32 v77, v18, v19
v_mfma_f32_16x16x32_bf16 a[72:75], a[168:171], v[96:99], a[72:75]
s_add_u32 m0, s49, 7168
v_exp_f32 v20, v20
v_mfma_f32_16x16x32_bf16 a[104:107], a[168:171], v[100:103], a[104:107]
s_add_u32 s48, s91, 32256
buffer_load_dwordx4 v250, s[64:67], s48 offen  lds
v_mfma_f32_16x16x32_bf16 v[64:67], a[128:131], v[200:203], v[148:151]
v_exp_f32 v21, v21
v_mfma_f32_16x16x32_bf16 v[64:67], a[132:135], v[204:207], v[64:67]
ds_read_b64_tr_b16 a[168:169], v222 offset:32768
ds_read_b64_tr_b16 a[170:171], v222 offset:36864
v_mfma_f32_16x16x32_bf16 v[64:67], a[136:139], v[208:211], v[64:67]
v_exp_f32 v22, v22
v_mfma_f32_16x16x32_bf16 v[64:67], a[140:143], v[212:215], v[64:67]
ds_read_b128 a[128:131], v216 offset:16384
ds_read_b128 a[132:135], v217 offset:16384
v_mfma_f32_16x16x32_bf16 a[12:15], a[172:175], v[88:91], a[12:15]
s_add_u32 m0, s37, 65536
v_exp_f32 v23, v23
v_mfma_f32_16x16x32_bf16 a[44:47], a[172:175], v[92:95], a[44:47]
buffer_load_dwordx4 v232, s[12:15], s39 offen offset:0 lds
v_mfma_f32_16x16x32_bf16 a[76:79], a[172:175], v[96:99], a[76:79]
v_exp_f32 v24, v24
v_mfma_f32_16x16x32_bf16 a[108:111], a[172:175], v[100:103], a[108:111]
v_exp_f32 v25, v25
v_mfma_f32_16x16x32_bf16 v[44:47], a[144:147], v[152:155], v[136:139]
ds_read_b128 a[136:139], v218 offset:16384
ds_read_b128 a[140:143], v219 offset:16384
v_mfma_f32_16x16x32_bf16 v[44:47], a[148:151], v[156:159], v[44:47]
v_exp_f32 v26, v26
v_mfma_f32_16x16x32_bf16 v[44:47], a[152:155], v[160:163], v[44:47]
buffer_load_dwordx4 v233, s[12:15], s39 offen offset:1024 lds
v_mfma_f32_16x16x32_bf16 v[44:47], a[156:159], v[164:167], v[44:47]
v_exp_f32 v27, v27
v_mfma_f32_16x16x32_bf16 a[16:19], a[176:179], v[88:91], a[16:19]
ds_read_b64_tr_b16 a[172:173], v223 offset:32768
ds_read_b64_tr_b16 a[174:175], v223 offset:36864
v_mfma_f32_16x16x32_bf16 a[48:51], a[176:179], v[92:95], a[48:51]
v_exp_f32 v28, v28
v_mfma_f32_16x16x32_bf16 a[80:83], a[176:179], v[96:99], a[80:83]
v_cvt_pk_bf16_f32 v78, v20, v21
v_cvt_pk_bf16_f32 v79, v22, v23
v_mfma_f32_16x16x32_bf16 a[112:115], a[176:179], v[100:103], a[112:115]
v_exp_f32 v29, v29
v_mfma_f32_16x16x32_bf16 v[52:55], a[144:147], v[168:171], v[140:143]
buffer_load_dwordx4 v232, s[12:15], s39 offen offset:2048 lds
v_mfma_f32_16x16x32_bf16 v[52:55], a[148:151], v[172:175], v[52:55]
v_exp_f32 v30, v30
v_mfma_f32_16x16x32_bf16 v[52:55], a[152:155], v[176:179], v[52:55]
ds_read_b64_tr_b16 a[176:177], v224 offset:32768
ds_read_b64_tr_b16 a[178:179], v224 offset:36864
v_mfma_f32_16x16x32_bf16 v[52:55], a[156:159], v[180:183], v[52:55]
v_exp_f32 v31, v31
v_mfma_f32_16x16x32_bf16 a[20:23], a[180:183], v[88:91], a[20:23]
v_cvt_pk_bf16_f32 v80, v24, v25
v_cvt_pk_bf16_f32 v81, v26, v27
v_mfma_f32_16x16x32_bf16 a[52:55], a[180:183], v[92:95], a[52:55]
v_exp_f32 v32, v32
v_mfma_f32_16x16x32_bf16 a[84:87], a[180:183], v[96:99], a[84:87]
buffer_load_dwordx4 v233, s[12:15], s39 offen offset:3072 lds
v_mfma_f32_16x16x32_bf16 a[116:119], a[180:183], v[100:103], a[116:119]
v_exp_f32 v33, v33
v_smfmac_f32_16x16x64_bf16 a[252:255], a[208:211], v[96:103], v235
ds_read_b64_tr_b16 a[180:181], v225 offset:32768
ds_read_b64_tr_b16 a[182:183], v225 offset:36864
v_mfma_f32_16x16x32_bf16 v[60:63], a[144:147], v[184:187], v[144:147]
v_exp_f32 v34, v34
v_mfma_f32_16x16x32_bf16 v[60:63], a[148:151], v[188:191], v[60:63]
s_add_u32 s39, s39, 16384
v_cvt_pk_bf16_f32 v82, v28, v29
v_cvt_pk_bf16_f32 v83, v30, v31
v_mfma_f32_16x16x32_bf16 v[60:63], a[152:155], v[192:195], v[60:63]
s_add_u32 m0, s37, 49152
v_exp_f32 v35, v35
v_mfma_f32_16x16x32_bf16 v[60:63], a[156:159], v[196:199], v[60:63]
buffer_load_dwordx4 v228, s[8:11], s38 offen offset:0 lds
v_mfma_f32_16x16x32_bf16 a[24:27], a[184:187], v[88:91], a[24:27]
v_exp_f32 v36, v36
v_mfma_f32_16x16x32_bf16 a[56:59], a[184:187], v[92:95], a[56:59]
v_cvt_pk_bf16_f32 v84, v32, v33
v_cvt_pk_bf16_f32 v85, v34, v35
v_mfma_f32_16x16x32_bf16 a[88:91], a[184:187], v[96:99], a[88:91]
v_exp_f32 v37, v37
v_mfma_f32_16x16x32_bf16 a[120:123], a[184:187], v[100:103], a[120:123]
buffer_load_dwordx4 v229, s[8:11], s38 offen offset:1024 lds
v_mfma_f32_16x16x32_bf16 v[68:71], a[144:147], v[200:203], v[148:151]
v_exp_f32 v38, v38
v_mfma_f32_16x16x32_bf16 v[68:71], a[148:151], v[204:207], v[68:71]
ds_read_b64_tr_b16 a[184:185], v226 offset:32768
ds_read_b64_tr_b16 a[186:187], v226 offset:36864
v_mfma_f32_16x16x32_bf16 v[68:71], a[152:155], v[208:211], v[68:71]
v_exp_f32 v39, v39
v_mfma_f32_16x16x32_bf16 v[68:71], a[156:159], v[212:215], v[68:71]
ds_read_b128 a[144:147], v216 offset:20480
ds_read_b128 a[148:151], v217 offset:20480
v_mfma_f32_16x16x32_bf16 a[28:31], a[188:191], v[88:91], a[28:31]
ds_read_b128 a[152:155], v218 offset:20480
ds_read_b128 a[156:159], v219 offset:20480
v_mfma_f32_16x16x32_bf16 a[60:63], a[188:191], v[92:95], a[60:63]
v_cvt_pk_bf16_f32 v86, v36, v37
v_cvt_pk_bf16_f32 v87, v38, v39
v_mfma_f32_16x16x32_bf16 a[92:95], a[188:191], v[96:99], a[92:95]
ds_read_b64 v[110:111], v5 offset:3072
v_and_b32 v7, 7, v1
v_mfma_f32_16x16x32_bf16 a[124:127], a[188:191], v[100:103], a[124:127]
s_waitcnt lgkmcnt(7)
ds_read_b64_tr_b16 a[188:189], v227 offset:32768
ds_read_b64_tr_b16 a[190:191], v227 offset:36864
v_mul_u32_u24 v248, 18560, v4
v_lshl_add_u32 v248, v7, 4, v248
v_mfma_f32_16x16x32_bf16 v[8:11], a[128:131], v[152:155], v[136:139]
v_exp_f32 v40, v40
v_mfma_f32_16x16x32_bf16 v[8:11], a[132:135], v[156:159], v[8:11]
v_exp_f32 v41, v41
v_mfma_f32_16x16x32_bf16 v[8:11], a[136:139], v[160:163], v[8:11]
buffer_load_dwordx4 v230, s[8:11], s38 offen offset:2048 lds
v_mfma_f32_16x16x32_bf16 v[8:11], a[140:143], v[164:167], v[8:11]
v_exp_f32 v42, v42
v_mfma_f32_16x16x32_bf16 a[0:3], a[160:163], v[72:75], a[0:3]
v_cvt_pk_bf16_f32 v88, v40, v41
s_waitcnt lgkmcnt(2)
v_lshlrev_b32 v112, 16, v104
v_mfma_f32_16x16x32_bf16 a[32:35], a[160:163], v[76:79], a[32:35]
v_exp_f32 v43, v43
v_mfma_f32_16x16x32_bf16 a[64:67], a[160:163], v[80:83], a[64:67]
v_cvt_pk_bf16_f32 v89, v42, v43
v_and_b32 v113, 0xffff0000, v104
v_mfma_f32_16x16x32_bf16 a[96:99], a[160:163], v[84:87], a[96:99]
v_exp_f32 v44, v44
v_mfma_f32_16x16x32_bf16 v[16:19], a[128:131], v[168:171], v[140:143]
ds_read_b64_tr_b16 a[160:161], v220 offset:40960
ds_read_b64_tr_b16 a[162:163], v220 offset:45056
v_mfma_f32_16x16x32_bf16 v[16:19], a[132:135], v[172:175], v[16:19]
v_exp_f32 v45, v45
v_mfma_f32_16x16x32_bf16 v[16:19], a[136:139], v[176:179], v[16:19]
v_cvt_pk_bf16_f32 v90, v44, v45
v_lshlrev_b32 v114, 16, v105
v_mfma_f32_16x16x32_bf16 v[16:19], a[140:143], v[180:183], v[16:19]
v_exp_f32 v46, v46
v_mfma_f32_16x16x32_bf16 a[4:7], a[164:167], v[72:75], a[4:7]
v_and_b32 v115, 0xffff0000, v105
v_lshlrev_b32 v116, 16, v106
v_mfma_f32_16x16x32_bf16 a[36:39], a[164:167], v[76:79], a[36:39]
v_exp_f32 v47, v47
v_mfma_f32_16x16x32_bf16 a[68:71], a[164:167], v[80:83], a[68:71]
buffer_load_dwordx4 v231, s[8:11], s38 offen offset:3072 lds
v_mfma_f32_16x16x32_bf16 a[100:103], a[164:167], v[84:87], a[100:103]
v_exp_f32 v48, v48
v_smfmac_f32_16x16x64_bf16 a[248:251], a[208:211], v[72:79], v235
ds_read_b64_tr_b16 a[164:165], v221 offset:40960
ds_read_b64_tr_b16 a[166:167], v221 offset:45056
v_mfma_f32_16x16x32_bf16 v[24:27], a[128:131], v[184:187], v[144:147]
v_exp_f32 v49, v49
v_mfma_f32_16x16x32_bf16 v[24:27], a[132:135], v[188:191], v[24:27]
v_cvt_pk_bf16_f32 v91, v46, v47
v_cvt_pk_bf16_f32 v92, v48, v49
v_mfma_f32_16x16x32_bf16 v[24:27], a[136:139], v[192:195], v[24:27]
v_exp_f32 v50, v50
v_mfma_f32_16x16x32_bf16 v[24:27], a[140:143], v[196:199], v[24:27]
v_and_b32 v117, 0xffff0000, v106
v_lshlrev_b32 v118, 16, v107
v_mfma_f32_16x16x32_bf16 a[8:11], a[168:171], v[72:75], a[8:11]
v_exp_f32 v51, v51
v_mfma_f32_16x16x32_bf16 a[40:43], a[168:171], v[76:79], a[40:43]
v_cvt_pk_bf16_f32 v93, v50, v51
v_and_b32 v119, 0xffff0000, v107
v_mfma_f32_16x16x32_bf16 a[72:75], a[168:171], v[80:83], a[72:75]
v_exp_f32 v52, v52
v_mfma_f32_16x16x32_bf16 a[104:107], a[168:171], v[84:87], a[104:107]
ds_read_b64_tr_b16 a[168:169], v222 offset:40960
ds_read_b64_tr_b16 a[170:171], v222 offset:45056
v_mfma_f32_16x16x32_bf16 v[32:35], a[128:131], v[200:203], v[148:151]
s_add_u32 s38, s38, 16384
v_exp_f32 v53, v53
v_mfma_f32_16x16x32_bf16 v[32:35], a[132:135], v[204:207], v[32:35]
s_add_u32 m0, s37, 81920
ds_read_b128 a[128:131], v216 offset:24576
ds_read_b128 a[132:135], v217 offset:24576
v_mfma_f32_16x16x32_bf16 v[32:35], a[136:139], v[208:211], v[32:35]
v_exp_f32 v54, v54
v_mfma_f32_16x16x32_bf16 v[32:35], a[140:143], v[212:215], v[32:35]
buffer_load_dwordx4 v232, s[12:15], s39 offen offset:0 lds
v_mfma_f32_16x16x32_bf16 a[12:15], a[172:175], v[72:75], a[12:15]
v_exp_f32 v55, v55
v_mfma_f32_16x16x32_bf16 a[44:47], a[172:175], v[76:79], a[44:47]
ds_read_b128 a[136:139], v218 offset:24576
ds_read_b128 a[140:143], v219 offset:24576
v_mfma_f32_16x16x32_bf16 a[76:79], a[172:175], v[80:83], a[76:79]
v_exp_f32 v56, v56
v_mfma_f32_16x16x32_bf16 a[108:111], a[172:175], v[84:87], a[108:111]
v_exp_f32 v57, v57
v_mfma_f32_16x16x32_bf16 v[12:15], a[144:147], v[152:155], v[136:139]
ds_read_b64_tr_b16 a[172:173], v223 offset:40960
ds_read_b64_tr_b16 a[174:175], v223 offset:45056
v_mfma_f32_16x16x32_bf16 v[12:15], a[148:151], v[156:159], v[12:15]
v_exp_f32 v58, v58
v_mfma_f32_16x16x32_bf16 v[12:15], a[152:155], v[160:163], v[12:15]
v_cvt_pk_bf16_f32 v94, v52, v53
v_cvt_pk_bf16_f32 v95, v54, v55
v_mfma_f32_16x16x32_bf16 v[12:15], a[156:159], v[164:167], v[12:15]
v_exp_f32 v59, v59
v_mfma_f32_16x16x32_bf16 a[16:19], a[176:179], v[72:75], a[16:19]
v_cvt_pk_bf16_f32 v96, v56, v57
v_cvt_pk_bf16_f32 v97, v58, v59
v_mfma_f32_16x16x32_bf16 a[48:51], a[176:179], v[76:79], a[48:51]
v_exp_f32 v60, v60
v_mfma_f32_16x16x32_bf16 a[80:83], a[176:179], v[80:83], a[80:83]
buffer_load_dwordx4 v233, s[12:15], s39 offen offset:1024 lds
v_mfma_f32_16x16x32_bf16 a[112:115], a[176:179], v[84:87], a[112:115]
v_exp_f32 v61, v61
v_mfma_f32_16x16x32_bf16 v[20:23], a[144:147], v[168:171], v[140:143]
ds_read_b64_tr_b16 a[176:177], v224 offset:40960
ds_read_b64_tr_b16 a[178:179], v224 offset:45056
v_mfma_f32_16x16x32_bf16 v[20:23], a[148:151], v[172:175], v[20:23]
v_exp_f32 v62, v62
v_mfma_f32_16x16x32_bf16 v[20:23], a[152:155], v[176:179], v[20:23]
v_cvt_pk_bf16_f32 v98, v60, v61
v_lshlrev_b32 v120, 16, v108
v_mfma_f32_16x16x32_bf16 v[20:23], a[156:159], v[180:183], v[20:23]
v_exp_f32 v63, v63
v_mfma_f32_16x16x32_bf16 a[20:23], a[180:183], v[72:75], a[20:23]
v_cvt_pk_bf16_f32 v99, v62, v63
v_and_b32 v121, 0xffff0000, v108
v_mfma_f32_16x16x32_bf16 a[52:55], a[180:183], v[76:79], a[52:55]
v_exp_f32 v64, v64
v_mfma_f32_16x16x32_bf16 a[84:87], a[180:183], v[80:83], a[84:87]
v_lshlrev_b32 v122, 16, v109
v_and_b32 v123, 0xffff0000, v109
v_mfma_f32_16x16x32_bf16 a[116:119], a[180:183], v[84:87], a[116:119]
v_exp_f32 v65, v65
v_smfmac_f32_16x16x64_bf16 a[252:255], a[208:211], v[80:87], v235
ds_read_b64_tr_b16 a[180:181], v225 offset:40960
ds_read_b64_tr_b16 a[182:183], v225 offset:45056
v_mfma_f32_16x16x32_bf16 v[28:31], a[144:147], v[184:187], v[144:147]
v_exp_f32 v66, v66
v_mfma_f32_16x16x32_bf16 v[28:31], a[148:151], v[188:191], v[28:31]
buffer_load_dwordx4 v232, s[12:15], s39 offen offset:2048 lds
v_mfma_f32_16x16x32_bf16 v[28:31], a[152:155], v[192:195], v[28:31]
v_exp_f32 v67, v67
v_mfma_f32_16x16x32_bf16 v[28:31], a[156:159], v[196:199], v[28:31]
v_cvt_pk_bf16_f32 v100, v64, v65
v_cvt_pk_bf16_f32 v101, v66, v67
v_mfma_f32_16x16x32_bf16 a[24:27], a[184:187], v[72:75], a[24:27]
v_exp_f32 v68, v68
v_mfma_f32_16x16x32_bf16 a[56:59], a[184:187], v[76:79], a[56:59]
v_lshlrev_b32 v124, 16, v110
v_and_b32 v125, 0xffff0000, v110
v_mfma_f32_16x16x32_bf16 a[88:91], a[184:187], v[80:83], a[88:91]
v_exp_f32 v69, v69
v_mfma_f32_16x16x32_bf16 a[120:123], a[184:187], v[84:87], a[120:123]
ds_read_b64_tr_b16 a[184:185], v226 offset:40960
ds_read_b64_tr_b16 a[186:187], v226 offset:45056
v_mfma_f32_16x16x32_bf16 v[36:39], a[144:147], v[200:203], v[148:151]
v_exp_f32 v70, v70
v_mfma_f32_16x16x32_bf16 v[36:39], a[148:151], v[204:207], v[36:39]
ds_read_b128 a[144:147], v216 offset:28672
ds_read_b128 a[148:151], v217 offset:28672
v_mfma_f32_16x16x32_bf16 v[36:39], a[152:155], v[208:211], v[36:39]
v_exp_f32 v71, v71
v_mfma_f32_16x16x32_bf16 v[36:39], a[156:159], v[212:215], v[36:39]
s_waitcnt lgkmcnt(4)
ds_read_b128 a[152:155], v218 offset:28672
ds_read_b128 a[156:159], v219 offset:28672
v_mfma_f32_16x16x32_bf16 a[28:31], a[188:191], v[72:75], a[28:31]
v_cvt_pk_bf16_f32 v102, v68, v69
v_cvt_pk_bf16_f32 v103, v70, v71
v_mfma_f32_16x16x32_bf16 a[60:63], a[188:191], v[76:79], a[60:63]
v_lshlrev_b32 v126, 16, v111
v_and_b32 v127, 0xffff0000, v111
v_mfma_f32_16x16x32_bf16 a[92:95], a[188:191], v[80:83], a[92:95]
v_mul_f32 v112, v112, v120
v_mul_f32 v113, v113, v121
v_mfma_f32_16x16x32_bf16 a[124:127], a[188:191], v[84:87], a[124:127]
ds_read_b64_tr_b16 a[188:189], v227 offset:40960
ds_read_b64_tr_b16 a[190:191], v227 offset:45056
v_mfma_f32_16x16x32_bf16 v[40:43], a[128:131], v[152:155], v[136:139]
v_exp_f32 v8, v8
v_mfma_f32_16x16x32_bf16 v[40:43], a[132:135], v[156:159], v[40:43]
v_exp_f32 v9, v9
v_mfma_f32_16x16x32_bf16 v[40:43], a[136:139], v[160:163], v[40:43]
buffer_load_dwordx4 v233, s[12:15], s39 offen offset:3072 lds
v_mfma_f32_16x16x32_bf16 v[40:43], a[140:143], v[164:167], v[40:43]
v_exp_f32 v10, v10
v_mfma_f32_16x16x32_bf16 a[0:3], a[160:163], v[88:91], a[0:3]
v_cvt_pk_bf16_f32 v72, v8, v9
v_mul_f32 v114, v114, v122
v_mfma_f32_16x16x32_bf16 a[32:35], a[160:163], v[92:95], a[32:35]
v_exp_f32 v11, v11
v_mfma_f32_16x16x32_bf16 a[64:67], a[160:163], v[96:99], a[64:67]
v_cvt_pk_bf16_f32 v73, v10, v11
v_mul_f32 v115, v115, v123
v_mfma_f32_16x16x32_bf16 a[96:99], a[160:163], v[100:103], a[96:99]
v_exp_f32 v12, v12
v_mfma_f32_16x16x32_bf16 v[48:51], a[128:131], v[168:171], v[140:143]
ds_read_b64_tr_b16 a[160:161], v220 offset:49152
ds_read_b64_tr_b16 a[162:163], v220 offset:53248
v_mfma_f32_16x16x32_bf16 v[48:51], a[132:135], v[172:175], v[48:51]
v_exp_f32 v13, v13
v_mfma_f32_16x16x32_bf16 v[48:51], a[136:139], v[176:179], v[48:51]
v_cvt_pk_bf16_f32 v74, v12, v13
v_mul_f32 v116, v116, v124
v_mfma_f32_16x16x32_bf16 v[48:51], a[140:143], v[180:183], v[48:51]
v_exp_f32 v14, v14
v_mfma_f32_16x16x32_bf16 a[4:7], a[164:167], v[88:91], a[4:7]
v_mul_f32 v117, v117, v125
v_mul_f32 v118, v118, v126
v_mfma_f32_16x16x32_bf16 a[36:39], a[164:167], v[92:95], a[36:39]
s_add_u32 s39, s39, 16384
v_exp_f32 v15, v15
v_mfma_f32_16x16x32_bf16 a[68:71], a[164:167], v[96:99], a[68:71]
s_add_u32 m0, s37, 32768
v_cvt_pk_bf16_f32 v75, v14, v15
v_mul_f32 v119, v119, v127
v_mfma_f32_16x16x32_bf16 a[100:103], a[164:167], v[100:103], a[100:103]
v_exp_f32 v16, v16
v_smfmac_f32_16x16x64_bf16 a[248:251], a[208:211], v[88:95], v235
buffer_load_dwordx4 v228, s[8:11], s38 offen offset:0 lds
v_mfma_f32_16x16x32_bf16 v[56:59], a[128:131], v[184:187], v[144:147]
v_exp_f32 v17, v17
v_mfma_f32_16x16x32_bf16 v[56:59], a[132:135], v[188:191], v[56:59]
ds_read_b64_tr_b16 a[164:165], v221 offset:49152
ds_read_b64_tr_b16 a[166:167], v221 offset:53248
v_mfma_f32_16x16x32_bf16 v[56:59], a[136:139], v[192:195], v[56:59]
v_exp_f32 v18, v18
v_mfma_f32_16x16x32_bf16 v[56:59], a[140:143], v[196:199], v[56:59]
v_cvt_pk_bf16_f32 v76, v16, v17
v_cvt_pk_bf16_f32 v244, v112, v113
v_mfma_f32_16x16x32_bf16 a[8:11], a[168:171], v[88:91], a[8:11]
v_exp_f32 v19, v19
v_mfma_f32_16x16x32_bf16 a[40:43], a[168:171], v[92:95], a[40:43]
v_cvt_pk_bf16_f32 v77, v18, v19
v_cvt_pk_bf16_f32 v245, v114, v115
v_mfma_f32_16x16x32_bf16 a[72:75], a[168:171], v[96:99], a[72:75]
v_exp_f32 v20, v20
v_mfma_f32_16x16x32_bf16 a[104:107], a[168:171], v[100:103], a[104:107]
ds_read_b64_tr_b16 a[168:169], v222 offset:49152
ds_read_b64_tr_b16 a[170:171], v222 offset:53248
v_mfma_f32_16x16x32_bf16 v[64:67], a[128:131], v[200:203], v[148:151]
v_exp_f32 v21, v21
v_mfma_f32_16x16x32_bf16 v[64:67], a[132:135], v[204:207], v[64:67]
buffer_load_dwordx4 v229, s[8:11], s38 offen offset:1024 lds
v_mfma_f32_16x16x32_bf16 v[64:67], a[136:139], v[208:211], v[64:67]
v_exp_f32 v22, v22
v_mfma_f32_16x16x32_bf16 v[64:67], a[140:143], v[212:215], v[64:67]
ds_read_b128 a[128:131], v216 offset:0
ds_read_b128 a[132:135], v217 offset:0
v_mfma_f32_16x16x32_bf16 a[12:15], a[172:175], v[88:91], a[12:15]
v_exp_f32 v23, v23
v_mfma_f32_16x16x32_bf16 a[44:47], a[172:175], v[92:95], a[44:47]
ds_read_b128 a[136:139], v218 offset:0
ds_read_b128 a[140:143], v219 offset:0
v_mfma_f32_16x16x32_bf16 a[76:79], a[172:175], v[96:99], a[76:79]
v_exp_f32 v24, v24
v_mfma_f32_16x16x32_bf16 a[108:111], a[172:175], v[100:103], a[108:111]
s_waitcnt lgkmcnt(6)
v_exp_f32 v25, v25
v_mfma_f32_16x16x32_bf16 v[44:47], a[144:147], v[152:155], v[136:139]
ds_read_b64_tr_b16 a[172:173], v223 offset:49152
ds_read_b64_tr_b16 a[174:175], v223 offset:53248
v_mfma_f32_16x16x32_bf16 v[44:47], a[148:151], v[156:159], v[44:47]
v_exp_f32 v26, v26
v_mfma_f32_16x16x32_bf16 v[44:47], a[152:155], v[160:163], v[44:47]
v_cvt_pk_bf16_f32 v78, v20, v21
v_cvt_pk_bf16_f32 v79, v22, v23
v_mfma_f32_16x16x32_bf16 v[44:47], a[156:159], v[164:167], v[44:47]
v_exp_f32 v27, v27
v_mfma_f32_16x16x32_bf16 a[16:19], a[176:179], v[88:91], a[16:19]
v_cvt_pk_bf16_f32 v80, v24, v25
v_cvt_pk_bf16_f32 v81, v26, v27
v_mfma_f32_16x16x32_bf16 a[48:51], a[176:179], v[92:95], a[48:51]
v_exp_f32 v28, v28
v_mfma_f32_16x16x32_bf16 a[80:83], a[176:179], v[96:99], a[80:83]
buffer_load_dwordx4 v230, s[8:11], s38 offen offset:2048 lds
v_mfma_f32_16x16x32_bf16 a[112:115], a[176:179], v[100:103], a[112:115]
v_exp_f32 v29, v29
v_mfma_f32_16x16x32_bf16 v[52:55], a[144:147], v[168:171], v[140:143]
ds_read_b64_tr_b16 a[176:177], v224 offset:49152
ds_read_b64_tr_b16 a[178:179], v224 offset:53248
v_mfma_f32_16x16x32_bf16 v[52:55], a[148:151], v[172:175], v[52:55]
v_exp_f32 v30, v30
v_mfma_f32_16x16x32_bf16 v[52:55], a[152:155], v[176:179], v[52:55]
v_cvt_pk_bf16_f32 v82, v28, v29
v_cvt_pk_bf16_f32 v246, v116, v117
v_mfma_f32_16x16x32_bf16 v[52:55], a[156:159], v[180:183], v[52:55]
v_exp_f32 v31, v31
v_mfma_f32_16x16x32_bf16 a[20:23], a[180:183], v[88:91], a[20:23]
v_cvt_pk_bf16_f32 v83, v30, v31
v_cvt_pk_bf16_f32 v247, v118, v119
v_mfma_f32_16x16x32_bf16 a[52:55], a[180:183], v[92:95], a[52:55]
v_exp_f32 v32, v32
v_mfma_f32_16x16x32_bf16 a[84:87], a[180:183], v[96:99], a[84:87]
s_waitcnt vmcnt(15)
ds_read_b64_tr_b16 a[194:195], v128
ds_read_b64_tr_b16 a[198:199], v129
v_mfma_f32_16x16x32_bf16 a[116:119], a[180:183], v[100:103], a[116:119]
v_exp_f32 v33, v33
v_smfmac_f32_16x16x64_bf16 a[252:255], a[208:211], v[96:103], v235
ds_read_b64_tr_b16 a[180:181], v225 offset:49152
ds_read_b64_tr_b16 a[182:183], v225 offset:53248
v_mfma_f32_16x16x32_bf16 v[60:63], a[144:147], v[184:187], v[144:147]
v_exp_f32 v34, v34
v_mfma_f32_16x16x32_bf16 v[60:63], a[148:151], v[188:191], v[60:63]
buffer_load_dwordx4 v231, s[8:11], s38 offen offset:3072 lds
v_mfma_f32_16x16x32_bf16 v[60:63], a[152:155], v[192:195], v[60:63]
v_exp_f32 v35, v35
v_mfma_f32_16x16x32_bf16 v[60:63], a[156:159], v[196:199], v[60:63]
v_cvt_pk_bf16_f32 v84, v32, v33
v_cvt_pk_bf16_f32 v85, v34, v35
v_mfma_f32_16x16x32_bf16 a[24:27], a[184:187], v[88:91], a[24:27]
v_exp_f32 v36, v36
v_mfma_f32_16x16x32_bf16 a[56:59], a[184:187], v[92:95], a[56:59]
ds_read_b64_tr_b16 a[202:203], v130
ds_read_b64_tr_b16 a[206:207], v131
v_mfma_f32_16x16x32_bf16 a[88:91], a[184:187], v[96:99], a[88:91]
v_exp_f32 v37, v37
v_mfma_f32_16x16x32_bf16 a[120:123], a[184:187], v[100:103], a[120:123]
ds_read_b64_tr_b16 a[184:185], v226 offset:49152
ds_read_b64_tr_b16 a[186:187], v226 offset:53248
v_mfma_f32_16x16x32_bf16 v[68:71], a[144:147], v[200:203], v[148:151]
v_exp_f32 v38, v38
v_mfma_f32_16x16x32_bf16 v[68:71], a[148:151], v[204:207], v[68:71]
ds_read_b128 a[144:147], v216 offset:4096
ds_read_b128 a[148:151], v217 offset:4096
v_mfma_f32_16x16x32_bf16 v[68:71], a[152:155], v[208:211], v[68:71]
v_exp_f32 v39, v39
v_mfma_f32_16x16x32_bf16 v[68:71], a[156:159], v[212:215], v[68:71]
ds_read_b128 a[152:155], v218 offset:4096
ds_read_b128 a[156:159], v219 offset:4096
v_mfma_f32_16x16x32_bf16 a[28:31], a[188:191], v[88:91], a[28:31]
v_cvt_pk_bf16_f32 v86, v36, v37
v_cvt_pk_bf16_f32 v87, v38, v39
v_mfma_f32_16x16x32_bf16 a[60:63], a[188:191], v[92:95], a[60:63]
s_add_u32 s38, s38, 16384
ds_read_b64_tr_b16 a[214:215], v132
ds_read_b64_tr_b16 a[218:219], v133
v_mfma_f32_16x16x32_bf16 a[92:95], a[188:191], v[96:99], a[92:95]
ds_read_b64_tr_b16 a[222:223], v134
ds_read_b64_tr_b16 a[226:227], v135
v_mfma_f32_16x16x32_bf16 a[124:127], a[188:191], v[100:103], a[124:127]
s_waitcnt lgkmcnt(10)
ds_read_b64_tr_b16 a[188:189], v227 offset:49152
ds_read_b64_tr_b16 a[190:191], v227 offset:53248
v_mfma_f32_16x16x32_bf16 v[8:11], a[128:131], v[152:155], v[136:139]
s_mov_b32 s40, 6
v_exp_f32 v40, v40
v_mfma_f32_16x16x32_bf16 v[8:11], a[132:135], v[156:159], v[8:11]
s_cmp_eq_u32 s32, 0
s_cselect_b32 s74, 0x180, s74
buffer_load_dwordx2 v[252:253], v251, s[76:79], s42 offen sc1
v_mfma_f32_16x16x32_bf16 v[8:11], a[136:139], v[160:163], v[8:11]
s_add_u32 s52, s52, 1
v_exp_f32 v41, v41
v_mfma_f32_16x16x32_bf16 v[8:11], a[140:143], v[164:167], v[8:11]
v_cvt_pk_bf16_f32 v88, v40, v41
v_mfma_f32_16x16x32_bf16 a[0:3], a[160:163], v[72:75], a[0:3]
v_exp_f32 v42, v42
v_mfma_f32_16x16x32_bf16 a[32:35], a[160:163], v[76:79], a[32:35]
v_mfma_f32_16x16x32_bf16 a[64:67], a[160:163], v[80:83], a[64:67]
s_add_u32 s42, s42, s43
v_exp_f32 v43, v43
v_mfma_f32_16x16x32_bf16 a[96:99], a[160:163], v[84:87], a[96:99]
buffer_load_dword v255, v243, s[28:31], s45 offen
v_mfma_f32_16x16x32_bf16 a[228:231], a[232:235], v[244:247], 0
v_exp_f32 v44, v44
v_mfma_f32_16x16x32_bf16 v[104:107], a[192:195], v[244:247], 0
ds_read_b64_tr_b16 a[160:161], v220 offset:57344
ds_read_b64_tr_b16 a[162:163], v220 offset:61440
v_mfma_f32_16x16x32_bf16 v[108:111], a[196:199], v[244:247], 0
v_cvt_pk_bf16_f32 v89, v42, v43
v_mfma_f32_16x16x32_bf16 v[112:115], a[200:203], v[244:247], 0
s_add_u32 s45, s45, 589824
v_exp_f32 v45, v45
v_mfma_f32_16x16x32_bf16 v[116:119], a[204:207], v[244:247], 0
global_load_dword v255, v242, s[72:73]
v_mfma_f32_16x16x32_bf16 v[16:19], a[128:131], v[168:171], v[140:143]
v_exp_f32 v46, v46
v_mfma_f32_16x16x32_bf16 v[16:19], a[132:135], v[172:175], v[16:19]
v_cvt_pk_bf16_f32 v90, v44, v45
v_mfma_f32_16x16x32_bf16 v[16:19], a[136:139], v[176:179], v[16:19]
v_exp_f32 v47, v47
v_mfma_f32_16x16x32_bf16 v[16:19], a[140:143], v[180:183], v[16:19]
v_cvt_pk_bf16_f32 v91, v46, v47
v_mfma_f32_16x16x32_bf16 a[4:7], a[164:167], v[72:75], a[4:7]
v_exp_f32 v48, v48
v_mfma_f32_16x16x32_bf16 a[36:39], a[164:167], v[76:79], a[36:39]
buffer_load_dword v255, v0, s[24:27], s44 offen sc1
v_mfma_f32_16x16x32_bf16 a[68:71], a[164:167], v[80:83], a[68:71]
v_exp_f32 v49, v49
v_mfma_f32_16x16x32_bf16 a[100:103], a[164:167], v[84:87], a[100:103]
ds_read_b64_tr_b16 a[164:165], v221 offset:57344
ds_read_b64_tr_b16 a[166:167], v221 offset:61440
v_smfmac_f32_16x16x64_bf16 a[248:251], a[208:211], v[72:79], v235
s_waitcnt lgkmcnt(2)
v_cvt_pk_bf16_f32 v92, v48, v49
v_mfma_f32_16x16x32_bf16 v[120:123], a[212:215], v[244:247], 0
s_add_u32 s44, s44, 8192
v_exp_f32 v50, v50
v_mfma_f32_16x16x32_bf16 v[124:127], a[216:219], v[244:247], 0
buffer_store_dwordx4 a[228:231], v248, s[20:23], s92 offen sc0 sc1
v_mfma_f32_16x16x32_bf16 v[128:131], a[220:223], v[244:247], 0
v_exp_f32 v51, v51
v_mfma_f32_16x16x32_bf16 v[132:135], a[224:227], v[244:247], 0
v_cvt_pk_bf16_f32 v93, v50, v51
v_mfma_f32_16x16x32_bf16 v[24:27], a[128:131], v[184:187], v[144:147]
v_exp_f32 v52, v52
v_mfma_f32_16x16x32_bf16 v[24:27], a[132:135], v[188:191], v[24:27]
v_mfma_f32_16x16x32_bf16 v[24:27], a[136:139], v[192:195], v[24:27]
s_add_u32 s48, s90, 0
v_exp_f32 v53, v53
v_mfma_f32_16x16x32_bf16 v[24:27], a[140:143], v[196:199], v[24:27]
buffer_store_dwordx4 v[104:107], v248, s[20:23], s48 offen sc0 sc1
v_mfma_f32_16x16x32_bf16 a[8:11], a[168:171], v[72:75], a[8:11]
v_cvt_pk_bf16_f32 v94, v52, v53
v_mfma_f32_16x16x32_bf16 a[40:43], a[168:171], v[76:79], a[40:43]
v_exp_f32 v54, v54
v_mfma_f32_16x16x32_bf16 a[72:75], a[168:171], v[80:83], a[72:75]
v_mfma_f32_16x16x32_bf16 a[104:107], a[168:171], v[84:87], a[104:107]
s_add_u32 s48, s90, 74240
v_exp_f32 v55, v55
v_mfma_f32_16x16x32_bf16 v[32:35], a[128:131], v[200:203], v[148:151]
buffer_store_dwordx4 v[108:111], v248, s[20:23], s48 offen sc0 sc1
v_mfma_f32_16x16x32_bf16 v[32:35], a[132:135], v[204:207], v[32:35]
v_exp_f32 v56, v56
v_mfma_f32_16x16x32_bf16 v[32:35], a[136:139], v[208:211], v[32:35]
ds_read_b64_tr_b16 a[168:169], v222 offset:57344
ds_read_b64_tr_b16 a[170:171], v222 offset:61440
v_mfma_f32_16x16x32_bf16 v[32:35], a[140:143], v[212:215], v[32:35]
v_exp_f32 v57, v57
v_mfma_f32_16x16x32_bf16 a[12:15], a[172:175], v[72:75], a[12:15]
ds_read_b128 a[128:131], v216 offset:8192
ds_read_b128 a[132:135], v217 offset:8192
v_mfma_f32_16x16x32_bf16 a[44:47], a[172:175], v[76:79], a[44:47]
s_add_u32 s48, s90, 148480
v_exp_f32 v58, v58
v_mfma_f32_16x16x32_bf16 a[76:79], a[172:175], v[80:83], a[76:79]
buffer_store_dwordx4 v[112:115], v248, s[20:23], s48 offen sc0 sc1
v_mfma_f32_16x16x32_bf16 a[108:111], a[172:175], v[84:87], a[108:111]
ds_read_b128 a[136:139], v218 offset:8192
ds_read_b128 a[140:143], v219 offset:8192
v_mfma_f32_16x16x32_bf16 v[12:15], a[144:147], v[152:155], v[136:139]
v_exp_f32 v59, v59
v_mfma_f32_16x16x32_bf16 v[12:15], a[148:151], v[156:159], v[12:15]
ds_read_b64_tr_b16 a[172:173], v223 offset:57344
ds_read_b64_tr_b16 a[174:175], v223 offset:61440
v_mfma_f32_16x16x32_bf16 v[12:15], a[152:155], v[160:163], v[12:15]
s_add_u32 s48, s90, 222720
v_exp_f32 v60, v60
v_mfma_f32_16x16x32_bf16 v[12:15], a[156:159], v[164:167], v[12:15]
buffer_store_dwordx4 v[116:119], v248, s[20:23], s48 offen sc0 sc1
v_mfma_f32_16x16x32_bf16 a[16:19], a[176:179], v[72:75], a[16:19]
v_exp_f32 v61, v61
v_mfma_f32_16x16x32_bf16 a[48:51], a[176:179], v[76:79], a[48:51]
v_cvt_pk_bf16_f32 v95, v54, v55
v_cvt_pk_bf16_f32 v96, v56, v57
v_mfma_f32_16x16x32_bf16 a[80:83], a[176:179], v[80:83], a[80:83]
v_exp_f32 v62, v62
v_mfma_f32_16x16x32_bf16 a[112:115], a[176:179], v[84:87], a[112:115]
ds_read_b64_tr_b16 a[176:177], v224 offset:57344
ds_read_b64_tr_b16 a[178:179], v224 offset:61440
v_mfma_f32_16x16x32_bf16 v[20:23], a[144:147], v[168:171], v[140:143]
s_add_u32 s48, s90, 296960
buffer_store_dwordx4 v[120:123], v248, s[20:23], s48 offen sc0 sc1
v_mfma_f32_16x16x32_bf16 v[20:23], a[148:151], v[172:175], v[20:23]
v_exp_f32 v63, v63
v_mfma_f32_16x16x32_bf16 v[20:23], a[152:155], v[176:179], v[20:23]
v_cvt_pk_bf16_f32 v97, v58, v59
v_cvt_pk_bf16_f32 v98, v60, v61
v_mfma_f32_16x16x32_bf16 v[20:23], a[156:159], v[180:183], v[20:23]
v_exp_f32 v64, v64
v_mfma_f32_16x16x32_bf16 a[20:23], a[180:183], v[72:75], a[20:23]
v_cvt_pk_bf16_f32 v99, v62, v63
v_mfma_f32_16x16x32_bf16 a[52:55], a[180:183], v[76:79], a[52:55]
s_add_u32 s48, s90, 371200
v_exp_f32 v65, v65
v_mfma_f32_16x16x32_bf16 a[84:87], a[180:183], v[80:83], a[84:87]
buffer_store_dwordx4 v[124:127], v248, s[20:23], s48 offen sc0 sc1
v_mfma_f32_16x16x32_bf16 a[116:119], a[180:183], v[84:87], a[116:119]
v_exp_f32 v66, v66
v_smfmac_f32_16x16x64_bf16 a[252:255], a[208:211], v[80:87], v235
ds_read_b64_tr_b16 a[180:181], v225 offset:57344
ds_read_b64_tr_b16 a[182:183], v225 offset:61440
v_mfma_f32_16x16x32_bf16 v[28:31], a[144:147], v[184:187], v[144:147]
v_exp_f32 v67, v67
v_mfma_f32_16x16x32_bf16 v[28:31], a[148:151], v[188:191], v[28:31]
v_cvt_pk_bf16_f32 v100, v64, v65
v_cvt_pk_bf16_f32 v101, v66, v67
v_mfma_f32_16x16x32_bf16 v[28:31], a[152:155], v[192:195], v[28:31]
s_add_u32 s48, s90, 445440
buffer_store_dwordx4 v[128:131], v248, s[20:23], s48 offen sc0 sc1
v_mfma_f32_16x16x32_bf16 v[28:31], a[156:159], v[196:199], v[28:31]
v_exp_f32 v68, v68
v_mfma_f32_16x16x32_bf16 a[24:27], a[184:187], v[72:75], a[24:27]
v_mfma_f32_16x16x32_bf16 a[56:59], a[184:187], v[76:79], a[56:59]
v_exp_f32 v69, v69
v_mfma_f32_16x16x32_bf16 a[88:91], a[184:187], v[80:83], a[88:91]
v_cvt_pk_bf16_f32 v102, v68, v69
v_mfma_f32_16x16x32_bf16 a[120:123], a[184:187], v[84:87], a[120:123]
s_add_u32 s48, s90, 519680
v_exp_f32 v70, v70
v_mfma_f32_16x16x32_bf16 v[36:39], a[144:147], v[200:203], v[148:151]
buffer_store_dwordx4 v[132:135], v248, s[20:23], s48 offen sc0 sc1
v_mfma_f32_16x16x32_bf16 v[36:39], a[148:151], v[204:207], v[36:39]
v_exp_f32 v71, v71
v_mfma_f32_16x16x32_bf16 v[36:39], a[152:155], v[208:211], v[36:39]
ds_read_b64_tr_b16 a[184:185], v226 offset:57344
ds_read_b64_tr_b16 a[186:187], v226 offset:61440
v_mfma_f32_16x16x32_bf16 v[36:39], a[156:159], v[212:215], v[36:39]
ds_read_b128 a[144:147], v216 offset:12288
ds_read_b128 a[148:151], v217 offset:12288
v_mfma_f32_16x16x32_bf16 a[28:31], a[188:191], v[72:75], a[28:31]
ds_read_b128 a[152:155], v218 offset:12288
ds_read_b128 a[156:159], v219 offset:12288
v_mfma_f32_16x16x32_bf16 a[60:63], a[188:191], v[76:79], a[60:63]
v_cvt_pk_bf16_f32 v103, v70, v71
v_mfma_f32_16x16x32_bf16 a[92:95], a[188:191], v[80:83], a[92:95]
v_mfma_f32_16x16x32_bf16 a[124:127], a[188:191], v[84:87], a[124:127]
s_waitcnt lgkmcnt(6)
ds_read_b64_tr_b16 a[188:189], v227 offset:57344
ds_read_b64_tr_b16 a[190:191], v227 offset:61440
v_mfma_f32_16x16x32_bf16 v[40:43], a[128:131], v[152:155], v[136:139]
v_exp_f32 v8, v8
v_mfma_f32_16x16x32_bf16 v[40:43], a[132:135], v[156:159], v[40:43]
v_exp_f32 v9, v9
v_mfma_f32_16x16x32_bf16 v[40:43], a[136:139], v[160:163], v[40:43]
v_cvt_pk_bf16_f32 v72, v8, v9
v_mfma_f32_16x16x32_bf16 v[40:43], a[140:143], v[164:167], v[40:43]
v_exp_f32 v10, v10
v_mfma_f32_16x16x32_bf16 a[0:3], a[160:163], v[88:91], a[0:3]
v_mfma_f32_16x16x32_bf16 a[32:35], a[160:163], v[92:95], a[32:35]
v_exp_f32 v11, v11
s_waitcnt vmcnt(13) lgkmcnt(0)
s_barrier
v_mfma_f32_16x16x32_bf16 a[64:67], a[160:163], v[96:99], a[64:67]
v_cvt_pk_bf16_f32 v73, v10, v11
v_mfma_f32_16x16x32_bf16 a[96:99], a[160:163], v[100:103], a[96:99]
s_add_u32 m0, s37, 98304
v_exp_f32 v12, v12
v_mfma_f32_16x16x32_bf16 v[48:51], a[128:131], v[168:171], v[140:143]
buffer_load_dwordx4 v232, s[12:15], s39 offen offset:0 lds
v_mfma_f32_16x16x32_bf16 v[48:51], a[132:135], v[172:175], v[48:51]
v_exp_f32 v13, v13
v_mfma_f32_16x16x32_bf16 v[48:51], a[136:139], v[176:179], v[48:51]
ds_read_b64_tr_b16 a[160:161], v220 offset:0
ds_read_b64_tr_b16 a[162:163], v220 offset:4096
v_mfma_f32_16x16x32_bf16 v[48:51], a[140:143], v[180:183], v[48:51]
v_exp_f32 v14, v14
v_mfma_f32_16x16x32_bf16 a[4:7], a[164:167], v[88:91], a[4:7]
v_cvt_pk_bf16_f32 v74, v12, v13
v_mfma_f32_16x16x32_bf16 a[36:39], a[164:167], v[92:95], a[36:39]
v_exp_f32 v15, v15
v_mfma_f32_16x16x32_bf16 a[68:71], a[164:167], v[96:99], a[68:71]
v_cvt_pk_bf16_f32 v75, v14, v15
v_mfma_f32_16x16x32_bf16 a[100:103], a[164:167], v[100:103], a[100:103]
v_exp_f32 v16, v16
v_smfmac_f32_16x16x64_bf16 a[248:251], a[208:211], v[88:95], v235
buffer_load_dwordx4 v233, s[12:15], s39 offen offset:1024 lds
v_mfma_f32_16x16x32_bf16 v[56:59], a[128:131], v[184:187], v[144:147]
v_exp_f32 v17, v17
v_mfma_f32_16x16x32_bf16 v[56:59], a[132:135], v[188:191], v[56:59]
ds_read_b64_tr_b16 a[164:165], v221 offset:0
ds_read_b64_tr_b16 a[166:167], v221 offset:4096
v_mfma_f32_16x16x32_bf16 v[56:59], a[136:139], v[192:195], v[56:59]
v_exp_f32 v18, v18
v_mfma_f32_16x16x32_bf16 v[56:59], a[140:143], v[196:199], v[56:59]
v_cvt_pk_bf16_f32 v76, v16, v17
v_mfma_f32_16x16x32_bf16 a[8:11], a[168:171], v[88:91], a[8:11]
v_exp_f32 v19, v19
v_mfma_f32_16x16x32_bf16 a[40:43], a[168:171], v[92:95], a[40:43]
v_cvt_pk_bf16_f32 v77, v18, v19
v_mfma_f32_16x16x32_bf16 a[72:75], a[168:171], v[96:99], a[72:75]
v_exp_f32 v20, v20
v_mfma_f32_16x16x32_bf16 a[104:107], a[168:171], v[100:103], a[104:107]
ds_read_b64_tr_b16 a[168:169], v222 offset:0
ds_read_b64_tr_b16 a[170:171], v222 offset:4096
v_mfma_f32_16x16x32_bf16 v[64:67], a[128:131], v[200:203], v[148:151]
v_exp_f32 v21, v21
v_mfma_f32_16x16x32_bf16 v[64:67], a[132:135], v[204:207], v[64:67]
buffer_load_dwordx4 v232, s[12:15], s39 offen offset:2048 lds
v_mfma_f32_16x16x32_bf16 v[64:67], a[136:139], v[208:211], v[64:67]
v_exp_f32 v22, v22
v_mfma_f32_16x16x32_bf16 v[64:67], a[140:143], v[212:215], v[64:67]
ds_read_b128 a[128:131], v216 offset:49152
ds_read_b128 a[132:135], v217 offset:49152
v_mfma_f32_16x16x32_bf16 a[12:15], a[172:175], v[88:91], a[12:15]
v_exp_f32 v23, v23
v_mfma_f32_16x16x32_bf16 a[44:47], a[172:175], v[92:95], a[44:47]
ds_read_b128 a[136:139], v218 offset:49152
ds_read_b128 a[140:143], v219 offset:49152
v_mfma_f32_16x16x32_bf16 a[76:79], a[172:175], v[96:99], a[76:79]
v_exp_f32 v24, v24
v_mfma_f32_16x16x32_bf16 a[108:111], a[172:175], v[100:103], a[108:111]
v_exp_f32 v25, v25
v_mfma_f32_16x16x32_bf16 v[44:47], a[144:147], v[152:155], v[136:139]
ds_read_b64_tr_b16 a[172:173], v223 offset:0
ds_read_b64_tr_b16 a[174:175], v223 offset:4096
v_mfma_f32_16x16x32_bf16 v[44:47], a[148:151], v[156:159], v[44:47]
v_exp_f32 v26, v26
v_mfma_f32_16x16x32_bf16 v[44:47], a[152:155], v[160:163], v[44:47]
buffer_load_dwordx4 v233, s[12:15], s39 offen offset:3072 lds
v_mfma_f32_16x16x32_bf16 v[44:47], a[156:159], v[164:167], v[44:47]
v_exp_f32 v27, v27
v_mfma_f32_16x16x32_bf16 a[16:19], a[176:179], v[88:91], a[16:19]
v_cvt_pk_bf16_f32 v78, v20, v21
v_cvt_pk_bf16_f32 v79, v22, v23
v_mfma_f32_16x16x32_bf16 a[48:51], a[176:179], v[92:95], a[48:51]
v_exp_f32 v28, v28
v_mfma_f32_16x16x32_bf16 a[80:83], a[176:179], v[96:99], a[80:83]
v_cvt_pk_bf16_f32 v80, v24, v25
v_cvt_pk_bf16_f32 v81, v26, v27
v_mfma_f32_16x16x32_bf16 a[112:115], a[176:179], v[100:103], a[112:115]
v_exp_f32 v29, v29
v_mfma_f32_16x16x32_bf16 v[52:55], a[144:147], v[168:171], v[140:143]
ds_read_b64_tr_b16 a[176:177], v224 offset:0
ds_read_b64_tr_b16 a[178:179], v224 offset:4096
v_mfma_f32_16x16x32_bf16 v[52:55], a[148:151], v[172:175], v[52:55]
v_exp_f32 v30, v30
v_mfma_f32_16x16x32_bf16 v[52:55], a[152:155], v[176:179], v[52:55]
v_cvt_pk_bf16_f32 v82, v28, v29
v_mfma_f32_16x16x32_bf16 v[52:55], a[156:159], v[180:183], v[52:55]
s_add_u32 s39, s39, 16384
v_exp_f32 v31, v31
v_mfma_f32_16x16x32_bf16 a[20:23], a[180:183], v[88:91], a[20:23]
s_add_u32 m0, s37, 16384
v_cvt_pk_bf16_f32 v83, v30, v31
v_mfma_f32_16x16x32_bf16 a[52:55], a[180:183], v[92:95], a[52:55]
v_exp_f32 v32, v32
v_mfma_f32_16x16x32_bf16 a[84:87], a[180:183], v[96:99], a[84:87]
buffer_load_dwordx4 v228, s[8:11], s38 offen offset:0 lds
v_mfma_f32_16x16x32_bf16 a[116:119], a[180:183], v[100:103], a[116:119]
v_exp_f32 v33, v33
v_smfmac_f32_16x16x64_bf16 a[252:255], a[208:211], v[96:103], v235
ds_read_b64_tr_b16 a[180:181], v225 offset:0
ds_read_b64_tr_b16 a[182:183], v225 offset:4096
v_mfma_f32_16x16x32_bf16 v[60:63], a[144:147], v[184:187], v[144:147]
v_exp_f32 v34, v34
v_mfma_f32_16x16x32_bf16 v[60:63], a[148:151], v[188:191], v[60:63]
v_cvt_pk_bf16_f32 v84, v32, v33
v_mfma_f32_16x16x32_bf16 v[60:63], a[152:155], v[192:195], v[60:63]
v_exp_f32 v35, v35
v_mfma_f32_16x16x32_bf16 v[60:63], a[156:159], v[196:199], v[60:63]
buffer_load_dwordx4 v229, s[8:11], s38 offen offset:1024 lds
v_mfma_f32_16x16x32_bf16 a[24:27], a[184:187], v[88:91], a[24:27]
v_exp_f32 v36, v36
v_mfma_f32_16x16x32_bf16 a[56:59], a[184:187], v[92:95], a[56:59]
v_cvt_pk_bf16_f32 v85, v34, v35
v_mfma_f32_16x16x32_bf16 a[88:91], a[184:187], v[96:99], a[88:91]
v_exp_f32 v37, v37
v_mfma_f32_16x16x32_bf16 a[120:123], a[184:187], v[100:103], a[120:123]
ds_read_b64_tr_b16 a[184:185], v226 offset:0
ds_read_b64_tr_b16 a[186:187], v226 offset:4096
v_mfma_f32_16x16x32_bf16 v[68:71], a[144:147], v[200:203], v[148:151]
v_exp_f32 v38, v38
v_mfma_f32_16x16x32_bf16 v[68:71], a[148:151], v[204:207], v[68:71]
ds_read_b128 a[144:147], v216 offset:53248
ds_read_b128 a[148:151], v217 offset:53248
v_mfma_f32_16x16x32_bf16 v[68:71], a[152:155], v[208:211], v[68:71]
v_exp_f32 v39, v39
v_mfma_f32_16x16x32_bf16 v[68:71], a[156:159], v[212:215], v[68:71]
ds_read_b128 a[152:155], v218 offset:53248
ds_read_b128 a[156:159], v219 offset:53248
v_mfma_f32_16x16x32_bf16 a[28:31], a[188:191], v[88:91], a[28:31]
v_cvt_pk_bf16_f32 v86, v36, v37
v_cvt_pk_bf16_f32 v87, v38, v39
v_mfma_f32_16x16x32_bf16 a[60:63], a[188:191], v[92:95], a[60:63]
v_mfma_f32_16x16x32_bf16 a[92:95], a[188:191], v[96:99], a[92:95]
v_mfma_f32_16x16x32_bf16 a[124:127], a[188:191], v[100:103], a[124:127]
s_waitcnt lgkmcnt(6)
ds_read_b64_tr_b16 a[188:189], v227 offset:0
ds_read_b64_tr_b16 a[190:191], v227 offset:4096
s_waitcnt lgkmcnt(8)
s_branch K_B5
K_PUB:
v_mov_b32 v5, 1
s_and_b32 s46, s52, 15
s_lshl_b32 s46, s46, 7
s_add_u32 s46, s46, 0x272000
s_mov_b64 exec, 1
buffer_atomic_add v5, v234, s[20:23], s46 offen sc1
s_mov_b64 exec, -1
s_branch K_B4
K_RANK:
s_mov_b32 s46, 2
K_RANK1:
v_cmp_lt_u32 vcc, s92, v255
s_bcnt1_i32_b64 s48, vcc
s_cmp_lt_u32 s48, 8
s_cbranch_scc0 K_RANK2
v_mov_b32 v246, 0
v_cmp_lt_u32 vcc, s92, v104
v_addc_co_u32 v246, vcc, 0, v246, vcc
v_cmp_lt_u32 vcc, s92, v105
v_addc_co_u32 v246, vcc, 0, v246, vcc
v_cmp_lt_u32 vcc, s92, v106
v_addc_co_u32 v246, vcc, 0, v246, vcc
v_cmp_lt_u32 vcc, s92, v107
v_addc_co_u32 v246, vcc, 0, v246, vcc
v_cmp_lt_u32 vcc, s92, v108
v_addc_co_u32 v246, vcc, 0, v246, vcc
v_cmp_lt_u32 vcc, s92, v109
v_addc_co_u32 v246, vcc, 0, v246, vcc
v_cmp_lt_u32 vcc, s92, v110
v_addc_co_u32 v246, vcc, 0, v246, vcc
v_cmp_lt_u32 vcc, s92, v111
v_addc_co_u32 v246, vcc, 0, v246, vcc
v_cmp_lt_u32 vcc, s92, v112
v_addc_co_u32 v246, vcc, 0, v246, vcc
v_cmp_lt_u32 vcc, s92, v113
v_addc_co_u32 v246, vcc, 0, v246, vcc
v_cmp_lt_u32 vcc, s92, v114
v_addc_co_u32 v246, vcc, 0, v246, vcc
v_cmp_lt_u32 vcc, s92, v115
v_addc_co_u32 v246, vcc, 0, v246, vcc
v_cmp_lt_u32 vcc, s92, v116
v_addc_co_u32 v246, vcc, 0, v246, vcc
v_cmp_lt_u32 vcc, s92, v117
v_addc_co_u32 v246, vcc, 0, v246, vcc
v_cmp_lt_u32 vcc, s92, v118
v_addc_co_u32 v246, vcc, 0, v246, vcc
v_cmp_lt_u32 vcc, s92, v119
v_addc_co_u32 v246, vcc, 0, v246, vcc
v_cmp_lt_u32 vcc, s92, v120
v_addc_co_u32 v246, vcc, 0, v246, vcc
v_cmp_lt_u32 vcc, s92, v121
v_addc_co_u32 v246, vcc, 0, v246, vcc
v_cmp_lt_u32 vcc, s92, v122
v_addc_co_u32 v246, vcc, 0, v246, vcc
v_cmp_lt_u32 vcc, s92, v123
v_addc_co_u32 v246, vcc, 0, v246, vcc
v_cmp_lt_u32 vcc, s92, v124
v_addc_co_u32 v246, vcc, 0, v246, vcc
v_cmp_lt_u32 vcc, s92, v125
v_addc_co_u32 v246, vcc, 0, v246, vcc
v_cmp_lt_u32 vcc, s92, v126
v_addc_co_u32 v246, vcc, 0, v246, vcc
v_cmp_lt_u32 vcc, s92, v127
v_addc_co_u32 v246, vcc, 0, v246, vcc
v_cmp_lt_u32 vcc, s92, v128
v_addc_co_u32 v246, vcc, 0, v246, vcc
v_cmp_lt_u32 vcc, s92, v129
v_addc_co_u32 v246, vcc, 0, v246, vcc
v_cmp_lt_u32 vcc, s92, v130
v_addc_co_u32 v246, vcc, 0, v246, vcc
v_cmp_lt_u32 vcc, s92, v131
v_addc_co_u32 v246, vcc, 0, v246, vcc
v_cmp_lt_u32 vcc, s92, v132
v_addc_co_u32 v246, vcc, 0, v246, vcc
v_cmp_lt_u32 vcc, s92, v133
v_addc_co_u32 v246, vcc, 0, v246, vcc
v_cmp_lt_u32 vcc, s92, v134
v_addc_co_u32 v246, vcc, 0, v246, vcc
v_cmp_lt_u32 vcc, s92, v135
v_addc_co_u32 v246, vcc, 0, v246, vcc
s_mov_b32 s48, 0
v_cmp_lt_u32 vcc, 0, v246
s_bcnt1_i32_b64 s47, vcc
s_add_u32 s48, s48, s47
v_cmp_lt_u32 vcc, 1, v246
s_bcnt1_i32_b64 s47, vcc
s_add_u32 s48, s48, s47
v_cmp_lt_u32 vcc, 2, v246
s_bcnt1_i32_b64 s47, vcc
s_add_u32 s48, s48, s47
v_cmp_lt_u32 vcc, 3, v246
s_bcnt1_i32_b64 s47, vcc
s_add_u32 s48, s48, s47
v_cmp_lt_u32 vcc, 4, v246
s_bcnt1_i32_b64 s47, vcc
s_add_u32 s48, s48, s47
v_cmp_lt_u32 vcc, 5, v246
s_bcnt1_i32_b64 s47, vcc
s_add_u32 s48, s48, s47
v_cmp_lt_u32 vcc, 6, v246
s_bcnt1_i32_b64 s47, vcc
s_add_u32 s48, s48, s47
v_cmp_lt_u32 vcc, 7, v246
s_bcnt1_i32_b64 s47, vcc
s_add_u32 s48, s48, s47
s_cmp_lt_u32 s48, 8
s_cbranch_scc0 K_RANK2
s_and_b32 s47, s92, 0xffff
s_sub_u32 s47, 2048, s47
s_ashr_i32 s94, s92, 31
s_not_b32 s94, s94
s_or_b32 s94, s94, 0x80000000
s_xor_b32 s94, s94, s92
s_and_b32 s94, s94, 0xffff0000
v_mov_b32 v247, s94
v_mul_f32 v247, 0xbfb8aa3b, v247
v_exp_f32 v247, v247
s_nop 0
v_add_f32 v247, 1.0, v247
v_rcp_f32 v247, v247
s_nop 0
v_cvt_pk_bf16_f32 v247, v247, v247
v_lshlrev_b32 v247, 16, v247
v_or_b32 v247, 1, v247
v_mov_b32 v246, s47
s_lshl_b32 s48, s48, 3
s_add_u32 s48, s48, 0x270000
s_mov_b64 exec, 1
buffer_store_dword v246, v234, s[20:23], s48 offen offset:4 sc0 sc1
buffer_store_dword v247, v234, s[20:23], s48 offen offset:68 sc0 sc1
s_mov_b64 exec, -1
K_RANK2:
s_mov_b32 s92, s93
s_sub_u32 s46, s46, 1
s_cmp_lg_u32 s46, 0
s_cbranch_scc1 K_RANK1
s_branch K_RANKED
K_XP0:
s_cmp_eq_u32 s83, 0
s_cbranch_scc1 K_XM0
ds_read_b64 a[244:245], v156 offset:0
s_branch K_XP0D
K_XM0:
ds_read_b64 a[236:237], v152 offset:0
ds_read_b64 a[238:239], v153 offset:0
ds_read_b64 a[240:241], v154 offset:0
ds_read_b64 a[242:243], v155 offset:0
s_branch K_XP0D
K_XP1:
v_add_u32 v160, 0x10000, v152
v_add_u32 v161, 0x10000, v153
v_add_u32 v162, 0x10000, v154
v_add_u32 v163, 0x10000, v155
v_add_u32 v164, 0x10000, v156
s_cmp_eq_u32 s83, 1
s_cbranch_scc1 K_XM1
ds_read_b64 a[244:245], v164 offset:32768
s_branch K_XP1D
K_XM1:
ds_read_b64 a[236:237], v160 offset:32768
ds_read_b64 a[238:239], v161 offset:32768
ds_read_b64 a[240:241], v162 offset:32768
ds_read_b64 a[242:243], v163 offset:32768
s_branch K_XP1D
K_XP2:
s_cmp_eq_u32 s83, 2
s_cbranch_scc1 K_XM2
ds_read_b64 a[244:245], v156 offset:49152
s_branch K_XP2D
K_XM2:
ds_read_b64 a[236:237], v152 offset:49152
ds_read_b64 a[238:239], v153 offset:49152
ds_read_b64 a[240:241], v154 offset:49152
ds_read_b64 a[242:243], v155 offset:49152
s_branch K_XP2D
K_XP3:
s_cmp_eq_u32 s83, 3
s_cbranch_scc1 K_XM3
ds_read_b64 a[244:245], v156 offset:0
s_branch K_XP3D
K_XM3:
ds_read_b64 a[236:237], v152 offset:0
ds_read_b64 a[238:239], v153 offset:0
ds_read_b64 a[240:241], v154 offset:0
ds_read_b64 a[242:243], v155 offset:0
s_branch K_XP3D
K_XP4:
v_add_u32 v160, 0x10000, v152
v_add_u32 v161, 0x10000, v153
v_add_u32 v162, 0x10000, v154
v_add_u32 v163, 0x10000, v155
v_add_u32 v164, 0x10000, v156
s_cmp_eq_u32 s83, 4
s_cbranch_scc1 K_XM4
ds_read_b64 a[244:245], v164 offset:32768
s_branch K_XP4D
K_XM4:
ds_read_b64 a[236:237], v160 offset:32768
ds_read_b64 a[238:239], v161 offset:32768
ds_read_b64 a[240:241], v162 offset:32768
ds_read_b64 a[242:243], v163 offset:32768
s_branch K_XP4D
K_XP5:
s_cmp_eq_u32 s83, 5
s_cbranch_scc1 K_XM5
ds_read_b64 a[244:245], v156 offset:49152
s_branch K_XP5D
K_XM5:
ds_read_b64 a[236:237], v152 offset:49152
ds_read_b64 a[238:239], v153 offset:49152
ds_read_b64 a[240:241], v154 offset:49152
ds_read_b64 a[242:243], v155 offset:49152
s_branch K_XP5D
K_XP6:
s_cmp_eq_u32 s83, 6
s_cbranch_scc1 K_XM6
ds_read_b64 a[244:245], v156 offset:0
s_branch K_XP6D
K_XM6:
ds_read_b64 a[236:237], v152 offset:0
ds_read_b64 a[238:239], v153 offset:0
ds_read_b64 a[240:241], v154 offset:0
ds_read_b64 a[242:243], v155 offset:0
s_branch K_XP6D
K_XP7:
v_add_u32 v160, 0x10000, v152
v_add_u32 v161, 0x10000, v153
v_add_u32 v162, 0x10000, v154
v_add_u32 v163, 0x10000, v155
v_add_u32 v164, 0x10000, v156
s_cmp_eq_u32 s83, 7
s_cbranch_scc1 K_XM7
ds_read_b64 a[244:245], v164 offset:32768
s_branch K_XP7D
K_XM7:
ds_read_b64 a[236:237], v160 offset:32768
ds_read_b64 a[238:239], v161 offset:32768
ds_read_b64 a[240:241], v162 offset:32768
ds_read_b64 a[242:243], v163 offset:32768
s_branch K_XP7D
K_XP8:
s_cmp_eq_u32 s83, 8
s_cbranch_scc1 K_XM8
ds_read_b64 a[244:245], v156 offset:49152
s_branch K_XP8D
K_XM8:
ds_read_b64 a[236:237], v152 offset:49152
ds_read_b64 a[238:239], v153 offset:49152
ds_read_b64 a[240:241], v154 offset:49152
ds_read_b64 a[242:243], v155 offset:49152
s_branch K_XP8D
K_CODE_END:
K_FB:
s_mov_b32 s41, 1
s_waitcnt vmcnt(0) lgkmcnt(0)
s_barrier
v_mov_b32 v136, 0xff800000
v_mov_b32 v140, 0xff800000
v_mov_b32 v144, 0xff800000
v_mov_b32 v148, 0xff800000
s_mov_b32 s38, 0
s_mov_b32 s40, 32
K_FBLOOP:
s_add_u32 m0, s37, 0
s_nop 0
buffer_load_dwordx4 v228, s[8:11], s38 offen offset:0 lds
buffer_load_dwordx4 v229, s[8:11], s38 offen offset:1024 lds
buffer_load_dwordx4 v230, s[8:11], s38 offen offset:2048 lds
buffer_load_dwordx4 v231, s[8:11], s38 offen offset:3072 lds
s_add_u32 s38, s38, 16384
s_waitcnt vmcnt(0)
s_barrier
ds_read_b128 a[128:131], v216 offset:0
ds_read_b128 a[132:135], v217 offset:0
ds_read_b128 a[136:139], v218 offset:0
ds_read_b128 a[140:143], v219 offset:0
ds_read_b128 a[144:147], v216 offset:4096
ds_read_b128 a[148:151], v217 offset:4096
ds_read_b128 a[152:155], v218 offset:4096
ds_read_b128 a[156:159], v219 offset:4096
s_waitcnt lgkmcnt(0)
v_mfma_f32_16x16x32_bf16 v[8:11], a[128:131], v[152:155], 0
v_mfma_f32_16x16x32_bf16 v[8:11], a[132:135], v[156:159], v[8:11]
v_mfma_f32_16x16x32_bf16 v[8:11], a[136:139], v[160:163], v[8:11]
v_mfma_f32_16x16x32_bf16 v[8:11], a[140:143], v[164:167], v[8:11]
v_mfma_f32_16x16x32_bf16 v[12:15], a[144:147], v[152:155], 0
v_mfma_f32_16x16x32_bf16 v[12:15], a[148:151], v[156:159], v[12:15]
v_mfma_f32_16x16x32_bf16 v[12:15], a[152:155], v[160:163], v[12:15]
v_mfma_f32_16x16x32_bf16 v[12:15], a[156:159], v[164:167], v[12:15]
v_mfma_f32_16x16x32_bf16 v[16:19], a[128:131], v[168:171], 0
v_mfma_f32_16x16x32_bf16 v[16:19], a[132:135], v[172:175], v[16:19]
v_mfma_f32_16x16x32_bf16 v[16:19], a[136:139], v[176:179], v[16:19]
v_mfma_f32_16x16x32_bf16 v[16:19], a[140:143], v[180:183], v[16:19]
v_mfma_f32_16x16x32_bf16 v[20:23], a[144:147], v[168:171], 0
v_mfma_f32_16x16x32_bf16 v[20:23], a[148:151], v[172:175], v[20:23]
v_mfma_f32_16x16x32_bf16 v[20:23], a[152:155], v[176:179], v[20:23]
v_mfma_f32_16x16x32_bf16 v[20:23], a[156:159], v[180:183], v[20:23]
v_mfma_f32_16x16x32_bf16 v[24:27], a[128:131], v[184:187], 0
v_mfma_f32_16x16x32_bf16 v[24:27], a[132:135], v[188:191], v[24:27]
v_mfma_f32_16x16x32_bf16 v[24:27], a[136:139], v[192:195], v[24:27]
v_mfma_f32_16x16x32_bf16 v[24:27], a[140:143], v[196:199], v[24:27]
v_mfma_f32_16x16x32_bf16 v[28:31], a[144:147], v[184:187], 0
v_mfma_f32_16x16x32_bf16 v[28:31], a[148:151], v[188:191], v[28:31]
v_mfma_f32_16x16x32_bf16 v[28:31], a[152:155], v[192:195], v[28:31]
v_mfma_f32_16x16x32_bf16 v[28:31], a[156:159], v[196:199], v[28:31]
v_mfma_f32_16x16x32_bf16 v[32:35], a[128:131], v[200:203], 0
v_mfma_f32_16x16x32_bf16 v[32:35], a[132:135], v[204:207], v[32:35]
v_mfma_f32_16x16x32_bf16 v[32:35], a[136:139], v[208:211], v[32:35]
v_mfma_f32_16x16x32_bf16 v[32:35], a[140:143], v[212:215], v[32:35]
v_mfma_f32_16x16x32_bf16 v[36:39], a[144:147], v[200:203], 0
v_mfma_f32_16x16x32_bf16 v[36:39], a[148:151], v[204:207], v[36:39]
v_mfma_f32_16x16x32_bf16 v[36:39], a[152:155], v[208:211], v[36:39]
v_mfma_f32_16x16x32_bf16 v[36:39], a[156:159], v[212:215], v[36:39]
s_nop 7
v_max3_f32 v136, v136, v8, v9
v_max3_f32 v136, v136, v10, v11
v_max3_f32 v136, v136, v12, v13
v_max3_f32 v136, v136, v14, v15
v_max3_f32 v140, v140, v16, v17
v_max3_f32 v140, v140, v18, v19
v_max3_f32 v140, v140, v20, v21
v_max3_f32 v140, v140, v22, v23
v_max3_f32 v144, v144, v24, v25
v_max3_f32 v144, v144, v26, v27
v_max3_f32 v144, v144, v28, v29
v_max3_f32 v144, v144, v30, v31
v_max3_f32 v148, v148, v32, v33
v_max3_f32 v148, v148, v34, v35
v_max3_f32 v148, v148, v36, v37
v_max3_f32 v148, v148, v38, v39
ds_read_b128 a[128:131], v216 offset:8192
ds_read_b128 a[132:135], v217 offset:8192
ds_read_b128 a[136:139], v218 offset:8192
ds_read_b128 a[140:143], v219 offset:8192
ds_read_b128 a[144:147], v216 offset:12288
ds_read_b128 a[148:151], v217 offset:12288
ds_read_b128 a[152:155], v218 offset:12288
ds_read_b128 a[156:159], v219 offset:12288
s_waitcnt lgkmcnt(0)
v_mfma_f32_16x16x32_bf16 v[8:11], a[128:131], v[152:155], 0
v_mfma_f32_16x16x32_bf16 v[8:11], a[132:135], v[156:159], v[8:11]
v_mfma_f32_16x16x32_bf16 v[8:11], a[136:139], v[160:163], v[8:11]
v_mfma_f32_16x16x32_bf16 v[8:11], a[140:143], v[164:167], v[8:11]
v_mfma_f32_16x16x32_bf16 v[12:15], a[144:147], v[152:155], 0
v_mfma_f32_16x16x32_bf16 v[12:15], a[148:151], v[156:159], v[12:15]
v_mfma_f32_16x16x32_bf16 v[12:15], a[152:155], v[160:163], v[12:15]
v_mfma_f32_16x16x32_bf16 v[12:15], a[156:159], v[164:167], v[12:15]
v_mfma_f32_16x16x32_bf16 v[16:19], a[128:131], v[168:171], 0
v_mfma_f32_16x16x32_bf16 v[16:19], a[132:135], v[172:175], v[16:19]
v_mfma_f32_16x16x32_bf16 v[16:19], a[136:139], v[176:179], v[16:19]
v_mfma_f32_16x16x32_bf16 v[16:19], a[140:143], v[180:183], v[16:19]
v_mfma_f32_16x16x32_bf16 v[20:23], a[144:147], v[168:171], 0
v_mfma_f32_16x16x32_bf16 v[20:23], a[148:151], v[172:175], v[20:23]
v_mfma_f32_16x16x32_bf16 v[20:23], a[152:155], v[176:179], v[20:23]
v_mfma_f32_16x16x32_bf16 v[20:23], a[156:159], v[180:183], v[20:23]
v_mfma_f32_16x16x32_bf16 v[24:27], a[128:131], v[184:187], 0
v_mfma_f32_16x16x32_bf16 v[24:27], a[132:135], v[188:191], v[24:27]
v_mfma_f32_16x16x32_bf16 v[24:27], a[136:139], v[192:195], v[24:27]
v_mfma_f32_16x16x32_bf16 v[24:27], a[140:143], v[196:199], v[24:27]
v_mfma_f32_16x16x32_bf16 v[28:31], a[144:147], v[184:187], 0
v_mfma_f32_16x16x32_bf16 v[28:31], a[148:151], v[188:191], v[28:31]
v_mfma_f32_16x16x32_bf16 v[28:31], a[152:155], v[192:195], v[28:31]
v_mfma_f32_16x16x32_bf16 v[28:31], a[156:159], v[196:199], v[28:31]
v_mfma_f32_16x16x32_bf16 v[32:35], a[128:131], v[200:203], 0
v_mfma_f32_16x16x32_bf16 v[32:35], a[132:135], v[204:207], v[32:35]
v_mfma_f32_16x16x32_bf16 v[32:35], a[136:139], v[208:211], v[32:35]
v_mfma_f32_16x16x32_bf16 v[32:35], a[140:143], v[212:215], v[32:35]
v_mfma_f32_16x16x32_bf16 v[36:39], a[144:147], v[200:203], 0
v_mfma_f32_16x16x32_bf16 v[36:39], a[148:151], v[204:207], v[36:39]
v_mfma_f32_16x16x32_bf16 v[36:39], a[152:155], v[208:211], v[36:39]
v_mfma_f32_16x16x32_bf16 v[36:39], a[156:159], v[212:215], v[36:39]
s_nop 7
v_max3_f32 v136, v136, v8, v9
v_max3_f32 v136, v136, v10, v11
v_max3_f32 v136, v136, v12, v13
v_max3_f32 v136, v136, v14, v15
v_max3_f32 v140, v140, v16, v17
v_max3_f32 v140, v140, v18, v19
v_max3_f32 v140, v140, v20, v21
v_max3_f32 v140, v140, v22, v23
v_max3_f32 v144, v144, v24, v25
v_max3_f32 v144, v144, v26, v27
v_max3_f32 v144, v144, v28, v29
v_max3_f32 v144, v144, v30, v31
v_max3_f32 v148, v148, v32, v33
v_max3_f32 v148, v148, v34, v35
v_max3_f32 v148, v148, v36, v37
v_max3_f32 v148, v148, v38, v39
s_barrier
s_sub_u32 s40, s40, 1
s_cmp_lg_u32 s40, 0
s_cbranch_scc1 K_FBLOOP
v_mov_b32 v137, v136
s_nop 1
v_permlane16_swap_b32 v136, v137
v_max_f32 v136, v136, v137
v_mov_b32 v137, v136
s_nop 1
v_permlane32_swap_b32 v136, v137
v_max_f32 v136, v136, v137
v_sub_f32 v139, 0, v136
v_sub_f32 v138, 0, v136
v_sub_f32 v137, 0, v136
v_sub_f32 v136, 0, v136
v_mov_b32 v141, v140
s_nop 1
v_permlane16_swap_b32 v140, v141
v_max_f32 v140, v140, v141
v_mov_b32 v141, v140
s_nop 1
v_permlane32_swap_b32 v140, v141
v_max_f32 v140, v140, v141
v_sub_f32 v143, 0, v140
v_sub_f32 v142, 0, v140
v_sub_f32 v141, 0, v140
v_sub_f32 v140, 0, v140
v_mov_b32 v145, v144
s_nop 1
v_permlane16_swap_b32 v144, v145
v_max_f32 v144, v144, v145
v_mov_b32 v145, v144
s_nop 1
v_permlane32_swap_b32 v144, v145
v_max_f32 v144, v144, v145
v_sub_f32 v147, 0, v144
v_sub_f32 v146, 0, v144
v_sub_f32 v145, 0, v144
v_sub_f32 v144, 0, v144
v_mov_b32 v149, v148
s_nop 1
v_permlane16_swap_b32 v148, v149
v_max_f32 v148, v148, v149
v_mov_b32 v149, v148
s_nop 1
v_permlane32_swap_b32 v148, v149
v_max_f32 v148, v148, v149
v_sub_f32 v151, 0, v148
v_sub_f32 v150, 0, v148
v_sub_f32 v149, 0, v148
v_sub_f32 v148, 0, v148
s_mov_b32 s38, 0
s_add_u32 m0, s37, 32768
s_nop 0
buffer_load_dwordx4 v228, s[8:11], s38 offen offset:0 lds
buffer_load_dwordx4 v229, s[8:11], s38 offen offset:1024 lds
buffer_load_dwordx4 v230, s[8:11], s38 offen offset:2048 lds
buffer_load_dwordx4 v231, s[8:11], s38 offen offset:3072 lds
s_add_u32 s38, s38, 16384
s_add_u32 m0, s37, 16384
s_nop 0
buffer_load_dwordx4 v228, s[8:11], s38 offen offset:0 lds
buffer_load_dwordx4 v229, s[8:11], s38 offen offset:1024 lds
buffer_load_dwordx4 v230, s[8:11], s38 offen offset:2048 lds
buffer_load_dwordx4 v231, s[8:11], s38 offen offset:3072 lds
s_add_u32 s38, s38, 16384
s_add_u32 m0, s37, 0
s_nop 0
buffer_load_dwordx4 v228, s[8:11], s38 offen offset:0 lds
buffer_load_dwordx4 v229, s[8:11], s38 offen offset:1024 lds
buffer_load_dwordx4 v230, s[8:11], s38 offen offset:2048 lds
buffer_load_dwordx4 v231, s[8:11], s38 offen offset:3072 lds
s_add_u32 s38, s38, 16384
s_mov_b32 s39, 0
s_add_u32 m0, s37, 98304
s_nop 0
buffer_load_dwordx4 v232, s[12:15], s39 offen offset:0 lds
buffer_load_dwordx4 v233, s[12:15], s39 offen offset:1024 lds
buffer_load_dwordx4 v232, s[12:15], s39 offen offset:2048 lds
buffer_load_dwordx4 v233, s[12:15], s39 offen offset:3072 lds
s_add_u32 s39, s39, 16384
s_add_u32 m0, s37, 114688
s_nop 0
buffer_load_dwordx4 v232, s[12:15], s39 offen offset:0 lds
buffer_load_dwordx4 v233, s[12:15], s39 offen offset:1024 lds
buffer_load_dwordx4 v232, s[12:15], s39 offen offset:2048 lds
buffer_load_dwordx4 v233, s[12:15], s39 offen offset:3072 lds
s_add_u32 s39, s39, 16384
s_mov_b32 s40, 0
v_accvgpr_write_b32 a0, 0
v_accvgpr_write_b32 a1, 0
v_accvgpr_write_b32 a2, 0
v_accvgpr_write_b32 a3, 0
v_accvgpr_write_b32 a4, 0
v_accvgpr_write_b32 a5, 0
v_accvgpr_write_b32 a6, 0
v_accvgpr_write_b32 a7, 0
v_accvgpr_write_b32 a8, 0
v_accvgpr_write_b32 a9, 0
v_accvgpr_write_b32 a10, 0
v_accvgpr_write_b32 a11, 0
v_accvgpr_write_b32 a12, 0
v_accvgpr_write_b32 a13, 0
v_accvgpr_write_b32 a14, 0
v_accvgpr_write_b32 a15, 0
v_accvgpr_write_b32 a16, 0
v_accvgpr_write_b32 a17, 0
v_accvgpr_write_b32 a18, 0
v_accvgpr_write_b32 a19, 0
v_accvgpr_write_b32 a20, 0
v_accvgpr_write_b32 a21, 0
v_accvgpr_write_b32 a22, 0
v_accvgpr_write_b32 a23, 0
v_accvgpr_write_b32 a24, 0
v_accvgpr_write_b32 a25, 0
v_accvgpr_write_b32 a26, 0
v_accvgpr_write_b32 a27, 0
v_accvgpr_write_b32 a28, 0
v_accvgpr_write_b32 a29, 0
v_accvgpr_write_b32 a30, 0
v_accvgpr_write_b32 a31, 0
v_accvgpr_write_b32 a32, 0
v_accvgpr_write_b32 a33, 0
v_accvgpr_write_b32 a34, 0
v_accvgpr_write_b32 a35, 0
v_accvgpr_write_b32 a36, 0
v_accvgpr_write_b32 a37, 0
v_accvgpr_write_b32 a38, 0
v_accvgpr_write_b32 a39, 0
v_accvgpr_write_b32 a40, 0
v_accvgpr_write_b32 a41, 0
v_accvgpr_write_b32 a42, 0
v_accvgpr_write_b32 a43, 0
v_accvgpr_write_b32 a44, 0
v_accvgpr_write_b32 a45, 0
v_accvgpr_write_b32 a46, 0
v_accvgpr_write_b32 a47, 0
v_accvgpr_write_b32 a48, 0
v_accvgpr_write_b32 a49, 0
v_accvgpr_write_b32 a50, 0
v_accvgpr_write_b32 a51, 0
v_accvgpr_write_b32 a52, 0
v_accvgpr_write_b32 a53, 0
v_accvgpr_write_b32 a54, 0
v_accvgpr_write_b32 a55, 0
v_accvgpr_write_b32 a56, 0
v_accvgpr_write_b32 a57, 0
v_accvgpr_write_b32 a58, 0
v_accvgpr_write_b32 a59, 0
v_accvgpr_write_b32 a60, 0
v_accvgpr_write_b32 a61, 0
v_accvgpr_write_b32 a62, 0
v_accvgpr_write_b32 a63, 0
v_accvgpr_write_b32 a64, 0
v_accvgpr_write_b32 a65, 0
v_accvgpr_write_b32 a66, 0
v_accvgpr_write_b32 a67, 0
v_accvgpr_write_b32 a68, 0
v_accvgpr_write_b32 a69, 0
v_accvgpr_write_b32 a70, 0
v_accvgpr_write_b32 a71, 0
v_accvgpr_write_b32 a72, 0
v_accvgpr_write_b32 a73, 0
v_accvgpr_write_b32 a74, 0
v_accvgpr_write_b32 a75, 0
v_accvgpr_write_b32 a76, 0
v_accvgpr_write_b32 a77, 0
v_accvgpr_write_b32 a78, 0
v_accvgpr_write_b32 a79, 0
v_accvgpr_write_b32 a80, 0
v_accvgpr_write_b32 a81, 0
v_accvgpr_write_b32 a82, 0
v_accvgpr_write_b32 a83, 0
v_accvgpr_write_b32 a84, 0
v_accvgpr_write_b32 a85, 0
v_accvgpr_write_b32 a86, 0
v_accvgpr_write_b32 a87, 0
v_accvgpr_write_b32 a88, 0
v_accvgpr_write_b32 a89, 0
v_accvgpr_write_b32 a90, 0
v_accvgpr_write_b32 a91, 0
v_accvgpr_write_b32 a92, 0
v_accvgpr_write_b32 a93, 0
v_accvgpr_write_b32 a94, 0
v_accvgpr_write_b32 a95, 0
v_accvgpr_write_b32 a96, 0
v_accvgpr_write_b32 a97, 0
v_accvgpr_write_b32 a98, 0
v_accvgpr_write_b32 a99, 0
v_accvgpr_write_b32 a100, 0
v_accvgpr_write_b32 a101, 0
v_accvgpr_write_b32 a102, 0
v_accvgpr_write_b32 a103, 0
v_accvgpr_write_b32 a104, 0
v_accvgpr_write_b32 a105, 0
v_accvgpr_write_b32 a106, 0
v_accvgpr_write_b32 a107, 0
v_accvgpr_write_b32 a108, 0
v_accvgpr_write_b32 a109, 0
v_accvgpr_write_b32 a110, 0
v_accvgpr_write_b32 a111, 0
v_accvgpr_write_b32 a112, 0
v_accvgpr_write_b32 a113, 0
v_accvgpr_write_b32 a114, 0
v_accvgpr_write_b32 a115, 0
v_accvgpr_write_b32 a116, 0
v_accvgpr_write_b32 a117, 0
v_accvgpr_write_b32 a118, 0
v_accvgpr_write_b32 a119, 0
v_accvgpr_write_b32 a120, 0
v_accvgpr_write_b32 a121, 0
v_accvgpr_write_b32 a122, 0
v_accvgpr_write_b32 a123, 0
v_accvgpr_write_b32 a124, 0
v_accvgpr_write_b32 a125, 0
v_accvgpr_write_b32 a126, 0
v_accvgpr_write_b32 a127, 0
v_accvgpr_write_b32 a248, 0
v_accvgpr_write_b32 a249, 0
v_accvgpr_write_b32 a250, 0
v_accvgpr_write_b32 a251, 0
v_accvgpr_write_b32 a252, 0
v_accvgpr_write_b32 a253, 0
v_accvgpr_write_b32 a254, 0
v_accvgpr_write_b32 a255, 0
s_waitcnt vmcnt(0)
s_barrier
ds_read_b128 a[128:131], v216 offset:32768
ds_read_b128 a[132:135], v217 offset:32768
ds_read_b128 a[136:139], v218 offset:32768
ds_read_b128 a[140:143], v219 offset:32768
ds_read_b128 a[144:147], v216 offset:36864
ds_read_b128 a[148:151], v217 offset:36864
ds_read_b128 a[152:155], v218 offset:36864
ds_read_b128 a[156:159], v219 offset:36864
s_waitcnt lgkmcnt(0)
v_mfma_f32_16x16x32_bf16 v[8:11], a[128:131], v[152:155], 0
v_mfma_f32_16x16x32_bf16 v[8:11], a[132:135], v[156:159], v[8:11]
v_mfma_f32_16x16x32_bf16 v[8:11], a[136:139], v[160:163], v[8:11]
v_mfma_f32_16x16x32_bf16 v[8:11], a[140:143], v[164:167], v[8:11]
v_mfma_f32_16x16x32_bf16 v[12:15], a[144:147], v[152:155], 0
v_mfma_f32_16x16x32_bf16 v[12:15], a[148:151], v[156:159], v[12:15]
v_mfma_f32_16x16x32_bf16 v[12:15], a[152:155], v[160:163], v[12:15]
v_mfma_f32_16x16x32_bf16 v[12:15], a[156:159], v[164:167], v[12:15]
v_mfma_f32_16x16x32_bf16 v[16:19], a[128:131], v[168:171], 0
v_mfma_f32_16x16x32_bf16 v[16:19], a[132:135], v[172:175], v[16:19]
v_mfma_f32_16x16x32_bf16 v[16:19], a[136:139], v[176:179], v[16:19]
v_mfma_f32_16x16x32_bf16 v[16:19], a[140:143], v[180:183], v[16:19]
v_mfma_f32_16x16x32_bf16 v[20:23], a[144:147], v[168:171], 0
v_mfma_f32_16x16x32_bf16 v[20:23], a[148:151], v[172:175], v[20:23]
v_mfma_f32_16x16x32_bf16 v[20:23], a[152:155], v[176:179], v[20:23]
v_mfma_f32_16x16x32_bf16 v[20:23], a[156:159], v[180:183], v[20:23]
v_mfma_f32_16x16x32_bf16 v[24:27], a[128:131], v[184:187], 0
v_mfma_f32_16x16x32_bf16 v[24:27], a[132:135], v[188:191], v[24:27]
v_mfma_f32_16x16x32_bf16 v[24:27], a[136:139], v[192:195], v[24:27]
v_mfma_f32_16x16x32_bf16 v[24:27], a[140:143], v[196:199], v[24:27]
v_mfma_f32_16x16x32_bf16 v[28:31], a[144:147], v[184:187], 0
v_mfma_f32_16x16x32_bf16 v[28:31], a[148:151], v[188:191], v[28:31]
v_mfma_f32_16x16x32_bf16 v[28:31], a[152:155], v[192:195], v[28:31]
v_mfma_f32_16x16x32_bf16 v[28:31], a[156:159], v[196:199], v[28:31]
v_mfma_f32_16x16x32_bf16 v[32:35], a[128:131], v[200:203], 0
v_mfma_f32_16x16x32_bf16 v[32:35], a[132:135], v[204:207], v[32:35]
v_mfma_f32_16x16x32_bf16 v[32:35], a[136:139], v[208:211], v[32:35]
v_mfma_f32_16x16x32_bf16 v[32:35], a[140:143], v[212:215], v[32:35]
v_mfma_f32_16x16x32_bf16 v[36:39], a[144:147], v[200:203], 0
v_mfma_f32_16x16x32_bf16 v[36:39], a[148:151], v[204:207], v[36:39]
v_mfma_f32_16x16x32_bf16 v[36:39], a[152:155], v[208:211], v[36:39]
v_mfma_f32_16x16x32_bf16 v[36:39], a[156:159], v[212:215], v[36:39]
ds_read_b128 a[128:131], v216 offset:40960
ds_read_b128 a[132:135], v217 offset:40960
ds_read_b128 a[136:139], v218 offset:40960
ds_read_b128 a[140:143], v219 offset:40960
ds_read_b128 a[144:147], v216 offset:45056
ds_read_b128 a[148:151], v217 offset:45056
ds_read_b128 a[152:155], v218 offset:45056
ds_read_b128 a[156:159], v219 offset:45056
s_waitcnt lgkmcnt(0)
s_branch K_HAVEMAX
.section .rodata,"a"
.p2align 6
.amdhsa_kernel recurrent_scan__gqa_block_cached__moe_arch_mod__prompt_kernel
  .amdhsa_next_free_vgpr 512
  .amdhsa_next_free_sgpr 102
  .amdhsa_accum_offset 256
  .amdhsa_group_segment_fixed_size 0
  .amdhsa_kernarg_size 104
  .amdhsa_user_sgpr_count 2
  .amdhsa_user_sgpr_kernarg_segment_ptr 1
  .amdhsa_system_sgpr_workgroup_id_x 1
  .amdhsa_float_denorm_mode_32 3
.end_amdhsa_kernel
```

```asm
; @launch grid=(256,1,1) block=(256,1,1) lds=163840
.amdgcn_target "amdgcn-amd-amdhsa--gfx950"
.text
.globl recurrent_scan__gqa_block_cached__moe_arch_mod__prompt_kernel
.p2align 8
.type recurrent_scan__gqa_block_cached__moe_arch_mod__prompt_kernel,@function
recurrent_scan__gqa_block_cached__moe_arch_mod__prompt_kernel:
s_cmp_ge_u32 s2, 256
s_cbranch_scc1 K_END
s_getpc_b64 s[96:97]
v_lshlrev_b32 v7, 5, v0
global_load_dword a4, v7, s[96:97]
s_load_dwordx8 s[88:95], s[0:1], 0
s_load_dwordx2 s[86:87], s[0:1], 48
s_load_dwordx4 s[4:7], s[0:1], 88
v_and_b32 v1, 63, v0
v_lshrrev_b32 v5, 6, v0
s_bfe_u32 s35, s2, 0x20001
s_bfe_u32 s36, s2, 0x20003
v_readfirstlane_b32 s32, v5
s_lshl_b32 s33, s35, 2
s_add_u32 s33, s33, s36
s_and_b32 s34, s2, 1
s_lshl_b32 s34, s34, 3
s_lshr_b32 s46, s2, 5
s_add_u32 s34, s34, s46
s_lshl_b32 s46, s34, 7
s_lshl_b32 s47, s33, 3
s_add_u32 s3, s46, s47
v_lshrrev_b32 v8, 5, v0
v_add_u32 v8, s3, v8
v_and_b32 v9, 31, v0
v_mul_u32_u24 v11, 12, v9
v_mul_u32_u24 v10, 0x480, v8
v_add_u32 v10, v10, v11
v_lshrrev_b32 v5, 3, v1
v_and_b32 v6, 7, v1
v_xor_b32 v6, v6, v5
v_mul_u32_u24 v5, 0x480, v5
v_lshl_add_u32 v144, v6, 4, v5
v_add_u32 v145, 8192, v144
v_add_u32 v146, 18432, v144
v_add_u32 v147, 26624, v144
s_lshl_b32 s47, s32, 5
s_add_u32 s55, s46, s47
s_mul_i32 s43, s55, 1152
s_and_b32 s74, s34, 7
s_mul_i32 s74, s74, 1
s_mul_i32 s47, s36, 2
s_add_u32 s74, s74, s47
s_mul_i32 s47, s74, 57
s_lshr_b32 s47, s47, 9
s_mul_i32 s47, s47, 9
s_sub_u32 s74, s74, s47
s_movk_i32 s73, -1024
s_lshl_b32 s47, s74, 7
s_add_u32 s43, s43, s47
s_lshl_b32 s37, s32, 12
s_lshr_b32 s46, s35, 1
s_lshl_b32 s47, s46, 11
s_or_b32 s45, s37, s47
s_xor_b32 s85, s45, 2048
s_lshl_b32 s46, s46, 4
s_add_u32 s55, s55, s46
s_mov_b32 s26, 0x240000
s_mov_b32 s27, 0x00020000
s_waitcnt lgkmcnt(0)
s_mov_b32 s24, s88
s_and_b32 s25, s89, 0xffff
buffer_load_dwordx3 v[12:14], v10, s[24:27], 0 offen offset:0
buffer_load_dwordx3 v[16:18], v10, s[24:27], 0 offen offset:384
buffer_load_dwordx3 v[20:22], v10, s[24:27], 0 offen offset:768
s_mov_b32 s28, s86
s_and_b32 s29, s87, 0xffff
s_mov_b32 s30, 0x480
s_mov_b32 s31, 0x00020000
s_add_u32 m0, s45, 32768
s_nop 0
buffer_load_dwordx4 v144, s[24:27], s43 offen offset:0 lds
buffer_load_dwordx4 v145, s[24:27], s43 offen offset:1024 lds
s_add_u32 m0, s85, 32768
s_nop 0
buffer_load_dwordx4 v146, s[24:27], s43 offen offset:0 lds
buffer_load_dwordx4 v147, s[24:27], s43 offen offset:1024 lds
s_cmp_eq_u32 s74, 8
s_cselect_b32 s72, s73, 128
s_add_u32 s43, s43, s72
s_mov_b32 s16, s94
s_and_b32 s17, s95, 0xffff
s_mov_b32 s18, 0x480000
s_mov_b32 s19, 0x00020000
v_lshrrev_b32 v5, 5, v1
v_and_b32 v6, 31, v1
v_lshlrev_b32 v7, 1, v5
v_xor_b32 v6, v6, v7
v_lshlrev_b32 v6, 4, v6
v_lshl_add_u32 v136, v5, 13, v6
s_lshl_b32 s42, s33, 9
s_lshl_b32 s46, s32, 17
s_add_u32 s42, s42, s46
s_lshl_b32 s44, s32, 13
s_lshl_b32 s46, s74, 19
s_add_u32 s42, s42, s46
v_xor_b32 v137, 64, v136
v_add_u32 v137, 15360, v137
v_add_u32 v138, 30720, v136
v_xor_b32 v139, 64, v136
v_add_u32 v139, 46080, v139
v_xor_b32 v140, 128, v136
v_add_u32 v140, 65536, v140
v_xor_b32 v141, 192, v136
v_add_u32 v141, 80896, v141
v_xor_b32 v142, 128, v136
v_add_u32 v142, 96256, v142
v_xor_b32 v143, 192, v136
v_add_u32 v143, 111616, v143
s_add_u32 m0, s44, 0
s_nop 0
buffer_load_dwordx4 v136, s[16:19], s42 offen offset:0 lds
buffer_load_dwordx4 v137, s[16:19], s42 offen offset:1024 lds
buffer_load_dwordx4 v138, s[16:19], s42 offen offset:2048 lds
buffer_load_dwordx4 v139, s[16:19], s42 offen offset:3072 lds
s_add_u32 m0, s44, 4096
s_nop 0
buffer_load_dwordx4 v140, s[16:19], s42 offen offset:0 lds
s_load_dwordx2 s[68:69], s[0:1], 32
s_load_dwordx4 s[56:59], s[0:1], 56
s_load_dwordx4 s[64:67], s[0:1], 72
s_mov_b32 s100, 0
v_and_b32 v3, 15, v1
v_lshrrev_b32 v4, 4, v1
v_lshlrev_b32 v234, 4, v1
v_mov_b32 v255, 1
s_lshl_b32 s46, s33, 19
s_add_u32 s8, s90, s46
s_addc_u32 s9, s91, 0
s_and_b32 s9, s9, 0xffff
s_mov_b32 s10, 0x80000
s_mov_b32 s11, 0x00020000
s_add_u32 s12, s92, s46
s_addc_u32 s13, s93, 0
s_and_b32 s13, s13, 0xffff
s_mov_b32 s14, 0x80000
s_mov_b32 s15, 0x00020000
s_mov_b32 s20, s6
s_and_b32 s21, s7, 0xffff
s_mov_b32 s22, 0x4000000
s_mov_b32 s23, 0x00020000
v_bfe_u32 v248, v1, 2, 2
v_and_b32 v249, 3, v1
v_and_b32 v5, 1, v4
v_lshl_add_u32 v5, v5, 2, v248
s_lshl_b32 s46, s32, 1
v_xor_b32 v5, s46, v5
v_lshlrev_b32 v5, 5, v5
v_lshl_add_u32 v6, v4, 3, v248
v_lshl_add_u32 v5, v6, 9, v5
v_lshl_add_u32 v184, v249, 3, v5
v_xor_b32 v185, 32, v184
v_xor_b32 v186, 64, v184
v_xor_b32 v187, 96, v184
v_xor_b32 v188, 128, v184
v_xor_b32 v189, 160, v184
v_xor_b32 v190, 192, v184
v_xor_b32 v191, 224, v184
v_and_b32 v5, 7, v3
v_xor_b32 v5, v5, v4
v_lshlrev_b32 v5, 4, v5
v_lshl_add_u32 v5, v3, 7, v5
v_add_u32 v5, s37, v5
v_add_u32 v192, 0x8000, v5
v_xor_b32 v193, 64, v192
v_add_u32 v194, 0x18000, v184
v_add_u32 v195, 0x18000, v185
v_add_u32 v196, 0x18000, v186
v_add_u32 v197, 0x18000, v187
v_add_u32 v198, 0x18000, v188
v_add_u32 v199, 0x18000, v189
v_add_u32 v200, 0x18000, v190
v_add_u32 v201, 0x18000, v191
v_add_u32 v202, 0x18000, v192
v_add_u32 v203, 0x18000, v193
v_add_u32 v204, 0xc000, v184
v_add_u32 v205, 0xc000, v185
v_add_u32 v206, 0xc000, v186
v_add_u32 v207, 0xc000, v187
v_add_u32 v208, 0xc000, v188
v_add_u32 v209, 0xc000, v189
v_add_u32 v210, 0xc000, v190
v_add_u32 v211, 0xc000, v191
v_add_u32 v212, 0xc000, v192
v_add_u32 v213, 0xc000, v193
v_lshrrev_b32 v5, 1, v4
v_and_b32 v6, 7, v3
v_xor_b32 v5, v5, v6
v_lshlrev_b32 v5, 4, v5
v_lshl_add_u32 v5, v3, 7, v5
v_and_b32 v6, 1, v4
v_lshl_add_u32 v241, v6, 3, v5
s_lshl_b32 s83, s36, 1
s_and_b32 s46, s35, 1
s_add_u32 s83, s83, s46
s_sub_u32 s83, s83, s74
s_cselect_b32 s46, 9, 0
s_add_u32 s83, s83, s46
s_add_u32 s46, s37, 0x8000
v_add_u32 v152, s46, v241
v_xor_b32 v153, 32, v152
v_xor_b32 v154, 64, v152
v_xor_b32 v155, 96, v152
s_lshl_b32 s46, s36, 5
v_xor_b32 v156, s46, v152
s_lshr_b32 s40, 0x100, s74
s_bitset1_b32 s40, s83
v_bfe_u32 v5, v1, 1, 1
v_bfe_u32 v6, v1, 5, 1
v_cmp_eq_u32 vcc, v5, v6
v_mov_b32 v7, 0x3f803f80
v_and_b32 v5, 1, v1
v_cndmask_b32 v7, 0, v7, vcc
v_accvgpr_write_b32 a208, v7
v_accvgpr_write_b32 a209, v7
v_accvgpr_write_b32 a210, v7
v_accvgpr_write_b32 a211, v7
v_mul_u32_u24 v5, 0xaaaa, v5
v_add_u32 v235, 0x4444, v5
v_accvgpr_write_b32 a248, 0
v_accvgpr_write_b32 a249, 0
v_accvgpr_write_b32 a250, 0
v_accvgpr_write_b32 a251, 0
v_accvgpr_write_b32 a252, 0
v_accvgpr_write_b32 a253, 0
v_accvgpr_write_b32 a254, 0
v_accvgpr_write_b32 a255, 0
s_lshl_b32 s46, s34, 2
s_add_u32 s47, s46, s35
s_lshl_b32 s47, s47, 2
s_add_u32 s47, s47, s32
s_lshl_b32 s54, s47, 7
s_add_u32 s54, s54, 0x250000
s_add_u32 s47, s46, s36
s_lshl_b32 s47, s47, 2
s_add_u32 s47, s47, s32
s_lshl_b32 s47, s47, 7
s_add_u32 s47, s47, s35
s_lshl_b32 s47, s47, 2
s_add_u32 s38, s47, 0x280000
s_add_u32 s46, s46, s32
s_lshl_b32 s46, s46, 5
s_add_u32 s46, s46, s33
s_lshl_b32 s46, s46, 2
s_add_u32 s39, s46, 0x260000
s_lshl_b32 s46, s36, 3
s_add_u32 s46, s46, s54
s_add_u32 s47, s46, 4
v_lshl_add_u32 v60, v1, 7, s38
buffer_load_dwordx4 v141, s[16:19], s42 offen offset:1024 lds
v_mov_b32 v61, 0
v_writelane_b32 v60, s46, 4
v_writelane_b32 v60, s47, 5
v_writelane_b32 v60, s39, 6
s_lshl_b32 s46, s34, 2
s_add_u32 s46, s46, s35
s_lshl_b32 s46, s46, 3
s_add_u32 s46, s46, 0x270000
s_or_b32 s47, s36, s32
s_cselect_b32 s46, 0x7f000000, s46
v_writelane_b32 v60, s46, 7
s_add_u32 s46, s46, 4
v_writelane_b32 v60, s46, 8
s_lshl_b32 s47, s32, 8
s_or_b32 s47, s47, s2
s_lshl_b32 s46, s2, 7
s_add_u32 s46, s46, 0x272000
s_cmp_lt_u32 s47, 32
s_cselect_b32 s46, s46, 0x7f000000
v_writelane_b32 v60, s46, 9
s_getpc_b64 s[96:97]
PC_a:
s_sub_u32 s96, s96, PC_a-recurrent_scan__gqa_block_cached__moe_arch_mod__prompt_kernel
s_subb_u32 s97, s97, 0
s_lshr_b32 s46, s2, 3
s_lshl_b32 s46, s46, 2
s_add_u32 s46, s46, s32
s_min_u32 s46, s46, (K_CODE_END-recurrent_scan__gqa_block_cached__moe_arch_mod__prompt_kernel)>>10
s_lshl_b32 s46, s46, 10
v_lshlrev_b32 v7, 4, v1
buffer_load_dwordx4 v142, s[16:19], s42 offen offset:2048 lds
v_add_u32 v7, s46, v7
global_load_dwordx4 a[0:3], v7, s[96:97]
s_waitcnt lgkmcnt(0)
s_lshl_b32 s46, s32, 2
v_bfrev_b32 v5, v4
v_lshrrev_b32 v5, 30, v5
v_xor_b32 v5, s46, v5
v_xor_b32 v5, v5, v3
v_lshlrev_b32 v5, 4, v5
v_lshl_add_u32 v216, v3, 8, v5
v_xor_b32 v217, 64, v216
v_xor_b32 v218, 128, v216
v_xor_b32 v219, 192, v216
v_lshl_add_u32 v6, v4, 2, v248
v_and_b32 v5, 7, v6
v_lshlrev_b32 v5, 5, v5
v_lshl_add_u32 v5, v6, 8, v5
v_lshl_add_u32 v5, v249, 3, v5
v_add_u32 v220, 0x10000, v5
v_xor_b32 v221, 32, v220
v_xor_b32 v222, 64, v220
v_xor_b32 v223, 96, v220
v_xor_b32 v224, 128, v220
v_xor_b32 v225, 160, v220
buffer_load_dwordx4 v143, s[16:19], s42 offen offset:3072 lds
v_xor_b32 v226, 192, v220
v_xor_b32 v227, 224, v220
v_xor_b32 v5, v4, v3
v_lshlrev_b32 v5, 4, v5
v_lshl_add_u32 v5, v4, 8, v5
v_add_u32 v228, s37, v5
v_xor_b32 v229, 64, v228
v_xor_b32 v230, 128, v228
v_xor_b32 v231, 192, v228
v_lshlrev_b32 v5, 1, v4
v_xor_b32 v5, v5, v3
v_lshlrev_b32 v5, 4, v5
v_lshl_add_u32 v5, v4, 8, v5
v_add_u32 v232, s37, v5
v_xor_b32 v233, 128, v232
s_mov_b32 s41, 0
s_lshl_b32 s49, s32, 13
s_add_u32 s49, s49, 131072
s_lshl_b32 s3, s32, 10
s_lshl_b32 s53, s34, 4
s_add_u32 s53, s53, s33
s_lshl_b32 s53, s53, 2
s_add_u32 s53, s53, s32
s_lshl_b32 s53, s53, 14
s_add_u32 s53, s53, 0x400000
v_add_u32 v5, s46, v4
s_lshl_b32 s72, s72, 12
s_add_u32 s42, s42, s72
s_nop 0
buffer_load_dwordx3 v[24:26], v11, s[28:31], 0 offen offset:0
v_and_b32 v6, 7, v5
v_lshlrev_b32 v6, 1, v6
v_xor_b32 v6, v6, v3
v_mul_u32_u24 v5, 0x480, v5
v_lshl_add_u32 v236, v6, 4, v5
v_lshrrev_b32 v5, 3, v0
v_and_b32 v6, 6, v5
v_and_b32 v7, 7, v1
v_xor_b32 v6, v6, v7
v_mul_u32_u24 v5, 0x480, v5
v_lshl_add_u32 v237, v6, 4, v5
v_lshrrev_b32 v5, 2, v1
v_mul_u32_u24 v5, 0x2400, v5
v_lshl_add_u32 v238, v249, 4, v5
s_lshl_b32 s47, s36, 8
s_mul_i32 s84, s35, 1179648
s_add_u32 s84, s84, s47
s_mul_i32 s75, s33, 294912
s_add_u32 s51, s75, s47
s_add_u32 s75, s75, 1024
s_mov_b64 s[86:87], s[68:69]
s_mov_b64 s[88:89], s[56:57]
s_mov_b64 s[90:91], s[58:59]
s_mov_b32 s68, s66
s_and_b32 s69, s67, 0xffff
s_mov_b32 s70, 0x240000
s_mov_b32 s71, 0x00020000
s_mov_b32 s64, s64
s_and_b32 s65, s65, 0xffff
s_mov_b32 s66, 0x510000
s_mov_b32 s67, 0x00020000
s_mov_b32 s56, s88
s_and_b32 s57, s89, 0xffff
s_mov_b32 s58, 0x510000
s_mov_b32 s59, 0x00020000
s_mov_b32 s60, s90
s_and_b32 s61, s91, 0xffff
s_mov_b32 s62, 0x510000
s_mov_b32 s63, 0x00020000
s_mov_b32 s52, 0
s_and_b32 s82, s35, 1
s_lshl_b32 s82, s82, 7
s_mul_i32 s80, s55, 1152
s_lshl_b32 s46, s36, 5
s_add_u32 s81, s80, s46
s_add_u32 s81, s81, 1024
s_add_u32 s80, s80, s47
s_add_u32 s80, s80, s82
s_bitcmp1_b32 s35, 0
s_cselect_b32 s81, 0x7f000000, s81
v_mov_b32 v239, v144
buffer_load_dwordx3 v[28:30], v11, s[28:31], 0 offen offset:384
v_mul_u32_u24 v5, 0x480, v3
v_lshl_add_u32 v240, v4, 3, v5
v_min_u32 v243, 35, v1
v_lshlrev_b32 v243, 7, v243
v_lshlrev_b32 v251, 3, v1
v_accvgpr_write_b32 a16, 0
v_accvgpr_write_b32 a17, 0
v_accvgpr_write_b32 a18, 0
v_accvgpr_write_b32 a19, 0
v_accvgpr_write_b32 a20, 0
v_accvgpr_write_b32 a21, 0
v_accvgpr_write_b32 a22, 0
v_accvgpr_write_b32 a23, 0
v_accvgpr_write_b32 a24, 0
v_accvgpr_write_b32 a25, 0
v_accvgpr_write_b32 a26, 0
v_accvgpr_write_b32 a27, 0
v_accvgpr_write_b32 a28, 0
v_accvgpr_write_b32 a29, 0
v_accvgpr_write_b32 a30, 0
v_accvgpr_write_b32 a31, 0
v_accvgpr_write_b32 a32, 0
v_accvgpr_write_b32 a33, 0
v_accvgpr_write_b32 a34, 0
buffer_load_dwordx3 v[32:34], v11, s[28:31], 0 offen offset:768
v_accvgpr_write_b32 a35, 0
v_accvgpr_write_b32 a36, 0
v_accvgpr_write_b32 a37, 0
v_accvgpr_write_b32 a38, 0
v_accvgpr_write_b32 a39, 0
v_accvgpr_write_b32 a40, 0
v_accvgpr_write_b32 a41, 0
v_accvgpr_write_b32 a42, 0
v_accvgpr_write_b32 a43, 0
v_accvgpr_write_b32 a44, 0
v_accvgpr_write_b32 a45, 0
v_accvgpr_write_b32 a46, 0
v_accvgpr_write_b32 a47, 0
v_accvgpr_write_b32 a48, 0
v_accvgpr_write_b32 a49, 0
v_accvgpr_write_b32 a50, 0
v_accvgpr_write_b32 a51, 0
v_accvgpr_write_b32 a52, 0
v_accvgpr_write_b32 a53, 0
v_accvgpr_write_b32 a54, 0
v_accvgpr_write_b32 a55, 0
v_accvgpr_write_b32 a56, 0
v_accvgpr_write_b32 a57, 0
v_accvgpr_write_b32 a58, 0
s_add_u32 m0, s45, 131072
s_nop 0
buffer_load_dwordx4 v144, s[24:27], s43 offen offset:0 lds
v_accvgpr_write_b32 a59, 0
v_accvgpr_write_b32 a60, 0
v_accvgpr_write_b32 a61, 0
v_accvgpr_write_b32 a62, 0
v_accvgpr_write_b32 a63, 0
v_accvgpr_write_b32 a64, 0
v_accvgpr_write_b32 a65, 0
v_accvgpr_write_b32 a66, 0
v_accvgpr_write_b32 a67, 0
v_accvgpr_write_b32 a68, 0
v_accvgpr_write_b32 a69, 0
v_accvgpr_write_b32 a70, 0
v_accvgpr_write_b32 a71, 0
v_accvgpr_write_b32 a72, 0
v_accvgpr_write_b32 a73, 0
v_accvgpr_write_b32 a74, 0
v_accvgpr_write_b32 a75, 0
v_accvgpr_write_b32 a76, 0
v_accvgpr_write_b32 a77, 0
v_accvgpr_write_b32 a78, 0
v_accvgpr_write_b32 a79, 0
v_accvgpr_write_b32 a80, 0
v_accvgpr_write_b32 a81, 0
v_accvgpr_write_b32 a82, 0
buffer_load_dwordx4 v145, s[24:27], s43 offen offset:1024 lds
v_accvgpr_write_b32 a83, 0
v_accvgpr_write_b32 a84, 0
v_accvgpr_write_b32 a85, 0
v_accvgpr_write_b32 a86, 0
v_accvgpr_write_b32 a87, 0
v_accvgpr_write_b32 a88, 0
v_accvgpr_write_b32 a89, 0
v_accvgpr_write_b32 a90, 0
v_accvgpr_write_b32 a91, 0
v_accvgpr_write_b32 a92, 0
v_accvgpr_write_b32 a93, 0
v_accvgpr_write_b32 a94, 0
v_accvgpr_write_b32 a95, 0
v_accvgpr_write_b32 a96, 0
v_accvgpr_write_b32 a97, 0
v_accvgpr_write_b32 a98, 0
v_accvgpr_write_b32 a99, 0
v_accvgpr_write_b32 a100, 0
v_accvgpr_write_b32 a101, 0
v_accvgpr_write_b32 a102, 0
v_accvgpr_write_b32 a103, 0
v_accvgpr_write_b32 a104, 0
v_accvgpr_write_b32 a105, 0
v_accvgpr_write_b32 a106, 0
s_add_u32 m0, s85, 131072
s_nop 0
buffer_load_dwordx4 v146, s[24:27], s43 offen offset:0 lds
v_accvgpr_write_b32 a107, 0
v_accvgpr_write_b32 a108, 0
v_accvgpr_write_b32 a109, 0
v_accvgpr_write_b32 a110, 0
v_accvgpr_write_b32 a111, 0
v_accvgpr_write_b32 a112, 0
v_accvgpr_write_b32 a113, 0
v_accvgpr_write_b32 a114, 0
v_accvgpr_write_b32 a115, 0
v_accvgpr_write_b32 a116, 0
v_accvgpr_write_b32 a117, 0
v_accvgpr_write_b32 a118, 0
v_accvgpr_write_b32 a119, 0
v_accvgpr_write_b32 a120, 0
v_accvgpr_write_b32 a121, 0
v_accvgpr_write_b32 a122, 0
v_accvgpr_write_b32 a123, 0
v_accvgpr_write_b32 a124, 0
v_accvgpr_write_b32 a125, 0
v_accvgpr_write_b32 a126, 0
v_accvgpr_write_b32 a127, 0
s_mov_b32 s92, 0x3ae38e39
s_mov_b32 s93, 0x3727c5ac
s_mov_b32 s94, 0xffff0000
v_and_b32 v5, 3, v1
buffer_load_dwordx4 v147, s[24:27], s43 offen offset:1024 lds
v_lshlrev_b32 v5, 21, v5
buffer_load_dword a7, v61, s[8:11], 0 offen
buffer_load_dword a8, v61, s[12:15], 0 offen
buffer_load_dword a9, v5, s[16:19], 0 offen
s_mov_b64 exec, 0x3ff
buffer_store_dword v61, v60, s[20:23], 0 offen sc0 sc1
s_mov_b64 exec, -1
s_waitcnt vmcnt(24)
v_lshlrev_b32 v40, 16, v12
v_and_b32 v41, s94, v12
v_lshlrev_b32 v42, 16, v13
v_and_b32 v43, s94, v13
v_lshlrev_b32 v44, 16, v14
v_and_b32 v45, s94, v14
v_lshlrev_b32 v46, 16, v16
v_and_b32 v47, s94, v16
v_lshlrev_b32 v48, 16, v17
v_and_b32 v49, s94, v17
v_lshlrev_b32 v50, 16, v18
v_and_b32 v51, s94, v18
v_lshlrev_b32 v52, 16, v20
v_and_b32 v53, s94, v20
v_lshlrev_b32 v54, 16, v21
v_and_b32 v55, s94, v21
s_cmp_eq_u32 s74, 7
s_cselect_b32 s72, s73, 128
s_add_u32 s43, s43, s72
s_add_u32 m0, s44, 98304
s_nop 0
buffer_load_dwordx4 v136, s[16:19], s42 offen offset:0 lds
v_lshlrev_b32 v56, 16, v22
v_and_b32 v57, s94, v22
v_pk_add_f32 v[64:65], v[40:41], v[42:43]
v_pk_add_f32 v[66:67], v[44:45], v[46:47]
v_pk_add_f32 v[64:65], v[64:65], v[48:49]
v_pk_add_f32 v[66:67], v[66:67], v[50:51]
v_pk_add_f32 v[64:65], v[64:65], v[52:53]
v_pk_add_f32 v[66:67], v[66:67], v[54:55]
v_pk_add_f32 v[64:65], v[64:65], v[56:57]
v_pk_add_f32 v[64:65], v[64:65], v[66:67]
v_add_f32 v64, v64, v65
s_nop 1
v_add_f32_dpp v65, v64, v64 row_ror:8 row_mask:0xf bank_mask:0xf
s_nop 1
v_add_f32_dpp v64, v65, v65 row_ror:4 row_mask:0xf bank_mask:0xf
s_nop 1
v_add_f32_dpp v65, v64, v64 row_ror:2 row_mask:0xf bank_mask:0xf
s_nop 1
v_add_f32_dpp v64, v65, v65 row_ror:1 row_mask:0xf bank_mask:0xf
v_mov_b32 v65, v64
s_nop 1
v_permlane16_swap_b32 v64, v65
v_add_f32 v64, v64, v65
v_mul_f32 v64, s92, v64
buffer_load_dwordx4 v137, s[16:19], s42 offen offset:1024 lds
v_pk_add_f32 v[72:73], v[40:41], v[64:65] op_sel_hi:[1,0] neg_lo:[0,1] neg_hi:[0,1]
v_pk_add_f32 v[74:75], v[42:43], v[64:65] op_sel_hi:[1,0] neg_lo:[0,1] neg_hi:[0,1]
v_pk_add_f32 v[76:77], v[44:45], v[64:65] op_sel_hi:[1,0] neg_lo:[0,1] neg_hi:[0,1]
v_pk_add_f32 v[78:79], v[46:47], v[64:65] op_sel_hi:[1,0] neg_lo:[0,1] neg_hi:[0,1]
v_pk_add_f32 v[80:81], v[48:49], v[64:65] op_sel_hi:[1,0] neg_lo:[0,1] neg_hi:[0,1]
v_pk_add_f32 v[82:83], v[50:51], v[64:65] op_sel_hi:[1,0] neg_lo:[0,1] neg_hi:[0,1]
v_pk_add_f32 v[84:85], v[52:53], v[64:65] op_sel_hi:[1,0] neg_lo:[0,1] neg_hi:[0,1]
v_pk_add_f32 v[86:87], v[54:55], v[64:65] op_sel_hi:[1,0] neg_lo:[0,1] neg_hi:[0,1]
v_pk_add_f32 v[88:89], v[56:57], v[64:65] op_sel_hi:[1,0] neg_lo:[0,1] neg_hi:[0,1]
v_pk_mul_f32 v[66:67], v[72:73], v[72:73]
v_pk_mul_f32 v[68:69], v[74:75], v[74:75]
v_pk_fma_f32 v[66:67], v[76:77], v[76:77], v[66:67]
v_pk_fma_f32 v[68:69], v[78:79], v[78:79], v[68:69]
v_pk_fma_f32 v[66:67], v[80:81], v[80:81], v[66:67]
v_pk_fma_f32 v[68:69], v[82:83], v[82:83], v[68:69]
v_pk_fma_f32 v[66:67], v[84:85], v[84:85], v[66:67]
v_pk_fma_f32 v[68:69], v[86:87], v[86:87], v[68:69]
v_pk_fma_f32 v[66:67], v[88:89], v[88:89], v[66:67]
v_pk_add_f32 v[66:67], v[66:67], v[68:69]
v_add_f32 v69, v66, v67
v_cvt_pk_bf16_f32 v64, v64, v64
v_lshlrev_b32 v64, 16, v64
v_pk_add_f32 v[40:41], v[40:41], v[64:65] op_sel_hi:[1,0] neg_lo:[0,1] neg_hi:[0,1]
v_cvt_pk_bf16_f32 v12, v40, v41
buffer_load_dwordx4 v138, s[16:19], s42 offen offset:2048 lds
v_add_f32_dpp v68, v69, v69 row_ror:8 row_mask:0xf bank_mask:0xf
v_pk_add_f32 v[42:43], v[42:43], v[64:65] op_sel_hi:[1,0] neg_lo:[0,1] neg_hi:[0,1]
v_cvt_pk_bf16_f32 v13, v42, v43
v_add_f32_dpp v69, v68, v68 row_ror:4 row_mask:0xf bank_mask:0xf
v_pk_add_f32 v[44:45], v[44:45], v[64:65] op_sel_hi:[1,0] neg_lo:[0,1] neg_hi:[0,1]
v_cvt_pk_bf16_f32 v14, v44, v45
v_add_f32_dpp v68, v69, v69 row_ror:2 row_mask:0xf bank_mask:0xf
v_pk_add_f32 v[46:47], v[46:47], v[64:65] op_sel_hi:[1,0] neg_lo:[0,1] neg_hi:[0,1]
v_cvt_pk_bf16_f32 v16, v46, v47
v_add_f32_dpp v69, v68, v68 row_ror:1 row_mask:0xf bank_mask:0xf
v_mov_b32 v68, v69
v_pk_add_f32 v[48:49], v[48:49], v[64:65] op_sel_hi:[1,0] neg_lo:[0,1] neg_hi:[0,1]
v_cvt_pk_bf16_f32 v17, v48, v49
v_permlane16_swap_b32 v69, v68
v_add_f32 v69, v69, v68
v_mul_f32 v69, s92, v69
v_cvt_pk_bf16_f32 v69, v69, v69
v_lshlrev_b32 v69, 16, v69
v_add_f32 v69, s93, v69
v_cvt_pk_bf16_f32 v69, v69, v69
v_lshlrev_b32 v69, 16, v69
v_sqrt_f32 v69, v69
v_pk_add_f32 v[50:51], v[50:51], v[64:65] op_sel_hi:[1,0] neg_lo:[0,1] neg_hi:[0,1]
v_cvt_pk_bf16_f32 v18, v50, v51
buffer_load_dwordx4 v139, s[16:19], s42 offen offset:3072 lds
v_cvt_pk_bf16_f32 v65, v69, v69
v_lshlrev_b32 v65, 16, v65
v_rcp_f32 v66, v65
v_pk_add_f32 v[52:53], v[52:53], v[64:65] op_sel_hi:[1,0] neg_lo:[0,1] neg_hi:[0,1]
v_cvt_pk_bf16_f32 v20, v52, v53
v_pk_add_f32 v[54:55], v[54:55], v[64:65] op_sel_hi:[1,0] neg_lo:[0,1] neg_hi:[0,1]
v_cvt_pk_bf16_f32 v21, v54, v55
v_pk_add_f32 v[56:57], v[56:57], v[64:65] op_sel_hi:[1,0] neg_lo:[0,1] neg_hi:[0,1]
v_cvt_pk_bf16_f32 v22, v56, v57
v_lshlrev_b32 v40, 16, v12
v_and_b32 v41, s94, v12
v_lshlrev_b32 v42, 16, v13
v_and_b32 v43, s94, v13
v_lshlrev_b32 v44, 16, v14
v_and_b32 v45, s94, v14
v_lshlrev_b32 v46, 16, v16
v_and_b32 v47, s94, v16
v_lshlrev_b32 v48, 16, v17
v_and_b32 v49, s94, v17
v_lshlrev_b32 v50, 16, v18
v_and_b32 v51, s94, v18
v_lshlrev_b32 v52, 16, v20
v_and_b32 v53, s94, v20
v_lshlrev_b32 v54, 16, v21
s_add_u32 m0, s44, 102400
s_nop 0
buffer_load_dwordx4 v140, s[16:19], s42 offen offset:0 lds
v_and_b32 v55, s94, v21
v_lshlrev_b32 v56, 16, v22
v_and_b32 v57, s94, v22
v_lshlrev_b32 v5, 3, v8
s_mov_b32 s46, 0x240000
s_mov_b32 exec_lo, 1
s_mov_b32 exec_hi, 1
buffer_store_dwordx2 v[64:65], v5, s[20:23], s46 offen sc0 sc1
s_mov_b64 exec, -1
v_mov_b32 v70, 0
s_waitcnt lgkmcnt(0)
v_pk_mul_f32 v[72:73], v[40:41], v[66:67] op_sel_hi:[1,0]
v_pk_fma_f32 v[40:41], v[72:73], v[64:65], v[40:41] op_sel:[0,1,0] op_sel_hi:[1,1,1] neg_lo:[1,0,0] neg_hi:[1,0,0]
v_pk_fma_f32 v[72:73], v[40:41], v[66:67], v[72:73] op_sel_hi:[1,0,1]
v_cvt_pk_bf16_f32 v12, v72, v73
v_pk_mul_f32 v[74:75], v[42:43], v[66:67] op_sel_hi:[1,0]
v_pk_fma_f32 v[42:43], v[74:75], v[64:65], v[42:43] op_sel:[0,1,0] op_sel_hi:[1,1,1] neg_lo:[1,0,0] neg_hi:[1,0,0]
v_pk_fma_f32 v[74:75], v[42:43], v[66:67], v[74:75] op_sel_hi:[1,0,1]
v_cvt_pk_bf16_f32 v13, v74, v75
v_pk_mul_f32 v[76:77], v[44:45], v[66:67] op_sel_hi:[1,0]
v_pk_fma_f32 v[44:45], v[76:77], v[64:65], v[44:45] op_sel:[0,1,0] op_sel_hi:[1,1,1] neg_lo:[1,0,0] neg_hi:[1,0,0]
v_pk_fma_f32 v[76:77], v[44:45], v[66:67], v[76:77] op_sel_hi:[1,0,1]
v_cvt_pk_bf16_f32 v14, v76, v77
buffer_store_dwordx3 v[12:14], v10, s[20:23], 0 offen offset:0 sc0 sc1
v_pk_mul_f32 v[78:79], v[46:47], v[66:67] op_sel_hi:[1,0]
buffer_load_dwordx4 v141, s[16:19], s42 offen offset:1024 lds
v_pk_fma_f32 v[46:47], v[78:79], v[64:65], v[46:47] op_sel:[0,1,0] op_sel_hi:[1,1,1] neg_lo:[1,0,0] neg_hi:[1,0,0]
v_pk_fma_f32 v[78:79], v[46:47], v[66:67], v[78:79] op_sel_hi:[1,0,1]
v_cvt_pk_bf16_f32 v16, v78, v79
v_pk_mul_f32 v[80:81], v[48:49], v[66:67] op_sel_hi:[1,0]
v_pk_fma_f32 v[48:49], v[80:81], v[64:65], v[48:49] op_sel:[0,1,0] op_sel_hi:[1,1,1] neg_lo:[1,0,0] neg_hi:[1,0,0]
v_pk_fma_f32 v[80:81], v[48:49], v[66:67], v[80:81] op_sel_hi:[1,0,1]
v_cvt_pk_bf16_f32 v17, v80, v81
v_pk_mul_f32 v[82:83], v[50:51], v[66:67] op_sel_hi:[1,0]
v_pk_fma_f32 v[50:51], v[82:83], v[64:65], v[50:51] op_sel:[0,1,0] op_sel_hi:[1,1,1] neg_lo:[1,0,0] neg_hi:[1,0,0]
v_pk_fma_f32 v[82:83], v[50:51], v[66:67], v[82:83] op_sel_hi:[1,0,1]
v_cvt_pk_bf16_f32 v18, v82, v83
buffer_store_dwordx3 v[16:18], v10, s[20:23], 0 offen offset:384 sc0 sc1
v_pk_mul_f32 v[84:85], v[52:53], v[66:67] op_sel_hi:[1,0]
v_pk_fma_f32 v[52:53], v[84:85], v[64:65], v[52:53] op_sel:[0,1,0] op_sel_hi:[1,1,1] neg_lo:[1,0,0] neg_hi:[1,0,0]
v_pk_fma_f32 v[84:85], v[52:53], v[66:67], v[84:85] op_sel_hi:[1,0,1]
v_cvt_pk_bf16_f32 v20, v84, v85
v_pk_mul_f32 v[86:87], v[54:55], v[66:67] op_sel_hi:[1,0]
v_pk_fma_f32 v[54:55], v[86:87], v[64:65], v[54:55] op_sel:[0,1,0] op_sel_hi:[1,1,1] neg_lo:[1,0,0] neg_hi:[1,0,0]
v_pk_fma_f32 v[86:87], v[54:55], v[66:67], v[86:87] op_sel_hi:[1,0,1]
v_cvt_pk_bf16_f32 v21, v86, v87
v_pk_mul_f32 v[88:89], v[56:57], v[66:67] op_sel_hi:[1,0]
v_pk_fma_f32 v[56:57], v[88:89], v[64:65], v[56:57] op_sel:[0,1,0] op_sel_hi:[1,1,1] neg_lo:[1,0,0] neg_hi:[1,0,0]
v_pk_fma_f32 v[88:89], v[56:57], v[66:67], v[88:89] op_sel_hi:[1,0,1]
v_cvt_pk_bf16_f32 v22, v88, v89
buffer_load_dwordx4 v142, s[16:19], s42 offen offset:2048 lds
buffer_store_dwordx3 v[20:22], v10, s[20:23], 0 offen offset:768 sc0 sc1
s_waitcnt vmcnt(19)
v_dot2_f32_bf16 v70, v12, v24, v70
v_dot2_f32_bf16 v70, v13, v25, v70
v_dot2_f32_bf16 v70, v14, v26, v70
v_dot2_f32_bf16 v70, v16, v28, v70
v_dot2_f32_bf16 v70, v17, v29, v70
v_dot2_f32_bf16 v70, v18, v30, v70
v_dot2_f32_bf16 v70, v20, v32, v70
v_dot2_f32_bf16 v70, v21, v33, v70
v_dot2_f32_bf16 v70, v22, v34, v70
v_sub_u32 v68, 2047, v8
v_lshlrev_b32 v5, 2, v8
s_nop 1
v_add_f32_dpp v71, v70, v70 row_ror:8 row_mask:0xf bank_mask:0xf
s_nop 1
v_add_f32_dpp v70, v71, v71 row_ror:4 row_mask:0xf bank_mask:0xf
s_nop 1
v_add_f32_dpp v71, v70, v70 row_ror:2 row_mask:0xf bank_mask:0xf
s_nop 1
v_add_f32_dpp v70, v71, v71 row_ror:1 row_mask:0xf bank_mask:0xf
v_mov_b32 v71, v70
s_nop 1
v_permlane16_swap_b32 v70, v71
buffer_load_dwordx4 v143, s[16:19], s42 offen offset:3072 lds
s_lshl_b32 s72, s72, 12
s_add_u32 s42, s42, s72
v_add_f32 v70, v70, v71
v_cvt_pk_bf16_f32 v70, v70, v70
v_ashrrev_i32 v71, 31, v70
v_or_b32 v71, 0x80000000, v71
v_xor_b32 v70, v70, v71
v_and_or_b32 v214, v70, s94, v68
s_mov_b32 s46, 0x244000
s_mov_b32 exec_lo, 1
s_mov_b32 exec_hi, 1
buffer_store_dword v214, v5, s[20:23], s46 offen sc0 sc1
s_mov_b64 exec, -1
s_mov_b32 s28, s4
s_and_b32 s29, s5, 0xffff
s_mov_b32 s30, 0x100
s_mov_b32 s31, 0x00020000
s_waitcnt vmcnt(24)
s_barrier
ds_read_b128 a[192:195], v192 offset:0
ds_read_b128 a[196:199], v192 offset:2048
ds_read_b64_tr_b16 a[128:129], v184 offset:0
ds_read_b64_tr_b16 a[130:131], v184 offset:2048
ds_read_b64_tr_b16 a[132:133], v185 offset:0
ds_read_b64_tr_b16 a[134:135], v185 offset:2048
ds_read_b64_tr_b16 a[160:161], v184 offset:256
ds_read_b64_tr_b16 a[162:163], v184 offset:2304
ds_read_b64_tr_b16 a[164:165], v185 offset:256
ds_read_b64_tr_b16 a[166:167], v185 offset:2304
ds_read_b64_tr_b16 a[136:137], v186 offset:0
ds_read_b64_tr_b16 a[138:139], v186 offset:2048
ds_read_b64_tr_b16 a[140:141], v187 offset:0
ds_read_b64_tr_b16 a[142:143], v187 offset:2048
ds_read_b64_tr_b16 a[144:145], v188 offset:0
ds_read_b64_tr_b16 a[146:147], v188 offset:2048
ds_read_b64_tr_b16 a[148:149], v189 offset:0
ds_read_b64_tr_b16 a[150:151], v189 offset:2048
ds_read_b64_tr_b16 a[152:153], v190 offset:0
ds_read_b64_tr_b16 a[154:155], v190 offset:2048
ds_read_b64_tr_b16 a[156:157], v191 offset:0
ds_read_b64_tr_b16 a[158:159], v191 offset:2048
ds_read_b64_tr_b16 a[168:169], v186 offset:256
ds_read_b64_tr_b16 a[170:171], v186 offset:2304
ds_read_b64_tr_b16 a[172:173], v187 offset:256
ds_read_b64_tr_b16 a[174:175], v187 offset:2304
ds_read_b64_tr_b16 a[176:177], v188 offset:256
ds_read_b64_tr_b16 a[178:179], v188 offset:2304
ds_read_b64_tr_b16 a[180:181], v189 offset:256
ds_read_b64_tr_b16 a[182:183], v189 offset:2304
ds_read_b64_tr_b16 a[184:185], v190 offset:256
ds_read_b64_tr_b16 a[186:187], v190 offset:2304
ds_read_b64_tr_b16 a[188:189], v191 offset:256
ds_read_b64_tr_b16 a[190:191], v191 offset:2304
s_bitcmp1_b32 s40, 0
s_cbranch_scc1 K_XP0
K_XP0D:
s_waitcnt lgkmcnt(15)
v_mfma_f32_16x16x32_bf16 v[8:11], a[128:131], a[192:195], 0
ds_read_b128 a[200:203], v193 offset:0
ds_read_b128 a[204:207], v193 offset:2048
v_mfma_f32_16x16x32_bf16 v[40:43], a[128:131], a[196:199], 0
s_add_u32 m0, s45, 81920
v_mfma_f32_16x16x32_bf16 v[12:15], a[132:135], a[192:195], 0
buffer_load_dwordx4 v144, s[24:27], s43 offen offset:0 lds
v_mfma_f32_16x16x32_bf16 v[44:47], a[132:135], a[196:199], 0
v_smfmac_f32_16x16x64_bf16 a[248:251], a[208:211], a[128:135], v235
ds_read_b64_tr_b16 a[128:129], v184 offset:16384
ds_read_b64_tr_b16 a[130:131], v184 offset:18432
v_mfma_f32_16x16x32_bf16 v[72:75], a[160:163], a[192:195], 0
ds_read_b64_tr_b16 a[132:133], v185 offset:16384
ds_read_b64_tr_b16 a[134:135], v185 offset:18432
v_mfma_f32_16x16x32_bf16 v[104:107], a[160:163], a[196:199], 0
buffer_load_dwordx4 v145, s[24:27], s43 offen offset:1024 lds
v_mfma_f32_16x16x32_bf16 v[76:79], a[164:167], a[192:195], 0
v_mfma_f32_16x16x32_bf16 v[108:111], a[164:167], a[196:199], 0
v_smfmac_f32_16x16x64_bf16 a[252:255], a[208:211], a[160:167], v235
s_add_u32 m0, s85, 81920
ds_read_b64_tr_b16 a[160:161], v184 offset:16640
ds_read_b64_tr_b16 a[162:163], v184 offset:18688
v_mfma_f32_16x16x32_bf16 v[16:19], a[136:139], a[192:195], 0
buffer_load_dwordx4 v146, s[24:27], s43 offen offset:0 lds
v_mfma_f32_16x16x32_bf16 v[48:51], a[136:139], a[196:199], 0
ds_read_b64_tr_b16 a[164:165], v185 offset:16640
ds_read_b64_tr_b16 a[166:167], v185 offset:18688
v_mfma_f32_16x16x32_bf16 v[20:23], a[140:143], a[192:195], 0
ds_read_b64_tr_b16 a[136:137], v186 offset:16384
ds_read_b64_tr_b16 a[138:139], v186 offset:18432
v_mfma_f32_16x16x32_bf16 v[52:55], a[140:143], a[196:199], 0
ds_read_b64_tr_b16 a[140:141], v187 offset:16384
ds_read_b64_tr_b16 a[142:143], v187 offset:18432
v_mfma_f32_16x16x32_bf16 v[24:27], a[144:147], a[192:195], 0
buffer_load_dwordx4 v147, s[24:27], s43 offen offset:1024 lds
v_mfma_f32_16x16x32_bf16 v[56:59], a[144:147], a[196:199], 0
s_cmp_eq_u32 s74, 6
s_cselect_b32 s72, s73, 128
ds_read_b64_tr_b16 a[144:145], v188 offset:16384
ds_read_b64_tr_b16 a[146:147], v188 offset:18432
v_mfma_f32_16x16x32_bf16 v[28:31], a[148:151], a[192:195], 0
s_add_u32 s43, s43, s72
v_mfma_f32_16x16x32_bf16 v[60:63], a[148:151], a[196:199], 0
s_waitcnt lgkmcnt(10)
s_add_u32 m0, s44, 49152
ds_read_b64_tr_b16 a[148:149], v189 offset:16384
ds_read_b64_tr_b16 a[150:151], v189 offset:18432
v_mfma_f32_16x16x32_bf16 v[32:35], a[152:155], a[192:195], 0
buffer_load_dwordx4 v136, s[16:19], s42 offen offset:0 lds
v_mfma_f32_16x16x32_bf16 v[64:67], a[152:155], a[196:199], 0
ds_read_b64_tr_b16 a[152:153], v190 offset:16384
ds_read_b64_tr_b16 a[154:155], v190 offset:18432
v_mfma_f32_16x16x32_bf16 v[36:39], a[156:159], a[192:195], 0
v_mfma_f32_16x16x32_bf16 v[68:71], a[156:159], a[196:199], 0
ds_read_b64_tr_b16 a[156:157], v191 offset:16384
ds_read_b64_tr_b16 a[158:159], v191 offset:18432
v_mfma_f32_16x16x32_bf16 v[80:83], a[168:171], a[192:195], 0
v_mfma_f32_16x16x32_bf16 v[112:115], a[168:171], a[196:199], 0
buffer_load_dwordx4 v137, s[16:19], s42 offen offset:1024 lds
v_mfma_f32_16x16x32_bf16 v[84:87], a[172:175], a[192:195], 0
ds_read_b64_tr_b16 a[168:169], v186 offset:16640
ds_read_b64_tr_b16 a[170:171], v186 offset:18688
v_mfma_f32_16x16x32_bf16 v[116:119], a[172:175], a[196:199], 0
ds_read_b64_tr_b16 a[172:173], v187 offset:16640
ds_read_b64_tr_b16 a[174:175], v187 offset:18688
v_mfma_f32_16x16x32_bf16 v[88:91], a[176:179], a[192:195], 0
v_mfma_f32_16x16x32_bf16 v[120:123], a[176:179], a[196:199], 0
buffer_load_dwordx4 v138, s[16:19], s42 offen offset:2048 lds
v_mfma_f32_16x16x32_bf16 v[92:95], a[180:183], a[192:195], 0
ds_read_b64_tr_b16 a[176:177], v188 offset:16640
ds_read_b64_tr_b16 a[178:179], v188 offset:18688
v_mfma_f32_16x16x32_bf16 v[124:127], a[180:183], a[196:199], 0
ds_read_b64_tr_b16 a[180:181], v189 offset:16640
ds_read_b64_tr_b16 a[182:183], v189 offset:18688
v_mfma_f32_16x16x32_bf16 v[96:99], a[184:187], a[192:195], 0
v_mfma_f32_16x16x32_bf16 v[128:131], a[184:187], a[196:199], 0
buffer_load_dwordx4 v139, s[16:19], s42 offen offset:3072 lds
v_mfma_f32_16x16x32_bf16 v[100:103], a[188:191], a[192:195], 0
ds_read_b64_tr_b16 a[184:185], v190 offset:16640
ds_read_b64_tr_b16 a[186:187], v190 offset:18688
v_mfma_f32_16x16x32_bf16 v[132:135], a[188:191], a[196:199], 0
ds_read_b64_tr_b16 a[188:189], v191 offset:16640
ds_read_b64_tr_b16 a[190:191], v191 offset:18688
v_mfma_f32_16x16x32_bf16 v[8:11], a[128:131], a[200:203], v[8:11]
s_add_u32 m0, s44, 53248
v_mfma_f32_16x16x32_bf16 v[40:43], a[128:131], a[204:207], v[40:43]
buffer_load_dwordx4 v140, s[16:19], s42 offen offset:0 lds
v_mfma_f32_16x16x32_bf16 v[12:15], a[132:135], a[200:203], v[12:15]
v_mfma_f32_16x16x32_bf16 v[44:47], a[132:135], a[204:207], v[44:47]
v_smfmac_f32_16x16x64_bf16 a[248:251], a[208:211], a[128:135], v235
s_waitcnt lgkmcnt(6)
v_mfma_f32_16x16x32_bf16 v[72:75], a[160:163], a[200:203], v[72:75]
v_mfma_f32_16x16x32_bf16 v[104:107], a[160:163], a[204:207], v[104:107]
s_waitcnt vmcnt(10) lgkmcnt(0)
s_barrier
v_mfma_f32_16x16x32_bf16 v[76:79], a[164:167], a[200:203], v[76:79]
ds_read_b128 a[192:195], v202 offset:0
ds_read_b128 a[196:199], v202 offset:2048
v_mfma_f32_16x16x32_bf16 v[108:111], a[164:167], a[204:207], v[108:111]
buffer_load_dwordx4 v141, s[16:19], s42 offen offset:1024 lds
v_smfmac_f32_16x16x64_bf16 a[252:255], a[208:211], a[160:167], v235
ds_read_b64_tr_b16 a[128:129], v194 offset:0
ds_read_b64_tr_b16 a[130:131], v194 offset:2048
v_mfma_f32_16x16x32_bf16 v[16:19], a[136:139], a[200:203], v[16:19]
ds_read_b64_tr_b16 a[132:133], v195 offset:0
ds_read_b64_tr_b16 a[134:135], v195 offset:2048
v_mfma_f32_16x16x32_bf16 v[48:51], a[136:139], a[204:207], v[48:51]
ds_read_b64_tr_b16 a[160:161], v194 offset:256
ds_read_b64_tr_b16 a[162:163], v194 offset:2304
v_mfma_f32_16x16x32_bf16 v[20:23], a[140:143], a[200:203], v[20:23]
ds_read_b64_tr_b16 a[164:165], v195 offset:256
ds_read_b64_tr_b16 a[166:167], v195 offset:2304
v_mfma_f32_16x16x32_bf16 v[52:55], a[140:143], a[204:207], v[52:55]
buffer_load_dwordx4 v142, s[16:19], s42 offen offset:2048 lds
v_mfma_f32_16x16x32_bf16 v[24:27], a[144:147], a[200:203], v[24:27]
ds_read_b64_tr_b16 a[136:137], v196 offset:0
ds_read_b64_tr_b16 a[138:139], v196 offset:2048
v_mfma_f32_16x16x32_bf16 v[56:59], a[144:147], a[204:207], v[56:59]
ds_read_b64_tr_b16 a[140:141], v197 offset:0
ds_read_b64_tr_b16 a[142:143], v197 offset:2048
v_mfma_f32_16x16x32_bf16 v[28:31], a[148:151], a[200:203], v[28:31]
ds_read_b64_tr_b16 a[144:145], v198 offset:0
ds_read_b64_tr_b16 a[146:147], v198 offset:2048
v_mfma_f32_16x16x32_bf16 v[60:63], a[148:151], a[204:207], v[60:63]
buffer_load_dwordx4 v143, s[16:19], s42 offen offset:3072 lds
v_mfma_f32_16x16x32_bf16 v[32:35], a[152:155], a[200:203], v[32:35]
s_lshl_b32 s72, s72, 12
ds_read_b64_tr_b16 a[148:149], v199 offset:0
ds_read_b64_tr_b16 a[150:151], v199 offset:2048
v_mfma_f32_16x16x32_bf16 v[64:67], a[152:155], a[204:207], v[64:67]
s_add_u32 s42, s42, s72
ds_read_b64_tr_b16 a[152:153], v200 offset:0
ds_read_b64_tr_b16 a[154:155], v200 offset:2048
v_mfma_f32_16x16x32_bf16 v[36:39], a[156:159], a[200:203], v[36:39]
s_add_u32 m0, s45, 32768
v_mfma_f32_16x16x32_bf16 v[68:71], a[156:159], a[204:207], v[68:71]
buffer_load_dwordx4 v144, s[24:27], s43 offen offset:0 lds
v_mfma_f32_16x16x32_bf16 v[80:83], a[168:171], a[200:203], v[80:83]
ds_read_b64_tr_b16 a[156:157], v201 offset:0
ds_read_b64_tr_b16 a[158:159], v201 offset:2048
v_mfma_f32_16x16x32_bf16 v[112:115], a[168:171], a[204:207], v[112:115]
ds_read_b64_tr_b16 a[168:169], v196 offset:256
ds_read_b64_tr_b16 a[170:171], v196 offset:2304
v_mfma_f32_16x16x32_bf16 v[84:87], a[172:175], a[200:203], v[84:87]
v_mfma_f32_16x16x32_bf16 v[116:119], a[172:175], a[204:207], v[116:119]
buffer_load_dwordx4 v145, s[24:27], s43 offen offset:1024 lds
v_mfma_f32_16x16x32_bf16 v[88:91], a[176:179], a[200:203], v[88:91]
ds_read_b64_tr_b16 a[172:173], v197 offset:256
ds_read_b64_tr_b16 a[174:175], v197 offset:2304
v_mfma_f32_16x16x32_bf16 v[120:123], a[176:179], a[204:207], v[120:123]
ds_read_b64_tr_b16 a[176:177], v198 offset:256
ds_read_b64_tr_b16 a[178:179], v198 offset:2304
v_mfma_f32_16x16x32_bf16 v[92:95], a[180:183], a[200:203], v[92:95]
s_add_u32 m0, s85, 32768
v_mfma_f32_16x16x32_bf16 v[124:127], a[180:183], a[204:207], v[124:127]
buffer_load_dwordx4 v146, s[24:27], s43 offen offset:0 lds
v_mfma_f32_16x16x32_bf16 v[96:99], a[184:187], a[200:203], v[96:99]
ds_read_b64_tr_b16 a[180:181], v199 offset:256
ds_read_b64_tr_b16 a[182:183], v199 offset:2304
v_mfma_f32_16x16x32_bf16 v[128:131], a[184:187], a[204:207], v[128:131]
ds_read_b64_tr_b16 a[184:185], v200 offset:256
ds_read_b64_tr_b16 a[186:187], v200 offset:2304
v_mfma_f32_16x16x32_bf16 v[100:103], a[188:191], a[200:203], v[100:103]
v_mfma_f32_16x16x32_bf16 v[132:135], a[188:191], a[204:207], v[132:135]
s_waitcnt lgkmcnt(8)
ds_read_b64_tr_b16 a[188:189], v201 offset:256
ds_read_b64_tr_b16 a[190:191], v201 offset:2304
s_bitcmp1_b32 s40, 1
s_cbranch_scc1 K_XP1
K_XP1D:
v_mfma_f32_16x16x32_bf16 v[8:11], a[128:131], a[192:195], v[8:11]
buffer_load_dwordx4 v147, s[24:27], s43 offen offset:1024 lds
v_mfma_f32_16x16x32_bf16 v[40:43], a[128:131], a[196:199], v[40:43]
s_cmp_eq_u32 s74, 5
s_cselect_b32 s72, s73, 128
ds_read_b128 a[200:203], v203 offset:0
ds_read_b128 a[204:207], v203 offset:2048
v_mfma_f32_16x16x32_bf16 v[12:15], a[132:135], a[192:195], v[12:15]
s_add_u32 s43, s43, s72
v_mfma_f32_16x16x32_bf16 v[44:47], a[132:135], a[196:199], v[44:47]
s_add_u32 m0, s44, 0
v_smfmac_f32_16x16x64_bf16 a[248:251], a[208:211], a[128:135], v235
buffer_load_dwordx4 v136, s[16:19], s42 offen offset:0 lds
v_mfma_f32_16x16x32_bf16 v[72:75], a[160:163], a[192:195], v[72:75]
ds_read_b64_tr_b16 a[128:129], v194 offset:16384
ds_read_b64_tr_b16 a[130:131], v194 offset:18432
v_mfma_f32_16x16x32_bf16 v[104:107], a[160:163], a[196:199], v[104:107]
ds_read_b64_tr_b16 a[132:133], v195 offset:16384
ds_read_b64_tr_b16 a[134:135], v195 offset:18432
v_mfma_f32_16x16x32_bf16 v[76:79], a[164:167], a[192:195], v[76:79]
v_mfma_f32_16x16x32_bf16 v[108:111], a[164:167], a[196:199], v[108:111]
buffer_load_dwordx4 v137, s[16:19], s42 offen offset:1024 lds
v_smfmac_f32_16x16x64_bf16 a[252:255], a[208:211], a[160:167], v235
ds_read_b64_tr_b16 a[160:161], v194 offset:16640
ds_read_b64_tr_b16 a[162:163], v194 offset:18688
v_mfma_f32_16x16x32_bf16 v[16:19], a[136:139], a[192:195], v[16:19]
ds_read_b64_tr_b16 a[164:165], v195 offset:16640
ds_read_b64_tr_b16 a[166:167], v195 offset:18688
v_mfma_f32_16x16x32_bf16 v[48:51], a[136:139], a[196:199], v[48:51]
ds_read_b64_tr_b16 a[136:137], v196 offset:16384
ds_read_b64_tr_b16 a[138:139], v196 offset:18432
v_mfma_f32_16x16x32_bf16 v[20:23], a[140:143], a[192:195], v[20:23]
buffer_load_dwordx4 v138, s[16:19], s42 offen offset:2048 lds
v_mfma_f32_16x16x32_bf16 v[52:55], a[140:143], a[196:199], v[52:55]
ds_read_b64_tr_b16 a[140:141], v197 offset:16384
ds_read_b64_tr_b16 a[142:143], v197 offset:18432
v_mfma_f32_16x16x32_bf16 v[24:27], a[144:147], a[192:195], v[24:27]
v_mfma_f32_16x16x32_bf16 v[56:59], a[144:147], a[196:199], v[56:59]
ds_read_b64_tr_b16 a[144:145], v198 offset:16384
ds_read_b64_tr_b16 a[146:147], v198 offset:18432
v_mfma_f32_16x16x32_bf16 v[28:31], a[148:151], a[192:195], v[28:31]
buffer_load_dwordx4 v139, s[16:19], s42 offen offset:3072 lds
v_mfma_f32_16x16x32_bf16 v[60:63], a[148:151], a[196:199], v[60:63]
ds_read_b64_tr_b16 a[148:149], v199 offset:16384
ds_read_b64_tr_b16 a[150:151], v199 offset:18432
v_mfma_f32_16x16x32_bf16 v[32:35], a[152:155], a[192:195], v[32:35]
v_mfma_f32_16x16x32_bf16 v[64:67], a[152:155], a[196:199], v[64:67]
ds_read_b64_tr_b16 a[152:153], v200 offset:16384
ds_read_b64_tr_b16 a[154:155], v200 offset:18432
v_mfma_f32_16x16x32_bf16 v[36:39], a[156:159], a[192:195], v[36:39]
s_add_u32 m0, s44, 4096
v_mfma_f32_16x16x32_bf16 v[68:71], a[156:159], a[196:199], v[68:71]
buffer_load_dwordx4 v140, s[16:19], s42 offen offset:0 lds
v_mfma_f32_16x16x32_bf16 v[80:83], a[168:171], a[192:195], v[80:83]
ds_read_b64_tr_b16 a[156:157], v201 offset:16384
ds_read_b64_tr_b16 a[158:159], v201 offset:18432
v_mfma_f32_16x16x32_bf16 v[112:115], a[168:171], a[196:199], v[112:115]
s_waitcnt lgkmcnt(8)
ds_read_b64_tr_b16 a[168:169], v196 offset:16640
ds_read_b64_tr_b16 a[170:171], v196 offset:18688
v_mfma_f32_16x16x32_bf16 v[84:87], a[172:175], a[192:195], v[84:87]
v_mfma_f32_16x16x32_bf16 v[116:119], a[172:175], a[196:199], v[116:119]
buffer_load_dwordx4 v141, s[16:19], s42 offen offset:1024 lds
v_mfma_f32_16x16x32_bf16 v[88:91], a[176:179], a[192:195], v[88:91]
ds_read_b64_tr_b16 a[172:173], v197 offset:16640
ds_read_b64_tr_b16 a[174:175], v197 offset:18688
v_mfma_f32_16x16x32_bf16 v[120:123], a[176:179], a[196:199], v[120:123]
ds_read_b64_tr_b16 a[176:177], v198 offset:16640
ds_read_b64_tr_b16 a[178:179], v198 offset:18688
v_mfma_f32_16x16x32_bf16 v[92:95], a[180:183], a[192:195], v[92:95]
v_mfma_f32_16x16x32_bf16 v[124:127], a[180:183], a[196:199], v[124:127]
buffer_load_dwordx4 v142, s[16:19], s42 offen offset:2048 lds
v_mfma_f32_16x16x32_bf16 v[96:99], a[184:187], a[192:195], v[96:99]
ds_read_b64_tr_b16 a[180:181], v199 offset:16640
ds_read_b64_tr_b16 a[182:183], v199 offset:18688
v_mfma_f32_16x16x32_bf16 v[128:131], a[184:187], a[196:199], v[128:131]
ds_read_b64_tr_b16 a[184:185], v200 offset:16640
ds_read_b64_tr_b16 a[186:187], v200 offset:18688
v_mfma_f32_16x16x32_bf16 v[100:103], a[188:191], a[192:195], v[100:103]
v_mfma_f32_16x16x32_bf16 v[132:135], a[188:191], a[196:199], v[132:135]
ds_read_b64_tr_b16 a[188:189], v201 offset:16640
ds_read_b64_tr_b16 a[190:191], v201 offset:18688
v_mfma_f32_16x16x32_bf16 v[8:11], a[128:131], a[200:203], v[8:11]
buffer_load_dwordx4 v143, s[16:19], s42 offen offset:3072 lds
v_mfma_f32_16x16x32_bf16 v[40:43], a[128:131], a[204:207], v[40:43]
v_mfma_f32_16x16x32_bf16 v[12:15], a[132:135], a[200:203], v[12:15]
s_lshl_b32 s72, s72, 12
v_mfma_f32_16x16x32_bf16 v[44:47], a[132:135], a[204:207], v[44:47]
s_add_u32 s42, s42, s72
v_smfmac_f32_16x16x64_bf16 a[248:251], a[208:211], a[128:135], v235
v_mfma_f32_16x16x32_bf16 v[72:75], a[160:163], a[200:203], v[72:75]
v_mfma_f32_16x16x32_bf16 v[104:107], a[160:163], a[204:207], v[104:107]
s_waitcnt vmcnt(12) lgkmcnt(0)
s_barrier
s_cmp_lg_u32 s32, 0
s_cbranch_scc1 K_W0_3
s_lshl_b32 s48, s34, 4
s_mov_b64 exec, 1
buffer_atomic_add v255, v234, s[28:31], s48 offen sc1
s_mov_b64 exec, -1
K_W0_3:
v_mfma_f32_16x16x32_bf16 v[76:79], a[164:167], a[200:203], v[76:79]
s_add_u32 m0, s45, 131072
ds_read_b128 a[192:195], v212 offset:0
ds_read_b128 a[196:199], v212 offset:2048
v_mfma_f32_16x16x32_bf16 v[108:111], a[164:167], a[204:207], v[108:111]
buffer_load_dwordx4 v144, s[24:27], s43 offen offset:0 lds
v_smfmac_f32_16x16x64_bf16 a[252:255], a[208:211], a[160:167], v235
ds_read_b64_tr_b16 a[128:129], v204 offset:0
ds_read_b64_tr_b16 a[130:131], v204 offset:2048
v_mfma_f32_16x16x32_bf16 v[16:19], a[136:139], a[200:203], v[16:19]
ds_read_b64_tr_b16 a[132:133], v205 offset:0
ds_read_b64_tr_b16 a[134:135], v205 offset:2048
v_mfma_f32_16x16x32_bf16 v[48:51], a[136:139], a[204:207], v[48:51]
ds_read_b64_tr_b16 a[160:161], v204 offset:256
ds_read_b64_tr_b16 a[162:163], v204 offset:2304
v_mfma_f32_16x16x32_bf16 v[20:23], a[140:143], a[200:203], v[20:23]
ds_read_b64_tr_b16 a[164:165], v205 offset:256
ds_read_b64_tr_b16 a[166:167], v205 offset:2304
v_mfma_f32_16x16x32_bf16 v[52:55], a[140:143], a[204:207], v[52:55]
buffer_load_dwordx4 v145, s[24:27], s43 offen offset:1024 lds
v_mfma_f32_16x16x32_bf16 v[24:27], a[144:147], a[200:203], v[24:27]
ds_read_b64_tr_b16 a[136:137], v206 offset:0
ds_read_b64_tr_b16 a[138:139], v206 offset:2048
v_mfma_f32_16x16x32_bf16 v[56:59], a[144:147], a[204:207], v[56:59]
ds_read_b64_tr_b16 a[140:141], v207 offset:0
ds_read_b64_tr_b16 a[142:143], v207 offset:2048
v_mfma_f32_16x16x32_bf16 v[28:31], a[148:151], a[200:203], v[28:31]
s_add_u32 m0, s85, 131072
ds_read_b64_tr_b16 a[144:145], v208 offset:0
ds_read_b64_tr_b16 a[146:147], v208 offset:2048
v_mfma_f32_16x16x32_bf16 v[60:63], a[148:151], a[204:207], v[60:63]
buffer_load_dwordx4 v146, s[24:27], s43 offen offset:0 lds
v_mfma_f32_16x16x32_bf16 v[32:35], a[152:155], a[200:203], v[32:35]
ds_read_b64_tr_b16 a[148:149], v209 offset:0
ds_read_b64_tr_b16 a[150:151], v209 offset:2048
v_mfma_f32_16x16x32_bf16 v[64:67], a[152:155], a[204:207], v[64:67]
ds_read_b64_tr_b16 a[152:153], v210 offset:0
ds_read_b64_tr_b16 a[154:155], v210 offset:2048
v_mfma_f32_16x16x32_bf16 v[36:39], a[156:159], a[200:203], v[36:39]
v_mfma_f32_16x16x32_bf16 v[68:71], a[156:159], a[204:207], v[68:71]
buffer_load_dwordx4 v147, s[24:27], s43 offen offset:1024 lds
v_mfma_f32_16x16x32_bf16 v[80:83], a[168:171], a[200:203], v[80:83]
s_cmp_eq_u32 s74, 4
s_cselect_b32 s72, s73, 128
ds_read_b64_tr_b16 a[156:157], v211 offset:0
ds_read_b64_tr_b16 a[158:159], v211 offset:2048
v_mfma_f32_16x16x32_bf16 v[112:115], a[168:171], a[204:207], v[112:115]
s_add_u32 s43, s43, s72
ds_read_b64_tr_b16 a[168:169], v206 offset:256
ds_read_b64_tr_b16 a[170:171], v206 offset:2304
v_mfma_f32_16x16x32_bf16 v[84:87], a[172:175], a[200:203], v[84:87]
s_add_u32 m0, s44, 98304
v_mfma_f32_16x16x32_bf16 v[116:119], a[172:175], a[204:207], v[116:119]
buffer_load_dwordx4 v136, s[16:19], s42 offen offset:0 lds
v_mfma_f32_16x16x32_bf16 v[88:91], a[176:179], a[200:203], v[88:91]
ds_read_b64_tr_b16 a[172:173], v207 offset:256
ds_read_b64_tr_b16 a[174:175], v207 offset:2304
v_mfma_f32_16x16x32_bf16 v[120:123], a[176:179], a[204:207], v[120:123]
ds_read_b64_tr_b16 a[176:177], v208 offset:256
ds_read_b64_tr_b16 a[178:179], v208 offset:2304
v_mfma_f32_16x16x32_bf16 v[92:95], a[180:183], a[200:203], v[92:95]
v_mfma_f32_16x16x32_bf16 v[124:127], a[180:183], a[204:207], v[124:127]
buffer_load_dwordx4 v137, s[16:19], s42 offen offset:1024 lds
v_mfma_f32_16x16x32_bf16 v[96:99], a[184:187], a[200:203], v[96:99]
ds_read_b64_tr_b16 a[180:181], v209 offset:256
ds_read_b64_tr_b16 a[182:183], v209 offset:2304
v_mfma_f32_16x16x32_bf16 v[128:131], a[184:187], a[204:207], v[128:131]
ds_read_b64_tr_b16 a[184:185], v210 offset:256
ds_read_b64_tr_b16 a[186:187], v210 offset:2304
v_mfma_f32_16x16x32_bf16 v[100:103], a[188:191], a[200:203], v[100:103]
v_mfma_f32_16x16x32_bf16 v[132:135], a[188:191], a[204:207], v[132:135]
s_waitcnt lgkmcnt(8)
ds_read_b64_tr_b16 a[188:189], v211 offset:256
ds_read_b64_tr_b16 a[190:191], v211 offset:2304
s_bitcmp1_b32 s40, 2
s_cbranch_scc1 K_XP2
K_XP2D:
v_mfma_f32_16x16x32_bf16 v[8:11], a[128:131], a[192:195], v[8:11]
buffer_load_dwordx4 v138, s[16:19], s42 offen offset:2048 lds
v_mfma_f32_16x16x32_bf16 v[40:43], a[128:131], a[196:199], v[40:43]
ds_read_b128 a[200:203], v213 offset:0
ds_read_b128 a[204:207], v213 offset:2048
v_mfma_f32_16x16x32_bf16 v[12:15], a[132:135], a[192:195], v[12:15]
v_accvgpr_write_b32 a0, 0
v_accvgpr_write_b32 a1, 0
v_mfma_f32_16x16x32_bf16 v[44:47], a[132:135], a[196:199], v[44:47]
v_accvgpr_write_b32 a2, 0
v_accvgpr_write_b32 a3, 0
v_smfmac_f32_16x16x64_bf16 a[248:251], a[208:211], a[128:135], v235
buffer_load_dwordx4 v139, s[16:19], s42 offen offset:3072 lds
v_mfma_f32_16x16x32_bf16 v[72:75], a[160:163], a[192:195], v[72:75]
ds_read_b64_tr_b16 a[128:129], v204 offset:16384
ds_read_b64_tr_b16 a[130:131], v204 offset:18432
v_mfma_f32_16x16x32_bf16 v[104:107], a[160:163], a[196:199], v[104:107]
ds_read_b64_tr_b16 a[132:133], v205 offset:16384
ds_read_b64_tr_b16 a[134:135], v205 offset:18432
v_mfma_f32_16x16x32_bf16 v[76:79], a[164:167], a[192:195], v[76:79]
s_add_u32 m0, s44, 102400
v_accvgpr_write_b32 a4, 0
v_accvgpr_write_b32 a5, 0
v_mfma_f32_16x16x32_bf16 v[108:111], a[164:167], a[196:199], v[108:111]
buffer_load_dwordx4 v140, s[16:19], s42 offen offset:0 lds
v_smfmac_f32_16x16x64_bf16 a[252:255], a[208:211], a[160:167], v235
ds_read_b64_tr_b16 a[160:161], v204 offset:16640
ds_read_b64_tr_b16 a[162:163], v204 offset:18688
v_mfma_f32_16x16x32_bf16 v[16:19], a[136:139], a[192:195], v[16:19]
ds_read_b64_tr_b16 a[164:165], v205 offset:16640
ds_read_b64_tr_b16 a[166:167], v205 offset:18688
v_mfma_f32_16x16x32_bf16 v[48:51], a[136:139], a[196:199], v[48:51]
ds_read_b64_tr_b16 a[136:137], v206 offset:16384
ds_read_b64_tr_b16 a[138:139], v206 offset:18432
v_mfma_f32_16x16x32_bf16 v[20:23], a[140:143], a[192:195], v[20:23]
buffer_load_dwordx4 v141, s[16:19], s42 offen offset:1024 lds
v_mfma_f32_16x16x32_bf16 v[52:55], a[140:143], a[196:199], v[52:55]
ds_read_b64_tr_b16 a[140:141], v207 offset:16384
ds_read_b64_tr_b16 a[142:143], v207 offset:18432
v_mfma_f32_16x16x32_bf16 v[24:27], a[144:147], a[192:195], v[24:27]
v_accvgpr_write_b32 a6, 0
v_accvgpr_write_b32 a7, 0
v_mfma_f32_16x16x32_bf16 v[56:59], a[144:147], a[196:199], v[56:59]
ds_read_b64_tr_b16 a[144:145], v208 offset:16384
ds_read_b64_tr_b16 a[146:147], v208 offset:18432
v_mfma_f32_16x16x32_bf16 v[28:31], a[148:151], a[192:195], v[28:31]
buffer_load_dwordx4 v142, s[16:19], s42 offen offset:2048 lds
v_mfma_f32_16x16x32_bf16 v[60:63], a[148:151], a[196:199], v[60:63]
ds_read_b64_tr_b16 a[148:149], v209 offset:16384
ds_read_b64_tr_b16 a[150:151], v209 offset:18432
v_mfma_f32_16x16x32_bf16 v[32:35], a[152:155], a[192:195], v[32:35]
v_accvgpr_write_b32 a8, 0
v_accvgpr_write_b32 a9, 0
v_mfma_f32_16x16x32_bf16 v[64:67], a[152:155], a[196:199], v[64:67]
ds_read_b64_tr_b16 a[152:153], v210 offset:16384
ds_read_b64_tr_b16 a[154:155], v210 offset:18432
v_mfma_f32_16x16x32_bf16 v[36:39], a[156:159], a[192:195], v[36:39]
v_accvgpr_write_b32 a10, 0
v_accvgpr_write_b32 a11, 0
v_mfma_f32_16x16x32_bf16 v[68:71], a[156:159], a[196:199], v[68:71]
buffer_load_dwordx4 v143, s[16:19], s42 offen offset:3072 lds
v_mfma_f32_16x16x32_bf16 v[80:83], a[168:171], a[192:195], v[80:83]
s_waitcnt lgkmcnt(8)
ds_read_b64_tr_b16 a[156:157], v211 offset:16384
ds_read_b64_tr_b16 a[158:159], v211 offset:18432
v_mfma_f32_16x16x32_bf16 v[112:115], a[168:171], a[196:199], v[112:115]
s_lshl_b32 s72, s72, 12
ds_read_b64_tr_b16 a[168:169], v206 offset:16640
ds_read_b64_tr_b16 a[170:171], v206 offset:18688
v_mfma_f32_16x16x32_bf16 v[84:87], a[172:175], a[192:195], v[84:87]
s_add_u32 s42, s42, s72
v_accvgpr_write_b32 a12, 0
v_accvgpr_write_b32 a13, 0
v_mfma_f32_16x16x32_bf16 v[116:119], a[172:175], a[196:199], v[116:119]
ds_read_b64_tr_b16 a[172:173], v207 offset:16640
ds_read_b64_tr_b16 a[174:175], v207 offset:18688
v_mfma_f32_16x16x32_bf16 v[88:91], a[176:179], a[192:195], v[88:91]
v_accvgpr_write_b32 a14, 0
v_accvgpr_write_b32 a15, 0
v_mfma_f32_16x16x32_bf16 v[120:123], a[176:179], a[196:199], v[120:123]
ds_read_b64_tr_b16 a[176:177], v208 offset:16640
ds_read_b64_tr_b16 a[178:179], v208 offset:18688
v_mfma_f32_16x16x32_bf16 v[92:95], a[180:183], a[192:195], v[92:95]
v_mfma_f32_16x16x32_bf16 v[124:127], a[180:183], a[196:199], v[124:127]
ds_read_b64_tr_b16 a[180:181], v209 offset:16640
ds_read_b64_tr_b16 a[182:183], v209 offset:18688
v_mfma_f32_16x16x32_bf16 v[96:99], a[184:187], a[192:195], v[96:99]
v_mfma_f32_16x16x32_bf16 v[128:131], a[184:187], a[196:199], v[128:131]
ds_read_b64_tr_b16 a[184:185], v210 offset:16640
ds_read_b64_tr_b16 a[186:187], v210 offset:18688
v_mfma_f32_16x16x32_bf16 v[100:103], a[188:191], a[192:195], v[100:103]
v_mfma_f32_16x16x32_bf16 v[132:135], a[188:191], a[196:199], v[132:135]
ds_read_b64_tr_b16 a[188:189], v211 offset:16640
ds_read_b64_tr_b16 a[190:191], v211 offset:18688
v_mfma_f32_16x16x32_bf16 v[8:11], a[128:131], a[200:203], v[8:11]
v_mfma_f32_16x16x32_bf16 v[40:43], a[128:131], a[204:207], v[40:43]
v_mfma_f32_16x16x32_bf16 v[12:15], a[132:135], a[200:203], v[12:15]
v_mfma_f32_16x16x32_bf16 v[44:47], a[132:135], a[204:207], v[44:47]
v_smfmac_f32_16x16x64_bf16 a[248:251], a[208:211], a[128:135], v235
v_mfma_f32_16x16x32_bf16 v[72:75], a[160:163], a[200:203], v[72:75]
v_mfma_f32_16x16x32_bf16 v[104:107], a[160:163], a[204:207], v[104:107]
s_waitcnt vmcnt(12) lgkmcnt(0)
s_barrier
v_mfma_f32_16x16x32_bf16 v[76:79], a[164:167], a[200:203], v[76:79]
s_add_u32 m0, s45, 81920
ds_read_b128 a[192:195], v192 offset:0
ds_read_b128 a[196:199], v192 offset:2048
v_mfma_f32_16x16x32_bf16 v[108:111], a[164:167], a[204:207], v[108:111]
buffer_load_dwordx4 v144, s[24:27], s43 offen offset:0 lds
v_smfmac_f32_16x16x64_bf16 a[252:255], a[208:211], a[160:167], v235
ds_read_b64_tr_b16 a[128:129], v184 offset:0
ds_read_b64_tr_b16 a[130:131], v184 offset:2048
v_mfma_f32_16x16x32_bf16 v[16:19], a[136:139], a[200:203], v[16:19]
ds_read_b64_tr_b16 a[132:133], v185 offset:0
ds_read_b64_tr_b16 a[134:135], v185 offset:2048
v_mfma_f32_16x16x32_bf16 v[48:51], a[136:139], a[204:207], v[48:51]
ds_read_b64_tr_b16 a[160:161], v184 offset:256
ds_read_b64_tr_b16 a[162:163], v184 offset:2304
v_mfma_f32_16x16x32_bf16 v[20:23], a[140:143], a[200:203], v[20:23]
buffer_load_dwordx4 v145, s[24:27], s43 offen offset:1024 lds
v_mfma_f32_16x16x32_bf16 v[52:55], a[140:143], a[204:207], v[52:55]
ds_read_b64_tr_b16 a[164:165], v185 offset:256
ds_read_b64_tr_b16 a[166:167], v185 offset:2304
v_mfma_f32_16x16x32_bf16 v[24:27], a[144:147], a[200:203], v[24:27]
ds_read_b64_tr_b16 a[136:137], v186 offset:0
ds_read_b64_tr_b16 a[138:139], v186 offset:2048
v_mfma_f32_16x16x32_bf16 v[56:59], a[144:147], a[204:207], v[56:59]
s_add_u32 m0, s85, 81920
ds_read_b64_tr_b16 a[140:141], v187 offset:0
ds_read_b64_tr_b16 a[142:143], v187 offset:2048
v_mfma_f32_16x16x32_bf16 v[28:31], a[148:151], a[200:203], v[28:31]
buffer_load_dwordx4 v146, s[24:27], s43 offen offset:0 lds
v_mfma_f32_16x16x32_bf16 v[60:63], a[148:151], a[204:207], v[60:63]
ds_read_b64_tr_b16 a[144:145], v188 offset:0
ds_read_b64_tr_b16 a[146:147], v188 offset:2048
v_mfma_f32_16x16x32_bf16 v[32:35], a[152:155], a[200:203], v[32:35]
ds_read_b64_tr_b16 a[148:149], v189 offset:0
ds_read_b64_tr_b16 a[150:151], v189 offset:2048
v_mfma_f32_16x16x32_bf16 v[64:67], a[152:155], a[204:207], v[64:67]
ds_read_b64_tr_b16 a[152:153], v190 offset:0
ds_read_b64_tr_b16 a[154:155], v190 offset:2048
v_mfma_f32_16x16x32_bf16 v[36:39], a[156:159], a[200:203], v[36:39]
buffer_load_dwordx4 v147, s[24:27], s43 offen offset:1024 lds
v_mfma_f32_16x16x32_bf16 v[68:71], a[156:159], a[204:207], v[68:71]
ds_read_b64_tr_b16 a[156:157], v191 offset:0
ds_read_b64_tr_b16 a[158:159], v191 offset:2048
v_mfma_f32_16x16x32_bf16 v[80:83], a[168:171], a[200:203], v[80:83]
s_cmp_eq_u32 s74, 3
s_cselect_b32 s72, s73, 128
v_mfma_f32_16x16x32_bf16 v[112:115], a[168:171], a[204:207], v[112:115]
s_add_u32 s43, s43, s72
ds_read_b64_tr_b16 a[168:169], v186 offset:256
ds_read_b64_tr_b16 a[170:171], v186 offset:2304
v_mfma_f32_16x16x32_bf16 v[84:87], a[172:175], a[200:203], v[84:87]
s_add_u32 m0, s44, 49152
v_mfma_f32_16x16x32_bf16 v[116:119], a[172:175], a[204:207], v[116:119]
buffer_load_dwordx4 v136, s[16:19], s42 offen offset:0 lds
v_mfma_f32_16x16x32_bf16 v[88:91], a[176:179], a[200:203], v[88:91]
ds_read_b64_tr_b16 a[172:173], v187 offset:256
ds_read_b64_tr_b16 a[174:175], v187 offset:2304
v_mfma_f32_16x16x32_bf16 v[120:123], a[176:179], a[204:207], v[120:123]
ds_read_b64_tr_b16 a[176:177], v188 offset:256
ds_read_b64_tr_b16 a[178:179], v188 offset:2304
v_mfma_f32_16x16x32_bf16 v[92:95], a[180:183], a[200:203], v[92:95]
v_mfma_f32_16x16x32_bf16 v[124:127], a[180:183], a[204:207], v[124:127]
buffer_load_dwordx4 v137, s[16:19], s42 offen offset:1024 lds
v_mfma_f32_16x16x32_bf16 v[96:99], a[184:187], a[200:203], v[96:99]
ds_read_b64_tr_b16 a[180:181], v189 offset:256
ds_read_b64_tr_b16 a[182:183], v189 offset:2304
v_mfma_f32_16x16x32_bf16 v[128:131], a[184:187], a[204:207], v[128:131]
ds_read_b64_tr_b16 a[184:185], v190 offset:256
ds_read_b64_tr_b16 a[186:187], v190 offset:2304
v_mfma_f32_16x16x32_bf16 v[100:103], a[188:191], a[200:203], v[100:103]
v_mfma_f32_16x16x32_bf16 v[132:135], a[188:191], a[204:207], v[132:135]
s_waitcnt lgkmcnt(8)
ds_read_b64_tr_b16 a[188:189], v191 offset:256
ds_read_b64_tr_b16 a[190:191], v191 offset:2304
s_bitcmp1_b32 s40, 3
s_cbranch_scc1 K_XP3
K_XP3D:
v_mfma_f32_16x16x32_bf16 v[8:11], a[128:131], a[192:195], v[8:11]
buffer_load_dwordx4 v138, s[16:19], s42 offen offset:2048 lds
v_mfma_f32_16x16x32_bf16 v[40:43], a[128:131], a[196:199], v[40:43]
ds_read_b128 a[200:203], v193 offset:0
ds_read_b128 a[204:207], v193 offset:2048
v_mfma_f32_16x16x32_bf16 v[12:15], a[132:135], a[192:195], v[12:15]
v_mfma_f32_16x16x32_bf16 v[44:47], a[132:135], a[196:199], v[44:47]
v_smfmac_f32_16x16x64_bf16 a[248:251], a[208:211], a[128:135], v235
buffer_load_dwordx4 v139, s[16:19], s42 offen offset:3072 lds
v_mfma_f32_16x16x32_bf16 v[72:75], a[160:163], a[192:195], v[72:75]
ds_read_b64_tr_b16 a[128:129], v184 offset:16384
ds_read_b64_tr_b16 a[130:131], v184 offset:18432
v_mfma_f32_16x16x32_bf16 v[104:107], a[160:163], a[196:199], v[104:107]
ds_read_b64_tr_b16 a[132:133], v185 offset:16384
ds_read_b64_tr_b16 a[134:135], v185 offset:18432
v_mfma_f32_16x16x32_bf16 v[76:79], a[164:167], a[192:195], v[76:79]
s_add_u32 m0, s44, 53248
v_mfma_f32_16x16x32_bf16 v[108:111], a[164:167], a[196:199], v[108:111]
buffer_load_dwordx4 v140, s[16:19], s42 offen offset:0 lds
v_smfmac_f32_16x16x64_bf16 a[252:255], a[208:211], a[160:167], v235
ds_read_b64_tr_b16 a[160:161], v184 offset:16640
ds_read_b64_tr_b16 a[162:163], v184 offset:18688
v_mfma_f32_16x16x32_bf16 v[16:19], a[136:139], a[192:195], v[16:19]
ds_read_b64_tr_b16 a[164:165], v185 offset:16640
ds_read_b64_tr_b16 a[166:167], v185 offset:18688
v_mfma_f32_16x16x32_bf16 v[48:51], a[136:139], a[196:199], v[48:51]
ds_read_b64_tr_b16 a[136:137], v186 offset:16384
ds_read_b64_tr_b16 a[138:139], v186 offset:18432
v_mfma_f32_16x16x32_bf16 v[20:23], a[140:143], a[192:195], v[20:23]
v_mfma_f32_16x16x32_bf16 v[52:55], a[140:143], a[196:199], v[52:55]
buffer_load_dwordx4 v141, s[16:19], s42 offen offset:1024 lds
v_mfma_f32_16x16x32_bf16 v[24:27], a[144:147], a[192:195], v[24:27]
ds_read_b64_tr_b16 a[140:141], v187 offset:16384
ds_read_b64_tr_b16 a[142:143], v187 offset:18432
v_mfma_f32_16x16x32_bf16 v[56:59], a[144:147], a[196:199], v[56:59]
ds_read_b64_tr_b16 a[144:145], v188 offset:16384
ds_read_b64_tr_b16 a[146:147], v188 offset:18432
v_mfma_f32_16x16x32_bf16 v[28:31], a[148:151], a[192:195], v[28:31]
v_mfma_f32_16x16x32_bf16 v[60:63], a[148:151], a[196:199], v[60:63]
buffer_load_dwordx4 v142, s[16:19], s42 offen offset:2048 lds
v_mfma_f32_16x16x32_bf16 v[32:35], a[152:155], a[192:195], v[32:35]
ds_read_b64_tr_b16 a[148:149], v189 offset:16384
ds_read_b64_tr_b16 a[150:151], v189 offset:18432
v_mfma_f32_16x16x32_bf16 v[64:67], a[152:155], a[196:199], v[64:67]
ds_read_b64_tr_b16 a[152:153], v190 offset:16384
ds_read_b64_tr_b16 a[154:155], v190 offset:18432
v_mfma_f32_16x16x32_bf16 v[36:39], a[156:159], a[192:195], v[36:39]
v_mfma_f32_16x16x32_bf16 v[68:71], a[156:159], a[196:199], v[68:71]
buffer_load_dwordx4 v143, s[16:19], s42 offen offset:3072 lds
v_mfma_f32_16x16x32_bf16 v[80:83], a[168:171], a[192:195], v[80:83]
s_waitcnt lgkmcnt(8)
ds_read_b64_tr_b16 a[156:157], v191 offset:16384
ds_read_b64_tr_b16 a[158:159], v191 offset:18432
v_mfma_f32_16x16x32_bf16 v[112:115], a[168:171], a[196:199], v[112:115]
s_lshl_b32 s72, s72, 12
ds_read_b64_tr_b16 a[168:169], v186 offset:16640
ds_read_b64_tr_b16 a[170:171], v186 offset:18688
v_mfma_f32_16x16x32_bf16 v[84:87], a[172:175], a[192:195], v[84:87]
s_add_u32 s42, s42, s72
v_mfma_f32_16x16x32_bf16 v[116:119], a[172:175], a[196:199], v[116:119]
ds_read_b64_tr_b16 a[172:173], v187 offset:16640
ds_read_b64_tr_b16 a[174:175], v187 offset:18688
v_mfma_f32_16x16x32_bf16 v[88:91], a[176:179], a[192:195], v[88:91]
v_mfma_f32_16x16x32_bf16 v[120:123], a[176:179], a[196:199], v[120:123]
ds_read_b64_tr_b16 a[176:177], v188 offset:16640
ds_read_b64_tr_b16 a[178:179], v188 offset:18688
v_mfma_f32_16x16x32_bf16 v[92:95], a[180:183], a[192:195], v[92:95]
v_mfma_f32_16x16x32_bf16 v[124:127], a[180:183], a[196:199], v[124:127]
ds_read_b64_tr_b16 a[180:181], v189 offset:16640
ds_read_b64_tr_b16 a[182:183], v189 offset:18688
v_mfma_f32_16x16x32_bf16 v[96:99], a[184:187], a[192:195], v[96:99]
v_mfma_f32_16x16x32_bf16 v[128:131], a[184:187], a[196:199], v[128:131]
ds_read_b64_tr_b16 a[184:185], v190 offset:16640
ds_read_b64_tr_b16 a[186:187], v190 offset:18688
v_mfma_f32_16x16x32_bf16 v[100:103], a[188:191], a[192:195], v[100:103]
v_mfma_f32_16x16x32_bf16 v[132:135], a[188:191], a[196:199], v[132:135]
ds_read_b64_tr_b16 a[188:189], v191 offset:16640
ds_read_b64_tr_b16 a[190:191], v191 offset:18688
v_mfma_f32_16x16x32_bf16 v[8:11], a[128:131], a[200:203], v[8:11]
v_mfma_f32_16x16x32_bf16 v[40:43], a[128:131], a[204:207], v[40:43]
v_mfma_f32_16x16x32_bf16 v[12:15], a[132:135], a[200:203], v[12:15]
v_mfma_f32_16x16x32_bf16 v[44:47], a[132:135], a[204:207], v[44:47]
v_smfmac_f32_16x16x64_bf16 a[248:251], a[208:211], a[128:135], v235
v_mfma_f32_16x16x32_bf16 v[72:75], a[160:163], a[200:203], v[72:75]
v_mfma_f32_16x16x32_bf16 v[104:107], a[160:163], a[204:207], v[104:107]
s_waitcnt vmcnt(12) lgkmcnt(0)
s_barrier
v_mfma_f32_16x16x32_bf16 v[76:79], a[164:167], a[200:203], v[76:79]
s_add_u32 m0, s45, 32768
ds_read_b128 a[192:195], v202 offset:0
ds_read_b128 a[196:199], v202 offset:2048
v_mfma_f32_16x16x32_bf16 v[108:111], a[164:167], a[204:207], v[108:111]
buffer_load_dwordx4 v144, s[24:27], s43 offen offset:0 lds
v_smfmac_f32_16x16x64_bf16 a[252:255], a[208:211], a[160:167], v235
ds_read_b64_tr_b16 a[128:129], v194 offset:0
ds_read_b64_tr_b16 a[130:131], v194 offset:2048
v_mfma_f32_16x16x32_bf16 v[16:19], a[136:139], a[200:203], v[16:19]
ds_read_b64_tr_b16 a[132:133], v195 offset:0
ds_read_b64_tr_b16 a[134:135], v195 offset:2048
v_mfma_f32_16x16x32_bf16 v[48:51], a[136:139], a[204:207], v[48:51]
ds_read_b64_tr_b16 a[160:161], v194 offset:256
ds_read_b64_tr_b16 a[162:163], v194 offset:2304
v_mfma_f32_16x16x32_bf16 v[20:23], a[140:143], a[200:203], v[20:23]
buffer_load_dwordx4 v145, s[24:27], s43 offen offset:1024 lds
v_mfma_f32_16x16x32_bf16 v[52:55], a[140:143], a[204:207], v[52:55]
ds_read_b64_tr_b16 a[164:165], v195 offset:256
ds_read_b64_tr_b16 a[166:167], v195 offset:2304
v_mfma_f32_16x16x32_bf16 v[24:27], a[144:147], a[200:203], v[24:27]
ds_read_b64_tr_b16 a[136:137], v196 offset:0
ds_read_b64_tr_b16 a[138:139], v196 offset:2048
v_mfma_f32_16x16x32_bf16 v[56:59], a[144:147], a[204:207], v[56:59]
ds_read_b64_tr_b16 a[140:141], v197 offset:0
ds_read_b64_tr_b16 a[142:143], v197 offset:2048
v_mfma_f32_16x16x32_bf16 v[28:31], a[148:151], a[200:203], v[28:31]
s_add_u32 m0, s85, 32768
ds_read_b64_tr_b16 a[144:145], v198 offset:0
ds_read_b64_tr_b16 a[146:147], v198 offset:2048
v_mfma_f32_16x16x32_bf16 v[60:63], a[148:151], a[204:207], v[60:63]
buffer_load_dwordx4 v146, s[24:27], s43 offen offset:0 lds
v_mfma_f32_16x16x32_bf16 v[32:35], a[152:155], a[200:203], v[32:35]
ds_read_b64_tr_b16 a[148:149], v199 offset:0
ds_read_b64_tr_b16 a[150:151], v199 offset:2048
v_mfma_f32_16x16x32_bf16 v[64:67], a[152:155], a[204:207], v[64:67]
ds_read_b64_tr_b16 a[152:153], v200 offset:0
ds_read_b64_tr_b16 a[154:155], v200 offset:2048
v_mfma_f32_16x16x32_bf16 v[36:39], a[156:159], a[200:203], v[36:39]
v_mfma_f32_16x16x32_bf16 v[68:71], a[156:159], a[204:207], v[68:71]
buffer_load_dwordx4 v147, s[24:27], s43 offen offset:1024 lds
v_mfma_f32_16x16x32_bf16 v[80:83], a[168:171], a[200:203], v[80:83]
s_cmp_eq_u32 s74, 2
s_cselect_b32 s72, s73, 128
ds_read_b64_tr_b16 a[156:157], v201 offset:0
ds_read_b64_tr_b16 a[158:159], v201 offset:2048
v_mfma_f32_16x16x32_bf16 v[112:115], a[168:171], a[204:207], v[112:115]
s_add_u32 s43, s43, s72
ds_read_b64_tr_b16 a[168:169], v196 offset:256
ds_read_b64_tr_b16 a[170:171], v196 offset:2304
v_mfma_f32_16x16x32_bf16 v[84:87], a[172:175], a[200:203], v[84:87]
s_add_u32 m0, s44, 0
v_mfma_f32_16x16x32_bf16 v[116:119], a[172:175], a[204:207], v[116:119]
buffer_load_dwordx4 v136, s[16:19], s42 offen offset:0 lds
v_mfma_f32_16x16x32_bf16 v[88:91], a[176:179], a[200:203], v[88:91]
ds_read_b64_tr_b16 a[172:173], v197 offset:256
ds_read_b64_tr_b16 a[174:175], v197 offset:2304
v_mfma_f32_16x16x32_bf16 v[120:123], a[176:179], a[204:207], v[120:123]
ds_read_b64_tr_b16 a[176:177], v198 offset:256
ds_read_b64_tr_b16 a[178:179], v198 offset:2304
v_mfma_f32_16x16x32_bf16 v[92:95], a[180:183], a[200:203], v[92:95]
v_mfma_f32_16x16x32_bf16 v[124:127], a[180:183], a[204:207], v[124:127]
buffer_load_dwordx4 v137, s[16:19], s42 offen offset:1024 lds
v_mfma_f32_16x16x32_bf16 v[96:99], a[184:187], a[200:203], v[96:99]
ds_read_b64_tr_b16 a[180:181], v199 offset:256
ds_read_b64_tr_b16 a[182:183], v199 offset:2304
v_mfma_f32_16x16x32_bf16 v[128:131], a[184:187], a[204:207], v[128:131]
ds_read_b64_tr_b16 a[184:185], v200 offset:256
ds_read_b64_tr_b16 a[186:187], v200 offset:2304
v_mfma_f32_16x16x32_bf16 v[100:103], a[188:191], a[200:203], v[100:103]
v_mfma_f32_16x16x32_bf16 v[132:135], a[188:191], a[204:207], v[132:135]
s_waitcnt lgkmcnt(8)
ds_read_b64_tr_b16 a[188:189], v201 offset:256
ds_read_b64_tr_b16 a[190:191], v201 offset:2304
s_bitcmp1_b32 s40, 4
s_cbranch_scc1 K_XP4
K_XP4D:
v_mfma_f32_16x16x32_bf16 v[8:11], a[128:131], a[192:195], v[8:11]
buffer_load_dwordx4 v138, s[16:19], s42 offen offset:2048 lds
v_mfma_f32_16x16x32_bf16 v[40:43], a[128:131], a[196:199], v[40:43]
ds_read_b128 a[200:203], v203 offset:0
ds_read_b128 a[204:207], v203 offset:2048
v_mfma_f32_16x16x32_bf16 v[12:15], a[132:135], a[192:195], v[12:15]
v_mfma_f32_16x16x32_bf16 v[44:47], a[132:135], a[196:199], v[44:47]
v_smfmac_f32_16x16x64_bf16 a[248:251], a[208:211], a[128:135], v235
ds_read_b64_tr_b16 a[128:129], v194 offset:16384
ds_read_b64_tr_b16 a[130:131], v194 offset:18432
v_mfma_f32_16x16x32_bf16 v[72:75], a[160:163], a[192:195], v[72:75]
buffer_load_dwordx4 v139, s[16:19], s42 offen offset:3072 lds
v_mfma_f32_16x16x32_bf16 v[104:107], a[160:163], a[196:199], v[104:107]
ds_read_b64_tr_b16 a[132:133], v195 offset:16384
ds_read_b64_tr_b16 a[134:135], v195 offset:18432
v_mfma_f32_16x16x32_bf16 v[76:79], a[164:167], a[192:195], v[76:79]
v_mfma_f32_16x16x32_bf16 v[108:111], a[164:167], a[196:199], v[108:111]
s_add_u32 m0, s44, 4096
v_smfmac_f32_16x16x64_bf16 a[252:255], a[208:211], a[160:167], v235
buffer_load_dwordx4 v140, s[16:19], s42 offen offset:0 lds
v_mfma_f32_16x16x32_bf16 v[16:19], a[136:139], a[192:195], v[16:19]
ds_read_b64_tr_b16 a[160:161], v194 offset:16640
ds_read_b64_tr_b16 a[162:163], v194 offset:18688
v_mfma_f32_16x16x32_bf16 v[48:51], a[136:139], a[196:199], v[48:51]
ds_read_b64_tr_b16 a[164:165], v195 offset:16640
ds_read_b64_tr_b16 a[166:167], v195 offset:18688
v_mfma_f32_16x16x32_bf16 v[20:23], a[140:143], a[192:195], v[20:23]
ds_read_b64_tr_b16 a[136:137], v196 offset:16384
ds_read_b64_tr_b16 a[138:139], v196 offset:18432
v_mfma_f32_16x16x32_bf16 v[52:55], a[140:143], a[196:199], v[52:55]
buffer_load_dwordx4 v141, s[16:19], s42 offen offset:1024 lds
v_mfma_f32_16x16x32_bf16 v[24:27], a[144:147], a[192:195], v[24:27]
ds_read_b64_tr_b16 a[140:141], v197 offset:16384
ds_read_b64_tr_b16 a[142:143], v197 offset:18432
v_mfma_f32_16x16x32_bf16 v[56:59], a[144:147], a[196:199], v[56:59]
ds_read_b64_tr_b16 a[144:145], v198 offset:16384
ds_read_b64_tr_b16 a[146:147], v198 offset:18432
v_mfma_f32_16x16x32_bf16 v[28:31], a[148:151], a[192:195], v[28:31]
v_mfma_f32_16x16x32_bf16 v[60:63], a[148:151], a[196:199], v[60:63]
buffer_load_dwordx4 v142, s[16:19], s42 offen offset:2048 lds
v_mfma_f32_16x16x32_bf16 v[32:35], a[152:155], a[192:195], v[32:35]
ds_read_b64_tr_b16 a[148:149], v199 offset:16384
ds_read_b64_tr_b16 a[150:151], v199 offset:18432
v_mfma_f32_16x16x32_bf16 v[64:67], a[152:155], a[196:199], v[64:67]
ds_read_b64_tr_b16 a[152:153], v200 offset:16384
ds_read_b64_tr_b16 a[154:155], v200 offset:18432
v_mfma_f32_16x16x32_bf16 v[36:39], a[156:159], a[192:195], v[36:39]
v_mfma_f32_16x16x32_bf16 v[68:71], a[156:159], a[196:199], v[68:71]
buffer_load_dwordx4 v143, s[16:19], s42 offen offset:3072 lds
v_mfma_f32_16x16x32_bf16 v[80:83], a[168:171], a[192:195], v[80:83]
s_lshl_b32 s72, s72, 12
ds_read_b64_tr_b16 a[156:157], v201 offset:16384
ds_read_b64_tr_b16 a[158:159], v201 offset:18432
v_mfma_f32_16x16x32_bf16 v[112:115], a[168:171], a[196:199], v[112:115]
s_waitcnt lgkmcnt(10)
s_add_u32 s42, s42, s72
ds_read_b64_tr_b16 a[168:169], v196 offset:16640
ds_read_b64_tr_b16 a[170:171], v196 offset:18688
v_mfma_f32_16x16x32_bf16 v[84:87], a[172:175], a[192:195], v[84:87]
s_lshr_b32 s48, s2, 5
v_mfma_f32_16x16x32_bf16 v[116:119], a[172:175], a[196:199], v[116:119]
s_lshl_b32 s48, s48, 13
ds_read_b64_tr_b16 a[172:173], v197 offset:16640
v_lshlrev_b32 v254, 5, v0
v_mfma_f32_16x16x32_bf16 v[88:91], a[176:179], a[192:195], v[88:91]
buffer_load_dword v252, v254, s[8:11], s48 offen
v_mfma_f32_16x16x32_bf16 v[120:123], a[176:179], a[196:199], v[120:123]
ds_read_b64_tr_b16 a[174:175], v197 offset:18688
ds_read_b64_tr_b16 a[176:177], v198 offset:16640
v_mfma_f32_16x16x32_bf16 v[92:95], a[180:183], a[192:195], v[92:95]
ds_read_b64_tr_b16 a[178:179], v198 offset:18688
v_mfma_f32_16x16x32_bf16 v[124:127], a[180:183], a[196:199], v[124:127]
ds_read_b64_tr_b16 a[180:181], v199 offset:16640
ds_read_b64_tr_b16 a[182:183], v199 offset:18688
v_mfma_f32_16x16x32_bf16 v[96:99], a[184:187], a[192:195], v[96:99]
buffer_load_dword v253, v254, s[12:15], s48 offen
v_mfma_f32_16x16x32_bf16 v[128:131], a[184:187], a[196:199], v[128:131]
ds_read_b64_tr_b16 a[184:185], v200 offset:16640
ds_read_b64_tr_b16 a[186:187], v200 offset:18688
v_mfma_f32_16x16x32_bf16 v[100:103], a[188:191], a[192:195], v[100:103]
v_mfma_f32_16x16x32_bf16 v[132:135], a[188:191], a[196:199], v[132:135]
ds_read_b64_tr_b16 a[188:189], v201 offset:16640
ds_read_b64_tr_b16 a[190:191], v201 offset:18688
v_mfma_f32_16x16x32_bf16 v[8:11], a[128:131], a[200:203], v[8:11]
v_mfma_f32_16x16x32_bf16 v[40:43], a[128:131], a[204:207], v[40:43]
v_mfma_f32_16x16x32_bf16 v[12:15], a[132:135], a[200:203], v[12:15]
v_mfma_f32_16x16x32_bf16 v[44:47], a[132:135], a[204:207], v[44:47]
v_smfmac_f32_16x16x64_bf16 a[248:251], a[208:211], a[128:135], v235
v_mfma_f32_16x16x32_bf16 v[72:75], a[160:163], a[200:203], v[72:75]
v_mfma_f32_16x16x32_bf16 v[104:107], a[160:163], a[204:207], v[104:107]
s_waitcnt vmcnt(14) lgkmcnt(0)
s_barrier
v_mfma_f32_16x16x32_bf16 v[76:79], a[164:167], a[200:203], v[76:79]
s_add_u32 m0, s45, 131072
ds_read_b128 a[192:195], v212 offset:0
ds_read_b128 a[196:199], v212 offset:2048
v_mfma_f32_16x16x32_bf16 v[108:111], a[164:167], a[204:207], v[108:111]
buffer_load_dwordx4 v144, s[24:27], s43 offen offset:0 lds
v_smfmac_f32_16x16x64_bf16 a[252:255], a[208:211], a[160:167], v235
ds_read_b64_tr_b16 a[128:129], v204 offset:0
ds_read_b64_tr_b16 a[130:131], v204 offset:2048
v_mfma_f32_16x16x32_bf16 v[16:19], a[136:139], a[200:203], v[16:19]
ds_read_b64_tr_b16 a[132:133], v205 offset:0
ds_read_b64_tr_b16 a[134:135], v205 offset:2048
v_mfma_f32_16x16x32_bf16 v[48:51], a[136:139], a[204:207], v[48:51]
ds_read_b64_tr_b16 a[160:161], v204 offset:256
ds_read_b64_tr_b16 a[162:163], v204 offset:2304
v_mfma_f32_16x16x32_bf16 v[20:23], a[140:143], a[200:203], v[20:23]
buffer_load_dwordx4 v145, s[24:27], s43 offen offset:1024 lds
v_mfma_f32_16x16x32_bf16 v[52:55], a[140:143], a[204:207], v[52:55]
ds_read_b64_tr_b16 a[164:165], v205 offset:256
ds_read_b64_tr_b16 a[166:167], v205 offset:2304
v_mfma_f32_16x16x32_bf16 v[24:27], a[144:147], a[200:203], v[24:27]
ds_read_b64_tr_b16 a[136:137], v206 offset:0
ds_read_b64_tr_b16 a[138:139], v206 offset:2048
v_mfma_f32_16x16x32_bf16 v[56:59], a[144:147], a[204:207], v[56:59]
s_add_u32 m0, s85, 131072
ds_read_b64_tr_b16 a[140:141], v207 offset:0
ds_read_b64_tr_b16 a[142:143], v207 offset:2048
v_mfma_f32_16x16x32_bf16 v[28:31], a[148:151], a[200:203], v[28:31]
buffer_load_dwordx4 v146, s[24:27], s43 offen offset:0 lds
v_mfma_f32_16x16x32_bf16 v[60:63], a[148:151], a[204:207], v[60:63]
ds_read_b64_tr_b16 a[144:145], v208 offset:0
ds_read_b64_tr_b16 a[146:147], v208 offset:2048
v_mfma_f32_16x16x32_bf16 v[32:35], a[152:155], a[200:203], v[32:35]
ds_read_b64_tr_b16 a[148:149], v209 offset:0
ds_read_b64_tr_b16 a[150:151], v209 offset:2048
v_mfma_f32_16x16x32_bf16 v[64:67], a[152:155], a[204:207], v[64:67]
ds_read_b64_tr_b16 a[152:153], v210 offset:0
ds_read_b64_tr_b16 a[154:155], v210 offset:2048
v_mfma_f32_16x16x32_bf16 v[36:39], a[156:159], a[200:203], v[36:39]
v_mfma_f32_16x16x32_bf16 v[68:71], a[156:159], a[204:207], v[68:71]
buffer_load_dwordx4 v147, s[24:27], s43 offen offset:1024 lds
v_mfma_f32_16x16x32_bf16 v[80:83], a[168:171], a[200:203], v[80:83]
s_cmp_eq_u32 s74, 1
s_cselect_b32 s72, s73, 128
ds_read_b64_tr_b16 a[156:157], v211 offset:0
ds_read_b64_tr_b16 a[158:159], v211 offset:2048
v_mfma_f32_16x16x32_bf16 v[112:115], a[168:171], a[204:207], v[112:115]
s_add_u32 s43, s43, s72
ds_read_b64_tr_b16 a[168:169], v206 offset:256
ds_read_b64_tr_b16 a[170:171], v206 offset:2304
v_mfma_f32_16x16x32_bf16 v[84:87], a[172:175], a[200:203], v[84:87]
s_add_u32 m0, s44, 98304
v_mfma_f32_16x16x32_bf16 v[116:119], a[172:175], a[204:207], v[116:119]
buffer_load_dwordx4 v136, s[16:19], s42 offen offset:0 lds
v_mfma_f32_16x16x32_bf16 v[88:91], a[176:179], a[200:203], v[88:91]
ds_read_b64_tr_b16 a[172:173], v207 offset:256
ds_read_b64_tr_b16 a[174:175], v207 offset:2304
v_mfma_f32_16x16x32_bf16 v[120:123], a[176:179], a[204:207], v[120:123]
ds_read_b64_tr_b16 a[176:177], v208 offset:256
ds_read_b64_tr_b16 a[178:179], v208 offset:2304
v_mfma_f32_16x16x32_bf16 v[92:95], a[180:183], a[200:203], v[92:95]
v_mfma_f32_16x16x32_bf16 v[124:127], a[180:183], a[204:207], v[124:127]
buffer_load_dwordx4 v137, s[16:19], s42 offen offset:1024 lds
v_mfma_f32_16x16x32_bf16 v[96:99], a[184:187], a[200:203], v[96:99]
ds_read_b64_tr_b16 a[180:181], v209 offset:256
ds_read_b64_tr_b16 a[182:183], v209 offset:2304
v_mfma_f32_16x16x32_bf16 v[128:131], a[184:187], a[204:207], v[128:131]
ds_read_b64_tr_b16 a[184:185], v210 offset:256
ds_read_b64_tr_b16 a[186:187], v210 offset:2304
v_mfma_f32_16x16x32_bf16 v[100:103], a[188:191], a[200:203], v[100:103]
v_mfma_f32_16x16x32_bf16 v[132:135], a[188:191], a[204:207], v[132:135]
s_waitcnt lgkmcnt(8)
ds_read_b64_tr_b16 a[188:189], v211 offset:256
ds_read_b64_tr_b16 a[190:191], v211 offset:2304
s_bitcmp1_b32 s40, 5
s_cbranch_scc1 K_XP5
K_XP5D:
v_mfma_f32_16x16x32_bf16 v[8:11], a[128:131], a[192:195], v[8:11]
buffer_load_dwordx4 v138, s[16:19], s42 offen offset:2048 lds
v_mfma_f32_16x16x32_bf16 v[40:43], a[128:131], a[196:199], v[40:43]
ds_read_b128 a[200:203], v213 offset:0
ds_read_b128 a[204:207], v213 offset:2048
v_mfma_f32_16x16x32_bf16 v[12:15], a[132:135], a[192:195], v[12:15]
v_mfma_f32_16x16x32_bf16 v[44:47], a[132:135], a[196:199], v[44:47]
v_smfmac_f32_16x16x64_bf16 a[248:251], a[208:211], a[128:135], v235
buffer_load_dwordx4 v139, s[16:19], s42 offen offset:3072 lds
v_mfma_f32_16x16x32_bf16 v[72:75], a[160:163], a[192:195], v[72:75]
ds_read_b64_tr_b16 a[128:129], v204 offset:16384
ds_read_b64_tr_b16 a[130:131], v204 offset:18432
v_mfma_f32_16x16x32_bf16 v[104:107], a[160:163], a[196:199], v[104:107]
ds_read_b64_tr_b16 a[132:133], v205 offset:16384
ds_read_b64_tr_b16 a[134:135], v205 offset:18432
v_mfma_f32_16x16x32_bf16 v[76:79], a[164:167], a[192:195], v[76:79]
v_mfma_f32_16x16x32_bf16 v[108:111], a[164:167], a[196:199], v[108:111]
s_add_u32 m0, s44, 102400
v_smfmac_f32_16x16x64_bf16 a[252:255], a[208:211], a[160:167], v235
buffer_load_dwordx4 v140, s[16:19], s42 offen offset:0 lds
v_mfma_f32_16x16x32_bf16 v[16:19], a[136:139], a[192:195], v[16:19]
ds_read_b64_tr_b16 a[160:161], v204 offset:16640
ds_read_b64_tr_b16 a[162:163], v204 offset:18688
v_mfma_f32_16x16x32_bf16 v[48:51], a[136:139], a[196:199], v[48:51]
ds_read_b64_tr_b16 a[164:165], v205 offset:16640
ds_read_b64_tr_b16 a[166:167], v205 offset:18688
v_mfma_f32_16x16x32_bf16 v[20:23], a[140:143], a[192:195], v[20:23]
ds_read_b64_tr_b16 a[136:137], v206 offset:16384
ds_read_b64_tr_b16 a[138:139], v206 offset:18432
v_mfma_f32_16x16x32_bf16 v[52:55], a[140:143], a[196:199], v[52:55]
buffer_load_dwordx4 v141, s[16:19], s42 offen offset:1024 lds
v_mfma_f32_16x16x32_bf16 v[24:27], a[144:147], a[192:195], v[24:27]
ds_read_b64_tr_b16 a[140:141], v207 offset:16384
ds_read_b64_tr_b16 a[142:143], v207 offset:18432
v_mfma_f32_16x16x32_bf16 v[56:59], a[144:147], a[196:199], v[56:59]
ds_read_b64_tr_b16 a[144:145], v208 offset:16384
ds_read_b64_tr_b16 a[146:147], v208 offset:18432
v_mfma_f32_16x16x32_bf16 v[28:31], a[148:151], a[192:195], v[28:31]
v_mfma_f32_16x16x32_bf16 v[60:63], a[148:151], a[196:199], v[60:63]
buffer_load_dwordx4 v142, s[16:19], s42 offen offset:2048 lds
v_mfma_f32_16x16x32_bf16 v[32:35], a[152:155], a[192:195], v[32:35]
ds_read_b64_tr_b16 a[148:149], v209 offset:16384
ds_read_b64_tr_b16 a[150:151], v209 offset:18432
v_mfma_f32_16x16x32_bf16 v[64:67], a[152:155], a[196:199], v[64:67]
ds_read_b64_tr_b16 a[152:153], v210 offset:16384
ds_read_b64_tr_b16 a[154:155], v210 offset:18432
v_mfma_f32_16x16x32_bf16 v[36:39], a[156:159], a[192:195], v[36:39]
v_mfma_f32_16x16x32_bf16 v[68:71], a[156:159], a[196:199], v[68:71]
buffer_load_dwordx4 v143, s[16:19], s42 offen offset:3072 lds
v_mfma_f32_16x16x32_bf16 v[80:83], a[168:171], a[192:195], v[80:83]
s_waitcnt lgkmcnt(8)
ds_read_b64_tr_b16 a[156:157], v211 offset:16384
ds_read_b64_tr_b16 a[158:159], v211 offset:18432
v_mfma_f32_16x16x32_bf16 v[112:115], a[168:171], a[196:199], v[112:115]
s_lshl_b32 s72, s72, 12
ds_read_b64_tr_b16 a[168:169], v206 offset:16640
ds_read_b64_tr_b16 a[170:171], v206 offset:18688
v_mfma_f32_16x16x32_bf16 v[84:87], a[172:175], a[192:195], v[84:87]
s_add_u32 s42, s42, s72
v_mfma_f32_16x16x32_bf16 v[116:119], a[172:175], a[196:199], v[116:119]
ds_read_b64_tr_b16 a[172:173], v207 offset:16640
ds_read_b64_tr_b16 a[174:175], v207 offset:18688
v_mfma_f32_16x16x32_bf16 v[88:91], a[176:179], a[192:195], v[88:91]
v_mfma_f32_16x16x32_bf16 v[120:123], a[176:179], a[196:199], v[120:123]
ds_read_b64_tr_b16 a[176:177], v208 offset:16640
ds_read_b64_tr_b16 a[178:179], v208 offset:18688
v_mfma_f32_16x16x32_bf16 v[92:95], a[180:183], a[192:195], v[92:95]
v_mfma_f32_16x16x32_bf16 v[124:127], a[180:183], a[196:199], v[124:127]
ds_read_b64_tr_b16 a[180:181], v209 offset:16640
ds_read_b64_tr_b16 a[182:183], v209 offset:18688
v_mfma_f32_16x16x32_bf16 v[96:99], a[184:187], a[192:195], v[96:99]
v_mfma_f32_16x16x32_bf16 v[128:131], a[184:187], a[196:199], v[128:131]
ds_read_b64_tr_b16 a[184:185], v210 offset:16640
ds_read_b64_tr_b16 a[186:187], v210 offset:18688
v_mfma_f32_16x16x32_bf16 v[100:103], a[188:191], a[192:195], v[100:103]
v_mfma_f32_16x16x32_bf16 v[132:135], a[188:191], a[196:199], v[132:135]
ds_read_b64_tr_b16 a[188:189], v211 offset:16640
ds_read_b64_tr_b16 a[190:191], v211 offset:18688
v_mfma_f32_16x16x32_bf16 v[8:11], a[128:131], a[200:203], v[8:11]
v_mfma_f32_16x16x32_bf16 v[40:43], a[128:131], a[204:207], v[40:43]
v_mfma_f32_16x16x32_bf16 v[12:15], a[132:135], a[200:203], v[12:15]
v_mfma_f32_16x16x32_bf16 v[44:47], a[132:135], a[204:207], v[44:47]
v_smfmac_f32_16x16x64_bf16 a[248:251], a[208:211], a[128:135], v235
v_mfma_f32_16x16x32_bf16 v[72:75], a[160:163], a[200:203], v[72:75]
v_mfma_f32_16x16x32_bf16 v[104:107], a[160:163], a[204:207], v[104:107]
s_waitcnt vmcnt(14) lgkmcnt(0)
s_barrier
s_cmp_lg_u32 s32, 0
s_cbranch_scc1 K_W0_11
v_lshlrev_b32 v255, 4, v3
buffer_load_dword v254, v255, s[28:31], 0 offen sc0 sc1
K_W0_11:
v_mfma_f32_16x16x32_bf16 v[76:79], a[164:167], a[200:203], v[76:79]
s_add_u32 m0, s45, 81920
ds_read_b128 a[192:195], v192 offset:0
ds_read_b128 a[196:199], v192 offset:2048
v_mfma_f32_16x16x32_bf16 v[108:111], a[164:167], a[204:207], v[108:111]
buffer_load_dwordx4 v144, s[24:27], s43 offen offset:0 lds
v_smfmac_f32_16x16x64_bf16 a[252:255], a[208:211], a[160:167], v235
ds_read_b64_tr_b16 a[128:129], v184 offset:0
ds_read_b64_tr_b16 a[130:131], v184 offset:2048
v_mfma_f32_16x16x32_bf16 v[16:19], a[136:139], a[200:203], v[16:19]
ds_read_b64_tr_b16 a[132:133], v185 offset:0
ds_read_b64_tr_b16 a[134:135], v185 offset:2048
v_mfma_f32_16x16x32_bf16 v[48:51], a[136:139], a[204:207], v[48:51]
ds_read_b64_tr_b16 a[160:161], v184 offset:256
ds_read_b64_tr_b16 a[162:163], v184 offset:2304
v_mfma_f32_16x16x32_bf16 v[20:23], a[140:143], a[200:203], v[20:23]
ds_read_b64_tr_b16 a[164:165], v185 offset:256
ds_read_b64_tr_b16 a[166:167], v185 offset:2304
v_mfma_f32_16x16x32_bf16 v[52:55], a[140:143], a[204:207], v[52:55]
buffer_load_dwordx4 v145, s[24:27], s43 offen offset:1024 lds
v_mfma_f32_16x16x32_bf16 v[24:27], a[144:147], a[200:203], v[24:27]
ds_read_b64_tr_b16 a[136:137], v186 offset:0
ds_read_b64_tr_b16 a[138:139], v186 offset:2048
v_mfma_f32_16x16x32_bf16 v[56:59], a[144:147], a[204:207], v[56:59]
ds_read_b64_tr_b16 a[140:141], v187 offset:0
ds_read_b64_tr_b16 a[142:143], v187 offset:2048
v_mfma_f32_16x16x32_bf16 v[28:31], a[148:151], a[200:203], v[28:31]
s_add_u32 m0, s85, 81920
ds_read_b64_tr_b16 a[144:145], v188 offset:0
ds_read_b64_tr_b16 a[146:147], v188 offset:2048
v_mfma_f32_16x16x32_bf16 v[60:63], a[148:151], a[204:207], v[60:63]
buffer_load_dwordx4 v146, s[24:27], s43 offen offset:0 lds
v_mfma_f32_16x16x32_bf16 v[32:35], a[152:155], a[200:203], v[32:35]
ds_read_b64_tr_b16 a[148:149], v189 offset:0
ds_read_b64_tr_b16 a[150:151], v189 offset:2048
v_mfma_f32_16x16x32_bf16 v[64:67], a[152:155], a[204:207], v[64:67]
ds_read_b64_tr_b16 a[152:153], v190 offset:0
ds_read_b64_tr_b16 a[154:155], v190 offset:2048
v_mfma_f32_16x16x32_bf16 v[36:39], a[156:159], a[200:203], v[36:39]
v_mfma_f32_16x16x32_bf16 v[68:71], a[156:159], a[204:207], v[68:71]
buffer_load_dwordx4 v147, s[24:27], s43 offen offset:1024 lds
v_mfma_f32_16x16x32_bf16 v[80:83], a[168:171], a[200:203], v[80:83]
s_cmp_eq_u32 s74, 0
s_cselect_b32 s72, s73, 128
ds_read_b64_tr_b16 a[156:157], v191 offset:0
ds_read_b64_tr_b16 a[158:159], v191 offset:2048
v_mfma_f32_16x16x32_bf16 v[112:115], a[168:171], a[204:207], v[112:115]
s_add_u32 s43, s43, s72
ds_read_b64_tr_b16 a[168:169], v186 offset:256
ds_read_b64_tr_b16 a[170:171], v186 offset:2304
v_mfma_f32_16x16x32_bf16 v[84:87], a[172:175], a[200:203], v[84:87]
s_add_u32 m0, s44, 49152
v_mfma_f32_16x16x32_bf16 v[116:119], a[172:175], a[204:207], v[116:119]
buffer_load_dwordx4 v136, s[16:19], s42 offen offset:0 lds
v_mfma_f32_16x16x32_bf16 v[88:91], a[176:179], a[200:203], v[88:91]
ds_read_b64_tr_b16 a[172:173], v187 offset:256
ds_read_b64_tr_b16 a[174:175], v187 offset:2304
v_mfma_f32_16x16x32_bf16 v[120:123], a[176:179], a[204:207], v[120:123]
ds_read_b64_tr_b16 a[176:177], v188 offset:256
ds_read_b64_tr_b16 a[178:179], v188 offset:2304
v_mfma_f32_16x16x32_bf16 v[92:95], a[180:183], a[200:203], v[92:95]
v_mfma_f32_16x16x32_bf16 v[124:127], a[180:183], a[204:207], v[124:127]
buffer_load_dwordx4 v137, s[16:19], s42 offen offset:1024 lds
v_mfma_f32_16x16x32_bf16 v[96:99], a[184:187], a[200:203], v[96:99]
ds_read_b64_tr_b16 a[180:181], v189 offset:256
ds_read_b64_tr_b16 a[182:183], v189 offset:2304
v_mfma_f32_16x16x32_bf16 v[128:131], a[184:187], a[204:207], v[128:131]
ds_read_b64_tr_b16 a[184:185], v190 offset:256
ds_read_b64_tr_b16 a[186:187], v190 offset:2304
v_mfma_f32_16x16x32_bf16 v[100:103], a[188:191], a[200:203], v[100:103]
v_mfma_f32_16x16x32_bf16 v[132:135], a[188:191], a[204:207], v[132:135]
s_waitcnt lgkmcnt(8)
ds_read_b64_tr_b16 a[188:189], v191 offset:256
ds_read_b64_tr_b16 a[190:191], v191 offset:2304
s_bitcmp1_b32 s40, 6
s_cbranch_scc1 K_XP6
K_XP6D:
v_mfma_f32_16x16x32_bf16 v[8:11], a[128:131], a[192:195], v[8:11]
buffer_load_dwordx4 v138, s[16:19], s42 offen offset:2048 lds
v_mfma_f32_16x16x32_bf16 v[40:43], a[128:131], a[196:199], v[40:43]
ds_read_b128 a[200:203], v193 offset:0
ds_read_b128 a[204:207], v193 offset:2048
v_mfma_f32_16x16x32_bf16 v[12:15], a[132:135], a[192:195], v[12:15]
v_mfma_f32_16x16x32_bf16 v[44:47], a[132:135], a[196:199], v[44:47]
v_smfmac_f32_16x16x64_bf16 a[248:251], a[208:211], a[128:135], v235
buffer_load_dwordx4 v139, s[16:19], s42 offen offset:3072 lds
v_mfma_f32_16x16x32_bf16 v[72:75], a[160:163], a[192:195], v[72:75]
ds_read_b64_tr_b16 a[128:129], v184 offset:16384
ds_read_b64_tr_b16 a[130:131], v184 offset:18432
v_mfma_f32_16x16x32_bf16 v[104:107], a[160:163], a[196:199], v[104:107]
ds_read_b64_tr_b16 a[132:133], v185 offset:16384
ds_read_b64_tr_b16 a[134:135], v185 offset:18432
v_mfma_f32_16x16x32_bf16 v[76:79], a[164:167], a[192:195], v[76:79]
s_add_u32 m0, s44, 53248
v_mfma_f32_16x16x32_bf16 v[108:111], a[164:167], a[196:199], v[108:111]
buffer_load_dwordx4 v140, s[16:19], s42 offen offset:0 lds
v_smfmac_f32_16x16x64_bf16 a[252:255], a[208:211], a[160:167], v235
ds_read_b64_tr_b16 a[160:161], v184 offset:16640
ds_read_b64_tr_b16 a[162:163], v184 offset:18688
v_mfma_f32_16x16x32_bf16 v[16:19], a[136:139], a[192:195], v[16:19]
ds_read_b64_tr_b16 a[164:165], v185 offset:16640
ds_read_b64_tr_b16 a[166:167], v185 offset:18688
v_mfma_f32_16x16x32_bf16 v[48:51], a[136:139], a[196:199], v[48:51]
ds_read_b64_tr_b16 a[136:137], v186 offset:16384
ds_read_b64_tr_b16 a[138:139], v186 offset:18432
v_mfma_f32_16x16x32_bf16 v[20:23], a[140:143], a[192:195], v[20:23]
buffer_load_dwordx4 v141, s[16:19], s42 offen offset:1024 lds
v_mfma_f32_16x16x32_bf16 v[52:55], a[140:143], a[196:199], v[52:55]
ds_read_b64_tr_b16 a[140:141], v187 offset:16384
ds_read_b64_tr_b16 a[142:143], v187 offset:18432
v_mfma_f32_16x16x32_bf16 v[24:27], a[144:147], a[192:195], v[24:27]
v_mfma_f32_16x16x32_bf16 v[56:59], a[144:147], a[196:199], v[56:59]
ds_read_b64_tr_b16 a[144:145], v188 offset:16384
ds_read_b64_tr_b16 a[146:147], v188 offset:18432
v_mfma_f32_16x16x32_bf16 v[28:31], a[148:151], a[192:195], v[28:31]
buffer_load_dwordx4 v142, s[16:19], s42 offen offset:2048 lds
v_mfma_f32_16x16x32_bf16 v[60:63], a[148:151], a[196:199], v[60:63]
ds_read_b64_tr_b16 a[148:149], v189 offset:16384
ds_read_b64_tr_b16 a[150:151], v189 offset:18432
v_mfma_f32_16x16x32_bf16 v[32:35], a[152:155], a[192:195], v[32:35]
v_mfma_f32_16x16x32_bf16 v[64:67], a[152:155], a[196:199], v[64:67]
ds_read_b64_tr_b16 a[152:153], v190 offset:16384
ds_read_b64_tr_b16 a[154:155], v190 offset:18432
v_mfma_f32_16x16x32_bf16 v[36:39], a[156:159], a[192:195], v[36:39]
v_mfma_f32_16x16x32_bf16 v[68:71], a[156:159], a[196:199], v[68:71]
buffer_load_dwordx4 v143, s[16:19], s42 offen offset:3072 lds
v_mfma_f32_16x16x32_bf16 v[80:83], a[168:171], a[192:195], v[80:83]
s_waitcnt lgkmcnt(8)
ds_read_b64_tr_b16 a[156:157], v191 offset:16384
ds_read_b64_tr_b16 a[158:159], v191 offset:18432
v_mfma_f32_16x16x32_bf16 v[112:115], a[168:171], a[196:199], v[112:115]
s_lshl_b32 s72, s72, 12
ds_read_b64_tr_b16 a[168:169], v186 offset:16640
ds_read_b64_tr_b16 a[170:171], v186 offset:18688
v_mfma_f32_16x16x32_bf16 v[84:87], a[172:175], a[192:195], v[84:87]
s_add_u32 s42, s42, s72
v_mfma_f32_16x16x32_bf16 v[116:119], a[172:175], a[196:199], v[116:119]
ds_read_b64_tr_b16 a[172:173], v187 offset:16640
ds_read_b64_tr_b16 a[174:175], v187 offset:18688
v_mfma_f32_16x16x32_bf16 v[88:91], a[176:179], a[192:195], v[88:91]
v_mfma_f32_16x16x32_bf16 v[120:123], a[176:179], a[196:199], v[120:123]
ds_read_b64_tr_b16 a[176:177], v188 offset:16640
ds_read_b64_tr_b16 a[178:179], v188 offset:18688
v_mfma_f32_16x16x32_bf16 v[92:95], a[180:183], a[192:195], v[92:95]
v_mfma_f32_16x16x32_bf16 v[124:127], a[180:183], a[196:199], v[124:127]
ds_read_b64_tr_b16 a[180:181], v189 offset:16640
ds_read_b64_tr_b16 a[182:183], v189 offset:18688
v_mfma_f32_16x16x32_bf16 v[96:99], a[184:187], a[192:195], v[96:99]
v_mfma_f32_16x16x32_bf16 v[128:131], a[184:187], a[196:199], v[128:131]
ds_read_b64_tr_b16 a[184:185], v190 offset:16640
ds_read_b64_tr_b16 a[186:187], v190 offset:18688
v_mfma_f32_16x16x32_bf16 v[100:103], a[188:191], a[192:195], v[100:103]
v_mfma_f32_16x16x32_bf16 v[132:135], a[188:191], a[196:199], v[132:135]
ds_read_b64_tr_b16 a[188:189], v191 offset:16640
ds_read_b64_tr_b16 a[190:191], v191 offset:18688
v_mfma_f32_16x16x32_bf16 v[8:11], a[128:131], a[200:203], v[8:11]
v_mfma_f32_16x16x32_bf16 v[40:43], a[128:131], a[204:207], v[40:43]
v_mfma_f32_16x16x32_bf16 v[12:15], a[132:135], a[200:203], v[12:15]
v_mfma_f32_16x16x32_bf16 v[44:47], a[132:135], a[204:207], v[44:47]
v_smfmac_f32_16x16x64_bf16 a[248:251], a[208:211], a[128:135], v235
v_mfma_f32_16x16x32_bf16 v[72:75], a[160:163], a[200:203], v[72:75]
v_mfma_f32_16x16x32_bf16 v[104:107], a[160:163], a[204:207], v[104:107]
s_cmp_lg_u32 s32, 0
s_cbranch_scc1 K_CNTOK
s_waitcnt vmcnt(12)
v_cmp_gt_u32 vcc, 16, v254
s_cbranch_vccz K_CNTOK
K_CNTSPIN:
s_sleep 2
s_add_u32 s100, s100, 1
s_bitcmp1_b32 s100, 19
s_cbranch_scc1 K_END
buffer_load_dword v254, v255, s[28:31], 0 offen sc0 sc1
s_waitcnt vmcnt(0)
v_cmp_gt_u32 vcc, 16, v254
s_cbranch_vccnz K_CNTSPIN
K_CNTOK:
s_waitcnt vmcnt(12) lgkmcnt(0)
s_barrier
v_mfma_f32_16x16x32_bf16 v[76:79], a[164:167], a[200:203], v[76:79]
s_mov_b32 s38, 0
ds_read_b128 a[192:195], v202 offset:0
ds_read_b128 a[196:199], v202 offset:2048
v_mfma_f32_16x16x32_bf16 v[108:111], a[164:167], a[204:207], v[108:111]
s_add_u32 m0, s37, 32768
ds_read_b64_tr_b16 a[128:129], v194 offset:0
ds_read_b64_tr_b16 a[130:131], v194 offset:2048
v_smfmac_f32_16x16x64_bf16 a[252:255], a[208:211], a[160:167], v235
buffer_load_dwordx4 v228, s[8:11], s38 offen offset:0 lds
v_mfma_f32_16x16x32_bf16 v[16:19], a[136:139], a[200:203], v[16:19]
ds_read_b64_tr_b16 a[132:133], v195 offset:0
ds_read_b64_tr_b16 a[134:135], v195 offset:2048
v_mfma_f32_16x16x32_bf16 v[48:51], a[136:139], a[204:207], v[48:51]
ds_read_b64_tr_b16 a[160:161], v194 offset:256
ds_read_b64_tr_b16 a[162:163], v194 offset:2304
v_mfma_f32_16x16x32_bf16 v[20:23], a[140:143], a[200:203], v[20:23]
ds_read_b64_tr_b16 a[164:165], v195 offset:256
ds_read_b64_tr_b16 a[166:167], v195 offset:2304
v_mfma_f32_16x16x32_bf16 v[52:55], a[140:143], a[204:207], v[52:55]
buffer_load_dwordx4 v229, s[8:11], s38 offen offset:1024 lds
v_mfma_f32_16x16x32_bf16 v[24:27], a[144:147], a[200:203], v[24:27]
ds_read_b64_tr_b16 a[136:137], v196 offset:0
ds_read_b64_tr_b16 a[138:139], v196 offset:2048
v_mfma_f32_16x16x32_bf16 v[56:59], a[144:147], a[204:207], v[56:59]
ds_read_b64_tr_b16 a[140:141], v197 offset:0
ds_read_b64_tr_b16 a[142:143], v197 offset:2048
v_mfma_f32_16x16x32_bf16 v[28:31], a[148:151], a[200:203], v[28:31]
ds_read_b64_tr_b16 a[144:145], v198 offset:0
ds_read_b64_tr_b16 a[146:147], v198 offset:2048
v_mfma_f32_16x16x32_bf16 v[60:63], a[148:151], a[204:207], v[60:63]
buffer_load_dwordx4 v230, s[8:11], s38 offen offset:2048 lds
v_mfma_f32_16x16x32_bf16 v[32:35], a[152:155], a[200:203], v[32:35]
ds_read_b64_tr_b16 a[148:149], v199 offset:0
ds_read_b64_tr_b16 a[150:151], v199 offset:2048
v_mfma_f32_16x16x32_bf16 v[64:67], a[152:155], a[204:207], v[64:67]
ds_read_b64_tr_b16 a[152:153], v200 offset:0
ds_read_b64_tr_b16 a[154:155], v200 offset:2048
v_mfma_f32_16x16x32_bf16 v[36:39], a[156:159], a[200:203], v[36:39]
v_mfma_f32_16x16x32_bf16 v[68:71], a[156:159], a[204:207], v[68:71]
buffer_load_dwordx4 v231, s[8:11], s38 offen offset:3072 lds
v_mfma_f32_16x16x32_bf16 v[80:83], a[168:171], a[200:203], v[80:83]
ds_read_b64_tr_b16 a[156:157], v201 offset:0
ds_read_b64_tr_b16 a[158:159], v201 offset:2048
v_mfma_f32_16x16x32_bf16 v[112:115], a[168:171], a[204:207], v[112:115]
ds_read_b64_tr_b16 a[168:169], v196 offset:256
ds_read_b64_tr_b16 a[170:171], v196 offset:2304
v_mfma_f32_16x16x32_bf16 v[84:87], a[172:175], a[200:203], v[84:87]
s_add_u32 s38, s38, 16384
v_mfma_f32_16x16x32_bf16 v[116:119], a[172:175], a[204:207], v[116:119]
s_add_u32 m0, s37, 16384
ds_read_b64_tr_b16 a[172:173], v197 offset:256
ds_read_b64_tr_b16 a[174:175], v197 offset:2304
v_mfma_f32_16x16x32_bf16 v[88:91], a[176:179], a[200:203], v[88:91]
buffer_load_dwordx4 v228, s[8:11], s38 offen offset:0 lds
v_mfma_f32_16x16x32_bf16 v[120:123], a[176:179], a[204:207], v[120:123]
ds_read_b64_tr_b16 a[176:177], v198 offset:256
ds_read_b64_tr_b16 a[178:179], v198 offset:2304
v_mfma_f32_16x16x32_bf16 v[92:95], a[180:183], a[200:203], v[92:95]
v_mfma_f32_16x16x32_bf16 v[124:127], a[180:183], a[204:207], v[124:127]
ds_read_b64_tr_b16 a[180:181], v199 offset:256
ds_read_b64_tr_b16 a[182:183], v199 offset:2304
v_mfma_f32_16x16x32_bf16 v[96:99], a[184:187], a[200:203], v[96:99]
buffer_load_dwordx4 v229, s[8:11], s38 offen offset:1024 lds
v_mfma_f32_16x16x32_bf16 v[128:131], a[184:187], a[204:207], v[128:131]
ds_read_b64_tr_b16 a[184:185], v200 offset:256
ds_read_b64_tr_b16 a[186:187], v200 offset:2304
v_mfma_f32_16x16x32_bf16 v[100:103], a[188:191], a[200:203], v[100:103]
v_mfma_f32_16x16x32_bf16 v[132:135], a[188:191], a[204:207], v[132:135]
s_waitcnt lgkmcnt(8)
ds_read_b64_tr_b16 a[188:189], v201 offset:256
ds_read_b64_tr_b16 a[190:191], v201 offset:2304
s_bitcmp1_b32 s40, 7
s_cbranch_scc1 K_XP7
K_XP7D:
v_mfma_f32_16x16x32_bf16 v[8:11], a[128:131], a[192:195], v[8:11]
s_add_u32 s76, s6, 0x270000
s_addc_u32 s77, s7, 0
buffer_load_dwordx4 v230, s[8:11], s38 offen offset:2048 lds
v_mfma_f32_16x16x32_bf16 v[40:43], a[128:131], a[196:199], v[40:43]
s_and_b32 s77, s77, 0xffff
ds_read_b128 a[200:203], v203 offset:0
ds_read_b128 a[204:207], v203 offset:2048
v_mfma_f32_16x16x32_bf16 v[12:15], a[132:135], a[192:195], v[12:15]
s_mov_b32 s78, 512
v_mfma_f32_16x16x32_bf16 v[44:47], a[132:135], a[196:199], v[44:47]
s_mov_b32 s79, 0x00020000
v_smfmac_f32_16x16x64_bf16 a[248:251], a[208:211], a[128:135], v235
s_mov_b32 s16, s86
buffer_load_dwordx4 v231, s[8:11], s38 offen offset:3072 lds
v_mfma_f32_16x16x32_bf16 v[72:75], a[160:163], a[192:195], v[72:75]
s_and_b32 s17, s87, 0xffff
ds_read_b64_tr_b16 a[128:129], v194 offset:16384
ds_read_b64_tr_b16 a[130:131], v194 offset:18432
v_mfma_f32_16x16x32_bf16 v[104:107], a[160:163], a[196:199], v[104:107]
s_add_u32 s38, s38, 16384
ds_read_b64_tr_b16 a[132:133], v195 offset:16384
ds_read_b64_tr_b16 a[134:135], v195 offset:18432
v_mfma_f32_16x16x32_bf16 v[76:79], a[164:167], a[192:195], v[76:79]
s_add_u32 m0, s37, 0
v_mfma_f32_16x16x32_bf16 v[108:111], a[164:167], a[196:199], v[108:111]
s_mov_b32 s18, 4718592
buffer_load_dwordx4 v228, s[8:11], s38 offen offset:0 lds
v_smfmac_f32_16x16x64_bf16 a[252:255], a[208:211], a[160:167], v235
s_mul_i32 s47, s35, 1179648
ds_read_b64_tr_b16 a[160:161], v194 offset:16640
ds_read_b64_tr_b16 a[162:163], v194 offset:18688
v_mfma_f32_16x16x32_bf16 v[16:19], a[136:139], a[192:195], v[16:19]
s_add_u32 s28, s86, s47
s_addc_u32 s29, s87, 0
ds_read_b64_tr_b16 a[164:165], v195 offset:16640
ds_read_b64_tr_b16 a[166:167], v195 offset:18688
v_mfma_f32_16x16x32_bf16 v[48:51], a[136:139], a[196:199], v[48:51]
s_and_b32 s29, s29, 0xffff
ds_read_b64_tr_b16 a[136:137], v196 offset:16384
ds_read_b64_tr_b16 a[138:139], v196 offset:18432
v_mfma_f32_16x16x32_bf16 v[20:23], a[140:143], a[192:195], v[20:23]
s_mov_b32 s30, 1179648
v_mfma_f32_16x16x32_bf16 v[52:55], a[140:143], a[196:199], v[52:55]
s_mov_b32 s42, 0xffc00000
buffer_load_dwordx4 v229, s[8:11], s38 offen offset:1024 lds
v_mfma_f32_16x16x32_bf16 v[24:27], a[144:147], a[192:195], v[24:27]
s_mov_b32 s43, 0x100000
ds_read_b64_tr_b16 a[140:141], v197 offset:16384
ds_read_b64_tr_b16 a[142:143], v197 offset:18432
v_mfma_f32_16x16x32_bf16 v[56:59], a[144:147], a[196:199], v[56:59]
s_lshr_b32 s46, s2, 3
ds_read_b64_tr_b16 a[144:145], v198 offset:16384
ds_read_b64_tr_b16 a[146:147], v198 offset:18432
v_mfma_f32_16x16x32_bf16 v[28:31], a[148:151], a[192:195], v[28:31]
s_lshl_b32 s46, s46, 2
v_mfma_f32_16x16x32_bf16 v[60:63], a[148:151], a[196:199], v[60:63]
s_add_u32 s46, s46, s32
buffer_load_dwordx4 v230, s[8:11], s38 offen offset:2048 lds
v_mfma_f32_16x16x32_bf16 v[32:35], a[152:155], a[192:195], v[32:35]
s_mul_i32 s45, s46, 4608
ds_read_b64_tr_b16 a[148:149], v199 offset:16384
ds_read_b64_tr_b16 a[150:151], v199 offset:18432
v_mfma_f32_16x16x32_bf16 v[64:67], a[152:155], a[196:199], v[64:67]
s_sub_u32 s45, s45, 6488064
ds_read_b64_tr_b16 a[152:153], v200 offset:16384
ds_read_b64_tr_b16 a[154:155], v200 offset:18432
v_mfma_f32_16x16x32_bf16 v[36:39], a[156:159], a[192:195], v[36:39]
s_min_u32 s46, s46, (K_CODE_END-K_LAST)>>10
v_mfma_f32_16x16x32_bf16 v[68:71], a[156:159], a[196:199], v[68:71]
s_lshl_b32 s46, s46, 10
buffer_load_dwordx4 v231, s[8:11], s38 offen offset:3072 lds
v_mfma_f32_16x16x32_bf16 v[80:83], a[168:171], a[192:195], v[80:83]
s_add_u32 s38, s38, 16384
ds_read_b64_tr_b16 a[156:157], v201 offset:16384
v_lshlrev_b32 v255, 3, v3
v_mfma_f32_16x16x32_bf16 v[112:115], a[168:171], a[196:199], v[112:115]
s_waitcnt lgkmcnt(9)
s_lshl_b32 s48, s55, 3
ds_read_b64_tr_b16 a[158:159], v201 offset:18432
ds_read_b64_tr_b16 a[168:169], v196 offset:16640
v_mfma_f32_16x16x32_bf16 v[84:87], a[172:175], a[192:195], v[84:87]
s_add_u32 s48, s48, 0x240000
ds_read_b64_tr_b16 a[170:171], v196 offset:18688
v_add_u32 v242, s46, v234
v_mfma_f32_16x16x32_bf16 v[116:119], a[172:175], a[196:199], v[116:119]
s_lshl_b32 s47, s2, 2
buffer_load_dwordx2 v[148:149], v255, s[20:23], s48 offen sc0 sc1
v_mfma_f32_16x16x32_bf16 v[88:91], a[176:179], a[192:195], v[88:91]
s_add_u32 s47, s47, s32
ds_read_b64_tr_b16 a[172:173], v197 offset:16640
ds_read_b64_tr_b16 a[174:175], v197 offset:18688
v_mfma_f32_16x16x32_bf16 v[120:123], a[176:179], a[196:199], v[120:123]
s_cmp_ge_u32 s47, 324
s_cselect_b64 s[24:25], s[60:61], s[56:57]
s_cselect_b32 s46, 324, 0
ds_read_b64_tr_b16 a[176:177], v198 offset:16640
ds_read_b64_tr_b16 a[178:179], v198 offset:18688
v_mfma_f32_16x16x32_bf16 v[92:95], a[180:183], a[192:195], v[92:95]
s_xor_b32 s48, s48, 128
v_mfma_f32_16x16x32_bf16 v[124:127], a[180:183], a[196:199], v[124:127]
s_cmp_ge_u32 s47, 648
s_cselect_b64 s[24:25], s[64:65], s[24:25]
s_cselect_b32 s46, 648, s46
buffer_load_dwordx2 v[150:151], v255, s[20:23], s48 offen sc0 sc1
v_mfma_f32_16x16x32_bf16 v[96:99], a[184:187], a[192:195], v[96:99]
s_sub_u32 s47, s47, s46
ds_read_b64_tr_b16 a[180:181], v199 offset:16640
ds_read_b64_tr_b16 a[182:183], v199 offset:18688
v_mfma_f32_16x16x32_bf16 v[128:131], a[184:187], a[196:199], v[128:131]
s_min_u32 s47, s47, 323
ds_read_b64_tr_b16 a[184:185], v200 offset:16640
ds_read_b64_tr_b16 a[186:187], v200 offset:18688
v_mfma_f32_16x16x32_bf16 v[100:103], a[188:191], a[192:195], v[100:103]
s_lshl_b32 s47, s47, 14
v_mfma_f32_16x16x32_bf16 v[132:135], a[188:191], a[196:199], v[132:135]
s_add_u32 s24, s24, s47
s_addc_u32 s25, s25, 0
ds_read_b64_tr_b16 a[188:189], v201 offset:16640
ds_read_b64_tr_b16 a[190:191], v201 offset:18688
s_mov_b32 s26, 16384
v_mfma_f32_16x16x32_bf16 v[8:11], a[128:131], a[200:203], v[8:11]
s_mov_b32 s44, 0
v_lshlrev_b32 v0, 6, v1
v_mfma_f32_16x16x32_bf16 v[40:43], a[128:131], a[204:207], v[40:43]
s_or_b32 s46, s32, s36
s_cselect_b32 s74, 8, 12
v_mfma_f32_16x16x32_bf16 v[12:15], a[132:135], a[200:203], v[12:15]
s_bitset1_b32 s74, 8
v_mfma_f32_16x16x32_bf16 v[44:47], a[132:135], a[204:207], v[44:47]
s_getpc_b64 s[72:73]
PC_c:
s_add_u32 s72, s72, K_LAST-PC_c
s_addc_u32 s73, s73, 0
v_smfmac_f32_16x16x64_bf16 a[248:251], a[208:211], a[128:135], v235
v_mfma_f32_16x16x32_bf16 v[72:75], a[160:163], a[200:203], v[72:75]
v_mfma_f32_16x16x32_bf16 v[104:107], a[160:163], a[204:207], v[104:107]
s_waitcnt vmcnt(2) lgkmcnt(0)
s_barrier
v_mfma_f32_16x16x32_bf16 v[76:79], a[164:167], a[200:203], v[76:79]
s_mov_b32 s39, 0
ds_read_b128 a[192:195], v212 offset:0
ds_read_b128 a[196:199], v212 offset:2048
v_mfma_f32_16x16x32_bf16 v[108:111], a[164:167], a[204:207], v[108:111]
s_add_u32 m0, s37, 98304
ds_read_b64_tr_b16 a[128:129], v204 offset:0
ds_read_b64_tr_b16 a[130:131], v204 offset:2048
v_smfmac_f32_16x16x64_bf16 a[252:255], a[208:211], a[160:167], v235
buffer_load_dwordx4 v232, s[12:15], s39 offen offset:0 lds
v_mfma_f32_16x16x32_bf16 v[16:19], a[136:139], a[200:203], v[16:19]
ds_read_b64_tr_b16 a[132:133], v205 offset:0
ds_read_b64_tr_b16 a[134:135], v205 offset:2048
v_mfma_f32_16x16x32_bf16 v[48:51], a[136:139], a[204:207], v[48:51]
ds_read_b64_tr_b16 a[160:161], v204 offset:256
ds_read_b64_tr_b16 a[162:163], v204 offset:2304
v_mfma_f32_16x16x32_bf16 v[20:23], a[140:143], a[200:203], v[20:23]
ds_read_b64_tr_b16 a[164:165], v205 offset:256
ds_read_b64_tr_b16 a[166:167], v205 offset:2304
v_mfma_f32_16x16x32_bf16 v[52:55], a[140:143], a[204:207], v[52:55]
buffer_load_dwordx4 v233, s[12:15], s39 offen offset:1024 lds
v_mfma_f32_16x16x32_bf16 v[24:27], a[144:147], a[200:203], v[24:27]
ds_read_b64_tr_b16 a[136:137], v206 offset:0
ds_read_b64_tr_b16 a[138:139], v206 offset:2048
v_mfma_f32_16x16x32_bf16 v[56:59], a[144:147], a[204:207], v[56:59]
ds_read_b64_tr_b16 a[140:141], v207 offset:0
ds_read_b64_tr_b16 a[142:143], v207 offset:2048
v_mfma_f32_16x16x32_bf16 v[28:31], a[148:151], a[200:203], v[28:31]
ds_read_b64_tr_b16 a[144:145], v208 offset:0
ds_read_b64_tr_b16 a[146:147], v208 offset:2048
v_mfma_f32_16x16x32_bf16 v[60:63], a[148:151], a[204:207], v[60:63]
buffer_load_dwordx4 v232, s[12:15], s39 offen offset:2048 lds
v_mfma_f32_16x16x32_bf16 v[32:35], a[152:155], a[200:203], v[32:35]
ds_read_b64_tr_b16 a[148:149], v209 offset:0
ds_read_b64_tr_b16 a[150:151], v209 offset:2048
v_mfma_f32_16x16x32_bf16 v[64:67], a[152:155], a[204:207], v[64:67]
ds_read_b64_tr_b16 a[152:153], v210 offset:0
ds_read_b64_tr_b16 a[154:155], v210 offset:2048
v_mfma_f32_16x16x32_bf16 v[36:39], a[156:159], a[200:203], v[36:39]
v_mfma_f32_16x16x32_bf16 v[68:71], a[156:159], a[204:207], v[68:71]
buffer_load_dwordx4 v233, s[12:15], s39 offen offset:3072 lds
v_mfma_f32_16x16x32_bf16 v[80:83], a[168:171], a[200:203], v[80:83]
ds_read_b64_tr_b16 a[156:157], v211 offset:0
ds_read_b64_tr_b16 a[158:159], v211 offset:2048
v_mfma_f32_16x16x32_bf16 v[112:115], a[168:171], a[204:207], v[112:115]
s_add_u32 s39, s39, 16384
ds_read_b64_tr_b16 a[168:169], v206 offset:256
ds_read_b64_tr_b16 a[170:171], v206 offset:2304
v_mfma_f32_16x16x32_bf16 v[84:87], a[172:175], a[200:203], v[84:87]
s_add_u32 m0, s37, 114688
v_mfma_f32_16x16x32_bf16 v[116:119], a[172:175], a[204:207], v[116:119]
buffer_load_dwordx4 v232, s[12:15], s39 offen offset:0 lds
v_mfma_f32_16x16x32_bf16 v[88:91], a[176:179], a[200:203], v[88:91]
ds_read_b64_tr_b16 a[172:173], v207 offset:256
ds_read_b64_tr_b16 a[174:175], v207 offset:2304
v_mfma_f32_16x16x32_bf16 v[120:123], a[176:179], a[204:207], v[120:123]
ds_read_b64_tr_b16 a[176:177], v208 offset:256
ds_read_b64_tr_b16 a[178:179], v208 offset:2304
v_mfma_f32_16x16x32_bf16 v[92:95], a[180:183], a[200:203], v[92:95]
v_mfma_f32_16x16x32_bf16 v[124:127], a[180:183], a[204:207], v[124:127]
ds_read_b64_tr_b16 a[180:181], v209 offset:256
ds_read_b64_tr_b16 a[182:183], v209 offset:2304
v_mfma_f32_16x16x32_bf16 v[96:99], a[184:187], a[200:203], v[96:99]
buffer_load_dwordx4 v233, s[12:15], s39 offen offset:1024 lds
v_mfma_f32_16x16x32_bf16 v[128:131], a[184:187], a[204:207], v[128:131]
ds_read_b64_tr_b16 a[184:185], v210 offset:256
ds_read_b64_tr_b16 a[186:187], v210 offset:2304
v_mfma_f32_16x16x32_bf16 v[100:103], a[188:191], a[200:203], v[100:103]
v_mfma_f32_16x16x32_bf16 v[132:135], a[188:191], a[204:207], v[132:135]
s_waitcnt lgkmcnt(8)
ds_read_b64_tr_b16 a[188:189], v211 offset:256
ds_read_b64_tr_b16 a[190:191], v211 offset:2304
s_bitcmp1_b32 s40, 8
s_cbranch_scc1 K_XP8
K_XP8D:
v_mfma_f32_16x16x32_bf16 v[8:11], a[128:131], a[192:195], v[8:11]
s_lshl_b32 s46, s32, 7
buffer_load_dwordx4 v232, s[12:15], s39 offen offset:2048 lds
v_mfma_f32_16x16x32_bf16 v[40:43], a[128:131], a[196:199], v[40:43]
s_add_u32 s46, s46, 147456
ds_read_b128 a[200:203], v213 offset:0
ds_read_b128 a[204:207], v213 offset:2048
v_mfma_f32_16x16x32_bf16 v[12:15], a[132:135], a[192:195], v[12:15]
v_lshl_add_u32 v144, v3, 2, s46
v_lshl_add_u32 v5, v4, 4, s46
v_mfma_f32_16x16x32_bf16 v[44:47], a[132:135], a[196:199], v[44:47]
v_xor_b32 v6, 128, v5
v_xor_b32 v7, 256, v5
v_smfmac_f32_16x16x64_bf16 a[248:251], a[208:211], a[128:135], v235
buffer_load_dwordx4 v233, s[12:15], s39 offen offset:3072 lds
v_mfma_f32_16x16x32_bf16 v[72:75], a[160:163], a[192:195], v[72:75]
ds_read_b64_tr_b16 a[128:129], v204 offset:16384
ds_read_b64_tr_b16 a[130:131], v204 offset:18432
v_mfma_f32_16x16x32_bf16 v[104:107], a[160:163], a[196:199], v[104:107]
ds_read_b64_tr_b16 a[132:133], v205 offset:16384
ds_read_b64_tr_b16 a[134:135], v205 offset:18432
v_mfma_f32_16x16x32_bf16 v[76:79], a[164:167], a[192:195], v[76:79]
s_add_u32 s39, s39, 16384
v_xor_b32 v254, 384, v5
v_readlane_b32 s92, v214, 0
v_mfma_f32_16x16x32_bf16 v[108:111], a[164:167], a[196:199], v[108:111]
v_readlane_b32 s93, v214, 32
v_smfmac_f32_16x16x64_bf16 a[252:255], a[208:211], a[160:167], v235
ds_read_b64_tr_b16 a[160:161], v204 offset:16640
ds_read_b64_tr_b16 a[162:163], v204 offset:18688
v_mfma_f32_16x16x32_bf16 v[16:19], a[136:139], a[192:195], v[16:19]
ds_read_b64_tr_b16 a[164:165], v205 offset:16640
ds_read_b64_tr_b16 a[166:167], v205 offset:18688
v_mfma_f32_16x16x32_bf16 v[48:51], a[136:139], a[196:199], v[48:51]
ds_read_b64_tr_b16 a[136:137], v206 offset:16384
ds_read_b64_tr_b16 a[138:139], v206 offset:18432
v_mfma_f32_16x16x32_bf16 v[20:23], a[140:143], a[192:195], v[20:23]
v_mfma_f32_16x16x32_bf16 v[52:55], a[140:143], a[196:199], v[52:55]
ds_read_b64_tr_b16 a[140:141], v207 offset:16384
ds_read_b64_tr_b16 a[142:143], v207 offset:18432
v_mfma_f32_16x16x32_bf16 v[24:27], a[144:147], a[192:195], v[24:27]
v_mfma_f32_16x16x32_bf16 v[56:59], a[144:147], a[196:199], v[56:59]
ds_read_b64_tr_b16 a[144:145], v208 offset:16384
ds_read_b64_tr_b16 a[146:147], v208 offset:18432
v_mfma_f32_16x16x32_bf16 v[28:31], a[148:151], a[192:195], v[28:31]
v_mfma_f32_16x16x32_bf16 v[60:63], a[148:151], a[196:199], v[60:63]
ds_read_b64_tr_b16 a[148:149], v209 offset:16384
ds_read_b64_tr_b16 a[150:151], v209 offset:18432
v_mfma_f32_16x16x32_bf16 v[32:35], a[152:155], a[192:195], v[32:35]
v_mfma_f32_16x16x32_bf16 v[64:67], a[152:155], a[196:199], v[64:67]
ds_read_b64_tr_b16 a[152:153], v210 offset:16384
ds_read_b64_tr_b16 a[154:155], v210 offset:18432
v_mfma_f32_16x16x32_bf16 v[36:39], a[156:159], a[192:195], v[36:39]
v_mfma_f32_16x16x32_bf16 v[68:71], a[156:159], a[196:199], v[68:71]
ds_read_b64_tr_b16 a[156:157], v211 offset:16384
ds_read_b64_tr_b16 a[158:159], v211 offset:18432
v_mfma_f32_16x16x32_bf16 v[80:83], a[168:171], a[192:195], v[80:83]
v_mfma_f32_16x16x32_bf16 v[112:115], a[168:171], a[196:199], v[112:115]
s_waitcnt lgkmcnt(8)
ds_read_b64_tr_b16 a[168:169], v206 offset:16640
ds_read_b64_tr_b16 a[170:171], v206 offset:18688
v_mfma_f32_16x16x32_bf16 v[84:87], a[172:175], a[192:195], v[84:87]
v_mfma_f32_16x16x32_bf16 v[116:119], a[172:175], a[196:199], v[116:119]
ds_read_b64_tr_b16 a[172:173], v207 offset:16640
ds_read_b64_tr_b16 a[174:175], v207 offset:18688
v_mfma_f32_16x16x32_bf16 v[88:91], a[176:179], a[192:195], v[88:91]
v_mfma_f32_16x16x32_bf16 v[120:123], a[176:179], a[196:199], v[120:123]
ds_read_b64_tr_b16 a[176:177], v208 offset:16640
ds_read_b64_tr_b16 a[178:179], v208 offset:18688
v_mfma_f32_16x16x32_bf16 v[92:95], a[180:183], a[192:195], v[92:95]
v_mfma_f32_16x16x32_bf16 v[124:127], a[180:183], a[196:199], v[124:127]
ds_read_b64_tr_b16 a[180:181], v209 offset:16640
ds_read_b64_tr_b16 a[182:183], v209 offset:18688
v_mfma_f32_16x16x32_bf16 v[96:99], a[184:187], a[192:195], v[96:99]
v_mfma_f32_16x16x32_bf16 v[128:131], a[184:187], a[196:199], v[128:131]
ds_read_b64_tr_b16 a[184:185], v210 offset:16640
ds_read_b64_tr_b16 a[186:187], v210 offset:18688
v_mfma_f32_16x16x32_bf16 v[100:103], a[188:191], a[192:195], v[100:103]
v_mfma_f32_16x16x32_bf16 v[132:135], a[188:191], a[196:199], v[132:135]
ds_read_b64_tr_b16 a[188:189], v211 offset:16640
ds_read_b64_tr_b16 a[190:191], v211 offset:18688
v_mfma_f32_16x16x32_bf16 v[8:11], a[128:131], a[200:203], v[8:11]
v_mfma_f32_16x16x32_bf16 v[40:43], a[128:131], a[204:207], v[40:43]
v_mfma_f32_16x16x32_bf16 v[12:15], a[132:135], a[200:203], v[12:15]
v_mfma_f32_16x16x32_bf16 v[44:47], a[132:135], a[204:207], v[44:47]
v_smfmac_f32_16x16x64_bf16 a[248:251], a[208:211], a[128:135], v235
ds_read_b128 a[128:131], v216 offset:32768
ds_read_b128 a[132:135], v217 offset:32768
v_mfma_f32_16x16x32_bf16 v[72:75], a[160:163], a[200:203], v[72:75]
v_mfma_f32_16x16x32_bf16 v[104:107], a[160:163], a[204:207], v[104:107]
v_mfma_f32_16x16x32_bf16 v[76:79], a[164:167], a[200:203], v[76:79]
v_mfma_f32_16x16x32_bf16 v[108:111], a[164:167], a[204:207], v[108:111]
v_smfmac_f32_16x16x64_bf16 a[252:255], a[208:211], a[160:167], v235
v_mfma_f32_16x16x32_bf16 v[16:19], a[136:139], a[200:203], v[16:19]
v_accvgpr_read_b32 v136, a248
v_accvgpr_read_b32 v137, a249
v_mfma_f32_16x16x32_bf16 v[48:51], a[136:139], a[204:207], v[48:51]
v_accvgpr_read_b32 v138, a250
v_accvgpr_read_b32 v139, a251
v_mfma_f32_16x16x32_bf16 v[20:23], a[140:143], a[200:203], v[20:23]
ds_read_b128 a[136:139], v218 offset:32768
v_mfma_f32_16x16x32_bf16 v[52:55], a[140:143], a[204:207], v[52:55]
s_waitcnt lgkmcnt(3)
ds_read_b128 a[140:143], v219 offset:32768
v_mfma_f32_16x16x32_bf16 v[24:27], a[144:147], a[200:203], v[24:27]
v_mfma_f32_16x16x32_bf16 v[56:59], a[144:147], a[204:207], v[56:59]
v_accvgpr_read_b32 v140, a252
v_accvgpr_read_b32 v141, a253
v_mfma_f32_16x16x32_bf16 v[28:31], a[148:151], a[200:203], v[28:31]
v_accvgpr_read_b32 v142, a254
v_accvgpr_read_b32 v143, a255
v_mfma_f32_16x16x32_bf16 v[60:63], a[148:151], a[204:207], v[60:63]
v_add_f32 v136, v136, v137
v_add_f32 v138, v138, v139
v_mfma_f32_16x16x32_bf16 v[32:35], a[152:155], a[200:203], v[32:35]
v_add_f32 v140, v140, v141
v_add_f32 v142, v142, v143
v_mfma_f32_16x16x32_bf16 v[64:67], a[152:155], a[204:207], v[64:67]
ds_write_b32 v144, v136 offset:0
ds_write_b32 v144, v138 offset:64
v_mfma_f32_16x16x32_bf16 v[36:39], a[156:159], a[200:203], v[36:39]
ds_write_b32 v144, v140 offset:512
ds_write_b32 v144, v142 offset:576
v_mfma_f32_16x16x32_bf16 v[68:71], a[156:159], a[204:207], v[68:71]
s_waitcnt vmcnt(8)
s_nop 0
ds_read_b128 a[144:147], v216 offset:36864
ds_read_b128 a[148:151], v217 offset:36864
v_mfma_f32_16x16x32_bf16 v[80:83], a[168:171], a[200:203], v[80:83]
ds_read_b128 a[152:155], v218 offset:36864
ds_read_b128 a[156:159], v219 offset:36864
v_mfma_f32_16x16x32_bf16 v[112:115], a[168:171], a[204:207], v[112:115]
v_accvgpr_write_b32 a246, v148
v_accvgpr_write_b32 a247, v149
v_mfma_f32_16x16x32_bf16 v[84:87], a[172:175], a[200:203], v[84:87]
v_rcp_f32 v149, v149
v_mfma_f32_16x16x32_bf16 v[116:119], a[172:175], a[204:207], v[116:119]
s_waitcnt lgkmcnt(0)
s_barrier
v_mfma_f32_16x16x32_bf16 v[88:91], a[176:179], a[200:203], v[88:91]
ds_read_b128 v[184:187], v5 offset:0
ds_read_b128 v[188:191], v5 offset:64
v_mfma_f32_16x16x32_bf16 v[120:123], a[176:179], a[204:207], v[120:123]
ds_read_b128 v[192:195], v6 offset:0
ds_read_b128 v[196:199], v6 offset:64
v_mfma_f32_16x16x32_bf16 v[92:95], a[180:183], a[200:203], v[92:95]
ds_read_b128 v[200:203], v7 offset:0
ds_read_b128 v[204:207], v7 offset:64
v_mfma_f32_16x16x32_bf16 v[124:127], a[180:183], a[204:207], v[124:127]
ds_read_b128 v[208:211], v254 offset:0
ds_read_b128 v[212:215], v254 offset:64
v_mfma_f32_16x16x32_bf16 v[96:99], a[184:187], a[200:203], v[96:99]
v_rcp_f32 v151, v151
v_mfma_f32_16x16x32_bf16 v[128:131], a[184:187], a[204:207], v[128:131]
v_sub_f32 v148, 0, v148
v_sub_f32 v150, 0, v150
v_mfma_f32_16x16x32_bf16 v[100:103], a[188:191], a[200:203], v[100:103]
v_mul_f32 v149, 0x3e0293ee, v149
v_mul_f32 v151, 0x3e0293ee, v151
v_mfma_f32_16x16x32_bf16 v[132:135], a[188:191], a[204:207], v[132:135]
v_accvgpr_write_b32 a248, 0
v_accvgpr_write_b32 a249, 0
v_accvgpr_write_b32 a250, 0
v_accvgpr_write_b32 a251, 0
v_accvgpr_write_b32 a252, 0
v_accvgpr_write_b32 a253, 0
v_accvgpr_write_b32 a254, 0
v_accvgpr_write_b32 a255, 0
s_waitcnt lgkmcnt(0)
v_pk_fma_f32 v[8:9], v[184:185], v[148:149], v[8:9] op_sel:[0,0,0] op_sel_hi:[1,0,1]
v_pk_fma_f32 v[10:11], v[186:187], v[148:149], v[10:11] op_sel:[0,0,0] op_sel_hi:[1,0,1]
v_pk_mul_f32 v[8:9], v[8:9], v[148:149] op_sel:[0,1] op_sel_hi:[1,1]
v_pk_mul_f32 v[10:11], v[10:11], v[148:149] op_sel:[0,1] op_sel_hi:[1,1]
v_pk_fma_f32 v[12:13], v[188:189], v[148:149], v[12:13] op_sel:[0,0,0] op_sel_hi:[1,0,1]
v_pk_fma_f32 v[14:15], v[190:191], v[148:149], v[14:15] op_sel:[0,0,0] op_sel_hi:[1,0,1]
v_pk_mul_f32 v[12:13], v[12:13], v[148:149] op_sel:[0,1] op_sel_hi:[1,1]
v_pk_mul_f32 v[14:15], v[14:15], v[148:149] op_sel:[0,1] op_sel_hi:[1,1]
v_pk_fma_f32 v[16:17], v[192:193], v[148:149], v[16:17] op_sel:[0,0,0] op_sel_hi:[1,0,1]
v_pk_fma_f32 v[18:19], v[194:195], v[148:149], v[18:19] op_sel:[0,0,0] op_sel_hi:[1,0,1]
v_pk_mul_f32 v[16:17], v[16:17], v[148:149] op_sel:[0,1] op_sel_hi:[1,1]
v_pk_mul_f32 v[18:19], v[18:19], v[148:149] op_sel:[0,1] op_sel_hi:[1,1]
v_pk_fma_f32 v[20:21], v[196:197], v[148:149], v[20:21] op_sel:[0,0,0] op_sel_hi:[1,0,1]
v_pk_fma_f32 v[22:23], v[198:199], v[148:149], v[22:23] op_sel:[0,0,0] op_sel_hi:[1,0,1]
v_pk_mul_f32 v[20:21], v[20:21], v[148:149] op_sel:[0,1] op_sel_hi:[1,1]
v_pk_mul_f32 v[22:23], v[22:23], v[148:149] op_sel:[0,1] op_sel_hi:[1,1]
v_pk_fma_f32 v[24:25], v[200:201], v[148:149], v[24:25] op_sel:[0,0,0] op_sel_hi:[1,0,1]
v_pk_fma_f32 v[26:27], v[202:203], v[148:149], v[26:27] op_sel:[0,0,0] op_sel_hi:[1,0,1]
v_pk_mul_f32 v[24:25], v[24:25], v[148:149] op_sel:[0,1] op_sel_hi:[1,1]
v_pk_mul_f32 v[26:27], v[26:27], v[148:149] op_sel:[0,1] op_sel_hi:[1,1]
v_pk_fma_f32 v[28:29], v[204:205], v[148:149], v[28:29] op_sel:[0,0,0] op_sel_hi:[1,0,1]
v_pk_fma_f32 v[30:31], v[206:207], v[148:149], v[30:31] op_sel:[0,0,0] op_sel_hi:[1,0,1]
v_pk_mul_f32 v[28:29], v[28:29], v[148:149] op_sel:[0,1] op_sel_hi:[1,1]
v_pk_mul_f32 v[30:31], v[30:31], v[148:149] op_sel:[0,1] op_sel_hi:[1,1]
v_pk_fma_f32 v[32:33], v[208:209], v[148:149], v[32:33] op_sel:[0,0,0] op_sel_hi:[1,0,1]
v_pk_fma_f32 v[34:35], v[210:211], v[148:149], v[34:35] op_sel:[0,0,0] op_sel_hi:[1,0,1]
v_pk_mul_f32 v[32:33], v[32:33], v[148:149] op_sel:[0,1] op_sel_hi:[1,1]
v_pk_mul_f32 v[34:35], v[34:35], v[148:149] op_sel:[0,1] op_sel_hi:[1,1]
v_pk_fma_f32 v[36:37], v[212:213], v[148:149], v[36:37] op_sel:[0,0,0] op_sel_hi:[1,0,1]
v_pk_fma_f32 v[38:39], v[214:215], v[148:149], v[38:39] op_sel:[0,0,0] op_sel_hi:[1,0,1]
v_pk_mul_f32 v[36:37], v[36:37], v[148:149] op_sel:[0,1] op_sel_hi:[1,1]
v_pk_mul_f32 v[38:39], v[38:39], v[148:149] op_sel:[0,1] op_sel_hi:[1,1]
v_cvt_pk_bf16_f32 v152, v8, v9
v_cvt_pk_bf16_f32 v153, v10, v11
v_cvt_pk_bf16_f32 v154, v12, v13
v_cvt_pk_bf16_f32 v155, v14, v15
v_cvt_pk_bf16_f32 v156, v16, v17
v_cvt_pk_bf16_f32 v157, v18, v19
v_cvt_pk_bf16_f32 v158, v20, v21
v_cvt_pk_bf16_f32 v159, v22, v23
v_cvt_pk_bf16_f32 v160, v24, v25
v_cvt_pk_bf16_f32 v161, v26, v27
v_cvt_pk_bf16_f32 v162, v28, v29
v_cvt_pk_bf16_f32 v163, v30, v31
v_cvt_pk_bf16_f32 v164, v32, v33
v_cvt_pk_bf16_f32 v165, v34, v35
v_cvt_pk_bf16_f32 v166, v36, v37
v_cvt_pk_bf16_f32 v167, v38, v39
v_permlane16_swap_b32 v152, v154
v_permlane16_swap_b32 v153, v155
v_permlane16_swap_b32 v156, v158
v_permlane16_swap_b32 v157, v159
v_permlane16_swap_b32 v160, v162
v_permlane16_swap_b32 v161, v163
v_permlane16_swap_b32 v164, v166
v_permlane16_swap_b32 v165, v167
v_pk_fma_f32 v[40:41], v[184:185], v[150:151], v[40:41] op_sel:[0,0,0] op_sel_hi:[1,0,1]
v_pk_fma_f32 v[42:43], v[186:187], v[150:151], v[42:43] op_sel:[0,0,0] op_sel_hi:[1,0,1]
v_pk_mul_f32 v[40:41], v[40:41], v[150:151] op_sel:[0,1] op_sel_hi:[1,1]
v_pk_mul_f32 v[42:43], v[42:43], v[150:151] op_sel:[0,1] op_sel_hi:[1,1]
v_pk_fma_f32 v[44:45], v[188:189], v[150:151], v[44:45] op_sel:[0,0,0] op_sel_hi:[1,0,1]
v_pk_fma_f32 v[46:47], v[190:191], v[150:151], v[46:47] op_sel:[0,0,0] op_sel_hi:[1,0,1]
v_pk_mul_f32 v[44:45], v[44:45], v[150:151] op_sel:[0,1] op_sel_hi:[1,1]
v_pk_mul_f32 v[46:47], v[46:47], v[150:151] op_sel:[0,1] op_sel_hi:[1,1]
v_pk_fma_f32 v[48:49], v[192:193], v[150:151], v[48:49] op_sel:[0,0,0] op_sel_hi:[1,0,1]
v_pk_fma_f32 v[50:51], v[194:195], v[150:151], v[50:51] op_sel:[0,0,0] op_sel_hi:[1,0,1]
v_pk_mul_f32 v[48:49], v[48:49], v[150:151] op_sel:[0,1] op_sel_hi:[1,1]
v_pk_mul_f32 v[50:51], v[50:51], v[150:151] op_sel:[0,1] op_sel_hi:[1,1]
v_pk_fma_f32 v[52:53], v[196:197], v[150:151], v[52:53] op_sel:[0,0,0] op_sel_hi:[1,0,1]
v_pk_fma_f32 v[54:55], v[198:199], v[150:151], v[54:55] op_sel:[0,0,0] op_sel_hi:[1,0,1]
v_pk_mul_f32 v[52:53], v[52:53], v[150:151] op_sel:[0,1] op_sel_hi:[1,1]
v_pk_mul_f32 v[54:55], v[54:55], v[150:151] op_sel:[0,1] op_sel_hi:[1,1]
v_pk_fma_f32 v[56:57], v[200:201], v[150:151], v[56:57] op_sel:[0,0,0] op_sel_hi:[1,0,1]
v_pk_fma_f32 v[58:59], v[202:203], v[150:151], v[58:59] op_sel:[0,0,0] op_sel_hi:[1,0,1]
v_pk_mul_f32 v[56:57], v[56:57], v[150:151] op_sel:[0,1] op_sel_hi:[1,1]
v_pk_mul_f32 v[58:59], v[58:59], v[150:151] op_sel:[0,1] op_sel_hi:[1,1]
v_pk_fma_f32 v[60:61], v[204:205], v[150:151], v[60:61] op_sel:[0,0,0] op_sel_hi:[1,0,1]
v_pk_fma_f32 v[62:63], v[206:207], v[150:151], v[62:63] op_sel:[0,0,0] op_sel_hi:[1,0,1]
v_pk_mul_f32 v[60:61], v[60:61], v[150:151] op_sel:[0,1] op_sel_hi:[1,1]
v_pk_mul_f32 v[62:63], v[62:63], v[150:151] op_sel:[0,1] op_sel_hi:[1,1]
v_pk_fma_f32 v[64:65], v[208:209], v[150:151], v[64:65] op_sel:[0,0,0] op_sel_hi:[1,0,1]
v_pk_fma_f32 v[66:67], v[210:211], v[150:151], v[66:67] op_sel:[0,0,0] op_sel_hi:[1,0,1]
v_pk_mul_f32 v[64:65], v[64:65], v[150:151] op_sel:[0,1] op_sel_hi:[1,1]
v_pk_mul_f32 v[66:67], v[66:67], v[150:151] op_sel:[0,1] op_sel_hi:[1,1]
v_pk_fma_f32 v[68:69], v[212:213], v[150:151], v[68:69] op_sel:[0,0,0] op_sel_hi:[1,0,1]
v_pk_fma_f32 v[70:71], v[214:215], v[150:151], v[70:71] op_sel:[0,0,0] op_sel_hi:[1,0,1]
v_pk_mul_f32 v[68:69], v[68:69], v[150:151] op_sel:[0,1] op_sel_hi:[1,1]
v_pk_mul_f32 v[70:71], v[70:71], v[150:151] op_sel:[0,1] op_sel_hi:[1,1]
v_mfma_f32_16x16x32_bf16 v[8:11], a[128:131], v[152:155], 0
ds_read_b128 v[24:27], v5 offset:512
v_cvt_pk_bf16_f32 v168, v40, v41
v_mfma_f32_16x16x32_bf16 v[8:11], a[132:135], v[156:159], v[8:11]
ds_read_b128 v[28:31], v5 offset:576
v_cvt_pk_bf16_f32 v169, v42, v43
v_mfma_f32_16x16x32_bf16 v[8:11], a[136:139], v[160:163], v[8:11]
ds_read_b128 v[32:35], v6 offset:512
v_cvt_pk_bf16_f32 v170, v44, v45
v_mfma_f32_16x16x32_bf16 v[8:11], a[140:143], v[164:167], v[8:11]
ds_read_b128 v[36:39], v6 offset:576
v_cvt_pk_bf16_f32 v171, v46, v47
v_mfma_f32_16x16x32_bf16 v[12:15], a[144:147], v[152:155], 0
ds_read_b128 v[136:139], v7 offset:512
v_cvt_pk_bf16_f32 v172, v48, v49
v_mfma_f32_16x16x32_bf16 v[12:15], a[148:151], v[156:159], v[12:15]
ds_read_b128 v[140:143], v7 offset:576
v_cvt_pk_bf16_f32 v173, v50, v51
v_mfma_f32_16x16x32_bf16 v[12:15], a[152:155], v[160:163], v[12:15]
ds_read_b128 v[144:147], v254 offset:512
v_cvt_pk_bf16_f32 v174, v52, v53
v_mfma_f32_16x16x32_bf16 v[12:15], a[156:159], v[164:167], v[12:15]
ds_read_b128 v[244:247], v254 offset:576
v_cvt_pk_bf16_f32 v175, v54, v55
v_cvt_pk_bf16_f32 v176, v56, v57
v_cvt_pk_bf16_f32 v177, v58, v59
v_cvt_pk_bf16_f32 v178, v60, v61
v_cvt_pk_bf16_f32 v179, v62, v63
v_cvt_pk_bf16_f32 v180, v64, v65
v_cvt_pk_bf16_f32 v181, v66, v67
v_cvt_pk_bf16_f32 v182, v68, v69
v_cvt_pk_bf16_f32 v183, v70, v71
v_permlane16_swap_b32 v168, v170
v_permlane16_swap_b32 v169, v171
v_permlane16_swap_b32 v172, v174
v_permlane16_swap_b32 v173, v175
v_permlane16_swap_b32 v176, v178
v_permlane16_swap_b32 v177, v179
v_permlane16_swap_b32 v180, v182
v_permlane16_swap_b32 v181, v183
s_waitcnt lgkmcnt(0)
v_pk_fma_f32 v[72:73], v[24:25], v[148:149], v[72:73] op_sel:[0,0,0] op_sel_hi:[1,0,1]
v_pk_fma_f32 v[74:75], v[26:27], v[148:149], v[74:75] op_sel:[0,0,0] op_sel_hi:[1,0,1]
v_pk_mul_f32 v[72:73], v[72:73], v[148:149] op_sel:[0,1] op_sel_hi:[1,1]
v_pk_mul_f32 v[74:75], v[74:75], v[148:149] op_sel:[0,1] op_sel_hi:[1,1]
v_pk_fma_f32 v[76:77], v[28:29], v[148:149], v[76:77] op_sel:[0,0,0] op_sel_hi:[1,0,1]
v_pk_fma_f32 v[78:79], v[30:31], v[148:149], v[78:79] op_sel:[0,0,0] op_sel_hi:[1,0,1]
v_pk_mul_f32 v[76:77], v[76:77], v[148:149] op_sel:[0,1] op_sel_hi:[1,1]
v_pk_mul_f32 v[78:79], v[78:79], v[148:149] op_sel:[0,1] op_sel_hi:[1,1]
v_pk_fma_f32 v[80:81], v[32:33], v[148:149], v[80:81] op_sel:[0,0,0] op_sel_hi:[1,0,1]
v_pk_fma_f32 v[82:83], v[34:35], v[148:149], v[82:83] op_sel:[0,0,0] op_sel_hi:[1,0,1]
v_pk_mul_f32 v[80:81], v[80:81], v[148:149] op_sel:[0,1] op_sel_hi:[1,1]
v_pk_mul_f32 v[82:83], v[82:83], v[148:149] op_sel:[0,1] op_sel_hi:[1,1]
v_pk_fma_f32 v[84:85], v[36:37], v[148:149], v[84:85] op_sel:[0,0,0] op_sel_hi:[1,0,1]
v_pk_fma_f32 v[86:87], v[38:39], v[148:149], v[86:87] op_sel:[0,0,0] op_sel_hi:[1,0,1]
v_pk_mul_f32 v[84:85], v[84:85], v[148:149] op_sel:[0,1] op_sel_hi:[1,1]
v_pk_mul_f32 v[86:87], v[86:87], v[148:149] op_sel:[0,1] op_sel_hi:[1,1]
v_pk_fma_f32 v[88:89], v[136:137], v[148:149], v[88:89] op_sel:[0,0,0] op_sel_hi:[1,0,1]
v_pk_fma_f32 v[90:91], v[138:139], v[148:149], v[90:91] op_sel:[0,0,0] op_sel_hi:[1,0,1]
v_pk_mul_f32 v[88:89], v[88:89], v[148:149] op_sel:[0,1] op_sel_hi:[1,1]
v_pk_mul_f32 v[90:91], v[90:91], v[148:149] op_sel:[0,1] op_sel_hi:[1,1]
v_pk_fma_f32 v[92:93], v[140:141], v[148:149], v[92:93] op_sel:[0,0,0] op_sel_hi:[1,0,1]
v_pk_fma_f32 v[94:95], v[142:143], v[148:149], v[94:95] op_sel:[0,0,0] op_sel_hi:[1,0,1]
v_pk_mul_f32 v[92:93], v[92:93], v[148:149] op_sel:[0,1] op_sel_hi:[1,1]
v_pk_mul_f32 v[94:95], v[94:95], v[148:149] op_sel:[0,1] op_sel_hi:[1,1]
v_pk_fma_f32 v[96:97], v[144:145], v[148:149], v[96:97] op_sel:[0,0,0] op_sel_hi:[1,0,1]
v_pk_fma_f32 v[98:99], v[146:147], v[148:149], v[98:99] op_sel:[0,0,0] op_sel_hi:[1,0,1]
v_pk_mul_f32 v[96:97], v[96:97], v[148:149] op_sel:[0,1] op_sel_hi:[1,1]
v_pk_mul_f32 v[98:99], v[98:99], v[148:149] op_sel:[0,1] op_sel_hi:[1,1]
v_pk_fma_f32 v[100:101], v[244:245], v[148:149], v[100:101] op_sel:[0,0,0] op_sel_hi:[1,0,1]
v_pk_fma_f32 v[102:103], v[246:247], v[148:149], v[102:103] op_sel:[0,0,0] op_sel_hi:[1,0,1]
v_pk_mul_f32 v[100:101], v[100:101], v[148:149] op_sel:[0,1] op_sel_hi:[1,1]
v_pk_mul_f32 v[102:103], v[102:103], v[148:149] op_sel:[0,1] op_sel_hi:[1,1]
v_mfma_f32_16x16x32_bf16 v[16:19], a[128:131], v[168:171], 0
v_cvt_pk_bf16_f32 v184, v72, v73
v_cvt_pk_bf16_f32 v185, v74, v75
v_mfma_f32_16x16x32_bf16 v[16:19], a[132:135], v[172:175], v[16:19]
v_cvt_pk_bf16_f32 v186, v76, v77
v_cvt_pk_bf16_f32 v187, v78, v79
v_mfma_f32_16x16x32_bf16 v[16:19], a[136:139], v[176:179], v[16:19]
v_cvt_pk_bf16_f32 v188, v80, v81
v_cvt_pk_bf16_f32 v189, v82, v83
v_mfma_f32_16x16x32_bf16 v[16:19], a[140:143], v[180:183], v[16:19]
v_cvt_pk_bf16_f32 v190, v84, v85
v_cvt_pk_bf16_f32 v191, v86, v87
v_mfma_f32_16x16x32_bf16 v[20:23], a[144:147], v[168:171], 0
v_cvt_pk_bf16_f32 v192, v88, v89
v_cvt_pk_bf16_f32 v193, v90, v91
v_mfma_f32_16x16x32_bf16 v[20:23], a[148:151], v[172:175], v[20:23]
v_cvt_pk_bf16_f32 v194, v92, v93
v_cvt_pk_bf16_f32 v195, v94, v95
v_mfma_f32_16x16x32_bf16 v[20:23], a[152:155], v[176:179], v[20:23]
v_cvt_pk_bf16_f32 v196, v96, v97
v_cvt_pk_bf16_f32 v197, v98, v99
v_mfma_f32_16x16x32_bf16 v[20:23], a[156:159], v[180:183], v[20:23]
v_cvt_pk_bf16_f32 v198, v100, v101
v_cvt_pk_bf16_f32 v199, v102, v103
v_permlane16_swap_b32 v184, v186
v_permlane16_swap_b32 v185, v187
v_permlane16_swap_b32 v188, v190
v_permlane16_swap_b32 v189, v191
v_permlane16_swap_b32 v192, v194
v_permlane16_swap_b32 v193, v195
v_permlane16_swap_b32 v196, v198
v_permlane16_swap_b32 v197, v199
v_pk_fma_f32 v[104:105], v[24:25], v[150:151], v[104:105] op_sel:[0,0,0] op_sel_hi:[1,0,1]
v_pk_fma_f32 v[106:107], v[26:27], v[150:151], v[106:107] op_sel:[0,0,0] op_sel_hi:[1,0,1]
v_pk_mul_f32 v[104:105], v[104:105], v[150:151] op_sel:[0,1] op_sel_hi:[1,1]
v_pk_mul_f32 v[106:107], v[106:107], v[150:151] op_sel:[0,1] op_sel_hi:[1,1]
v_pk_fma_f32 v[108:109], v[28:29], v[150:151], v[108:109] op_sel:[0,0,0] op_sel_hi:[1,0,1]
v_pk_fma_f32 v[110:111], v[30:31], v[150:151], v[110:111] op_sel:[0,0,0] op_sel_hi:[1,0,1]
v_pk_mul_f32 v[108:109], v[108:109], v[150:151] op_sel:[0,1] op_sel_hi:[1,1]
v_pk_mul_f32 v[110:111], v[110:111], v[150:151] op_sel:[0,1] op_sel_hi:[1,1]
v_pk_fma_f32 v[112:113], v[32:33], v[150:151], v[112:113] op_sel:[0,0,0] op_sel_hi:[1,0,1]
v_pk_fma_f32 v[114:115], v[34:35], v[150:151], v[114:115] op_sel:[0,0,0] op_sel_hi:[1,0,1]
v_pk_mul_f32 v[112:113], v[112:113], v[150:151] op_sel:[0,1] op_sel_hi:[1,1]
v_pk_mul_f32 v[114:115], v[114:115], v[150:151] op_sel:[0,1] op_sel_hi:[1,1]
v_pk_fma_f32 v[116:117], v[36:37], v[150:151], v[116:117] op_sel:[0,0,0] op_sel_hi:[1,0,1]
v_pk_fma_f32 v[118:119], v[38:39], v[150:151], v[118:119] op_sel:[0,0,0] op_sel_hi:[1,0,1]
v_pk_mul_f32 v[116:117], v[116:117], v[150:151] op_sel:[0,1] op_sel_hi:[1,1]
v_pk_mul_f32 v[118:119], v[118:119], v[150:151] op_sel:[0,1] op_sel_hi:[1,1]
v_pk_fma_f32 v[120:121], v[136:137], v[150:151], v[120:121] op_sel:[0,0,0] op_sel_hi:[1,0,1]
v_pk_fma_f32 v[122:123], v[138:139], v[150:151], v[122:123] op_sel:[0,0,0] op_sel_hi:[1,0,1]
v_pk_mul_f32 v[120:121], v[120:121], v[150:151] op_sel:[0,1] op_sel_hi:[1,1]
v_pk_mul_f32 v[122:123], v[122:123], v[150:151] op_sel:[0,1] op_sel_hi:[1,1]
v_pk_fma_f32 v[124:125], v[140:141], v[150:151], v[124:125] op_sel:[0,0,0] op_sel_hi:[1,0,1]
v_pk_fma_f32 v[126:127], v[142:143], v[150:151], v[126:127] op_sel:[0,0,0] op_sel_hi:[1,0,1]
v_pk_mul_f32 v[124:125], v[124:125], v[150:151] op_sel:[0,1] op_sel_hi:[1,1]
v_pk_mul_f32 v[126:127], v[126:127], v[150:151] op_sel:[0,1] op_sel_hi:[1,1]
v_pk_fma_f32 v[128:129], v[144:145], v[150:151], v[128:129] op_sel:[0,0,0] op_sel_hi:[1,0,1]
v_pk_fma_f32 v[130:131], v[146:147], v[150:151], v[130:131] op_sel:[0,0,0] op_sel_hi:[1,0,1]
v_pk_mul_f32 v[128:129], v[128:129], v[150:151] op_sel:[0,1] op_sel_hi:[1,1]
v_pk_mul_f32 v[130:131], v[130:131], v[150:151] op_sel:[0,1] op_sel_hi:[1,1]
v_pk_fma_f32 v[132:133], v[244:245], v[150:151], v[132:133] op_sel:[0,0,0] op_sel_hi:[1,0,1]
v_pk_fma_f32 v[134:135], v[246:247], v[150:151], v[134:135] op_sel:[0,0,0] op_sel_hi:[1,0,1]
v_pk_mul_f32 v[132:133], v[132:133], v[150:151] op_sel:[0,1] op_sel_hi:[1,1]
v_pk_mul_f32 v[134:135], v[134:135], v[150:151] op_sel:[0,1] op_sel_hi:[1,1]
v_mfma_f32_16x16x32_bf16 v[24:27], a[128:131], v[184:187], 0
v_cvt_pk_bf16_f32 v200, v104, v105
v_cvt_pk_bf16_f32 v201, v106, v107
v_mfma_f32_16x16x32_bf16 v[24:27], a[132:135], v[188:191], v[24:27]
v_cvt_pk_bf16_f32 v202, v108, v109
v_cvt_pk_bf16_f32 v203, v110, v111
v_mfma_f32_16x16x32_bf16 v[24:27], a[136:139], v[192:195], v[24:27]
v_cvt_pk_bf16_f32 v204, v112, v113
v_cvt_pk_bf16_f32 v205, v114, v115
v_mfma_f32_16x16x32_bf16 v[24:27], a[140:143], v[196:199], v[24:27]
v_cvt_pk_bf16_f32 v206, v116, v117
v_cvt_pk_bf16_f32 v207, v118, v119
v_mfma_f32_16x16x32_bf16 v[28:31], a[144:147], v[184:187], 0
v_cvt_pk_bf16_f32 v208, v120, v121
v_cvt_pk_bf16_f32 v209, v122, v123
v_mfma_f32_16x16x32_bf16 v[28:31], a[148:151], v[188:191], v[28:31]
v_cvt_pk_bf16_f32 v210, v124, v125
v_cvt_pk_bf16_f32 v211, v126, v127
v_mfma_f32_16x16x32_bf16 v[28:31], a[152:155], v[192:195], v[28:31]
v_cvt_pk_bf16_f32 v212, v128, v129
v_cvt_pk_bf16_f32 v213, v130, v131
v_mfma_f32_16x16x32_bf16 v[28:31], a[156:159], v[196:199], v[28:31]
v_cvt_pk_bf16_f32 v214, v132, v133
v_cvt_pk_bf16_f32 v215, v134, v135
v_permlane16_swap_b32 v200, v202
v_permlane16_swap_b32 v201, v203
v_permlane16_swap_b32 v204, v206
v_permlane16_swap_b32 v205, v207
v_permlane16_swap_b32 v208, v210
v_permlane16_swap_b32 v209, v211
v_permlane16_swap_b32 v212, v214
v_permlane16_swap_b32 v213, v215
v_max3_f32 v136, v8, v9, v10
v_max3_f32 v136, v136, v11, v12
v_mfma_f32_16x16x32_bf16 v[32:35], a[128:131], v[200:203], 0
ds_read_b128 a[128:131], v216 offset:40960
v_max3_f32 v136, v136, v13, v14
v_mfma_f32_16x16x32_bf16 v[32:35], a[132:135], v[204:207], v[32:35]
ds_read_b128 a[132:135], v217 offset:40960
v_max_f32 v136, v136, v15
v_mfma_f32_16x16x32_bf16 v[32:35], a[136:139], v[208:211], v[32:35]
ds_read_b128 a[136:139], v218 offset:40960
v_mov_b32 v137, v136
v_mfma_f32_16x16x32_bf16 v[32:35], a[140:143], v[212:215], v[32:35]
ds_read_b128 a[140:143], v219 offset:40960
v_max3_f32 v140, v16, v17, v18
v_mfma_f32_16x16x32_bf16 v[36:39], a[144:147], v[200:203], 0
ds_read_b128 a[144:147], v216 offset:45056
v_max3_f32 v140, v140, v19, v20
v_mfma_f32_16x16x32_bf16 v[36:39], a[148:151], v[204:207], v[36:39]
ds_read_b128 a[148:151], v217 offset:45056
v_max3_f32 v140, v140, v21, v22
v_mfma_f32_16x16x32_bf16 v[36:39], a[152:155], v[208:211], v[36:39]
ds_read_b128 a[152:155], v218 offset:45056
v_max_f32 v140, v140, v23
v_mfma_f32_16x16x32_bf16 v[36:39], a[156:159], v[212:215], v[36:39]
ds_read_b128 a[156:159], v219 offset:45056
v_mov_b32 v141, v140
s_mov_b32 s48, 0x244000
buffer_load_dwordx4 v[104:107], v234, s[20:23], s48 offen offset:0 sc0 sc1
buffer_load_dwordx4 v[108:111], v234, s[20:23], s48 offen offset:1024 sc0 sc1
buffer_load_dwordx4 v[112:115], v234, s[20:23], s48 offen offset:2048 sc0 sc1
buffer_load_dwordx4 v[116:119], v234, s[20:23], s48 offen offset:3072 sc0 sc1
v_max3_f32 v144, v24, v25, v26
v_max3_f32 v144, v144, v27, v28
v_max3_f32 v144, v144, v29, v30
v_max_f32 v144, v144, v31
v_mov_b32 v145, v144
s_mov_b32 s48, 0x245000
buffer_load_dwordx4 v[120:123], v234, s[20:23], s48 offen offset:0 sc0 sc1
buffer_load_dwordx4 v[124:127], v234, s[20:23], s48 offen offset:1024 sc0 sc1
buffer_load_dwordx4 v[128:131], v234, s[20:23], s48 offen offset:2048 sc0 sc1
buffer_load_dwordx4 v[132:135], v234, s[20:23], s48 offen offset:3072 sc0 sc1
v_max3_f32 v148, v32, v33, v34
v_max3_f32 v148, v148, v35, v36
v_max3_f32 v148, v148, v37, v38
v_max_f32 v148, v148, v39
v_mov_b32 v149, v148
v_permlane16_swap_b32 v136, v137
v_permlane16_swap_b32 v140, v141
v_permlane16_swap_b32 v144, v145
v_permlane16_swap_b32 v148, v149
v_max_f32 v136, v136, v137
v_mov_b32 v137, v136
v_max_f32 v140, v140, v141
v_mov_b32 v141, v140
v_max_f32 v144, v144, v145
v_mov_b32 v145, v144
v_max_f32 v148, v148, v149
v_mov_b32 v149, v148
v_permlane32_swap_b32 v136, v137
v_permlane32_swap_b32 v140, v141
v_permlane32_swap_b32 v144, v145
v_permlane32_swap_b32 v148, v149
v_max_f32 v136, v136, v137
v_max_f32 v140, v140, v141
v_max_f32 v144, v144, v145
v_max_f32 v148, v148, v149
v_sub_f32 v139, 0, v136
v_sub_f32 v138, 0, v136
v_sub_f32 v137, 0, v136
v_sub_f32 v136, 0, v136
v_sub_f32 v143, 0, v140
v_sub_f32 v142, 0, v140
v_sub_f32 v141, 0, v140
v_sub_f32 v140, 0, v140
v_sub_f32 v147, 0, v144
v_sub_f32 v146, 0, v144
v_sub_f32 v145, 0, v144
v_sub_f32 v144, 0, v144
v_sub_f32 v151, 0, v148
v_sub_f32 v150, 0, v148
v_sub_f32 v149, 0, v148
v_sub_f32 v148, 0, v148
K_HAVEMAX:
v_pk_add_f32 v[8:9], v[8:9], v[136:137]
v_pk_add_f32 v[10:11], v[10:11], v[136:137]
v_pk_add_f32 v[12:13], v[12:13], v[136:137]
v_pk_add_f32 v[14:15], v[14:15], v[136:137]
v_pk_add_f32 v[16:17], v[16:17], v[140:141]
v_pk_add_f32 v[18:19], v[18:19], v[140:141]
v_pk_add_f32 v[20:21], v[20:21], v[140:141]
v_pk_add_f32 v[22:23], v[22:23], v[140:141]
v_pk_add_f32 v[24:25], v[24:25], v[144:145]
v_pk_add_f32 v[26:27], v[26:27], v[144:145]
v_pk_add_f32 v[28:29], v[28:29], v[144:145]
v_pk_add_f32 v[30:31], v[30:31], v[144:145]
v_pk_add_f32 v[32:33], v[32:33], v[148:149]
v_pk_add_f32 v[34:35], v[34:35], v[148:149]
v_pk_add_f32 v[36:37], v[36:37], v[148:149]
v_pk_add_f32 v[38:39], v[38:39], v[148:149]
v_mov_b32 v5, 0
s_lshl_b32 s46, s32, 2
s_add_u32 s46, s46, 163776
v_mov_b32 v6, s46
v_and_b32 v7, 12, v1
v_add_u32 v7, 163776, v7
ds_write_b32 v6, v5
s_waitcnt lgkmcnt(8)
v_mfma_f32_16x16x32_bf16 v[40:43], a[128:131], v[152:155], v[136:139]
s_waitcnt lgkmcnt(7)
v_exp_f32 v8, v8
v_exp_f32 v9, v9
v_mfma_f32_16x16x32_bf16 v[40:43], a[132:135], v[156:159], v[40:43]
s_waitcnt lgkmcnt(6)
v_cvt_pk_bf16_f32 v72, v8, v9
v_exp_f32 v10, v10
v_mfma_f32_16x16x32_bf16 v[40:43], a[136:139], v[160:163], v[40:43]
s_waitcnt lgkmcnt(5)
v_exp_f32 v11, v11
v_mfma_f32_16x16x32_bf16 v[40:43], a[140:143], v[164:167], v[40:43]
v_cvt_pk_bf16_f32 v73, v10, v11
v_exp_f32 v12, v12
v_mfma_f32_16x16x32_bf16 v[48:51], a[128:131], v[168:171], v[140:143]
v_exp_f32 v13, v13
v_mfma_f32_16x16x32_bf16 v[48:51], a[132:135], v[172:175], v[48:51]
v_cvt_pk_bf16_f32 v74, v12, v13
v_exp_f32 v14, v14
s_waitcnt vmcnt(8) lgkmcnt(0)
s_barrier
v_mfma_f32_16x16x32_bf16 v[48:51], a[136:139], v[176:179], v[48:51]
ds_read_b64_tr_b16 a[160:161], v220 offset:32768
ds_read_b64_tr_b16 a[162:163], v220 offset:36864
v_exp_f32 v15, v15
v_mfma_f32_16x16x32_bf16 v[48:51], a[140:143], v[180:183], v[48:51]
s_add_u32 m0, s37, 65536
v_exp_f32 v16, v16
v_exp_f32 v17, v17
v_mfma_f32_16x16x32_bf16 v[56:59], a[128:131], v[184:187], v[144:147]
buffer_load_dwordx4 v232, s[12:15], s39 offen offset:0 lds
v_exp_f32 v18, v18
v_mfma_f32_16x16x32_bf16 v[56:59], a[132:135], v[188:191], v[56:59]
ds_read_b64_tr_b16 a[164:165], v221 offset:32768
ds_read_b64_tr_b16 a[166:167], v221 offset:36864
v_exp_f32 v19, v19
v_mfma_f32_16x16x32_bf16 v[56:59], a[136:139], v[192:195], v[56:59]
buffer_load_dwordx4 v233, s[12:15], s39 offen offset:1024 lds
v_exp_f32 v20, v20
v_mfma_f32_16x16x32_bf16 v[56:59], a[140:143], v[196:199], v[56:59]
ds_read_b64_tr_b16 a[168:169], v222 offset:32768
ds_read_b64_tr_b16 a[170:171], v222 offset:36864
v_exp_f32 v21, v21
v_mfma_f32_16x16x32_bf16 v[64:67], a[128:131], v[200:203], v[148:151]
ds_read_b64_tr_b16 a[172:173], v223 offset:32768
ds_read_b64_tr_b16 a[174:175], v223 offset:36864
v_exp_f32 v22, v22
v_mfma_f32_16x16x32_bf16 v[64:67], a[132:135], v[204:207], v[64:67]
ds_read_b128 a[128:131], v216 offset:16384
ds_read_b64_tr_b16 a[176:177], v224 offset:32768
v_exp_f32 v23, v23
v_mfma_f32_16x16x32_bf16 v[64:67], a[136:139], v[208:211], v[64:67]
v_exp_f32 v24, v24
v_exp_f32 v25, v25
v_mfma_f32_16x16x32_bf16 v[64:67], a[140:143], v[212:215], v[64:67]
buffer_load_dwordx4 v232, s[12:15], s39 offen offset:2048 lds
v_exp_f32 v26, v26
v_mfma_f32_16x16x32_bf16 v[44:47], a[144:147], v[152:155], v[136:139]
ds_read_b64_tr_b16 a[178:179], v224 offset:36864
ds_read_b128 a[132:135], v217 offset:16384
v_exp_f32 v27, v27
v_mfma_f32_16x16x32_bf16 v[44:47], a[148:151], v[156:159], v[44:47]
ds_read_b128 a[136:139], v218 offset:16384
ds_read_b128 a[140:143], v219 offset:16384
v_exp_f32 v28, v28
v_mfma_f32_16x16x32_bf16 v[44:47], a[152:155], v[160:163], v[44:47]
buffer_load_dwordx4 v233, s[12:15], s39 offen offset:3072 lds
v_exp_f32 v29, v29
v_mfma_f32_16x16x32_bf16 v[44:47], a[156:159], v[164:167], v[44:47]
ds_read_b64_tr_b16 a[180:181], v225 offset:32768
ds_read_b64_tr_b16 a[182:183], v225 offset:36864
v_exp_f32 v30, v30
v_mfma_f32_16x16x32_bf16 v[52:55], a[144:147], v[168:171], v[140:143]
ds_read_b64_tr_b16 a[184:185], v226 offset:32768
ds_read_b64_tr_b16 a[186:187], v226 offset:36864
v_exp_f32 v31, v31
v_mfma_f32_16x16x32_bf16 v[52:55], a[148:151], v[172:175], v[52:55]
s_add_u32 s39, s39, 16384
v_exp_f32 v32, v32
v_exp_f32 v33, v33
v_mfma_f32_16x16x32_bf16 v[52:55], a[152:155], v[176:179], v[52:55]
s_add_u32 m0, s37, 49152
ds_read_b64_tr_b16 a[188:189], v227 offset:32768
ds_read_b64_tr_b16 a[190:191], v227 offset:36864
v_exp_f32 v34, v34
v_mfma_f32_16x16x32_bf16 v[52:55], a[156:159], v[180:183], v[52:55]
buffer_load_dwordx4 v228, s[8:11], s38 offen offset:0 lds
v_exp_f32 v35, v35
v_mfma_f32_16x16x32_bf16 v[60:63], a[144:147], v[184:187], v[144:147]
v_cvt_pk_bf16_f32 v75, v14, v15
v_cvt_pk_bf16_f32 v76, v16, v17
v_exp_f32 v36, v36
v_mfma_f32_16x16x32_bf16 v[60:63], a[148:151], v[188:191], v[60:63]
buffer_load_dwordx4 v229, s[8:11], s38 offen offset:1024 lds
v_exp_f32 v37, v37
v_mfma_f32_16x16x32_bf16 v[60:63], a[152:155], v[192:195], v[60:63]
v_cvt_pk_bf16_f32 v77, v18, v19
v_cvt_pk_bf16_f32 v78, v20, v21
v_exp_f32 v38, v38
v_mfma_f32_16x16x32_bf16 v[60:63], a[156:159], v[196:199], v[60:63]
v_cvt_pk_bf16_f32 v79, v22, v23
v_cvt_pk_bf16_f32 v80, v24, v25
v_exp_f32 v39, v39
v_mfma_f32_16x16x32_bf16 v[68:71], a[144:147], v[200:203], v[148:151]
ds_read_b128 a[144:147], v216 offset:20480
v_cvt_pk_bf16_f32 v81, v26, v27
v_cvt_pk_bf16_f32 v82, v28, v29
v_cvt_pk_bf16_f32 v83, v30, v31
v_mfma_f32_16x16x32_bf16 v[68:71], a[148:151], v[204:207], v[68:71]
ds_read_b128 a[148:151], v217 offset:20480
v_cvt_pk_bf16_f32 v84, v32, v33
v_cvt_pk_bf16_f32 v85, v34, v35
v_cvt_pk_bf16_f32 v86, v36, v37
v_mfma_f32_16x16x32_bf16 v[68:71], a[152:155], v[208:211], v[68:71]
ds_read_b128 a[152:155], v218 offset:20480
v_cvt_pk_bf16_f32 v87, v38, v39
v_mfma_f32_16x16x32_bf16 v[68:71], a[156:159], v[212:215], v[68:71]
ds_read_b128 a[156:159], v219 offset:20480
s_cmp_lg_u32 s41, 0
s_cbranch_scc1 K_RANKED
s_waitcnt vmcnt(6)
v_max3_u32 v255, v104, v105, v106
s_max_u32 s48, s92, s93
v_max3_u32 v255, v255, v107, v108
v_max3_u32 v255, v255, v109, v110
v_max3_u32 v255, v255, v111, v112
v_max3_u32 v255, v255, v113, v114
v_max3_u32 v255, v255, v115, v116
v_max3_u32 v255, v255, v117, v118
v_max3_u32 v255, v255, v119, v120
v_max3_u32 v255, v255, v121, v122
v_max3_u32 v255, v255, v123, v124
v_max3_u32 v255, v255, v125, v126
v_max3_u32 v255, v255, v127, v128
v_max3_u32 v255, v255, v129, v130
v_max3_u32 v255, v255, v131, v132
v_max3_u32 v255, v255, v133, v134
v_max_u32 v255, v255, v135
v_cmp_lt_u32 vcc, s48, v255
s_bcnt1_i32_b64 s48, vcc
s_cmp_lt_u32 s48, 8
s_cbranch_scc1 K_RANK
K_RANKED:
s_memrealtime s[94:95]
s_waitcnt lgkmcnt(0)
s_mov_b32 s40, 0
.p2align 6
K_LOOP:
v_mfma_f32_16x16x32_bf16 v[8:11], a[128:131], v[152:155], v[136:139]
v_exp_f32 v40, v40
v_mfma_f32_16x16x32_bf16 v[8:11], a[132:135], v[156:159], v[8:11]
v_exp_f32 v41, v41
v_mfma_f32_16x16x32_bf16 v[8:11], a[136:139], v[160:163], v[8:11]
buffer_load_dwordx4 v230, s[8:11], s38 offen offset:2048 lds
v_mfma_f32_16x16x32_bf16 v[8:11], a[140:143], v[164:167], v[8:11]
v_exp_f32 v42, v42
v_mfma_f32_16x16x32_bf16 a[0:3], a[160:163], v[72:75], a[0:3]
v_cvt_pk_bf16_f32 v88, v40, v41
v_mfma_f32_16x16x32_bf16 a[32:35], a[160:163], v[76:79], a[32:35]
v_exp_f32 v43, v43
v_mfma_f32_16x16x32_bf16 a[64:67], a[160:163], v[80:83], a[64:67]
v_cvt_pk_bf16_f32 v89, v42, v43
v_mfma_f32_16x16x32_bf16 a[96:99], a[160:163], v[84:87], a[96:99]
v_exp_f32 v44, v44
v_mfma_f32_16x16x32_bf16 v[16:19], a[128:131], v[168:171], v[140:143]
ds_read_b64_tr_b16 a[160:161], v220 offset:40960
ds_read_b64_tr_b16 a[162:163], v220 offset:45056
v_mfma_f32_16x16x32_bf16 v[16:19], a[132:135], v[172:175], v[16:19]
v_exp_f32 v45, v45
v_mfma_f32_16x16x32_bf16 v[16:19], a[136:139], v[176:179], v[16:19]
v_cvt_pk_bf16_f32 v90, v44, v45
v_mfma_f32_16x16x32_bf16 v[16:19], a[140:143], v[180:183], v[16:19]
v_exp_f32 v46, v46
v_mfma_f32_16x16x32_bf16 a[4:7], a[164:167], v[72:75], a[4:7]
v_mfma_f32_16x16x32_bf16 a[36:39], a[164:167], v[76:79], a[36:39]
v_exp_f32 v47, v47
v_mfma_f32_16x16x32_bf16 a[68:71], a[164:167], v[80:83], a[68:71]
buffer_load_dwordx4 v231, s[8:11], s38 offen offset:3072 lds
v_mfma_f32_16x16x32_bf16 a[100:103], a[164:167], v[84:87], a[100:103]
v_exp_f32 v48, v48
v_smfmac_f32_16x16x64_bf16 a[248:251], a[208:211], v[72:79], v235
ds_read_b64_tr_b16 a[164:165], v221 offset:40960
ds_read_b64_tr_b16 a[166:167], v221 offset:45056
v_mfma_f32_16x16x32_bf16 v[24:27], a[128:131], v[184:187], v[144:147]
v_exp_f32 v49, v49
v_mfma_f32_16x16x32_bf16 v[24:27], a[132:135], v[188:191], v[24:27]
v_cvt_pk_bf16_f32 v91, v46, v47
v_cvt_pk_bf16_f32 v92, v48, v49
v_mfma_f32_16x16x32_bf16 v[24:27], a[136:139], v[192:195], v[24:27]
v_exp_f32 v50, v50
v_mfma_f32_16x16x32_bf16 v[24:27], a[140:143], v[196:199], v[24:27]
v_mfma_f32_16x16x32_bf16 a[8:11], a[168:171], v[72:75], a[8:11]
v_exp_f32 v51, v51
v_mfma_f32_16x16x32_bf16 a[40:43], a[168:171], v[76:79], a[40:43]
v_cvt_pk_bf16_f32 v93, v50, v51
v_mfma_f32_16x16x32_bf16 a[72:75], a[168:171], v[80:83], a[72:75]
v_exp_f32 v52, v52
v_mfma_f32_16x16x32_bf16 a[104:107], a[168:171], v[84:87], a[104:107]
ds_read_b64_tr_b16 a[168:169], v222 offset:40960
ds_read_b64_tr_b16 a[170:171], v222 offset:45056
v_mfma_f32_16x16x32_bf16 v[32:35], a[128:131], v[200:203], v[148:151]
s_add_u32 s38, s38, 16384
v_exp_f32 v53, v53
v_mfma_f32_16x16x32_bf16 v[32:35], a[132:135], v[204:207], v[32:35]
s_add_u32 m0, s37, 81920
ds_read_b128 a[128:131], v216 offset:24576
ds_read_b128 a[132:135], v217 offset:24576
v_mfma_f32_16x16x32_bf16 v[32:35], a[136:139], v[208:211], v[32:35]
v_exp_f32 v54, v54
v_mfma_f32_16x16x32_bf16 v[32:35], a[140:143], v[212:215], v[32:35]
buffer_load_dwordx4 v232, s[12:15], s39 offen offset:0 lds
v_mfma_f32_16x16x32_bf16 a[12:15], a[172:175], v[72:75], a[12:15]
v_exp_f32 v55, v55
v_mfma_f32_16x16x32_bf16 a[44:47], a[172:175], v[76:79], a[44:47]
ds_read_b128 a[136:139], v218 offset:24576
ds_read_b128 a[140:143], v219 offset:24576
v_mfma_f32_16x16x32_bf16 a[76:79], a[172:175], v[80:83], a[76:79]
v_exp_f32 v56, v56
v_mfma_f32_16x16x32_bf16 a[108:111], a[172:175], v[84:87], a[108:111]
s_waitcnt lgkmcnt(6)
v_exp_f32 v57, v57
v_mfma_f32_16x16x32_bf16 v[12:15], a[144:147], v[152:155], v[136:139]
ds_read_b64_tr_b16 a[172:173], v223 offset:40960
ds_read_b64_tr_b16 a[174:175], v223 offset:45056
v_mfma_f32_16x16x32_bf16 v[12:15], a[148:151], v[156:159], v[12:15]
v_exp_f32 v58, v58
v_mfma_f32_16x16x32_bf16 v[12:15], a[152:155], v[160:163], v[12:15]
v_cvt_pk_bf16_f32 v94, v52, v53
v_cvt_pk_bf16_f32 v95, v54, v55
v_mfma_f32_16x16x32_bf16 v[12:15], a[156:159], v[164:167], v[12:15]
v_exp_f32 v59, v59
v_mfma_f32_16x16x32_bf16 a[16:19], a[176:179], v[72:75], a[16:19]
v_cvt_pk_bf16_f32 v96, v56, v57
v_cvt_pk_bf16_f32 v97, v58, v59
v_mfma_f32_16x16x32_bf16 a[48:51], a[176:179], v[76:79], a[48:51]
v_exp_f32 v60, v60
v_mfma_f32_16x16x32_bf16 a[80:83], a[176:179], v[80:83], a[80:83]
buffer_load_dwordx4 v233, s[12:15], s39 offen offset:1024 lds
v_mfma_f32_16x16x32_bf16 a[112:115], a[176:179], v[84:87], a[112:115]
v_exp_f32 v61, v61
v_mfma_f32_16x16x32_bf16 v[20:23], a[144:147], v[168:171], v[140:143]
ds_read_b64_tr_b16 a[176:177], v224 offset:40960
ds_read_b64_tr_b16 a[178:179], v224 offset:45056
v_mfma_f32_16x16x32_bf16 v[20:23], a[148:151], v[172:175], v[20:23]
v_exp_f32 v62, v62
v_mfma_f32_16x16x32_bf16 v[20:23], a[152:155], v[176:179], v[20:23]
v_cvt_pk_bf16_f32 v98, v60, v61
v_mfma_f32_16x16x32_bf16 v[20:23], a[156:159], v[180:183], v[20:23]
v_exp_f32 v63, v63
v_mfma_f32_16x16x32_bf16 a[20:23], a[180:183], v[72:75], a[20:23]
v_cvt_pk_bf16_f32 v99, v62, v63
v_mfma_f32_16x16x32_bf16 a[52:55], a[180:183], v[76:79], a[52:55]
v_exp_f32 v64, v64
v_mfma_f32_16x16x32_bf16 a[84:87], a[180:183], v[80:83], a[84:87]
v_mfma_f32_16x16x32_bf16 a[116:119], a[180:183], v[84:87], a[116:119]
v_exp_f32 v65, v65
v_smfmac_f32_16x16x64_bf16 a[252:255], a[208:211], v[80:87], v235
ds_read_b64_tr_b16 a[180:181], v225 offset:40960
ds_read_b64_tr_b16 a[182:183], v225 offset:45056
v_mfma_f32_16x16x32_bf16 v[28:31], a[144:147], v[184:187], v[144:147]
v_exp_f32 v66, v66
v_mfma_f32_16x16x32_bf16 v[28:31], a[148:151], v[188:191], v[28:31]
buffer_load_dwordx4 v232, s[12:15], s39 offen offset:2048 lds
v_mfma_f32_16x16x32_bf16 v[28:31], a[152:155], v[192:195], v[28:31]
v_exp_f32 v67, v67
v_mfma_f32_16x16x32_bf16 v[28:31], a[156:159], v[196:199], v[28:31]
v_cvt_pk_bf16_f32 v100, v64, v65
v_cvt_pk_bf16_f32 v101, v66, v67
v_mfma_f32_16x16x32_bf16 a[24:27], a[184:187], v[72:75], a[24:27]
v_exp_f32 v68, v68
v_mfma_f32_16x16x32_bf16 a[56:59], a[184:187], v[76:79], a[56:59]
v_mfma_f32_16x16x32_bf16 a[88:91], a[184:187], v[80:83], a[88:91]
v_exp_f32 v69, v69
v_mfma_f32_16x16x32_bf16 a[120:123], a[184:187], v[84:87], a[120:123]
ds_read_b64_tr_b16 a[184:185], v226 offset:40960
ds_read_b64_tr_b16 a[186:187], v226 offset:45056
v_mfma_f32_16x16x32_bf16 v[36:39], a[144:147], v[200:203], v[148:151]
v_exp_f32 v70, v70
v_mfma_f32_16x16x32_bf16 v[36:39], a[148:151], v[204:207], v[36:39]
ds_read_b128 a[144:147], v216 offset:28672
ds_read_b128 a[148:151], v217 offset:28672
v_mfma_f32_16x16x32_bf16 v[36:39], a[152:155], v[208:211], v[36:39]
v_exp_f32 v71, v71
v_mfma_f32_16x16x32_bf16 v[36:39], a[156:159], v[212:215], v[36:39]
ds_read_b128 a[152:155], v218 offset:28672
ds_read_b128 a[156:159], v219 offset:28672
v_mfma_f32_16x16x32_bf16 a[28:31], a[188:191], v[72:75], a[28:31]
v_cvt_pk_bf16_f32 v102, v68, v69
v_cvt_pk_bf16_f32 v103, v70, v71
v_mfma_f32_16x16x32_bf16 a[60:63], a[188:191], v[76:79], a[60:63]
v_mfma_f32_16x16x32_bf16 a[92:95], a[188:191], v[80:83], a[92:95]
v_mfma_f32_16x16x32_bf16 a[124:127], a[188:191], v[84:87], a[124:127]
s_waitcnt lgkmcnt(6)
ds_read_b64_tr_b16 a[188:189], v227 offset:40960
ds_read_b64_tr_b16 a[190:191], v227 offset:45056
v_mfma_f32_16x16x32_bf16 v[40:43], a[128:131], v[152:155], v[136:139]
v_exp_f32 v8, v8
v_mfma_f32_16x16x32_bf16 v[40:43], a[132:135], v[156:159], v[40:43]
v_exp_f32 v9, v9
v_mfma_f32_16x16x32_bf16 v[40:43], a[136:139], v[160:163], v[40:43]
buffer_load_dwordx4 v233, s[12:15], s39 offen offset:3072 lds
v_mfma_f32_16x16x32_bf16 v[40:43], a[140:143], v[164:167], v[40:43]
v_exp_f32 v10, v10
v_mfma_f32_16x16x32_bf16 a[0:3], a[160:163], v[88:91], a[0:3]
v_cvt_pk_bf16_f32 v72, v8, v9
v_mfma_f32_16x16x32_bf16 a[32:35], a[160:163], v[92:95], a[32:35]
v_exp_f32 v11, v11
v_mfma_f32_16x16x32_bf16 a[64:67], a[160:163], v[96:99], a[64:67]
v_cvt_pk_bf16_f32 v73, v10, v11
v_mfma_f32_16x16x32_bf16 a[96:99], a[160:163], v[100:103], a[96:99]
v_exp_f32 v12, v12
v_mfma_f32_16x16x32_bf16 v[48:51], a[128:131], v[168:171], v[140:143]
ds_read_b64_tr_b16 a[160:161], v220 offset:49152
ds_read_b64_tr_b16 a[162:163], v220 offset:53248
v_mfma_f32_16x16x32_bf16 v[48:51], a[132:135], v[172:175], v[48:51]
v_exp_f32 v13, v13
v_mfma_f32_16x16x32_bf16 v[48:51], a[136:139], v[176:179], v[48:51]
v_cvt_pk_bf16_f32 v74, v12, v13
v_mfma_f32_16x16x32_bf16 v[48:51], a[140:143], v[180:183], v[48:51]
v_exp_f32 v14, v14
v_mfma_f32_16x16x32_bf16 a[4:7], a[164:167], v[88:91], a[4:7]
v_mfma_f32_16x16x32_bf16 a[36:39], a[164:167], v[92:95], a[36:39]
s_add_u32 s39, s39, 16384
v_exp_f32 v15, v15
v_mfma_f32_16x16x32_bf16 a[68:71], a[164:167], v[96:99], a[68:71]
s_add_u32 m0, s37, 32768
v_cvt_pk_bf16_f32 v75, v14, v15
v_mfma_f32_16x16x32_bf16 a[100:103], a[164:167], v[100:103], a[100:103]
v_exp_f32 v16, v16
v_smfmac_f32_16x16x64_bf16 a[248:251], a[208:211], v[88:95], v235
buffer_load_dwordx4 v228, s[8:11], s38 offen offset:0 lds
v_mfma_f32_16x16x32_bf16 v[56:59], a[128:131], v[184:187], v[144:147]
v_exp_f32 v17, v17
v_mfma_f32_16x16x32_bf16 v[56:59], a[132:135], v[188:191], v[56:59]
ds_read_b64_tr_b16 a[164:165], v221 offset:49152
ds_read_b64_tr_b16 a[166:167], v221 offset:53248
v_mfma_f32_16x16x32_bf16 v[56:59], a[136:139], v[192:195], v[56:59]
v_exp_f32 v18, v18
v_mfma_f32_16x16x32_bf16 v[56:59], a[140:143], v[196:199], v[56:59]
v_cvt_pk_bf16_f32 v76, v16, v17
v_mfma_f32_16x16x32_bf16 a[8:11], a[168:171], v[88:91], a[8:11]
v_exp_f32 v19, v19
v_mfma_f32_16x16x32_bf16 a[40:43], a[168:171], v[92:95], a[40:43]
v_cvt_pk_bf16_f32 v77, v18, v19
v_mfma_f32_16x16x32_bf16 a[72:75], a[168:171], v[96:99], a[72:75]
v_exp_f32 v20, v20
v_mfma_f32_16x16x32_bf16 a[104:107], a[168:171], v[100:103], a[104:107]
ds_read_b64_tr_b16 a[168:169], v222 offset:49152
ds_read_b64_tr_b16 a[170:171], v222 offset:53248
v_mfma_f32_16x16x32_bf16 v[64:67], a[128:131], v[200:203], v[148:151]
v_exp_f32 v21, v21
v_mfma_f32_16x16x32_bf16 v[64:67], a[132:135], v[204:207], v[64:67]
buffer_load_dwordx4 v229, s[8:11], s38 offen offset:1024 lds
v_mfma_f32_16x16x32_bf16 v[64:67], a[136:139], v[208:211], v[64:67]
v_exp_f32 v22, v22
v_mfma_f32_16x16x32_bf16 v[64:67], a[140:143], v[212:215], v[64:67]
ds_read_b128 a[128:131], v216 offset:0
ds_read_b128 a[132:135], v217 offset:0
v_mfma_f32_16x16x32_bf16 a[12:15], a[172:175], v[88:91], a[12:15]
v_exp_f32 v23, v23
v_mfma_f32_16x16x32_bf16 a[44:47], a[172:175], v[92:95], a[44:47]
ds_read_b128 a[136:139], v218 offset:0
ds_read_b128 a[140:143], v219 offset:0
v_mfma_f32_16x16x32_bf16 a[76:79], a[172:175], v[96:99], a[76:79]
v_exp_f32 v24, v24
v_mfma_f32_16x16x32_bf16 a[108:111], a[172:175], v[100:103], a[108:111]
s_waitcnt lgkmcnt(6)
v_exp_f32 v25, v25
v_mfma_f32_16x16x32_bf16 v[44:47], a[144:147], v[152:155], v[136:139]
ds_read_b64_tr_b16 a[172:173], v223 offset:49152
ds_read_b64_tr_b16 a[174:175], v223 offset:53248
v_mfma_f32_16x16x32_bf16 v[44:47], a[148:151], v[156:159], v[44:47]
v_exp_f32 v26, v26
v_mfma_f32_16x16x32_bf16 v[44:47], a[152:155], v[160:163], v[44:47]
v_cvt_pk_bf16_f32 v78, v20, v21
v_cvt_pk_bf16_f32 v79, v22, v23
v_mfma_f32_16x16x32_bf16 v[44:47], a[156:159], v[164:167], v[44:47]
v_exp_f32 v27, v27
v_mfma_f32_16x16x32_bf16 a[16:19], a[176:179], v[88:91], a[16:19]
v_cvt_pk_bf16_f32 v80, v24, v25
v_cvt_pk_bf16_f32 v81, v26, v27
v_mfma_f32_16x16x32_bf16 a[48:51], a[176:179], v[92:95], a[48:51]
v_exp_f32 v28, v28
v_mfma_f32_16x16x32_bf16 a[80:83], a[176:179], v[96:99], a[80:83]
buffer_load_dwordx4 v230, s[8:11], s38 offen offset:2048 lds
v_mfma_f32_16x16x32_bf16 a[112:115], a[176:179], v[100:103], a[112:115]
v_exp_f32 v29, v29
v_mfma_f32_16x16x32_bf16 v[52:55], a[144:147], v[168:171], v[140:143]
ds_read_b64_tr_b16 a[176:177], v224 offset:49152
ds_read_b64_tr_b16 a[178:179], v224 offset:53248
v_mfma_f32_16x16x32_bf16 v[52:55], a[148:151], v[172:175], v[52:55]
v_exp_f32 v30, v30
v_mfma_f32_16x16x32_bf16 v[52:55], a[152:155], v[176:179], v[52:55]
v_cvt_pk_bf16_f32 v82, v28, v29
v_mfma_f32_16x16x32_bf16 v[52:55], a[156:159], v[180:183], v[52:55]
v_exp_f32 v31, v31
v_mfma_f32_16x16x32_bf16 a[20:23], a[180:183], v[88:91], a[20:23]
v_cvt_pk_bf16_f32 v83, v30, v31
v_mfma_f32_16x16x32_bf16 a[52:55], a[180:183], v[92:95], a[52:55]
v_exp_f32 v32, v32
v_mfma_f32_16x16x32_bf16 a[84:87], a[180:183], v[96:99], a[84:87]
v_mfma_f32_16x16x32_bf16 a[116:119], a[180:183], v[100:103], a[116:119]
v_exp_f32 v33, v33
v_smfmac_f32_16x16x64_bf16 a[252:255], a[208:211], v[96:103], v235
ds_read_b64_tr_b16 a[180:181], v225 offset:49152
ds_read_b64_tr_b16 a[182:183], v225 offset:53248
v_mfma_f32_16x16x32_bf16 v[60:63], a[144:147], v[184:187], v[144:147]
v_exp_f32 v34, v34
v_mfma_f32_16x16x32_bf16 v[60:63], a[148:151], v[188:191], v[60:63]
buffer_load_dwordx4 v231, s[8:11], s38 offen offset:3072 lds
v_mfma_f32_16x16x32_bf16 v[60:63], a[152:155], v[192:195], v[60:63]
v_exp_f32 v35, v35
v_mfma_f32_16x16x32_bf16 v[60:63], a[156:159], v[196:199], v[60:63]
v_cvt_pk_bf16_f32 v84, v32, v33
v_cvt_pk_bf16_f32 v85, v34, v35
v_mfma_f32_16x16x32_bf16 a[24:27], a[184:187], v[88:91], a[24:27]
v_exp_f32 v36, v36
v_mfma_f32_16x16x32_bf16 a[56:59], a[184:187], v[92:95], a[56:59]
v_mfma_f32_16x16x32_bf16 a[88:91], a[184:187], v[96:99], a[88:91]
v_exp_f32 v37, v37
v_mfma_f32_16x16x32_bf16 a[120:123], a[184:187], v[100:103], a[120:123]
ds_read_b64_tr_b16 a[184:185], v226 offset:49152
ds_read_b64_tr_b16 a[186:187], v226 offset:53248
v_mfma_f32_16x16x32_bf16 v[68:71], a[144:147], v[200:203], v[148:151]
v_exp_f32 v38, v38
v_mfma_f32_16x16x32_bf16 v[68:71], a[148:151], v[204:207], v[68:71]
ds_read_b128 a[144:147], v216 offset:4096
ds_read_b128 a[148:151], v217 offset:4096
v_mfma_f32_16x16x32_bf16 v[68:71], a[152:155], v[208:211], v[68:71]
v_exp_f32 v39, v39
v_mfma_f32_16x16x32_bf16 v[68:71], a[156:159], v[212:215], v[68:71]
ds_read_b128 a[152:155], v218 offset:4096
ds_read_b128 a[156:159], v219 offset:4096
v_mfma_f32_16x16x32_bf16 a[28:31], a[188:191], v[88:91], a[28:31]
v_cvt_pk_bf16_f32 v86, v36, v37
v_cvt_pk_bf16_f32 v87, v38, v39
v_mfma_f32_16x16x32_bf16 a[60:63], a[188:191], v[92:95], a[60:63]
s_add_u32 s38, s38, 16384
v_mfma_f32_16x16x32_bf16 a[92:95], a[188:191], v[96:99], a[92:95]
v_mfma_f32_16x16x32_bf16 a[124:127], a[188:191], v[100:103], a[124:127]
s_waitcnt lgkmcnt(6)
ds_read_b64_tr_b16 a[188:189], v227 offset:49152
ds_read_b64_tr_b16 a[190:191], v227 offset:53248
v_mfma_f32_16x16x32_bf16 v[8:11], a[128:131], v[152:155], v[136:139]
v_exp_f32 v40, v40
v_mfma_f32_16x16x32_bf16 v[8:11], a[132:135], v[156:159], v[8:11]
v_exp_f32 v41, v41
v_mfma_f32_16x16x32_bf16 v[8:11], a[136:139], v[160:163], v[8:11]
buffer_load_dwordx2 v[252:253], v251, s[76:79], s42 offen sc1
v_mfma_f32_16x16x32_bf16 v[8:11], a[140:143], v[164:167], v[8:11]
v_exp_f32 v42, v42
v_mfma_f32_16x16x32_bf16 a[0:3], a[160:163], v[72:75], a[0:3]
v_cvt_pk_bf16_f32 v88, v40, v41
v_mfma_f32_16x16x32_bf16 a[32:35], a[160:163], v[76:79], a[32:35]
v_exp_f32 v43, v43
v_mfma_f32_16x16x32_bf16 a[64:67], a[160:163], v[80:83], a[64:67]
v_cvt_pk_bf16_f32 v89, v42, v43
v_mfma_f32_16x16x32_bf16 a[96:99], a[160:163], v[84:87], a[96:99]
v_exp_f32 v44, v44
v_mfma_f32_16x16x32_bf16 v[16:19], a[128:131], v[168:171], v[140:143]
ds_read_b64_tr_b16 a[160:161], v220 offset:57344
ds_read_b64_tr_b16 a[162:163], v220 offset:61440
v_mfma_f32_16x16x32_bf16 v[16:19], a[132:135], v[172:175], v[16:19]
v_exp_f32 v45, v45
v_mfma_f32_16x16x32_bf16 v[16:19], a[136:139], v[176:179], v[16:19]
s_add_u32 s42, s42, s43
buffer_load_dword v255, v243, s[28:31], s45 offen
v_mfma_f32_16x16x32_bf16 v[16:19], a[140:143], v[180:183], v[16:19]
v_exp_f32 v46, v46
v_mfma_f32_16x16x32_bf16 a[4:7], a[164:167], v[72:75], a[4:7]
v_cvt_pk_bf16_f32 v90, v44, v45
v_mfma_f32_16x16x32_bf16 a[36:39], a[164:167], v[76:79], a[36:39]
v_exp_f32 v47, v47
v_mfma_f32_16x16x32_bf16 a[68:71], a[164:167], v[80:83], a[68:71]
v_cvt_pk_bf16_f32 v91, v46, v47
v_mfma_f32_16x16x32_bf16 a[100:103], a[164:167], v[84:87], a[100:103]
v_exp_f32 v48, v48
v_smfmac_f32_16x16x64_bf16 a[248:251], a[208:211], v[72:79], v235
ds_read_b64_tr_b16 a[164:165], v221 offset:57344
ds_read_b64_tr_b16 a[166:167], v221 offset:61440
v_mfma_f32_16x16x32_bf16 v[24:27], a[128:131], v[184:187], v[144:147]
v_exp_f32 v49, v49
v_mfma_f32_16x16x32_bf16 v[24:27], a[132:135], v[188:191], v[24:27]
v_cvt_pk_bf16_f32 v92, v48, v49
v_mfma_f32_16x16x32_bf16 v[24:27], a[136:139], v[192:195], v[24:27]
s_add_u32 s45, s45, 589824
v_exp_f32 v50, v50
v_mfma_f32_16x16x32_bf16 v[24:27], a[140:143], v[196:199], v[24:27]
global_load_dword v255, v242, s[72:73]
v_mfma_f32_16x16x32_bf16 a[8:11], a[168:171], v[72:75], a[8:11]
v_exp_f32 v51, v51
v_mfma_f32_16x16x32_bf16 a[40:43], a[168:171], v[76:79], a[40:43]
v_cvt_pk_bf16_f32 v93, v50, v51
v_mfma_f32_16x16x32_bf16 a[72:75], a[168:171], v[80:83], a[72:75]
v_exp_f32 v52, v52
v_mfma_f32_16x16x32_bf16 a[104:107], a[168:171], v[84:87], a[104:107]
ds_read_b64_tr_b16 a[168:169], v222 offset:57344
ds_read_b64_tr_b16 a[170:171], v222 offset:61440
v_mfma_f32_16x16x32_bf16 v[32:35], a[128:131], v[200:203], v[148:151]
v_exp_f32 v53, v53
v_mfma_f32_16x16x32_bf16 v[32:35], a[132:135], v[204:207], v[32:35]
ds_read_b128 a[128:131], v216 offset:8192
ds_read_b128 a[132:135], v217 offset:8192
v_mfma_f32_16x16x32_bf16 v[32:35], a[136:139], v[208:211], v[32:35]
v_exp_f32 v54, v54
v_mfma_f32_16x16x32_bf16 v[32:35], a[140:143], v[212:215], v[32:35]
buffer_load_dword v255, v0, s[24:27], s44 offen
v_mfma_f32_16x16x32_bf16 a[12:15], a[172:175], v[72:75], a[12:15]
v_exp_f32 v55, v55
v_mfma_f32_16x16x32_bf16 a[44:47], a[172:175], v[76:79], a[44:47]
ds_read_b128 a[136:139], v218 offset:8192
ds_read_b128 a[140:143], v219 offset:8192
v_mfma_f32_16x16x32_bf16 a[76:79], a[172:175], v[80:83], a[76:79]
v_exp_f32 v56, v56
v_mfma_f32_16x16x32_bf16 a[108:111], a[172:175], v[84:87], a[108:111]
s_waitcnt lgkmcnt(6)
v_exp_f32 v57, v57
v_mfma_f32_16x16x32_bf16 v[12:15], a[144:147], v[152:155], v[136:139]
ds_read_b64_tr_b16 a[172:173], v223 offset:57344
ds_read_b64_tr_b16 a[174:175], v223 offset:61440
v_mfma_f32_16x16x32_bf16 v[12:15], a[148:151], v[156:159], v[12:15]
v_exp_f32 v58, v58
v_mfma_f32_16x16x32_bf16 v[12:15], a[152:155], v[160:163], v[12:15]
v_cvt_pk_bf16_f32 v94, v52, v53
v_cvt_pk_bf16_f32 v95, v54, v55
v_mfma_f32_16x16x32_bf16 v[12:15], a[156:159], v[164:167], v[12:15]
v_exp_f32 v59, v59
v_mfma_f32_16x16x32_bf16 a[16:19], a[176:179], v[72:75], a[16:19]
s_add_u32 s44, s44, 4096
v_cvt_pk_bf16_f32 v96, v56, v57
v_cvt_pk_bf16_f32 v97, v58, v59
v_mfma_f32_16x16x32_bf16 a[48:51], a[176:179], v[76:79], a[48:51]
v_exp_f32 v60, v60
v_mfma_f32_16x16x32_bf16 a[80:83], a[176:179], v[80:83], a[80:83]
v_mfma_f32_16x16x32_bf16 a[112:115], a[176:179], v[84:87], a[112:115]
v_exp_f32 v61, v61
v_mfma_f32_16x16x32_bf16 v[20:23], a[144:147], v[168:171], v[140:143]
ds_read_b64_tr_b16 a[176:177], v224 offset:57344
ds_read_b64_tr_b16 a[178:179], v224 offset:61440
v_mfma_f32_16x16x32_bf16 v[20:23], a[148:151], v[172:175], v[20:23]
v_exp_f32 v62, v62
v_mfma_f32_16x16x32_bf16 v[20:23], a[152:155], v[176:179], v[20:23]
v_cvt_pk_bf16_f32 v98, v60, v61
v_mfma_f32_16x16x32_bf16 v[20:23], a[156:159], v[180:183], v[20:23]
v_exp_f32 v63, v63
v_mfma_f32_16x16x32_bf16 a[20:23], a[180:183], v[72:75], a[20:23]
v_cvt_pk_bf16_f32 v99, v62, v63
v_mfma_f32_16x16x32_bf16 a[52:55], a[180:183], v[76:79], a[52:55]
v_exp_f32 v64, v64
v_mfma_f32_16x16x32_bf16 a[84:87], a[180:183], v[80:83], a[84:87]
v_mfma_f32_16x16x32_bf16 a[116:119], a[180:183], v[84:87], a[116:119]
v_exp_f32 v65, v65
v_smfmac_f32_16x16x64_bf16 a[252:255], a[208:211], v[80:87], v235
ds_read_b64_tr_b16 a[180:181], v225 offset:57344
ds_read_b64_tr_b16 a[182:183], v225 offset:61440
v_mfma_f32_16x16x32_bf16 v[28:31], a[144:147], v[184:187], v[144:147]
v_exp_f32 v66, v66
v_mfma_f32_16x16x32_bf16 v[28:31], a[148:151], v[188:191], v[28:31]
v_cvt_pk_bf16_f32 v100, v64, v65
v_mfma_f32_16x16x32_bf16 v[28:31], a[152:155], v[192:195], v[28:31]
v_exp_f32 v67, v67
v_mfma_f32_16x16x32_bf16 v[28:31], a[156:159], v[196:199], v[28:31]
v_cvt_pk_bf16_f32 v101, v66, v67
v_mfma_f32_16x16x32_bf16 a[24:27], a[184:187], v[72:75], a[24:27]
v_exp_f32 v68, v68
v_mfma_f32_16x16x32_bf16 a[56:59], a[184:187], v[76:79], a[56:59]
v_mfma_f32_16x16x32_bf16 a[88:91], a[184:187], v[80:83], a[88:91]
v_exp_f32 v69, v69
v_mfma_f32_16x16x32_bf16 a[120:123], a[184:187], v[84:87], a[120:123]
ds_read_b64_tr_b16 a[184:185], v226 offset:57344
ds_read_b64_tr_b16 a[186:187], v226 offset:61440
v_mfma_f32_16x16x32_bf16 v[36:39], a[144:147], v[200:203], v[148:151]
v_exp_f32 v70, v70
v_mfma_f32_16x16x32_bf16 v[36:39], a[148:151], v[204:207], v[36:39]
ds_read_b128 a[144:147], v216 offset:12288
ds_read_b128 a[148:151], v217 offset:12288
v_mfma_f32_16x16x32_bf16 v[36:39], a[152:155], v[208:211], v[36:39]
v_exp_f32 v71, v71
v_mfma_f32_16x16x32_bf16 v[36:39], a[156:159], v[212:215], v[36:39]
ds_read_b128 a[152:155], v218 offset:12288
ds_read_b128 a[156:159], v219 offset:12288
v_mfma_f32_16x16x32_bf16 a[28:31], a[188:191], v[72:75], a[28:31]
s_add_u32 s40, s40, 1
v_cvt_pk_bf16_f32 v102, v68, v69
v_cvt_pk_bf16_f32 v103, v70, v71
v_mfma_f32_16x16x32_bf16 a[60:63], a[188:191], v[76:79], a[60:63]
s_bitcmp1_b32 s74, s40
v_mfma_f32_16x16x32_bf16 a[92:95], a[188:191], v[80:83], a[92:95]
v_mfma_f32_16x16x32_bf16 a[124:127], a[188:191], v[84:87], a[124:127]
s_waitcnt lgkmcnt(6)
ds_read_b64_tr_b16 a[188:189], v227 offset:57344
ds_read_b64_tr_b16 a[190:191], v227 offset:61440
s_cbranch_scc1 K_EXIT
K_B4:
v_mfma_f32_16x16x32_bf16 v[40:43], a[128:131], v[152:155], v[136:139]
v_exp_f32 v8, v8
v_mfma_f32_16x16x32_bf16 v[40:43], a[132:135], v[156:159], v[40:43]
v_exp_f32 v9, v9
v_mfma_f32_16x16x32_bf16 v[40:43], a[136:139], v[160:163], v[40:43]
v_cvt_pk_bf16_f32 v72, v8, v9
v_mfma_f32_16x16x32_bf16 v[40:43], a[140:143], v[164:167], v[40:43]
v_exp_f32 v10, v10
v_mfma_f32_16x16x32_bf16 a[0:3], a[160:163], v[88:91], a[0:3]
v_mfma_f32_16x16x32_bf16 a[32:35], a[160:163], v[92:95], a[32:35]
v_exp_f32 v11, v11
s_waitcnt vmcnt(4) lgkmcnt(0)
s_barrier
v_mfma_f32_16x16x32_bf16 a[64:67], a[160:163], v[96:99], a[64:67]
v_cvt_pk_bf16_f32 v73, v10, v11
v_mfma_f32_16x16x32_bf16 a[96:99], a[160:163], v[100:103], a[96:99]
s_add_u32 m0, s37, 98304
v_exp_f32 v12, v12
v_mfma_f32_16x16x32_bf16 v[48:51], a[128:131], v[168:171], v[140:143]
buffer_load_dwordx4 v232, s[12:15], s39 offen offset:0 lds
v_mfma_f32_16x16x32_bf16 v[48:51], a[132:135], v[172:175], v[48:51]
v_exp_f32 v13, v13
v_mfma_f32_16x16x32_bf16 v[48:51], a[136:139], v[176:179], v[48:51]
ds_read_b64_tr_b16 a[160:161], v220 offset:0
ds_read_b64_tr_b16 a[162:163], v220 offset:4096
v_mfma_f32_16x16x32_bf16 v[48:51], a[140:143], v[180:183], v[48:51]
v_exp_f32 v14, v14
v_mfma_f32_16x16x32_bf16 a[4:7], a[164:167], v[88:91], a[4:7]
v_cvt_pk_bf16_f32 v74, v12, v13
v_mfma_f32_16x16x32_bf16 a[36:39], a[164:167], v[92:95], a[36:39]
v_exp_f32 v15, v15
v_mfma_f32_16x16x32_bf16 a[68:71], a[164:167], v[96:99], a[68:71]
v_cvt_pk_bf16_f32 v75, v14, v15
v_mfma_f32_16x16x32_bf16 a[100:103], a[164:167], v[100:103], a[100:103]
v_exp_f32 v16, v16
v_smfmac_f32_16x16x64_bf16 a[248:251], a[208:211], v[88:95], v235
buffer_load_dwordx4 v233, s[12:15], s39 offen offset:1024 lds
v_mfma_f32_16x16x32_bf16 v[56:59], a[128:131], v[184:187], v[144:147]
v_exp_f32 v17, v17
v_mfma_f32_16x16x32_bf16 v[56:59], a[132:135], v[188:191], v[56:59]
ds_read_b64_tr_b16 a[164:165], v221 offset:0
ds_read_b64_tr_b16 a[166:167], v221 offset:4096
v_mfma_f32_16x16x32_bf16 v[56:59], a[136:139], v[192:195], v[56:59]
v_exp_f32 v18, v18
v_mfma_f32_16x16x32_bf16 v[56:59], a[140:143], v[196:199], v[56:59]
v_cvt_pk_bf16_f32 v76, v16, v17
v_mfma_f32_16x16x32_bf16 a[8:11], a[168:171], v[88:91], a[8:11]
v_exp_f32 v19, v19
v_mfma_f32_16x16x32_bf16 a[40:43], a[168:171], v[92:95], a[40:43]
v_cvt_pk_bf16_f32 v77, v18, v19
v_mfma_f32_16x16x32_bf16 a[72:75], a[168:171], v[96:99], a[72:75]
v_exp_f32 v20, v20
v_mfma_f32_16x16x32_bf16 a[104:107], a[168:171], v[100:103], a[104:107]
ds_read_b64_tr_b16 a[168:169], v222 offset:0
ds_read_b64_tr_b16 a[170:171], v222 offset:4096
v_mfma_f32_16x16x32_bf16 v[64:67], a[128:131], v[200:203], v[148:151]
v_exp_f32 v21, v21
v_mfma_f32_16x16x32_bf16 v[64:67], a[132:135], v[204:207], v[64:67]
buffer_load_dwordx4 v232, s[12:15], s39 offen offset:2048 lds
v_mfma_f32_16x16x32_bf16 v[64:67], a[136:139], v[208:211], v[64:67]
v_exp_f32 v22, v22
v_mfma_f32_16x16x32_bf16 v[64:67], a[140:143], v[212:215], v[64:67]
ds_read_b128 a[128:131], v216 offset:49152
ds_read_b128 a[132:135], v217 offset:49152
v_mfma_f32_16x16x32_bf16 a[12:15], a[172:175], v[88:91], a[12:15]
v_exp_f32 v23, v23
v_mfma_f32_16x16x32_bf16 a[44:47], a[172:175], v[92:95], a[44:47]
ds_read_b128 a[136:139], v218 offset:49152
ds_read_b128 a[140:143], v219 offset:49152
v_mfma_f32_16x16x32_bf16 a[76:79], a[172:175], v[96:99], a[76:79]
v_exp_f32 v24, v24
v_mfma_f32_16x16x32_bf16 a[108:111], a[172:175], v[100:103], a[108:111]
v_exp_f32 v25, v25
v_mfma_f32_16x16x32_bf16 v[44:47], a[144:147], v[152:155], v[136:139]
ds_read_b64_tr_b16 a[172:173], v223 offset:0
ds_read_b64_tr_b16 a[174:175], v223 offset:4096
v_mfma_f32_16x16x32_bf16 v[44:47], a[148:151], v[156:159], v[44:47]
v_exp_f32 v26, v26
v_mfma_f32_16x16x32_bf16 v[44:47], a[152:155], v[160:163], v[44:47]
buffer_load_dwordx4 v233, s[12:15], s39 offen offset:3072 lds
v_mfma_f32_16x16x32_bf16 v[44:47], a[156:159], v[164:167], v[44:47]
v_exp_f32 v27, v27
v_mfma_f32_16x16x32_bf16 a[16:19], a[176:179], v[88:91], a[16:19]
v_cvt_pk_bf16_f32 v78, v20, v21
v_cvt_pk_bf16_f32 v79, v22, v23
v_mfma_f32_16x16x32_bf16 a[48:51], a[176:179], v[92:95], a[48:51]
v_exp_f32 v28, v28
v_mfma_f32_16x16x32_bf16 a[80:83], a[176:179], v[96:99], a[80:83]
v_cvt_pk_bf16_f32 v80, v24, v25
v_cvt_pk_bf16_f32 v81, v26, v27
v_mfma_f32_16x16x32_bf16 a[112:115], a[176:179], v[100:103], a[112:115]
v_exp_f32 v29, v29
v_mfma_f32_16x16x32_bf16 v[52:55], a[144:147], v[168:171], v[140:143]
ds_read_b64_tr_b16 a[176:177], v224 offset:0
ds_read_b64_tr_b16 a[178:179], v224 offset:4096
v_mfma_f32_16x16x32_bf16 v[52:55], a[148:151], v[172:175], v[52:55]
v_exp_f32 v30, v30
v_mfma_f32_16x16x32_bf16 v[52:55], a[152:155], v[176:179], v[52:55]
v_cvt_pk_bf16_f32 v82, v28, v29
v_mfma_f32_16x16x32_bf16 v[52:55], a[156:159], v[180:183], v[52:55]
s_add_u32 s39, s39, 16384
v_exp_f32 v31, v31
v_mfma_f32_16x16x32_bf16 a[20:23], a[180:183], v[88:91], a[20:23]
s_add_u32 m0, s37, 16384
v_cvt_pk_bf16_f32 v83, v30, v31
v_mfma_f32_16x16x32_bf16 a[52:55], a[180:183], v[92:95], a[52:55]
v_exp_f32 v32, v32
v_mfma_f32_16x16x32_bf16 a[84:87], a[180:183], v[96:99], a[84:87]
buffer_load_dwordx4 v228, s[8:11], s38 offen offset:0 lds
v_mfma_f32_16x16x32_bf16 a[116:119], a[180:183], v[100:103], a[116:119]
v_exp_f32 v33, v33
v_smfmac_f32_16x16x64_bf16 a[252:255], a[208:211], v[96:103], v235
ds_read_b64_tr_b16 a[180:181], v225 offset:0
ds_read_b64_tr_b16 a[182:183], v225 offset:4096
v_mfma_f32_16x16x32_bf16 v[60:63], a[144:147], v[184:187], v[144:147]
v_exp_f32 v34, v34
v_mfma_f32_16x16x32_bf16 v[60:63], a[148:151], v[188:191], v[60:63]
v_cvt_pk_bf16_f32 v84, v32, v33
v_mfma_f32_16x16x32_bf16 v[60:63], a[152:155], v[192:195], v[60:63]
v_exp_f32 v35, v35
v_mfma_f32_16x16x32_bf16 v[60:63], a[156:159], v[196:199], v[60:63]
buffer_load_dwordx4 v229, s[8:11], s38 offen offset:1024 lds
v_mfma_f32_16x16x32_bf16 a[24:27], a[184:187], v[88:91], a[24:27]
v_exp_f32 v36, v36
v_mfma_f32_16x16x32_bf16 a[56:59], a[184:187], v[92:95], a[56:59]
v_cvt_pk_bf16_f32 v85, v34, v35
v_mfma_f32_16x16x32_bf16 a[88:91], a[184:187], v[96:99], a[88:91]
v_exp_f32 v37, v37
v_mfma_f32_16x16x32_bf16 a[120:123], a[184:187], v[100:103], a[120:123]
ds_read_b64_tr_b16 a[184:185], v226 offset:0
ds_read_b64_tr_b16 a[186:187], v226 offset:4096
v_mfma_f32_16x16x32_bf16 v[68:71], a[144:147], v[200:203], v[148:151]
v_exp_f32 v38, v38
v_mfma_f32_16x16x32_bf16 v[68:71], a[148:151], v[204:207], v[68:71]
ds_read_b128 a[144:147], v216 offset:53248
ds_read_b128 a[148:151], v217 offset:53248
v_mfma_f32_16x16x32_bf16 v[68:71], a[152:155], v[208:211], v[68:71]
v_exp_f32 v39, v39
v_mfma_f32_16x16x32_bf16 v[68:71], a[156:159], v[212:215], v[68:71]
ds_read_b128 a[152:155], v218 offset:53248
ds_read_b128 a[156:159], v219 offset:53248
v_mfma_f32_16x16x32_bf16 a[28:31], a[188:191], v[88:91], a[28:31]
v_cvt_pk_bf16_f32 v86, v36, v37
v_cvt_pk_bf16_f32 v87, v38, v39
v_mfma_f32_16x16x32_bf16 a[60:63], a[188:191], v[92:95], a[60:63]
v_mfma_f32_16x16x32_bf16 a[92:95], a[188:191], v[96:99], a[92:95]
v_mfma_f32_16x16x32_bf16 a[124:127], a[188:191], v[100:103], a[124:127]
s_waitcnt lgkmcnt(6)
ds_read_b64_tr_b16 a[188:189], v227 offset:0
ds_read_b64_tr_b16 a[190:191], v227 offset:4096
K_B5:
v_mfma_f32_16x16x32_bf16 v[8:11], a[128:131], v[152:155], v[136:139]
v_exp_f32 v40, v40
v_mfma_f32_16x16x32_bf16 v[8:11], a[132:135], v[156:159], v[8:11]
v_exp_f32 v41, v41
v_mfma_f32_16x16x32_bf16 v[8:11], a[136:139], v[160:163], v[8:11]
buffer_load_dwordx4 v230, s[8:11], s38 offen offset:2048 lds
v_mfma_f32_16x16x32_bf16 v[8:11], a[140:143], v[164:167], v[8:11]
v_exp_f32 v42, v42
v_mfma_f32_16x16x32_bf16 a[0:3], a[160:163], v[72:75], a[0:3]
v_cvt_pk_bf16_f32 v88, v40, v41
v_mfma_f32_16x16x32_bf16 a[32:35], a[160:163], v[76:79], a[32:35]
v_exp_f32 v43, v43
v_mfma_f32_16x16x32_bf16 a[64:67], a[160:163], v[80:83], a[64:67]
v_cvt_pk_bf16_f32 v89, v42, v43
v_mfma_f32_16x16x32_bf16 a[96:99], a[160:163], v[84:87], a[96:99]
v_exp_f32 v44, v44
v_mfma_f32_16x16x32_bf16 v[16:19], a[128:131], v[168:171], v[140:143]
ds_read_b64_tr_b16 a[160:161], v220 offset:8192
ds_read_b64_tr_b16 a[162:163], v220 offset:12288
v_mfma_f32_16x16x32_bf16 v[16:19], a[132:135], v[172:175], v[16:19]
v_exp_f32 v45, v45
v_mfma_f32_16x16x32_bf16 v[16:19], a[136:139], v[176:179], v[16:19]
v_cvt_pk_bf16_f32 v90, v44, v45
v_mfma_f32_16x16x32_bf16 v[16:19], a[140:143], v[180:183], v[16:19]
v_exp_f32 v46, v46
v_mfma_f32_16x16x32_bf16 a[4:7], a[164:167], v[72:75], a[4:7]
v_mfma_f32_16x16x32_bf16 a[36:39], a[164:167], v[76:79], a[36:39]
v_exp_f32 v47, v47
v_mfma_f32_16x16x32_bf16 a[68:71], a[164:167], v[80:83], a[68:71]
buffer_load_dwordx4 v231, s[8:11], s38 offen offset:3072 lds
v_mfma_f32_16x16x32_bf16 a[100:103], a[164:167], v[84:87], a[100:103]
v_exp_f32 v48, v48
v_smfmac_f32_16x16x64_bf16 a[248:251], a[208:211], v[72:79], v235
ds_read_b64_tr_b16 a[164:165], v221 offset:8192
ds_read_b64_tr_b16 a[166:167], v221 offset:12288
v_mfma_f32_16x16x32_bf16 v[24:27], a[128:131], v[184:187], v[144:147]
v_exp_f32 v49, v49
v_mfma_f32_16x16x32_bf16 v[24:27], a[132:135], v[188:191], v[24:27]
v_cvt_pk_bf16_f32 v91, v46, v47
v_cvt_pk_bf16_f32 v92, v48, v49
v_mfma_f32_16x16x32_bf16 v[24:27], a[136:139], v[192:195], v[24:27]
v_exp_f32 v50, v50
v_mfma_f32_16x16x32_bf16 v[24:27], a[140:143], v[196:199], v[24:27]
v_mfma_f32_16x16x32_bf16 a[8:11], a[168:171], v[72:75], a[8:11]
v_exp_f32 v51, v51
v_mfma_f32_16x16x32_bf16 a[40:43], a[168:171], v[76:79], a[40:43]
v_cvt_pk_bf16_f32 v93, v50, v51
v_mfma_f32_16x16x32_bf16 a[72:75], a[168:171], v[80:83], a[72:75]
v_exp_f32 v52, v52
v_mfma_f32_16x16x32_bf16 a[104:107], a[168:171], v[84:87], a[104:107]
ds_read_b64_tr_b16 a[168:169], v222 offset:8192
ds_read_b64_tr_b16 a[170:171], v222 offset:12288
v_mfma_f32_16x16x32_bf16 v[32:35], a[128:131], v[200:203], v[148:151]
s_add_u32 s38, s38, 16384
v_exp_f32 v53, v53
v_mfma_f32_16x16x32_bf16 v[32:35], a[132:135], v[204:207], v[32:35]
s_add_u32 m0, s37, 114688
ds_read_b128 a[128:131], v216 offset:57344
ds_read_b128 a[132:135], v217 offset:57344
v_mfma_f32_16x16x32_bf16 v[32:35], a[136:139], v[208:211], v[32:35]
v_exp_f32 v54, v54
v_mfma_f32_16x16x32_bf16 v[32:35], a[140:143], v[212:215], v[32:35]
buffer_load_dwordx4 v232, s[12:15], s39 offen offset:0 lds
v_mfma_f32_16x16x32_bf16 a[12:15], a[172:175], v[72:75], a[12:15]
v_exp_f32 v55, v55
v_mfma_f32_16x16x32_bf16 a[44:47], a[172:175], v[76:79], a[44:47]
ds_read_b128 a[136:139], v218 offset:57344
ds_read_b128 a[140:143], v219 offset:57344
v_mfma_f32_16x16x32_bf16 a[76:79], a[172:175], v[80:83], a[76:79]
v_exp_f32 v56, v56
v_mfma_f32_16x16x32_bf16 a[108:111], a[172:175], v[84:87], a[108:111]
s_waitcnt lgkmcnt(6)
v_exp_f32 v57, v57
v_mfma_f32_16x16x32_bf16 v[12:15], a[144:147], v[152:155], v[136:139]
ds_read_b64_tr_b16 a[172:173], v223 offset:8192
ds_read_b64_tr_b16 a[174:175], v223 offset:12288
v_mfma_f32_16x16x32_bf16 v[12:15], a[148:151], v[156:159], v[12:15]
v_exp_f32 v58, v58
v_mfma_f32_16x16x32_bf16 v[12:15], a[152:155], v[160:163], v[12:15]
v_cvt_pk_bf16_f32 v94, v52, v53
v_cvt_pk_bf16_f32 v95, v54, v55
v_mfma_f32_16x16x32_bf16 v[12:15], a[156:159], v[164:167], v[12:15]
v_exp_f32 v59, v59
v_mfma_f32_16x16x32_bf16 a[16:19], a[176:179], v[72:75], a[16:19]
v_cvt_pk_bf16_f32 v96, v56, v57
v_cvt_pk_bf16_f32 v97, v58, v59
v_mfma_f32_16x16x32_bf16 a[48:51], a[176:179], v[76:79], a[48:51]
v_exp_f32 v60, v60
v_mfma_f32_16x16x32_bf16 a[80:83], a[176:179], v[80:83], a[80:83]
buffer_load_dwordx4 v233, s[12:15], s39 offen offset:1024 lds
v_mfma_f32_16x16x32_bf16 a[112:115], a[176:179], v[84:87], a[112:115]
v_exp_f32 v61, v61
v_mfma_f32_16x16x32_bf16 v[20:23], a[144:147], v[168:171], v[140:143]
ds_read_b64_tr_b16 a[176:177], v224 offset:8192
ds_read_b64_tr_b16 a[178:179], v224 offset:12288
v_mfma_f32_16x16x32_bf16 v[20:23], a[148:151], v[172:175], v[20:23]
v_exp_f32 v62, v62
v_mfma_f32_16x16x32_bf16 v[20:23], a[152:155], v[176:179], v[20:23]
v_cvt_pk_bf16_f32 v98, v60, v61
v_mfma_f32_16x16x32_bf16 v[20:23], a[156:159], v[180:183], v[20:23]
v_exp_f32 v63, v63
v_mfma_f32_16x16x32_bf16 a[20:23], a[180:183], v[72:75], a[20:23]
v_cvt_pk_bf16_f32 v99, v62, v63
v_mfma_f32_16x16x32_bf16 a[52:55], a[180:183], v[76:79], a[52:55]
v_exp_f32 v64, v64
v_mfma_f32_16x16x32_bf16 a[84:87], a[180:183], v[80:83], a[84:87]
v_mfma_f32_16x16x32_bf16 a[116:119], a[180:183], v[84:87], a[116:119]
v_exp_f32 v65, v65
v_smfmac_f32_16x16x64_bf16 a[252:255], a[208:211], v[80:87], v235
ds_read_b64_tr_b16 a[180:181], v225 offset:8192
ds_read_b64_tr_b16 a[182:183], v225 offset:12288
v_mfma_f32_16x16x32_bf16 v[28:31], a[144:147], v[184:187], v[144:147]
v_exp_f32 v66, v66
v_mfma_f32_16x16x32_bf16 v[28:31], a[148:151], v[188:191], v[28:31]
buffer_load_dwordx4 v232, s[12:15], s39 offen offset:2048 lds
v_mfma_f32_16x16x32_bf16 v[28:31], a[152:155], v[192:195], v[28:31]
v_exp_f32 v67, v67
v_mfma_f32_16x16x32_bf16 v[28:31], a[156:159], v[196:199], v[28:31]
v_cvt_pk_bf16_f32 v100, v64, v65
v_cvt_pk_bf16_f32 v101, v66, v67
v_mfma_f32_16x16x32_bf16 a[24:27], a[184:187], v[72:75], a[24:27]
v_exp_f32 v68, v68
v_mfma_f32_16x16x32_bf16 a[56:59], a[184:187], v[76:79], a[56:59]
v_mfma_f32_16x16x32_bf16 a[88:91], a[184:187], v[80:83], a[88:91]
v_exp_f32 v69, v69
v_mfma_f32_16x16x32_bf16 a[120:123], a[184:187], v[84:87], a[120:123]
ds_read_b64_tr_b16 a[184:185], v226 offset:8192
ds_read_b64_tr_b16 a[186:187], v226 offset:12288
v_mfma_f32_16x16x32_bf16 v[36:39], a[144:147], v[200:203], v[148:151]
v_exp_f32 v70, v70
v_mfma_f32_16x16x32_bf16 v[36:39], a[148:151], v[204:207], v[36:39]
ds_read_b128 a[144:147], v216 offset:61440
ds_read_b128 a[148:151], v217 offset:61440
v_mfma_f32_16x16x32_bf16 v[36:39], a[152:155], v[208:211], v[36:39]
v_exp_f32 v71, v71
v_mfma_f32_16x16x32_bf16 v[36:39], a[156:159], v[212:215], v[36:39]
ds_read_b128 a[152:155], v218 offset:61440
ds_read_b128 a[156:159], v219 offset:61440
v_mfma_f32_16x16x32_bf16 a[28:31], a[188:191], v[72:75], a[28:31]
v_cvt_pk_bf16_f32 v102, v68, v69
v_cvt_pk_bf16_f32 v103, v70, v71
v_mfma_f32_16x16x32_bf16 a[60:63], a[188:191], v[76:79], a[60:63]
v_mfma_f32_16x16x32_bf16 a[92:95], a[188:191], v[80:83], a[92:95]
v_mfma_f32_16x16x32_bf16 a[124:127], a[188:191], v[84:87], a[124:127]
s_waitcnt lgkmcnt(6)
ds_read_b64_tr_b16 a[188:189], v227 offset:8192
ds_read_b64_tr_b16 a[190:191], v227 offset:12288
v_mfma_f32_16x16x32_bf16 v[40:43], a[128:131], v[152:155], v[136:139]
v_exp_f32 v8, v8
v_mfma_f32_16x16x32_bf16 v[40:43], a[132:135], v[156:159], v[40:43]
v_exp_f32 v9, v9
v_mfma_f32_16x16x32_bf16 v[40:43], a[136:139], v[160:163], v[40:43]
buffer_load_dwordx4 v233, s[12:15], s39 offen offset:3072 lds
v_mfma_f32_16x16x32_bf16 v[40:43], a[140:143], v[164:167], v[40:43]
v_exp_f32 v10, v10
v_mfma_f32_16x16x32_bf16 a[0:3], a[160:163], v[88:91], a[0:3]
v_cvt_pk_bf16_f32 v72, v8, v9
v_mfma_f32_16x16x32_bf16 a[32:35], a[160:163], v[92:95], a[32:35]
v_exp_f32 v11, v11
v_mfma_f32_16x16x32_bf16 a[64:67], a[160:163], v[96:99], a[64:67]
v_cvt_pk_bf16_f32 v73, v10, v11
v_mfma_f32_16x16x32_bf16 a[96:99], a[160:163], v[100:103], a[96:99]
v_exp_f32 v12, v12
v_mfma_f32_16x16x32_bf16 v[48:51], a[128:131], v[168:171], v[140:143]
ds_read_b64_tr_b16 a[160:161], v220 offset:16384
ds_read_b64_tr_b16 a[162:163], v220 offset:20480
v_mfma_f32_16x16x32_bf16 v[48:51], a[132:135], v[172:175], v[48:51]
v_exp_f32 v13, v13
v_mfma_f32_16x16x32_bf16 v[48:51], a[136:139], v[176:179], v[48:51]
v_cvt_pk_bf16_f32 v74, v12, v13
v_mfma_f32_16x16x32_bf16 v[48:51], a[140:143], v[180:183], v[48:51]
v_exp_f32 v14, v14
v_mfma_f32_16x16x32_bf16 a[4:7], a[164:167], v[88:91], a[4:7]
v_mfma_f32_16x16x32_bf16 a[36:39], a[164:167], v[92:95], a[36:39]
s_add_u32 s39, s39, 16384
v_exp_f32 v15, v15
v_mfma_f32_16x16x32_bf16 a[68:71], a[164:167], v[96:99], a[68:71]
s_add_u32 m0, s37, 0
v_cvt_pk_bf16_f32 v75, v14, v15
v_mfma_f32_16x16x32_bf16 a[100:103], a[164:167], v[100:103], a[100:103]
v_exp_f32 v16, v16
v_smfmac_f32_16x16x64_bf16 a[248:251], a[208:211], v[88:95], v235
buffer_load_dwordx4 v228, s[8:11], s38 offen offset:0 lds
v_mfma_f32_16x16x32_bf16 v[56:59], a[128:131], v[184:187], v[144:147]
v_exp_f32 v17, v17
v_mfma_f32_16x16x32_bf16 v[56:59], a[132:135], v[188:191], v[56:59]
ds_read_b64_tr_b16 a[164:165], v221 offset:16384
ds_read_b64_tr_b16 a[166:167], v221 offset:20480
v_mfma_f32_16x16x32_bf16 v[56:59], a[136:139], v[192:195], v[56:59]
v_exp_f32 v18, v18
v_mfma_f32_16x16x32_bf16 v[56:59], a[140:143], v[196:199], v[56:59]
v_cvt_pk_bf16_f32 v76, v16, v17
v_mfma_f32_16x16x32_bf16 a[8:11], a[168:171], v[88:91], a[8:11]
v_exp_f32 v19, v19
v_mfma_f32_16x16x32_bf16 a[40:43], a[168:171], v[92:95], a[40:43]
v_cvt_pk_bf16_f32 v77, v18, v19
v_mfma_f32_16x16x32_bf16 a[72:75], a[168:171], v[96:99], a[72:75]
v_exp_f32 v20, v20
v_mfma_f32_16x16x32_bf16 a[104:107], a[168:171], v[100:103], a[104:107]
ds_read_b64_tr_b16 a[168:169], v222 offset:16384
ds_read_b64_tr_b16 a[170:171], v222 offset:20480
v_mfma_f32_16x16x32_bf16 v[64:67], a[128:131], v[200:203], v[148:151]
v_exp_f32 v21, v21
v_mfma_f32_16x16x32_bf16 v[64:67], a[132:135], v[204:207], v[64:67]
buffer_load_dwordx4 v229, s[8:11], s38 offen offset:1024 lds
v_mfma_f32_16x16x32_bf16 v[64:67], a[136:139], v[208:211], v[64:67]
v_exp_f32 v22, v22
v_mfma_f32_16x16x32_bf16 v[64:67], a[140:143], v[212:215], v[64:67]
ds_read_b128 a[128:131], v216 offset:32768
ds_read_b128 a[132:135], v217 offset:32768
v_mfma_f32_16x16x32_bf16 a[12:15], a[172:175], v[88:91], a[12:15]
v_exp_f32 v23, v23
v_mfma_f32_16x16x32_bf16 a[44:47], a[172:175], v[92:95], a[44:47]
ds_read_b128 a[136:139], v218 offset:32768
ds_read_b128 a[140:143], v219 offset:32768
v_mfma_f32_16x16x32_bf16 a[76:79], a[172:175], v[96:99], a[76:79]
v_exp_f32 v24, v24
v_mfma_f32_16x16x32_bf16 a[108:111], a[172:175], v[100:103], a[108:111]
s_waitcnt lgkmcnt(6)
v_exp_f32 v25, v25
v_mfma_f32_16x16x32_bf16 v[44:47], a[144:147], v[152:155], v[136:139]
ds_read_b64_tr_b16 a[172:173], v223 offset:16384
ds_read_b64_tr_b16 a[174:175], v223 offset:20480
v_mfma_f32_16x16x32_bf16 v[44:47], a[148:151], v[156:159], v[44:47]
v_exp_f32 v26, v26
v_mfma_f32_16x16x32_bf16 v[44:47], a[152:155], v[160:163], v[44:47]
v_cvt_pk_bf16_f32 v78, v20, v21
v_cvt_pk_bf16_f32 v79, v22, v23
v_mfma_f32_16x16x32_bf16 v[44:47], a[156:159], v[164:167], v[44:47]
v_exp_f32 v27, v27
v_mfma_f32_16x16x32_bf16 a[16:19], a[176:179], v[88:91], a[16:19]
v_cvt_pk_bf16_f32 v80, v24, v25
v_cvt_pk_bf16_f32 v81, v26, v27
v_mfma_f32_16x16x32_bf16 a[48:51], a[176:179], v[92:95], a[48:51]
v_exp_f32 v28, v28
v_mfma_f32_16x16x32_bf16 a[80:83], a[176:179], v[96:99], a[80:83]
buffer_load_dwordx4 v230, s[8:11], s38 offen offset:2048 lds
v_mfma_f32_16x16x32_bf16 a[112:115], a[176:179], v[100:103], a[112:115]
v_exp_f32 v29, v29
v_mfma_f32_16x16x32_bf16 v[52:55], a[144:147], v[168:171], v[140:143]
ds_read_b64_tr_b16 a[176:177], v224 offset:16384
ds_read_b64_tr_b16 a[178:179], v224 offset:20480
v_mfma_f32_16x16x32_bf16 v[52:55], a[148:151], v[172:175], v[52:55]
v_exp_f32 v30, v30
v_mfma_f32_16x16x32_bf16 v[52:55], a[152:155], v[176:179], v[52:55]
v_cvt_pk_bf16_f32 v82, v28, v29
v_mfma_f32_16x16x32_bf16 v[52:55], a[156:159], v[180:183], v[52:55]
v_exp_f32 v31, v31
v_mfma_f32_16x16x32_bf16 a[20:23], a[180:183], v[88:91], a[20:23]
v_cvt_pk_bf16_f32 v83, v30, v31
v_mfma_f32_16x16x32_bf16 a[52:55], a[180:183], v[92:95], a[52:55]
v_exp_f32 v32, v32
v_mfma_f32_16x16x32_bf16 a[84:87], a[180:183], v[96:99], a[84:87]
v_mfma_f32_16x16x32_bf16 a[116:119], a[180:183], v[100:103], a[116:119]
v_exp_f32 v33, v33
v_smfmac_f32_16x16x64_bf16 a[252:255], a[208:211], v[96:103], v235
ds_read_b64_tr_b16 a[180:181], v225 offset:16384
ds_read_b64_tr_b16 a[182:183], v225 offset:20480
v_mfma_f32_16x16x32_bf16 v[60:63], a[144:147], v[184:187], v[144:147]
v_exp_f32 v34, v34
v_mfma_f32_16x16x32_bf16 v[60:63], a[148:151], v[188:191], v[60:63]
buffer_load_dwordx4 v231, s[8:11], s38 offen offset:3072 lds
v_mfma_f32_16x16x32_bf16 v[60:63], a[152:155], v[192:195], v[60:63]
v_exp_f32 v35, v35
v_mfma_f32_16x16x32_bf16 v[60:63], a[156:159], v[196:199], v[60:63]
v_cvt_pk_bf16_f32 v84, v32, v33
v_cvt_pk_bf16_f32 v85, v34, v35
v_mfma_f32_16x16x32_bf16 a[24:27], a[184:187], v[88:91], a[24:27]
v_exp_f32 v36, v36
v_mfma_f32_16x16x32_bf16 a[56:59], a[184:187], v[92:95], a[56:59]
v_mfma_f32_16x16x32_bf16 a[88:91], a[184:187], v[96:99], a[88:91]
v_exp_f32 v37, v37
v_mfma_f32_16x16x32_bf16 a[120:123], a[184:187], v[100:103], a[120:123]
ds_read_b64_tr_b16 a[184:185], v226 offset:16384
ds_read_b64_tr_b16 a[186:187], v226 offset:20480
v_mfma_f32_16x16x32_bf16 v[68:71], a[144:147], v[200:203], v[148:151]
v_exp_f32 v38, v38
v_mfma_f32_16x16x32_bf16 v[68:71], a[148:151], v[204:207], v[68:71]
ds_read_b128 a[144:147], v216 offset:36864
ds_read_b128 a[148:151], v217 offset:36864
v_mfma_f32_16x16x32_bf16 v[68:71], a[152:155], v[208:211], v[68:71]
v_exp_f32 v39, v39
v_mfma_f32_16x16x32_bf16 v[68:71], a[156:159], v[212:215], v[68:71]
ds_read_b128 a[152:155], v218 offset:36864
ds_read_b128 a[156:159], v219 offset:36864
v_mfma_f32_16x16x32_bf16 a[28:31], a[188:191], v[88:91], a[28:31]
v_cvt_pk_bf16_f32 v86, v36, v37
v_cvt_pk_bf16_f32 v87, v38, v39
v_mfma_f32_16x16x32_bf16 a[60:63], a[188:191], v[92:95], a[60:63]
s_add_u32 s38, s38, 16384
v_mfma_f32_16x16x32_bf16 a[92:95], a[188:191], v[96:99], a[92:95]
v_mfma_f32_16x16x32_bf16 a[124:127], a[188:191], v[100:103], a[124:127]
s_waitcnt lgkmcnt(6)
ds_read_b64_tr_b16 a[188:189], v227 offset:16384
ds_read_b64_tr_b16 a[190:191], v227 offset:20480
v_mfma_f32_16x16x32_bf16 v[8:11], a[128:131], v[152:155], v[136:139]
v_exp_f32 v40, v40
v_mfma_f32_16x16x32_bf16 v[8:11], a[132:135], v[156:159], v[8:11]
v_exp_f32 v41, v41
v_mfma_f32_16x16x32_bf16 v[8:11], a[136:139], v[160:163], v[8:11]
buffer_load_dwordx2 v[252:253], v251, s[76:79], s42 offen sc1
v_mfma_f32_16x16x32_bf16 v[8:11], a[140:143], v[164:167], v[8:11]
v_exp_f32 v42, v42
v_mfma_f32_16x16x32_bf16 a[0:3], a[160:163], v[72:75], a[0:3]
v_cvt_pk_bf16_f32 v88, v40, v41
v_mfma_f32_16x16x32_bf16 a[32:35], a[160:163], v[76:79], a[32:35]
v_exp_f32 v43, v43
v_mfma_f32_16x16x32_bf16 a[64:67], a[160:163], v[80:83], a[64:67]
v_cvt_pk_bf16_f32 v89, v42, v43
v_mfma_f32_16x16x32_bf16 a[96:99], a[160:163], v[84:87], a[96:99]
v_exp_f32 v44, v44
v_mfma_f32_16x16x32_bf16 v[16:19], a[128:131], v[168:171], v[140:143]
ds_read_b64_tr_b16 a[160:161], v220 offset:24576
ds_read_b64_tr_b16 a[162:163], v220 offset:28672
v_mfma_f32_16x16x32_bf16 v[16:19], a[132:135], v[172:175], v[16:19]
v_exp_f32 v45, v45
v_mfma_f32_16x16x32_bf16 v[16:19], a[136:139], v[176:179], v[16:19]
s_add_u32 s42, s42, s43
buffer_load_dword v255, v243, s[28:31], s45 offen
v_mfma_f32_16x16x32_bf16 v[16:19], a[140:143], v[180:183], v[16:19]
v_exp_f32 v46, v46
v_mfma_f32_16x16x32_bf16 a[4:7], a[164:167], v[72:75], a[4:7]
v_cvt_pk_bf16_f32 v90, v44, v45
v_mfma_f32_16x16x32_bf16 a[36:39], a[164:167], v[76:79], a[36:39]
v_exp_f32 v47, v47
v_mfma_f32_16x16x32_bf16 a[68:71], a[164:167], v[80:83], a[68:71]
v_cvt_pk_bf16_f32 v91, v46, v47
v_mfma_f32_16x16x32_bf16 a[100:103], a[164:167], v[84:87], a[100:103]
v_exp_f32 v48, v48
v_smfmac_f32_16x16x64_bf16 a[248:251], a[208:211], v[72:79], v235
ds_read_b64_tr_b16 a[164:165], v221 offset:24576
ds_read_b64_tr_b16 a[166:167], v221 offset:28672
v_mfma_f32_16x16x32_bf16 v[24:27], a[128:131], v[184:187], v[144:147]
v_exp_f32 v49, v49
v_mfma_f32_16x16x32_bf16 v[24:27], a[132:135], v[188:191], v[24:27]
v_cvt_pk_bf16_f32 v92, v48, v49
v_mfma_f32_16x16x32_bf16 v[24:27], a[136:139], v[192:195], v[24:27]
s_add_u32 s45, s45, 589824
v_exp_f32 v50, v50
v_mfma_f32_16x16x32_bf16 v[24:27], a[140:143], v[196:199], v[24:27]
global_load_dword v255, v242, s[72:73]
v_mfma_f32_16x16x32_bf16 a[8:11], a[168:171], v[72:75], a[8:11]
v_exp_f32 v51, v51
v_mfma_f32_16x16x32_bf16 a[40:43], a[168:171], v[76:79], a[40:43]
v_cvt_pk_bf16_f32 v93, v50, v51
v_mfma_f32_16x16x32_bf16 a[72:75], a[168:171], v[80:83], a[72:75]
v_exp_f32 v52, v52
v_mfma_f32_16x16x32_bf16 a[104:107], a[168:171], v[84:87], a[104:107]
ds_read_b64_tr_b16 a[168:169], v222 offset:24576
ds_read_b64_tr_b16 a[170:171], v222 offset:28672
v_mfma_f32_16x16x32_bf16 v[32:35], a[128:131], v[200:203], v[148:151]
v_exp_f32 v53, v53
v_mfma_f32_16x16x32_bf16 v[32:35], a[132:135], v[204:207], v[32:35]
ds_read_b128 a[128:131], v216 offset:40960
ds_read_b128 a[132:135], v217 offset:40960
v_mfma_f32_16x16x32_bf16 v[32:35], a[136:139], v[208:211], v[32:35]
v_exp_f32 v54, v54
v_mfma_f32_16x16x32_bf16 v[32:35], a[140:143], v[212:215], v[32:35]
buffer_load_dword v255, v0, s[24:27], s44 offen
v_mfma_f32_16x16x32_bf16 a[12:15], a[172:175], v[72:75], a[12:15]
v_exp_f32 v55, v55
v_mfma_f32_16x16x32_bf16 a[44:47], a[172:175], v[76:79], a[44:47]
ds_read_b128 a[136:139], v218 offset:40960
ds_read_b128 a[140:143], v219 offset:40960
v_mfma_f32_16x16x32_bf16 a[76:79], a[172:175], v[80:83], a[76:79]
v_exp_f32 v56, v56
v_mfma_f32_16x16x32_bf16 a[108:111], a[172:175], v[84:87], a[108:111]
s_waitcnt lgkmcnt(6)
v_exp_f32 v57, v57
v_mfma_f32_16x16x32_bf16 v[12:15], a[144:147], v[152:155], v[136:139]
ds_read_b64_tr_b16 a[172:173], v223 offset:24576
ds_read_b64_tr_b16 a[174:175], v223 offset:28672
v_mfma_f32_16x16x32_bf16 v[12:15], a[148:151], v[156:159], v[12:15]
v_exp_f32 v58, v58
v_mfma_f32_16x16x32_bf16 v[12:15], a[152:155], v[160:163], v[12:15]
v_cvt_pk_bf16_f32 v94, v52, v53
v_cvt_pk_bf16_f32 v95, v54, v55
v_mfma_f32_16x16x32_bf16 v[12:15], a[156:159], v[164:167], v[12:15]
v_exp_f32 v59, v59
v_mfma_f32_16x16x32_bf16 a[16:19], a[176:179], v[72:75], a[16:19]
s_add_u32 s44, s44, 4096
v_cvt_pk_bf16_f32 v96, v56, v57
v_cvt_pk_bf16_f32 v97, v58, v59
v_mfma_f32_16x16x32_bf16 a[48:51], a[176:179], v[76:79], a[48:51]
v_exp_f32 v60, v60
v_mfma_f32_16x16x32_bf16 a[80:83], a[176:179], v[80:83], a[80:83]
v_mfma_f32_16x16x32_bf16 a[112:115], a[176:179], v[84:87], a[112:115]
v_exp_f32 v61, v61
v_mfma_f32_16x16x32_bf16 v[20:23], a[144:147], v[168:171], v[140:143]
ds_read_b64_tr_b16 a[176:177], v224 offset:24576
ds_read_b64_tr_b16 a[178:179], v224 offset:28672
v_mfma_f32_16x16x32_bf16 v[20:23], a[148:151], v[172:175], v[20:23]
v_exp_f32 v62, v62
v_mfma_f32_16x16x32_bf16 v[20:23], a[152:155], v[176:179], v[20:23]
v_cvt_pk_bf16_f32 v98, v60, v61
v_mfma_f32_16x16x32_bf16 v[20:23], a[156:159], v[180:183], v[20:23]
v_exp_f32 v63, v63
v_mfma_f32_16x16x32_bf16 a[20:23], a[180:183], v[72:75], a[20:23]
v_cvt_pk_bf16_f32 v99, v62, v63
v_mfma_f32_16x16x32_bf16 a[52:55], a[180:183], v[76:79], a[52:55]
v_exp_f32 v64, v64
v_mfma_f32_16x16x32_bf16 a[84:87], a[180:183], v[80:83], a[84:87]
v_mfma_f32_16x16x32_bf16 a[116:119], a[180:183], v[84:87], a[116:119]
v_exp_f32 v65, v65
v_smfmac_f32_16x16x64_bf16 a[252:255], a[208:211], v[80:87], v235
ds_read_b64_tr_b16 a[180:181], v225 offset:24576
ds_read_b64_tr_b16 a[182:183], v225 offset:28672
v_mfma_f32_16x16x32_bf16 v[28:31], a[144:147], v[184:187], v[144:147]
v_exp_f32 v66, v66
v_mfma_f32_16x16x32_bf16 v[28:31], a[148:151], v[188:191], v[28:31]
v_cvt_pk_bf16_f32 v100, v64, v65
v_mfma_f32_16x16x32_bf16 v[28:31], a[152:155], v[192:195], v[28:31]
v_exp_f32 v67, v67
v_mfma_f32_16x16x32_bf16 v[28:31], a[156:159], v[196:199], v[28:31]
v_cvt_pk_bf16_f32 v101, v66, v67
v_mfma_f32_16x16x32_bf16 a[24:27], a[184:187], v[72:75], a[24:27]
v_exp_f32 v68, v68
v_mfma_f32_16x16x32_bf16 a[56:59], a[184:187], v[76:79], a[56:59]
v_mfma_f32_16x16x32_bf16 a[88:91], a[184:187], v[80:83], a[88:91]
v_exp_f32 v69, v69
v_mfma_f32_16x16x32_bf16 a[120:123], a[184:187], v[84:87], a[120:123]
ds_read_b64_tr_b16 a[184:185], v226 offset:24576
ds_read_b64_tr_b16 a[186:187], v226 offset:28672
v_mfma_f32_16x16x32_bf16 v[36:39], a[144:147], v[200:203], v[148:151]
v_exp_f32 v70, v70
v_mfma_f32_16x16x32_bf16 v[36:39], a[148:151], v[204:207], v[36:39]
ds_read_b128 a[144:147], v216 offset:45056
ds_read_b128 a[148:151], v217 offset:45056
v_mfma_f32_16x16x32_bf16 v[36:39], a[152:155], v[208:211], v[36:39]
v_exp_f32 v71, v71
v_mfma_f32_16x16x32_bf16 v[36:39], a[156:159], v[212:215], v[36:39]
ds_read_b128 a[152:155], v218 offset:45056
ds_read_b128 a[156:159], v219 offset:45056
v_mfma_f32_16x16x32_bf16 a[28:31], a[188:191], v[72:75], a[28:31]
v_cvt_pk_bf16_f32 v102, v68, v69
v_cvt_pk_bf16_f32 v103, v70, v71
v_mfma_f32_16x16x32_bf16 a[60:63], a[188:191], v[76:79], a[60:63]
v_mfma_f32_16x16x32_bf16 a[92:95], a[188:191], v[80:83], a[92:95]
v_mfma_f32_16x16x32_bf16 a[124:127], a[188:191], v[84:87], a[124:127]
s_waitcnt lgkmcnt(6)
ds_read_b64_tr_b16 a[188:189], v227 offset:24576
ds_read_b64_tr_b16 a[190:191], v227 offset:28672
v_mfma_f32_16x16x32_bf16 v[40:43], a[128:131], v[152:155], v[136:139]
v_exp_f32 v8, v8
v_mfma_f32_16x16x32_bf16 v[40:43], a[132:135], v[156:159], v[40:43]
v_exp_f32 v9, v9
v_mfma_f32_16x16x32_bf16 v[40:43], a[136:139], v[160:163], v[40:43]
v_cvt_pk_bf16_f32 v72, v8, v9
v_mfma_f32_16x16x32_bf16 v[40:43], a[140:143], v[164:167], v[40:43]
v_exp_f32 v10, v10
v_mfma_f32_16x16x32_bf16 a[0:3], a[160:163], v[88:91], a[0:3]
v_mfma_f32_16x16x32_bf16 a[32:35], a[160:163], v[92:95], a[32:35]
v_exp_f32 v11, v11
s_waitcnt vmcnt(4) lgkmcnt(0)
s_barrier
v_mfma_f32_16x16x32_bf16 a[64:67], a[160:163], v[96:99], a[64:67]
v_cvt_pk_bf16_f32 v73, v10, v11
v_mfma_f32_16x16x32_bf16 a[96:99], a[160:163], v[100:103], a[96:99]
s_add_u32 m0, s37, 65536
v_exp_f32 v12, v12
v_mfma_f32_16x16x32_bf16 v[48:51], a[128:131], v[168:171], v[140:143]
buffer_load_dwordx4 v232, s[12:15], s39 offen offset:0 lds
v_mfma_f32_16x16x32_bf16 v[48:51], a[132:135], v[172:175], v[48:51]
v_exp_f32 v13, v13
v_mfma_f32_16x16x32_bf16 v[48:51], a[136:139], v[176:179], v[48:51]
ds_read_b64_tr_b16 a[160:161], v220 offset:32768
ds_read_b64_tr_b16 a[162:163], v220 offset:36864
v_mfma_f32_16x16x32_bf16 v[48:51], a[140:143], v[180:183], v[48:51]
v_exp_f32 v14, v14
v_mfma_f32_16x16x32_bf16 a[4:7], a[164:167], v[88:91], a[4:7]
v_cvt_pk_bf16_f32 v74, v12, v13
v_mfma_f32_16x16x32_bf16 a[36:39], a[164:167], v[92:95], a[36:39]
v_exp_f32 v15, v15
v_mfma_f32_16x16x32_bf16 a[68:71], a[164:167], v[96:99], a[68:71]
v_cvt_pk_bf16_f32 v75, v14, v15
v_mfma_f32_16x16x32_bf16 a[100:103], a[164:167], v[100:103], a[100:103]
v_exp_f32 v16, v16
v_smfmac_f32_16x16x64_bf16 a[248:251], a[208:211], v[88:95], v235
buffer_load_dwordx4 v233, s[12:15], s39 offen offset:1024 lds
v_mfma_f32_16x16x32_bf16 v[56:59], a[128:131], v[184:187], v[144:147]
v_exp_f32 v17, v17
v_mfma_f32_16x16x32_bf16 v[56:59], a[132:135], v[188:191], v[56:59]
ds_read_b64_tr_b16 a[164:165], v221 offset:32768
ds_read_b64_tr_b16 a[166:167], v221 offset:36864
v_mfma_f32_16x16x32_bf16 v[56:59], a[136:139], v[192:195], v[56:59]
v_exp_f32 v18, v18
v_mfma_f32_16x16x32_bf16 v[56:59], a[140:143], v[196:199], v[56:59]
v_cvt_pk_bf16_f32 v76, v16, v17
v_mfma_f32_16x16x32_bf16 a[8:11], a[168:171], v[88:91], a[8:11]
v_exp_f32 v19, v19
v_mfma_f32_16x16x32_bf16 a[40:43], a[168:171], v[92:95], a[40:43]
v_cvt_pk_bf16_f32 v77, v18, v19
v_mfma_f32_16x16x32_bf16 a[72:75], a[168:171], v[96:99], a[72:75]
v_exp_f32 v20, v20
v_mfma_f32_16x16x32_bf16 a[104:107], a[168:171], v[100:103], a[104:107]
ds_read_b64_tr_b16 a[168:169], v222 offset:32768
ds_read_b64_tr_b16 a[170:171], v222 offset:36864
v_mfma_f32_16x16x32_bf16 v[64:67], a[128:131], v[200:203], v[148:151]
v_exp_f32 v21, v21
v_mfma_f32_16x16x32_bf16 v[64:67], a[132:135], v[204:207], v[64:67]
buffer_load_dwordx4 v232, s[12:15], s39 offen offset:2048 lds
v_mfma_f32_16x16x32_bf16 v[64:67], a[136:139], v[208:211], v[64:67]
v_exp_f32 v22, v22
v_mfma_f32_16x16x32_bf16 v[64:67], a[140:143], v[212:215], v[64:67]
ds_read_b128 a[128:131], v216 offset:16384
ds_read_b128 a[132:135], v217 offset:16384
v_mfma_f32_16x16x32_bf16 a[12:15], a[172:175], v[88:91], a[12:15]
v_exp_f32 v23, v23
v_mfma_f32_16x16x32_bf16 a[44:47], a[172:175], v[92:95], a[44:47]
ds_read_b128 a[136:139], v218 offset:16384
ds_read_b128 a[140:143], v219 offset:16384
v_mfma_f32_16x16x32_bf16 a[76:79], a[172:175], v[96:99], a[76:79]
v_exp_f32 v24, v24
v_mfma_f32_16x16x32_bf16 a[108:111], a[172:175], v[100:103], a[108:111]
v_exp_f32 v25, v25
v_mfma_f32_16x16x32_bf16 v[44:47], a[144:147], v[152:155], v[136:139]
ds_read_b64_tr_b16 a[172:173], v223 offset:32768
ds_read_b64_tr_b16 a[174:175], v223 offset:36864
v_mfma_f32_16x16x32_bf16 v[44:47], a[148:151], v[156:159], v[44:47]
v_exp_f32 v26, v26
v_mfma_f32_16x16x32_bf16 v[44:47], a[152:155], v[160:163], v[44:47]
buffer_load_dwordx4 v233, s[12:15], s39 offen offset:3072 lds
v_mfma_f32_16x16x32_bf16 v[44:47], a[156:159], v[164:167], v[44:47]
v_exp_f32 v27, v27
v_mfma_f32_16x16x32_bf16 a[16:19], a[176:179], v[88:91], a[16:19]
v_cvt_pk_bf16_f32 v78, v20, v21
v_cvt_pk_bf16_f32 v79, v22, v23
v_mfma_f32_16x16x32_bf16 a[48:51], a[176:179], v[92:95], a[48:51]
v_exp_f32 v28, v28
v_mfma_f32_16x16x32_bf16 a[80:83], a[176:179], v[96:99], a[80:83]
v_cvt_pk_bf16_f32 v80, v24, v25
v_cvt_pk_bf16_f32 v81, v26, v27
v_mfma_f32_16x16x32_bf16 a[112:115], a[176:179], v[100:103], a[112:115]
v_exp_f32 v29, v29
v_mfma_f32_16x16x32_bf16 v[52:55], a[144:147], v[168:171], v[140:143]
ds_read_b64_tr_b16 a[176:177], v224 offset:32768
ds_read_b64_tr_b16 a[178:179], v224 offset:36864
v_mfma_f32_16x16x32_bf16 v[52:55], a[148:151], v[172:175], v[52:55]
v_exp_f32 v30, v30
v_mfma_f32_16x16x32_bf16 v[52:55], a[152:155], v[176:179], v[52:55]
v_cvt_pk_bf16_f32 v82, v28, v29
v_mfma_f32_16x16x32_bf16 v[52:55], a[156:159], v[180:183], v[52:55]
s_add_u32 s39, s39, 16384
v_exp_f32 v31, v31
v_mfma_f32_16x16x32_bf16 a[20:23], a[180:183], v[88:91], a[20:23]
s_add_u32 m0, s37, 49152
v_cvt_pk_bf16_f32 v83, v30, v31
v_mfma_f32_16x16x32_bf16 a[52:55], a[180:183], v[92:95], a[52:55]
v_exp_f32 v32, v32
v_mfma_f32_16x16x32_bf16 a[84:87], a[180:183], v[96:99], a[84:87]
buffer_load_dwordx4 v228, s[8:11], s38 offen offset:0 lds
v_mfma_f32_16x16x32_bf16 a[116:119], a[180:183], v[100:103], a[116:119]
v_exp_f32 v33, v33
v_smfmac_f32_16x16x64_bf16 a[252:255], a[208:211], v[96:103], v235
ds_read_b64_tr_b16 a[180:181], v225 offset:32768
ds_read_b64_tr_b16 a[182:183], v225 offset:36864
v_mfma_f32_16x16x32_bf16 v[60:63], a[144:147], v[184:187], v[144:147]
v_exp_f32 v34, v34
v_mfma_f32_16x16x32_bf16 v[60:63], a[148:151], v[188:191], v[60:63]
v_cvt_pk_bf16_f32 v84, v32, v33
v_mfma_f32_16x16x32_bf16 v[60:63], a[152:155], v[192:195], v[60:63]
v_exp_f32 v35, v35
v_mfma_f32_16x16x32_bf16 v[60:63], a[156:159], v[196:199], v[60:63]
buffer_load_dwordx4 v229, s[8:11], s38 offen offset:1024 lds
v_mfma_f32_16x16x32_bf16 a[24:27], a[184:187], v[88:91], a[24:27]
v_exp_f32 v36, v36
v_mfma_f32_16x16x32_bf16 a[56:59], a[184:187], v[92:95], a[56:59]
v_cvt_pk_bf16_f32 v85, v34, v35
v_mfma_f32_16x16x32_bf16 a[88:91], a[184:187], v[96:99], a[88:91]
v_exp_f32 v37, v37
v_mfma_f32_16x16x32_bf16 a[120:123], a[184:187], v[100:103], a[120:123]
ds_read_b64_tr_b16 a[184:185], v226 offset:32768
ds_read_b64_tr_b16 a[186:187], v226 offset:36864
v_mfma_f32_16x16x32_bf16 v[68:71], a[144:147], v[200:203], v[148:151]
v_exp_f32 v38, v38
v_mfma_f32_16x16x32_bf16 v[68:71], a[148:151], v[204:207], v[68:71]
ds_read_b128 a[144:147], v216 offset:20480
ds_read_b128 a[148:151], v217 offset:20480
v_mfma_f32_16x16x32_bf16 v[68:71], a[152:155], v[208:211], v[68:71]
v_exp_f32 v39, v39
v_mfma_f32_16x16x32_bf16 v[68:71], a[156:159], v[212:215], v[68:71]
ds_read_b128 a[152:155], v218 offset:20480
ds_read_b128 a[156:159], v219 offset:20480
v_mfma_f32_16x16x32_bf16 a[28:31], a[188:191], v[88:91], a[28:31]
v_cvt_pk_bf16_f32 v86, v36, v37
v_cvt_pk_bf16_f32 v87, v38, v39
v_mfma_f32_16x16x32_bf16 a[60:63], a[188:191], v[92:95], a[60:63]
v_mfma_f32_16x16x32_bf16 a[92:95], a[188:191], v[96:99], a[92:95]
v_mfma_f32_16x16x32_bf16 a[124:127], a[188:191], v[100:103], a[124:127]
s_waitcnt lgkmcnt(6)
ds_read_b64_tr_b16 a[188:189], v227 offset:32768
ds_read_b64_tr_b16 a[190:191], v227 offset:36864
s_branch K_LOOP
K_EXIT:
s_cmp_lg_u32 s40, 8
s_cbranch_scc1 K_HOOK
s_cmp_lg_u32 s52, 0
s_cbranch_scc1 K_YR0
K_LAST:
v_mfma_f32_16x16x32_bf16 v[40:43], a[128:131], v[152:155], v[136:139]
s_add_u32 s46, s36, 1
v_exp_f32 v8, v8
v_mfma_f32_16x16x32_bf16 v[40:43], a[132:135], v[156:159], v[40:43]
s_and_b32 s46, s46, 3
v_exp_f32 v9, v9
v_mfma_f32_16x16x32_bf16 v[40:43], a[136:139], v[160:163], v[40:43]
s_mul_i32 s42, s46, 294912
v_cvt_pk_bf16_f32 v72, v8, v9
v_mfma_f32_16x16x32_bf16 v[40:43], a[140:143], v[164:167], v[40:43]
s_add_u32 s42, s42, s84
v_exp_f32 v10, v10
v_mfma_f32_16x16x32_bf16 a[0:3], a[160:163], v[88:91], a[0:3]
s_add_u32 s46, s36, 2
v_mfma_f32_16x16x32_bf16 a[32:35], a[160:163], v[92:95], a[32:35]
s_and_b32 s46, s46, 3
v_exp_f32 v11, v11
s_waitcnt vmcnt(4) lgkmcnt(0)
s_barrier
v_mfma_f32_16x16x32_bf16 a[64:67], a[160:163], v[96:99], a[64:67]
s_mul_i32 s43, s46, 294912
v_cvt_pk_bf16_f32 v73, v10, v11
v_mfma_f32_16x16x32_bf16 a[96:99], a[160:163], v[100:103], a[96:99]
s_add_u32 m0, s3, 98304
v_exp_f32 v12, v12
v_mfma_f32_16x16x32_bf16 v[48:51], a[128:131], v[168:171], v[140:143]
s_add_u32 s48, s51, 0
buffer_load_dwordx4 v236, s[16:19], s48 offen lds
v_mfma_f32_16x16x32_bf16 v[48:51], a[132:135], v[172:175], v[48:51]
s_add_u32 s43, s43, s84
v_exp_f32 v13, v13
v_mfma_f32_16x16x32_bf16 v[48:51], a[136:139], v[176:179], v[48:51]
s_add_u32 s46, s36, 3
ds_read_b64_tr_b16 a[160:161], v220 offset:0
ds_read_b64_tr_b16 a[162:163], v220 offset:4096
v_mfma_f32_16x16x32_bf16 v[48:51], a[140:143], v[180:183], v[48:51]
s_and_b32 s46, s46, 3
v_exp_f32 v14, v14
v_mfma_f32_16x16x32_bf16 a[4:7], a[164:167], v[88:91], a[4:7]
s_add_u32 m0, s3, 102400
v_cvt_pk_bf16_f32 v74, v12, v13
v_mfma_f32_16x16x32_bf16 a[36:39], a[164:167], v[92:95], a[36:39]
s_add_u32 s48, s51, 18432
v_exp_f32 v15, v15
v_mfma_f32_16x16x32_bf16 a[68:71], a[164:167], v[96:99], a[68:71]
s_mul_i32 s44, s46, 294912
buffer_load_dwordx4 v236, s[16:19], s48 offen lds
v_mfma_f32_16x16x32_bf16 a[100:103], a[164:167], v[100:103], a[100:103]
s_add_u32 s44, s44, s84
v_exp_f32 v16, v16
v_smfmac_f32_16x16x64_bf16 a[248:251], a[208:211], v[88:95], v235
s_cmp_eq_u32 s32, s36
s_cselect_b32 s83, s52, 0
ds_read_b64_tr_b16 a[164:165], v221 offset:0
ds_read_b64_tr_b16 a[166:167], v221 offset:4096
v_mfma_f32_16x16x32_bf16 v[56:59], a[128:131], v[184:187], v[144:147]
v_exp_f32 v17, v17
v_mfma_f32_16x16x32_bf16 v[56:59], a[132:135], v[188:191], v[56:59]
s_add_u32 m0, s3, 106496
v_cvt_pk_bf16_f32 v75, v14, v15
v_cvt_pk_bf16_f32 v76, v16, v17
v_mfma_f32_16x16x32_bf16 v[56:59], a[136:139], v[192:195], v[56:59]
s_add_u32 s48, s51, 36864
v_exp_f32 v18, v18
v_mfma_f32_16x16x32_bf16 v[56:59], a[140:143], v[196:199], v[56:59]
buffer_load_dwordx4 v236, s[16:19], s48 offen lds
v_mfma_f32_16x16x32_bf16 a[8:11], a[168:171], v[88:91], a[8:11]
v_exp_f32 v19, v19
v_mfma_f32_16x16x32_bf16 a[40:43], a[168:171], v[92:95], a[40:43]
v_cvt_pk_bf16_f32 v77, v18, v19
v_mfma_f32_16x16x32_bf16 a[72:75], a[168:171], v[96:99], a[72:75]
s_add_u32 m0, s3, 110592
v_exp_f32 v20, v20
v_mfma_f32_16x16x32_bf16 a[104:107], a[168:171], v[100:103], a[104:107]
s_add_u32 s48, s51, 55296
buffer_load_dwordx4 v236, s[16:19], s48 offen lds
v_mfma_f32_16x16x32_bf16 v[64:67], a[128:131], v[200:203], v[148:151]
v_exp_f32 v21, v21
v_mfma_f32_16x16x32_bf16 v[64:67], a[132:135], v[204:207], v[64:67]
ds_read_b64_tr_b16 a[168:169], v222 offset:0
ds_read_b64_tr_b16 a[170:171], v222 offset:4096
v_mfma_f32_16x16x32_bf16 v[64:67], a[136:139], v[208:211], v[64:67]
v_exp_f32 v22, v22
v_mfma_f32_16x16x32_bf16 v[64:67], a[140:143], v[212:215], v[64:67]
ds_read_b128 a[128:131], v216 offset:49152
ds_read_b128 a[132:135], v217 offset:49152
v_mfma_f32_16x16x32_bf16 a[12:15], a[172:175], v[88:91], a[12:15]
s_add_u32 m0, s3, 114688
v_exp_f32 v23, v23
v_mfma_f32_16x16x32_bf16 a[44:47], a[172:175], v[92:95], a[44:47]
s_add_u32 s48, s51, 73728
buffer_load_dwordx4 v236, s[16:19], s48 offen lds
v_mfma_f32_16x16x32_bf16 a[76:79], a[172:175], v[96:99], a[76:79]
v_exp_f32 v24, v24
v_mfma_f32_16x16x32_bf16 a[108:111], a[172:175], v[100:103], a[108:111]
v_exp_f32 v25, v25
v_mfma_f32_16x16x32_bf16 v[44:47], a[144:147], v[152:155], v[136:139]
ds_read_b128 a[136:139], v218 offset:49152
ds_read_b128 a[140:143], v219 offset:49152
v_mfma_f32_16x16x32_bf16 v[44:47], a[148:151], v[156:159], v[44:47]
v_exp_f32 v26, v26
v_mfma_f32_16x16x32_bf16 v[44:47], a[152:155], v[160:163], v[44:47]
s_add_u32 m0, s3, 118784
ds_read_b64_tr_b16 a[172:173], v223 offset:0
ds_read_b64_tr_b16 a[174:175], v223 offset:4096
v_mfma_f32_16x16x32_bf16 v[44:47], a[156:159], v[164:167], v[44:47]
s_add_u32 s48, s51, 92160
v_exp_f32 v27, v27
v_mfma_f32_16x16x32_bf16 a[16:19], a[176:179], v[88:91], a[16:19]
buffer_load_dwordx4 v236, s[16:19], s48 offen lds
v_mfma_f32_16x16x32_bf16 a[48:51], a[176:179], v[92:95], a[48:51]
v_exp_f32 v28, v28
v_mfma_f32_16x16x32_bf16 a[80:83], a[176:179], v[96:99], a[80:83]
v_cvt_pk_bf16_f32 v78, v20, v21
v_cvt_pk_bf16_f32 v79, v22, v23
v_mfma_f32_16x16x32_bf16 a[112:115], a[176:179], v[100:103], a[112:115]
s_add_u32 m0, s3, 122880
v_exp_f32 v29, v29
v_mfma_f32_16x16x32_bf16 v[52:55], a[144:147], v[168:171], v[140:143]
s_add_u32 s48, s51, 110592
buffer_load_dwordx4 v236, s[16:19], s48 offen lds
v_mfma_f32_16x16x32_bf16 v[52:55], a[148:151], v[172:175], v[52:55]
v_exp_f32 v30, v30
v_mfma_f32_16x16x32_bf16 v[52:55], a[152:155], v[176:179], v[52:55]
ds_read_b64_tr_b16 a[176:177], v224 offset:0
ds_read_b64_tr_b16 a[178:179], v224 offset:4096
v_mfma_f32_16x16x32_bf16 v[52:55], a[156:159], v[180:183], v[52:55]
v_exp_f32 v31, v31
v_mfma_f32_16x16x32_bf16 a[20:23], a[180:183], v[88:91], a[20:23]
v_cvt_pk_bf16_f32 v80, v24, v25
v_cvt_pk_bf16_f32 v81, v26, v27
v_mfma_f32_16x16x32_bf16 a[52:55], a[180:183], v[92:95], a[52:55]
s_add_u32 m0, s3, 126976
v_exp_f32 v32, v32
v_mfma_f32_16x16x32_bf16 a[84:87], a[180:183], v[96:99], a[84:87]
s_add_u32 s48, s51, 129024
buffer_load_dwordx4 v236, s[16:19], s48 offen lds
v_mfma_f32_16x16x32_bf16 a[116:119], a[180:183], v[100:103], a[116:119]
v_exp_f32 v33, v33
v_smfmac_f32_16x16x64_bf16 a[252:255], a[208:211], v[96:103], v235
ds_read_b64_tr_b16 a[180:181], v225 offset:0
ds_read_b64_tr_b16 a[182:183], v225 offset:4096
v_mfma_f32_16x16x32_bf16 v[60:63], a[144:147], v[184:187], v[144:147]
v_exp_f32 v34, v34
v_mfma_f32_16x16x32_bf16 v[60:63], a[148:151], v[188:191], v[60:63]
s_add_u32 m0, s3, 0
v_cvt_pk_bf16_f32 v82, v28, v29
v_cvt_pk_bf16_f32 v83, v30, v31
v_mfma_f32_16x16x32_bf16 v[60:63], a[152:155], v[192:195], v[60:63]
s_add_u32 s48, s75, 0
v_exp_f32 v35, v35
v_mfma_f32_16x16x32_bf16 v[60:63], a[156:159], v[196:199], v[60:63]
buffer_load_dwordx4 v237, s[16:19], s48 offen lds
v_mfma_f32_16x16x32_bf16 a[24:27], a[184:187], v[88:91], a[24:27]
v_exp_f32 v36, v36
v_mfma_f32_16x16x32_bf16 a[56:59], a[184:187], v[92:95], a[56:59]
v_cvt_pk_bf16_f32 v84, v32, v33
v_cvt_pk_bf16_f32 v85, v34, v35
v_mfma_f32_16x16x32_bf16 a[88:91], a[184:187], v[96:99], a[88:91]
v_exp_f32 v37, v37
v_mfma_f32_16x16x32_bf16 a[120:123], a[184:187], v[100:103], a[120:123]
s_add_u32 m0, s3, 4096
ds_read_b64_tr_b16 a[184:185], v226 offset:0
ds_read_b64_tr_b16 a[186:187], v226 offset:4096
v_mfma_f32_16x16x32_bf16 v[68:71], a[144:147], v[200:203], v[148:151]
s_add_u32 s48, s75, 36864
v_exp_f32 v38, v38
v_mfma_f32_16x16x32_bf16 v[68:71], a[148:151], v[204:207], v[68:71]
buffer_load_dwordx4 v237, s[16:19], s48 offen lds
v_mfma_f32_16x16x32_bf16 v[68:71], a[152:155], v[208:211], v[68:71]
v_exp_f32 v39, v39
v_mfma_f32_16x16x32_bf16 v[68:71], a[156:159], v[212:215], v[68:71]
ds_read_b128 a[144:147], v216 offset:53248
ds_read_b128 a[148:151], v217 offset:53248
v_mfma_f32_16x16x32_bf16 a[28:31], a[188:191], v[88:91], a[28:31]
ds_read_b128 a[152:155], v218 offset:53248
ds_read_b128 a[156:159], v219 offset:53248
v_mfma_f32_16x16x32_bf16 a[60:63], a[188:191], v[92:95], a[60:63]
v_cvt_pk_bf16_f32 v86, v36, v37
v_cvt_pk_bf16_f32 v87, v38, v39
v_mfma_f32_16x16x32_bf16 a[92:95], a[188:191], v[96:99], a[92:95]
v_mfma_f32_16x16x32_bf16 a[124:127], a[188:191], v[100:103], a[124:127]
s_waitcnt lgkmcnt(6)
ds_read_b64_tr_b16 a[188:189], v227 offset:0
ds_read_b64_tr_b16 a[190:191], v227 offset:4096
v_mfma_f32_16x16x32_bf16 v[8:11], a[128:131], v[152:155], v[136:139]
v_exp_f32 v40, v40
v_mfma_f32_16x16x32_bf16 v[8:11], a[132:135], v[156:159], v[8:11]
s_add_u32 m0, s3, 8192
v_exp_f32 v41, v41
v_mfma_f32_16x16x32_bf16 v[8:11], a[136:139], v[160:163], v[8:11]
s_add_u32 s48, s75, 73728
buffer_load_dwordx4 v237, s[16:19], s48 offen lds
v_mfma_f32_16x16x32_bf16 v[8:11], a[140:143], v[164:167], v[8:11]
v_exp_f32 v42, v42
v_mfma_f32_16x16x32_bf16 a[0:3], a[160:163], v[72:75], a[0:3]
v_cvt_pk_bf16_f32 v88, v40, v41
v_mfma_f32_16x16x32_bf16 a[32:35], a[160:163], v[76:79], a[32:35]
v_exp_f32 v43, v43
v_mfma_f32_16x16x32_bf16 a[64:67], a[160:163], v[80:83], a[64:67]
s_add_u32 m0, s3, 12288
v_cvt_pk_bf16_f32 v89, v42, v43
v_mfma_f32_16x16x32_bf16 a[96:99], a[160:163], v[84:87], a[96:99]
s_add_u32 s48, s75, 110592
v_exp_f32 v44, v44
v_mfma_f32_16x16x32_bf16 v[16:19], a[128:131], v[168:171], v[140:143]
buffer_load_dwordx4 v237, s[16:19], s48 offen lds
v_mfma_f32_16x16x32_bf16 v[16:19], a[132:135], v[172:175], v[16:19]
v_exp_f32 v45, v45
v_mfma_f32_16x16x32_bf16 v[16:19], a[136:139], v[176:179], v[16:19]
ds_read_b64_tr_b16 a[160:161], v220 offset:8192
ds_read_b64_tr_b16 a[162:163], v220 offset:12288
v_mfma_f32_16x16x32_bf16 v[16:19], a[140:143], v[180:183], v[16:19]
s_add_u32 m0, s3, 16384
v_exp_f32 v46, v46
v_mfma_f32_16x16x32_bf16 a[4:7], a[164:167], v[72:75], a[4:7]
s_add_u32 s48, s75, 147456
buffer_load_dwordx4 v237, s[16:19], s48 offen lds
v_mfma_f32_16x16x32_bf16 a[36:39], a[164:167], v[76:79], a[36:39]
v_exp_f32 v47, v47
v_mfma_f32_16x16x32_bf16 a[68:71], a[164:167], v[80:83], a[68:71]
v_cvt_pk_bf16_f32 v90, v44, v45
v_cvt_pk_bf16_f32 v91, v46, v47
v_mfma_f32_16x16x32_bf16 a[100:103], a[164:167], v[84:87], a[100:103]
v_exp_f32 v48, v48
v_smfmac_f32_16x16x64_bf16 a[248:251], a[208:211], v[72:79], v235
s_add_u32 m0, s3, 20480
ds_read_b64_tr_b16 a[164:165], v221 offset:8192
ds_read_b64_tr_b16 a[166:167], v221 offset:12288
v_mfma_f32_16x16x32_bf16 v[24:27], a[128:131], v[184:187], v[144:147]
s_add_u32 s48, s75, 184320
v_exp_f32 v49, v49
v_mfma_f32_16x16x32_bf16 v[24:27], a[132:135], v[188:191], v[24:27]
buffer_load_dwordx4 v237, s[16:19], s48 offen lds
v_mfma_f32_16x16x32_bf16 v[24:27], a[136:139], v[192:195], v[24:27]
v_exp_f32 v50, v50
v_mfma_f32_16x16x32_bf16 v[24:27], a[140:143], v[196:199], v[24:27]
v_cvt_pk_bf16_f32 v92, v48, v49
v_mfma_f32_16x16x32_bf16 a[8:11], a[168:171], v[72:75], a[8:11]
s_add_u32 m0, s3, 24576
v_exp_f32 v51, v51
v_mfma_f32_16x16x32_bf16 a[40:43], a[168:171], v[76:79], a[40:43]
s_add_u32 s48, s75, 221184
buffer_load_dwordx4 v237, s[16:19], s48 offen lds
v_mfma_f32_16x16x32_bf16 a[72:75], a[168:171], v[80:83], a[72:75]
v_exp_f32 v52, v52
v_mfma_f32_16x16x32_bf16 a[104:107], a[168:171], v[84:87], a[104:107]
ds_read_b64_tr_b16 a[168:169], v222 offset:8192
ds_read_b64_tr_b16 a[170:171], v222 offset:12288
v_mfma_f32_16x16x32_bf16 v[32:35], a[128:131], v[200:203], v[148:151]
v_exp_f32 v53, v53
v_mfma_f32_16x16x32_bf16 v[32:35], a[132:135], v[204:207], v[32:35]
s_add_u32 m0, s3, 28672
ds_read_b128 a[128:131], v216 offset:57344
ds_read_b128 a[132:135], v217 offset:57344
v_mfma_f32_16x16x32_bf16 v[32:35], a[136:139], v[208:211], v[32:35]
s_add_u32 s48, s75, 258048
v_exp_f32 v54, v54
v_mfma_f32_16x16x32_bf16 v[32:35], a[140:143], v[212:215], v[32:35]
buffer_load_dwordx4 v237, s[16:19], s48 offen lds
v_mfma_f32_16x16x32_bf16 a[12:15], a[172:175], v[72:75], a[12:15]
v_exp_f32 v55, v55
v_mfma_f32_16x16x32_bf16 a[44:47], a[172:175], v[76:79], a[44:47]
ds_read_b128 a[136:139], v218 offset:57344
ds_read_b128 a[140:143], v219 offset:57344
v_mfma_f32_16x16x32_bf16 a[76:79], a[172:175], v[80:83], a[76:79]
s_waitcnt lgkmcnt(6)
v_exp_f32 v56, v56
v_mfma_f32_16x16x32_bf16 a[108:111], a[172:175], v[84:87], a[108:111]
s_add_u32 m0, s3, 131072
v_exp_f32 v57, v57
v_mfma_f32_16x16x32_bf16 v[12:15], a[144:147], v[152:155], v[136:139]
s_add_u32 s48, s51, 147456
buffer_load_dwordx4 v236, s[16:19], s48 offen lds
v_mfma_f32_16x16x32_bf16 v[12:15], a[148:151], v[156:159], v[12:15]
v_exp_f32 v58, v58
v_mfma_f32_16x16x32_bf16 v[12:15], a[152:155], v[160:163], v[12:15]
ds_read_b64_tr_b16 a[172:173], v223 offset:8192
ds_read_b64_tr_b16 a[174:175], v223 offset:12288
v_mfma_f32_16x16x32_bf16 v[12:15], a[156:159], v[164:167], v[12:15]
v_exp_f32 v59, v59
v_mfma_f32_16x16x32_bf16 a[16:19], a[176:179], v[72:75], a[16:19]
s_add_u32 m0, s3, 135168
v_cvt_pk_bf16_f32 v93, v50, v51
v_cvt_pk_bf16_f32 v94, v52, v53
v_mfma_f32_16x16x32_bf16 a[48:51], a[176:179], v[76:79], a[48:51]
s_add_u32 s48, s51, 165888
v_exp_f32 v60, v60
v_mfma_f32_16x16x32_bf16 a[80:83], a[176:179], v[80:83], a[80:83]
buffer_load_dwordx4 v236, s[16:19], s48 offen lds
v_mfma_f32_16x16x32_bf16 a[112:115], a[176:179], v[84:87], a[112:115]
v_exp_f32 v61, v61
v_mfma_f32_16x16x32_bf16 v[20:23], a[144:147], v[168:171], v[140:143]
ds_read_b64_tr_b16 a[176:177], v224 offset:8192
ds_read_b64_tr_b16 a[178:179], v224 offset:12288
v_mfma_f32_16x16x32_bf16 v[20:23], a[148:151], v[172:175], v[20:23]
s_add_u32 m0, s3, 139264
v_exp_f32 v62, v62
v_mfma_f32_16x16x32_bf16 v[20:23], a[152:155], v[176:179], v[20:23]
s_add_u32 s48, s51, 184320
buffer_load_dwordx4 v236, s[16:19], s48 offen lds
v_mfma_f32_16x16x32_bf16 v[20:23], a[156:159], v[180:183], v[20:23]
v_exp_f32 v63, v63
v_mfma_f32_16x16x32_bf16 a[20:23], a[180:183], v[72:75], a[20:23]
v_cvt_pk_bf16_f32 v95, v54, v55
v_cvt_pk_bf16_f32 v96, v56, v57
v_mfma_f32_16x16x32_bf16 a[52:55], a[180:183], v[76:79], a[52:55]
v_exp_f32 v64, v64
v_mfma_f32_16x16x32_bf16 a[84:87], a[180:183], v[80:83], a[84:87]
s_add_u32 m0, s3, 143360
v_cvt_pk_bf16_f32 v97, v58, v59
v_cvt_pk_bf16_f32 v98, v60, v61
v_mfma_f32_16x16x32_bf16 a[116:119], a[180:183], v[84:87], a[116:119]
s_add_u32 s48, s51, 202752
v_exp_f32 v65, v65
v_smfmac_f32_16x16x64_bf16 a[252:255], a[208:211], v[80:87], v235
buffer_load_dwordx4 v236, s[16:19], s48 offen lds
v_mfma_f32_16x16x32_bf16 v[28:31], a[144:147], v[184:187], v[144:147]
v_exp_f32 v66, v66
v_mfma_f32_16x16x32_bf16 v[28:31], a[148:151], v[188:191], v[28:31]
ds_read_b64_tr_b16 a[180:181], v225 offset:8192
ds_read_b64_tr_b16 a[182:183], v225 offset:12288
v_mfma_f32_16x16x32_bf16 v[28:31], a[152:155], v[192:195], v[28:31]
s_add_u32 m0, s3, 147456
v_exp_f32 v67, v67
v_mfma_f32_16x16x32_bf16 v[28:31], a[156:159], v[196:199], v[28:31]
s_add_u32 s48, s51, 221184
buffer_load_dwordx4 v236, s[16:19], s48 offen lds
v_mfma_f32_16x16x32_bf16 a[24:27], a[184:187], v[72:75], a[24:27]
v_exp_f32 v68, v68
v_mfma_f32_16x16x32_bf16 a[56:59], a[184:187], v[76:79], a[56:59]
v_cvt_pk_bf16_f32 v99, v62, v63
v_cvt_pk_bf16_f32 v100, v64, v65
v_mfma_f32_16x16x32_bf16 a[88:91], a[184:187], v[80:83], a[88:91]
v_exp_f32 v69, v69
v_mfma_f32_16x16x32_bf16 a[120:123], a[184:187], v[84:87], a[120:123]
s_add_u32 m0, s3, 151552
ds_read_b64_tr_b16 a[184:185], v226 offset:8192
ds_read_b64_tr_b16 a[186:187], v226 offset:12288
v_mfma_f32_16x16x32_bf16 v[36:39], a[144:147], v[200:203], v[148:151]
s_add_u32 s48, s51, 239616
v_exp_f32 v70, v70
v_mfma_f32_16x16x32_bf16 v[36:39], a[148:151], v[204:207], v[36:39]
buffer_load_dwordx4 v236, s[16:19], s48 offen lds
v_mfma_f32_16x16x32_bf16 v[36:39], a[152:155], v[208:211], v[36:39]
v_exp_f32 v71, v71
v_mfma_f32_16x16x32_bf16 v[36:39], a[156:159], v[212:215], v[36:39]
ds_read_b128 a[144:147], v216 offset:61440
ds_read_b128 a[148:151], v217 offset:61440
v_mfma_f32_16x16x32_bf16 a[28:31], a[188:191], v[72:75], a[28:31]
ds_read_b128 a[152:155], v218 offset:61440
ds_read_b128 a[156:159], v219 offset:61440
v_mfma_f32_16x16x32_bf16 a[60:63], a[188:191], v[76:79], a[60:63]
v_cvt_pk_bf16_f32 v101, v66, v67
v_cvt_pk_bf16_f32 v102, v68, v69
v_mfma_f32_16x16x32_bf16 a[92:95], a[188:191], v[80:83], a[92:95]
v_cvt_pk_bf16_f32 v103, v70, v71
v_mfma_f32_16x16x32_bf16 a[124:127], a[188:191], v[84:87], a[124:127]
s_waitcnt lgkmcnt(6)
ds_read_b64_tr_b16 a[188:189], v227 offset:8192
ds_read_b64_tr_b16 a[190:191], v227 offset:12288
v_mfma_f32_16x16x32_bf16 v[40:43], a[128:131], v[152:155], v[136:139]
v_exp_f32 v8, v8
v_mfma_f32_16x16x32_bf16 v[40:43], a[132:135], v[156:159], v[40:43]
v_exp_f32 v9, v9
v_mfma_f32_16x16x32_bf16 v[40:43], a[136:139], v[160:163], v[40:43]
v_cvt_pk_bf16_f32 v72, v8, v9
v_mfma_f32_16x16x32_bf16 v[40:43], a[140:143], v[164:167], v[40:43]
v_exp_f32 v10, v10
v_mfma_f32_16x16x32_bf16 a[0:3], a[160:163], v[88:91], a[0:3]
v_mfma_f32_16x16x32_bf16 a[32:35], a[160:163], v[92:95], a[32:35]
v_exp_f32 v11, v11
s_waitcnt lgkmcnt(0)
s_barrier
v_mfma_f32_16x16x32_bf16 a[64:67], a[160:163], v[96:99], a[64:67]
v_cvt_pk_bf16_f32 v73, v10, v11
v_mfma_f32_16x16x32_bf16 a[96:99], a[160:163], v[100:103], a[96:99]
s_add_u32 m0, s3, 155648
v_exp_f32 v12, v12
v_mfma_f32_16x16x32_bf16 v[48:51], a[128:131], v[168:171], v[140:143]
s_add_u32 s48, s51, 258048
buffer_load_dwordx4 v236, s[16:19], s48 offen lds
v_mfma_f32_16x16x32_bf16 v[48:51], a[132:135], v[172:175], v[48:51]
v_exp_f32 v13, v13
v_mfma_f32_16x16x32_bf16 v[48:51], a[136:139], v[176:179], v[48:51]
ds_read_b64_tr_b16 a[160:161], v220 offset:16384
ds_read_b64_tr_b16 a[162:163], v220 offset:20480
v_mfma_f32_16x16x32_bf16 v[48:51], a[140:143], v[180:183], v[48:51]
s_add_u32 m0, s3, 159744
v_exp_f32 v14, v14
v_mfma_f32_16x16x32_bf16 a[4:7], a[164:167], v[88:91], a[4:7]
s_add_u32 s48, s51, 276480
buffer_load_dwordx4 v236, s[16:19], s48 offen lds
v_mfma_f32_16x16x32_bf16 a[36:39], a[164:167], v[92:95], a[36:39]
v_exp_f32 v15, v15
v_mfma_f32_16x16x32_bf16 a[68:71], a[164:167], v[96:99], a[68:71]
v_cvt_pk_bf16_f32 v74, v12, v13
v_cvt_pk_bf16_f32 v75, v14, v15
v_mfma_f32_16x16x32_bf16 a[100:103], a[164:167], v[100:103], a[100:103]
s_add_u32 m0, s3, 32768
v_exp_f32 v16, v16
v_smfmac_f32_16x16x64_bf16 a[248:251], a[208:211], v[88:95], v235
s_add_u32 s48, s42, 0
buffer_load_dwordx4 v236, s[16:19], s48 offen lds
v_mfma_f32_16x16x32_bf16 v[56:59], a[128:131], v[184:187], v[144:147]
v_exp_f32 v17, v17
v_mfma_f32_16x16x32_bf16 v[56:59], a[132:135], v[188:191], v[56:59]
ds_read_b64_tr_b16 a[164:165], v221 offset:16384
ds_read_b64_tr_b16 a[166:167], v221 offset:20480
v_mfma_f32_16x16x32_bf16 v[56:59], a[136:139], v[192:195], v[56:59]
s_add_u32 m0, s3, 36864
v_exp_f32 v18, v18
v_mfma_f32_16x16x32_bf16 v[56:59], a[140:143], v[196:199], v[56:59]
s_add_u32 s48, s42, 18432
buffer_load_dwordx4 v236, s[16:19], s48 offen lds
v_mfma_f32_16x16x32_bf16 a[8:11], a[168:171], v[88:91], a[8:11]
v_exp_f32 v19, v19
v_mfma_f32_16x16x32_bf16 a[40:43], a[168:171], v[92:95], a[40:43]
v_cvt_pk_bf16_f32 v76, v16, v17
v_cvt_pk_bf16_f32 v77, v18, v19
v_mfma_f32_16x16x32_bf16 a[72:75], a[168:171], v[96:99], a[72:75]
v_exp_f32 v20, v20
v_mfma_f32_16x16x32_bf16 a[104:107], a[168:171], v[100:103], a[104:107]
s_add_u32 m0, s3, 40960
ds_read_b64_tr_b16 a[168:169], v222 offset:16384
ds_read_b64_tr_b16 a[170:171], v222 offset:20480
v_mfma_f32_16x16x32_bf16 v[64:67], a[128:131], v[200:203], v[148:151]
s_add_u32 s48, s42, 36864
v_exp_f32 v21, v21
v_mfma_f32_16x16x32_bf16 v[64:67], a[132:135], v[204:207], v[64:67]
buffer_load_dwordx4 v236, s[16:19], s48 offen lds
v_mfma_f32_16x16x32_bf16 v[64:67], a[136:139], v[208:211], v[64:67]
v_exp_f32 v22, v22
v_mfma_f32_16x16x32_bf16 v[64:67], a[140:143], v[212:215], v[64:67]
s_add_u32 m0, s3, 45056
v_cvt_pk_bf16_f32 v78, v20, v21
v_mfma_f32_16x16x32_bf16 a[12:15], a[172:175], v[88:91], a[12:15]
s_add_u32 s48, s42, 55296
v_exp_f32 v23, v23
v_mfma_f32_16x16x32_bf16 a[44:47], a[172:175], v[92:95], a[44:47]
buffer_load_dwordx4 v236, s[16:19], s48 offen lds
v_mfma_f32_16x16x32_bf16 a[76:79], a[172:175], v[96:99], a[76:79]
v_exp_f32 v24, v24
v_mfma_f32_16x16x32_bf16 a[108:111], a[172:175], v[100:103], a[108:111]
s_add_u32 m0, s3, 49152
v_exp_f32 v25, v25
v_mfma_f32_16x16x32_bf16 v[44:47], a[144:147], v[152:155], v[136:139]
s_add_u32 s48, s42, 73728
buffer_load_dwordx4 v236, s[16:19], s48 offen lds
v_mfma_f32_16x16x32_bf16 v[44:47], a[148:151], v[156:159], v[44:47]
v_exp_f32 v26, v26
v_mfma_f32_16x16x32_bf16 v[44:47], a[152:155], v[160:163], v[44:47]
ds_read_b64_tr_b16 a[172:173], v223 offset:16384
ds_read_b64_tr_b16 a[174:175], v223 offset:20480
v_mfma_f32_16x16x32_bf16 v[44:47], a[156:159], v[164:167], v[44:47]
v_exp_f32 v27, v27
v_mfma_f32_16x16x32_bf16 a[16:19], a[176:179], v[88:91], a[16:19]
s_add_u32 m0, s3, 53248
v_cvt_pk_bf16_f32 v79, v22, v23
v_cvt_pk_bf16_f32 v80, v24, v25
v_mfma_f32_16x16x32_bf16 a[48:51], a[176:179], v[92:95], a[48:51]
s_add_u32 s48, s42, 92160
v_exp_f32 v28, v28
v_mfma_f32_16x16x32_bf16 a[80:83], a[176:179], v[96:99], a[80:83]
buffer_load_dwordx4 v236, s[16:19], s48 offen lds
v_mfma_f32_16x16x32_bf16 a[112:115], a[176:179], v[100:103], a[112:115]
v_exp_f32 v29, v29
v_mfma_f32_16x16x32_bf16 v[52:55], a[144:147], v[168:171], v[140:143]
s_add_u32 m0, s3, 57344
ds_read_b64_tr_b16 a[176:177], v224 offset:16384
ds_read_b64_tr_b16 a[178:179], v224 offset:20480
v_mfma_f32_16x16x32_bf16 v[52:55], a[148:151], v[172:175], v[52:55]
s_add_u32 s48, s42, 110592
v_exp_f32 v30, v30
v_mfma_f32_16x16x32_bf16 v[52:55], a[152:155], v[176:179], v[52:55]
buffer_load_dwordx4 v236, s[16:19], s48 offen lds
v_mfma_f32_16x16x32_bf16 v[52:55], a[156:159], v[180:183], v[52:55]
v_exp_f32 v31, v31
v_mfma_f32_16x16x32_bf16 a[20:23], a[180:183], v[88:91], a[20:23]
s_add_u32 m0, s3, 61440
v_cvt_pk_bf16_f32 v81, v26, v27
v_cvt_pk_bf16_f32 v82, v28, v29
v_mfma_f32_16x16x32_bf16 a[52:55], a[180:183], v[92:95], a[52:55]
s_add_u32 s48, s42, 129024
v_exp_f32 v32, v32
v_mfma_f32_16x16x32_bf16 a[84:87], a[180:183], v[96:99], a[84:87]
buffer_load_dwordx4 v236, s[16:19], s48 offen lds
v_mfma_f32_16x16x32_bf16 a[116:119], a[180:183], v[100:103], a[116:119]
v_exp_f32 v33, v33
v_smfmac_f32_16x16x64_bf16 a[252:255], a[208:211], v[96:103], v235
ds_read_b64_tr_b16 a[180:181], v225 offset:16384
ds_read_b64_tr_b16 a[182:183], v225 offset:20480
v_mfma_f32_16x16x32_bf16 v[60:63], a[144:147], v[184:187], v[144:147]
s_add_u32 m0, s3, 65536
v_exp_f32 v34, v34
v_mfma_f32_16x16x32_bf16 v[60:63], a[148:151], v[188:191], v[60:63]
s_add_u32 s48, s43, 0
buffer_load_dwordx4 v236, s[16:19], s48 offen lds
v_mfma_f32_16x16x32_bf16 v[60:63], a[152:155], v[192:195], v[60:63]
v_exp_f32 v35, v35
v_mfma_f32_16x16x32_bf16 v[60:63], a[156:159], v[196:199], v[60:63]
v_cvt_pk_bf16_f32 v83, v30, v31
v_cvt_pk_bf16_f32 v84, v32, v33
v_mfma_f32_16x16x32_bf16 a[24:27], a[184:187], v[88:91], a[24:27]
s_add_u32 m0, s3, 69632
v_exp_f32 v36, v36
v_mfma_f32_16x16x32_bf16 a[56:59], a[184:187], v[92:95], a[56:59]
s_add_u32 s48, s43, 18432
buffer_load_dwordx4 v236, s[16:19], s48 offen lds
v_mfma_f32_16x16x32_bf16 a[88:91], a[184:187], v[96:99], a[88:91]
v_exp_f32 v37, v37
v_mfma_f32_16x16x32_bf16 a[120:123], a[184:187], v[100:103], a[120:123]
ds_read_b64_tr_b16 a[184:185], v226 offset:16384
ds_read_b64_tr_b16 a[186:187], v226 offset:20480
v_mfma_f32_16x16x32_bf16 v[68:71], a[144:147], v[200:203], v[148:151]
s_add_u32 m0, s3, 73728
v_exp_f32 v38, v38
v_mfma_f32_16x16x32_bf16 v[68:71], a[148:151], v[204:207], v[68:71]
s_add_u32 s48, s43, 36864
buffer_load_dwordx4 v236, s[16:19], s48 offen lds
v_mfma_f32_16x16x32_bf16 v[68:71], a[152:155], v[208:211], v[68:71]
v_exp_f32 v39, v39
v_mfma_f32_16x16x32_bf16 v[68:71], a[156:159], v[212:215], v[68:71]
v_cvt_pk_bf16_f32 v85, v34, v35
v_cvt_pk_bf16_f32 v86, v36, v37
v_mfma_f32_16x16x32_bf16 a[28:31], a[188:191], v[88:91], a[28:31]
v_cvt_pk_bf16_f32 v87, v38, v39
v_mfma_f32_16x16x32_bf16 a[60:63], a[188:191], v[92:95], a[60:63]
v_mfma_f32_16x16x32_bf16 a[92:95], a[188:191], v[96:99], a[92:95]
v_mfma_f32_16x16x32_bf16 a[124:127], a[188:191], v[100:103], a[124:127]
ds_read_b64_tr_b16 a[188:189], v227 offset:16384
ds_read_b64_tr_b16 a[190:191], v227 offset:20480
s_waitcnt lgkmcnt(4)
v_mfma_f32_16x16x32_bf16 a[0:3], a[160:163], v[72:75], a[0:3]
v_exp_f32 v40, v40
v_exp_f32 v41, v41
v_mfma_f32_16x16x32_bf16 a[32:35], a[160:163], v[76:79], a[32:35]
v_cvt_pk_bf16_f32 v88, v40, v41
v_exp_f32 v42, v42
v_mfma_f32_16x16x32_bf16 a[64:67], a[160:163], v[80:83], a[64:67]
v_exp_f32 v43, v43
v_mfma_f32_16x16x32_bf16 a[96:99], a[160:163], v[84:87], a[96:99]
ds_read_b64_tr_b16 a[160:161], v220 offset:24576
ds_read_b64_tr_b16 a[162:163], v220 offset:28672
v_exp_f32 v44, v44
v_mfma_f32_16x16x32_bf16 a[4:7], a[164:167], v[72:75], a[4:7]
v_cvt_pk_bf16_f32 v89, v42, v43
v_exp_f32 v45, v45
v_mfma_f32_16x16x32_bf16 a[36:39], a[164:167], v[76:79], a[36:39]
v_cvt_pk_bf16_f32 v90, v44, v45
v_exp_f32 v46, v46
v_mfma_f32_16x16x32_bf16 a[68:71], a[164:167], v[80:83], a[68:71]
v_exp_f32 v47, v47
v_mfma_f32_16x16x32_bf16 a[100:103], a[164:167], v[84:87], a[100:103]
ds_read_b64_tr_b16 a[164:165], v221 offset:24576
ds_read_b64_tr_b16 a[166:167], v221 offset:28672
v_exp_f32 v48, v48
v_smfmac_f32_16x16x64_bf16 a[248:251], a[208:211], v[72:79], v235
v_cvt_pk_bf16_f32 v91, v46, v47
v_exp_f32 v49, v49
v_mfma_f32_16x16x32_bf16 a[8:11], a[168:171], v[72:75], a[8:11]
v_cvt_pk_bf16_f32 v92, v48, v49
v_exp_f32 v50, v50
v_mfma_f32_16x16x32_bf16 a[40:43], a[168:171], v[76:79], a[40:43]
v_exp_f32 v51, v51
v_mfma_f32_16x16x32_bf16 a[72:75], a[168:171], v[80:83], a[72:75]
v_cvt_pk_bf16_f32 v93, v50, v51
v_exp_f32 v52, v52
v_mfma_f32_16x16x32_bf16 a[104:107], a[168:171], v[84:87], a[104:107]
ds_read_b64_tr_b16 a[168:169], v222 offset:24576
ds_read_b64_tr_b16 a[170:171], v222 offset:28672
v_exp_f32 v53, v53
v_mfma_f32_16x16x32_bf16 a[12:15], a[172:175], v[72:75], a[12:15]
v_cvt_pk_bf16_f32 v94, v52, v53
v_exp_f32 v54, v54
v_mfma_f32_16x16x32_bf16 a[44:47], a[172:175], v[76:79], a[44:47]
v_exp_f32 v55, v55
v_mfma_f32_16x16x32_bf16 a[76:79], a[172:175], v[80:83], a[76:79]
v_exp_f32 v56, v56
v_exp_f32 v57, v57
v_mfma_f32_16x16x32_bf16 a[108:111], a[172:175], v[84:87], a[108:111]
ds_read_b64_tr_b16 a[172:173], v223 offset:24576
ds_read_b64_tr_b16 a[174:175], v223 offset:28672
v_exp_f32 v58, v58
v_mfma_f32_16x16x32_bf16 a[16:19], a[176:179], v[72:75], a[16:19]
v_cvt_pk_bf16_f32 v95, v54, v55
v_cvt_pk_bf16_f32 v96, v56, v57
v_exp_f32 v59, v59
v_mfma_f32_16x16x32_bf16 a[48:51], a[176:179], v[76:79], a[48:51]
v_cvt_pk_bf16_f32 v97, v58, v59
v_exp_f32 v60, v60
v_mfma_f32_16x16x32_bf16 a[80:83], a[176:179], v[80:83], a[80:83]
v_exp_f32 v61, v61
v_mfma_f32_16x16x32_bf16 a[112:115], a[176:179], v[84:87], a[112:115]
ds_read_b64_tr_b16 a[176:177], v224 offset:24576
ds_read_b64_tr_b16 a[178:179], v224 offset:28672
v_exp_f32 v62, v62
v_mfma_f32_16x16x32_bf16 a[20:23], a[180:183], v[72:75], a[20:23]
v_cvt_pk_bf16_f32 v98, v60, v61
v_exp_f32 v63, v63
v_mfma_f32_16x16x32_bf16 a[52:55], a[180:183], v[76:79], a[52:55]
v_cvt_pk_bf16_f32 v99, v62, v63
v_exp_f32 v64, v64
v_mfma_f32_16x16x32_bf16 a[84:87], a[180:183], v[80:83], a[84:87]
v_exp_f32 v65, v65
v_mfma_f32_16x16x32_bf16 a[116:119], a[180:183], v[84:87], a[116:119]
ds_read_b64_tr_b16 a[180:181], v225 offset:24576
ds_read_b64_tr_b16 a[182:183], v225 offset:28672
v_exp_f32 v66, v66
v_smfmac_f32_16x16x64_bf16 a[252:255], a[208:211], v[80:87], v235
s_waitcnt lgkmcnt(6)
v_cvt_pk_bf16_f32 v100, v64, v65
v_exp_f32 v67, v67
v_mfma_f32_16x16x32_bf16 a[24:27], a[184:187], v[72:75], a[24:27]
v_cvt_pk_bf16_f32 v101, v66, v67
v_exp_f32 v68, v68
v_mfma_f32_16x16x32_bf16 a[56:59], a[184:187], v[76:79], a[56:59]
v_exp_f32 v69, v69
v_mfma_f32_16x16x32_bf16 a[88:91], a[184:187], v[80:83], a[88:91]
v_cvt_pk_bf16_f32 v102, v68, v69
v_exp_f32 v70, v70
v_mfma_f32_16x16x32_bf16 a[120:123], a[184:187], v[84:87], a[120:123]
ds_read_b64_tr_b16 a[184:185], v226 offset:24576
ds_read_b64_tr_b16 a[186:187], v226 offset:28672
v_exp_f32 v71, v71
v_mfma_f32_16x16x32_bf16 a[28:31], a[188:191], v[72:75], a[28:31]
v_cvt_pk_bf16_f32 v103, v70, v71
v_mfma_f32_16x16x32_bf16 a[60:63], a[188:191], v[76:79], a[60:63]
v_mfma_f32_16x16x32_bf16 a[92:95], a[188:191], v[80:83], a[92:95]
v_mfma_f32_16x16x32_bf16 a[124:127], a[188:191], v[84:87], a[124:127]
ds_read_b64_tr_b16 a[188:189], v227 offset:24576
ds_read_b64_tr_b16 a[190:191], v227 offset:28672
v_smfmac_f32_16x16x64_bf16 a[248:251], a[208:211], v[88:95], v235
s_lshl_b32 s46, s32, 2
v_and_b32 v138, 3, v1
v_smfmac_f32_16x16x64_bf16 a[252:255], a[208:211], v[96:103], v235
s_add_u32 s46, s46, 77824
v_lshlrev_b32 v138, 10, v138
v_mfma_f32_16x16x32_bf16 a[0:3], a[160:163], v[88:91], a[0:3]
s_add_u32 s47, s3, 77824
v_add_u32 v138, s46, v138
v_mfma_f32_16x16x32_bf16 a[4:7], a[164:167], v[88:91], a[4:7]
v_mov_b32 v139, s47
v_mfma_f32_16x16x32_bf16 a[8:11], a[168:171], v[88:91], a[8:11]
s_nop 0
s_nop 0
s_waitcnt lgkmcnt(4)
v_mfma_f32_16x16x32_bf16 a[12:15], a[172:175], v[88:91], a[12:15]
v_accvgpr_read_b32 v104, a248
v_accvgpr_read_b32 v105, a249
v_mfma_f32_16x16x32_bf16 a[16:19], a[176:179], v[88:91], a[16:19]
v_accvgpr_read_b32 v106, a250
v_accvgpr_read_b32 v107, a251
v_mfma_f32_16x16x32_bf16 a[20:23], a[180:183], v[88:91], a[20:23]
v_accvgpr_read_b32 v108, a252
v_accvgpr_read_b32 v109, a253
s_waitcnt lgkmcnt(2)
v_mfma_f32_16x16x32_bf16 a[24:27], a[184:187], v[88:91], a[24:27]
v_accvgpr_read_b32 v110, a254
v_accvgpr_read_b32 v111, a255
s_waitcnt lgkmcnt(0)
v_mfma_f32_16x16x32_bf16 a[28:31], a[188:191], v[88:91], a[28:31]
v_add_f32 v104, v104, v105
v_add_f32 v106, v106, v107
v_mfma_f32_16x16x32_bf16 a[32:35], a[160:163], v[92:95], a[32:35]
v_add_f32 v108, v108, v109
v_add_f32 v110, v110, v111
v_mfma_f32_16x16x32_bf16 a[36:39], a[164:167], v[92:95], a[36:39]
v_max3_f32 v136, v104, v106, v108
v_add_f32 v137, v104, v106
v_mfma_f32_16x16x32_bf16 a[40:43], a[168:171], v[92:95], a[40:43]
v_max_f32 v136, v136, v110
v_add_f32 v137, v137, v108
v_mfma_f32_16x16x32_bf16 a[44:47], a[172:175], v[92:95], a[44:47]
v_cmp_nge_f32 vcc, 0x5f800000, v136
v_add_f32 v137, v137, v110
v_mfma_f32_16x16x32_bf16 a[48:51], a[176:179], v[92:95], a[48:51]
v_cmp_u_f32 s[94:95], v137, v137
v_mfma_f32_16x16x32_bf16 a[52:55], a[180:183], v[92:95], a[52:55]
v_mfma_f32_16x16x32_bf16 a[56:59], a[184:187], v[92:95], a[56:59]
v_mfma_f32_16x16x32_bf16 a[60:63], a[188:191], v[92:95], a[60:63]
s_or_b64 vcc, vcc, s[94:95]
s_cmp_lg_u64 vcc, 0
s_cselect_b32 s48, 1, 0
v_mov_b32 v136, s48
ds_write_b32 v138, v136
s_cmp_lg_u32 s52, 0
s_cbranch_scc1 K_YRA
K_YRAD:
v_rcp_f32 v104, v104
v_rcp_f32 v106, v106
v_rcp_f32 v108, v108
v_rcp_f32 v110, v110
s_waitcnt vmcnt(0) lgkmcnt(0)
s_barrier
ds_read_b128 v[140:143], v139
v_mfma_f32_16x16x32_bf16 a[64:67], a[160:163], v[96:99], a[64:67]
v_accvgpr_read_b32 v40, a0
v_accvgpr_read_b32 v41, a1
v_mfma_f32_16x16x32_bf16 a[68:71], a[164:167], v[96:99], a[68:71]
v_accvgpr_read_b32 v42, a2
v_accvgpr_read_b32 v43, a3
v_mfma_f32_16x16x32_bf16 a[72:75], a[168:171], v[96:99], a[72:75]
v_accvgpr_read_b32 v44, a4
v_accvgpr_read_b32 v45, a5
v_mfma_f32_16x16x32_bf16 a[76:79], a[172:175], v[96:99], a[76:79]
v_accvgpr_read_b32 v46, a6
v_accvgpr_read_b32 v47, a7
v_mfma_f32_16x16x32_bf16 a[80:83], a[176:179], v[96:99], a[80:83]
v_accvgpr_read_b32 v48, a8
v_accvgpr_read_b32 v49, a9
v_mfma_f32_16x16x32_bf16 a[84:87], a[180:183], v[96:99], a[84:87]
v_accvgpr_read_b32 v50, a10
v_accvgpr_read_b32 v51, a11
v_mfma_f32_16x16x32_bf16 a[88:91], a[184:187], v[96:99], a[88:91]
v_accvgpr_read_b32 v52, a12
v_accvgpr_read_b32 v53, a13
v_mfma_f32_16x16x32_bf16 a[92:95], a[188:191], v[96:99], a[92:95]
v_accvgpr_read_b32 v54, a14
v_accvgpr_read_b32 v55, a15
v_mfma_f32_16x16x32_bf16 a[96:99], a[160:163], v[100:103], a[96:99]
v_accvgpr_read_b32 v56, a16
v_accvgpr_read_b32 v57, a17
v_mfma_f32_16x16x32_bf16 a[100:103], a[164:167], v[100:103], a[100:103]
v_accvgpr_read_b32 v58, a18
v_accvgpr_read_b32 v59, a19
v_mfma_f32_16x16x32_bf16 a[104:107], a[168:171], v[100:103], a[104:107]
v_accvgpr_read_b32 v60, a20
v_accvgpr_read_b32 v61, a21
v_mfma_f32_16x16x32_bf16 a[108:111], a[172:175], v[100:103], a[108:111]
v_accvgpr_read_b32 v62, a22
v_accvgpr_read_b32 v63, a23
v_mfma_f32_16x16x32_bf16 a[112:115], a[176:179], v[100:103], a[112:115]
v_accvgpr_read_b32 v64, a24
v_accvgpr_read_b32 v65, a25
v_mfma_f32_16x16x32_bf16 a[116:119], a[180:183], v[100:103], a[116:119]
v_accvgpr_read_b32 v66, a26
v_accvgpr_read_b32 v67, a27
v_mfma_f32_16x16x32_bf16 a[120:123], a[184:187], v[100:103], a[120:123]
v_accvgpr_read_b32 v68, a28
v_accvgpr_read_b32 v69, a29
v_mfma_f32_16x16x32_bf16 a[124:127], a[188:191], v[100:103], a[124:127]
v_accvgpr_read_b32 v70, a30
v_accvgpr_read_b32 v71, a31
v_pk_mul_f32 v[40:41], v[40:41], v[104:105] op_sel_hi:[1,0]
v_pk_mul_f32 v[42:43], v[42:43], v[104:105] op_sel_hi:[1,0]
v_pk_mul_f32 v[44:45], v[44:45], v[104:105] op_sel_hi:[1,0]
v_pk_mul_f32 v[46:47], v[46:47], v[104:105] op_sel_hi:[1,0]
v_cvt_pk_bf16_f32 v8, v40, v41
v_cvt_pk_bf16_f32 v9, v42, v43
v_cvt_pk_bf16_f32 v10, v44, v45
v_cvt_pk_bf16_f32 v11, v46, v47
s_add_u32 s94, s53, 0
buffer_store_dwordx4 v[8:11], v234, s[20:23], s94 offen offset:0 sc0 sc1
v_pk_mul_f32 v[48:49], v[48:49], v[104:105] op_sel_hi:[1,0]
v_pk_mul_f32 v[50:51], v[50:51], v[104:105] op_sel_hi:[1,0]
v_pk_mul_f32 v[52:53], v[52:53], v[104:105] op_sel_hi:[1,0]
v_pk_mul_f32 v[54:55], v[54:55], v[104:105] op_sel_hi:[1,0]
v_cvt_pk_bf16_f32 v16, v48, v49
v_cvt_pk_bf16_f32 v17, v50, v51
v_cvt_pk_bf16_f32 v18, v52, v53
v_cvt_pk_bf16_f32 v19, v54, v55
s_add_u32 s94, s53, 0
buffer_store_dwordx4 v[16:19], v234, s[20:23], s94 offen offset:2048 sc0 sc1
v_pk_mul_f32 v[56:57], v[56:57], v[104:105] op_sel_hi:[1,0]
v_pk_mul_f32 v[58:59], v[58:59], v[104:105] op_sel_hi:[1,0]
v_pk_mul_f32 v[60:61], v[60:61], v[104:105] op_sel_hi:[1,0]
v_pk_mul_f32 v[62:63], v[62:63], v[104:105] op_sel_hi:[1,0]
v_cvt_pk_bf16_f32 v24, v56, v57
v_cvt_pk_bf16_f32 v25, v58, v59
v_cvt_pk_bf16_f32 v26, v60, v61
v_cvt_pk_bf16_f32 v27, v62, v63
s_add_u32 s94, s53, 4096
buffer_store_dwordx4 v[24:27], v234, s[20:23], s94 offen offset:0 sc0 sc1
v_pk_mul_f32 v[64:65], v[64:65], v[104:105] op_sel_hi:[1,0]
v_pk_mul_f32 v[66:67], v[66:67], v[104:105] op_sel_hi:[1,0]
v_pk_mul_f32 v[68:69], v[68:69], v[104:105] op_sel_hi:[1,0]
v_pk_mul_f32 v[70:71], v[70:71], v[104:105] op_sel_hi:[1,0]
v_cvt_pk_bf16_f32 v32, v64, v65
v_cvt_pk_bf16_f32 v33, v66, v67
v_cvt_pk_bf16_f32 v34, v68, v69
v_cvt_pk_bf16_f32 v35, v70, v71
s_add_u32 s94, s53, 4096
buffer_store_dwordx4 v[32:35], v234, s[20:23], s94 offen offset:2048 sc0 sc1
v_accvgpr_read_b32 v72, a32
v_accvgpr_read_b32 v73, a33
v_accvgpr_read_b32 v74, a34
v_accvgpr_read_b32 v75, a35
v_accvgpr_read_b32 v76, a36
v_accvgpr_read_b32 v77, a37
v_accvgpr_read_b32 v78, a38
v_accvgpr_read_b32 v79, a39
v_accvgpr_read_b32 v80, a40
v_accvgpr_read_b32 v81, a41
v_accvgpr_read_b32 v82, a42
v_accvgpr_read_b32 v83, a43
v_accvgpr_read_b32 v84, a44
v_accvgpr_read_b32 v85, a45
v_accvgpr_read_b32 v86, a46
v_accvgpr_read_b32 v87, a47
v_accvgpr_read_b32 v88, a48
v_accvgpr_read_b32 v89, a49
v_accvgpr_read_b32 v90, a50
v_accvgpr_read_b32 v91, a51
v_accvgpr_read_b32 v92, a52
v_accvgpr_read_b32 v93, a53
v_accvgpr_read_b32 v94, a54
v_accvgpr_read_b32 v95, a55
v_accvgpr_read_b32 v96, a56
v_accvgpr_read_b32 v97, a57
v_accvgpr_read_b32 v98, a58
v_accvgpr_read_b32 v99, a59
v_accvgpr_read_b32 v100, a60
v_accvgpr_read_b32 v101, a61
v_accvgpr_read_b32 v102, a62
v_accvgpr_read_b32 v103, a63
v_pk_mul_f32 v[72:73], v[72:73], v[106:107] op_sel_hi:[1,0]
v_pk_mul_f32 v[74:75], v[74:75], v[106:107] op_sel_hi:[1,0]
v_pk_mul_f32 v[76:77], v[76:77], v[106:107] op_sel_hi:[1,0]
v_pk_mul_f32 v[78:79], v[78:79], v[106:107] op_sel_hi:[1,0]
v_cvt_pk_bf16_f32 v12, v72, v73
v_cvt_pk_bf16_f32 v13, v74, v75
v_cvt_pk_bf16_f32 v14, v76, v77
v_cvt_pk_bf16_f32 v15, v78, v79
s_add_u32 s94, s53, 0
buffer_store_dwordx4 v[12:15], v234, s[20:23], s94 offen offset:1024 sc0 sc1
v_pk_mul_f32 v[80:81], v[80:81], v[106:107] op_sel_hi:[1,0]
v_pk_mul_f32 v[82:83], v[82:83], v[106:107] op_sel_hi:[1,0]
v_pk_mul_f32 v[84:85], v[84:85], v[106:107] op_sel_hi:[1,0]
v_pk_mul_f32 v[86:87], v[86:87], v[106:107] op_sel_hi:[1,0]
v_cvt_pk_bf16_f32 v20, v80, v81
v_cvt_pk_bf16_f32 v21, v82, v83
v_cvt_pk_bf16_f32 v22, v84, v85
v_cvt_pk_bf16_f32 v23, v86, v87
s_add_u32 s94, s53, 0
buffer_store_dwordx4 v[20:23], v234, s[20:23], s94 offen offset:3072 sc0 sc1
v_pk_mul_f32 v[88:89], v[88:89], v[106:107] op_sel_hi:[1,0]
v_pk_mul_f32 v[90:91], v[90:91], v[106:107] op_sel_hi:[1,0]
v_pk_mul_f32 v[92:93], v[92:93], v[106:107] op_sel_hi:[1,0]
v_pk_mul_f32 v[94:95], v[94:95], v[106:107] op_sel_hi:[1,0]
v_cvt_pk_bf16_f32 v28, v88, v89
v_cvt_pk_bf16_f32 v29, v90, v91
v_cvt_pk_bf16_f32 v30, v92, v93
v_cvt_pk_bf16_f32 v31, v94, v95
s_add_u32 s94, s53, 4096
buffer_store_dwordx4 v[28:31], v234, s[20:23], s94 offen offset:1024 sc0 sc1
v_pk_mul_f32 v[96:97], v[96:97], v[106:107] op_sel_hi:[1,0]
v_pk_mul_f32 v[98:99], v[98:99], v[106:107] op_sel_hi:[1,0]
v_pk_mul_f32 v[100:101], v[100:101], v[106:107] op_sel_hi:[1,0]
v_pk_mul_f32 v[102:103], v[102:103], v[106:107] op_sel_hi:[1,0]
v_cvt_pk_bf16_f32 v36, v96, v97
v_cvt_pk_bf16_f32 v37, v98, v99
v_cvt_pk_bf16_f32 v38, v100, v101
v_cvt_pk_bf16_f32 v39, v102, v103
s_add_u32 s94, s53, 4096
buffer_store_dwordx4 v[36:39], v234, s[20:23], s94 offen offset:3072 sc0 sc1
s_waitcnt lgkmcnt(0)
v_or3_b32 v140, v140, v141, v142
v_or_b32 v140, v140, v143
s_nop 0
v_readfirstlane_b32 s46, v140
s_andn2_b32 s46, s46, s41
s_cbranch_scc1 K_FB
s_cmp_lg_u32 s83, 0
s_cbranch_scc1 K_YR1
K_YR1D:
v_accvgpr_read_b32 v120, a236
v_accvgpr_read_b32 v121, a237
v_accvgpr_read_b32 v122, a238
v_accvgpr_read_b32 v123, a239
v_accvgpr_read_b32 v124, a240
v_accvgpr_read_b32 v125, a241
v_accvgpr_read_b32 v126, a242
v_accvgpr_read_b32 v127, a243
v_accvgpr_read_b32 v128, a244
v_accvgpr_read_b32 v129, a245
v_accvgpr_read_b32 v130, a246
v_accvgpr_read_b32 v131, a247
v_xor_b32 v220, s82, v220
v_xor_b32 v221, s82, v221
v_xor_b32 v222, s82, v222
v_xor_b32 v223, s82, v223
v_xor_b32 v224, s82, v224
v_xor_b32 v225, s82, v225
v_xor_b32 v226, s82, v226
v_xor_b32 v227, s82, v227
v_bfe_u32 v5, v1, 2, 2
v_lshl_add_u32 v5, v4, 2, v5
v_bfe_u32 v6, v5, 1, 2
v_lshlrev_b32 v6, 5, v6
v_lshl_add_u32 v6, v5, 7, v6
v_and_b32 v5, 3, v1
v_lshl_add_u32 v216, v5, 3, v6
v_xor_b32 v217, 32, v216
v_xor_b32 v218, 64, v216
v_xor_b32 v219, 96, v216
ds_read_b64_tr_b16 a[192:193], v220 offset:32768
ds_read_b64_tr_b16 a[194:195], v220 offset:36864
ds_read_b64_tr_b16 a[196:197], v221 offset:32768
ds_read_b64_tr_b16 a[198:199], v221 offset:36864
ds_read_b64_tr_b16 a[200:201], v222 offset:32768
ds_read_b64_tr_b16 a[202:203], v222 offset:36864
ds_read_b64_tr_b16 a[204:205], v223 offset:32768
ds_read_b64_tr_b16 a[206:207], v223 offset:36864
ds_read_b64_tr_b16 a[208:209], v224 offset:32768
ds_read_b64_tr_b16 a[210:211], v224 offset:36864
ds_read_b64_tr_b16 a[212:213], v225 offset:32768
ds_read_b64_tr_b16 a[214:215], v225 offset:36864
ds_read_b64_tr_b16 a[216:217], v226 offset:32768
ds_read_b64_tr_b16 a[218:219], v226 offset:36864
ds_read_b64_tr_b16 a[220:221], v227 offset:32768
ds_read_b64_tr_b16 a[222:223], v227 offset:36864
ds_read_b64_tr_b16 a[224:225], v216 offset:0
ds_read_b64_tr_b16 a[226:227], v216 offset:2048
ds_read_b64_tr_b16 a[228:229], v217 offset:0
ds_read_b64_tr_b16 a[230:231], v217 offset:2048
ds_read_b64_tr_b16 a[232:233], v218 offset:0
ds_read_b64_tr_b16 a[234:235], v218 offset:2048
ds_read_b64_tr_b16 a[236:237], v219 offset:0
ds_read_b64_tr_b16 a[238:239], v219 offset:2048
v_accvgpr_read_b32 v112, a64
v_accvgpr_read_b32 v113, a65
v_accvgpr_read_b32 v114, a66
v_accvgpr_read_b32 v115, a67
v_accvgpr_read_b32 v116, a68
v_accvgpr_read_b32 v117, a69
v_accvgpr_read_b32 v118, a70
v_accvgpr_read_b32 v119, a71
v_pk_mul_f32 v[112:113], v[112:113], v[108:109] op_sel_hi:[1,0]
v_pk_mul_f32 v[114:115], v[114:115], v[108:109] op_sel_hi:[1,0]
v_pk_mul_f32 v[116:117], v[116:117], v[108:109] op_sel_hi:[1,0]
v_pk_mul_f32 v[118:119], v[118:119], v[108:109] op_sel_hi:[1,0]
v_cvt_pk_bf16_f32 v40, v112, v113
v_cvt_pk_bf16_f32 v41, v114, v115
v_cvt_pk_bf16_f32 v42, v116, v117
v_cvt_pk_bf16_f32 v43, v118, v119
v_accvgpr_read_b32 v112, a96
v_accvgpr_read_b32 v113, a97
v_accvgpr_read_b32 v114, a98
v_accvgpr_read_b32 v115, a99
v_accvgpr_read_b32 v116, a100
v_accvgpr_read_b32 v117, a101
v_accvgpr_read_b32 v118, a102
v_accvgpr_read_b32 v119, a103
v_pk_mul_f32 v[112:113], v[112:113], v[110:111] op_sel_hi:[1,0]
v_pk_mul_f32 v[114:115], v[114:115], v[110:111] op_sel_hi:[1,0]
v_pk_mul_f32 v[116:117], v[116:117], v[110:111] op_sel_hi:[1,0]
v_pk_mul_f32 v[118:119], v[118:119], v[110:111] op_sel_hi:[1,0]
v_cvt_pk_bf16_f32 v44, v112, v113
v_cvt_pk_bf16_f32 v45, v114, v115
v_cvt_pk_bf16_f32 v46, v116, v117
v_cvt_pk_bf16_f32 v47, v118, v119
v_accvgpr_read_b32 v112, a72
v_accvgpr_read_b32 v113, a73
v_accvgpr_read_b32 v114, a74
v_accvgpr_read_b32 v115, a75
v_accvgpr_read_b32 v116, a76
v_accvgpr_read_b32 v117, a77
v_accvgpr_read_b32 v118, a78
v_accvgpr_read_b32 v119, a79
v_pk_mul_f32 v[112:113], v[112:113], v[108:109] op_sel_hi:[1,0]
v_pk_mul_f32 v[114:115], v[114:115], v[108:109] op_sel_hi:[1,0]
v_pk_mul_f32 v[116:117], v[116:117], v[108:109] op_sel_hi:[1,0]
v_pk_mul_f32 v[118:119], v[118:119], v[108:109] op_sel_hi:[1,0]
v_cvt_pk_bf16_f32 v48, v112, v113
v_cvt_pk_bf16_f32 v49, v114, v115
v_cvt_pk_bf16_f32 v50, v116, v117
v_cvt_pk_bf16_f32 v51, v118, v119
v_accvgpr_read_b32 v112, a104
v_accvgpr_read_b32 v113, a105
v_accvgpr_read_b32 v114, a106
v_accvgpr_read_b32 v115, a107
v_accvgpr_read_b32 v116, a108
v_accvgpr_read_b32 v117, a109
v_accvgpr_read_b32 v118, a110
v_accvgpr_read_b32 v119, a111
v_pk_mul_f32 v[112:113], v[112:113], v[110:111] op_sel_hi:[1,0]
v_pk_mul_f32 v[114:115], v[114:115], v[110:111] op_sel_hi:[1,0]
v_pk_mul_f32 v[116:117], v[116:117], v[110:111] op_sel_hi:[1,0]
v_pk_mul_f32 v[118:119], v[118:119], v[110:111] op_sel_hi:[1,0]
v_cvt_pk_bf16_f32 v52, v112, v113
v_cvt_pk_bf16_f32 v53, v114, v115
v_cvt_pk_bf16_f32 v54, v116, v117
v_cvt_pk_bf16_f32 v55, v118, v119
v_accvgpr_read_b32 v112, a80
v_accvgpr_read_b32 v113, a81
v_accvgpr_read_b32 v114, a82
v_accvgpr_read_b32 v115, a83
v_accvgpr_read_b32 v116, a84
v_accvgpr_read_b32 v117, a85
v_accvgpr_read_b32 v118, a86
v_accvgpr_read_b32 v119, a87
v_pk_mul_f32 v[112:113], v[112:113], v[108:109] op_sel_hi:[1,0]
v_pk_mul_f32 v[114:115], v[114:115], v[108:109] op_sel_hi:[1,0]
v_pk_mul_f32 v[116:117], v[116:117], v[108:109] op_sel_hi:[1,0]
v_pk_mul_f32 v[118:119], v[118:119], v[108:109] op_sel_hi:[1,0]
v_cvt_pk_bf16_f32 v56, v112, v113
v_cvt_pk_bf16_f32 v57, v114, v115
v_cvt_pk_bf16_f32 v58, v116, v117
v_cvt_pk_bf16_f32 v59, v118, v119
v_accvgpr_read_b32 v112, a112
v_accvgpr_read_b32 v113, a113
v_accvgpr_read_b32 v114, a114
v_accvgpr_read_b32 v115, a115
v_accvgpr_read_b32 v116, a116
v_accvgpr_read_b32 v117, a117
v_accvgpr_read_b32 v118, a118
v_accvgpr_read_b32 v119, a119
v_pk_mul_f32 v[112:113], v[112:113], v[110:111] op_sel_hi:[1,0]
v_pk_mul_f32 v[114:115], v[114:115], v[110:111] op_sel_hi:[1,0]
v_pk_mul_f32 v[116:117], v[116:117], v[110:111] op_sel_hi:[1,0]
v_pk_mul_f32 v[118:119], v[118:119], v[110:111] op_sel_hi:[1,0]
v_cvt_pk_bf16_f32 v60, v112, v113
v_cvt_pk_bf16_f32 v61, v114, v115
v_cvt_pk_bf16_f32 v62, v116, v117
v_cvt_pk_bf16_f32 v63, v118, v119
v_accvgpr_read_b32 v112, a88
v_accvgpr_read_b32 v113, a89
v_accvgpr_read_b32 v114, a90
v_accvgpr_read_b32 v115, a91
v_accvgpr_read_b32 v116, a92
v_accvgpr_read_b32 v117, a93
v_accvgpr_read_b32 v118, a94
v_accvgpr_read_b32 v119, a95
v_pk_mul_f32 v[112:113], v[112:113], v[108:109] op_sel_hi:[1,0]
v_pk_mul_f32 v[114:115], v[114:115], v[108:109] op_sel_hi:[1,0]
v_pk_mul_f32 v[116:117], v[116:117], v[108:109] op_sel_hi:[1,0]
v_pk_mul_f32 v[118:119], v[118:119], v[108:109] op_sel_hi:[1,0]
v_cvt_pk_bf16_f32 v64, v112, v113
v_cvt_pk_bf16_f32 v65, v114, v115
v_cvt_pk_bf16_f32 v66, v116, v117
v_cvt_pk_bf16_f32 v67, v118, v119
v_accvgpr_read_b32 v112, a120
v_accvgpr_read_b32 v113, a121
v_accvgpr_read_b32 v114, a122
v_accvgpr_read_b32 v115, a123
v_accvgpr_read_b32 v116, a124
v_accvgpr_read_b32 v117, a125
v_accvgpr_read_b32 v118, a126
v_accvgpr_read_b32 v119, a127
v_pk_mul_f32 v[112:113], v[112:113], v[110:111] op_sel_hi:[1,0]
v_pk_mul_f32 v[114:115], v[114:115], v[110:111] op_sel_hi:[1,0]
v_pk_mul_f32 v[116:117], v[116:117], v[110:111] op_sel_hi:[1,0]
v_pk_mul_f32 v[118:119], v[118:119], v[110:111] op_sel_hi:[1,0]
v_cvt_pk_bf16_f32 v68, v112, v113
v_cvt_pk_bf16_f32 v69, v114, v115
v_cvt_pk_bf16_f32 v70, v116, v117
v_cvt_pk_bf16_f32 v71, v118, v119
s_lshl_b32 s95, s36, 3
v_mov_b32 v5, 1
v_and_b32 v6, 7, v1
s_add_u32 s95, s95, s54
v_lshlrev_b32 v6, 2, v6
v_lshlrev_b32 v250, 3, v1
s_waitcnt lgkmcnt(15)
v_mfma_f32_16x16x32_bf16 v[136:139], a[192:195], v[8:11], 0
s_add_u32 s67, s36, 1
v_add_u32 v208, 0x10000, v220
v_add_u32 v209, 0x10000, v221
v_mfma_f32_16x16x32_bf16 v[168:171], a[192:195], v[12:15], 0
s_and_b32 s67, s67, 3
ds_read_b64_tr_b16 a[192:193], v220 offset:40960
ds_read_b64_tr_b16 a[194:195], v220 offset:45056
v_mfma_f32_16x16x32_bf16 v[140:143], a[196:199], v[8:11], 0
s_sub_u32 s67, s67, s36
v_add_u32 v210, 0x10000, v222
v_add_u32 v211, 0x10000, v223
v_mfma_f32_16x16x32_bf16 v[172:175], a[196:199], v[12:15], 0
s_lshl_b32 s67, s67, 16
ds_read_b64_tr_b16 a[196:197], v221 offset:40960
ds_read_b64_tr_b16 a[198:199], v221 offset:45056
v_mfma_f32_16x16x32_bf16 v[144:147], a[200:203], v[8:11], 0
s_add_u32 s90, s53, s67
v_add_u32 v212, 0x10000, v224
v_add_u32 v213, 0x10000, v225
v_mfma_f32_16x16x32_bf16 v[176:179], a[200:203], v[12:15], 0
s_add_u32 s67, s36, 2
ds_read_b64_tr_b16 a[200:201], v222 offset:40960
ds_read_b64_tr_b16 a[202:203], v222 offset:45056
v_mfma_f32_16x16x32_bf16 v[148:151], a[204:207], v[8:11], 0
s_add_u32 m0, s3, 77824
v_add_u32 v214, 0x10000, v226
v_add_u32 v215, 0x10000, v227
v_mfma_f32_16x16x32_bf16 v[180:183], a[204:207], v[12:15], 0
s_waitcnt lgkmcnt(15)
s_add_u32 s48, s43, 55296
ds_read_b64_tr_b16 a[204:205], v223 offset:40960
ds_read_b64_tr_b16 a[206:207], v223 offset:45056
v_mfma_f32_16x16x32_bf16 v[152:155], a[208:211], v[8:11], 0
s_and_b32 s67, s67, 3
buffer_load_dwordx4 v236, s[16:19], s48 offen lds
v_mfma_f32_16x16x32_bf16 v[184:187], a[208:211], v[12:15], 0
s_sub_u32 s67, s67, s36
ds_read_b64_tr_b16 a[208:209], v224 offset:40960
ds_read_b64_tr_b16 a[210:211], v224 offset:45056
v_mfma_f32_16x16x32_bf16 v[156:159], a[212:215], v[8:11], 0
s_add_u32 m0, s3, 81920
v_subrev_u32 v200, 0x10000, v220
v_subrev_u32 v201, 0x10000, v221
v_mfma_f32_16x16x32_bf16 v[188:191], a[212:215], v[12:15], 0
s_add_u32 s48, s43, 73728
ds_read_b64_tr_b16 a[212:213], v225 offset:40960
ds_read_b64_tr_b16 a[214:215], v225 offset:45056
v_mfma_f32_16x16x32_bf16 v[160:163], a[216:219], v[8:11], 0
s_lshl_b32 s67, s67, 16
buffer_load_dwordx4 v236, s[16:19], s48 offen lds
v_mfma_f32_16x16x32_bf16 v[192:195], a[216:219], v[12:15], 0
s_waitcnt lgkmcnt(8)
s_add_u32 s91, s53, s67
ds_read_b64_tr_b16 a[216:217], v226 offset:40960
ds_read_b64_tr_b16 a[218:219], v226 offset:45056
v_mfma_f32_16x16x32_bf16 v[164:167], a[220:223], v[8:11], 0
s_add_u32 m0, s3, 86016
v_subrev_u32 v202, 0x10000, v222
v_subrev_u32 v203, 0x10000, v223
v_mfma_f32_16x16x32_bf16 v[196:199], a[220:223], v[12:15], 0
s_add_u32 s48, s43, 92160
ds_read_b64_tr_b16 a[220:221], v227 offset:40960
ds_read_b64_tr_b16 a[222:223], v227 offset:45056
v_mfma_f32_16x16x32_bf16 v[72:75], a[224:227], v[8:11], 0
s_add_u32 s67, s36, 3
buffer_load_dwordx4 v236, s[16:19], s48 offen lds
v_mfma_f32_16x16x32_bf16 v[88:91], a[224:227], v[12:15], 0
s_and_b32 s67, s67, 3
ds_read_b64_tr_b16 a[224:225], v216 offset:4096
ds_read_b64_tr_b16 a[226:227], v216 offset:6144
v_mfma_f32_16x16x32_bf16 v[76:79], a[228:231], v[8:11], 0
s_add_u32 m0, s3, 90112
v_subrev_u32 v204, 0x10000, v224
v_subrev_u32 v205, 0x10000, v225
v_mfma_f32_16x16x32_bf16 v[92:95], a[228:231], v[12:15], 0
s_add_u32 s48, s43, 110592
ds_read_b64_tr_b16 a[228:229], v217 offset:4096
ds_read_b64_tr_b16 a[230:231], v217 offset:6144
v_mfma_f32_16x16x32_bf16 v[80:83], a[232:235], v[8:11], 0
s_sub_u32 s67, s67, s36
buffer_load_dwordx4 v236, s[16:19], s48 offen lds
v_mfma_f32_16x16x32_bf16 v[96:99], a[232:235], v[12:15], 0
ds_read_b64_tr_b16 a[232:233], v218 offset:4096
ds_read_b64_tr_b16 a[234:235], v218 offset:6144
v_mfma_f32_16x16x32_bf16 v[84:87], a[236:239], v[8:11], 0
v_subrev_u32 v206, 0x10000, v226
v_mfma_f32_16x16x32_bf16 v[100:103], a[236:239], v[12:15], 0
ds_read_b64_tr_b16 a[236:237], v219 offset:4096
ds_read_b64_tr_b16 a[238:239], v219 offset:6144
s_waitcnt vmcnt(4)
s_mov_b64 exec, 1
buffer_store_dword v5, v234, s[20:23], s95 offen offset:0 sc0 sc1
s_mov_b64 exec, -1
v_mfma_f32_16x16x32_bf16 v[136:139], a[192:195], v[16:19], v[136:139]
s_add_u32 m0, s3, 94208
v_subrev_u32 v207, 0x10000, v227
v_mfma_f32_16x16x32_bf16 v[168:171], a[192:195], v[20:23], v[168:171]
s_add_u32 s48, s43, 129024
ds_read_b64_tr_b16 a[192:193], v220 offset:49152
ds_read_b64_tr_b16 a[194:195], v220 offset:53248
v_mfma_f32_16x16x32_bf16 v[140:143], a[196:199], v[16:19], v[140:143]
s_lshl_b32 s67, s67, 16
buffer_load_dwordx4 v236, s[16:19], s48 offen lds
v_mfma_f32_16x16x32_bf16 v[172:175], a[196:199], v[20:23], v[172:175]
s_waitcnt lgkmcnt(8)
s_add_u32 s92, s53, s67
ds_read_b64_tr_b16 a[196:197], v221 offset:49152
ds_read_b64_tr_b16 a[198:199], v221 offset:53248
v_mfma_f32_16x16x32_bf16 v[144:147], a[200:203], v[16:19], v[144:147]
s_lshl_b32 s67, s34, 2
v_mfma_f32_16x16x32_bf16 v[176:179], a[200:203], v[20:23], v[176:179]
s_add_u32 s94, s53, 8192
ds_read_b64_tr_b16 a[200:201], v222 offset:49152
ds_read_b64_tr_b16 a[202:203], v222 offset:53248
v_mfma_f32_16x16x32_bf16 v[148:151], a[204:207], v[16:19], v[148:151]
s_add_u32 s67, s67, s32
buffer_store_dwordx4 v[40:43], v234, s[20:23], s94 offen offset:0 sc0 sc1
v_mfma_f32_16x16x32_bf16 v[180:183], a[204:207], v[20:23], v[180:183]
s_lshl_b32 s86, s67, 7
ds_read_b64_tr_b16 a[204:205], v223 offset:49152
ds_read_b64_tr_b16 a[206:207], v223 offset:53248
v_mfma_f32_16x16x32_bf16 v[152:155], a[208:211], v[16:19], v[152:155]
s_add_u32 s86, s86, 0x260000
v_mfma_f32_16x16x32_bf16 v[184:187], a[208:211], v[20:23], v[184:187]
s_lshl_b32 s67, s67, 1
ds_read_b64_tr_b16 a[208:209], v224 offset:49152
ds_read_b64_tr_b16 a[210:211], v224 offset:53248
v_mfma_f32_16x16x32_bf16 v[156:159], a[212:215], v[16:19], v[156:159]
s_lshr_b32 s47, s35, 1
v_mfma_f32_16x16x32_bf16 v[188:191], a[212:215], v[20:23], v[188:191]
s_add_u32 s67, s67, s47
ds_read_b64_tr_b16 a[212:213], v225 offset:49152
ds_read_b64_tr_b16 a[214:215], v225 offset:53248
v_mfma_f32_16x16x32_bf16 v[160:163], a[216:219], v[16:19], v[160:163]
s_lshl_b32 s87, s67, 15
v_mfma_f32_16x16x32_bf16 v[192:195], a[216:219], v[20:23], v[192:195]
s_add_u32 s87, s87, 0x2000000
ds_read_b64_tr_b16 a[216:217], v226 offset:49152
ds_read_b64_tr_b16 a[218:219], v226 offset:53248
v_mfma_f32_16x16x32_bf16 v[164:167], a[220:223], v[16:19], v[164:167]
s_lshl_b32 s67, s33, 9
v_mfma_f32_16x16x32_bf16 v[196:199], a[220:223], v[20:23], v[196:199]
s_add_u32 s88, s87, s67
ds_read_b64_tr_b16 a[220:221], v227 offset:49152
ds_read_b64_tr_b16 a[222:223], v227 offset:53248
v_mfma_f32_16x16x32_bf16 v[72:75], a[224:227], v[16:19], v[72:75]
s_xor_b32 s89, s88, 0x8000
v_mfma_f32_16x16x32_bf16 v[88:91], a[224:227], v[20:23], v[88:91]
s_waitcnt lgkmcnt(8)
s_add_u32 s94, s53, 8192
ds_read_b64_tr_b16 a[224:225], v216 offset:8192
ds_read_b64_tr_b16 a[226:227], v216 offset:10240
v_mfma_f32_16x16x32_bf16 v[76:79], a[228:231], v[16:19], v[76:79]
s_lshl_b32 s47, s34, 2
buffer_store_dwordx4 v[44:47], v234, s[20:23], s94 offen offset:1024 sc0 sc1
v_mfma_f32_16x16x32_bf16 v[92:95], a[228:231], v[20:23], v[92:95]
s_add_u32 s47, s47, s36
ds_read_b64_tr_b16 a[228:229], v217 offset:8192
ds_read_b64_tr_b16 a[230:231], v217 offset:10240
v_mfma_f32_16x16x32_bf16 v[80:83], a[232:235], v[16:19], v[80:83]
s_lshl_b32 s63, s47, 2
v_mfma_f32_16x16x32_bf16 v[96:99], a[232:235], v[20:23], v[96:99]
ds_read_b64_tr_b16 a[232:233], v218 offset:8192
ds_read_b64_tr_b16 a[234:235], v218 offset:10240
v_mfma_f32_16x16x32_bf16 v[84:87], a[236:239], v[16:19], v[84:87]
v_mfma_f32_16x16x32_bf16 v[100:103], a[236:239], v[20:23], v[100:103]
ds_read_b64_tr_b16 a[236:237], v219 offset:8192
ds_read_b64_tr_b16 a[238:239], v219 offset:10240
v_mfma_f32_16x16x32_bf16 v[136:139], a[192:195], v[24:27], v[136:139]
s_add_u32 s63, s63, s32
v_mfma_f32_16x16x32_bf16 v[168:171], a[192:195], v[28:31], v[168:171]
s_lshl_b32 s63, s63, 9
ds_read_b64_tr_b16 a[192:193], v220 offset:57344
ds_read_b64_tr_b16 a[194:195], v220 offset:61440
v_mfma_f32_16x16x32_bf16 v[140:143], a[196:199], v[24:27], v[140:143]
s_add_u32 s63, s63, 0x280000
v_mfma_f32_16x16x32_bf16 v[172:175], a[196:199], v[28:31], v[172:175]
s_lshl_b32 s47, s47, 6
ds_read_b64_tr_b16 a[196:197], v221 offset:57344
ds_read_b64_tr_b16 a[198:199], v221 offset:61440
v_mfma_f32_16x16x32_bf16 v[144:147], a[200:203], v[24:27], v[144:147]
s_add_u32 s47, s47, s32
v_mfma_f32_16x16x32_bf16 v[176:179], a[200:203], v[28:31], v[176:179]
s_add_u32 s94, s53, 8192
ds_read_b64_tr_b16 a[200:201], v222 offset:57344
ds_read_b64_tr_b16 a[202:203], v222 offset:61440
v_mfma_f32_16x16x32_bf16 v[148:151], a[204:207], v[24:27], v[148:151]
s_lshl_b32 s47, s47, 11
buffer_store_dwordx4 v[48:51], v234, s[20:23], s94 offen offset:2048 sc0 sc1
v_mfma_f32_16x16x32_bf16 v[180:183], a[204:207], v[28:31], v[180:183]
s_waitcnt lgkmcnt(8)
s_mul_i32 s67, s35, 40960
ds_read_b64_tr_b16 a[204:205], v223 offset:57344
ds_read_b64_tr_b16 a[206:207], v223 offset:61440
v_mfma_f32_16x16x32_bf16 v[152:155], a[208:211], v[24:27], v[152:155]
s_add_u32 s67, s67, s47
v_mfma_f32_16x16x32_bf16 v[184:187], a[208:211], v[28:31], v[184:187]
s_add_u32 s67, s67, 0x1400000
ds_read_b64_tr_b16 a[208:209], v224 offset:57344
ds_read_b64_tr_b16 a[210:211], v224 offset:61440
v_mfma_f32_16x16x32_bf16 v[156:159], a[212:215], v[24:27], v[156:159]
s_mov_b32 s57, 0xbfb8aa3b
v_mfma_f32_16x16x32_bf16 v[188:191], a[212:215], v[28:31], v[188:191]
s_mov_b32 s56, 0xffff0000
ds_read_b64_tr_b16 a[212:213], v225 offset:57344
ds_read_b64_tr_b16 a[214:215], v225 offset:61440
v_mfma_f32_16x16x32_bf16 v[160:163], a[216:219], v[24:27], v[160:163]
s_mov_b32 s58, 0x00003f80
v_mfma_f32_16x16x32_bf16 v[192:195], a[216:219], v[28:31], v[192:195]
s_mov_b32 s59, 0x3f800000
ds_read_b64_tr_b16 a[216:217], v226 offset:57344
ds_read_b64_tr_b16 a[218:219], v226 offset:61440
v_mfma_f32_16x16x32_bf16 v[164:167], a[220:223], v[24:27], v[164:167]
s_lshl_b32 s47, s36, 13
v_mfma_f32_16x16x32_bf16 v[196:199], a[220:223], v[28:31], v[196:199]
s_add_u32 s87, s87, s47
ds_read_b64_tr_b16 a[220:221], v227 offset:57344
ds_read_b64_tr_b16 a[222:223], v227 offset:61440
v_mfma_f32_16x16x32_bf16 v[72:75], a[224:227], v[24:27], v[72:75]
s_mov_b32 s38, 15
v_mfma_f32_16x16x32_bf16 v[88:91], a[224:227], v[28:31], v[88:91]
s_add_u32 s94, s53, 8192
ds_read_b64_tr_b16 a[224:225], v216 offset:12288
ds_read_b64_tr_b16 a[226:227], v216 offset:14336
v_mfma_f32_16x16x32_bf16 v[76:79], a[228:231], v[24:27], v[76:79]
s_bitset0_b32 s38, s35
buffer_store_dwordx4 v[52:55], v234, s[20:23], s94 offen offset:3072 sc0 sc1
v_mfma_f32_16x16x32_bf16 v[92:95], a[228:231], v[28:31], v[92:95]
s_xor_b32 s60, s67, 8192
ds_read_b64_tr_b16 a[228:229], v217 offset:12288
ds_read_b64_tr_b16 a[230:231], v217 offset:14336
v_mfma_f32_16x16x32_bf16 v[80:83], a[232:235], v[24:27], v[80:83]
s_xor_b32 s64, s67, 32768
v_mfma_f32_16x16x32_bf16 v[96:99], a[232:235], v[28:31], v[96:99]
s_waitcnt lgkmcnt(8)
ds_read_b64_tr_b16 a[232:233], v218 offset:12288
ds_read_b64_tr_b16 a[234:235], v218 offset:14336
v_mfma_f32_16x16x32_bf16 v[84:87], a[236:239], v[24:27], v[84:87]
v_mfma_f32_16x16x32_bf16 v[100:103], a[236:239], v[28:31], v[100:103]
ds_read_b64_tr_b16 a[236:237], v219 offset:12288
ds_read_b64_tr_b16 a[238:239], v219 offset:14336
v_mfma_f32_16x16x32_bf16 v[136:139], a[192:195], v[32:35], v[136:139]
v_mfma_f32_16x16x32_bf16 v[168:171], a[192:195], v[36:39], v[168:171]
v_mfma_f32_16x16x32_bf16 v[140:143], a[196:199], v[32:35], v[140:143]
v_mfma_f32_16x16x32_bf16 v[172:175], a[196:199], v[36:39], v[172:175]
v_mfma_f32_16x16x32_bf16 v[144:147], a[200:203], v[32:35], v[144:147]
s_waitcnt lgkmcnt(0)
s_barrier
v_mfma_f32_16x16x32_bf16 v[176:179], a[200:203], v[36:39], v[176:179]
s_xor_b32 s61, s67, 16384
ds_read_b64_tr_b16 a[192:193], v208 offset:0
ds_read_b64_tr_b16 a[194:195], v208 offset:4096
v_mfma_f32_16x16x32_bf16 v[148:151], a[204:207], v[32:35], v[148:151]
s_add_u32 s94, s53, 12288
ds_read_b64_tr_b16 a[196:197], v209 offset:0
ds_read_b64_tr_b16 a[198:199], v209 offset:4096
v_mfma_f32_16x16x32_bf16 v[180:183], a[204:207], v[36:39], v[180:183]
s_xor_b32 s65, s67, 65536
buffer_store_dwordx4 v[56:59], v234, s[20:23], s94 offen offset:0 sc0 sc1
v_mfma_f32_16x16x32_bf16 v[152:155], a[208:211], v[32:35], v[152:155]
s_xor_b32 s62, s67, 24576
ds_read_b64_tr_b16 a[200:201], v210 offset:0
ds_read_b64_tr_b16 a[202:203], v210 offset:4096
v_mfma_f32_16x16x32_bf16 v[184:187], a[208:211], v[36:39], v[184:187]
s_xor_b32 s66, s67, 98304
ds_read_b64_tr_b16 a[204:205], v211 offset:0
ds_read_b64_tr_b16 a[206:207], v211 offset:4096
v_mfma_f32_16x16x32_bf16 v[156:159], a[212:215], v[32:35], v[156:159]
ds_read_b64_tr_b16 a[208:209], v212 offset:0
ds_read_b64_tr_b16 a[210:211], v212 offset:4096
v_mfma_f32_16x16x32_bf16 v[188:191], a[212:215], v[36:39], v[188:191]
ds_read_b64_tr_b16 a[212:213], v213 offset:0
ds_read_b64_tr_b16 a[214:215], v213 offset:4096
v_mfma_f32_16x16x32_bf16 v[160:163], a[216:219], v[32:35], v[160:163]
v_mfma_f32_16x16x32_bf16 v[192:195], a[216:219], v[36:39], v[192:195]
ds_read_b64_tr_b16 a[216:217], v214 offset:0
ds_read_b64_tr_b16 a[218:219], v214 offset:4096
v_mfma_f32_16x16x32_bf16 v[164:167], a[220:223], v[32:35], v[164:167]
v_mfma_f32_16x16x32_bf16 v[196:199], a[220:223], v[36:39], v[196:199]
ds_read_b64_tr_b16 a[220:221], v215 offset:0
ds_read_b64_tr_b16 a[222:223], v215 offset:4096
v_mfma_f32_16x16x32_bf16 v[72:75], a[224:227], v[32:35], v[72:75]
v_mfma_f32_16x16x32_bf16 v[88:91], a[224:227], v[36:39], v[88:91]
ds_read_b64_tr_b16 a[224:225], v216 offset:16384
ds_read_b64_tr_b16 a[226:227], v216 offset:18432
v_mfma_f32_16x16x32_bf16 v[76:79], a[228:231], v[32:35], v[76:79]
s_add_u32 s94, s53, 12288
v_mfma_f32_16x16x32_bf16 v[92:95], a[228:231], v[36:39], v[92:95]
buffer_store_dwordx4 v[60:63], v234, s[20:23], s94 offen offset:1024 sc0 sc1
v_mfma_f32_16x16x32_bf16 v[80:83], a[232:235], v[32:35], v[80:83]
ds_read_b64_tr_b16 a[228:229], v217 offset:16384
ds_read_b64_tr_b16 a[230:231], v217 offset:18432
v_mfma_f32_16x16x32_bf16 v[96:99], a[232:235], v[36:39], v[96:99]
ds_read_b64_tr_b16 a[232:233], v218 offset:16384
ds_read_b64_tr_b16 a[234:235], v218 offset:18432
v_mfma_f32_16x16x32_bf16 v[84:87], a[236:239], v[32:35], v[84:87]
v_mfma_f32_16x16x32_bf16 v[100:103], a[236:239], v[36:39], v[100:103]
s_waitcnt lgkmcnt(8)
ds_read_b64_tr_b16 a[236:237], v219 offset:16384
ds_read_b64_tr_b16 a[238:239], v219 offset:18432
buffer_load_dword v246, v6, s[20:23], s54 offen sc0 sc1
v_mfma_f32_16x16x32_bf16 v[136:139], a[192:195], v[40:43], v[136:139]
v_mfma_f32_16x16x32_bf16 v[168:171], a[192:195], v[44:47], v[168:171]
ds_read_b64_tr_b16 a[192:193], v208 offset:8192
ds_read_b64_tr_b16 a[194:195], v208 offset:12288
v_mfma_f32_16x16x32_bf16 v[140:143], a[196:199], v[40:43], v[140:143]
v_mfma_f32_16x16x32_bf16 v[172:175], a[196:199], v[44:47], v[172:175]
ds_read_b64_tr_b16 a[196:197], v209 offset:8192
ds_read_b64_tr_b16 a[198:199], v209 offset:12288
v_mfma_f32_16x16x32_bf16 v[144:147], a[200:203], v[40:43], v[144:147]
v_mfma_f32_16x16x32_bf16 v[176:179], a[200:203], v[44:47], v[176:179]
ds_read_b64_tr_b16 a[200:201], v210 offset:8192
ds_read_b64_tr_b16 a[202:203], v210 offset:12288
v_mfma_f32_16x16x32_bf16 v[148:151], a[204:207], v[40:43], v[148:151]
s_add_u32 s94, s53, 12288
v_mfma_f32_16x16x32_bf16 v[180:183], a[204:207], v[44:47], v[180:183]
buffer_store_dwordx4 v[64:67], v234, s[20:23], s94 offen offset:2048 sc0 sc1
v_mfma_f32_16x16x32_bf16 v[152:155], a[208:211], v[40:43], v[152:155]
ds_read_b64_tr_b16 a[204:205], v211 offset:8192
ds_read_b64_tr_b16 a[206:207], v211 offset:12288
v_mfma_f32_16x16x32_bf16 v[184:187], a[208:211], v[44:47], v[184:187]
ds_read_b64_tr_b16 a[208:209], v212 offset:8192
ds_read_b64_tr_b16 a[210:211], v212 offset:12288
v_mfma_f32_16x16x32_bf16 v[156:159], a[212:215], v[40:43], v[156:159]
v_mfma_f32_16x16x32_bf16 v[188:191], a[212:215], v[44:47], v[188:191]
ds_read_b64_tr_b16 a[212:213], v213 offset:8192
ds_read_b64_tr_b16 a[214:215], v213 offset:12288
v_mfma_f32_16x16x32_bf16 v[160:163], a[216:219], v[40:43], v[160:163]
v_mfma_f32_16x16x32_bf16 v[192:195], a[216:219], v[44:47], v[192:195]
s_waitcnt lgkmcnt(8)
ds_read_b64_tr_b16 a[216:217], v214 offset:8192
ds_read_b64_tr_b16 a[218:219], v214 offset:12288
v_mfma_f32_16x16x32_bf16 v[164:167], a[220:223], v[40:43], v[164:167]
v_mfma_f32_16x16x32_bf16 v[196:199], a[220:223], v[44:47], v[196:199]
ds_read_b64_tr_b16 a[220:221], v215 offset:8192
ds_read_b64_tr_b16 a[222:223], v215 offset:12288
v_mfma_f32_16x16x32_bf16 v[72:75], a[224:227], v[40:43], v[72:75]
v_mfma_f32_16x16x32_bf16 v[88:91], a[224:227], v[44:47], v[88:91]
ds_read_b64_tr_b16 a[224:225], v216 offset:20480
ds_read_b64_tr_b16 a[226:227], v216 offset:22528
v_mfma_f32_16x16x32_bf16 v[76:79], a[228:231], v[40:43], v[76:79]
s_add_u32 s94, s53, 12288
v_mfma_f32_16x16x32_bf16 v[92:95], a[228:231], v[44:47], v[92:95]
buffer_store_dwordx4 v[68:71], v234, s[20:23], s94 offen offset:3072 sc0 sc1
v_mfma_f32_16x16x32_bf16 v[80:83], a[232:235], v[40:43], v[80:83]
ds_read_b64_tr_b16 a[228:229], v217 offset:20480
ds_read_b64_tr_b16 a[230:231], v217 offset:22528
v_mfma_f32_16x16x32_bf16 v[96:99], a[232:235], v[44:47], v[96:99]
ds_read_b64_tr_b16 a[232:233], v218 offset:20480
ds_read_b64_tr_b16 a[234:235], v218 offset:22528
v_mfma_f32_16x16x32_bf16 v[84:87], a[236:239], v[40:43], v[84:87]
v_mfma_f32_16x16x32_bf16 v[100:103], a[236:239], v[44:47], v[100:103]
ds_read_b64_tr_b16 a[236:237], v219 offset:20480
ds_read_b64_tr_b16 a[238:239], v219 offset:22528
v_mfma_f32_16x16x32_bf16 v[136:139], a[192:195], v[48:51], v[136:139]
v_mfma_f32_16x16x32_bf16 v[168:171], a[192:195], v[52:55], v[168:171]
ds_read_b64_tr_b16 a[192:193], v208 offset:16384
ds_read_b64_tr_b16 a[194:195], v208 offset:20480
v_mfma_f32_16x16x32_bf16 v[140:143], a[196:199], v[48:51], v[140:143]
v_mfma_f32_16x16x32_bf16 v[172:175], a[196:199], v[52:55], v[172:175]
s_waitcnt lgkmcnt(8)
ds_read_b64_tr_b16 a[196:197], v209 offset:16384
ds_read_b64_tr_b16 a[198:199], v209 offset:20480
v_mfma_f32_16x16x32_bf16 v[144:147], a[200:203], v[48:51], v[144:147]
v_mfma_f32_16x16x32_bf16 v[176:179], a[200:203], v[52:55], v[176:179]
s_add_u32 m0, s3, 98304
ds_read_b64_tr_b16 a[200:201], v210 offset:16384
ds_read_b64_tr_b16 a[202:203], v210 offset:20480
v_mfma_f32_16x16x32_bf16 v[148:151], a[204:207], v[48:51], v[148:151]
s_add_u32 s48, s44, 0
v_mfma_f32_16x16x32_bf16 v[180:183], a[204:207], v[52:55], v[180:183]
buffer_load_dwordx4 v236, s[16:19], s48 offen lds
v_mfma_f32_16x16x32_bf16 v[152:155], a[208:211], v[48:51], v[152:155]
ds_read_b64_tr_b16 a[204:205], v211 offset:16384
ds_read_b64_tr_b16 a[206:207], v211 offset:20480
v_mfma_f32_16x16x32_bf16 v[184:187], a[208:211], v[52:55], v[184:187]
s_add_u32 m0, s3, 102400
ds_read_b64_tr_b16 a[208:209], v212 offset:16384
ds_read_b64_tr_b16 a[210:211], v212 offset:20480
v_mfma_f32_16x16x32_bf16 v[156:159], a[212:215], v[48:51], v[156:159]
s_add_u32 s48, s44, 18432
v_mfma_f32_16x16x32_bf16 v[188:191], a[212:215], v[52:55], v[188:191]
buffer_load_dwordx4 v236, s[16:19], s48 offen lds
v_mfma_f32_16x16x32_bf16 v[160:163], a[216:219], v[48:51], v[160:163]
ds_read_b64_tr_b16 a[212:213], v213 offset:16384
ds_read_b64_tr_b16 a[214:215], v213 offset:20480
v_mfma_f32_16x16x32_bf16 v[192:195], a[216:219], v[52:55], v[192:195]
s_add_u32 m0, s3, 106496
ds_read_b64_tr_b16 a[216:217], v214 offset:16384
ds_read_b64_tr_b16 a[218:219], v214 offset:20480
v_mfma_f32_16x16x32_bf16 v[164:167], a[220:223], v[48:51], v[164:167]
s_add_u32 s48, s44, 36864
v_mfma_f32_16x16x32_bf16 v[196:199], a[220:223], v[52:55], v[196:199]
buffer_load_dwordx4 v236, s[16:19], s48 offen lds
v_mfma_f32_16x16x32_bf16 v[72:75], a[224:227], v[48:51], v[72:75]
s_waitcnt lgkmcnt(8)
ds_read_b64_tr_b16 a[220:221], v215 offset:16384
ds_read_b64_tr_b16 a[222:223], v215 offset:20480
v_mfma_f32_16x16x32_bf16 v[88:91], a[224:227], v[52:55], v[88:91]
s_add_u32 m0, s3, 110592
ds_read_b64_tr_b16 a[224:225], v216 offset:24576
ds_read_b64_tr_b16 a[226:227], v216 offset:26624
v_mfma_f32_16x16x32_bf16 v[76:79], a[228:231], v[48:51], v[76:79]
s_add_u32 s48, s44, 55296
v_mfma_f32_16x16x32_bf16 v[92:95], a[228:231], v[52:55], v[92:95]
buffer_load_dwordx4 v236, s[16:19], s48 offen lds
v_mfma_f32_16x16x32_bf16 v[80:83], a[232:235], v[48:51], v[80:83]
ds_read_b64_tr_b16 a[228:229], v217 offset:24576
ds_read_b64_tr_b16 a[230:231], v217 offset:26624
v_mfma_f32_16x16x32_bf16 v[96:99], a[232:235], v[52:55], v[96:99]
ds_read_b64_tr_b16 a[232:233], v218 offset:24576
ds_read_b64_tr_b16 a[234:235], v218 offset:26624
v_mfma_f32_16x16x32_bf16 v[84:87], a[236:239], v[48:51], v[84:87]
v_mfma_f32_16x16x32_bf16 v[100:103], a[236:239], v[52:55], v[100:103]
ds_read_b64_tr_b16 a[236:237], v219 offset:24576
ds_read_b64_tr_b16 a[238:239], v219 offset:26624
v_rcp_f32 v132, v131
s_waitcnt vmcnt(6)
v_cmp_ne_u32 vcc, 1, v246
s_and_b32 s46, vcc_lo, 85
s_cbranch_scc0 K_F0_OK
K_F0:
s_sleep 1
s_add_u32 s100, s100, 1
s_bitcmp1_b32 s100, 19
s_cbranch_scc1 K_END
buffer_load_dword v246, v6, s[20:23], s54 offen sc0 sc1
s_waitcnt vmcnt(0)
v_cmp_ne_u32 vcc, 1, v246
s_and_b32 s46, vcc_lo, 85
s_cbranch_scc1 K_F0
K_F0_OK:
v_mfma_f32_16x16x32_bf16 v[136:139], a[192:195], v[56:59], v[136:139]
s_add_u32 s94, s90, 0
v_mfma_f32_16x16x32_bf16 v[168:171], a[192:195], v[60:63], v[168:171]
buffer_load_dwordx4 a[0:3], v234, s[20:23], s94 offen offset:0 sc0 sc1
v_mfma_f32_16x16x32_bf16 v[140:143], a[196:199], v[56:59], v[140:143]
ds_read_b64_tr_b16 a[192:193], v208 offset:24576
ds_read_b64_tr_b16 a[194:195], v208 offset:28672
v_mfma_f32_16x16x32_bf16 v[172:175], a[196:199], v[60:63], v[172:175]
s_add_u32 s94, s90, 0
ds_read_b64_tr_b16 a[196:197], v209 offset:24576
ds_read_b64_tr_b16 a[198:199], v209 offset:28672
v_mfma_f32_16x16x32_bf16 v[144:147], a[200:203], v[56:59], v[144:147]
buffer_load_dwordx4 a[4:7], v234, s[20:23], s94 offen offset:1024 sc0 sc1
v_mfma_f32_16x16x32_bf16 v[176:179], a[200:203], v[60:63], v[176:179]
s_waitcnt lgkmcnt(10)
ds_read_b64_tr_b16 a[200:201], v210 offset:24576
ds_read_b64_tr_b16 a[202:203], v210 offset:28672
v_mfma_f32_16x16x32_bf16 v[148:151], a[204:207], v[56:59], v[148:151]
s_add_u32 s94, s90, 0
v_mfma_f32_16x16x32_bf16 v[180:183], a[204:207], v[60:63], v[180:183]
buffer_load_dwordx4 a[8:11], v234, s[20:23], s94 offen offset:2048 sc0 sc1
v_mfma_f32_16x16x32_bf16 v[152:155], a[208:211], v[56:59], v[152:155]
ds_read_b64_tr_b16 a[204:205], v211 offset:24576
ds_read_b64_tr_b16 a[206:207], v211 offset:28672
v_mfma_f32_16x16x32_bf16 v[184:187], a[208:211], v[60:63], v[184:187]
s_add_u32 s94, s90, 0
ds_read_b64_tr_b16 a[208:209], v212 offset:24576
ds_read_b64_tr_b16 a[210:211], v212 offset:28672
v_mfma_f32_16x16x32_bf16 v[156:159], a[212:215], v[56:59], v[156:159]
buffer_load_dwordx4 a[12:15], v234, s[20:23], s94 offen offset:3072 sc0 sc1
v_mfma_f32_16x16x32_bf16 v[188:191], a[212:215], v[60:63], v[188:191]
ds_read_b64_tr_b16 a[212:213], v213 offset:24576
ds_read_b64_tr_b16 a[214:215], v213 offset:28672
v_mfma_f32_16x16x32_bf16 v[160:163], a[216:219], v[56:59], v[160:163]
s_add_u32 s94, s90, 4096
v_mfma_f32_16x16x32_bf16 v[192:195], a[216:219], v[60:63], v[192:195]
buffer_load_dwordx4 a[16:19], v234, s[20:23], s94 offen offset:0 sc0 sc1
v_mfma_f32_16x16x32_bf16 v[164:167], a[220:223], v[56:59], v[164:167]
ds_read_b64_tr_b16 a[216:217], v214 offset:24576
ds_read_b64_tr_b16 a[218:219], v214 offset:28672
v_mfma_f32_16x16x32_bf16 v[196:199], a[220:223], v[60:63], v[196:199]
s_add_u32 s94, s90, 4096
ds_read_b64_tr_b16 a[220:221], v215 offset:24576
ds_read_b64_tr_b16 a[222:223], v215 offset:28672
v_mfma_f32_16x16x32_bf16 v[72:75], a[224:227], v[56:59], v[72:75]
buffer_load_dwordx4 a[20:23], v234, s[20:23], s94 offen offset:1024 sc0 sc1
v_mfma_f32_16x16x32_bf16 v[88:91], a[224:227], v[60:63], v[88:91]
s_waitcnt lgkmcnt(10)
ds_read_b64_tr_b16 a[224:225], v216 offset:28672
ds_read_b64_tr_b16 a[226:227], v216 offset:30720
v_mfma_f32_16x16x32_bf16 v[76:79], a[228:231], v[56:59], v[76:79]
s_add_u32 s94, s90, 4096
v_mfma_f32_16x16x32_bf16 v[92:95], a[228:231], v[60:63], v[92:95]
buffer_load_dwordx4 a[24:27], v234, s[20:23], s94 offen offset:2048 sc0 sc1
v_mfma_f32_16x16x32_bf16 v[80:83], a[232:235], v[56:59], v[80:83]
ds_read_b64_tr_b16 a[228:229], v217 offset:28672
ds_read_b64_tr_b16 a[230:231], v217 offset:30720
v_mfma_f32_16x16x32_bf16 v[96:99], a[232:235], v[60:63], v[96:99]
s_add_u32 s94, s90, 4096
ds_read_b64_tr_b16 a[232:233], v218 offset:28672
ds_read_b64_tr_b16 a[234:235], v218 offset:30720
v_mfma_f32_16x16x32_bf16 v[84:87], a[236:239], v[56:59], v[84:87]
buffer_load_dwordx4 a[28:31], v234, s[20:23], s94 offen offset:3072 sc0 sc1
v_mfma_f32_16x16x32_bf16 v[100:103], a[236:239], v[60:63], v[100:103]
ds_read_b64_tr_b16 a[236:237], v219 offset:28672
ds_read_b64_tr_b16 a[238:239], v219 offset:30720
s_waitcnt vmcnt(12)
s_mov_b64 exec, 1
buffer_store_dword v5, v234, s[20:23], s95 offen offset:4 sc0 sc1
s_mov_b64 exec, -1
v_mfma_f32_16x16x32_bf16 v[136:139], a[192:195], v[64:67], v[136:139]
v_mfma_f32_16x16x32_bf16 v[168:171], a[192:195], v[68:71], v[168:171]
v_mfma_f32_16x16x32_bf16 v[140:143], a[196:199], v[64:67], v[140:143]
v_mfma_f32_16x16x32_bf16 v[172:175], a[196:199], v[68:71], v[172:175]
v_mfma_f32_16x16x32_bf16 v[144:147], a[200:203], v[64:67], v[144:147]
s_waitcnt vmcnt(22) lgkmcnt(0)
s_barrier
v_mfma_f32_16x16x32_bf16 v[176:179], a[200:203], v[68:71], v[176:179]
ds_read_b64_tr_b16 a[192:193], v200 offset:32768
ds_read_b64_tr_b16 a[194:195], v200 offset:36864
v_mfma_f32_16x16x32_bf16 v[148:151], a[204:207], v[64:67], v[148:151]
s_add_u32 s94, s91, 0
ds_read_b64_tr_b16 a[196:197], v201 offset:32768
ds_read_b64_tr_b16 a[198:199], v201 offset:36864
v_mfma_f32_16x16x32_bf16 v[180:183], a[204:207], v[68:71], v[180:183]
buffer_load_dwordx4 a[32:35], v234, s[20:23], s94 offen offset:0 sc0 sc1
v_mfma_f32_16x16x32_bf16 v[152:155], a[208:211], v[64:67], v[152:155]
ds_read_b64_tr_b16 a[200:201], v202 offset:32768
ds_read_b64_tr_b16 a[202:203], v202 offset:36864
v_mfma_f32_16x16x32_bf16 v[184:187], a[208:211], v[68:71], v[184:187]
ds_read_b64_tr_b16 a[204:205], v203 offset:32768
ds_read_b64_tr_b16 a[206:207], v203 offset:36864
v_mfma_f32_16x16x32_bf16 v[156:159], a[212:215], v[64:67], v[156:159]
s_add_u32 s94, s91, 0
ds_read_b64_tr_b16 a[208:209], v204 offset:32768
ds_read_b64_tr_b16 a[210:211], v204 offset:36864
v_mfma_f32_16x16x32_bf16 v[188:191], a[212:215], v[68:71], v[188:191]
buffer_load_dwordx4 a[36:39], v234, s[20:23], s94 offen offset:1024 sc0 sc1
v_mfma_f32_16x16x32_bf16 v[160:163], a[216:219], v[64:67], v[160:163]
ds_read_b64_tr_b16 a[212:213], v205 offset:32768
ds_read_b64_tr_b16 a[214:215], v205 offset:36864
v_mfma_f32_16x16x32_bf16 v[192:195], a[216:219], v[68:71], v[192:195]
ds_read_b64_tr_b16 a[216:217], v206 offset:32768
ds_read_b64_tr_b16 a[218:219], v206 offset:36864
v_mfma_f32_16x16x32_bf16 v[164:167], a[220:223], v[64:67], v[164:167]
s_add_u32 s94, s91, 0
v_mfma_f32_16x16x32_bf16 v[196:199], a[220:223], v[68:71], v[196:199]
buffer_load_dwordx4 a[40:43], v234, s[20:23], s94 offen offset:2048 sc0 sc1
v_mfma_f32_16x16x32_bf16 v[72:75], a[224:227], v[64:67], v[72:75]
ds_read_b64_tr_b16 a[220:221], v207 offset:32768
ds_read_b64_tr_b16 a[222:223], v207 offset:36864
v_mfma_f32_16x16x32_bf16 v[88:91], a[224:227], v[68:71], v[88:91]
v_mfma_f32_16x16x32_bf16 v[76:79], a[228:231], v[64:67], v[76:79]
s_add_u32 s94, s91, 0
v_mfma_f32_16x16x32_bf16 v[92:95], a[228:231], v[68:71], v[92:95]
buffer_load_dwordx4 a[44:47], v234, s[20:23], s94 offen offset:3072 sc0 sc1
v_mfma_f32_16x16x32_bf16 v[80:83], a[232:235], v[64:67], v[80:83]
v_mfma_f32_16x16x32_bf16 v[96:99], a[232:235], v[68:71], v[96:99]
v_mfma_f32_16x16x32_bf16 v[84:87], a[236:239], v[64:67], v[84:87]
v_mfma_f32_16x16x32_bf16 v[100:103], a[236:239], v[68:71], v[100:103]
s_waitcnt lgkmcnt(2)
s_cmp_lg_u32 s83, 0
s_cbranch_scc1 K_YR2
K_YR2D:
s_waitcnt vmcnt(5)
v_mfma_f32_16x16x32_bf16 v[136:139], a[192:195], a[0:3], v[136:139]
s_add_u32 s94, s91, 4096
v_mfma_f32_16x16x32_bf16 v[168:171], a[192:195], a[4:7], v[168:171]
buffer_load_dwordx4 a[48:51], v234, s[20:23], s94 offen offset:0 sc0 sc1
v_mfma_f32_16x16x32_bf16 v[140:143], a[196:199], a[0:3], v[140:143]
ds_read_b64_tr_b16 a[192:193], v200 offset:40960
ds_read_b64_tr_b16 a[194:195], v200 offset:45056
v_mfma_f32_16x16x32_bf16 v[172:175], a[196:199], a[4:7], v[172:175]
ds_read_b64_tr_b16 a[196:197], v201 offset:40960
ds_read_b64_tr_b16 a[198:199], v201 offset:45056
v_mfma_f32_16x16x32_bf16 v[144:147], a[200:203], a[0:3], v[144:147]
s_add_u32 s94, s91, 4096
v_cvt_pk_bf16_f32 v72, v72, v73
v_cvt_pk_bf16_f32 v73, v74, v75
v_mfma_f32_16x16x32_bf16 v[176:179], a[200:203], a[4:7], v[176:179]
buffer_load_dwordx4 a[52:55], v234, s[20:23], s94 offen offset:1024 sc0 sc1
v_mfma_f32_16x16x32_bf16 v[148:151], a[204:207], a[0:3], v[148:151]
ds_read_b64_tr_b16 a[200:201], v202 offset:40960
ds_read_b64_tr_b16 a[202:203], v202 offset:45056
v_mfma_f32_16x16x32_bf16 v[180:183], a[204:207], a[4:7], v[180:183]
ds_read_b64_tr_b16 a[204:205], v203 offset:40960
ds_read_b64_tr_b16 a[206:207], v203 offset:45056
v_mfma_f32_16x16x32_bf16 v[152:155], a[208:211], a[0:3], v[152:155]
s_add_u32 s94, s91, 4096
v_cvt_pk_bf16_f32 v76, v76, v77
v_cvt_pk_bf16_f32 v77, v78, v79
v_mfma_f32_16x16x32_bf16 v[184:187], a[208:211], a[4:7], v[184:187]
buffer_load_dwordx4 a[56:59], v234, s[20:23], s94 offen offset:2048 sc0 sc1
v_mfma_f32_16x16x32_bf16 v[156:159], a[212:215], a[0:3], v[156:159]
ds_read_b64_tr_b16 a[208:209], v204 offset:40960
ds_read_b64_tr_b16 a[210:211], v204 offset:45056
v_mfma_f32_16x16x32_bf16 v[188:191], a[212:215], a[4:7], v[188:191]
ds_read_b64_tr_b16 a[212:213], v205 offset:40960
ds_read_b64_tr_b16 a[214:215], v205 offset:45056
v_mfma_f32_16x16x32_bf16 v[160:163], a[216:219], a[0:3], v[160:163]
s_add_u32 s94, s91, 4096
v_cvt_pk_bf16_f32 v80, v80, v81
v_cvt_pk_bf16_f32 v81, v82, v83
v_mfma_f32_16x16x32_bf16 v[192:195], a[216:219], a[4:7], v[192:195]
s_waitcnt lgkmcnt(8)
buffer_load_dwordx4 a[60:63], v234, s[20:23], s94 offen offset:3072 sc0 sc1
v_mfma_f32_16x16x32_bf16 v[164:167], a[220:223], a[0:3], v[164:167]
ds_read_b64_tr_b16 a[216:217], v206 offset:40960
ds_read_b64_tr_b16 a[218:219], v206 offset:45056
v_mfma_f32_16x16x32_bf16 v[196:199], a[220:223], a[4:7], v[196:199]
ds_read_b64_tr_b16 a[220:221], v207 offset:40960
ds_read_b64_tr_b16 a[222:223], v207 offset:45056
v_mfma_f32_16x16x32_bf16 v[136:139], a[192:195], a[8:11], v[136:139]
s_add_u32 m0, s3, 114688
v_cvt_pk_bf16_f32 v84, v84, v85
v_cvt_pk_bf16_f32 v85, v86, v87
v_mfma_f32_16x16x32_bf16 v[168:171], a[192:195], a[12:15], v[168:171]
s_add_u32 s48, s44, 73728
ds_read_b64_tr_b16 a[192:193], v200 offset:49152
ds_read_b64_tr_b16 a[194:195], v200 offset:53248
v_mfma_f32_16x16x32_bf16 v[140:143], a[196:199], a[8:11], v[140:143]
buffer_load_dwordx4 v236, s[16:19], s48 offen lds
v_mfma_f32_16x16x32_bf16 v[172:175], a[196:199], a[12:15], v[172:175]
s_waitcnt lgkmcnt(10)
ds_read_b64_tr_b16 a[196:197], v201 offset:49152
ds_read_b64_tr_b16 a[198:199], v201 offset:53248
v_mfma_f32_16x16x32_bf16 v[144:147], a[200:203], a[8:11], v[144:147]
s_add_u32 m0, s3, 118784
v_cvt_pk_bf16_f32 v88, v88, v89
v_cvt_pk_bf16_f32 v89, v90, v91
v_mfma_f32_16x16x32_bf16 v[176:179], a[200:203], a[12:15], v[176:179]
s_add_u32 s48, s44, 92160
ds_read_b64_tr_b16 a[200:201], v202 offset:49152
ds_read_b64_tr_b16 a[202:203], v202 offset:53248
v_mfma_f32_16x16x32_bf16 v[148:151], a[204:207], a[8:11], v[148:151]
buffer_load_dwordx4 v236, s[16:19], s48 offen lds
v_mfma_f32_16x16x32_bf16 v[180:183], a[204:207], a[12:15], v[180:183]
s_waitcnt lgkmcnt(10)
ds_read_b64_tr_b16 a[204:205], v203 offset:49152
ds_read_b64_tr_b16 a[206:207], v203 offset:53248
v_mfma_f32_16x16x32_bf16 v[152:155], a[208:211], a[8:11], v[152:155]
s_add_u32 m0, s3, 122880
v_cvt_pk_bf16_f32 v92, v92, v93
v_cvt_pk_bf16_f32 v93, v94, v95
v_mfma_f32_16x16x32_bf16 v[184:187], a[208:211], a[12:15], v[184:187]
s_add_u32 s48, s44, 110592
ds_read_b64_tr_b16 a[208:209], v204 offset:49152
ds_read_b64_tr_b16 a[210:211], v204 offset:53248
v_mfma_f32_16x16x32_bf16 v[156:159], a[212:215], a[8:11], v[156:159]
buffer_load_dwordx4 v236, s[16:19], s48 offen lds
v_mfma_f32_16x16x32_bf16 v[188:191], a[212:215], a[12:15], v[188:191]
s_waitcnt lgkmcnt(8)
ds_read_b64_tr_b16 a[212:213], v205 offset:49152
ds_read_b64_tr_b16 a[214:215], v205 offset:53248
v_mfma_f32_16x16x32_bf16 v[160:163], a[216:219], a[8:11], v[160:163]
s_add_u32 m0, s3, 126976
v_cvt_pk_bf16_f32 v96, v96, v97
v_mfma_f32_16x16x32_bf16 v[192:195], a[216:219], a[12:15], v[192:195]
s_add_u32 s48, s44, 129024
ds_read_b64_tr_b16 a[216:217], v206 offset:49152
ds_read_b64_tr_b16 a[218:219], v206 offset:53248
v_mfma_f32_16x16x32_bf16 v[164:167], a[220:223], a[8:11], v[164:167]
buffer_load_dwordx4 v236, s[16:19], s48 offen lds
v_mfma_f32_16x16x32_bf16 v[196:199], a[220:223], a[12:15], v[196:199]
ds_read_b64_tr_b16 a[220:221], v207 offset:49152
ds_read_b64_tr_b16 a[222:223], v207 offset:53248
v_mfma_f32_16x16x32_bf16 v[136:139], a[192:195], a[16:19], v[136:139]
s_waitcnt lgkmcnt(10)
v_cvt_pk_bf16_f32 v97, v98, v99
v_cvt_pk_bf16_f32 v100, v100, v101
v_mfma_f32_16x16x32_bf16 v[168:171], a[192:195], a[20:23], v[168:171]
s_add_u32 s94, s92, 0
ds_read_b64_tr_b16 a[192:193], v200 offset:57344
ds_read_b64_tr_b16 a[194:195], v200 offset:61440
v_mfma_f32_16x16x32_bf16 v[140:143], a[196:199], a[16:19], v[140:143]
buffer_load_dwordx4 a[64:67], v234, s[20:23], s94 offen offset:0 sc0 sc1
v_mfma_f32_16x16x32_bf16 v[172:175], a[196:199], a[20:23], v[172:175]
ds_read_b64_tr_b16 a[196:197], v201 offset:57344
ds_read_b64_tr_b16 a[198:199], v201 offset:61440
v_mfma_f32_16x16x32_bf16 v[144:147], a[200:203], a[16:19], v[144:147]
s_waitcnt lgkmcnt(10)
v_cvt_pk_bf16_f32 v101, v102, v103
v_lshlrev_b32 v249, 7, v1
v_mfma_f32_16x16x32_bf16 v[176:179], a[200:203], a[20:23], v[176:179]
s_add_u32 s94, s92, 0
ds_read_b64_tr_b16 a[200:201], v202 offset:57344
ds_read_b64_tr_b16 a[202:203], v202 offset:61440
v_mfma_f32_16x16x32_bf16 v[148:151], a[204:207], a[16:19], v[148:151]
buffer_load_dwordx4 a[68:71], v234, s[20:23], s94 offen offset:1024 sc0 sc1
v_mfma_f32_16x16x32_bf16 v[180:183], a[204:207], a[20:23], v[180:183]
ds_read_b64_tr_b16 a[204:205], v203 offset:57344
ds_read_b64_tr_b16 a[206:207], v203 offset:61440
v_mfma_f32_16x16x32_bf16 v[152:155], a[208:211], a[16:19], v[152:155]
s_waitcnt lgkmcnt(10)
v_lshlrev_b32 v7, 2, v3
v_subrev_u32 v248, s55, v254
v_mfma_f32_16x16x32_bf16 v[184:187], a[208:211], a[20:23], v[184:187]
s_add_u32 s94, s92, 0
ds_read_b64_tr_b16 a[208:209], v204 offset:57344
ds_read_b64_tr_b16 a[210:211], v204 offset:61440
v_mfma_f32_16x16x32_bf16 v[156:159], a[212:215], a[16:19], v[156:159]
buffer_load_dwordx4 a[72:75], v234, s[20:23], s94 offen offset:2048 sc0 sc1
v_mfma_f32_16x16x32_bf16 v[188:191], a[212:215], a[20:23], v[188:191]
ds_read_b64_tr_b16 a[212:213], v205 offset:57344
ds_read_b64_tr_b16 a[214:215], v205 offset:61440
v_mfma_f32_16x16x32_bf16 v[160:163], a[216:219], a[16:19], v[160:163]
s_waitcnt lgkmcnt(10)
v_subrev_u32 v248, 1, v248
v_mfma_f32_16x16x32_bf16 v[192:195], a[216:219], a[20:23], v[192:195]
s_add_u32 s94, s92, 0
ds_read_b64_tr_b16 a[216:217], v206 offset:57344
ds_read_b64_tr_b16 a[218:219], v206 offset:61440
v_mfma_f32_16x16x32_bf16 v[164:167], a[220:223], a[16:19], v[164:167]
buffer_load_dwordx4 a[76:79], v234, s[20:23], s94 offen offset:3072 sc0 sc1
v_mfma_f32_16x16x32_bf16 v[196:199], a[220:223], a[20:23], v[196:199]
ds_read_b64_tr_b16 a[220:221], v207 offset:57344
ds_read_b64_tr_b16 a[222:223], v207 offset:61440
buffer_load_dword v246, v6, s[20:23], s54 offen sc0 sc1
v_mfma_f32_16x16x32_bf16 v[136:139], a[192:195], a[24:27], v[136:139]
s_waitcnt lgkmcnt(10)
v_add_u32 v241, s37, v241
v_add_u32 v241, 65536, v241
v_mfma_f32_16x16x32_bf16 v[168:171], a[192:195], a[28:31], v[168:171]
s_add_u32 s94, s92, 4096
ds_read_b64_tr_b16 a[192:193], v220 offset:0
ds_read_b64_tr_b16 a[194:195], v220 offset:4096
v_mfma_f32_16x16x32_bf16 v[140:143], a[196:199], a[24:27], v[140:143]
buffer_load_dwordx4 a[80:83], v234, s[20:23], s94 offen offset:0 sc0 sc1
v_mfma_f32_16x16x32_bf16 v[172:175], a[196:199], a[28:31], v[172:175]
ds_read_b64_tr_b16 a[196:197], v221 offset:0
ds_read_b64_tr_b16 a[198:199], v221 offset:4096
v_mfma_f32_16x16x32_bf16 v[144:147], a[200:203], a[24:27], v[144:147]
s_waitcnt lgkmcnt(10)
v_xor_b32 v242, 32, v241
v_xor_b32 v243, 64, v241
v_mfma_f32_16x16x32_bf16 v[176:179], a[200:203], a[28:31], v[176:179]
s_add_u32 s94, s92, 4096
ds_read_b64_tr_b16 a[200:201], v222 offset:0
ds_read_b64_tr_b16 a[202:203], v222 offset:4096
v_mfma_f32_16x16x32_bf16 v[148:151], a[204:207], a[24:27], v[148:151]
buffer_load_dwordx4 a[84:87], v234, s[20:23], s94 offen offset:1024 sc0 sc1
v_mfma_f32_16x16x32_bf16 v[180:183], a[204:207], a[28:31], v[180:183]
ds_read_b64_tr_b16 a[204:205], v223 offset:0
ds_read_b64_tr_b16 a[206:207], v223 offset:4096
v_mfma_f32_16x16x32_bf16 v[152:155], a[208:211], a[24:27], v[152:155]
s_waitcnt lgkmcnt(10)
v_xor_b32 v244, 96, v241
v_mfma_f32_16x16x32_bf16 v[184:187], a[208:211], a[28:31], v[184:187]
s_add_u32 s94, s92, 4096
ds_read_b64_tr_b16 a[208:209], v224 offset:0
ds_read_b64_tr_b16 a[210:211], v224 offset:4096
v_mfma_f32_16x16x32_bf16 v[156:159], a[212:215], a[24:27], v[156:159]
buffer_load_dwordx4 a[88:91], v234, s[20:23], s94 offen offset:2048 sc0 sc1
v_mfma_f32_16x16x32_bf16 v[188:191], a[212:215], a[28:31], v[188:191]
ds_read_b64_tr_b16 a[212:213], v225 offset:0
ds_read_b64_tr_b16 a[214:215], v225 offset:4096
v_mfma_f32_16x16x32_bf16 v[160:163], a[216:219], a[24:27], v[160:163]
s_waitcnt lgkmcnt(10)
v_mfma_f32_16x16x32_bf16 v[192:195], a[216:219], a[28:31], v[192:195]
s_add_u32 s94, s92, 4096
ds_read_b64_tr_b16 a[216:217], v226 offset:0
ds_read_b64_tr_b16 a[218:219], v226 offset:4096
v_mfma_f32_16x16x32_bf16 v[164:167], a[220:223], a[24:27], v[164:167]
buffer_load_dwordx4 a[92:95], v234, s[20:23], s94 offen offset:3072 sc0 sc1
v_mfma_f32_16x16x32_bf16 v[196:199], a[220:223], a[28:31], v[196:199]
ds_read_b64_tr_b16 a[220:221], v227 offset:0
ds_read_b64_tr_b16 a[222:223], v227 offset:4096
s_waitcnt vmcnt(13)
v_mfma_f32_16x16x32_bf16 v[136:139], a[192:195], a[32:35], v[136:139]
s_add_u32 m0, s3, 131072
v_mfma_f32_16x16x32_bf16 v[168:171], a[192:195], a[36:39], v[168:171]
s_waitcnt lgkmcnt(8)
s_add_u32 s48, s42, 147456
ds_read_b64_tr_b16 a[192:193], v220 offset:8192
ds_read_b64_tr_b16 a[194:195], v220 offset:12288
v_mfma_f32_16x16x32_bf16 v[140:143], a[196:199], a[32:35], v[140:143]
buffer_load_dwordx4 v236, s[16:19], s48 offen lds
v_mfma_f32_16x16x32_bf16 v[172:175], a[196:199], a[36:39], v[172:175]
ds_read_b64_tr_b16 a[196:197], v221 offset:8192
ds_read_b64_tr_b16 a[198:199], v221 offset:12288
v_mfma_f32_16x16x32_bf16 v[144:147], a[200:203], a[32:35], v[144:147]
s_add_u32 m0, s3, 135168
v_mfma_f32_16x16x32_bf16 v[176:179], a[200:203], a[36:39], v[176:179]
s_add_u32 s48, s42, 165888
ds_read_b64_tr_b16 a[200:201], v222 offset:8192
ds_read_b64_tr_b16 a[202:203], v222 offset:12288
v_mfma_f32_16x16x32_bf16 v[148:151], a[204:207], a[32:35], v[148:151]
buffer_load_dwordx4 v236, s[16:19], s48 offen lds
v_mfma_f32_16x16x32_bf16 v[180:183], a[204:207], a[36:39], v[180:183]
s_waitcnt lgkmcnt(8)
ds_read_b64_tr_b16 a[204:205], v223 offset:8192
ds_read_b64_tr_b16 a[206:207], v223 offset:12288
v_mfma_f32_16x16x32_bf16 v[152:155], a[208:211], a[32:35], v[152:155]
s_add_u32 m0, s3, 139264
v_mfma_f32_16x16x32_bf16 v[184:187], a[208:211], a[36:39], v[184:187]
s_add_u32 s48, s42, 184320
ds_read_b64_tr_b16 a[208:209], v224 offset:8192
ds_read_b64_tr_b16 a[210:211], v224 offset:12288
v_mfma_f32_16x16x32_bf16 v[156:159], a[212:215], a[32:35], v[156:159]
buffer_load_dwordx4 v236, s[16:19], s48 offen lds
v_mfma_f32_16x16x32_bf16 v[188:191], a[212:215], a[36:39], v[188:191]
ds_read_b64_tr_b16 a[212:213], v225 offset:8192
ds_read_b64_tr_b16 a[214:215], v225 offset:12288
v_mfma_f32_16x16x32_bf16 v[160:163], a[216:219], a[32:35], v[160:163]
s_add_u32 m0, s3, 143360
v_mfma_f32_16x16x32_bf16 v[192:195], a[216:219], a[36:39], v[192:195]
s_waitcnt lgkmcnt(8)
s_add_u32 s48, s42, 202752
ds_read_b64_tr_b16 a[216:217], v226 offset:8192
ds_read_b64_tr_b16 a[218:219], v226 offset:12288
v_mfma_f32_16x16x32_bf16 v[164:167], a[220:223], a[32:35], v[164:167]
buffer_load_dwordx4 v236, s[16:19], s48 offen lds
v_mfma_f32_16x16x32_bf16 v[196:199], a[220:223], a[36:39], v[196:199]
ds_read_b64_tr_b16 a[220:221], v227 offset:8192
ds_read_b64_tr_b16 a[222:223], v227 offset:12288
v_mfma_f32_16x16x32_bf16 v[136:139], a[192:195], a[40:43], v[136:139]
s_add_u32 m0, s3, 147456
v_mfma_f32_16x16x32_bf16 v[168:171], a[192:195], a[44:47], v[168:171]
s_add_u32 s48, s42, 221184
ds_read_b64_tr_b16 a[192:193], v220 offset:16384
ds_read_b64_tr_b16 a[194:195], v220 offset:20480
v_mfma_f32_16x16x32_bf16 v[140:143], a[196:199], a[40:43], v[140:143]
buffer_load_dwordx4 v236, s[16:19], s48 offen lds
v_mfma_f32_16x16x32_bf16 v[172:175], a[196:199], a[44:47], v[172:175]
s_waitcnt lgkmcnt(8)
ds_read_b64_tr_b16 a[196:197], v221 offset:16384
ds_read_b64_tr_b16 a[198:199], v221 offset:20480
v_mfma_f32_16x16x32_bf16 v[144:147], a[200:203], a[40:43], v[144:147]
s_add_u32 m0, s3, 151552
v_mfma_f32_16x16x32_bf16 v[176:179], a[200:203], a[44:47], v[176:179]
s_add_u32 s48, s42, 239616
ds_read_b64_tr_b16 a[200:201], v222 offset:16384
ds_read_b64_tr_b16 a[202:203], v222 offset:20480
v_mfma_f32_16x16x32_bf16 v[148:151], a[204:207], a[40:43], v[148:151]
buffer_load_dwordx4 v236, s[16:19], s48 offen lds
v_mfma_f32_16x16x32_bf16 v[180:183], a[204:207], a[44:47], v[180:183]
ds_read_b64_tr_b16 a[204:205], v223 offset:16384
ds_read_b64_tr_b16 a[206:207], v223 offset:20480
v_mfma_f32_16x16x32_bf16 v[152:155], a[208:211], a[40:43], v[152:155]
s_add_u32 m0, s3, 155648
v_mfma_f32_16x16x32_bf16 v[184:187], a[208:211], a[44:47], v[184:187]
s_waitcnt lgkmcnt(8)
s_add_u32 s48, s42, 258048
ds_read_b64_tr_b16 a[208:209], v224 offset:16384
ds_read_b64_tr_b16 a[210:211], v224 offset:20480
v_mfma_f32_16x16x32_bf16 v[156:159], a[212:215], a[40:43], v[156:159]
buffer_load_dwordx4 v236, s[16:19], s48 offen lds
v_mfma_f32_16x16x32_bf16 v[188:191], a[212:215], a[44:47], v[188:191]
ds_read_b64_tr_b16 a[212:213], v225 offset:16384
ds_read_b64_tr_b16 a[214:215], v225 offset:20480
v_mfma_f32_16x16x32_bf16 v[160:163], a[216:219], a[40:43], v[160:163]
s_add_u32 m0, s3, 159744
v_mfma_f32_16x16x32_bf16 v[192:195], a[216:219], a[44:47], v[192:195]
s_add_u32 s48, s42, 276480
ds_read_b64_tr_b16 a[216:217], v226 offset:16384
ds_read_b64_tr_b16 a[218:219], v226 offset:20480
v_mfma_f32_16x16x32_bf16 v[164:167], a[220:223], a[40:43], v[164:167]
buffer_load_dwordx4 v236, s[16:19], s48 offen lds
v_mfma_f32_16x16x32_bf16 v[196:199], a[220:223], a[44:47], v[196:199]
s_waitcnt lgkmcnt(8)
ds_read_b64_tr_b16 a[220:221], v227 offset:16384
ds_read_b64_tr_b16 a[222:223], v227 offset:20480
s_waitcnt vmcnt(12)
v_cmp_ne_u32 vcc, 1, v246
s_and_b32 s46, vcc_lo, 170
s_cbranch_scc0 K_F1_OK
K_F1:
s_sleep 1
s_add_u32 s100, s100, 1
s_bitcmp1_b32 s100, 19
s_cbranch_scc1 K_END
buffer_load_dword v246, v6, s[20:23], s54 offen sc0 sc1
s_waitcnt vmcnt(0)
v_cmp_ne_u32 vcc, 1, v246
s_and_b32 s46, vcc_lo, 170
s_cbranch_scc1 K_F1
K_F1_OK:
v_mfma_f32_16x16x32_bf16 v[136:139], a[192:195], a[48:51], v[136:139]
v_mfma_f32_16x16x32_bf16 v[168:171], a[192:195], a[52:55], v[168:171]
s_add_u32 s94, s90, 8192
ds_read_b64_tr_b16 a[192:193], v220 offset:24576
ds_read_b64_tr_b16 a[194:195], v220 offset:28672
v_mfma_f32_16x16x32_bf16 v[140:143], a[196:199], a[48:51], v[140:143]
buffer_load_dwordx4 a[96:99], v234, s[20:23], s94 offen offset:0 sc0 sc1
v_mfma_f32_16x16x32_bf16 v[172:175], a[196:199], a[52:55], v[172:175]
ds_read_b64_tr_b16 a[196:197], v221 offset:24576
ds_read_b64_tr_b16 a[198:199], v221 offset:28672
v_mfma_f32_16x16x32_bf16 v[144:147], a[200:203], a[48:51], v[144:147]
s_add_u32 s94, s90, 8192
v_mfma_f32_16x16x32_bf16 v[176:179], a[200:203], a[52:55], v[176:179]
s_waitcnt lgkmcnt(8)
buffer_load_dwordx4 a[100:103], v234, s[20:23], s94 offen offset:1024 sc0 sc1
v_mfma_f32_16x16x32_bf16 v[148:151], a[204:207], a[48:51], v[148:151]
ds_read_b64_tr_b16 a[200:201], v222 offset:24576
ds_read_b64_tr_b16 a[202:203], v222 offset:28672
v_mfma_f32_16x16x32_bf16 v[180:183], a[204:207], a[52:55], v[180:183]
ds_read_b64_tr_b16 a[204:205], v223 offset:24576
ds_read_b64_tr_b16 a[206:207], v223 offset:28672
v_mfma_f32_16x16x32_bf16 v[152:155], a[208:211], a[48:51], v[152:155]
s_add_u32 s94, s90, 8192
v_mfma_f32_16x16x32_bf16 v[184:187], a[208:211], a[52:55], v[184:187]
buffer_load_dwordx4 a[104:107], v234, s[20:23], s94 offen offset:2048 sc0 sc1
v_mfma_f32_16x16x32_bf16 v[156:159], a[212:215], a[48:51], v[156:159]
s_waitcnt lgkmcnt(8)
ds_read_b64_tr_b16 a[208:209], v224 offset:24576
ds_read_b64_tr_b16 a[210:211], v224 offset:28672
v_mfma_f32_16x16x32_bf16 v[188:191], a[212:215], a[52:55], v[188:191]
s_add_u32 s94, s90, 8192
ds_read_b64_tr_b16 a[212:213], v225 offset:24576
ds_read_b64_tr_b16 a[214:215], v225 offset:28672
v_mfma_f32_16x16x32_bf16 v[160:163], a[216:219], a[48:51], v[160:163]
buffer_load_dwordx4 a[108:111], v234, s[20:23], s94 offen offset:3072 sc0 sc1
v_mfma_f32_16x16x32_bf16 v[192:195], a[216:219], a[52:55], v[192:195]
ds_read_b64_tr_b16 a[216:217], v226 offset:24576
ds_read_b64_tr_b16 a[218:219], v226 offset:28672
v_mfma_f32_16x16x32_bf16 v[164:167], a[220:223], a[48:51], v[164:167]
v_mfma_f32_16x16x32_bf16 v[196:199], a[220:223], a[52:55], v[196:199]
s_waitcnt lgkmcnt(10)
ds_read_b64_tr_b16 a[220:221], v227 offset:24576
ds_read_b64_tr_b16 a[222:223], v227 offset:28672
v_mfma_f32_16x16x32_bf16 v[136:139], a[192:195], a[56:59], v[136:139]
v_mfma_f32_16x16x32_bf16 v[168:171], a[192:195], a[60:63], v[168:171]
v_mfma_f32_16x16x32_bf16 v[140:143], a[196:199], a[56:59], v[140:143]
v_mfma_f32_16x16x32_bf16 v[172:175], a[196:199], a[60:63], v[172:175]
s_waitcnt lgkmcnt(8)
v_mfma_f32_16x16x32_bf16 v[144:147], a[200:203], a[56:59], v[144:147]
s_waitcnt vmcnt(21) lgkmcnt(0)
s_barrier
v_mfma_f32_16x16x32_bf16 v[176:179], a[200:203], a[60:63], v[176:179]
ds_read_b64_tr_b16 a[192:193], v220 offset:32768
ds_read_b64_tr_b16 a[194:195], v220 offset:36864
v_mfma_f32_16x16x32_bf16 v[148:151], a[204:207], a[56:59], v[148:151]
s_add_u32 s94, s90, 12288
ds_read_b64_tr_b16 a[196:197], v221 offset:32768
ds_read_b64_tr_b16 a[198:199], v221 offset:36864
v_mfma_f32_16x16x32_bf16 v[180:183], a[204:207], a[60:63], v[180:183]
buffer_load_dwordx4 a[112:115], v234, s[20:23], s94 offen offset:0 sc0 sc1
v_mfma_f32_16x16x32_bf16 v[152:155], a[208:211], a[56:59], v[152:155]
ds_read_b64_tr_b16 a[200:201], v222 offset:32768
ds_read_b64_tr_b16 a[202:203], v222 offset:36864
v_mfma_f32_16x16x32_bf16 v[184:187], a[208:211], a[60:63], v[184:187]
s_add_u32 s94, s90, 12288
ds_read_b64_tr_b16 a[204:205], v223 offset:32768
ds_read_b64_tr_b16 a[206:207], v223 offset:36864
v_mfma_f32_16x16x32_bf16 v[156:159], a[212:215], a[56:59], v[156:159]
buffer_load_dwordx4 a[116:119], v234, s[20:23], s94 offen offset:1024 sc0 sc1
v_mfma_f32_16x16x32_bf16 v[188:191], a[212:215], a[60:63], v[188:191]
ds_read_b64_tr_b16 a[208:209], v224 offset:32768
ds_read_b64_tr_b16 a[210:211], v224 offset:36864
v_mfma_f32_16x16x32_bf16 v[160:163], a[216:219], a[56:59], v[160:163]
ds_read_b64_tr_b16 a[212:213], v225 offset:32768
ds_read_b64_tr_b16 a[214:215], v225 offset:36864
v_mfma_f32_16x16x32_bf16 v[192:195], a[216:219], a[60:63], v[192:195]
s_add_u32 s94, s90, 12288
ds_read_b64_tr_b16 a[216:217], v226 offset:32768
ds_read_b64_tr_b16 a[218:219], v226 offset:36864
v_mfma_f32_16x16x32_bf16 v[164:167], a[220:223], a[56:59], v[164:167]
buffer_load_dwordx4 a[120:123], v234, s[20:23], s94 offen offset:2048 sc0 sc1
v_mfma_f32_16x16x32_bf16 v[196:199], a[220:223], a[60:63], v[196:199]
s_waitcnt lgkmcnt(12)
ds_read_b64_tr_b16 a[220:221], v227 offset:32768
ds_read_b64_tr_b16 a[222:223], v227 offset:36864
s_waitcnt vmcnt(15)
v_mfma_f32_16x16x32_bf16 v[136:139], a[192:195], a[64:67], v[136:139]
s_add_u32 s94, s90, 12288
v_mfma_f32_16x16x32_bf16 v[168:171], a[192:195], a[68:71], v[168:171]
s_waitcnt lgkmcnt(12)
buffer_load_dwordx4 a[124:127], v234, s[20:23], s94 offen offset:3072 sc0 sc1
v_mfma_f32_16x16x32_bf16 v[140:143], a[196:199], a[64:67], v[140:143]
s_waitcnt lgkmcnt(10)
ds_read_b64_tr_b16 a[192:193], v220 offset:40960
ds_read_b64_tr_b16 a[194:195], v220 offset:45056
v_mfma_f32_16x16x32_bf16 v[172:175], a[196:199], a[68:71], v[172:175]
s_add_u32 m0, s3, 0
ds_read_b64_tr_b16 a[196:197], v221 offset:40960
ds_read_b64_tr_b16 a[198:199], v221 offset:45056
v_mfma_f32_16x16x32_bf16 v[144:147], a[200:203], a[64:67], v[144:147]
s_add_u32 s48, s43, 147456
v_mfma_f32_16x16x32_bf16 v[176:179], a[200:203], a[68:71], v[176:179]
s_waitcnt lgkmcnt(10)
buffer_load_dwordx4 v236, s[16:19], s48 offen lds
v_mfma_f32_16x16x32_bf16 v[148:151], a[204:207], a[64:67], v[148:151]
s_add_u32 m0, s3, 4096
ds_read_b64_tr_b16 a[200:201], v222 offset:40960
ds_read_b64_tr_b16 a[202:203], v222 offset:45056
v_mfma_f32_16x16x32_bf16 v[180:183], a[204:207], a[68:71], v[180:183]
s_add_u32 s48, s43, 165888
ds_read_b64_tr_b16 a[204:205], v223 offset:40960
ds_read_b64_tr_b16 a[206:207], v223 offset:45056
v_mfma_f32_16x16x32_bf16 v[152:155], a[208:211], a[64:67], v[152:155]
s_waitcnt lgkmcnt(10)
buffer_load_dwordx4 v236, s[16:19], s48 offen lds
v_mfma_f32_16x16x32_bf16 v[184:187], a[208:211], a[68:71], v[184:187]
s_add_u32 m0, s3, 8192
ds_read_b64_tr_b16 a[208:209], v224 offset:40960
ds_read_b64_tr_b16 a[210:211], v224 offset:45056
v_mfma_f32_16x16x32_bf16 v[156:159], a[212:215], a[64:67], v[156:159]
s_add_u32 s48, s43, 184320
v_mfma_f32_16x16x32_bf16 v[188:191], a[212:215], a[68:71], v[188:191]
buffer_load_dwordx4 v236, s[16:19], s48 offen lds
v_mfma_f32_16x16x32_bf16 v[160:163], a[216:219], a[64:67], v[160:163]
ds_read_b64_tr_b16 a[212:213], v225 offset:40960
ds_read_b64_tr_b16 a[214:215], v225 offset:45056
v_mfma_f32_16x16x32_bf16 v[192:195], a[216:219], a[68:71], v[192:195]
s_waitcnt lgkmcnt(8)
ds_read_b64_tr_b16 a[216:217], v226 offset:40960
ds_read_b64_tr_b16 a[218:219], v226 offset:45056
v_mfma_f32_16x16x32_bf16 v[164:167], a[220:223], a[64:67], v[164:167]
v_mfma_f32_16x16x32_bf16 v[196:199], a[220:223], a[68:71], v[196:199]
ds_read_b64_tr_b16 a[220:221], v227 offset:40960
ds_read_b64_tr_b16 a[222:223], v227 offset:45056
v_mfma_f32_16x16x32_bf16 v[136:139], a[192:195], a[72:75], v[136:139]
s_add_u32 m0, s3, 12288
v_mfma_f32_16x16x32_bf16 v[168:171], a[192:195], a[76:79], v[168:171]
s_add_u32 s48, s43, 202752
ds_read_b64_tr_b16 a[192:193], v220 offset:49152
ds_read_b64_tr_b16 a[194:195], v220 offset:53248
v_mfma_f32_16x16x32_bf16 v[140:143], a[196:199], a[72:75], v[140:143]
s_waitcnt lgkmcnt(10)
buffer_load_dwordx4 v236, s[16:19], s48 offen lds
v_mfma_f32_16x16x32_bf16 v[172:175], a[196:199], a[76:79], v[172:175]
s_add_u32 m0, s3, 16384
ds_read_b64_tr_b16 a[196:197], v221 offset:49152
ds_read_b64_tr_b16 a[198:199], v221 offset:53248
v_mfma_f32_16x16x32_bf16 v[144:147], a[200:203], a[72:75], v[144:147]
s_add_u32 s48, s43, 221184
v_mfma_f32_16x16x32_bf16 v[176:179], a[200:203], a[76:79], v[176:179]
buffer_load_dwordx4 v236, s[16:19], s48 offen lds
v_mfma_f32_16x16x32_bf16 v[148:151], a[204:207], a[72:75], v[148:151]
s_add_u32 m0, s3, 20480
ds_read_b64_tr_b16 a[200:201], v222 offset:49152
ds_read_b64_tr_b16 a[202:203], v222 offset:53248
v_mfma_f32_16x16x32_bf16 v[180:183], a[204:207], a[76:79], v[180:183]
s_waitcnt lgkmcnt(8)
s_add_u32 s48, s43, 239616
ds_read_b64_tr_b16 a[204:205], v223 offset:49152
ds_read_b64_tr_b16 a[206:207], v223 offset:53248
v_mfma_f32_16x16x32_bf16 v[152:155], a[208:211], a[72:75], v[152:155]
buffer_load_dwordx4 v236, s[16:19], s48 offen lds
v_mfma_f32_16x16x32_bf16 v[184:187], a[208:211], a[76:79], v[184:187]
ds_read_b64_tr_b16 a[208:209], v224 offset:49152
ds_read_b64_tr_b16 a[210:211], v224 offset:53248
v_mfma_f32_16x16x32_bf16 v[156:159], a[212:215], a[72:75], v[156:159]
s_add_u32 m0, s3, 24576
v_mfma_f32_16x16x32_bf16 v[188:191], a[212:215], a[76:79], v[188:191]
s_add_u32 s48, s43, 258048
ds_read_b64_tr_b16 a[212:213], v225 offset:49152
ds_read_b64_tr_b16 a[214:215], v225 offset:53248
v_mfma_f32_16x16x32_bf16 v[160:163], a[216:219], a[72:75], v[160:163]
buffer_load_dwordx4 v236, s[16:19], s48 offen lds
v_mfma_f32_16x16x32_bf16 v[192:195], a[216:219], a[76:79], v[192:195]
s_waitcnt lgkmcnt(8)
ds_read_b64_tr_b16 a[216:217], v226 offset:49152
ds_read_b64_tr_b16 a[218:219], v226 offset:53248
v_mfma_f32_16x16x32_bf16 v[164:167], a[220:223], a[72:75], v[164:167]
v_mfma_f32_16x16x32_bf16 v[196:199], a[220:223], a[76:79], v[196:199]
ds_read_b64_tr_b16 a[220:221], v227 offset:49152
ds_read_b64_tr_b16 a[222:223], v227 offset:53248
v_mfma_f32_16x16x32_bf16 v[136:139], a[192:195], a[80:83], v[136:139]
s_add_u32 m0, s3, 28672
v_mfma_f32_16x16x32_bf16 v[168:171], a[192:195], a[84:87], v[168:171]
s_add_u32 s48, s43, 276480
ds_read_b64_tr_b16 a[192:193], v220 offset:57344
ds_read_b64_tr_b16 a[194:195], v220 offset:61440
v_mfma_f32_16x16x32_bf16 v[140:143], a[196:199], a[80:83], v[140:143]
buffer_load_dwordx4 v236, s[16:19], s48 offen lds
v_mfma_f32_16x16x32_bf16 v[172:175], a[196:199], a[84:87], v[172:175]
s_waitcnt lgkmcnt(8)
ds_read_b64_tr_b16 a[196:197], v221 offset:57344
ds_read_b64_tr_b16 a[198:199], v221 offset:61440
v_mfma_f32_16x16x32_bf16 v[144:147], a[200:203], a[80:83], v[144:147]
s_add_u32 s94, s88, 0
v_mfma_f32_16x16x32_bf16 v[176:179], a[200:203], a[84:87], v[176:179]
buffer_store_dwordx2 v[72:73], v250, s[20:23], s94 offen sc0 sc1
v_mfma_f32_16x16x32_bf16 v[148:151], a[204:207], a[80:83], v[148:151]
ds_read_b64_tr_b16 a[200:201], v222 offset:57344
ds_read_b64_tr_b16 a[202:203], v222 offset:61440
v_mfma_f32_16x16x32_bf16 v[180:183], a[204:207], a[84:87], v[180:183]
ds_read_b64_tr_b16 a[204:205], v223 offset:57344
ds_read_b64_tr_b16 a[206:207], v223 offset:61440
v_mfma_f32_16x16x32_bf16 v[152:155], a[208:211], a[80:83], v[152:155]
s_waitcnt lgkmcnt(10)
v_mfma_f32_16x16x32_bf16 v[184:187], a[208:211], a[84:87], v[184:187]
s_add_u32 s94, s88, 8192
ds_read_b64_tr_b16 a[208:209], v224 offset:57344
ds_read_b64_tr_b16 a[210:211], v224 offset:61440
v_mfma_f32_16x16x32_bf16 v[156:159], a[212:215], a[80:83], v[156:159]
buffer_store_dwordx2 v[76:77], v250, s[20:23], s94 offen sc0 sc1
v_mfma_f32_16x16x32_bf16 v[188:191], a[212:215], a[84:87], v[188:191]
ds_read_b64_tr_b16 a[212:213], v225 offset:57344
ds_read_b64_tr_b16 a[214:215], v225 offset:61440
v_mfma_f32_16x16x32_bf16 v[160:163], a[216:219], a[80:83], v[160:163]
s_waitcnt lgkmcnt(10)
v_mfma_f32_16x16x32_bf16 v[192:195], a[216:219], a[84:87], v[192:195]
s_add_u32 s94, s88, 16384
ds_read_b64_tr_b16 a[216:217], v226 offset:57344
ds_read_b64_tr_b16 a[218:219], v226 offset:61440
v_mfma_f32_16x16x32_bf16 v[164:167], a[220:223], a[80:83], v[164:167]
buffer_store_dwordx2 v[80:81], v250, s[20:23], s94 offen sc0 sc1
v_mfma_f32_16x16x32_bf16 v[196:199], a[220:223], a[84:87], v[196:199]
ds_read_b64_tr_b16 a[220:221], v227 offset:57344
ds_read_b64_tr_b16 a[222:223], v227 offset:61440
v_mfma_f32_16x16x32_bf16 v[136:139], a[192:195], a[88:91], v[136:139]
v_mfma_f32_16x16x32_bf16 v[168:171], a[192:195], a[92:95], v[168:171]
s_waitcnt lgkmcnt(8)
v_mfma_f32_16x16x32_bf16 v[140:143], a[196:199], a[88:91], v[140:143]
v_mfma_f32_16x16x32_bf16 v[172:175], a[196:199], a[92:95], v[172:175]
v_mfma_f32_16x16x32_bf16 v[144:147], a[200:203], a[88:91], v[144:147]
s_waitcnt vmcnt(19) lgkmcnt(0)
s_barrier
v_mfma_f32_16x16x32_bf16 v[176:179], a[200:203], a[92:95], v[176:179]
ds_read_b64_tr_b16 a[192:193], v208 offset:0
ds_read_b64_tr_b16 a[194:195], v208 offset:4096
v_mfma_f32_16x16x32_bf16 v[148:151], a[204:207], a[88:91], v[148:151]
s_add_u32 s94, s88, 24576
ds_read_b64_tr_b16 a[196:197], v209 offset:0
ds_read_b64_tr_b16 a[198:199], v209 offset:4096
v_mfma_f32_16x16x32_bf16 v[180:183], a[204:207], a[92:95], v[180:183]
buffer_store_dwordx2 v[84:85], v250, s[20:23], s94 offen sc0 sc1
v_mfma_f32_16x16x32_bf16 v[152:155], a[208:211], a[88:91], v[152:155]
ds_read_b64_tr_b16 a[200:201], v210 offset:0
ds_read_b64_tr_b16 a[202:203], v210 offset:4096
v_mfma_f32_16x16x32_bf16 v[184:187], a[208:211], a[92:95], v[184:187]
ds_read_b64_tr_b16 a[204:205], v211 offset:0
ds_read_b64_tr_b16 a[206:207], v211 offset:4096
v_mfma_f32_16x16x32_bf16 v[156:159], a[212:215], a[88:91], v[156:159]
s_add_u32 s94, s89, 0
ds_read_b64_tr_b16 a[208:209], v212 offset:0
ds_read_b64_tr_b16 a[210:211], v212 offset:4096
v_mfma_f32_16x16x32_bf16 v[188:191], a[212:215], a[92:95], v[188:191]
buffer_store_dwordx2 v[88:89], v250, s[20:23], s94 offen sc0 sc1
v_mfma_f32_16x16x32_bf16 v[160:163], a[216:219], a[88:91], v[160:163]
ds_read_b64_tr_b16 a[212:213], v213 offset:0
ds_read_b64_tr_b16 a[214:215], v213 offset:4096
v_mfma_f32_16x16x32_bf16 v[192:195], a[216:219], a[92:95], v[192:195]
ds_read_b64_tr_b16 a[216:217], v214 offset:0
ds_read_b64_tr_b16 a[218:219], v214 offset:4096
v_mfma_f32_16x16x32_bf16 v[164:167], a[220:223], a[88:91], v[164:167]
v_mfma_f32_16x16x32_bf16 v[196:199], a[220:223], a[92:95], v[196:199]
s_waitcnt lgkmcnt(12)
ds_read_b64_tr_b16 a[220:221], v215 offset:0
ds_read_b64_tr_b16 a[222:223], v215 offset:4096
s_waitcnt vmcnt(13)
v_mfma_f32_16x16x32_bf16 v[136:139], a[192:195], a[96:99], v[136:139]
s_add_u32 s94, s89, 8192
v_mfma_f32_16x16x32_bf16 v[168:171], a[192:195], a[100:103], v[168:171]
s_waitcnt lgkmcnt(12)
buffer_store_dwordx2 v[92:93], v250, s[20:23], s94 offen sc0 sc1
v_mfma_f32_16x16x32_bf16 v[140:143], a[196:199], a[96:99], v[140:143]
ds_read_b64_tr_b16 a[192:193], v208 offset:8192
ds_read_b64_tr_b16 a[194:195], v208 offset:12288
v_mfma_f32_16x16x32_bf16 v[172:175], a[196:199], a[100:103], v[172:175]
s_waitcnt lgkmcnt(10)
ds_read_b64_tr_b16 a[196:197], v209 offset:8192
ds_read_b64_tr_b16 a[198:199], v209 offset:12288
v_mfma_f32_16x16x32_bf16 v[144:147], a[200:203], a[96:99], v[144:147]
s_add_u32 s94, s89, 16384
v_mfma_f32_16x16x32_bf16 v[176:179], a[200:203], a[100:103], v[176:179]
buffer_store_dwordx2 v[96:97], v250, s[20:23], s94 offen sc0 sc1
v_mfma_f32_16x16x32_bf16 v[148:151], a[204:207], a[96:99], v[148:151]
ds_read_b64_tr_b16 a[200:201], v210 offset:8192
ds_read_b64_tr_b16 a[202:203], v210 offset:12288
v_mfma_f32_16x16x32_bf16 v[180:183], a[204:207], a[100:103], v[180:183]
s_waitcnt lgkmcnt(8)
ds_read_b64_tr_b16 a[204:205], v211 offset:8192
ds_read_b64_tr_b16 a[206:207], v211 offset:12288
v_mfma_f32_16x16x32_bf16 v[152:155], a[208:211], a[96:99], v[152:155]
s_add_u32 s94, s89, 24576
v_mfma_f32_16x16x32_bf16 v[184:187], a[208:211], a[100:103], v[184:187]
buffer_store_dwordx2 v[100:101], v250, s[20:23], s94 offen sc0 sc1
v_mfma_f32_16x16x32_bf16 v[156:159], a[212:215], a[96:99], v[156:159]
ds_read_b64_tr_b16 a[208:209], v212 offset:8192
ds_read_b64_tr_b16 a[210:211], v212 offset:12288
v_mfma_f32_16x16x32_bf16 v[188:191], a[212:215], a[100:103], v[188:191]
ds_read_b64_tr_b16 a[212:213], v213 offset:8192
ds_read_b64_tr_b16 a[214:215], v213 offset:12288
v_mfma_f32_16x16x32_bf16 v[160:163], a[216:219], a[96:99], v[160:163]
s_add_u32 s94, s91, 8192
v_mfma_f32_16x16x32_bf16 v[192:195], a[216:219], a[100:103], v[192:195]
s_waitcnt lgkmcnt(8)
buffer_load_dwordx4 a[128:131], v234, s[20:23], s94 offen offset:0 sc0 sc1
v_mfma_f32_16x16x32_bf16 v[164:167], a[220:223], a[96:99], v[164:167]
ds_read_b64_tr_b16 a[216:217], v214 offset:8192
ds_read_b64_tr_b16 a[218:219], v214 offset:12288
v_mfma_f32_16x16x32_bf16 v[196:199], a[220:223], a[100:103], v[196:199]
ds_read_b64_tr_b16 a[220:221], v215 offset:8192
ds_read_b64_tr_b16 a[222:223], v215 offset:12288
v_mfma_f32_16x16x32_bf16 v[136:139], a[192:195], a[104:107], v[136:139]
s_add_u32 s94, s91, 8192
v_mfma_f32_16x16x32_bf16 v[168:171], a[192:195], a[108:111], v[168:171]
buffer_load_dwordx4 a[132:135], v234, s[20:23], s94 offen offset:1024 sc0 sc1
v_mfma_f32_16x16x32_bf16 v[140:143], a[196:199], a[104:107], v[140:143]
s_waitcnt lgkmcnt(8)
ds_read_b64_tr_b16 a[192:193], v208 offset:16384
ds_read_b64_tr_b16 a[194:195], v208 offset:20480
v_mfma_f32_16x16x32_bf16 v[172:175], a[196:199], a[108:111], v[172:175]
s_add_u32 s94, s91, 8192
ds_read_b64_tr_b16 a[196:197], v209 offset:16384
ds_read_b64_tr_b16 a[198:199], v209 offset:20480
v_mfma_f32_16x16x32_bf16 v[144:147], a[200:203], a[104:107], v[144:147]
buffer_load_dwordx4 a[136:139], v234, s[20:23], s94 offen offset:2048 sc0 sc1
v_mfma_f32_16x16x32_bf16 v[176:179], a[200:203], a[108:111], v[176:179]
s_add_u32 s94, s91, 8192
ds_read_b64_tr_b16 a[200:201], v210 offset:16384
ds_read_b64_tr_b16 a[202:203], v210 offset:20480
v_mfma_f32_16x16x32_bf16 v[148:151], a[204:207], a[104:107], v[148:151]
s_waitcnt lgkmcnt(10)
buffer_load_dwordx4 a[140:143], v234, s[20:23], s94 offen offset:3072 sc0 sc1
v_mfma_f32_16x16x32_bf16 v[180:183], a[204:207], a[108:111], v[180:183]
s_add_u32 s94, s91, 12288
ds_read_b64_tr_b16 a[204:205], v211 offset:16384
ds_read_b64_tr_b16 a[206:207], v211 offset:20480
v_mfma_f32_16x16x32_bf16 v[152:155], a[208:211], a[104:107], v[152:155]
buffer_load_dwordx4 a[144:147], v234, s[20:23], s94 offen offset:0 sc0 sc1
v_mfma_f32_16x16x32_bf16 v[184:187], a[208:211], a[108:111], v[184:187]
ds_read_b64_tr_b16 a[208:209], v212 offset:16384
ds_read_b64_tr_b16 a[210:211], v212 offset:20480
v_mfma_f32_16x16x32_bf16 v[156:159], a[212:215], a[104:107], v[156:159]
s_add_u32 s94, s91, 12288
v_mfma_f32_16x16x32_bf16 v[188:191], a[212:215], a[108:111], v[188:191]
s_waitcnt lgkmcnt(10)
buffer_load_dwordx4 a[148:151], v234, s[20:23], s94 offen offset:1024 sc0 sc1
v_mfma_f32_16x16x32_bf16 v[160:163], a[216:219], a[104:107], v[160:163]
s_add_u32 s94, s91, 12288
ds_read_b64_tr_b16 a[212:213], v213 offset:16384
ds_read_b64_tr_b16 a[214:215], v213 offset:20480
v_mfma_f32_16x16x32_bf16 v[192:195], a[216:219], a[108:111], v[192:195]
buffer_load_dwordx4 a[152:155], v234, s[20:23], s94 offen offset:2048 sc0 sc1
v_mfma_f32_16x16x32_bf16 v[164:167], a[220:223], a[104:107], v[164:167]
ds_read_b64_tr_b16 a[216:217], v214 offset:16384
ds_read_b64_tr_b16 a[218:219], v214 offset:20480
v_mfma_f32_16x16x32_bf16 v[196:199], a[220:223], a[108:111], v[196:199]
s_waitcnt lgkmcnt(8)
ds_read_b64_tr_b16 a[220:221], v215 offset:16384
ds_read_b64_tr_b16 a[222:223], v215 offset:20480
v_mfma_f32_16x16x32_bf16 v[136:139], a[192:195], a[112:115], v[136:139]
s_add_u32 s94, s91, 12288
v_mfma_f32_16x16x32_bf16 v[168:171], a[192:195], a[116:119], v[168:171]
buffer_load_dwordx4 a[156:159], v234, s[20:23], s94 offen offset:3072 sc0 sc1
v_mfma_f32_16x16x32_bf16 v[140:143], a[196:199], a[112:115], v[140:143]
ds_read_b64_tr_b16 a[192:193], v208 offset:24576
ds_read_b64_tr_b16 a[194:195], v208 offset:28672
v_mfma_f32_16x16x32_bf16 v[172:175], a[196:199], a[116:119], v[172:175]
s_add_u32 m0, s3, 32768
ds_read_b64_tr_b16 a[196:197], v209 offset:24576
ds_read_b64_tr_b16 a[198:199], v209 offset:28672
v_mfma_f32_16x16x32_bf16 v[144:147], a[200:203], a[112:115], v[144:147]
s_add_u32 s48, s44, 147456
v_mfma_f32_16x16x32_bf16 v[176:179], a[200:203], a[116:119], v[176:179]
s_waitcnt lgkmcnt(10)
buffer_load_dwordx4 v236, s[16:19], s48 offen lds
v_mfma_f32_16x16x32_bf16 v[148:151], a[204:207], a[112:115], v[148:151]
ds_read_b64_tr_b16 a[200:201], v210 offset:24576
ds_read_b64_tr_b16 a[202:203], v210 offset:28672
v_mfma_f32_16x16x32_bf16 v[180:183], a[204:207], a[116:119], v[180:183]
s_add_u32 m0, s3, 36864
ds_read_b64_tr_b16 a[204:205], v211 offset:24576
ds_read_b64_tr_b16 a[206:207], v211 offset:28672
v_mfma_f32_16x16x32_bf16 v[152:155], a[208:211], a[112:115], v[152:155]
s_add_u32 s48, s44, 165888
v_mfma_f32_16x16x32_bf16 v[184:187], a[208:211], a[116:119], v[184:187]
s_waitcnt lgkmcnt(8)
buffer_load_dwordx4 v236, s[16:19], s48 offen lds
v_mfma_f32_16x16x32_bf16 v[156:159], a[212:215], a[112:115], v[156:159]
ds_read_b64_tr_b16 a[208:209], v212 offset:24576
ds_read_b64_tr_b16 a[210:211], v212 offset:28672
v_mfma_f32_16x16x32_bf16 v[188:191], a[212:215], a[116:119], v[188:191]
s_add_u32 m0, s3, 40960
ds_read_b64_tr_b16 a[212:213], v213 offset:24576
ds_read_b64_tr_b16 a[214:215], v213 offset:28672
v_mfma_f32_16x16x32_bf16 v[160:163], a[216:219], a[112:115], v[160:163]
s_add_u32 s48, s44, 184320
v_mfma_f32_16x16x32_bf16 v[192:195], a[216:219], a[116:119], v[192:195]
buffer_load_dwordx4 v236, s[16:19], s48 offen lds
v_mfma_f32_16x16x32_bf16 v[164:167], a[220:223], a[112:115], v[164:167]
ds_read_b64_tr_b16 a[216:217], v214 offset:24576
ds_read_b64_tr_b16 a[218:219], v214 offset:28672
v_mfma_f32_16x16x32_bf16 v[196:199], a[220:223], a[116:119], v[196:199]
s_waitcnt lgkmcnt(10)
ds_read_b64_tr_b16 a[220:221], v215 offset:24576
ds_read_b64_tr_b16 a[222:223], v215 offset:28672
v_mfma_f32_16x16x32_bf16 v[136:139], a[192:195], a[120:123], v[136:139]
v_mfma_f32_16x16x32_bf16 v[168:171], a[192:195], a[124:127], v[168:171]
v_mfma_f32_16x16x32_bf16 v[140:143], a[196:199], a[120:123], v[140:143]
v_mfma_f32_16x16x32_bf16 v[172:175], a[196:199], a[124:127], v[172:175]
s_waitcnt lgkmcnt(8)
v_mfma_f32_16x16x32_bf16 v[144:147], a[200:203], a[120:123], v[144:147]
s_waitcnt vmcnt(19) lgkmcnt(0)
s_barrier
v_mfma_f32_16x16x32_bf16 v[176:179], a[200:203], a[124:127], v[176:179]
s_add_u32 m0, s3, 45056
ds_read_b64_tr_b16 a[192:193], v200 offset:0
ds_read_b64_tr_b16 a[194:195], v200 offset:4096
v_mfma_f32_16x16x32_bf16 v[148:151], a[204:207], a[120:123], v[148:151]
s_add_u32 s48, s44, 202752
ds_read_b64_tr_b16 a[196:197], v201 offset:0
ds_read_b64_tr_b16 a[198:199], v201 offset:4096
v_mfma_f32_16x16x32_bf16 v[180:183], a[204:207], a[124:127], v[180:183]
buffer_load_dwordx4 v236, s[16:19], s48 offen lds
v_mfma_f32_16x16x32_bf16 v[152:155], a[208:211], a[120:123], v[152:155]
s_add_u32 m0, s3, 49152
ds_read_b64_tr_b16 a[200:201], v202 offset:0
ds_read_b64_tr_b16 a[202:203], v202 offset:4096
v_mfma_f32_16x16x32_bf16 v[184:187], a[208:211], a[124:127], v[184:187]
s_add_u32 s48, s44, 221184
ds_read_b64_tr_b16 a[204:205], v203 offset:0
ds_read_b64_tr_b16 a[206:207], v203 offset:4096
v_mfma_f32_16x16x32_bf16 v[156:159], a[212:215], a[120:123], v[156:159]
buffer_load_dwordx4 v236, s[16:19], s48 offen lds
v_mfma_f32_16x16x32_bf16 v[188:191], a[212:215], a[124:127], v[188:191]
ds_read_b64_tr_b16 a[208:209], v204 offset:0
ds_read_b64_tr_b16 a[210:211], v204 offset:4096
v_mfma_f32_16x16x32_bf16 v[160:163], a[216:219], a[120:123], v[160:163]
s_add_u32 m0, s3, 53248
ds_read_b64_tr_b16 a[212:213], v205 offset:0
ds_read_b64_tr_b16 a[214:215], v205 offset:4096
v_mfma_f32_16x16x32_bf16 v[192:195], a[216:219], a[124:127], v[192:195]
s_add_u32 s48, s44, 239616
ds_read_b64_tr_b16 a[216:217], v206 offset:0
ds_read_b64_tr_b16 a[218:219], v206 offset:4096
v_mfma_f32_16x16x32_bf16 v[164:167], a[220:223], a[120:123], v[164:167]
buffer_load_dwordx4 v236, s[16:19], s48 offen lds
v_mfma_f32_16x16x32_bf16 v[196:199], a[220:223], a[124:127], v[196:199]
s_waitcnt lgkmcnt(12)
ds_read_b64_tr_b16 a[220:221], v207 offset:0
ds_read_b64_tr_b16 a[222:223], v207 offset:4096
s_waitcnt vmcnt(6)
s_waitcnt vmcnt(14)
s_lshl_b32 s46, s33, 2
s_add_u32 s46, s46, s86
s_mov_b64 exec, 1
buffer_store_dword v5, v234, s[20:23], s46 offen sc0 sc1
s_mov_b64 exec, -1
v_mfma_f32_16x16x32_bf16 v[136:139], a[192:195], a[128:131], v[136:139]
s_add_u32 m0, s3, 57344
v_mfma_f32_16x16x32_bf16 v[168:171], a[192:195], a[132:135], v[168:171]
s_waitcnt lgkmcnt(12)
s_add_u32 s48, s44, 258048
ds_read_b64_tr_b16 a[192:193], v200 offset:8192
ds_read_b64_tr_b16 a[194:195], v200 offset:12288
v_mfma_f32_16x16x32_bf16 v[140:143], a[196:199], a[128:131], v[140:143]
s_waitcnt lgkmcnt(12)
buffer_load_dwordx4 v236, s[16:19], s48 offen lds
v_mfma_f32_16x16x32_bf16 v[172:175], a[196:199], a[132:135], v[172:175]
s_add_u32 m0, s3, 61440
ds_read_b64_tr_b16 a[196:197], v201 offset:8192
ds_read_b64_tr_b16 a[198:199], v201 offset:12288
v_mfma_f32_16x16x32_bf16 v[144:147], a[200:203], a[128:131], v[144:147]
s_add_u32 s48, s44, 276480
v_mfma_f32_16x16x32_bf16 v[176:179], a[200:203], a[132:135], v[176:179]
s_waitcnt lgkmcnt(10)
buffer_load_dwordx4 v236, s[16:19], s48 offen lds
v_mfma_f32_16x16x32_bf16 v[148:151], a[204:207], a[128:131], v[148:151]
ds_read_b64_tr_b16 a[200:201], v202 offset:8192
ds_read_b64_tr_b16 a[202:203], v202 offset:12288
v_mfma_f32_16x16x32_bf16 v[180:183], a[204:207], a[132:135], v[180:183]
s_add_u32 s94, s92, 8192
ds_read_b64_tr_b16 a[204:205], v203 offset:8192
ds_read_b64_tr_b16 a[206:207], v203 offset:12288
v_mfma_f32_16x16x32_bf16 v[152:155], a[208:211], a[128:131], v[152:155]
buffer_load_dwordx4 a[160:163], v234, s[20:23], s94 offen offset:0 sc0 sc1
v_mfma_f32_16x16x32_bf16 v[184:187], a[208:211], a[132:135], v[184:187]
s_waitcnt lgkmcnt(8)
ds_read_b64_tr_b16 a[208:209], v204 offset:8192
ds_read_b64_tr_b16 a[210:211], v204 offset:12288
v_mfma_f32_16x16x32_bf16 v[156:159], a[212:215], a[128:131], v[156:159]
s_add_u32 s94, s92, 8192
v_mfma_f32_16x16x32_bf16 v[188:191], a[212:215], a[132:135], v[188:191]
buffer_load_dwordx4 a[164:167], v234, s[20:23], s94 offen offset:1024 sc0 sc1
v_mfma_f32_16x16x32_bf16 v[160:163], a[216:219], a[128:131], v[160:163]
ds_read_b64_tr_b16 a[212:213], v205 offset:8192
ds_read_b64_tr_b16 a[214:215], v205 offset:12288
v_mfma_f32_16x16x32_bf16 v[192:195], a[216:219], a[132:135], v[192:195]
ds_read_b64_tr_b16 a[216:217], v206 offset:8192
ds_read_b64_tr_b16 a[218:219], v206 offset:12288
v_mfma_f32_16x16x32_bf16 v[164:167], a[220:223], a[128:131], v[164:167]
v_mfma_f32_16x16x32_bf16 v[196:199], a[220:223], a[132:135], v[196:199]
s_waitcnt lgkmcnt(10)
ds_read_b64_tr_b16 a[220:221], v207 offset:8192
ds_read_b64_tr_b16 a[222:223], v207 offset:12288
v_mfma_f32_16x16x32_bf16 v[136:139], a[192:195], a[136:139], v[136:139]
s_add_u32 s94, s92, 8192
v_mfma_f32_16x16x32_bf16 v[168:171], a[192:195], a[140:143], v[168:171]
buffer_load_dwordx4 a[168:171], v234, s[20:23], s94 offen offset:2048 sc0 sc1
v_mfma_f32_16x16x32_bf16 v[140:143], a[196:199], a[136:139], v[140:143]
s_add_u32 s94, s92, 8192
ds_read_b64_tr_b16 a[192:193], v200 offset:16384
ds_read_b64_tr_b16 a[194:195], v200 offset:20480
v_mfma_f32_16x16x32_bf16 v[172:175], a[196:199], a[140:143], v[172:175]
s_waitcnt lgkmcnt(8)
buffer_load_dwordx4 a[172:175], v234, s[20:23], s94 offen offset:3072 sc0 sc1
v_mfma_f32_16x16x32_bf16 v[144:147], a[200:203], a[136:139], v[144:147]
ds_read_b64_tr_b16 a[196:197], v201 offset:16384
ds_read_b64_tr_b16 a[198:199], v201 offset:20480
v_mfma_f32_16x16x32_bf16 v[176:179], a[200:203], a[140:143], v[176:179]
s_add_u32 s94, s92, 12288
ds_read_b64_tr_b16 a[200:201], v202 offset:16384
ds_read_b64_tr_b16 a[202:203], v202 offset:20480
v_mfma_f32_16x16x32_bf16 v[148:151], a[204:207], a[136:139], v[148:151]
buffer_load_dwordx4 a[176:179], v234, s[20:23], s94 offen offset:0 sc0 sc1
v_mfma_f32_16x16x32_bf16 v[180:183], a[204:207], a[140:143], v[180:183]
ds_read_b64_tr_b16 a[204:205], v203 offset:16384
ds_read_b64_tr_b16 a[206:207], v203 offset:20480
v_mfma_f32_16x16x32_bf16 v[152:155], a[208:211], a[136:139], v[152:155]
s_add_u32 s94, s92, 12288
v_mfma_f32_16x16x32_bf16 v[184:187], a[208:211], a[140:143], v[184:187]
s_waitcnt lgkmcnt(8)
buffer_load_dwordx4 a[180:183], v234, s[20:23], s94 offen offset:1024 sc0 sc1
v_mfma_f32_16x16x32_bf16 v[156:159], a[212:215], a[136:139], v[156:159]
ds_read_b64_tr_b16 a[208:209], v204 offset:16384
ds_read_b64_tr_b16 a[210:211], v204 offset:20480
v_mfma_f32_16x16x32_bf16 v[188:191], a[212:215], a[140:143], v[188:191]
s_add_u32 s94, s92, 12288
ds_read_b64_tr_b16 a[212:213], v205 offset:16384
ds_read_b64_tr_b16 a[214:215], v205 offset:20480
v_mfma_f32_16x16x32_bf16 v[160:163], a[216:219], a[136:139], v[160:163]
buffer_load_dwordx4 a[184:187], v234, s[20:23], s94 offen offset:2048 sc0 sc1
v_mfma_f32_16x16x32_bf16 v[192:195], a[216:219], a[140:143], v[192:195]
ds_read_b64_tr_b16 a[216:217], v206 offset:16384
ds_read_b64_tr_b16 a[218:219], v206 offset:20480
v_mfma_f32_16x16x32_bf16 v[164:167], a[220:223], a[136:139], v[164:167]
v_mfma_f32_16x16x32_bf16 v[196:199], a[220:223], a[140:143], v[196:199]
s_waitcnt lgkmcnt(8)
ds_read_b64_tr_b16 a[220:221], v207 offset:16384
ds_read_b64_tr_b16 a[222:223], v207 offset:20480
v_mfma_f32_16x16x32_bf16 v[136:139], a[192:195], a[144:147], v[136:139]
s_add_u32 s94, s92, 12288
v_mfma_f32_16x16x32_bf16 v[168:171], a[192:195], a[148:151], v[168:171]
buffer_load_dwordx4 a[188:191], v234, s[20:23], s94 offen offset:3072 sc0 sc1
v_mfma_f32_16x16x32_bf16 v[140:143], a[196:199], a[144:147], v[140:143]
ds_read_b64_tr_b16 a[192:193], v200 offset:24576
ds_read_b64_tr_b16 a[194:195], v200 offset:28672
v_mfma_f32_16x16x32_bf16 v[172:175], a[196:199], a[148:151], v[172:175]
ds_read_b64_tr_b16 a[196:197], v201 offset:24576
ds_read_b64_tr_b16 a[198:199], v201 offset:28672
v_mfma_f32_16x16x32_bf16 v[144:147], a[200:203], a[144:147], v[144:147]
v_mfma_f32_16x16x32_bf16 v[176:179], a[200:203], a[148:151], v[176:179]
s_waitcnt lgkmcnt(8)
ds_read_b64_tr_b16 a[200:201], v202 offset:24576
ds_read_b64_tr_b16 a[202:203], v202 offset:28672
v_mfma_f32_16x16x32_bf16 v[148:151], a[204:207], a[144:147], v[148:151]
v_mfma_f32_16x16x32_bf16 v[180:183], a[204:207], a[148:151], v[180:183]
ds_read_b64_tr_b16 a[204:205], v203 offset:24576
ds_read_b64_tr_b16 a[206:207], v203 offset:28672
v_mfma_f32_16x16x32_bf16 v[152:155], a[208:211], a[144:147], v[152:155]
v_mfma_f32_16x16x32_bf16 v[184:187], a[208:211], a[148:151], v[184:187]
ds_read_b64_tr_b16 a[208:209], v204 offset:24576
ds_read_b64_tr_b16 a[210:211], v204 offset:28672
v_mfma_f32_16x16x32_bf16 v[156:159], a[212:215], a[144:147], v[156:159]
v_mfma_f32_16x16x32_bf16 v[188:191], a[212:215], a[148:151], v[188:191]
s_waitcnt lgkmcnt(10)
ds_read_b64_tr_b16 a[212:213], v205 offset:24576
ds_read_b64_tr_b16 a[214:215], v205 offset:28672
v_mfma_f32_16x16x32_bf16 v[160:163], a[216:219], a[144:147], v[160:163]
v_mfma_f32_16x16x32_bf16 v[192:195], a[216:219], a[148:151], v[192:195]
ds_read_b64_tr_b16 a[216:217], v206 offset:24576
ds_read_b64_tr_b16 a[218:219], v206 offset:28672
v_mfma_f32_16x16x32_bf16 v[164:167], a[220:223], a[144:147], v[164:167]
v_mfma_f32_16x16x32_bf16 v[196:199], a[220:223], a[148:151], v[196:199]
s_waitcnt lgkmcnt(8)
ds_read_b64_tr_b16 a[220:221], v207 offset:24576
ds_read_b64_tr_b16 a[222:223], v207 offset:28672
v_mfma_f32_16x16x32_bf16 v[136:139], a[192:195], a[152:155], v[136:139]
v_mfma_f32_16x16x32_bf16 v[168:171], a[192:195], a[156:159], v[168:171]
v_mfma_f32_16x16x32_bf16 v[140:143], a[196:199], a[152:155], v[140:143]
v_mfma_f32_16x16x32_bf16 v[172:175], a[196:199], a[156:159], v[172:175]
v_mfma_f32_16x16x32_bf16 v[144:147], a[200:203], a[152:155], v[144:147]
s_waitcnt vmcnt(8) lgkmcnt(0)
s_barrier
v_mfma_f32_16x16x32_bf16 v[176:179], a[200:203], a[156:159], v[176:179]
ds_read_b64_tr_b16 a[192:193], v200 offset:32768
ds_read_b64_tr_b16 a[194:195], v200 offset:36864
v_mfma_f32_16x16x32_bf16 v[148:151], a[204:207], a[152:155], v[148:151]
ds_read_b64_tr_b16 a[196:197], v201 offset:32768
ds_read_b64_tr_b16 a[198:199], v201 offset:36864
v_mfma_f32_16x16x32_bf16 v[180:183], a[204:207], a[156:159], v[180:183]
ds_read_b64_tr_b16 a[200:201], v202 offset:32768
ds_read_b64_tr_b16 a[202:203], v202 offset:36864
v_mfma_f32_16x16x32_bf16 v[152:155], a[208:211], a[152:155], v[152:155]
ds_read_b64_tr_b16 a[204:205], v203 offset:32768
ds_read_b64_tr_b16 a[206:207], v203 offset:36864
v_mfma_f32_16x16x32_bf16 v[184:187], a[208:211], a[156:159], v[184:187]
ds_read_b64_tr_b16 a[208:209], v204 offset:32768
ds_read_b64_tr_b16 a[210:211], v204 offset:36864
v_mfma_f32_16x16x32_bf16 v[156:159], a[212:215], a[152:155], v[156:159]
v_mfma_f32_16x16x32_bf16 v[188:191], a[212:215], a[156:159], v[188:191]
ds_read_b64_tr_b16 a[212:213], v205 offset:32768
ds_read_b64_tr_b16 a[214:215], v205 offset:36864
v_mfma_f32_16x16x32_bf16 v[160:163], a[216:219], a[152:155], v[160:163]
v_mfma_f32_16x16x32_bf16 v[192:195], a[216:219], a[156:159], v[192:195]
ds_read_b64_tr_b16 a[216:217], v206 offset:32768
ds_read_b64_tr_b16 a[218:219], v206 offset:36864
v_mfma_f32_16x16x32_bf16 v[164:167], a[220:223], a[152:155], v[164:167]
v_mfma_f32_16x16x32_bf16 v[196:199], a[220:223], a[156:159], v[196:199]
s_waitcnt lgkmcnt(12)
ds_read_b64_tr_b16 a[220:221], v207 offset:32768
ds_read_b64_tr_b16 a[222:223], v207 offset:36864
s_waitcnt vmcnt(0)
v_mfma_f32_16x16x32_bf16 v[136:139], a[192:195], a[160:163], v[136:139]
v_mfma_f32_16x16x32_bf16 v[168:171], a[192:195], a[164:167], v[168:171]
s_waitcnt lgkmcnt(10)
ds_read_b64_tr_b16 a[192:193], v200 offset:40960
ds_read_b64_tr_b16 a[194:195], v200 offset:45056
v_mfma_f32_16x16x32_bf16 v[140:143], a[196:199], a[160:163], v[140:143]
v_mfma_f32_16x16x32_bf16 v[172:175], a[196:199], a[164:167], v[172:175]
ds_read_b64_tr_b16 a[196:197], v201 offset:40960
ds_read_b64_tr_b16 a[198:199], v201 offset:45056
v_mfma_f32_16x16x32_bf16 v[144:147], a[200:203], a[160:163], v[144:147]
v_mfma_f32_16x16x32_bf16 v[176:179], a[200:203], a[164:167], v[176:179]
s_waitcnt lgkmcnt(8)
ds_read_b64_tr_b16 a[200:201], v202 offset:40960
ds_read_b64_tr_b16 a[202:203], v202 offset:45056
v_mfma_f32_16x16x32_bf16 v[148:151], a[204:207], a[160:163], v[148:151]
v_mfma_f32_16x16x32_bf16 v[180:183], a[204:207], a[164:167], v[180:183]
ds_read_b64_tr_b16 a[204:205], v203 offset:40960
ds_read_b64_tr_b16 a[206:207], v203 offset:45056
v_mfma_f32_16x16x32_bf16 v[152:155], a[208:211], a[160:163], v[152:155]
v_mfma_f32_16x16x32_bf16 v[184:187], a[208:211], a[164:167], v[184:187]
ds_read_b64_tr_b16 a[208:209], v204 offset:40960
ds_read_b64_tr_b16 a[210:211], v204 offset:45056
v_mfma_f32_16x16x32_bf16 v[156:159], a[212:215], a[160:163], v[156:159]
v_mfma_f32_16x16x32_bf16 v[188:191], a[212:215], a[164:167], v[188:191]
s_waitcnt lgkmcnt(8)
ds_read_b64_tr_b16 a[212:213], v205 offset:40960
ds_read_b64_tr_b16 a[214:215], v205 offset:45056
v_mfma_f32_16x16x32_bf16 v[160:163], a[216:219], a[160:163], v[160:163]
v_mfma_f32_16x16x32_bf16 v[192:195], a[216:219], a[164:167], v[192:195]
ds_read_b64_tr_b16 a[216:217], v206 offset:40960
ds_read_b64_tr_b16 a[218:219], v206 offset:45056
v_mfma_f32_16x16x32_bf16 v[164:167], a[220:223], a[160:163], v[164:167]
v_mfma_f32_16x16x32_bf16 v[196:199], a[220:223], a[164:167], v[196:199]
ds_read_b64_tr_b16 a[220:221], v207 offset:40960
ds_read_b64_tr_b16 a[222:223], v207 offset:45056
v_cmp_gt_u32 vcc, 16, v248
v_lshlrev_b32 v6, 7, v3
v_add_u32 v6, 0x272800, v6
s_and_b32 s93, vcc_lo, 0xff
s_cselect_b32 s47, 0, 0x7f000000
v_mfma_f32_16x16x32_bf16 v[136:139], a[192:195], a[168:171], v[136:139]
buffer_load_dword v246, v7, s[20:23], s86 offen sc0 sc1
v_mfma_f32_16x16x32_bf16 v[168:171], a[192:195], a[172:175], v[168:171]
s_waitcnt lgkmcnt(8)
ds_read_b64_tr_b16 a[192:193], v200 offset:49152
ds_read_b64_tr_b16 a[194:195], v200 offset:53248
v_mfma_f32_16x16x32_bf16 v[140:143], a[196:199], a[168:171], v[140:143]
v_mfma_f32_16x16x32_bf16 v[172:175], a[196:199], a[172:175], v[172:175]
ds_read_b64_tr_b16 a[196:197], v201 offset:49152
ds_read_b64_tr_b16 a[198:199], v201 offset:53248
v_mfma_f32_16x16x32_bf16 v[144:147], a[200:203], a[168:171], v[144:147]
buffer_load_dword v247, v6, s[20:23], s47 offen sc0 sc1
v_mfma_f32_16x16x32_bf16 v[176:179], a[200:203], a[172:175], v[176:179]
ds_read_b64_tr_b16 a[200:201], v202 offset:49152
ds_read_b64_tr_b16 a[202:203], v202 offset:53248
v_mfma_f32_16x16x32_bf16 v[148:151], a[204:207], a[168:171], v[148:151]
v_mfma_f32_16x16x32_bf16 v[180:183], a[204:207], a[172:175], v[180:183]
s_waitcnt lgkmcnt(8)
ds_read_b64_tr_b16 a[204:205], v203 offset:49152
ds_read_b64_tr_b16 a[206:207], v203 offset:53248
v_mfma_f32_16x16x32_bf16 v[152:155], a[208:211], a[168:171], v[152:155]
v_mfma_f32_16x16x32_bf16 v[184:187], a[208:211], a[172:175], v[184:187]
ds_read_b64_tr_b16 a[208:209], v204 offset:49152
ds_read_b64_tr_b16 a[210:211], v204 offset:53248
v_mfma_f32_16x16x32_bf16 v[156:159], a[212:215], a[168:171], v[156:159]
v_mfma_f32_16x16x32_bf16 v[188:191], a[212:215], a[172:175], v[188:191]
ds_read_b64_tr_b16 a[212:213], v205 offset:49152
ds_read_b64_tr_b16 a[214:215], v205 offset:53248
v_mfma_f32_16x16x32_bf16 v[160:163], a[216:219], a[168:171], v[160:163]
v_mfma_f32_16x16x32_bf16 v[192:195], a[216:219], a[172:175], v[192:195]
s_waitcnt lgkmcnt(8)
ds_read_b64_tr_b16 a[216:217], v206 offset:49152
ds_read_b64_tr_b16 a[218:219], v206 offset:53248
v_mfma_f32_16x16x32_bf16 v[164:167], a[220:223], a[168:171], v[164:167]
v_mfma_f32_16x16x32_bf16 v[196:199], a[220:223], a[172:175], v[196:199]
ds_read_b64_tr_b16 a[220:221], v207 offset:49152
ds_read_b64_tr_b16 a[222:223], v207 offset:53248
v_mfma_f32_16x16x32_bf16 v[136:139], a[192:195], a[176:179], v[136:139]
v_mfma_f32_16x16x32_bf16 v[168:171], a[192:195], a[180:183], v[168:171]
ds_read_b64_tr_b16 a[192:193], v200 offset:57344
ds_read_b64_tr_b16 a[194:195], v200 offset:61440
v_mfma_f32_16x16x32_bf16 v[140:143], a[196:199], a[176:179], v[140:143]
v_mfma_f32_16x16x32_bf16 v[172:175], a[196:199], a[180:183], v[172:175]
s_waitcnt lgkmcnt(8)
ds_read_b64_tr_b16 a[196:197], v201 offset:57344
ds_read_b64_tr_b16 a[198:199], v201 offset:61440
v_mfma_f32_16x16x32_bf16 v[144:147], a[200:203], a[176:179], v[144:147]
v_mfma_f32_16x16x32_bf16 v[176:179], a[200:203], a[180:183], v[176:179]
ds_read_b64_tr_b16 a[200:201], v202 offset:57344
ds_read_b64_tr_b16 a[202:203], v202 offset:61440
v_mfma_f32_16x16x32_bf16 v[148:151], a[204:207], a[176:179], v[148:151]
v_mfma_f32_16x16x32_bf16 v[180:183], a[204:207], a[180:183], v[180:183]
ds_read_b64_tr_b16 a[204:205], v203 offset:57344
ds_read_b64_tr_b16 a[206:207], v203 offset:61440
v_mfma_f32_16x16x32_bf16 v[152:155], a[208:211], a[176:179], v[152:155]
v_mfma_f32_16x16x32_bf16 v[184:187], a[208:211], a[180:183], v[184:187]
s_waitcnt lgkmcnt(8)
ds_read_b64_tr_b16 a[208:209], v204 offset:57344
ds_read_b64_tr_b16 a[210:211], v204 offset:61440
v_mfma_f32_16x16x32_bf16 v[156:159], a[212:215], a[176:179], v[156:159]
v_mfma_f32_16x16x32_bf16 v[188:191], a[212:215], a[180:183], v[188:191]
ds_read_b64_tr_b16 a[212:213], v205 offset:57344
ds_read_b64_tr_b16 a[214:215], v205 offset:61440
v_mfma_f32_16x16x32_bf16 v[160:163], a[216:219], a[176:179], v[160:163]
v_mfma_f32_16x16x32_bf16 v[192:195], a[216:219], a[180:183], v[192:195]
ds_read_b64_tr_b16 a[216:217], v206 offset:57344
ds_read_b64_tr_b16 a[218:219], v206 offset:61440
v_mfma_f32_16x16x32_bf16 v[164:167], a[220:223], a[176:179], v[164:167]
v_mfma_f32_16x16x32_bf16 v[196:199], a[220:223], a[180:183], v[196:199]
s_waitcnt lgkmcnt(8)
ds_read_b64_tr_b16 a[220:221], v207 offset:57344
ds_read_b64_tr_b16 a[222:223], v207 offset:61440
v_mfma_f32_16x16x32_bf16 v[136:139], a[192:195], a[184:187], v[136:139]
v_mfma_f32_16x16x32_bf16 v[168:171], a[192:195], a[188:191], v[168:171]
v_mfma_f32_16x16x32_bf16 v[140:143], a[196:199], a[184:187], v[140:143]
v_mfma_f32_16x16x32_bf16 v[172:175], a[196:199], a[188:191], v[172:175]
v_mfma_f32_16x16x32_bf16 v[144:147], a[200:203], a[184:187], v[144:147]
v_mfma_f32_16x16x32_bf16 v[176:179], a[200:203], a[188:191], v[176:179]
s_waitcnt lgkmcnt(4)
v_mfma_f32_16x16x32_bf16 v[148:151], a[204:207], a[184:187], v[148:151]
v_mfma_f32_16x16x32_bf16 v[180:183], a[204:207], a[188:191], v[180:183]
v_mfma_f32_16x16x32_bf16 v[152:155], a[208:211], a[184:187], v[152:155]
v_mfma_f32_16x16x32_bf16 v[184:187], a[208:211], a[188:191], v[184:187]
v_mfma_f32_16x16x32_bf16 v[156:159], a[212:215], a[184:187], v[156:159]
v_mfma_f32_16x16x32_bf16 v[188:191], a[212:215], a[188:191], v[188:191]
s_waitcnt lgkmcnt(0)
v_mfma_f32_16x16x32_bf16 v[160:163], a[216:219], a[184:187], v[160:163]
v_mfma_f32_16x16x32_bf16 v[192:195], a[216:219], a[188:191], v[192:195]
v_mfma_f32_16x16x32_bf16 v[164:167], a[220:223], a[184:187], v[164:167]
v_mfma_f32_16x16x32_bf16 v[196:199], a[220:223], a[188:191], v[196:199]
s_lshl_b32 s95, s35, 2
s_add_u32 s95, s95, s63
s_lshl_b32 s46, s35, 7
s_add_u32 s63, s63, s46
v_cvt_pk_bf16_f32 v200, v168, v169
v_cvt_pk_bf16_f32 v201, v170, v171
v_cvt_pk_bf16_f32 v202, v172, v173
v_cvt_pk_bf16_f32 v203, v174, v175
buffer_store_dwordx4 v[200:203], v234, s[20:23], s65 offen offset:0 sc0 sc1
v_cvt_pk_bf16_f32 v204, v176, v177
v_cvt_pk_bf16_f32 v205, v178, v179
v_cvt_pk_bf16_f32 v206, v180, v181
v_cvt_pk_bf16_f32 v207, v182, v183
buffer_store_dwordx4 v[204:207], v234, s[20:23], s65 offen offset:1024 sc0 sc1
v_cvt_pk_bf16_f32 v208, v152, v153
v_cvt_pk_bf16_f32 v209, v154, v155
v_cvt_pk_bf16_f32 v210, v156, v157
v_cvt_pk_bf16_f32 v211, v158, v159
buffer_store_dwordx4 v[208:211], v234, s[20:23], s64 offen offset:0 sc0 sc1
v_cvt_pk_bf16_f32 v212, v160, v161
v_cvt_pk_bf16_f32 v213, v162, v163
v_cvt_pk_bf16_f32 v214, v164, v165
v_cvt_pk_bf16_f32 v215, v166, v167
buffer_store_dwordx4 v[212:215], v234, s[20:23], s64 offen offset:1024 sc0 sc1
v_cvt_pk_bf16_f32 v216, v184, v185
v_cvt_pk_bf16_f32 v217, v186, v187
v_cvt_pk_bf16_f32 v218, v188, v189
v_cvt_pk_bf16_f32 v219, v190, v191
buffer_store_dwordx4 v[216:219], v234, s[20:23], s66 offen offset:0 sc0 sc1
v_cvt_pk_bf16_f32 v220, v192, v193
v_cvt_pk_bf16_f32 v221, v194, v195
v_cvt_pk_bf16_f32 v222, v196, v197
v_cvt_pk_bf16_f32 v223, v198, v199
buffer_store_dwordx4 v[220:223], v234, s[20:23], s66 offen offset:1024 sc0 sc1
s_waitcnt vmcnt(6)
v_cmp_ne_u32 vcc, 1, v246
s_and_b32 s46, s35, 1
s_or_b32 s46, s46, vcc_lo
s_cselect_b32 s67, 0, 1
s_cbranch_scc1 K_NOER
s_add_u32 s48, s87, 4096
buffer_load_dwordx2 v[40:41], v250, s[20:23], s87 offen offset:0 sc0 sc1
buffer_load_dwordx2 v[42:43], v250, s[20:23], s87 offen offset:512 sc0 sc1
buffer_load_dwordx2 v[44:45], v250, s[20:23], s87 offen offset:1024 sc0 sc1
buffer_load_dwordx2 v[46:47], v250, s[20:23], s87 offen offset:1536 sc0 sc1
buffer_load_dwordx2 v[48:49], v250, s[20:23], s87 offen offset:2048 sc0 sc1
buffer_load_dwordx2 v[50:51], v250, s[20:23], s87 offen offset:2560 sc0 sc1
buffer_load_dwordx2 v[52:53], v250, s[20:23], s87 offen offset:3072 sc0 sc1
buffer_load_dwordx2 v[54:55], v250, s[20:23], s87 offen offset:3584 sc0 sc1
buffer_load_dwordx2 v[56:57], v250, s[20:23], s48 offen offset:0 sc0 sc1
buffer_load_dwordx2 v[58:59], v250, s[20:23], s48 offen offset:512 sc0 sc1
buffer_load_dwordx2 v[60:61], v250, s[20:23], s48 offen offset:1024 sc0 sc1
buffer_load_dwordx2 v[62:63], v250, s[20:23], s48 offen offset:1536 sc0 sc1
buffer_load_dwordx2 v[64:65], v250, s[20:23], s48 offen offset:2048 sc0 sc1
buffer_load_dwordx2 v[66:67], v250, s[20:23], s48 offen offset:2560 sc0 sc1
buffer_load_dwordx2 v[68:69], v250, s[20:23], s48 offen offset:3072 sc0 sc1
buffer_load_dwordx2 v[70:71], v250, s[20:23], s48 offen offset:3584 sc0 sc1
K_NOER:
v_lshlrev_b32 v30, 16, v120
v_and_b32 v31, s56, v120
v_lshlrev_b32 v32, 16, v121
v_and_b32 v33, s56, v121
v_pk_add_f32 v[30:31], v[30:31], v[130:131] op_sel_hi:[1,0] neg_lo:[0,1] neg_hi:[0,1]
v_pk_add_f32 v[32:33], v[32:33], v[130:131] op_sel_hi:[1,0] neg_lo:[0,1] neg_hi:[0,1]
v_cvt_pk_bf16_f32 v28, v30, v31
v_cvt_pk_bf16_f32 v29, v32, v33
v_lshlrev_b32 v30, 16, v28
v_and_b32 v31, s56, v28
v_lshlrev_b32 v32, 16, v29
v_and_b32 v33, s56, v29
v_pk_mul_f32 v[8:9], v[30:31], v[132:133] op_sel_hi:[1,0]
v_pk_mul_f32 v[10:11], v[32:33], v[132:133] op_sel_hi:[1,0]
v_pk_fma_f32 v[30:31], v[8:9], v[130:131], v[30:31] op_sel:[0,1,0] op_sel_hi:[1,1,1] neg_lo:[1,0,0] neg_hi:[1,0,0]
v_pk_fma_f32 v[32:33], v[10:11], v[130:131], v[32:33] op_sel:[0,1,0] op_sel_hi:[1,1,1] neg_lo:[1,0,0] neg_hi:[1,0,0]
v_pk_fma_f32 v[8:9], v[30:31], v[132:133], v[8:9] op_sel_hi:[1,0,1]
v_pk_fma_f32 v[10:11], v[32:33], v[132:133], v[10:11] op_sel_hi:[1,0,1]
v_cvt_pk_bf16_f32 v28, v8, v9
v_cvt_pk_bf16_f32 v29, v10, v11
v_lshlrev_b32 v8, 16, v28
v_and_b32 v9, s56, v28
v_lshlrev_b32 v10, 16, v29
v_and_b32 v11, s56, v29
v_mul_f32 v30, s57, v8
v_mul_f32 v31, s57, v9
v_mul_f32 v32, s57, v10
v_mul_f32 v33, s57, v11
v_exp_f32 v30, v30
v_exp_f32 v31, v31
v_exp_f32 v32, v32
v_exp_f32 v33, v33
s_nop 0
v_add_f32 v30, 1.0, v30
v_add_f32 v31, 1.0, v31
v_add_f32 v32, 1.0, v32
v_add_f32 v33, 1.0, v33
v_rcp_f32 v30, v30
v_rcp_f32 v31, v31
v_rcp_f32 v32, v32
v_rcp_f32 v33, v33
s_nop 0
v_pk_mul_f32 v[8:9], v[8:9], v[30:31]
v_pk_mul_f32 v[10:11], v[10:11], v[32:33]
v_cvt_pk_bf16_f32 v28, v8, v9
v_cvt_pk_bf16_f32 v29, v10, v11
v_lshlrev_b32 v8, 16, v28
v_and_b32 v9, s56, v28
v_lshlrev_b32 v10, 16, v29
v_and_b32 v11, s56, v29
v_lshlrev_b32 v30, 16, v122
v_and_b32 v31, s56, v122
v_lshlrev_b32 v32, 16, v123
v_and_b32 v33, s56, v123
v_pk_add_f32 v[30:31], v[30:31], v[130:131] op_sel_hi:[1,0] neg_lo:[0,1] neg_hi:[0,1]
v_pk_add_f32 v[32:33], v[32:33], v[130:131] op_sel_hi:[1,0] neg_lo:[0,1] neg_hi:[0,1]
v_cvt_pk_bf16_f32 v28, v30, v31
v_cvt_pk_bf16_f32 v29, v32, v33
v_lshlrev_b32 v30, 16, v28
v_and_b32 v31, s56, v28
v_lshlrev_b32 v32, 16, v29
v_and_b32 v33, s56, v29
v_pk_mul_f32 v[12:13], v[30:31], v[132:133] op_sel_hi:[1,0]
v_pk_mul_f32 v[14:15], v[32:33], v[132:133] op_sel_hi:[1,0]
v_pk_fma_f32 v[30:31], v[12:13], v[130:131], v[30:31] op_sel:[0,1,0] op_sel_hi:[1,1,1] neg_lo:[1,0,0] neg_hi:[1,0,0]
v_pk_fma_f32 v[32:33], v[14:15], v[130:131], v[32:33] op_sel:[0,1,0] op_sel_hi:[1,1,1] neg_lo:[1,0,0] neg_hi:[1,0,0]
v_pk_fma_f32 v[12:13], v[30:31], v[132:133], v[12:13] op_sel_hi:[1,0,1]
v_pk_fma_f32 v[14:15], v[32:33], v[132:133], v[14:15] op_sel_hi:[1,0,1]
v_cvt_pk_bf16_f32 v28, v12, v13
v_cvt_pk_bf16_f32 v29, v14, v15
v_lshlrev_b32 v12, 16, v28
v_and_b32 v13, s56, v28
v_lshlrev_b32 v14, 16, v29
v_and_b32 v15, s56, v29
v_mul_f32 v30, s57, v12
v_mul_f32 v31, s57, v13
v_mul_f32 v32, s57, v14
v_mul_f32 v33, s57, v15
v_exp_f32 v30, v30
v_exp_f32 v31, v31
v_exp_f32 v32, v32
v_exp_f32 v33, v33
s_nop 0
v_add_f32 v30, 1.0, v30
v_add_f32 v31, 1.0, v31
v_add_f32 v32, 1.0, v32
v_add_f32 v33, 1.0, v33
v_rcp_f32 v30, v30
v_rcp_f32 v31, v31
v_rcp_f32 v32, v32
v_rcp_f32 v33, v33
s_nop 0
v_pk_mul_f32 v[12:13], v[12:13], v[30:31]
v_pk_mul_f32 v[14:15], v[14:15], v[32:33]
v_cvt_pk_bf16_f32 v28, v12, v13
v_cvt_pk_bf16_f32 v29, v14, v15
v_lshlrev_b32 v12, 16, v28
v_and_b32 v13, s56, v28
v_lshlrev_b32 v14, 16, v29
v_and_b32 v15, s56, v29
s_mov_b32 s47, s67
s_and_b32 s46, s35, 1
s_or_b32 s67, s67, s46
s_cselect_b32 s46, 0, 16
v_and_b32 v153, 3, v1
v_lshl_add_u32 v153, v153, 2, s63
v_add_u32 v7, s86, v7
v_cmp_gt_u32 vcc, s46, v1
s_add_u32 s48, s35, 16
s_nop 0
v_cndmask_b32 v152, v153, v7, vcc
s_waitcnt vmcnt(16)
s_cmp_lg_u32 s47, 0
s_cbranch_scc1 K_FLAGGED
s_waitcnt vmcnt(0)
K_FLAGGED:
buffer_load_dword v246, v152, s[20:23], 0 offen sc0 sc1
s_mov_b32 exec_lo, s38
s_mov_b32 exec_hi, 0
buffer_store_dword v5, v249, s[20:23], s95 offen sc0 sc1
s_mov_b64 exec, -1
v_lshlrev_b32 v30, 16, v124
v_and_b32 v31, s56, v124
v_lshlrev_b32 v32, 16, v125
v_and_b32 v33, s56, v125
v_pk_add_f32 v[30:31], v[30:31], v[130:131] op_sel_hi:[1,0] neg_lo:[0,1] neg_hi:[0,1]
v_pk_add_f32 v[32:33], v[32:33], v[130:131] op_sel_hi:[1,0] neg_lo:[0,1] neg_hi:[0,1]
v_cvt_pk_bf16_f32 v28, v30, v31
v_cvt_pk_bf16_f32 v29, v32, v33
v_lshlrev_b32 v30, 16, v28
v_and_b32 v31, s56, v28
v_lshlrev_b32 v32, 16, v29
v_and_b32 v33, s56, v29
v_pk_mul_f32 v[16:17], v[30:31], v[132:133] op_sel_hi:[1,0]
v_pk_mul_f32 v[18:19], v[32:33], v[132:133] op_sel_hi:[1,0]
v_pk_fma_f32 v[30:31], v[16:17], v[130:131], v[30:31] op_sel:[0,1,0] op_sel_hi:[1,1,1] neg_lo:[1,0,0] neg_hi:[1,0,0]
v_pk_fma_f32 v[32:33], v[18:19], v[130:131], v[32:33] op_sel:[0,1,0] op_sel_hi:[1,1,1] neg_lo:[1,0,0] neg_hi:[1,0,0]
v_pk_fma_f32 v[16:17], v[30:31], v[132:133], v[16:17] op_sel_hi:[1,0,1]
v_pk_fma_f32 v[18:19], v[32:33], v[132:133], v[18:19] op_sel_hi:[1,0,1]
v_cvt_pk_bf16_f32 v28, v16, v17
v_cvt_pk_bf16_f32 v29, v18, v19
v_lshlrev_b32 v16, 16, v28
v_and_b32 v17, s56, v28
v_lshlrev_b32 v18, 16, v29
v_and_b32 v19, s56, v29
v_mul_f32 v30, s57, v16
v_mul_f32 v31, s57, v17
v_mul_f32 v32, s57, v18
v_mul_f32 v33, s57, v19
v_exp_f32 v30, v30
v_exp_f32 v31, v31
v_exp_f32 v32, v32
v_exp_f32 v33, v33
s_nop 0
v_add_f32 v30, 1.0, v30
v_add_f32 v31, 1.0, v31
v_add_f32 v32, 1.0, v32
v_add_f32 v33, 1.0, v33
v_rcp_f32 v30, v30
v_rcp_f32 v31, v31
v_rcp_f32 v32, v32
v_rcp_f32 v33, v33
s_nop 0
v_pk_mul_f32 v[16:17], v[16:17], v[30:31]
v_pk_mul_f32 v[18:19], v[18:19], v[32:33]
v_cvt_pk_bf16_f32 v28, v16, v17
v_cvt_pk_bf16_f32 v29, v18, v19
v_lshlrev_b32 v16, 16, v28
v_and_b32 v17, s56, v28
v_lshlrev_b32 v18, 16, v29
v_and_b32 v19, s56, v29
v_lshlrev_b32 v30, 16, v126
v_and_b32 v31, s56, v126
v_lshlrev_b32 v32, 16, v127
v_and_b32 v33, s56, v127
v_pk_add_f32 v[30:31], v[30:31], v[130:131] op_sel_hi:[1,0] neg_lo:[0,1] neg_hi:[0,1]
v_pk_add_f32 v[32:33], v[32:33], v[130:131] op_sel_hi:[1,0] neg_lo:[0,1] neg_hi:[0,1]
v_cvt_pk_bf16_f32 v28, v30, v31
v_cvt_pk_bf16_f32 v29, v32, v33
v_lshlrev_b32 v30, 16, v28
v_and_b32 v31, s56, v28
v_lshlrev_b32 v32, 16, v29
v_and_b32 v33, s56, v29
v_pk_mul_f32 v[20:21], v[30:31], v[132:133] op_sel_hi:[1,0]
v_pk_mul_f32 v[22:23], v[32:33], v[132:133] op_sel_hi:[1,0]
v_pk_fma_f32 v[30:31], v[20:21], v[130:131], v[30:31] op_sel:[0,1,0] op_sel_hi:[1,1,1] neg_lo:[1,0,0] neg_hi:[1,0,0]
v_pk_fma_f32 v[32:33], v[22:23], v[130:131], v[32:33] op_sel:[0,1,0] op_sel_hi:[1,1,1] neg_lo:[1,0,0] neg_hi:[1,0,0]
v_pk_fma_f32 v[20:21], v[30:31], v[132:133], v[20:21] op_sel_hi:[1,0,1]
v_pk_fma_f32 v[22:23], v[32:33], v[132:133], v[22:23] op_sel_hi:[1,0,1]
v_cvt_pk_bf16_f32 v28, v20, v21
v_cvt_pk_bf16_f32 v29, v22, v23
v_lshlrev_b32 v20, 16, v28
v_and_b32 v21, s56, v28
v_lshlrev_b32 v22, 16, v29
v_and_b32 v23, s56, v29
v_mul_f32 v30, s57, v20
v_mul_f32 v31, s57, v21
v_mul_f32 v32, s57, v22
v_mul_f32 v33, s57, v23
v_exp_f32 v30, v30
v_exp_f32 v31, v31
v_exp_f32 v32, v32
v_exp_f32 v33, v33
s_nop 0
v_add_f32 v30, 1.0, v30
v_add_f32 v31, 1.0, v31
v_add_f32 v32, 1.0, v32
v_add_f32 v33, 1.0, v33
v_rcp_f32 v30, v30
v_rcp_f32 v31, v31
v_rcp_f32 v32, v32
v_rcp_f32 v33, v33
s_nop 0
v_pk_mul_f32 v[20:21], v[20:21], v[30:31]
v_pk_mul_f32 v[22:23], v[22:23], v[32:33]
v_cvt_pk_bf16_f32 v28, v20, v21
v_cvt_pk_bf16_f32 v29, v22, v23
v_lshlrev_b32 v20, 16, v28
v_and_b32 v21, s56, v28
v_lshlrev_b32 v22, 16, v29
v_and_b32 v23, s56, v29
v_lshlrev_b32 v30, 16, v128
v_and_b32 v31, s56, v128
v_lshlrev_b32 v32, 16, v129
v_and_b32 v33, s56, v129
v_pk_add_f32 v[30:31], v[30:31], v[130:131] op_sel_hi:[1,0] neg_lo:[0,1] neg_hi:[0,1]
v_pk_add_f32 v[32:33], v[32:33], v[130:131] op_sel_hi:[1,0] neg_lo:[0,1] neg_hi:[0,1]
v_cvt_pk_bf16_f32 v28, v30, v31
v_cvt_pk_bf16_f32 v29, v32, v33
v_lshlrev_b32 v30, 16, v28
v_and_b32 v31, s56, v28
v_lshlrev_b32 v32, 16, v29
v_and_b32 v33, s56, v29
v_pk_mul_f32 v[24:25], v[30:31], v[132:133] op_sel_hi:[1,0]
v_pk_mul_f32 v[26:27], v[32:33], v[132:133] op_sel_hi:[1,0]
v_pk_fma_f32 v[30:31], v[24:25], v[130:131], v[30:31] op_sel:[0,1,0] op_sel_hi:[1,1,1] neg_lo:[1,0,0] neg_hi:[1,0,0]
v_pk_fma_f32 v[32:33], v[26:27], v[130:131], v[32:33] op_sel:[0,1,0] op_sel_hi:[1,1,1] neg_lo:[1,0,0] neg_hi:[1,0,0]
v_pk_fma_f32 v[24:25], v[30:31], v[132:133], v[24:25] op_sel_hi:[1,0,1]
v_pk_fma_f32 v[26:27], v[32:33], v[132:133], v[26:27] op_sel_hi:[1,0,1]
v_cvt_pk_bf16_f32 v28, v24, v25
v_cvt_pk_bf16_f32 v29, v26, v27
v_lshlrev_b32 v24, 16, v28
v_and_b32 v25, s56, v28
v_lshlrev_b32 v26, 16, v29
v_and_b32 v27, s56, v29
v_mul_f32 v30, s57, v24
v_mul_f32 v31, s57, v25
v_mul_f32 v32, s57, v26
v_mul_f32 v33, s57, v27
v_exp_f32 v30, v30
v_exp_f32 v31, v31
v_exp_f32 v32, v32
v_exp_f32 v33, v33
s_nop 0
v_add_f32 v30, 1.0, v30
v_add_f32 v31, 1.0, v31
v_add_f32 v32, 1.0, v32
v_add_f32 v33, 1.0, v33
v_rcp_f32 v30, v30
v_rcp_f32 v31, v31
v_rcp_f32 v32, v32
v_rcp_f32 v33, v33
s_nop 0
v_pk_mul_f32 v[24:25], v[24:25], v[30:31]
v_pk_mul_f32 v[26:27], v[26:27], v[32:33]
v_cvt_pk_bf16_f32 v28, v24, v25
v_cvt_pk_bf16_f32 v29, v26, v27
v_lshlrev_b32 v24, 16, v28
v_and_b32 v25, s56, v28
v_lshlrev_b32 v26, 16, v29
v_and_b32 v27, s56, v29
s_waitcnt vmcnt(2)
v_lshlrev_b32 v36, 16, v40
v_and_b32 v37, s56, v40
v_lshlrev_b32 v38, 16, v41
v_and_b32 v39, s56, v41
v_dot2_f32_bf16 v36, v42, s58, v36
v_dot2_f32_bf16 v37, v42, s59, v37
v_dot2_f32_bf16 v38, v43, s58, v38
v_dot2_f32_bf16 v39, v43, s59, v39
v_dot2_f32_bf16 v36, v44, s58, v36
v_dot2_f32_bf16 v37, v44, s59, v37
v_dot2_f32_bf16 v38, v45, s58, v38
v_dot2_f32_bf16 v39, v45, s59, v39
v_dot2_f32_bf16 v36, v46, s58, v36
v_dot2_f32_bf16 v37, v46, s59, v37
v_dot2_f32_bf16 v38, v47, s58, v38
v_dot2_f32_bf16 v39, v47, s59, v39
v_dot2_f32_bf16 v36, v48, s58, v36
v_dot2_f32_bf16 v37, v48, s59, v37
v_dot2_f32_bf16 v38, v49, s58, v38
v_dot2_f32_bf16 v39, v49, s59, v39
v_dot2_f32_bf16 v36, v50, s58, v36
v_dot2_f32_bf16 v37, v50, s59, v37
v_dot2_f32_bf16 v38, v51, s58, v38
v_dot2_f32_bf16 v39, v51, s59, v39
v_dot2_f32_bf16 v36, v52, s58, v36
v_dot2_f32_bf16 v37, v52, s59, v37
v_dot2_f32_bf16 v38, v53, s58, v38
v_dot2_f32_bf16 v39, v53, s59, v39
v_dot2_f32_bf16 v36, v54, s58, v36
v_dot2_f32_bf16 v37, v54, s59, v37
v_dot2_f32_bf16 v38, v55, s58, v38
v_dot2_f32_bf16 v39, v55, s59, v39
v_dot2_f32_bf16 v36, v56, s58, v36
v_dot2_f32_bf16 v37, v56, s59, v37
v_dot2_f32_bf16 v38, v57, s58, v38
v_dot2_f32_bf16 v39, v57, s59, v39
v_dot2_f32_bf16 v36, v58, s58, v36
v_dot2_f32_bf16 v37, v58, s59, v37
v_dot2_f32_bf16 v38, v59, s58, v38
v_dot2_f32_bf16 v39, v59, s59, v39
v_dot2_f32_bf16 v36, v60, s58, v36
v_dot2_f32_bf16 v37, v60, s59, v37
v_dot2_f32_bf16 v38, v61, s58, v38
v_dot2_f32_bf16 v39, v61, s59, v39
v_dot2_f32_bf16 v36, v62, s58, v36
v_dot2_f32_bf16 v37, v62, s59, v37
v_dot2_f32_bf16 v38, v63, s58, v38
v_dot2_f32_bf16 v39, v63, s59, v39
v_dot2_f32_bf16 v36, v64, s58, v36
v_dot2_f32_bf16 v37, v64, s59, v37
v_dot2_f32_bf16 v38, v65, s58, v38
v_dot2_f32_bf16 v39, v65, s59, v39
v_dot2_f32_bf16 v36, v66, s58, v36
v_dot2_f32_bf16 v37, v66, s59, v37
v_dot2_f32_bf16 v38, v67, s58, v38
v_dot2_f32_bf16 v39, v67, s59, v39
v_dot2_f32_bf16 v36, v68, s58, v36
v_dot2_f32_bf16 v37, v68, s59, v37
v_dot2_f32_bf16 v38, v69, s58, v38
v_dot2_f32_bf16 v39, v69, s59, v39
v_dot2_f32_bf16 v36, v70, s58, v36
v_dot2_f32_bf16 v37, v70, s59, v37
v_dot2_f32_bf16 v38, v71, s58, v38
v_dot2_f32_bf16 v39, v71, s59, v39
s_cmp_lg_u32 s93, 0
s_cbranch_scc1 K_YG
K_YGD:
s_waitcnt vmcnt(1)
s_branch K_XW
K_XPOLL:
s_sleep 2
s_add_u32 s100, s100, 1
s_bitcmp1_b32 s100, 19
s_cbranch_scc1 K_END
buffer_load_dword v246, v152, s[20:23], 0 offen sc0 sc1
s_waitcnt vmcnt(0)
K_XW:
v_writelane_b32 v246, 1, s48
v_cmp_ne_u32 vcc, 1, v246
s_cmp_lg_u32 s67, 0
s_cbranch_scc1 K_XW2
s_and_b32 s46, vcc_lo, 0xffff
s_cbranch_scc1 K_XPOLL
s_add_u32 s46, s87, 4096
s_mov_b32 s67, 2
v_mov_b32 v152, v153
buffer_load_dwordx2 v[40:41], v250, s[20:23], s87 offen offset:0 sc0 sc1
buffer_load_dwordx2 v[42:43], v250, s[20:23], s87 offen offset:512 sc0 sc1
buffer_load_dwordx2 v[44:45], v250, s[20:23], s87 offen offset:1024 sc0 sc1
buffer_load_dwordx2 v[46:47], v250, s[20:23], s87 offen offset:1536 sc0 sc1
buffer_load_dwordx2 v[48:49], v250, s[20:23], s87 offen offset:2048 sc0 sc1
buffer_load_dwordx2 v[50:51], v250, s[20:23], s87 offen offset:2560 sc0 sc1
buffer_load_dwordx2 v[52:53], v250, s[20:23], s87 offen offset:3072 sc0 sc1
buffer_load_dwordx2 v[54:55], v250, s[20:23], s87 offen offset:3584 sc0 sc1
buffer_load_dwordx2 v[56:57], v250, s[20:23], s46 offen offset:0 sc0 sc1
buffer_load_dwordx2 v[58:59], v250, s[20:23], s46 offen offset:512 sc0 sc1
buffer_load_dwordx2 v[60:61], v250, s[20:23], s46 offen offset:1024 sc0 sc1
buffer_load_dwordx2 v[62:63], v250, s[20:23], s46 offen offset:1536 sc0 sc1
buffer_load_dwordx2 v[64:65], v250, s[20:23], s46 offen offset:2048 sc0 sc1
buffer_load_dwordx2 v[66:67], v250, s[20:23], s46 offen offset:2560 sc0 sc1
buffer_load_dwordx2 v[68:69], v250, s[20:23], s46 offen offset:3072 sc0 sc1
buffer_load_dwordx2 v[70:71], v250, s[20:23], s46 offen offset:3584 sc0 sc1
K_XW2:
s_and_b32 s46, vcc_lo, 0xf0000
s_cbranch_scc1 K_XPOLL
buffer_load_dwordx4 v[96:99], v234, s[20:23], s60 offen offset:0 sc0 sc1
buffer_load_dwordx4 v[104:107], v234, s[20:23], s61 offen offset:0 sc0 sc1
buffer_load_dwordx4 v[112:115], v234, s[20:23], s62 offen offset:0 sc0 sc1
buffer_load_dwordx4 v[100:103], v234, s[20:23], s60 offen offset:1024 sc0 sc1
buffer_load_dwordx4 v[108:111], v234, s[20:23], s61 offen offset:1024 sc0 sc1
buffer_load_dwordx4 v[116:119], v234, s[20:23], s62 offen offset:1024 sc0 sc1
v_lshlrev_b32 v72, 16, v120
v_and_b32 v73, s56, v120
v_lshlrev_b32 v74, 16, v121
v_and_b32 v75, s56, v121
v_lshlrev_b32 v76, 16, v122
v_and_b32 v77, s56, v122
v_lshlrev_b32 v78, 16, v123
v_and_b32 v79, s56, v123
v_lshlrev_b32 v80, 16, v124
v_and_b32 v81, s56, v124
v_lshlrev_b32 v82, 16, v125
v_and_b32 v83, s56, v125
v_lshlrev_b32 v84, 16, v126
v_and_b32 v85, s56, v126
v_lshlrev_b32 v86, 16, v127
v_and_b32 v87, s56, v127
v_lshlrev_b32 v88, 16, v128
v_and_b32 v89, s56, v128
v_lshlrev_b32 v90, 16, v129
v_and_b32 v91, s56, v129
s_cmp_lg_u32 s67, 2
s_cbranch_scc1 K_EFIN
s_waitcnt vmcnt(6)
v_lshlrev_b32 v36, 16, v40
v_and_b32 v37, s56, v40
v_lshlrev_b32 v38, 16, v41
v_and_b32 v39, s56, v41
v_dot2_f32_bf16 v36, v42, s58, v36
v_dot2_f32_bf16 v37, v42, s59, v37
v_dot2_f32_bf16 v38, v43, s58, v38
v_dot2_f32_bf16 v39, v43, s59, v39
v_dot2_f32_bf16 v36, v44, s58, v36
v_dot2_f32_bf16 v37, v44, s59, v37
v_dot2_f32_bf16 v38, v45, s58, v38
v_dot2_f32_bf16 v39, v45, s59, v39
v_dot2_f32_bf16 v36, v46, s58, v36
v_dot2_f32_bf16 v37, v46, s59, v37
v_dot2_f32_bf16 v38, v47, s58, v38
v_dot2_f32_bf16 v39, v47, s59, v39
v_dot2_f32_bf16 v36, v48, s58, v36
v_dot2_f32_bf16 v37, v48, s59, v37
v_dot2_f32_bf16 v38, v49, s58, v38
v_dot2_f32_bf16 v39, v49, s59, v39
v_dot2_f32_bf16 v36, v50, s58, v36
v_dot2_f32_bf16 v37, v50, s59, v37
v_dot2_f32_bf16 v38, v51, s58, v38
v_dot2_f32_bf16 v39, v51, s59, v39
v_dot2_f32_bf16 v36, v52, s58, v36
v_dot2_f32_bf16 v37, v52, s59, v37
v_dot2_f32_bf16 v38, v53, s58, v38
v_dot2_f32_bf16 v39, v53, s59, v39
v_dot2_f32_bf16 v36, v54, s58, v36
v_dot2_f32_bf16 v37, v54, s59, v37
v_dot2_f32_bf16 v38, v55, s58, v38
v_dot2_f32_bf16 v39, v55, s59, v39
v_dot2_f32_bf16 v36, v56, s58, v36
v_dot2_f32_bf16 v37, v56, s59, v37
v_dot2_f32_bf16 v38, v57, s58, v38
v_dot2_f32_bf16 v39, v57, s59, v39
v_dot2_f32_bf16 v36, v58, s58, v36
v_dot2_f32_bf16 v37, v58, s59, v37
v_dot2_f32_bf16 v38, v59, s58, v38
v_dot2_f32_bf16 v39, v59, s59, v39
v_dot2_f32_bf16 v36, v60, s58, v36
v_dot2_f32_bf16 v37, v60, s59, v37
v_dot2_f32_bf16 v38, v61, s58, v38
v_dot2_f32_bf16 v39, v61, s59, v39
v_dot2_f32_bf16 v36, v62, s58, v36
v_dot2_f32_bf16 v37, v62, s59, v37
v_dot2_f32_bf16 v38, v63, s58, v38
v_dot2_f32_bf16 v39, v63, s59, v39
v_dot2_f32_bf16 v36, v64, s58, v36
v_dot2_f32_bf16 v37, v64, s59, v37
v_dot2_f32_bf16 v38, v65, s58, v38
v_dot2_f32_bf16 v39, v65, s59, v39
v_dot2_f32_bf16 v36, v66, s58, v36
v_dot2_f32_bf16 v37, v66, s59, v37
v_dot2_f32_bf16 v38, v67, s58, v38
v_dot2_f32_bf16 v39, v67, s59, v39
v_dot2_f32_bf16 v36, v68, s58, v36
v_dot2_f32_bf16 v37, v68, s59, v37
v_dot2_f32_bf16 v38, v69, s58, v38
v_dot2_f32_bf16 v39, v69, s59, v39
v_dot2_f32_bf16 v36, v70, s58, v36
v_dot2_f32_bf16 v37, v70, s59, v37
v_dot2_f32_bf16 v38, v71, s58, v38
v_dot2_f32_bf16 v39, v71, s59, v39
s_nop 1
K_EFIN:
v_cvt_pk_bf16_f32 v28, v36, v37
v_cvt_pk_bf16_f32 v29, v38, v39
v_lshlrev_b32 v36, 16, v28
v_and_b32 v37, s56, v28
v_lshlrev_b32 v38, 16, v29
v_and_b32 v39, s56, v29
v_pk_mul_f32 v[36:37], v[36:37], v[24:25]
v_pk_mul_f32 v[38:39], v[38:39], v[26:27]
v_cvt_pk_bf16_f32 v28, v36, v37
v_cvt_pk_bf16_f32 v29, v38, v39
v_lshlrev_b32 v36, 16, v28
v_and_b32 v37, s56, v28
v_lshlrev_b32 v38, 16, v29
v_and_b32 v39, s56, v29
v_pk_add_f32 v[36:37], v[36:37], v[88:89]
v_pk_add_f32 v[38:39], v[38:39], v[90:91]
v_cvt_pk_bf16_f32 v36, v36, v37
v_cvt_pk_bf16_f32 v37, v38, v39
buffer_store_dwordx2 v[36:37], v240, s[68:71], s81 offen sc0 sc1 nt
s_add_u32 s46, s37, 65536
v_add_u32 v5, s46, v234
s_add_u32 s46, s80, 9216
s_waitcnt vmcnt(4)
v_dot2_f32_bf16 v136, v96, s58, v136
v_dot2_f32_bf16 v137, v96, s59, v137
v_dot2_f32_bf16 v138, v97, s58, v138
v_dot2_f32_bf16 v139, v97, s59, v139
v_dot2_f32_bf16 v140, v98, s58, v140
v_dot2_f32_bf16 v141, v98, s59, v141
v_dot2_f32_bf16 v142, v99, s58, v142
v_dot2_f32_bf16 v143, v99, s59, v143
v_dot2_f32_bf16 v136, v104, s58, v136
v_dot2_f32_bf16 v137, v104, s59, v137
v_dot2_f32_bf16 v138, v105, s58, v138
v_dot2_f32_bf16 v139, v105, s59, v139
v_dot2_f32_bf16 v140, v106, s58, v140
v_dot2_f32_bf16 v141, v106, s59, v141
v_dot2_f32_bf16 v142, v107, s58, v142
v_dot2_f32_bf16 v143, v107, s59, v143
v_dot2_f32_bf16 v136, v112, s58, v136
v_dot2_f32_bf16 v137, v112, s59, v137
v_dot2_f32_bf16 v138, v113, s58, v138
v_dot2_f32_bf16 v139, v113, s59, v139
v_dot2_f32_bf16 v140, v114, s58, v140
v_dot2_f32_bf16 v141, v114, s59, v141
v_dot2_f32_bf16 v142, v115, s58, v142
v_dot2_f32_bf16 v143, v115, s59, v143
v_cvt_pk_bf16_f32 v28, v136, v137
v_cvt_pk_bf16_f32 v29, v138, v139
v_lshlrev_b32 v136, 16, v28
v_and_b32 v137, s56, v28
v_lshlrev_b32 v138, 16, v29
v_and_b32 v139, s56, v29
v_pk_mul_f32 v[136:137], v[136:137], v[8:9]
v_pk_mul_f32 v[138:139], v[138:139], v[10:11]
v_cvt_pk_bf16_f32 v28, v136, v137
v_cvt_pk_bf16_f32 v29, v138, v139
v_lshlrev_b32 v136, 16, v28
v_and_b32 v137, s56, v28
v_lshlrev_b32 v138, 16, v29
v_and_b32 v139, s56, v29
v_pk_add_f32 v[136:137], v[136:137], v[72:73]
v_pk_add_f32 v[138:139], v[138:139], v[74:75]
v_cvt_pk_bf16_f32 v136, v136, v137
v_cvt_pk_bf16_f32 v137, v138, v139
ds_write_b64 v241, v[136:137]
v_cvt_pk_bf16_f32 v28, v140, v141
v_cvt_pk_bf16_f32 v29, v142, v143
v_lshlrev_b32 v140, 16, v28
v_and_b32 v141, s56, v28
v_lshlrev_b32 v142, 16, v29
v_and_b32 v143, s56, v29
v_pk_mul_f32 v[140:141], v[140:141], v[12:13]
v_pk_mul_f32 v[142:143], v[142:143], v[14:15]
v_cvt_pk_bf16_f32 v28, v140, v141
v_cvt_pk_bf16_f32 v29, v142, v143
v_lshlrev_b32 v140, 16, v28
v_and_b32 v141, s56, v28
v_lshlrev_b32 v142, 16, v29
v_and_b32 v143, s56, v29
v_pk_add_f32 v[140:141], v[140:141], v[76:77]
v_pk_add_f32 v[142:143], v[142:143], v[78:79]
v_cvt_pk_bf16_f32 v140, v140, v141
v_cvt_pk_bf16_f32 v141, v142, v143
ds_write_b64 v242, v[140:141]
s_waitcnt vmcnt(1)
v_dot2_f32_bf16 v144, v100, s58, v144
v_dot2_f32_bf16 v145, v100, s59, v145
v_dot2_f32_bf16 v146, v101, s58, v146
v_dot2_f32_bf16 v147, v101, s59, v147
v_dot2_f32_bf16 v148, v102, s58, v148
v_dot2_f32_bf16 v149, v102, s59, v149
v_dot2_f32_bf16 v150, v103, s58, v150
v_dot2_f32_bf16 v151, v103, s59, v151
v_dot2_f32_bf16 v144, v108, s58, v144
v_dot2_f32_bf16 v145, v108, s59, v145
v_dot2_f32_bf16 v146, v109, s58, v146
v_dot2_f32_bf16 v147, v109, s59, v147
v_dot2_f32_bf16 v148, v110, s58, v148
v_dot2_f32_bf16 v149, v110, s59, v149
v_dot2_f32_bf16 v150, v111, s58, v150
v_dot2_f32_bf16 v151, v111, s59, v151
v_dot2_f32_bf16 v144, v116, s58, v144
v_dot2_f32_bf16 v145, v116, s59, v145
v_dot2_f32_bf16 v146, v117, s58, v146
v_dot2_f32_bf16 v147, v117, s59, v147
v_dot2_f32_bf16 v148, v118, s58, v148
v_dot2_f32_bf16 v149, v118, s59, v149
v_dot2_f32_bf16 v150, v119, s58, v150
v_dot2_f32_bf16 v151, v119, s59, v151
v_cvt_pk_bf16_f32 v28, v144, v145
v_cvt_pk_bf16_f32 v29, v146, v147
v_lshlrev_b32 v144, 16, v28
v_and_b32 v145, s56, v28
v_lshlrev_b32 v146, 16, v29
v_and_b32 v147, s56, v29
v_pk_mul_f32 v[144:145], v[144:145], v[16:17]
v_pk_mul_f32 v[146:147], v[146:147], v[18:19]
v_cvt_pk_bf16_f32 v28, v144, v145
v_cvt_pk_bf16_f32 v29, v146, v147
v_lshlrev_b32 v144, 16, v28
v_and_b32 v145, s56, v28
v_lshlrev_b32 v146, 16, v29
v_and_b32 v147, s56, v29
v_pk_add_f32 v[144:145], v[144:145], v[80:81]
v_pk_add_f32 v[146:147], v[146:147], v[82:83]
v_cvt_pk_bf16_f32 v144, v144, v145
v_cvt_pk_bf16_f32 v145, v146, v147
ds_write_b64 v243, v[144:145]
v_cvt_pk_bf16_f32 v28, v148, v149
v_cvt_pk_bf16_f32 v29, v150, v151
v_lshlrev_b32 v148, 16, v28
v_and_b32 v149, s56, v28
v_lshlrev_b32 v150, 16, v29
v_and_b32 v151, s56, v29
v_pk_mul_f32 v[148:149], v[148:149], v[20:21]
v_pk_mul_f32 v[150:151], v[150:151], v[22:23]
v_cvt_pk_bf16_f32 v28, v148, v149
v_cvt_pk_bf16_f32 v29, v150, v151
v_lshlrev_b32 v148, 16, v28
v_and_b32 v149, s56, v28
v_lshlrev_b32 v150, 16, v29
v_and_b32 v151, s56, v29
v_pk_add_f32 v[148:149], v[148:149], v[84:85]
v_pk_add_f32 v[150:151], v[150:151], v[86:87]
v_cvt_pk_bf16_f32 v148, v148, v149
v_cvt_pk_bf16_f32 v149, v150, v151
ds_write_b64 v244, v[148:149]
ds_read_b128 v[40:43], v5
ds_read_b128 v[44:47], v5 offset:1024
s_waitcnt lgkmcnt(1)
buffer_store_dwordx4 v[40:43], v239, s[68:71], s80 offen sc0 sc1 nt
s_waitcnt lgkmcnt(0)
buffer_store_dwordx4 v[44:47], v239, s[68:71], s46 offen sc0 sc1 nt
K_END:
s_endpgm
K_YSPIN:
s_sleep 4
s_add_u32 s100, s100, 1
s_bitcmp1_b32 s100, 19
s_cbranch_scc1 K_END
buffer_load_dwordx2 v[252:253], v251, s[76:79], s42 offen sc0 sc1
s_waitcnt vmcnt(0)
K_YR0:
s_cmp_lg_u32 s41, 0
s_cbranch_scc1 K_YR0B
s_waitcnt vmcnt(3)
v_cmp_gt_u32 vcc, 9, v252
s_cbranch_vccnz K_YSPIN
K_YR0B:
s_mul_i32 s48, s52, 18560
s_mul_i32 s46, s32, 4608
s_add_u32 s48, s48, s46
s_add_u32 s48, s48, 0x23fb780
s_add_u32 s46, s48, 4096
buffer_load_dwordx4 v[112:115], v234, s[20:23], s48 offen offset:0 sc0 sc1
buffer_load_dwordx4 v[116:119], v234, s[20:23], s48 offen offset:1024 sc0 sc1
buffer_load_dwordx4 v[120:123], v234, s[20:23], s48 offen offset:2048 sc0 sc1
buffer_load_dwordx4 v[124:127], v234, s[20:23], s48 offen offset:3072 sc0 sc1
v_subrev_u32 v245, 1, v254
v_and_b32 v245, 0x7ff, v245
v_mul_u32_u24 v245, 0x480, v245
v_mov_b64 v[128:129], 0
v_mov_b64 v[130:131], 0
s_lshl_b32 s50, s52, 3
s_sub_u32 s50, s50, 8
s_mov_b32 exec_hi, 0
buffer_load_dwordx4 v[128:131], v234, s[20:23], s46 offen sc0 sc1
s_mov_b32 exec_lo, 0xff
buffer_load_dwordx2 v[134:135], v245, s[20:23], s50 offen sc0 sc1
s_mov_b64 exec, -1
s_branch K_LAST
K_YRA:
s_waitcnt vmcnt(35)
v_pk_add_f32 v[112:113], v[112:113], v[116:117]
v_pk_add_f32 v[114:115], v[114:115], v[118:119]
v_pk_add_f32 v[112:113], v[112:113], v[120:121]
v_pk_add_f32 v[114:115], v[114:115], v[122:123]
v_pk_add_f32 v[112:113], v[112:113], v[124:125]
v_pk_add_f32 v[114:115], v[114:115], v[126:127]
v_pk_add_f32 v[112:113], v[112:113], v[128:129]
v_pk_add_f32 v[114:115], v[114:115], v[130:131]
s_lshl_b32 s46, s36, 10
s_lshl_b32 s47, s32, 7
s_add_u32 s46, s46, s47
v_add_f32_dpp v112, v112, v112 row_ror:8 row_mask:0xf bank_mask:0xf
v_add_f32_dpp v113, v113, v113 row_ror:8 row_mask:0xf bank_mask:0xf
v_add_f32_dpp v114, v114, v114 row_ror:8 row_mask:0xf bank_mask:0xf
v_add_f32_dpp v115, v115, v115 row_ror:8 row_mask:0xf bank_mask:0xf
s_add_u32 s46, s46, 77952
v_and_b32 v120, 0x70, v234
v_add_u32 v120, s46, v120
v_mov_b32 v116, v112
v_mov_b32 v117, v113
v_mov_b32 v118, v114
v_mov_b32 v119, v115
v_permlane16_swap_b32 v112, v116
v_permlane16_swap_b32 v113, v117
v_permlane16_swap_b32 v114, v118
v_permlane16_swap_b32 v115, v119
v_pk_add_f32 v[112:113], v[112:113], v[116:117]
v_pk_add_f32 v[114:115], v[114:115], v[118:119]
v_mov_b32 v116, v112
v_mov_b32 v117, v113
v_mov_b32 v118, v114
v_mov_b32 v119, v115
v_permlane32_swap_b32 v112, v116
v_permlane32_swap_b32 v113, v117
v_permlane32_swap_b32 v114, v118
v_permlane32_swap_b32 v115, v119
v_pk_add_f32 v[112:113], v[112:113], v[116:117]
v_pk_add_f32 v[114:115], v[114:115], v[118:119]
ds_write_b128 v120, v[112:115]
v_subrev_u32 v120, s47, v120
s_branch K_YRAD
K_YR1:
ds_read_b128 v[144:147], v120 offset:0
ds_read_b128 v[148:151], v120 offset:128
ds_read_b128 v[152:155], v120 offset:256
ds_read_b128 v[156:159], v120 offset:384
v_mov_b32_dpp v160, v254 row_ror:8 row_mask:0xf bank_mask:0xf
v_mul_u32_u24 v245, 0x480, v1
s_mov_b32 s57, 0xbfb8aa3b
s_mov_b32 s56, 0xffff0000
v_and_b32 v160, s56, v160
s_waitcnt lgkmcnt(0)
v_pk_add_f32 v[112:113], v[144:145], v[148:149]
v_pk_add_f32 v[116:117], v[152:153], v[156:157]
v_pk_add_f32 v[112:113], v[112:113], v[116:117]
v_pk_add_f32 v[114:115], v[146:147], v[150:151]
v_pk_add_f32 v[118:119], v[154:155], v[158:159]
v_pk_add_f32 v[114:115], v[114:115], v[118:119]
v_cvt_pk_bf16_f32 v162, v112, v113
v_cvt_pk_bf16_f32 v163, v114, v115
v_lshlrev_b32 v112, 16, v162
v_and_b32 v113, s56, v162
v_lshlrev_b32 v114, 16, v163
v_and_b32 v115, s56, v163
v_mul_f32 v112, v160, v112
v_mul_f32 v113, v160, v113
v_mul_f32 v114, v160, v114
v_mul_f32 v115, v160, v115
v_cvt_pk_bf16_f32 v162, v112, v113
v_cvt_pk_bf16_f32 v163, v114, v115
v_lshlrev_b32 v112, 16, v162
v_and_b32 v113, s56, v162
v_lshlrev_b32 v114, 16, v163
v_and_b32 v115, s56, v163
v_lshlrev_b32 v116, 16, v134
v_and_b32 v117, 0xffff0000, v134
v_lshlrev_b32 v118, 16, v135
v_and_b32 v119, 0xffff0000, v135
v_pk_add_f32 v[112:113], v[112:113], v[116:117]
v_pk_add_f32 v[114:115], v[114:115], v[118:119]
v_cvt_pk_bf16_f32 v162, v112, v113
v_cvt_pk_bf16_f32 v163, v114, v115
v_lshlrev_b32 v112, 16, v162
v_and_b32 v113, s56, v162
v_lshlrev_b32 v114, 16, v163
v_and_b32 v115, s56, v163
v_mul_f32 v116, s57, v112
v_mul_f32 v117, s57, v113
v_mul_f32 v118, s57, v114
v_mul_f32 v119, s57, v115
v_exp_f32 v116, v116
v_exp_f32 v117, v117
v_exp_f32 v118, v118
v_exp_f32 v119, v119
s_nop 0
v_add_f32 v116, 1.0, v116
v_add_f32 v117, 1.0, v117
v_add_f32 v118, 1.0, v118
v_add_f32 v119, 1.0, v119
v_rcp_f32 v116, v116
v_rcp_f32 v117, v117
v_rcp_f32 v118, v118
v_rcp_f32 v119, v119
s_add_u32 s46, s50, 0x274000
v_pk_mul_f32 v[112:113], v[112:113], v[116:117]
v_pk_mul_f32 v[114:115], v[114:115], v[118:119]
v_cvt_pk_bf16_f32 v134, v112, v113
v_cvt_pk_bf16_f32 v135, v114, v115
s_mov_b64 exec, 0xff
buffer_store_dwordx2 v[134:135], v245, s[20:23], s46 offen sc0 sc1
s_mov_b64 exec, -1
s_branch K_YR1D
K_YR2:
s_waitcnt vmcnt(32)
s_and_b32 s46, s83, 15
s_lshl_b32 s46, s46, 7
s_add_u32 s46, s46, 0x272800
s_mov_b64 exec, 1
buffer_atomic_add v5, v234, s[20:23], s46 offen sc1
s_mov_b64 exec, -1
s_branch K_YR2D
K_YG:
v_mov_b32 v157, -1
K_YG1:
s_ff1_i32_b32 s46, s93
s_bitset0_b32 s93, s46
v_readlane_b32 s47, v248, s46
v_mov_b32 v158, s46
s_nop 0
v_cmp_eq_u32 vcc, s47, v3
s_cmp_lg_u32 s93, 0
s_nop 0
v_cndmask_b32 v157, v157, v158, vcc
s_cbranch_scc1 K_YG1
v_mul_u32_u24 v158, 0x480, v157
v_lshl_add_u32 v158, v4, 3, v158
s_lshl_b32 s46, s36, 8
s_add_u32 s46, s46, s82
s_add_u32 s46, s46, 0x274000
s_lshl_b32 s47, s36, 5
s_add_u32 s47, s47, 0x274400
s_branch K_YG3
K_YG2:
s_sleep 2
s_add_u32 s100, s100, 1
s_bitcmp1_b32 s100, 19
s_cbranch_scc1 K_END
buffer_load_dword v247, v6, s[20:23], 0 offen sc0 sc1
s_waitcnt vmcnt(0)
K_YG3:
v_cmp_gt_u32 vcc, 9, v247
s_cbranch_vccnz K_YG2
v_cmp_gt_u32 vcc, 8, v157
s_nop 1
s_mov_b64 exec, vcc
buffer_load_dwordx2 v[160:161], v158, s[20:23], s46 offen offset:0 sc0 sc1
buffer_load_dwordx2 v[162:163], v158, s[20:23], s46 offen offset:32 sc0 sc1
buffer_load_dwordx2 v[164:165], v158, s[20:23], s46 offen offset:64 sc0 sc1
buffer_load_dwordx2 v[166:167], v158, s[20:23], s46 offen offset:96 sc0 sc1
buffer_load_dwordx2 v[168:169], v158, s[20:23], s47 offen offset:0 sc0 sc1
s_waitcnt vmcnt(0)
v_lshlrev_b32 v8, 16, v160
v_and_b32 v9, s56, v160
v_lshlrev_b32 v10, 16, v161
v_and_b32 v11, s56, v161
v_lshlrev_b32 v12, 16, v162
v_and_b32 v13, s56, v162
v_lshlrev_b32 v14, 16, v163
v_and_b32 v15, s56, v163
v_lshlrev_b32 v16, 16, v164
v_and_b32 v17, s56, v164
v_lshlrev_b32 v18, 16, v165
v_and_b32 v19, s56, v165
v_lshlrev_b32 v20, 16, v166
v_and_b32 v21, s56, v166
v_lshlrev_b32 v22, 16, v167
v_and_b32 v23, s56, v167
v_lshlrev_b32 v24, 16, v168
v_and_b32 v25, s56, v168
v_lshlrev_b32 v26, 16, v169
v_and_b32 v27, s56, v169
s_mov_b64 exec, -1
s_branch K_YGD
K_TAIL_END:
K_HOOK:
s_lshl_b32 s48, s34, 2
s_add_u32 s48, s48, s35
s_cmp_eq_u32 s40, 3
s_cbranch_scc1 K_QTW
s_cmp_eq_u32 s40, 7
s_cbranch_scc1 K_PUB
s_memrealtime s[46:47]
s_waitcnt lgkmcnt(0)
s_sub_u32 s47, s46, s94
s_mul_i32 s47, s47, 12
s_lshr_b32 s47, s47, 2
s_add_u32 s46, s46, s47
s_lshl_b32 s46, s46, 6
s_or_b32 s46, s46, s48
s_bitset1_b32 s46, 31
v_mov_b32 v244, s46
s_lshl_b32 s48, s48, 3
s_mov_b64 exec, 1
buffer_store_dword v244, v234, s[76:79], s48 offen sc0 sc1
s_mov_b64 exec, -1
s_branch K_B4
K_QTSPIN:
s_sleep 4
s_add_u32 s100, s100, 1
s_bitcmp1_b32 s100, 19
s_cbranch_scc1 K_END
buffer_load_dwordx2 v[252:253], v251, s[76:79], 0 offen sc0 sc1
s_waitcnt vmcnt(0)
K_QTW:
s_waitcnt vmcnt(3)
v_cmp_eq_u32 vcc, 0, v252
v_cmp_eq_u32 s[88:89], 0, v253
v_readlane_b32 s46, v252, s48
v_mov_b32 v254, v253
s_and_b32 s88, s88, 0xffff
s_or_b32 s88, s88, vcc_lo
s_or_b32 s88, s88, vcc_hi
v_cmp_gt_u32 vcc, s46, v252
s_cbranch_scc1 K_QTSPIN
s_bcnt1_i32_b64 s46, vcc
s_cmp_ge_u32 s46, 36
s_cbranch_scc1 K_B4
s_lshl_b32 s52, s46, 2
s_add_u32 s52, s52, s36
s_lshl_b32 s50, s52, 6
s_mul_i32 s90, s32, 294912
s_add_u32 s90, s90, s50
v_mfma_f32_16x16x32_bf16 v[40:43], a[128:131], v[152:155], v[136:139]
v_exp_f32 v8, v8
v_mfma_f32_16x16x32_bf16 v[40:43], a[132:135], v[156:159], v[40:43]
v_exp_f32 v9, v9
v_mfma_f32_16x16x32_bf16 v[40:43], a[136:139], v[160:163], v[40:43]
v_cvt_pk_bf16_f32 v72, v8, v9
v_lshlrev_b32 v5, 2, v4
v_mfma_f32_16x16x32_bf16 v[40:43], a[140:143], v[164:167], v[40:43]
v_exp_f32 v10, v10
v_mfma_f32_16x16x32_bf16 a[0:3], a[160:163], v[88:91], a[0:3]
v_add_u32 v6, 16, v5
v_and_b32 v7, 28, v1
v_mfma_f32_16x16x32_bf16 a[32:35], a[160:163], v[92:95], a[32:35]
v_exp_f32 v11, v11
s_waitcnt vmcnt(4) lgkmcnt(0)
s_barrier
v_mfma_f32_16x16x32_bf16 a[64:67], a[160:163], v[96:99], a[64:67]
ds_bpermute_b32 v5, v5, v254
v_cvt_pk_bf16_f32 v73, v10, v11
v_mfma_f32_16x16x32_bf16 a[96:99], a[160:163], v[100:103], a[96:99]
s_add_u32 m0, s37, 98304
v_exp_f32 v12, v12
v_mfma_f32_16x16x32_bf16 v[48:51], a[128:131], v[168:171], v[140:143]
buffer_load_dwordx4 v232, s[12:15], s39 offen offset:0 lds
v_mfma_f32_16x16x32_bf16 v[48:51], a[132:135], v[172:175], v[48:51]
v_exp_f32 v13, v13
v_mfma_f32_16x16x32_bf16 v[48:51], a[136:139], v[176:179], v[48:51]
ds_read_b64_tr_b16 a[160:161], v220 offset:0
ds_read_b64_tr_b16 a[162:163], v220 offset:4096
v_mfma_f32_16x16x32_bf16 v[48:51], a[140:143], v[180:183], v[48:51]
v_exp_f32 v14, v14
v_mfma_f32_16x16x32_bf16 a[4:7], a[164:167], v[88:91], a[4:7]
s_add_u32 m0, s49, 4096
ds_bpermute_b32 v6, v6, v254
v_cvt_pk_bf16_f32 v74, v12, v13
v_mfma_f32_16x16x32_bf16 a[36:39], a[164:167], v[92:95], a[36:39]
s_add_u32 s48, s90, 4718592
v_exp_f32 v15, v15
v_mfma_f32_16x16x32_bf16 a[68:71], a[164:167], v[96:99], a[68:71]
buffer_load_dwordx4 v238, s[56:59], s48 offen  lds
v_mfma_f32_16x16x32_bf16 a[100:103], a[164:167], v[100:103], a[100:103]
v_exp_f32 v16, v16
v_smfmac_f32_16x16x64_bf16 a[248:251], a[208:211], v[88:95], v235
ds_read_b64_tr_b16 a[164:165], v221 offset:0
ds_read_b64_tr_b16 a[166:167], v221 offset:4096
v_mfma_f32_16x16x32_bf16 v[56:59], a[128:131], v[184:187], v[144:147]
v_exp_f32 v17, v17
v_mfma_f32_16x16x32_bf16 v[56:59], a[132:135], v[188:191], v[56:59]
s_add_u32 m0, s37, 98304
v_cvt_pk_bf16_f32 v75, v14, v15
v_cvt_pk_bf16_f32 v76, v16, v17
v_mfma_f32_16x16x32_bf16 v[56:59], a[136:139], v[192:195], v[56:59]
v_exp_f32 v18, v18
v_mfma_f32_16x16x32_bf16 v[56:59], a[140:143], v[196:199], v[56:59]
buffer_load_dwordx4 v233, s[12:15], s39 offen offset:1024 lds
v_mfma_f32_16x16x32_bf16 a[8:11], a[168:171], v[88:91], a[8:11]
v_exp_f32 v19, v19
v_mfma_f32_16x16x32_bf16 a[40:43], a[168:171], v[92:95], a[40:43]
ds_bpermute_b32 v7, v7, v254
v_cvt_pk_bf16_f32 v77, v18, v19
v_mfma_f32_16x16x32_bf16 a[72:75], a[168:171], v[96:99], a[72:75]
s_add_u32 m0, s49, 5120
v_exp_f32 v20, v20
v_mfma_f32_16x16x32_bf16 a[104:107], a[168:171], v[100:103], a[104:107]
s_add_u32 s48, s90, 4866048
buffer_load_dwordx4 v238, s[56:59], s48 offen  lds
v_mfma_f32_16x16x32_bf16 v[64:67], a[128:131], v[200:203], v[148:151]
s_mul_i32 s91, s52, 36864
v_exp_f32 v21, v21
v_mfma_f32_16x16x32_bf16 v[64:67], a[132:135], v[204:207], v[64:67]
s_lshl_b32 s46, s32, 5
ds_read_b64_tr_b16 a[168:169], v222 offset:0
ds_read_b64_tr_b16 a[170:171], v222 offset:4096
v_mfma_f32_16x16x32_bf16 v[64:67], a[136:139], v[208:211], v[64:67]
s_add_u32 s92, s91, s46
v_exp_f32 v22, v22
v_mfma_f32_16x16x32_bf16 v[64:67], a[140:143], v[212:215], v[64:67]
s_mul_i32 s46, s32, 1179648
ds_read_b128 a[128:131], v216 offset:49152
ds_read_b128 a[132:135], v217 offset:49152
v_mfma_f32_16x16x32_bf16 a[12:15], a[172:175], v[88:91], a[12:15]
s_add_u32 m0, s37, 98304
v_exp_f32 v23, v23
v_mfma_f32_16x16x32_bf16 a[44:47], a[172:175], v[92:95], a[44:47]
s_add_u32 s50, s50, s46
buffer_load_dwordx4 v232, s[12:15], s39 offen offset:2048 lds
v_mfma_f32_16x16x32_bf16 a[76:79], a[172:175], v[96:99], a[76:79]
s_lshl_b32 s46, s32, 8
v_exp_f32 v24, v24
v_mfma_f32_16x16x32_bf16 a[108:111], a[172:175], v[100:103], a[108:111]
s_add_u32 s91, s91, s46
v_exp_f32 v25, v25
v_mfma_f32_16x16x32_bf16 v[44:47], a[144:147], v[152:155], v[136:139]
s_and_b32 s47, s32, 1
ds_read_b128 a[136:139], v218 offset:49152
ds_read_b128 a[140:143], v219 offset:49152
v_mfma_f32_16x16x32_bf16 v[44:47], a[148:151], v[156:159], v[44:47]
s_lshl_b32 s47, s47, 6
v_exp_f32 v26, v26
v_mfma_f32_16x16x32_bf16 v[44:47], a[152:155], v[160:163], v[44:47]
s_add_u32 m0, s49, 6144
ds_read_b64_tr_b16 a[172:173], v223 offset:0
ds_read_b64_tr_b16 a[174:175], v223 offset:4096
v_mfma_f32_16x16x32_bf16 v[44:47], a[156:159], v[164:167], v[44:47]
s_add_u32 s48, s90, 4718592
v_exp_f32 v27, v27
v_mfma_f32_16x16x32_bf16 a[16:19], a[176:179], v[88:91], a[16:19]
s_add_u32 s47, s47, 1024
buffer_load_dwordx4 v238, s[60:63], s48 offen  lds
v_mfma_f32_16x16x32_bf16 a[48:51], a[176:179], v[92:95], a[48:51]
s_mov_b32 s88, 0x480
v_exp_f32 v28, v28
v_mfma_f32_16x16x32_bf16 a[80:83], a[176:179], v[96:99], a[80:83]
v_cvt_pk_bf16_f32 v78, v20, v21
v_cvt_pk_bf16_f32 v79, v22, v23
v_mfma_f32_16x16x32_bf16 a[112:115], a[176:179], v[100:103], a[112:115]
s_add_u32 m0, s37, 98304
v_exp_f32 v29, v29
v_mfma_f32_16x16x32_bf16 v[52:55], a[144:147], v[168:171], v[140:143]
buffer_load_dwordx4 v233, s[12:15], s39 offen offset:3072 lds
v_mfma_f32_16x16x32_bf16 v[52:55], a[148:151], v[172:175], v[52:55]
v_exp_f32 v30, v30
v_mfma_f32_16x16x32_bf16 v[52:55], a[152:155], v[176:179], v[52:55]
ds_read_b64_tr_b16 a[176:177], v224 offset:0
ds_read_b64_tr_b16 a[178:179], v224 offset:4096
v_mfma_f32_16x16x32_bf16 v[52:55], a[156:159], v[180:183], v[52:55]
v_exp_f32 v31, v31
v_mfma_f32_16x16x32_bf16 a[20:23], a[180:183], v[88:91], a[20:23]
v_cvt_pk_bf16_f32 v80, v24, v25
v_cvt_pk_bf16_f32 v81, v26, v27
v_mfma_f32_16x16x32_bf16 a[52:55], a[180:183], v[92:95], a[52:55]
s_add_u32 m0, s49, 7168
v_exp_f32 v32, v32
v_mfma_f32_16x16x32_bf16 a[84:87], a[180:183], v[96:99], a[84:87]
s_add_u32 s48, s90, 4866048
buffer_load_dwordx4 v238, s[60:63], s48 offen  lds
v_mfma_f32_16x16x32_bf16 a[116:119], a[180:183], v[100:103], a[116:119]
v_exp_f32 v33, v33
v_smfmac_f32_16x16x64_bf16 a[252:255], a[208:211], v[96:103], v235
ds_read_b64_tr_b16 a[180:181], v225 offset:0
ds_read_b64_tr_b16 a[182:183], v225 offset:4096
v_mfma_f32_16x16x32_bf16 v[60:63], a[144:147], v[184:187], v[144:147]
v_exp_f32 v34, v34
v_mfma_f32_16x16x32_bf16 v[60:63], a[148:151], v[188:191], v[60:63]
s_add_u32 s39, s39, 16384
v_cvt_pk_bf16_f32 v82, v28, v29
v_cvt_pk_bf16_f32 v83, v30, v31
v_mfma_f32_16x16x32_bf16 v[60:63], a[152:155], v[192:195], v[60:63]
s_add_u32 m0, s37, 16384
v_exp_f32 v35, v35
v_mfma_f32_16x16x32_bf16 v[60:63], a[156:159], v[196:199], v[60:63]
buffer_load_dwordx4 v228, s[8:11], s38 offen offset:0 lds
v_mfma_f32_16x16x32_bf16 a[24:27], a[184:187], v[88:91], a[24:27]
v_exp_f32 v36, v36
v_mfma_f32_16x16x32_bf16 a[56:59], a[184:187], v[92:95], a[56:59]
v_cvt_pk_bf16_f32 v84, v32, v33
v_cvt_pk_bf16_f32 v85, v34, v35
v_mfma_f32_16x16x32_bf16 a[88:91], a[184:187], v[96:99], a[88:91]
v_exp_f32 v37, v37
v_mfma_f32_16x16x32_bf16 a[120:123], a[184:187], v[100:103], a[120:123]
buffer_load_dwordx4 v229, s[8:11], s38 offen offset:1024 lds
v_mfma_f32_16x16x32_bf16 v[68:71], a[144:147], v[200:203], v[148:151]
v_exp_f32 v38, v38
v_mfma_f32_16x16x32_bf16 v[68:71], a[148:151], v[204:207], v[68:71]
ds_read_b64_tr_b16 a[184:185], v226 offset:0
ds_read_b64_tr_b16 a[186:187], v226 offset:4096
v_mfma_f32_16x16x32_bf16 v[68:71], a[152:155], v[208:211], v[68:71]
v_exp_f32 v39, v39
v_mfma_f32_16x16x32_bf16 v[68:71], a[156:159], v[212:215], v[68:71]
ds_read_b128 a[144:147], v216 offset:53248
ds_read_b128 a[148:151], v217 offset:53248
v_mfma_f32_16x16x32_bf16 a[28:31], a[188:191], v[88:91], a[28:31]
ds_read_b128 a[152:155], v218 offset:53248
ds_read_b128 a[156:159], v219 offset:53248
v_mfma_f32_16x16x32_bf16 a[60:63], a[188:191], v[92:95], a[60:63]
v_cvt_pk_bf16_f32 v86, v36, v37
v_cvt_pk_bf16_f32 v87, v38, v39
v_mfma_f32_16x16x32_bf16 a[92:95], a[188:191], v[96:99], a[92:95]
v_and_b32 v250, 3, v1
v_mfma_f32_16x16x32_bf16 a[124:127], a[188:191], v[100:103], a[124:127]
s_waitcnt lgkmcnt(6)
ds_read_b64_tr_b16 a[188:189], v227 offset:0
ds_read_b64_tr_b16 a[190:191], v227 offset:4096
v_mfma_f32_16x16x32_bf16 v[8:11], a[128:131], v[152:155], v[136:139]
v_exp_f32 v40, v40
v_mfma_f32_16x16x32_bf16 v[8:11], a[132:135], v[156:159], v[8:11]
v_exp_f32 v41, v41
v_mfma_f32_16x16x32_bf16 v[8:11], a[136:139], v[160:163], v[8:11]
buffer_load_dwordx4 v230, s[8:11], s38 offen offset:2048 lds
v_mfma_f32_16x16x32_bf16 v[8:11], a[140:143], v[164:167], v[8:11]
v_exp_f32 v42, v42
v_mfma_f32_16x16x32_bf16 a[0:3], a[160:163], v[72:75], a[0:3]
v_cvt_pk_bf16_f32 v88, v40, v41
v_lshlrev_b32 v244, 1, v4
v_mfma_f32_16x16x32_bf16 a[32:35], a[160:163], v[76:79], a[32:35]
v_exp_f32 v43, v43
v_mfma_f32_16x16x32_bf16 a[64:67], a[160:163], v[80:83], a[64:67]
v_cvt_pk_bf16_f32 v89, v42, v43
v_xor_b32 v244, v244, v3
v_mfma_f32_16x16x32_bf16 a[96:99], a[160:163], v[84:87], a[96:99]
v_exp_f32 v44, v44
v_mfma_f32_16x16x32_bf16 v[16:19], a[128:131], v[168:171], v[140:143]
ds_read_b64_tr_b16 a[160:161], v220 offset:8192
ds_read_b64_tr_b16 a[162:163], v220 offset:12288
v_mfma_f32_16x16x32_bf16 v[16:19], a[132:135], v[172:175], v[16:19]
v_exp_f32 v45, v45
v_mfma_f32_16x16x32_bf16 v[16:19], a[136:139], v[176:179], v[16:19]
v_cvt_pk_bf16_f32 v90, v44, v45
v_lshlrev_b32 v244, 4, v244
v_mfma_f32_16x16x32_bf16 v[16:19], a[140:143], v[180:183], v[16:19]
v_exp_f32 v46, v46
v_mfma_f32_16x16x32_bf16 a[4:7], a[164:167], v[72:75], a[4:7]
v_xor_b32 v245, 128, v244
v_subrev_u32 v244, 0x480, v244
v_mfma_f32_16x16x32_bf16 a[36:39], a[164:167], v[76:79], a[36:39]
v_exp_f32 v47, v47
v_mfma_f32_16x16x32_bf16 a[68:71], a[164:167], v[80:83], a[68:71]
buffer_load_dwordx4 v231, s[8:11], s38 offen offset:3072 lds
v_mfma_f32_16x16x32_bf16 a[100:103], a[164:167], v[84:87], a[100:103]
v_exp_f32 v48, v48
v_smfmac_f32_16x16x64_bf16 a[248:251], a[208:211], v[72:79], v235
ds_read_b64_tr_b16 a[164:165], v221 offset:8192
ds_read_b64_tr_b16 a[166:167], v221 offset:12288
v_mfma_f32_16x16x32_bf16 v[24:27], a[128:131], v[184:187], v[144:147]
v_exp_f32 v49, v49
v_mfma_f32_16x16x32_bf16 v[24:27], a[132:135], v[188:191], v[24:27]
v_cvt_pk_bf16_f32 v91, v46, v47
v_cvt_pk_bf16_f32 v92, v48, v49
v_mfma_f32_16x16x32_bf16 v[24:27], a[136:139], v[192:195], v[24:27]
v_exp_f32 v50, v50
v_mfma_f32_16x16x32_bf16 v[24:27], a[140:143], v[196:199], v[24:27]
v_subrev_u32 v245, 0x480, v245
v_lshlrev_b32 v246, 4, v250
v_mfma_f32_16x16x32_bf16 a[8:11], a[168:171], v[72:75], a[8:11]
v_exp_f32 v51, v51
v_mfma_f32_16x16x32_bf16 a[40:43], a[168:171], v[76:79], a[40:43]
v_cvt_pk_bf16_f32 v93, v50, v51
v_subrev_u32 v246, 0x480, v246
v_mfma_f32_16x16x32_bf16 a[72:75], a[168:171], v[80:83], a[72:75]
v_exp_f32 v52, v52
v_mfma_f32_16x16x32_bf16 a[104:107], a[168:171], v[84:87], a[104:107]
ds_read_b64_tr_b16 a[168:169], v222 offset:8192
ds_read_b64_tr_b16 a[170:171], v222 offset:12288
v_mfma_f32_16x16x32_bf16 v[32:35], a[128:131], v[200:203], v[148:151]
s_add_u32 s38, s38, 16384
v_exp_f32 v53, v53
v_mfma_f32_16x16x32_bf16 v[32:35], a[132:135], v[204:207], v[32:35]
s_add_u32 m0, s37, 114688
ds_read_b128 a[128:131], v216 offset:57344
ds_read_b128 a[132:135], v217 offset:57344
v_mfma_f32_16x16x32_bf16 v[32:35], a[136:139], v[208:211], v[32:35]
v_exp_f32 v54, v54
v_mfma_f32_16x16x32_bf16 v[32:35], a[140:143], v[212:215], v[32:35]
buffer_load_dwordx4 v232, s[12:15], s39 offen offset:0 lds
v_mfma_f32_16x16x32_bf16 a[12:15], a[172:175], v[72:75], a[12:15]
v_exp_f32 v55, v55
v_mfma_f32_16x16x32_bf16 a[44:47], a[172:175], v[76:79], a[44:47]
ds_read_b128 a[136:139], v218 offset:57344
ds_read_b128 a[140:143], v219 offset:57344
v_mfma_f32_16x16x32_bf16 a[76:79], a[172:175], v[80:83], a[76:79]
v_exp_f32 v56, v56
v_mfma_f32_16x16x32_bf16 a[108:111], a[172:175], v[84:87], a[108:111]
s_waitcnt lgkmcnt(6)
v_exp_f32 v57, v57
v_mfma_f32_16x16x32_bf16 v[12:15], a[144:147], v[152:155], v[136:139]
ds_read_b64_tr_b16 a[172:173], v223 offset:8192
ds_read_b64_tr_b16 a[174:175], v223 offset:12288
v_mfma_f32_16x16x32_bf16 v[12:15], a[148:151], v[156:159], v[12:15]
v_exp_f32 v58, v58
v_mfma_f32_16x16x32_bf16 v[12:15], a[152:155], v[160:163], v[12:15]
v_cvt_pk_bf16_f32 v94, v52, v53
v_cvt_pk_bf16_f32 v95, v54, v55
v_mfma_f32_16x16x32_bf16 v[12:15], a[156:159], v[164:167], v[12:15]
v_exp_f32 v59, v59
v_mfma_f32_16x16x32_bf16 a[16:19], a[176:179], v[72:75], a[16:19]
v_cvt_pk_bf16_f32 v96, v56, v57
v_cvt_pk_bf16_f32 v97, v58, v59
v_mfma_f32_16x16x32_bf16 a[48:51], a[176:179], v[76:79], a[48:51]
v_exp_f32 v60, v60
v_mfma_f32_16x16x32_bf16 a[80:83], a[176:179], v[80:83], a[80:83]
buffer_load_dwordx4 v233, s[12:15], s39 offen offset:1024 lds
v_mfma_f32_16x16x32_bf16 a[112:115], a[176:179], v[84:87], a[112:115]
v_exp_f32 v61, v61
v_mfma_f32_16x16x32_bf16 v[20:23], a[144:147], v[168:171], v[140:143]
ds_read_b64_tr_b16 a[176:177], v224 offset:8192
ds_read_b64_tr_b16 a[178:179], v224 offset:12288
v_mfma_f32_16x16x32_bf16 v[20:23], a[148:151], v[172:175], v[20:23]
v_exp_f32 v62, v62
v_mfma_f32_16x16x32_bf16 v[20:23], a[152:155], v[176:179], v[20:23]
v_cvt_pk_bf16_f32 v98, v60, v61
v_mad_u32_u24 v5, v5, s88, v244
v_mfma_f32_16x16x32_bf16 v[20:23], a[156:159], v[180:183], v[20:23]
v_exp_f32 v63, v63
v_mfma_f32_16x16x32_bf16 a[20:23], a[180:183], v[72:75], a[20:23]
v_cvt_pk_bf16_f32 v99, v62, v63
v_mad_u32_u24 v6, v6, s88, v245
v_mfma_f32_16x16x32_bf16 a[52:55], a[180:183], v[76:79], a[52:55]
v_exp_f32 v64, v64
v_mfma_f32_16x16x32_bf16 a[84:87], a[180:183], v[80:83], a[84:87]
v_mad_u32_u24 v7, v7, s88, v246
v_lshrrev_b32 v249, 1, v1
v_mfma_f32_16x16x32_bf16 a[116:119], a[180:183], v[84:87], a[116:119]
v_exp_f32 v65, v65
v_smfmac_f32_16x16x64_bf16 a[252:255], a[208:211], v[80:87], v235
ds_read_b64_tr_b16 a[180:181], v225 offset:8192
ds_read_b64_tr_b16 a[182:183], v225 offset:12288
v_mfma_f32_16x16x32_bf16 v[28:31], a[144:147], v[184:187], v[144:147]
v_exp_f32 v66, v66
v_mfma_f32_16x16x32_bf16 v[28:31], a[148:151], v[188:191], v[28:31]
buffer_load_dwordx4 v232, s[12:15], s39 offen offset:2048 lds
v_mfma_f32_16x16x32_bf16 v[28:31], a[152:155], v[192:195], v[28:31]
v_exp_f32 v67, v67
v_mfma_f32_16x16x32_bf16 v[28:31], a[156:159], v[196:199], v[28:31]
v_cvt_pk_bf16_f32 v100, v64, v65
v_cvt_pk_bf16_f32 v101, v66, v67
v_mfma_f32_16x16x32_bf16 a[24:27], a[184:187], v[72:75], a[24:27]
v_exp_f32 v68, v68
v_mfma_f32_16x16x32_bf16 a[56:59], a[184:187], v[76:79], a[56:59]
v_mul_u32_u24 v249, 0x480, v249
v_and_b32 v248, 1, v1
v_mfma_f32_16x16x32_bf16 a[88:91], a[184:187], v[80:83], a[88:91]
v_exp_f32 v69, v69
v_mfma_f32_16x16x32_bf16 a[120:123], a[184:187], v[84:87], a[120:123]
ds_read_b64_tr_b16 a[184:185], v226 offset:8192
ds_read_b64_tr_b16 a[186:187], v226 offset:12288
v_mfma_f32_16x16x32_bf16 v[36:39], a[144:147], v[200:203], v[148:151]
v_exp_f32 v70, v70
v_mfma_f32_16x16x32_bf16 v[36:39], a[148:151], v[204:207], v[36:39]
ds_read_b128 a[144:147], v216 offset:61440
ds_read_b128 a[148:151], v217 offset:61440
v_mfma_f32_16x16x32_bf16 v[36:39], a[152:155], v[208:211], v[36:39]
v_exp_f32 v71, v71
v_mfma_f32_16x16x32_bf16 v[36:39], a[156:159], v[212:215], v[36:39]
ds_read_b128 a[152:155], v218 offset:61440
ds_read_b128 a[156:159], v219 offset:61440
v_mfma_f32_16x16x32_bf16 a[28:31], a[188:191], v[72:75], a[28:31]
v_cvt_pk_bf16_f32 v102, v68, v69
v_cvt_pk_bf16_f32 v103, v70, v71
v_mfma_f32_16x16x32_bf16 a[60:63], a[188:191], v[76:79], a[60:63]
v_lshl_add_u32 v249, v248, 4, v249
v_bfe_u32 v248, v1, 2, 2
v_mfma_f32_16x16x32_bf16 a[92:95], a[188:191], v[80:83], a[92:95]
v_lshl_add_u32 v248, v4, 3, v248
v_lshlrev_b32 v248, 6, v248
v_mfma_f32_16x16x32_bf16 a[124:127], a[188:191], v[84:87], a[124:127]
s_waitcnt lgkmcnt(6)
ds_read_b64_tr_b16 a[188:189], v227 offset:8192
ds_read_b64_tr_b16 a[190:191], v227 offset:12288
v_lshl_add_u32 v248, v250, 3, v248
v_mfma_f32_16x16x32_bf16 v[40:43], a[128:131], v[152:155], v[136:139]
v_exp_f32 v8, v8
v_mfma_f32_16x16x32_bf16 v[40:43], a[132:135], v[156:159], v[40:43]
s_add_u32 m0, s49, 0
v_exp_f32 v9, v9
v_mfma_f32_16x16x32_bf16 v[40:43], a[136:139], v[160:163], v[40:43]
buffer_load_dwordx4 v5, s[20:23], s46 offen sc0 sc1 lds
v_mfma_f32_16x16x32_bf16 v[40:43], a[140:143], v[164:167], v[40:43]
v_exp_f32 v10, v10
v_mfma_f32_16x16x32_bf16 a[0:3], a[160:163], v[88:91], a[0:3]
v_cvt_pk_bf16_f32 v72, v8, v9
v_add_u32 v248, s49, v248
v_mfma_f32_16x16x32_bf16 a[32:35], a[160:163], v[92:95], a[32:35]
v_exp_f32 v11, v11
v_mfma_f32_16x16x32_bf16 a[64:67], a[160:163], v[96:99], a[64:67]
v_cvt_pk_bf16_f32 v73, v10, v11
v_and_b32 v244, 7, v1
v_mfma_f32_16x16x32_bf16 a[96:99], a[160:163], v[100:103], a[96:99]
s_add_u32 m0, s49, 1024
v_exp_f32 v12, v12
v_mfma_f32_16x16x32_bf16 v[48:51], a[128:131], v[168:171], v[140:143]
buffer_load_dwordx4 v6, s[20:23], s46 offen sc0 sc1 lds
v_mfma_f32_16x16x32_bf16 v[48:51], a[132:135], v[172:175], v[48:51]
v_exp_f32 v13, v13
v_mfma_f32_16x16x32_bf16 v[48:51], a[136:139], v[176:179], v[48:51]
ds_read_b64_tr_b16 a[160:161], v220 offset:16384
ds_read_b64_tr_b16 a[162:163], v220 offset:20480
v_mfma_f32_16x16x32_bf16 v[48:51], a[140:143], v[180:183], v[48:51]
v_exp_f32 v14, v14
v_mfma_f32_16x16x32_bf16 a[4:7], a[164:167], v[88:91], a[4:7]
v_cvt_pk_bf16_f32 v74, v12, v13
v_lshlrev_b32 v245, 1, v244
v_mfma_f32_16x16x32_bf16 a[36:39], a[164:167], v[92:95], a[36:39]
v_exp_f32 v15, v15
v_mfma_f32_16x16x32_bf16 a[68:71], a[164:167], v[96:99], a[68:71]
s_add_u32 m0, s49, 2048
v_cvt_pk_bf16_f32 v75, v14, v15
v_xor_b32 v245, v245, v4
v_mfma_f32_16x16x32_bf16 a[100:103], a[164:167], v[100:103], a[100:103]
v_exp_f32 v16, v16
v_smfmac_f32_16x16x64_bf16 a[248:251], a[208:211], v[88:95], v235
buffer_load_dwordx4 v7, s[20:23], s47 offen sc0 sc1 lds
v_mfma_f32_16x16x32_bf16 v[56:59], a[128:131], v[184:187], v[144:147]
v_exp_f32 v17, v17
v_mfma_f32_16x16x32_bf16 v[56:59], a[132:135], v[188:191], v[56:59]
ds_read_b64_tr_b16 a[164:165], v221 offset:16384
ds_read_b64_tr_b16 a[166:167], v221 offset:20480
v_mfma_f32_16x16x32_bf16 v[56:59], a[136:139], v[192:195], v[56:59]
v_exp_f32 v18, v18
v_mfma_f32_16x16x32_bf16 v[56:59], a[140:143], v[196:199], v[56:59]
v_cvt_pk_bf16_f32 v76, v16, v17
v_lshlrev_b32 v245, 4, v245
v_mfma_f32_16x16x32_bf16 a[8:11], a[168:171], v[88:91], a[8:11]
s_add_u32 m0, s49, 3072
v_exp_f32 v19, v19
v_mfma_f32_16x16x32_bf16 a[40:43], a[168:171], v[92:95], a[40:43]
s_add_u32 s48, s92, 1024
buffer_load_dwordx4 v249, s[64:67], s48 offen  lds
v_mfma_f32_16x16x32_bf16 a[72:75], a[168:171], v[96:99], a[72:75]
v_exp_f32 v20, v20
v_mfma_f32_16x16x32_bf16 a[104:107], a[168:171], v[100:103], a[104:107]
ds_read_b64_tr_b16 a[168:169], v222 offset:16384
ds_read_b64_tr_b16 a[170:171], v222 offset:20480
v_mfma_f32_16x16x32_bf16 v[64:67], a[128:131], v[200:203], v[148:151]
v_exp_f32 v21, v21
v_mfma_f32_16x16x32_bf16 v[64:67], a[132:135], v[204:207], v[64:67]
ds_read_b128 a[128:131], v216 offset:32768
ds_read_b128 a[132:135], v217 offset:32768
v_mfma_f32_16x16x32_bf16 v[64:67], a[136:139], v[208:211], v[64:67]
v_exp_f32 v22, v22
v_mfma_f32_16x16x32_bf16 v[64:67], a[140:143], v[212:215], v[64:67]
s_add_u32 m0, s37, 114688
ds_read_b128 a[136:139], v218 offset:32768
ds_read_b128 a[140:143], v219 offset:32768
v_mfma_f32_16x16x32_bf16 a[12:15], a[172:175], v[88:91], a[12:15]
v_exp_f32 v23, v23
v_mfma_f32_16x16x32_bf16 a[44:47], a[172:175], v[92:95], a[44:47]
buffer_load_dwordx4 v233, s[12:15], s39 offen offset:3072 lds
v_mfma_f32_16x16x32_bf16 a[76:79], a[172:175], v[96:99], a[76:79]
v_exp_f32 v24, v24
v_mfma_f32_16x16x32_bf16 a[108:111], a[172:175], v[100:103], a[108:111]
s_waitcnt lgkmcnt(6)
v_exp_f32 v25, v25
v_mfma_f32_16x16x32_bf16 v[44:47], a[144:147], v[152:155], v[136:139]
ds_read_b64_tr_b16 a[172:173], v223 offset:16384
ds_read_b64_tr_b16 a[174:175], v223 offset:20480
v_mfma_f32_16x16x32_bf16 v[44:47], a[148:151], v[156:159], v[44:47]
v_exp_f32 v26, v26
v_mfma_f32_16x16x32_bf16 v[44:47], a[152:155], v[160:163], v[44:47]
s_add_u32 s39, s39, 16384
v_cvt_pk_bf16_f32 v77, v18, v19
v_cvt_pk_bf16_f32 v78, v20, v21
v_mfma_f32_16x16x32_bf16 v[44:47], a[156:159], v[164:167], v[44:47]
s_add_u32 m0, s37, 0
v_exp_f32 v27, v27
v_mfma_f32_16x16x32_bf16 a[16:19], a[176:179], v[88:91], a[16:19]
buffer_load_dwordx4 v228, s[8:11], s38 offen offset:0 lds
v_mfma_f32_16x16x32_bf16 a[48:51], a[176:179], v[92:95], a[48:51]
v_exp_f32 v28, v28
v_mfma_f32_16x16x32_bf16 a[80:83], a[176:179], v[96:99], a[80:83]
v_cvt_pk_bf16_f32 v79, v22, v23
v_cvt_pk_bf16_f32 v80, v24, v25
v_mfma_f32_16x16x32_bf16 a[112:115], a[176:179], v[100:103], a[112:115]
v_exp_f32 v29, v29
v_mfma_f32_16x16x32_bf16 v[52:55], a[144:147], v[168:171], v[140:143]
ds_read_b64_tr_b16 a[176:177], v224 offset:16384
ds_read_b64_tr_b16 a[178:179], v224 offset:20480
v_mfma_f32_16x16x32_bf16 v[52:55], a[148:151], v[172:175], v[52:55]
v_exp_f32 v30, v30
v_mfma_f32_16x16x32_bf16 v[52:55], a[152:155], v[176:179], v[52:55]
buffer_load_dwordx4 v229, s[8:11], s38 offen offset:1024 lds
v_mfma_f32_16x16x32_bf16 v[52:55], a[156:159], v[180:183], v[52:55]
v_exp_f32 v31, v31
v_mfma_f32_16x16x32_bf16 a[20:23], a[180:183], v[88:91], a[20:23]
v_cvt_pk_bf16_f32 v81, v26, v27
v_cvt_pk_bf16_f32 v82, v28, v29
v_mfma_f32_16x16x32_bf16 a[52:55], a[180:183], v[92:95], a[52:55]
v_exp_f32 v32, v32
v_mfma_f32_16x16x32_bf16 a[84:87], a[180:183], v[96:99], a[84:87]
v_cvt_pk_bf16_f32 v83, v30, v31
v_lshl_add_u32 v245, v244, 8, v245
v_mfma_f32_16x16x32_bf16 a[116:119], a[180:183], v[100:103], a[116:119]
v_exp_f32 v33, v33
v_smfmac_f32_16x16x64_bf16 a[252:255], a[208:211], v[96:103], v235
buffer_load_dwordx4 v230, s[8:11], s38 offen offset:2048 lds
v_mfma_f32_16x16x32_bf16 v[60:63], a[144:147], v[184:187], v[144:147]
v_exp_f32 v34, v34
v_mfma_f32_16x16x32_bf16 v[60:63], a[148:151], v[188:191], v[60:63]
ds_read_b64_tr_b16 a[180:181], v225 offset:16384
ds_read_b64_tr_b16 a[182:183], v225 offset:20480
v_mfma_f32_16x16x32_bf16 v[60:63], a[152:155], v[192:195], v[60:63]
v_exp_f32 v35, v35
v_mfma_f32_16x16x32_bf16 v[60:63], a[156:159], v[196:199], v[60:63]
v_cvt_pk_bf16_f32 v84, v32, v33
v_cvt_pk_bf16_f32 v85, v34, v35
v_mfma_f32_16x16x32_bf16 a[24:27], a[184:187], v[88:91], a[24:27]
v_exp_f32 v36, v36
v_mfma_f32_16x16x32_bf16 a[56:59], a[184:187], v[92:95], a[56:59]
v_add_u32 v245, s49, v245
v_lshlrev_b32 v246, 4, v4
v_mfma_f32_16x16x32_bf16 a[88:91], a[184:187], v[96:99], a[88:91]
v_exp_f32 v37, v37
v_mfma_f32_16x16x32_bf16 a[120:123], a[184:187], v[100:103], a[120:123]
buffer_load_dwordx4 v231, s[8:11], s38 offen offset:3072 lds
v_mfma_f32_16x16x32_bf16 v[68:71], a[144:147], v[200:203], v[148:151]
v_exp_f32 v38, v38
v_mfma_f32_16x16x32_bf16 v[68:71], a[148:151], v[204:207], v[68:71]
ds_read_b64_tr_b16 a[184:185], v226 offset:16384
ds_read_b64_tr_b16 a[186:187], v226 offset:20480
v_mfma_f32_16x16x32_bf16 v[68:71], a[152:155], v[208:211], v[68:71]
v_exp_f32 v39, v39
v_mfma_f32_16x16x32_bf16 v[68:71], a[156:159], v[212:215], v[68:71]
ds_read_b128 a[144:147], v216 offset:36864
ds_read_b128 a[148:151], v217 offset:36864
v_mfma_f32_16x16x32_bf16 a[28:31], a[188:191], v[88:91], a[28:31]
ds_read_b128 a[152:155], v218 offset:36864
ds_read_b128 a[156:159], v219 offset:36864
v_mfma_f32_16x16x32_bf16 a[60:63], a[188:191], v[92:95], a[60:63]
s_add_u32 s38, s38, 16384
v_cvt_pk_bf16_f32 v86, v36, v37
v_cvt_pk_bf16_f32 v87, v38, v39
v_mfma_f32_16x16x32_bf16 a[92:95], a[188:191], v[96:99], a[92:95]
v_lshl_add_u32 v246, v244, 6, v246
v_mfma_f32_16x16x32_bf16 a[124:127], a[188:191], v[100:103], a[124:127]
s_waitcnt lgkmcnt(6)
s_cmp_lt_u32 s32, 2
s_cselect_b64 s[88:89], -1, 0
ds_read_b64_tr_b16 a[188:189], v227 offset:16384
ds_read_b64_tr_b16 a[190:191], v227 offset:20480
v_mfma_f32_16x16x32_bf16 v[8:11], a[128:131], v[152:155], v[136:139]
v_exp_f32 v40, v40
v_mfma_f32_16x16x32_bf16 v[8:11], a[132:135], v[156:159], v[8:11]
v_exp_f32 v41, v41
v_mfma_f32_16x16x32_bf16 v[8:11], a[136:139], v[160:163], v[8:11]
buffer_load_dwordx2 v[252:253], v251, s[76:79], s42 offen sc1
v_mfma_f32_16x16x32_bf16 v[8:11], a[140:143], v[164:167], v[8:11]
v_exp_f32 v42, v42
v_mfma_f32_16x16x32_bf16 a[0:3], a[160:163], v[72:75], a[0:3]
v_cvt_pk_bf16_f32 v88, v40, v41
v_add_u32 v246, s49, v246
v_mfma_f32_16x16x32_bf16 a[32:35], a[160:163], v[76:79], a[32:35]
v_exp_f32 v43, v43
v_mfma_f32_16x16x32_bf16 a[64:67], a[160:163], v[80:83], a[64:67]
v_cvt_pk_bf16_f32 v89, v42, v43
v_xor_b32 v5, 64, v245
v_mfma_f32_16x16x32_bf16 a[96:99], a[160:163], v[84:87], a[96:99]
v_exp_f32 v44, v44
v_mfma_f32_16x16x32_bf16 v[16:19], a[128:131], v[168:171], v[140:143]
ds_read_b64_tr_b16 a[160:161], v220 offset:24576
ds_read_b64_tr_b16 a[162:163], v220 offset:28672
v_mfma_f32_16x16x32_bf16 v[16:19], a[132:135], v[172:175], v[16:19]
v_exp_f32 v45, v45
v_mfma_f32_16x16x32_bf16 v[16:19], a[136:139], v[176:179], v[16:19]
v_cvt_pk_bf16_f32 v90, v44, v45
v_xor_b32 v6, 128, v245
v_mfma_f32_16x16x32_bf16 v[16:19], a[140:143], v[180:183], v[16:19]
v_exp_f32 v46, v46
v_mfma_f32_16x16x32_bf16 a[4:7], a[164:167], v[72:75], a[4:7]
v_xor_b32 v7, 192, v245
v_lshrrev_b32 v249, 2, v1
v_mfma_f32_16x16x32_bf16 a[36:39], a[164:167], v[76:79], a[36:39]
v_exp_f32 v47, v47
v_mfma_f32_16x16x32_bf16 a[68:71], a[164:167], v[80:83], a[68:71]
v_cvt_pk_bf16_f32 v91, v46, v47
v_lshlrev_b32 v249, 5, v249
v_mfma_f32_16x16x32_bf16 a[100:103], a[164:167], v[84:87], a[100:103]
v_exp_f32 v48, v48
v_smfmac_f32_16x16x64_bf16 a[248:251], a[208:211], v[72:79], v235
s_add_u32 s42, s42, s43
buffer_load_dword v255, v243, s[28:31], s45 offen
v_mfma_f32_16x16x32_bf16 v[24:27], a[128:131], v[184:187], v[144:147]
v_exp_f32 v49, v49
v_mfma_f32_16x16x32_bf16 v[24:27], a[132:135], v[188:191], v[24:27]
ds_read_b64_tr_b16 a[164:165], v221 offset:24576
ds_read_b64_tr_b16 a[166:167], v221 offset:28672
v_mfma_f32_16x16x32_bf16 v[24:27], a[136:139], v[192:195], v[24:27]
v_exp_f32 v50, v50
v_mfma_f32_16x16x32_bf16 v[24:27], a[140:143], v[196:199], v[24:27]
v_cvt_pk_bf16_f32 v92, v48, v49
v_lshl_add_u32 v249, v250, 3, v249
v_mfma_f32_16x16x32_bf16 a[8:11], a[168:171], v[72:75], a[8:11]
v_exp_f32 v51, v51
v_mfma_f32_16x16x32_bf16 a[40:43], a[168:171], v[76:79], a[40:43]
v_cvt_pk_bf16_f32 v93, v50, v51
v_add_u32 v249, s49, v249
v_mfma_f32_16x16x32_bf16 a[72:75], a[168:171], v[80:83], a[72:75]
v_exp_f32 v52, v52
v_mfma_f32_16x16x32_bf16 a[104:107], a[168:171], v[84:87], a[104:107]
ds_read_b64_tr_b16 a[168:169], v222 offset:24576
ds_read_b64_tr_b16 a[170:171], v222 offset:28672
v_mfma_f32_16x16x32_bf16 v[32:35], a[128:131], v[200:203], v[148:151]
v_exp_f32 v53, v53
v_mfma_f32_16x16x32_bf16 v[32:35], a[132:135], v[204:207], v[32:35]
ds_read_b128 a[128:131], v216 offset:40960
ds_read_b128 a[132:135], v217 offset:40960
v_mfma_f32_16x16x32_bf16 v[32:35], a[136:139], v[208:211], v[32:35]
v_exp_f32 v54, v54
v_mfma_f32_16x16x32_bf16 v[32:35], a[140:143], v[212:215], v[32:35]
ds_read_b128 a[136:139], v218 offset:40960
ds_read_b128 a[140:143], v219 offset:40960
v_mfma_f32_16x16x32_bf16 a[12:15], a[172:175], v[72:75], a[12:15]
v_exp_f32 v55, v55
v_mfma_f32_16x16x32_bf16 a[44:47], a[172:175], v[76:79], a[44:47]
v_cvt_pk_bf16_f32 v94, v52, v53
v_cvt_pk_bf16_f32 v95, v54, v55
v_mfma_f32_16x16x32_bf16 a[76:79], a[172:175], v[80:83], a[76:79]
s_waitcnt lgkmcnt(6)
v_exp_f32 v56, v56
v_mfma_f32_16x16x32_bf16 a[108:111], a[172:175], v[84:87], a[108:111]
s_add_u32 s45, s45, 589824
v_exp_f32 v57, v57
v_mfma_f32_16x16x32_bf16 v[12:15], a[144:147], v[152:155], v[136:139]
global_load_dword v255, v242, s[72:73]
v_mfma_f32_16x16x32_bf16 v[12:15], a[148:151], v[156:159], v[12:15]
v_exp_f32 v58, v58
v_mfma_f32_16x16x32_bf16 v[12:15], a[152:155], v[160:163], v[12:15]
ds_read_b64_tr_b16 a[172:173], v223 offset:24576
ds_read_b64_tr_b16 a[174:175], v223 offset:28672
v_mfma_f32_16x16x32_bf16 v[12:15], a[156:159], v[164:167], v[12:15]
v_exp_f32 v59, v59
v_mfma_f32_16x16x32_bf16 a[16:19], a[176:179], v[72:75], a[16:19]
v_cvt_pk_bf16_f32 v96, v56, v57
v_cvt_pk_bf16_f32 v97, v58, v59
v_mfma_f32_16x16x32_bf16 a[48:51], a[176:179], v[76:79], a[48:51]
v_exp_f32 v60, v60
v_mfma_f32_16x16x32_bf16 a[80:83], a[176:179], v[80:83], a[80:83]
v_mfma_f32_16x16x32_bf16 a[112:115], a[176:179], v[84:87], a[112:115]
v_exp_f32 v61, v61
v_mfma_f32_16x16x32_bf16 v[20:23], a[144:147], v[168:171], v[140:143]
ds_read_b64_tr_b16 a[176:177], v224 offset:24576
ds_read_b64_tr_b16 a[178:179], v224 offset:28672
v_mfma_f32_16x16x32_bf16 v[20:23], a[148:151], v[172:175], v[20:23]
v_exp_f32 v62, v62
v_mfma_f32_16x16x32_bf16 v[20:23], a[152:155], v[176:179], v[20:23]
v_cvt_pk_bf16_f32 v98, v60, v61
v_mfma_f32_16x16x32_bf16 v[20:23], a[156:159], v[180:183], v[20:23]
v_exp_f32 v63, v63
v_mfma_f32_16x16x32_bf16 a[20:23], a[180:183], v[72:75], a[20:23]
v_cvt_pk_bf16_f32 v99, v62, v63
v_mfma_f32_16x16x32_bf16 a[52:55], a[180:183], v[76:79], a[52:55]
v_exp_f32 v64, v64
v_mfma_f32_16x16x32_bf16 a[84:87], a[180:183], v[80:83], a[84:87]
buffer_load_dword v255, v0, s[24:27], s44 offen
v_mfma_f32_16x16x32_bf16 a[116:119], a[180:183], v[84:87], a[116:119]
v_exp_f32 v65, v65
v_smfmac_f32_16x16x64_bf16 a[252:255], a[208:211], v[80:87], v235
ds_read_b64_tr_b16 a[180:181], v225 offset:24576
ds_read_b64_tr_b16 a[182:183], v225 offset:28672
v_mfma_f32_16x16x32_bf16 v[28:31], a[144:147], v[184:187], v[144:147]
v_exp_f32 v66, v66
v_mfma_f32_16x16x32_bf16 v[28:31], a[148:151], v[188:191], v[28:31]
v_cvt_pk_bf16_f32 v100, v64, v65
v_mfma_f32_16x16x32_bf16 v[28:31], a[152:155], v[192:195], v[28:31]
v_exp_f32 v67, v67
v_mfma_f32_16x16x32_bf16 v[28:31], a[156:159], v[196:199], v[28:31]
v_cvt_pk_bf16_f32 v101, v66, v67
v_mfma_f32_16x16x32_bf16 a[24:27], a[184:187], v[72:75], a[24:27]
v_exp_f32 v68, v68
v_mfma_f32_16x16x32_bf16 a[56:59], a[184:187], v[76:79], a[56:59]
v_mfma_f32_16x16x32_bf16 a[88:91], a[184:187], v[80:83], a[88:91]
v_exp_f32 v69, v69
v_mfma_f32_16x16x32_bf16 a[120:123], a[184:187], v[84:87], a[120:123]
ds_read_b64_tr_b16 a[184:185], v226 offset:24576
ds_read_b64_tr_b16 a[186:187], v226 offset:28672
v_mfma_f32_16x16x32_bf16 v[36:39], a[144:147], v[200:203], v[148:151]
v_exp_f32 v70, v70
v_mfma_f32_16x16x32_bf16 v[36:39], a[148:151], v[204:207], v[36:39]
ds_read_b128 a[144:147], v216 offset:45056
ds_read_b128 a[148:151], v217 offset:45056
v_mfma_f32_16x16x32_bf16 v[36:39], a[152:155], v[208:211], v[36:39]
v_exp_f32 v71, v71
v_mfma_f32_16x16x32_bf16 v[36:39], a[156:159], v[212:215], v[36:39]
ds_read_b128 a[152:155], v218 offset:45056
ds_read_b128 a[156:159], v219 offset:45056
v_mfma_f32_16x16x32_bf16 a[28:31], a[188:191], v[72:75], a[28:31]
v_cvt_pk_bf16_f32 v102, v68, v69
v_cvt_pk_bf16_f32 v103, v70, v71
v_mfma_f32_16x16x32_bf16 a[60:63], a[188:191], v[76:79], a[60:63]
s_add_u32 s44, s44, 4096
v_mfma_f32_16x16x32_bf16 a[92:95], a[188:191], v[80:83], a[92:95]
v_mfma_f32_16x16x32_bf16 a[124:127], a[188:191], v[84:87], a[124:127]
s_waitcnt lgkmcnt(6)
ds_read_b64_tr_b16 a[188:189], v227 offset:24576
ds_read_b64_tr_b16 a[190:191], v227 offset:28672
v_mfma_f32_16x16x32_bf16 v[40:43], a[128:131], v[152:155], v[136:139]
v_exp_f32 v8, v8
v_mfma_f32_16x16x32_bf16 v[40:43], a[132:135], v[156:159], v[40:43]
v_exp_f32 v9, v9
v_mfma_f32_16x16x32_bf16 v[40:43], a[136:139], v[160:163], v[40:43]
v_cvt_pk_bf16_f32 v72, v8, v9
v_mfma_f32_16x16x32_bf16 v[40:43], a[140:143], v[164:167], v[40:43]
v_exp_f32 v10, v10
v_mfma_f32_16x16x32_bf16 a[0:3], a[160:163], v[88:91], a[0:3]
v_mfma_f32_16x16x32_bf16 a[32:35], a[160:163], v[92:95], a[32:35]
v_exp_f32 v11, v11
s_waitcnt vmcnt(4) lgkmcnt(0)
s_barrier
v_mfma_f32_16x16x32_bf16 a[64:67], a[160:163], v[96:99], a[64:67]
v_cvt_pk_bf16_f32 v73, v10, v11
v_mfma_f32_16x16x32_bf16 a[96:99], a[160:163], v[100:103], a[96:99]
s_add_u32 m0, s37, 65536
v_exp_f32 v12, v12
v_mfma_f32_16x16x32_bf16 v[48:51], a[128:131], v[168:171], v[140:143]
s_waitcnt vmcnt(9)
s_nop 0
buffer_load_dwordx4 v232, s[12:15], s39 offen offset:0 lds
v_mfma_f32_16x16x32_bf16 v[48:51], a[132:135], v[172:175], v[48:51]
v_exp_f32 v13, v13
v_mfma_f32_16x16x32_bf16 v[48:51], a[136:139], v[176:179], v[48:51]
ds_read_b64_tr_b16 a[160:161], v220 offset:32768
ds_read_b64_tr_b16 a[162:163], v220 offset:36864
v_mfma_f32_16x16x32_bf16 v[48:51], a[140:143], v[180:183], v[48:51]
v_exp_f32 v14, v14
v_mfma_f32_16x16x32_bf16 a[4:7], a[164:167], v[88:91], a[4:7]
ds_read_b64_tr_b16 a[192:193], v248 offset:4096
v_cvt_pk_bf16_f32 v74, v12, v13
v_mfma_f32_16x16x32_bf16 a[36:39], a[164:167], v[92:95], a[36:39]
v_exp_f32 v15, v15
v_mfma_f32_16x16x32_bf16 a[68:71], a[164:167], v[96:99], a[68:71]
ds_read_b64_tr_b16 a[194:195], v248 offset:4352
v_cvt_pk_bf16_f32 v75, v14, v15
v_mfma_f32_16x16x32_bf16 a[100:103], a[164:167], v[100:103], a[100:103]
v_exp_f32 v16, v16
v_smfmac_f32_16x16x64_bf16 a[248:251], a[208:211], v[88:95], v235
buffer_load_dwordx4 v233, s[12:15], s39 offen offset:1024 lds
v_mfma_f32_16x16x32_bf16 v[56:59], a[128:131], v[184:187], v[144:147]
v_exp_f32 v17, v17
v_mfma_f32_16x16x32_bf16 v[56:59], a[132:135], v[188:191], v[56:59]
ds_read_b64_tr_b16 a[164:165], v221 offset:32768
ds_read_b64_tr_b16 a[166:167], v221 offset:36864
v_mfma_f32_16x16x32_bf16 v[56:59], a[136:139], v[192:195], v[56:59]
v_exp_f32 v18, v18
v_mfma_f32_16x16x32_bf16 v[56:59], a[140:143], v[196:199], v[56:59]
ds_read_b64_tr_b16 a[196:197], v248 offset:4128
v_cvt_pk_bf16_f32 v76, v16, v17
v_mfma_f32_16x16x32_bf16 a[8:11], a[168:171], v[88:91], a[8:11]
v_exp_f32 v19, v19
v_mfma_f32_16x16x32_bf16 a[40:43], a[168:171], v[92:95], a[40:43]
ds_read_b64_tr_b16 a[198:199], v248 offset:4384
v_cvt_pk_bf16_f32 v77, v18, v19
v_mfma_f32_16x16x32_bf16 a[72:75], a[168:171], v[96:99], a[72:75]
v_exp_f32 v20, v20
v_mfma_f32_16x16x32_bf16 a[104:107], a[168:171], v[100:103], a[104:107]
ds_read_b64_tr_b16 a[168:169], v222 offset:32768
ds_read_b64_tr_b16 a[170:171], v222 offset:36864
v_mfma_f32_16x16x32_bf16 v[64:67], a[128:131], v[200:203], v[148:151]
v_exp_f32 v21, v21
v_mfma_f32_16x16x32_bf16 v[64:67], a[132:135], v[204:207], v[64:67]
buffer_load_dwordx4 v232, s[12:15], s39 offen offset:2048 lds
v_mfma_f32_16x16x32_bf16 v[64:67], a[136:139], v[208:211], v[64:67]
v_exp_f32 v22, v22
v_mfma_f32_16x16x32_bf16 v[64:67], a[140:143], v[212:215], v[64:67]
ds_read_b128 a[128:131], v216 offset:16384
ds_read_b128 a[132:135], v217 offset:16384
v_mfma_f32_16x16x32_bf16 a[12:15], a[172:175], v[88:91], a[12:15]
v_exp_f32 v23, v23
v_mfma_f32_16x16x32_bf16 a[44:47], a[172:175], v[92:95], a[44:47]
ds_read_b128 a[136:139], v218 offset:16384
ds_read_b128 a[140:143], v219 offset:16384
v_mfma_f32_16x16x32_bf16 a[76:79], a[172:175], v[96:99], a[76:79]
v_exp_f32 v24, v24
v_mfma_f32_16x16x32_bf16 a[108:111], a[172:175], v[100:103], a[108:111]
v_exp_f32 v25, v25
v_mfma_f32_16x16x32_bf16 v[44:47], a[144:147], v[152:155], v[136:139]
ds_read_b64_tr_b16 a[172:173], v223 offset:32768
ds_read_b64_tr_b16 a[174:175], v223 offset:36864
v_mfma_f32_16x16x32_bf16 v[44:47], a[148:151], v[156:159], v[44:47]
v_exp_f32 v26, v26
v_mfma_f32_16x16x32_bf16 v[44:47], a[152:155], v[160:163], v[44:47]
buffer_load_dwordx4 v233, s[12:15], s39 offen offset:3072 lds
v_mfma_f32_16x16x32_bf16 v[44:47], a[156:159], v[164:167], v[44:47]
v_exp_f32 v27, v27
v_mfma_f32_16x16x32_bf16 a[16:19], a[176:179], v[88:91], a[16:19]
v_cvt_pk_bf16_f32 v78, v20, v21
v_cvt_pk_bf16_f32 v79, v22, v23
v_mfma_f32_16x16x32_bf16 a[48:51], a[176:179], v[92:95], a[48:51]
v_exp_f32 v28, v28
v_mfma_f32_16x16x32_bf16 a[80:83], a[176:179], v[96:99], a[80:83]
v_cvt_pk_bf16_f32 v80, v24, v25
v_cvt_pk_bf16_f32 v81, v26, v27
v_mfma_f32_16x16x32_bf16 a[112:115], a[176:179], v[100:103], a[112:115]
v_exp_f32 v29, v29
v_mfma_f32_16x16x32_bf16 v[52:55], a[144:147], v[168:171], v[140:143]
ds_read_b64_tr_b16 a[176:177], v224 offset:32768
ds_read_b64_tr_b16 a[178:179], v224 offset:36864
v_mfma_f32_16x16x32_bf16 v[52:55], a[148:151], v[172:175], v[52:55]
v_exp_f32 v30, v30
v_mfma_f32_16x16x32_bf16 v[52:55], a[152:155], v[176:179], v[52:55]
ds_read_b64_tr_b16 a[200:201], v248 offset:6144
v_cvt_pk_bf16_f32 v82, v28, v29
v_mfma_f32_16x16x32_bf16 v[52:55], a[156:159], v[180:183], v[52:55]
s_add_u32 s39, s39, 16384
v_exp_f32 v31, v31
v_mfma_f32_16x16x32_bf16 a[20:23], a[180:183], v[88:91], a[20:23]
s_add_u32 m0, s37, 49152
ds_read_b64_tr_b16 a[202:203], v248 offset:6400
v_cvt_pk_bf16_f32 v83, v30, v31
v_mfma_f32_16x16x32_bf16 a[52:55], a[180:183], v[92:95], a[52:55]
v_exp_f32 v32, v32
v_mfma_f32_16x16x32_bf16 a[84:87], a[180:183], v[96:99], a[84:87]
buffer_load_dwordx4 v228, s[8:11], s38 offen offset:0 lds
v_mfma_f32_16x16x32_bf16 a[116:119], a[180:183], v[100:103], a[116:119]
v_exp_f32 v33, v33
v_smfmac_f32_16x16x64_bf16 a[252:255], a[208:211], v[96:103], v235
ds_read_b64_tr_b16 a[180:181], v225 offset:32768
ds_read_b64_tr_b16 a[182:183], v225 offset:36864
v_mfma_f32_16x16x32_bf16 v[60:63], a[144:147], v[184:187], v[144:147]
v_exp_f32 v34, v34
v_mfma_f32_16x16x32_bf16 v[60:63], a[148:151], v[188:191], v[60:63]
ds_read_b64_tr_b16 a[204:205], v248 offset:6176
v_cvt_pk_bf16_f32 v84, v32, v33
v_mfma_f32_16x16x32_bf16 v[60:63], a[152:155], v[192:195], v[60:63]
v_exp_f32 v35, v35
v_mfma_f32_16x16x32_bf16 v[60:63], a[156:159], v[196:199], v[60:63]
buffer_load_dwordx4 v229, s[8:11], s38 offen offset:1024 lds
v_mfma_f32_16x16x32_bf16 a[24:27], a[184:187], v[88:91], a[24:27]
v_exp_f32 v36, v36
v_mfma_f32_16x16x32_bf16 a[56:59], a[184:187], v[92:95], a[56:59]
ds_read_b64_tr_b16 a[206:207], v248 offset:6432
v_cvt_pk_bf16_f32 v85, v34, v35
v_mfma_f32_16x16x32_bf16 a[88:91], a[184:187], v[96:99], a[88:91]
v_exp_f32 v37, v37
v_mfma_f32_16x16x32_bf16 a[120:123], a[184:187], v[100:103], a[120:123]
ds_read_b64_tr_b16 a[184:185], v226 offset:32768
ds_read_b64_tr_b16 a[186:187], v226 offset:36864
v_mfma_f32_16x16x32_bf16 v[68:71], a[144:147], v[200:203], v[148:151]
v_exp_f32 v38, v38
v_mfma_f32_16x16x32_bf16 v[68:71], a[148:151], v[204:207], v[68:71]
ds_read_b128 a[144:147], v216 offset:20480
ds_read_b128 a[148:151], v217 offset:20480
v_mfma_f32_16x16x32_bf16 v[68:71], a[152:155], v[208:211], v[68:71]
v_exp_f32 v39, v39
v_mfma_f32_16x16x32_bf16 v[68:71], a[156:159], v[212:215], v[68:71]
ds_read_b128 a[152:155], v218 offset:20480
ds_read_b128 a[156:159], v219 offset:20480
v_mfma_f32_16x16x32_bf16 a[28:31], a[188:191], v[88:91], a[28:31]
v_cvt_pk_bf16_f32 v86, v36, v37
v_cvt_pk_bf16_f32 v87, v38, v39
v_mfma_f32_16x16x32_bf16 a[60:63], a[188:191], v[92:95], a[60:63]
ds_read_b128 a[228:231], v246 offset:2048
ds_read_b128 a[212:215], v245
v_mfma_f32_16x16x32_bf16 a[92:95], a[188:191], v[96:99], a[92:95]
ds_read_b128 a[216:219], v5
v_mfma_f32_16x16x32_bf16 a[124:127], a[188:191], v[100:103], a[124:127]
s_waitcnt lgkmcnt(9)
ds_read_b64_tr_b16 a[188:189], v227 offset:32768
ds_read_b64_tr_b16 a[190:191], v227 offset:36864
v_mfma_f32_16x16x32_bf16 v[8:11], a[128:131], v[152:155], v[136:139]
v_exp_f32 v40, v40
v_mfma_f32_16x16x32_bf16 v[8:11], a[132:135], v[156:159], v[8:11]
buffer_load_dwordx4 v230, s[8:11], s38 offen offset:2048 lds
v_mfma_f32_16x16x32_bf16 v[8:11], a[136:139], v[160:163], v[8:11]
v_exp_f32 v41, v41
v_mfma_f32_16x16x32_bf16 v[8:11], a[140:143], v[164:167], v[8:11]
ds_read_b128 a[220:223], v6
v_cvt_pk_bf16_f32 v88, v40, v41
v_mfma_f32_16x16x32_bf16 a[0:3], a[160:163], v[72:75], a[0:3]
v_exp_f32 v42, v42
v_mfma_f32_16x16x32_bf16 a[32:35], a[160:163], v[76:79], a[32:35]
ds_read_b128 a[224:227], v7
ds_read_b64_tr_b16 a[232:233], v249 offset:3072
v_mfma_f32_16x16x32_bf16 a[64:67], a[160:163], v[80:83], a[64:67]
v_exp_f32 v43, v43
v_mfma_f32_16x16x32_bf16 a[96:99], a[160:163], v[84:87], a[96:99]
ds_read_b64_tr_b16 a[160:161], v220 offset:40960
ds_read_b64_tr_b16 a[162:163], v220 offset:45056
v_mfma_f32_16x16x32_bf16 v[16:19], a[128:131], v[168:171], v[140:143]
v_exp_f32 v44, v44
v_mfma_f32_16x16x32_bf16 v[16:19], a[132:135], v[172:175], v[16:19]
s_add_u32 m0, s49, 4096
ds_read_b64_tr_b16 a[234:235], v249 offset:3584
v_cvt_pk_bf16_f32 v89, v42, v43
v_mfma_f32_16x16x32_bf16 v[16:19], a[136:139], v[176:179], v[16:19]
s_add_u32 s48, s50, 0
v_exp_f32 v45, v45
v_mfma_f32_16x16x32_bf16 v[16:19], a[140:143], v[180:183], v[16:19]
buffer_load_dwordx4 v238, s[60:63], s48 offen  lds
v_mfma_f32_16x16x32_bf16 a[4:7], a[164:167], v[72:75], a[4:7]
v_exp_f32 v46, v46
v_mfma_f32_16x16x32_bf16 a[36:39], a[164:167], v[76:79], a[36:39]
v_cvt_pk_bf16_f32 v90, v44, v45
v_mfma_f32_16x16x32_bf16 a[68:71], a[164:167], v[80:83], a[68:71]
v_exp_f32 v47, v47
v_mfma_f32_16x16x32_bf16 a[100:103], a[164:167], v[84:87], a[100:103]
ds_read_b64_tr_b16 a[164:165], v221 offset:40960
ds_read_b64_tr_b16 a[166:167], v221 offset:45056
v_smfmac_f32_16x16x64_bf16 a[248:251], a[208:211], v[72:79], v235
s_waitcnt lgkmcnt(5)
v_exp_f32 v48, v48
v_mfma_f32_16x16x32_bf16 v[104:107], a[192:195], a[228:231], 0
s_add_u32 m0, s37, 49152
v_cvt_pk_bf16_f32 v91, v46, v47
v_mfma_f32_16x16x32_bf16 v[24:27], a[128:131], v[184:187], v[144:147]
v_exp_f32 v49, v49
v_mfma_f32_16x16x32_bf16 v[24:27], a[132:135], v[188:191], v[24:27]
buffer_load_dwordx4 v231, s[8:11], s38 offen offset:3072 lds
v_mfma_f32_16x16x32_bf16 v[24:27], a[136:139], v[192:195], v[24:27]
v_exp_f32 v50, v50
v_mfma_f32_16x16x32_bf16 v[24:27], a[140:143], v[196:199], v[24:27]
v_cvt_pk_bf16_f32 v92, v48, v49
v_mfma_f32_16x16x32_bf16 a[8:11], a[168:171], v[72:75], a[8:11]
v_exp_f32 v51, v51
v_mfma_f32_16x16x32_bf16 a[40:43], a[168:171], v[76:79], a[40:43]
v_cvt_pk_bf16_f32 v93, v50, v51
v_mfma_f32_16x16x32_bf16 a[72:75], a[168:171], v[80:83], a[72:75]
v_exp_f32 v52, v52
v_mfma_f32_16x16x32_bf16 a[104:107], a[168:171], v[84:87], a[104:107]
s_add_u32 m0, s49, 5120
ds_read_b64_tr_b16 a[168:169], v222 offset:40960
ds_read_b64_tr_b16 a[170:171], v222 offset:45056
v_mfma_f32_16x16x32_bf16 v[32:35], a[128:131], v[200:203], v[148:151]
s_add_u32 s48, s50, 147456
v_exp_f32 v53, v53
v_mfma_f32_16x16x32_bf16 v[32:35], a[132:135], v[204:207], v[32:35]
buffer_load_dwordx4 v238, s[60:63], s48 offen  lds
v_mfma_f32_16x16x32_bf16 v[32:35], a[136:139], v[208:211], v[32:35]
v_exp_f32 v54, v54
v_mfma_f32_16x16x32_bf16 v[32:35], a[140:143], v[212:215], v[32:35]
ds_read_b128 a[128:131], v216 offset:24576
ds_read_b128 a[132:135], v217 offset:24576
v_mfma_f32_16x16x32_bf16 a[12:15], a[172:175], v[72:75], a[12:15]
v_exp_f32 v55, v55
v_mfma_f32_16x16x32_bf16 a[44:47], a[172:175], v[76:79], a[44:47]
ds_read_b128 a[136:139], v218 offset:24576
ds_read_b128 a[140:143], v219 offset:24576
v_mfma_f32_16x16x32_bf16 a[76:79], a[172:175], v[80:83], a[76:79]
v_cvt_pk_bf16_f32 v94, v52, v53
v_cvt_pk_bf16_f32 v95, v54, v55
v_mfma_f32_16x16x32_bf16 a[108:111], a[172:175], v[84:87], a[108:111]
v_exp_f32 v56, v56
v_mfma_f32_16x16x32_bf16 v[108:111], a[196:199], a[228:231], 0
s_add_u32 s38, s38, 16384
ds_read_b64_tr_b16 a[172:173], v223 offset:40960
ds_read_b64_tr_b16 a[174:175], v223 offset:45056
v_mfma_f32_16x16x32_bf16 v[12:15], a[144:147], v[152:155], v[136:139]
s_add_u32 m0, s37, 81920
v_exp_f32 v57, v57
v_mfma_f32_16x16x32_bf16 v[12:15], a[148:151], v[156:159], v[12:15]
buffer_load_dwordx4 v232, s[12:15], s39 offen offset:0 lds
v_mfma_f32_16x16x32_bf16 v[12:15], a[152:155], v[160:163], v[12:15]
v_exp_f32 v58, v58
v_mfma_f32_16x16x32_bf16 v[12:15], a[156:159], v[164:167], v[12:15]
v_cvt_pk_bf16_f32 v96, v56, v57
v_mfma_f32_16x16x32_bf16 a[16:19], a[176:179], v[72:75], a[16:19]
v_exp_f32 v59, v59
v_mfma_f32_16x16x32_bf16 a[48:51], a[176:179], v[76:79], a[48:51]
v_cvt_pk_bf16_f32 v97, v58, v59
v_mfma_f32_16x16x32_bf16 a[80:83], a[176:179], v[80:83], a[80:83]
v_exp_f32 v60, v60
v_mfma_f32_16x16x32_bf16 a[112:115], a[176:179], v[84:87], a[112:115]
s_add_u32 m0, s49, 6144
ds_read_b64_tr_b16 a[176:177], v224 offset:40960
ds_read_b64_tr_b16 a[178:179], v224 offset:45056
v_mfma_f32_16x16x32_bf16 v[20:23], a[144:147], v[168:171], v[140:143]
s_add_u32 s48, s50, 294912
v_exp_f32 v61, v61
v_mfma_f32_16x16x32_bf16 v[20:23], a[148:151], v[172:175], v[20:23]
buffer_load_dwordx4 v238, s[60:63], s48 offen  lds
v_mfma_f32_16x16x32_bf16 v[20:23], a[152:155], v[176:179], v[20:23]
v_exp_f32 v62, v62
v_mfma_f32_16x16x32_bf16 v[20:23], a[156:159], v[180:183], v[20:23]
v_cvt_pk_bf16_f32 v98, v60, v61
v_mfma_f32_16x16x32_bf16 a[20:23], a[180:183], v[72:75], a[20:23]
v_exp_f32 v63, v63
v_mfma_f32_16x16x32_bf16 a[52:55], a[180:183], v[76:79], a[52:55]
v_cvt_pk_bf16_f32 v99, v62, v63
v_mfma_f32_16x16x32_bf16 a[84:87], a[180:183], v[80:83], a[84:87]
v_exp_f32 v64, v64
v_mfma_f32_16x16x32_bf16 a[116:119], a[180:183], v[84:87], a[116:119]
s_add_u32 m0, s37, 81920
ds_read_b64_tr_b16 a[180:181], v225 offset:40960
ds_read_b64_tr_b16 a[182:183], v225 offset:45056
v_smfmac_f32_16x16x64_bf16 a[252:255], a[208:211], v[80:87], v235
v_exp_f32 v65, v65
v_mfma_f32_16x16x32_bf16 v[112:115], a[200:203], a[228:231], 0
buffer_load_dwordx4 v233, s[12:15], s39 offen offset:1024 lds
v_mfma_f32_16x16x32_bf16 v[28:31], a[144:147], v[184:187], v[144:147]
v_exp_f32 v66, v66
v_mfma_f32_16x16x32_bf16 v[28:31], a[148:151], v[188:191], v[28:31]
v_cvt_pk_bf16_f32 v100, v64, v65
v_mfma_f32_16x16x32_bf16 v[28:31], a[152:155], v[192:195], v[28:31]
v_exp_f32 v67, v67
v_mfma_f32_16x16x32_bf16 v[28:31], a[156:159], v[196:199], v[28:31]
v_cvt_pk_bf16_f32 v101, v66, v67
v_mfma_f32_16x16x32_bf16 a[24:27], a[184:187], v[72:75], a[24:27]
v_exp_f32 v68, v68
v_mfma_f32_16x16x32_bf16 a[56:59], a[184:187], v[76:79], a[56:59]
buffer_load_dwordx4 v232, s[12:15], s39 offen offset:2048 lds
v_mfma_f32_16x16x32_bf16 a[88:91], a[184:187], v[80:83], a[88:91]
v_exp_f32 v69, v69
v_mfma_f32_16x16x32_bf16 a[120:123], a[184:187], v[84:87], a[120:123]
ds_read_b64_tr_b16 a[184:185], v226 offset:40960
ds_read_b64_tr_b16 a[186:187], v226 offset:45056
v_mfma_f32_16x16x32_bf16 v[36:39], a[144:147], v[200:203], v[148:151]
v_exp_f32 v70, v70
v_mfma_f32_16x16x32_bf16 v[36:39], a[148:151], v[204:207], v[36:39]
ds_read_b128 a[144:147], v216 offset:28672
ds_read_b128 a[148:151], v217 offset:28672
v_mfma_f32_16x16x32_bf16 v[36:39], a[152:155], v[208:211], v[36:39]
v_exp_f32 v71, v71
v_mfma_f32_16x16x32_bf16 v[36:39], a[156:159], v[212:215], v[36:39]
ds_read_b128 a[152:155], v218 offset:28672
ds_read_b128 a[156:159], v219 offset:28672
v_mfma_f32_16x16x32_bf16 a[28:31], a[188:191], v[72:75], a[28:31]
v_cvt_pk_bf16_f32 v102, v68, v69
v_cvt_pk_bf16_f32 v103, v70, v71
v_mfma_f32_16x16x32_bf16 a[60:63], a[188:191], v[76:79], a[60:63]
v_mfma_f32_16x16x32_bf16 a[92:95], a[188:191], v[80:83], a[92:95]
v_mfma_f32_16x16x32_bf16 a[124:127], a[188:191], v[84:87], a[124:127]
ds_read_b64_tr_b16 a[188:189], v227 offset:40960
ds_read_b64_tr_b16 a[190:191], v227 offset:45056
v_mfma_f32_16x16x32_bf16 v[116:119], a[204:207], a[228:231], 0
s_waitcnt lgkmcnt(8)
v_mfma_f32_16x16x32_bf16 v[40:43], a[128:131], v[152:155], v[136:139]
v_exp_f32 v8, v8
v_mfma_f32_16x16x32_bf16 v[40:43], a[132:135], v[156:159], v[40:43]
v_exp_f32 v9, v9
v_mfma_f32_16x16x32_bf16 v[40:43], a[136:139], v[160:163], v[40:43]
buffer_load_dwordx4 v233, s[12:15], s39 offen offset:3072 lds
v_mfma_f32_16x16x32_bf16 v[40:43], a[140:143], v[164:167], v[40:43]
v_exp_f32 v10, v10
v_mfma_f32_16x16x32_bf16 a[0:3], a[160:163], v[88:91], a[0:3]
v_cvt_pk_bf16_f32 v72, v8, v9
v_mfma_f32_16x16x32_bf16 a[32:35], a[160:163], v[92:95], a[32:35]
v_exp_f32 v11, v11
v_mfma_f32_16x16x32_bf16 a[64:67], a[160:163], v[96:99], a[64:67]
v_cvt_pk_bf16_f32 v73, v10, v11
v_mfma_f32_16x16x32_bf16 a[96:99], a[160:163], v[100:103], a[96:99]
v_exp_f32 v12, v12
v_mfma_f32_16x16x32_bf16 v[48:51], a[128:131], v[168:171], v[140:143]
s_add_u32 m0, s49, 7168
ds_read_b64_tr_b16 a[160:161], v220 offset:49152
ds_read_b64_tr_b16 a[162:163], v220 offset:53248
v_mfma_f32_16x16x32_bf16 v[48:51], a[132:135], v[172:175], v[48:51]
s_add_u32 s48, s50, 442368
v_exp_f32 v13, v13
v_mfma_f32_16x16x32_bf16 v[48:51], a[136:139], v[176:179], v[48:51]
buffer_load_dwordx4 v238, s[60:63], s48 offen  lds
v_mfma_f32_16x16x32_bf16 v[48:51], a[140:143], v[180:183], v[48:51]
v_exp_f32 v14, v14
v_mfma_f32_16x16x32_bf16 a[4:7], a[164:167], v[88:91], a[4:7]
v_cvt_pk_bf16_f32 v74, v12, v13
v_mfma_f32_16x16x32_bf16 a[36:39], a[164:167], v[92:95], a[36:39]
v_exp_f32 v15, v15
v_mfma_f32_16x16x32_bf16 a[68:71], a[164:167], v[96:99], a[68:71]
v_cvt_pk_bf16_f32 v75, v14, v15
v_mfma_f32_16x16x32_bf16 a[100:103], a[164:167], v[100:103], a[100:103]
v_exp_f32 v16, v16
v_smfmac_f32_16x16x64_bf16 a[248:251], a[208:211], v[88:95], v235
s_add_u32 s39, s39, 16384
ds_read_b64_tr_b16 a[164:165], v221 offset:49152
ds_read_b64_tr_b16 a[166:167], v221 offset:53248
v_mfma_f32_16x16x32_bf16 v[56:59], a[128:131], v[184:187], v[144:147]
s_add_u32 m0, s37, 32768
v_exp_f32 v17, v17
v_mfma_f32_16x16x32_bf16 v[56:59], a[132:135], v[188:191], v[56:59]
buffer_load_dwordx4 v228, s[8:11], s38 offen offset:0 lds
v_mfma_f32_16x16x32_bf16 v[56:59], a[136:139], v[192:195], v[56:59]
v_exp_f32 v18, v18
v_mfma_f32_16x16x32_bf16 v[56:59], a[140:143], v[196:199], v[56:59]
v_cvt_pk_bf16_f32 v76, v16, v17
v_mfma_f32_16x16x32_bf16 a[8:11], a[168:171], v[88:91], a[8:11]
v_exp_f32 v19, v19
v_mfma_f32_16x16x32_bf16 a[40:43], a[168:171], v[92:95], a[40:43]
v_cvt_pk_bf16_f32 v77, v18, v19
v_mfma_f32_16x16x32_bf16 a[72:75], a[168:171], v[96:99], a[72:75]
v_exp_f32 v20, v20
v_mfma_f32_16x16x32_bf16 a[104:107], a[168:171], v[100:103], a[104:107]
s_add_u32 m0, s49, 0
ds_read_b64_tr_b16 a[168:169], v222 offset:49152
ds_read_b64_tr_b16 a[170:171], v222 offset:53248
v_mfma_f32_16x16x32_bf16 v[64:67], a[128:131], v[200:203], v[148:151]
s_add_u32 s48, s50, 0
v_exp_f32 v21, v21
v_mfma_f32_16x16x32_bf16 v[64:67], a[132:135], v[204:207], v[64:67]
buffer_load_dwordx4 v238, s[56:59], s48 offen  lds
v_mfma_f32_16x16x32_bf16 v[64:67], a[136:139], v[208:211], v[64:67]
v_exp_f32 v22, v22
v_mfma_f32_16x16x32_bf16 v[64:67], a[140:143], v[212:215], v[64:67]
ds_read_b128 a[128:131], v216 offset:0
ds_read_b128 a[132:135], v217 offset:0
v_mfma_f32_16x16x32_bf16 a[12:15], a[172:175], v[88:91], a[12:15]
v_exp_f32 v23, v23
v_mfma_f32_16x16x32_bf16 a[44:47], a[172:175], v[92:95], a[44:47]
ds_read_b128 a[136:139], v218 offset:0
ds_read_b128 a[140:143], v219 offset:0
v_mfma_f32_16x16x32_bf16 a[76:79], a[172:175], v[96:99], a[76:79]
s_waitcnt lgkmcnt(6)
v_exp_f32 v24, v24
v_mfma_f32_16x16x32_bf16 a[108:111], a[172:175], v[100:103], a[108:111]
s_add_u32 m0, s37, 32768
v_exp_f32 v25, v25
v_mfma_f32_16x16x32_bf16 v[44:47], a[144:147], v[152:155], v[136:139]
buffer_load_dwordx4 v229, s[8:11], s38 offen offset:1024 lds
v_mfma_f32_16x16x32_bf16 v[44:47], a[148:151], v[156:159], v[44:47]
v_exp_f32 v26, v26
v_mfma_f32_16x16x32_bf16 v[44:47], a[152:155], v[160:163], v[44:47]
ds_read_b64_tr_b16 a[172:173], v223 offset:49152
ds_read_b64_tr_b16 a[174:175], v223 offset:53248
v_mfma_f32_16x16x32_bf16 v[44:47], a[156:159], v[164:167], v[44:47]
v_exp_f32 v27, v27
v_mfma_f32_16x16x32_bf16 a[16:19], a[176:179], v[88:91], a[16:19]
v_cvt_pk_bf16_f32 v78, v20, v21
v_cvt_pk_bf16_f32 v79, v22, v23
v_mfma_f32_16x16x32_bf16 a[48:51], a[176:179], v[92:95], a[48:51]
v_exp_f32 v28, v28
v_mfma_f32_16x16x32_bf16 a[80:83], a[176:179], v[96:99], a[80:83]
s_add_u32 m0, s49, 1024
v_cvt_pk_bf16_f32 v80, v24, v25
v_cvt_pk_bf16_f32 v81, v26, v27
v_mfma_f32_16x16x32_bf16 a[112:115], a[176:179], v[100:103], a[112:115]
s_add_u32 s48, s50, 147456
v_exp_f32 v29, v29
v_mfma_f32_16x16x32_bf16 v[52:55], a[144:147], v[168:171], v[140:143]
buffer_load_dwordx4 v238, s[56:59], s48 offen  lds
v_mfma_f32_16x16x32_bf16 v[52:55], a[148:151], v[172:175], v[52:55]
v_exp_f32 v30, v30
v_mfma_f32_16x16x32_bf16 v[52:55], a[152:155], v[176:179], v[52:55]
ds_read_b64_tr_b16 a[176:177], v224 offset:49152
ds_read_b64_tr_b16 a[178:179], v224 offset:53248
v_mfma_f32_16x16x32_bf16 v[52:55], a[156:159], v[180:183], v[52:55]
v_exp_f32 v31, v31
v_mfma_f32_16x16x32_bf16 a[20:23], a[180:183], v[88:91], a[20:23]
v_cvt_pk_bf16_f32 v82, v28, v29
v_cvt_pk_bf16_f32 v83, v30, v31
v_mfma_f32_16x16x32_bf16 a[52:55], a[180:183], v[92:95], a[52:55]
v_exp_f32 v32, v32
v_mfma_f32_16x16x32_bf16 a[84:87], a[180:183], v[96:99], a[84:87]
s_add_u32 m0, s37, 32768
v_mfma_f32_16x16x32_bf16 a[116:119], a[180:183], v[100:103], a[116:119]
v_exp_f32 v33, v33
v_smfmac_f32_16x16x64_bf16 a[252:255], a[208:211], v[96:103], v235
buffer_load_dwordx4 v230, s[8:11], s38 offen offset:2048 lds
v_mfma_f32_16x16x32_bf16 v[60:63], a[144:147], v[184:187], v[144:147]
v_exp_f32 v34, v34
v_mfma_f32_16x16x32_bf16 v[60:63], a[148:151], v[188:191], v[60:63]
ds_read_b64_tr_b16 a[180:181], v225 offset:49152
ds_read_b64_tr_b16 a[182:183], v225 offset:53248
v_mfma_f32_16x16x32_bf16 v[60:63], a[152:155], v[192:195], v[60:63]
v_exp_f32 v35, v35
v_mfma_f32_16x16x32_bf16 v[60:63], a[156:159], v[196:199], v[60:63]
v_cvt_pk_bf16_f32 v84, v32, v33
v_cvt_pk_bf16_f32 v85, v34, v35
v_mfma_f32_16x16x32_bf16 a[24:27], a[184:187], v[88:91], a[24:27]
v_exp_f32 v36, v36
v_mfma_f32_16x16x32_bf16 a[56:59], a[184:187], v[92:95], a[56:59]
buffer_load_dwordx4 v231, s[8:11], s38 offen offset:3072 lds
v_mfma_f32_16x16x32_bf16 a[88:91], a[184:187], v[96:99], a[88:91]
v_exp_f32 v37, v37
v_mfma_f32_16x16x32_bf16 a[120:123], a[184:187], v[100:103], a[120:123]
ds_read_b64_tr_b16 a[184:185], v226 offset:49152
ds_read_b64_tr_b16 a[186:187], v226 offset:53248
v_mfma_f32_16x16x32_bf16 v[68:71], a[144:147], v[200:203], v[148:151]
v_exp_f32 v38, v38
v_mfma_f32_16x16x32_bf16 v[68:71], a[148:151], v[204:207], v[68:71]
ds_read_b128 a[144:147], v216 offset:4096
ds_read_b128 a[148:151], v217 offset:4096
v_mfma_f32_16x16x32_bf16 v[68:71], a[152:155], v[208:211], v[68:71]
v_exp_f32 v39, v39
v_mfma_f32_16x16x32_bf16 v[68:71], a[156:159], v[212:215], v[68:71]
ds_read_b128 a[152:155], v218 offset:4096
ds_read_b128 a[156:159], v219 offset:4096
v_mfma_f32_16x16x32_bf16 a[28:31], a[188:191], v[88:91], a[28:31]
v_cvt_pk_bf16_f32 v86, v36, v37
v_cvt_pk_bf16_f32 v87, v38, v39
v_mfma_f32_16x16x32_bf16 a[60:63], a[188:191], v[92:95], a[60:63]
s_add_u32 s38, s38, 16384
v_mfma_f32_16x16x32_bf16 a[92:95], a[188:191], v[96:99], a[92:95]
v_mfma_f32_16x16x32_bf16 a[124:127], a[188:191], v[100:103], a[124:127]
s_waitcnt lgkmcnt(6)
ds_read_b64_tr_b16 a[188:189], v227 offset:49152
ds_read_b64_tr_b16 a[190:191], v227 offset:53248
v_mfma_f32_16x16x32_bf16 v[8:11], a[128:131], v[152:155], v[136:139]
v_exp_f32 v40, v40
v_mfma_f32_16x16x32_bf16 v[8:11], a[132:135], v[156:159], v[8:11]
s_add_u32 m0, s49, 2048
v_exp_f32 v41, v41
v_mfma_f32_16x16x32_bf16 v[8:11], a[136:139], v[160:163], v[8:11]
s_add_u32 s48, s50, 294912
buffer_load_dwordx4 v238, s[56:59], s48 offen  lds
v_mfma_f32_16x16x32_bf16 v[8:11], a[140:143], v[164:167], v[8:11]
v_exp_f32 v42, v42
v_mfma_f32_16x16x32_bf16 a[0:3], a[160:163], v[72:75], a[0:3]
v_cvt_pk_bf16_f32 v88, v40, v41
v_mfma_f32_16x16x32_bf16 a[32:35], a[160:163], v[76:79], a[32:35]
v_exp_f32 v43, v43
v_mfma_f32_16x16x32_bf16 a[64:67], a[160:163], v[80:83], a[64:67]
v_cvt_pk_bf16_f32 v89, v42, v43
v_mfma_f32_16x16x32_bf16 a[96:99], a[160:163], v[84:87], a[96:99]
v_exp_f32 v44, v44
v_mfma_f32_16x16x32_bf16 v[16:19], a[128:131], v[168:171], v[140:143]
ds_read_b64_tr_b16 a[160:161], v220 offset:57344
ds_read_b64_tr_b16 a[162:163], v220 offset:61440
v_mfma_f32_16x16x32_bf16 v[16:19], a[132:135], v[172:175], v[16:19]
v_exp_f32 v45, v45
v_mfma_f32_16x16x32_bf16 v[16:19], a[136:139], v[176:179], v[16:19]
v_cvt_pk_bf16_f32 v90, v44, v45
v_mfma_f32_16x16x32_bf16 v[16:19], a[140:143], v[180:183], v[16:19]
s_add_u32 m0, s49, 3072
v_exp_f32 v46, v46
v_mfma_f32_16x16x32_bf16 a[4:7], a[164:167], v[72:75], a[4:7]
s_add_u32 s48, s50, 442368
buffer_load_dwordx4 v238, s[56:59], s48 offen  lds
v_mfma_f32_16x16x32_bf16 a[36:39], a[164:167], v[76:79], a[36:39]
v_exp_f32 v47, v47
v_mfma_f32_16x16x32_bf16 a[68:71], a[164:167], v[80:83], a[68:71]
v_cvt_pk_bf16_f32 v91, v46, v47
v_mfma_f32_16x16x32_bf16 a[100:103], a[164:167], v[84:87], a[100:103]
v_exp_f32 v48, v48
v_smfmac_f32_16x16x64_bf16 a[248:251], a[208:211], v[72:79], v235
ds_read_b64_tr_b16 a[164:165], v221 offset:57344
ds_read_b64_tr_b16 a[166:167], v221 offset:61440
v_mfma_f32_16x16x32_bf16 v[24:27], a[128:131], v[184:187], v[144:147]
v_exp_f32 v49, v49
v_mfma_f32_16x16x32_bf16 v[24:27], a[132:135], v[188:191], v[24:27]
v_cvt_pk_bf16_f32 v92, v48, v49
v_mfma_f32_16x16x32_bf16 v[24:27], a[136:139], v[192:195], v[24:27]
v_exp_f32 v50, v50
v_mfma_f32_16x16x32_bf16 v[24:27], a[140:143], v[196:199], v[24:27]
v_mfma_f32_16x16x32_bf16 a[8:11], a[168:171], v[72:75], a[8:11]
v_exp_f32 v51, v51
v_mfma_f32_16x16x32_bf16 a[40:43], a[168:171], v[76:79], a[40:43]
buffer_load_dwordx2 v[252:253], v251, s[76:79], s42 offen sc1
v_mfma_f32_16x16x32_bf16 a[72:75], a[168:171], v[80:83], a[72:75]
v_exp_f32 v52, v52
v_mfma_f32_16x16x32_bf16 a[104:107], a[168:171], v[84:87], a[104:107]
ds_read_b64_tr_b16 a[168:169], v222 offset:57344
ds_read_b64_tr_b16 a[170:171], v222 offset:61440
v_mfma_f32_16x16x32_bf16 v[32:35], a[128:131], v[200:203], v[148:151]
v_exp_f32 v53, v53
v_mfma_f32_16x16x32_bf16 v[32:35], a[132:135], v[204:207], v[32:35]
ds_read_b128 a[128:131], v216 offset:8192
ds_read_b128 a[132:135], v217 offset:8192
v_mfma_f32_16x16x32_bf16 v[32:35], a[136:139], v[208:211], v[32:35]
v_exp_f32 v54, v54
v_mfma_f32_16x16x32_bf16 v[32:35], a[140:143], v[212:215], v[32:35]
ds_read_b128 a[136:139], v218 offset:8192
ds_read_b128 a[140:143], v219 offset:8192
v_mfma_f32_16x16x32_bf16 a[12:15], a[172:175], v[72:75], a[12:15]
v_exp_f32 v55, v55
v_mfma_f32_16x16x32_bf16 a[44:47], a[172:175], v[76:79], a[44:47]
v_cvt_pk_bf16_f32 v93, v50, v51
v_cvt_pk_bf16_f32 v94, v52, v53
v_mfma_f32_16x16x32_bf16 a[76:79], a[172:175], v[80:83], a[76:79]
s_waitcnt lgkmcnt(6)
v_exp_f32 v56, v56
v_mfma_f32_16x16x32_bf16 a[108:111], a[172:175], v[84:87], a[108:111]
s_add_u32 s42, s42, s43
v_exp_f32 v57, v57
v_mfma_f32_16x16x32_bf16 v[12:15], a[144:147], v[152:155], v[136:139]
buffer_load_dword v255, v243, s[28:31], s45 offen
v_mfma_f32_16x16x32_bf16 v[12:15], a[148:151], v[156:159], v[12:15]
v_exp_f32 v58, v58
v_mfma_f32_16x16x32_bf16 v[12:15], a[152:155], v[160:163], v[12:15]
ds_read_b64_tr_b16 a[172:173], v223 offset:57344
ds_read_b64_tr_b16 a[174:175], v223 offset:61440
v_mfma_f32_16x16x32_bf16 v[12:15], a[156:159], v[164:167], v[12:15]
v_exp_f32 v59, v59
v_mfma_f32_16x16x32_bf16 a[16:19], a[176:179], v[72:75], a[16:19]
v_cvt_pk_bf16_f32 v95, v54, v55
v_cvt_pk_bf16_f32 v96, v56, v57
v_mfma_f32_16x16x32_bf16 a[48:51], a[176:179], v[76:79], a[48:51]
v_exp_f32 v60, v60
v_mfma_f32_16x16x32_bf16 a[80:83], a[176:179], v[80:83], a[80:83]
v_cvt_pk_bf16_f32 v97, v58, v59
v_mfma_f32_16x16x32_bf16 a[112:115], a[176:179], v[84:87], a[112:115]
v_exp_f32 v61, v61
v_mfma_f32_16x16x32_bf16 v[20:23], a[144:147], v[168:171], v[140:143]
ds_read_b64_tr_b16 a[176:177], v224 offset:57344
ds_read_b64_tr_b16 a[178:179], v224 offset:61440
v_mfma_f32_16x16x32_bf16 v[20:23], a[148:151], v[172:175], v[20:23]
s_add_u32 s45, s45, 589824
v_exp_f32 v62, v62
v_mfma_f32_16x16x32_bf16 v[20:23], a[152:155], v[176:179], v[20:23]
global_load_dword v255, v242, s[72:73]
v_mfma_f32_16x16x32_bf16 v[20:23], a[156:159], v[180:183], v[20:23]
v_exp_f32 v63, v63
v_mfma_f32_16x16x32_bf16 a[20:23], a[180:183], v[72:75], a[20:23]
v_cvt_pk_bf16_f32 v98, v60, v61
v_cvt_pk_bf16_f32 v99, v62, v63
v_mfma_f32_16x16x32_bf16 a[52:55], a[180:183], v[76:79], a[52:55]
v_exp_f32 v64, v64
v_mfma_f32_16x16x32_bf16 a[84:87], a[180:183], v[80:83], a[84:87]
v_mfma_f32_16x16x32_bf16 a[116:119], a[180:183], v[84:87], a[116:119]
v_exp_f32 v65, v65
v_smfmac_f32_16x16x64_bf16 a[252:255], a[208:211], v[80:87], v235
ds_read_b64_tr_b16 a[180:181], v225 offset:57344
ds_read_b64_tr_b16 a[182:183], v225 offset:61440
v_mfma_f32_16x16x32_bf16 v[28:31], a[144:147], v[184:187], v[144:147]
v_exp_f32 v66, v66
v_mfma_f32_16x16x32_bf16 v[28:31], a[148:151], v[188:191], v[28:31]
v_cvt_pk_bf16_f32 v100, v64, v65
v_mfma_f32_16x16x32_bf16 v[28:31], a[152:155], v[192:195], v[28:31]
v_exp_f32 v67, v67
v_mfma_f32_16x16x32_bf16 v[28:31], a[156:159], v[196:199], v[28:31]
buffer_load_dword v255, v0, s[24:27], s44 offen
v_mfma_f32_16x16x32_bf16 a[24:27], a[184:187], v[72:75], a[24:27]
v_exp_f32 v68, v68
v_mfma_f32_16x16x32_bf16 a[56:59], a[184:187], v[76:79], a[56:59]
v_cvt_pk_bf16_f32 v101, v66, v67
v_mfma_f32_16x16x32_bf16 a[88:91], a[184:187], v[80:83], a[88:91]
v_exp_f32 v69, v69
v_mfma_f32_16x16x32_bf16 a[120:123], a[184:187], v[84:87], a[120:123]
ds_read_b64_tr_b16 a[184:185], v226 offset:57344
ds_read_b64_tr_b16 a[186:187], v226 offset:61440
v_mfma_f32_16x16x32_bf16 v[36:39], a[144:147], v[200:203], v[148:151]
v_exp_f32 v70, v70
v_mfma_f32_16x16x32_bf16 v[36:39], a[148:151], v[204:207], v[36:39]
ds_read_b128 a[144:147], v216 offset:12288
ds_read_b128 a[148:151], v217 offset:12288
v_mfma_f32_16x16x32_bf16 v[36:39], a[152:155], v[208:211], v[36:39]
v_exp_f32 v71, v71
v_mfma_f32_16x16x32_bf16 v[36:39], a[156:159], v[212:215], v[36:39]
ds_read_b128 a[152:155], v218 offset:12288
ds_read_b128 a[156:159], v219 offset:12288
v_mfma_f32_16x16x32_bf16 a[28:31], a[188:191], v[72:75], a[28:31]
v_cvt_pk_bf16_f32 v102, v68, v69
v_cvt_pk_bf16_f32 v103, v70, v71
v_mfma_f32_16x16x32_bf16 a[60:63], a[188:191], v[76:79], a[60:63]
s_add_u32 s44, s44, 4096
v_mfma_f32_16x16x32_bf16 a[92:95], a[188:191], v[80:83], a[92:95]
v_mfma_f32_16x16x32_bf16 a[124:127], a[188:191], v[84:87], a[124:127]
s_waitcnt lgkmcnt(6)
ds_read_b64_tr_b16 a[188:189], v227 offset:57344
ds_read_b64_tr_b16 a[190:191], v227 offset:61440
v_mfma_f32_16x16x32_bf16 v[40:43], a[128:131], v[152:155], v[136:139]
v_exp_f32 v8, v8
v_mfma_f32_16x16x32_bf16 v[40:43], a[132:135], v[156:159], v[40:43]
v_exp_f32 v9, v9
v_mfma_f32_16x16x32_bf16 v[40:43], a[136:139], v[160:163], v[40:43]
v_cvt_pk_bf16_f32 v72, v8, v9
v_add_u32 v5, s49, v234
v_mfma_f32_16x16x32_bf16 v[40:43], a[140:143], v[164:167], v[40:43]
s_add_u32 s46, s3, 131072
v_exp_f32 v10, v10
v_mfma_f32_16x16x32_bf16 a[0:3], a[160:163], v[88:91], a[0:3]
v_add_u32 v6, s46, v234
v_lshlrev_b32 v7, 1, v4
v_mfma_f32_16x16x32_bf16 a[32:35], a[160:163], v[92:95], a[32:35]
v_exp_f32 v11, v11
s_waitcnt vmcnt(6) lgkmcnt(0)
s_barrier
v_mfma_f32_16x16x32_bf16 a[64:67], a[160:163], v[96:99], a[64:67]
v_cvt_pk_bf16_f32 v73, v10, v11
v_xor_b32 v7, v7, v3
v_mfma_f32_16x16x32_bf16 a[96:99], a[160:163], v[100:103], a[96:99]
s_add_u32 m0, s37, 98304
v_exp_f32 v12, v12
v_mfma_f32_16x16x32_bf16 v[48:51], a[128:131], v[168:171], v[140:143]
buffer_load_dwordx4 v232, s[12:15], s39 offen offset:0 lds
v_mfma_f32_16x16x32_bf16 v[48:51], a[132:135], v[172:175], v[48:51]
v_exp_f32 v13, v13
v_mfma_f32_16x16x32_bf16 v[48:51], a[136:139], v[176:179], v[48:51]
ds_read_b64_tr_b16 a[160:161], v220 offset:0
ds_read_b64_tr_b16 a[162:163], v220 offset:4096
v_mfma_f32_16x16x32_bf16 v[48:51], a[140:143], v[180:183], v[48:51]
v_exp_f32 v14, v14
v_mfma_f32_16x16x32_bf16 a[4:7], a[164:167], v[88:91], a[4:7]
v_cvt_pk_bf16_f32 v74, v12, v13
v_mul_u32_u24 v249, 0x480, v4
v_mfma_f32_16x16x32_bf16 a[36:39], a[164:167], v[92:95], a[36:39]
v_exp_f32 v15, v15
v_mfma_f32_16x16x32_bf16 a[68:71], a[164:167], v[96:99], a[68:71]
v_cvt_pk_bf16_f32 v75, v14, v15
v_lshl_add_u32 v249, v7, 4, v249
v_mfma_f32_16x16x32_bf16 a[100:103], a[164:167], v[100:103], a[100:103]
v_exp_f32 v16, v16
v_smfmac_f32_16x16x64_bf16 a[248:251], a[208:211], v[88:95], v235
buffer_load_dwordx4 v233, s[12:15], s39 offen offset:1024 lds
v_mfma_f32_16x16x32_bf16 v[56:59], a[128:131], v[184:187], v[144:147]
v_exp_f32 v17, v17
v_mfma_f32_16x16x32_bf16 v[56:59], a[132:135], v[188:191], v[56:59]
ds_read_b64_tr_b16 a[164:165], v221 offset:0
ds_read_b64_tr_b16 a[166:167], v221 offset:4096
v_mfma_f32_16x16x32_bf16 v[56:59], a[136:139], v[192:195], v[56:59]
v_exp_f32 v18, v18
v_mfma_f32_16x16x32_bf16 v[56:59], a[140:143], v[196:199], v[56:59]
v_cvt_pk_bf16_f32 v76, v16, v17
v_and_b32 v7, 8, v7
v_mfma_f32_16x16x32_bf16 a[8:11], a[168:171], v[88:91], a[8:11]
v_exp_f32 v19, v19
v_mfma_f32_16x16x32_bf16 a[40:43], a[168:171], v[92:95], a[40:43]
v_cvt_pk_bf16_f32 v77, v18, v19
v_lshlrev_b32 v7, 5, v7
v_mfma_f32_16x16x32_bf16 a[72:75], a[168:171], v[96:99], a[72:75]
v_exp_f32 v20, v20
v_mfma_f32_16x16x32_bf16 a[104:107], a[168:171], v[100:103], a[104:107]
ds_read_b64_tr_b16 a[168:169], v222 offset:0
ds_read_b64_tr_b16 a[170:171], v222 offset:4096
v_mfma_f32_16x16x32_bf16 v[64:67], a[128:131], v[200:203], v[148:151]
v_exp_f32 v21, v21
v_mfma_f32_16x16x32_bf16 v[64:67], a[132:135], v[204:207], v[64:67]
buffer_load_dwordx4 v232, s[12:15], s39 offen offset:2048 lds
v_mfma_f32_16x16x32_bf16 v[64:67], a[136:139], v[208:211], v[64:67]
v_exp_f32 v22, v22
v_mfma_f32_16x16x32_bf16 v[64:67], a[140:143], v[212:215], v[64:67]
ds_read_b128 a[128:131], v216 offset:49152
ds_read_b128 a[132:135], v217 offset:49152
v_mfma_f32_16x16x32_bf16 a[12:15], a[172:175], v[88:91], a[12:15]
v_exp_f32 v23, v23
v_mfma_f32_16x16x32_bf16 a[44:47], a[172:175], v[92:95], a[44:47]
ds_read_b128 a[136:139], v218 offset:49152
ds_read_b128 a[140:143], v219 offset:49152
v_mfma_f32_16x16x32_bf16 a[76:79], a[172:175], v[96:99], a[76:79]
v_exp_f32 v24, v24
v_mfma_f32_16x16x32_bf16 a[108:111], a[172:175], v[100:103], a[108:111]
v_exp_f32 v25, v25
v_mfma_f32_16x16x32_bf16 v[44:47], a[144:147], v[152:155], v[136:139]
ds_read_b64_tr_b16 a[172:173], v223 offset:0
ds_read_b64_tr_b16 a[174:175], v223 offset:4096
v_mfma_f32_16x16x32_bf16 v[44:47], a[148:151], v[156:159], v[44:47]
v_exp_f32 v26, v26
v_mfma_f32_16x16x32_bf16 v[44:47], a[152:155], v[160:163], v[44:47]
buffer_load_dwordx4 v233, s[12:15], s39 offen offset:3072 lds
v_mfma_f32_16x16x32_bf16 v[44:47], a[156:159], v[164:167], v[44:47]
v_exp_f32 v27, v27
v_mfma_f32_16x16x32_bf16 a[16:19], a[176:179], v[88:91], a[16:19]
v_cvt_pk_bf16_f32 v78, v20, v21
v_cvt_pk_bf16_f32 v79, v22, v23
v_mfma_f32_16x16x32_bf16 a[48:51], a[176:179], v[92:95], a[48:51]
v_exp_f32 v28, v28
v_mfma_f32_16x16x32_bf16 a[80:83], a[176:179], v[96:99], a[80:83]
v_cvt_pk_bf16_f32 v80, v24, v25
v_cvt_pk_bf16_f32 v81, v26, v27
v_mfma_f32_16x16x32_bf16 a[112:115], a[176:179], v[100:103], a[112:115]
v_exp_f32 v29, v29
v_mfma_f32_16x16x32_bf16 v[52:55], a[144:147], v[168:171], v[140:143]
ds_read_b64_tr_b16 a[176:177], v224 offset:0
ds_read_b64_tr_b16 a[178:179], v224 offset:4096
v_mfma_f32_16x16x32_bf16 v[52:55], a[148:151], v[172:175], v[52:55]
v_exp_f32 v30, v30
v_mfma_f32_16x16x32_bf16 v[52:55], a[152:155], v[176:179], v[52:55]
v_cvt_pk_bf16_f32 v82, v28, v29
v_sub_u32 v250, v249, v7
v_mfma_f32_16x16x32_bf16 v[52:55], a[156:159], v[180:183], v[52:55]
s_add_u32 s39, s39, 16384
v_exp_f32 v31, v31
v_mfma_f32_16x16x32_bf16 a[20:23], a[180:183], v[88:91], a[20:23]
s_add_u32 m0, s37, 16384
v_cvt_pk_bf16_f32 v83, v30, v31
v_add_u32 v250, 128, v250
v_mfma_f32_16x16x32_bf16 a[52:55], a[180:183], v[92:95], a[52:55]
v_exp_f32 v32, v32
v_mfma_f32_16x16x32_bf16 a[84:87], a[180:183], v[96:99], a[84:87]
buffer_load_dwordx4 v228, s[8:11], s38 offen offset:0 lds
v_mfma_f32_16x16x32_bf16 a[116:119], a[180:183], v[100:103], a[116:119]
v_exp_f32 v33, v33
v_smfmac_f32_16x16x64_bf16 a[252:255], a[208:211], v[96:103], v235
ds_read_b64_tr_b16 a[180:181], v225 offset:0
ds_read_b64_tr_b16 a[182:183], v225 offset:4096
v_mfma_f32_16x16x32_bf16 v[60:63], a[144:147], v[184:187], v[144:147]
v_exp_f32 v34, v34
v_mfma_f32_16x16x32_bf16 v[60:63], a[148:151], v[188:191], v[60:63]
v_cvt_pk_bf16_f32 v84, v32, v33
v_mfma_f32_16x16x32_bf16 v[60:63], a[152:155], v[192:195], v[60:63]
v_exp_f32 v35, v35
v_mfma_f32_16x16x32_bf16 v[60:63], a[156:159], v[196:199], v[60:63]
buffer_load_dwordx4 v229, s[8:11], s38 offen offset:1024 lds
v_mfma_f32_16x16x32_bf16 a[24:27], a[184:187], v[88:91], a[24:27]
v_exp_f32 v36, v36
v_mfma_f32_16x16x32_bf16 a[56:59], a[184:187], v[92:95], a[56:59]
v_cvt_pk_bf16_f32 v85, v34, v35
v_mfma_f32_16x16x32_bf16 a[88:91], a[184:187], v[96:99], a[88:91]
v_exp_f32 v37, v37
v_mfma_f32_16x16x32_bf16 a[120:123], a[184:187], v[100:103], a[120:123]
ds_read_b64_tr_b16 a[184:185], v226 offset:0
ds_read_b64_tr_b16 a[186:187], v226 offset:4096
v_mfma_f32_16x16x32_bf16 v[68:71], a[144:147], v[200:203], v[148:151]
v_exp_f32 v38, v38
v_mfma_f32_16x16x32_bf16 v[68:71], a[148:151], v[204:207], v[68:71]
ds_read_b128 a[144:147], v216 offset:53248
ds_read_b128 a[148:151], v217 offset:53248
v_mfma_f32_16x16x32_bf16 v[68:71], a[152:155], v[208:211], v[68:71]
v_exp_f32 v39, v39
v_mfma_f32_16x16x32_bf16 v[68:71], a[156:159], v[212:215], v[68:71]
ds_read_b128 a[152:155], v218 offset:53248
ds_read_b128 a[156:159], v219 offset:53248
v_mfma_f32_16x16x32_bf16 a[28:31], a[188:191], v[88:91], a[28:31]
v_cvt_pk_bf16_f32 v86, v36, v37
v_cvt_pk_bf16_f32 v87, v38, v39
v_mfma_f32_16x16x32_bf16 a[60:63], a[188:191], v[92:95], a[60:63]
v_mfma_f32_16x16x32_bf16 a[92:95], a[188:191], v[96:99], a[92:95]
v_mfma_f32_16x16x32_bf16 a[124:127], a[188:191], v[100:103], a[124:127]
s_waitcnt lgkmcnt(6)
ds_read_b64_tr_b16 a[188:189], v227 offset:0
ds_read_b64_tr_b16 a[190:191], v227 offset:4096
v_mfma_f32_16x16x32_bf16 v[8:11], a[128:131], v[152:155], v[136:139]
s_waitcnt vmcnt(10)
s_nop 0
v_exp_f32 v40, v40
v_mfma_f32_16x16x32_bf16 v[8:11], a[132:135], v[156:159], v[8:11]
v_exp_f32 v41, v41
v_mfma_f32_16x16x32_bf16 v[8:11], a[136:139], v[160:163], v[8:11]
buffer_load_dwordx4 v230, s[8:11], s38 offen offset:2048 lds
v_mfma_f32_16x16x32_bf16 v[8:11], a[140:143], v[164:167], v[8:11]
v_exp_f32 v42, v42
v_mfma_f32_16x16x32_bf16 a[0:3], a[160:163], v[72:75], a[0:3]
ds_read_b64_tr_b16 a[192:193], v248 offset:0
v_cvt_pk_bf16_f32 v88, v40, v41
v_mfma_f32_16x16x32_bf16 a[32:35], a[160:163], v[76:79], a[32:35]
v_exp_f32 v43, v43
v_mfma_f32_16x16x32_bf16 a[64:67], a[160:163], v[80:83], a[64:67]
ds_read_b64_tr_b16 a[194:195], v248 offset:256
v_cvt_pk_bf16_f32 v89, v42, v43
v_mfma_f32_16x16x32_bf16 a[96:99], a[160:163], v[84:87], a[96:99]
v_exp_f32 v44, v44
v_mfma_f32_16x16x32_bf16 v[16:19], a[128:131], v[168:171], v[140:143]
ds_read_b64_tr_b16 a[160:161], v220 offset:8192
ds_read_b64_tr_b16 a[162:163], v220 offset:12288
v_mfma_f32_16x16x32_bf16 v[16:19], a[132:135], v[172:175], v[16:19]
v_exp_f32 v45, v45
v_mfma_f32_16x16x32_bf16 v[16:19], a[136:139], v[176:179], v[16:19]
ds_read_b64_tr_b16 a[196:197], v248 offset:32
v_cvt_pk_bf16_f32 v90, v44, v45
v_mfma_f32_16x16x32_bf16 v[16:19], a[140:143], v[180:183], v[16:19]
v_exp_f32 v46, v46
v_mfma_f32_16x16x32_bf16 a[4:7], a[164:167], v[72:75], a[4:7]
ds_read_b64_tr_b16 a[198:199], v248 offset:288
ds_read_b64_tr_b16 a[200:201], v248 offset:4096
v_mfma_f32_16x16x32_bf16 a[36:39], a[164:167], v[76:79], a[36:39]
v_exp_f32 v47, v47
v_mfma_f32_16x16x32_bf16 a[68:71], a[164:167], v[80:83], a[68:71]
buffer_load_dwordx4 v231, s[8:11], s38 offen offset:3072 lds
v_mfma_f32_16x16x32_bf16 a[100:103], a[164:167], v[84:87], a[100:103]
v_exp_f32 v48, v48
v_smfmac_f32_16x16x64_bf16 a[248:251], a[208:211], v[72:79], v235
ds_read_b64_tr_b16 a[164:165], v221 offset:8192
ds_read_b64_tr_b16 a[166:167], v221 offset:12288
v_mfma_f32_16x16x32_bf16 v[24:27], a[128:131], v[184:187], v[144:147]
v_exp_f32 v49, v49
v_mfma_f32_16x16x32_bf16 v[24:27], a[132:135], v[188:191], v[24:27]
v_cvt_pk_bf16_f32 v91, v46, v47
v_cvt_pk_bf16_f32 v92, v48, v49
v_mfma_f32_16x16x32_bf16 v[24:27], a[136:139], v[192:195], v[24:27]
v_exp_f32 v50, v50
v_mfma_f32_16x16x32_bf16 v[24:27], a[140:143], v[196:199], v[24:27]
ds_read_b64_tr_b16 a[202:203], v248 offset:4352
ds_read_b64_tr_b16 a[204:205], v248 offset:4128
v_mfma_f32_16x16x32_bf16 a[8:11], a[168:171], v[72:75], a[8:11]
v_exp_f32 v51, v51
v_mfma_f32_16x16x32_bf16 a[40:43], a[168:171], v[76:79], a[40:43]
ds_read_b64_tr_b16 a[206:207], v248 offset:4384
v_cvt_pk_bf16_f32 v93, v50, v51
v_mfma_f32_16x16x32_bf16 a[72:75], a[168:171], v[80:83], a[72:75]
v_exp_f32 v52, v52
v_mfma_f32_16x16x32_bf16 a[104:107], a[168:171], v[84:87], a[104:107]
ds_read_b64_tr_b16 a[168:169], v222 offset:8192
ds_read_b64_tr_b16 a[170:171], v222 offset:12288
v_mfma_f32_16x16x32_bf16 v[32:35], a[128:131], v[200:203], v[148:151]
s_add_u32 s38, s38, 16384
v_exp_f32 v53, v53
v_mfma_f32_16x16x32_bf16 v[32:35], a[132:135], v[204:207], v[32:35]
s_add_u32 m0, s37, 114688
ds_read_b128 a[128:131], v216 offset:57344
ds_read_b128 a[132:135], v217 offset:57344
v_mfma_f32_16x16x32_bf16 v[32:35], a[136:139], v[208:211], v[32:35]
v_exp_f32 v54, v54
v_mfma_f32_16x16x32_bf16 v[32:35], a[140:143], v[212:215], v[32:35]
buffer_load_dwordx4 v232, s[12:15], s39 offen offset:0 lds
v_mfma_f32_16x16x32_bf16 a[12:15], a[172:175], v[72:75], a[12:15]
v_exp_f32 v55, v55
v_mfma_f32_16x16x32_bf16 a[44:47], a[172:175], v[76:79], a[44:47]
ds_read_b128 a[136:139], v218 offset:57344
ds_read_b128 a[140:143], v219 offset:57344
v_mfma_f32_16x16x32_bf16 a[76:79], a[172:175], v[80:83], a[76:79]
v_exp_f32 v56, v56
v_mfma_f32_16x16x32_bf16 a[108:111], a[172:175], v[84:87], a[108:111]
s_waitcnt lgkmcnt(6)
v_exp_f32 v57, v57
v_mfma_f32_16x16x32_bf16 v[12:15], a[144:147], v[152:155], v[136:139]
ds_read_b64_tr_b16 a[172:173], v223 offset:8192
ds_read_b64_tr_b16 a[174:175], v223 offset:12288
v_mfma_f32_16x16x32_bf16 v[12:15], a[148:151], v[156:159], v[12:15]
v_exp_f32 v58, v58
v_mfma_f32_16x16x32_bf16 v[12:15], a[152:155], v[160:163], v[12:15]
v_cvt_pk_bf16_f32 v94, v52, v53
v_cvt_pk_bf16_f32 v95, v54, v55
v_mfma_f32_16x16x32_bf16 v[12:15], a[156:159], v[164:167], v[12:15]
v_exp_f32 v59, v59
v_mfma_f32_16x16x32_bf16 a[16:19], a[176:179], v[72:75], a[16:19]
v_cvt_pk_bf16_f32 v96, v56, v57
v_cvt_pk_bf16_f32 v97, v58, v59
v_mfma_f32_16x16x32_bf16 a[48:51], a[176:179], v[76:79], a[48:51]
v_exp_f32 v60, v60
v_mfma_f32_16x16x32_bf16 a[80:83], a[176:179], v[80:83], a[80:83]
buffer_load_dwordx4 v233, s[12:15], s39 offen offset:1024 lds
v_mfma_f32_16x16x32_bf16 a[112:115], a[176:179], v[84:87], a[112:115]
v_exp_f32 v61, v61
v_mfma_f32_16x16x32_bf16 v[20:23], a[144:147], v[168:171], v[140:143]
ds_read_b64_tr_b16 a[176:177], v224 offset:8192
ds_read_b64_tr_b16 a[178:179], v224 offset:12288
v_mfma_f32_16x16x32_bf16 v[20:23], a[148:151], v[172:175], v[20:23]
v_exp_f32 v62, v62
v_mfma_f32_16x16x32_bf16 v[20:23], a[152:155], v[176:179], v[20:23]
ds_read_b64_tr_b16 v[120:121], v248 offset:2048
v_cvt_pk_bf16_f32 v98, v60, v61
v_mfma_f32_16x16x32_bf16 v[20:23], a[156:159], v[180:183], v[20:23]
v_exp_f32 v63, v63
v_mfma_f32_16x16x32_bf16 a[20:23], a[180:183], v[72:75], a[20:23]
ds_read_b64_tr_b16 v[122:123], v248 offset:2304
v_cvt_pk_bf16_f32 v99, v62, v63
v_mfma_f32_16x16x32_bf16 a[52:55], a[180:183], v[76:79], a[52:55]
v_exp_f32 v64, v64
v_mfma_f32_16x16x32_bf16 a[84:87], a[180:183], v[80:83], a[84:87]
ds_read_b64_tr_b16 v[124:125], v248 offset:2080
ds_read_b64_tr_b16 v[126:127], v248 offset:2336
v_mfma_f32_16x16x32_bf16 a[116:119], a[180:183], v[84:87], a[116:119]
v_exp_f32 v65, v65
v_smfmac_f32_16x16x64_bf16 a[252:255], a[208:211], v[80:87], v235
ds_read_b64_tr_b16 a[180:181], v225 offset:8192
ds_read_b64_tr_b16 a[182:183], v225 offset:12288
v_mfma_f32_16x16x32_bf16 v[28:31], a[144:147], v[184:187], v[144:147]
v_exp_f32 v66, v66
v_mfma_f32_16x16x32_bf16 v[28:31], a[148:151], v[188:191], v[28:31]
buffer_load_dwordx4 v232, s[12:15], s39 offen offset:2048 lds
v_mfma_f32_16x16x32_bf16 v[28:31], a[152:155], v[192:195], v[28:31]
v_exp_f32 v67, v67
v_mfma_f32_16x16x32_bf16 v[28:31], a[156:159], v[196:199], v[28:31]
v_cvt_pk_bf16_f32 v100, v64, v65
v_cvt_pk_bf16_f32 v101, v66, v67
v_mfma_f32_16x16x32_bf16 a[24:27], a[184:187], v[72:75], a[24:27]
v_exp_f32 v68, v68
v_mfma_f32_16x16x32_bf16 a[56:59], a[184:187], v[76:79], a[56:59]
ds_read_b64_tr_b16 v[128:129], v248 offset:6144
ds_read_b64_tr_b16 v[130:131], v248 offset:6400
v_mfma_f32_16x16x32_bf16 a[88:91], a[184:187], v[80:83], a[88:91]
v_exp_f32 v69, v69
v_mfma_f32_16x16x32_bf16 a[120:123], a[184:187], v[84:87], a[120:123]
ds_read_b64_tr_b16 a[184:185], v226 offset:8192
ds_read_b64_tr_b16 a[186:187], v226 offset:12288
v_mfma_f32_16x16x32_bf16 v[36:39], a[144:147], v[200:203], v[148:151]
v_exp_f32 v70, v70
v_mfma_f32_16x16x32_bf16 v[36:39], a[148:151], v[204:207], v[36:39]
ds_read_b128 a[144:147], v216 offset:61440
ds_read_b128 a[148:151], v217 offset:61440
v_mfma_f32_16x16x32_bf16 v[36:39], a[152:155], v[208:211], v[36:39]
v_exp_f32 v71, v71
v_mfma_f32_16x16x32_bf16 v[36:39], a[156:159], v[212:215], v[36:39]
ds_read_b128 a[152:155], v218 offset:61440
ds_read_b128 a[156:159], v219 offset:61440
v_mfma_f32_16x16x32_bf16 a[28:31], a[188:191], v[72:75], a[28:31]
v_cvt_pk_bf16_f32 v102, v68, v69
v_cvt_pk_bf16_f32 v103, v70, v71
v_mfma_f32_16x16x32_bf16 a[60:63], a[188:191], v[76:79], a[60:63]
ds_read_b64_tr_b16 v[132:133], v248 offset:6176
ds_read_b64_tr_b16 v[134:135], v248 offset:6432
v_mfma_f32_16x16x32_bf16 a[92:95], a[188:191], v[80:83], a[92:95]
v_mfma_f32_16x16x32_bf16 a[124:127], a[188:191], v[84:87], a[124:127]
s_waitcnt lgkmcnt(8)
ds_read_b64_tr_b16 a[188:189], v227 offset:8192
ds_read_b64_tr_b16 a[190:191], v227 offset:12288
v_mfma_f32_16x16x32_bf16 v[40:43], a[128:131], v[152:155], v[136:139]
v_exp_f32 v8, v8
v_mfma_f32_16x16x32_bf16 v[40:43], a[132:135], v[156:159], v[40:43]
buffer_load_dwordx4 v233, s[12:15], s39 offen offset:3072 lds
v_mfma_f32_16x16x32_bf16 v[40:43], a[136:139], v[160:163], v[40:43]
v_exp_f32 v9, v9
v_mfma_f32_16x16x32_bf16 v[40:43], a[140:143], v[164:167], v[40:43]
v_cvt_pk_bf16_f32 v72, v8, v9
v_mfma_f32_16x16x32_bf16 a[0:3], a[160:163], v[88:91], a[0:3]
v_exp_f32 v10, v10
v_mfma_f32_16x16x32_bf16 a[32:35], a[160:163], v[92:95], a[32:35]
v_mfma_f32_16x16x32_bf16 a[64:67], a[160:163], v[96:99], a[64:67]
v_exp_f32 v11, v11
v_mfma_f32_16x16x32_bf16 a[96:99], a[160:163], v[100:103], a[96:99]
ds_read_b64_tr_b16 a[160:161], v220 offset:16384
ds_read_b64_tr_b16 a[162:163], v220 offset:20480
v_mfma_f32_16x16x32_bf16 v[104:107], a[192:195], a[212:215], v[104:107]
s_add_u32 m0, s49, 0
v_exp_f32 v12, v12
v_mfma_f32_16x16x32_bf16 v[48:51], a[128:131], v[168:171], v[140:143]
s_add_u32 s48, s50, 589824
s_waitcnt lgkmcnt(4)
buffer_load_dwordx4 v238, s[56:59], s48 offen  lds
v_mfma_f32_16x16x32_bf16 v[48:51], a[132:135], v[172:175], v[48:51]
v_exp_f32 v13, v13
v_mfma_f32_16x16x32_bf16 v[48:51], a[136:139], v[176:179], v[48:51]
v_cvt_pk_bf16_f32 v73, v10, v11
v_cvt_pk_bf16_f32 v74, v12, v13
v_mfma_f32_16x16x32_bf16 v[48:51], a[140:143], v[180:183], v[48:51]
v_mfma_f32_16x16x32_bf16 a[4:7], a[164:167], v[88:91], a[4:7]
v_exp_f32 v14, v14
v_mfma_f32_16x16x32_bf16 a[36:39], a[164:167], v[92:95], a[36:39]
v_mfma_f32_16x16x32_bf16 a[68:71], a[164:167], v[96:99], a[68:71]
v_exp_f32 v15, v15
v_mfma_f32_16x16x32_bf16 a[100:103], a[164:167], v[100:103], a[100:103]
s_add_u32 s39, s39, 16384
ds_read_b64_tr_b16 a[164:165], v221 offset:16384
ds_read_b64_tr_b16 a[166:167], v221 offset:20480
v_smfmac_f32_16x16x64_bf16 a[248:251], a[208:211], v[88:95], v235
s_add_u32 m0, s37, 0
v_exp_f32 v16, v16
v_mfma_f32_16x16x32_bf16 v[108:111], a[196:199], a[212:215], v[108:111]
buffer_load_dwordx4 v228, s[8:11], s38 offen offset:0 lds
v_mfma_f32_16x16x32_bf16 v[56:59], a[128:131], v[184:187], v[144:147]
v_exp_f32 v17, v17
v_mfma_f32_16x16x32_bf16 v[56:59], a[132:135], v[188:191], v[56:59]
v_cvt_pk_bf16_f32 v75, v14, v15
v_cvt_pk_bf16_f32 v76, v16, v17
v_mfma_f32_16x16x32_bf16 v[56:59], a[136:139], v[192:195], v[56:59]
v_exp_f32 v18, v18
v_mfma_f32_16x16x32_bf16 v[56:59], a[140:143], v[196:199], v[56:59]
v_mfma_f32_16x16x32_bf16 a[8:11], a[168:171], v[88:91], a[8:11]
v_mfma_f32_16x16x32_bf16 a[40:43], a[168:171], v[92:95], a[40:43]
s_add_u32 m0, s49, 1024
v_exp_f32 v19, v19
v_mfma_f32_16x16x32_bf16 a[72:75], a[168:171], v[96:99], a[72:75]
s_add_u32 s48, s50, 737280
buffer_load_dwordx4 v238, s[56:59], s48 offen  lds
v_mfma_f32_16x16x32_bf16 a[104:107], a[168:171], v[100:103], a[104:107]
v_exp_f32 v20, v20
v_mfma_f32_16x16x32_bf16 v[112:115], a[200:203], a[212:215], v[112:115]
ds_read_b64_tr_b16 a[168:169], v222 offset:16384
ds_read_b64_tr_b16 a[170:171], v222 offset:20480
v_mfma_f32_16x16x32_bf16 v[64:67], a[128:131], v[200:203], v[148:151]
v_exp_f32 v21, v21
v_mfma_f32_16x16x32_bf16 v[64:67], a[132:135], v[204:207], v[64:67]
ds_read_b128 a[128:131], v216 offset:32768
ds_read_b128 a[132:135], v217 offset:32768
v_mfma_f32_16x16x32_bf16 v[64:67], a[136:139], v[208:211], v[64:67]
v_exp_f32 v22, v22
v_mfma_f32_16x16x32_bf16 v[64:67], a[140:143], v[212:215], v[64:67]
ds_read_b128 a[136:139], v218 offset:32768
ds_read_b128 a[140:143], v219 offset:32768
v_mfma_f32_16x16x32_bf16 a[12:15], a[172:175], v[88:91], a[12:15]
s_add_u32 m0, s37, 0
v_exp_f32 v23, v23
v_mfma_f32_16x16x32_bf16 a[44:47], a[172:175], v[92:95], a[44:47]
buffer_load_dwordx4 v229, s[8:11], s38 offen offset:1024 lds
v_mfma_f32_16x16x32_bf16 a[76:79], a[172:175], v[96:99], a[76:79]
v_cvt_pk_bf16_f32 v77, v18, v19
v_cvt_pk_bf16_f32 v78, v20, v21
v_mfma_f32_16x16x32_bf16 a[108:111], a[172:175], v[100:103], a[108:111]
v_exp_f32 v24, v24
v_mfma_f32_16x16x32_bf16 v[116:119], a[204:207], a[212:215], v[116:119]
ds_read_b64_tr_b16 a[172:173], v223 offset:16384
ds_read_b64_tr_b16 a[174:175], v223 offset:20480
v_mfma_f32_16x16x32_bf16 v[44:47], a[144:147], v[152:155], v[136:139]
v_exp_f32 v25, v25
v_mfma_f32_16x16x32_bf16 v[44:47], a[148:151], v[156:159], v[44:47]
v_cvt_pk_bf16_f32 v79, v22, v23
v_cvt_pk_bf16_f32 v80, v24, v25
v_mfma_f32_16x16x32_bf16 v[44:47], a[152:155], v[160:163], v[44:47]
s_add_u32 m0, s49, 2048
v_exp_f32 v26, v26
v_mfma_f32_16x16x32_bf16 v[44:47], a[156:159], v[164:167], v[44:47]
s_add_u32 s48, s50, 884736
buffer_load_dwordx4 v238, s[56:59], s48 offen  lds
v_mfma_f32_16x16x32_bf16 a[16:19], a[176:179], v[88:91], a[16:19]
v_exp_f32 v27, v27
v_mfma_f32_16x16x32_bf16 a[48:51], a[176:179], v[92:95], a[48:51]
v_cvt_pk_bf16_f32 v81, v26, v27
v_mfma_f32_16x16x32_bf16 a[80:83], a[176:179], v[96:99], a[80:83]
v_exp_f32 v28, v28
v_mfma_f32_16x16x32_bf16 a[112:115], a[176:179], v[100:103], a[112:115]
ds_read_b64_tr_b16 a[176:177], v224 offset:16384
ds_read_b64_tr_b16 a[178:179], v224 offset:20480
v_mfma_f32_16x16x32_bf16 v[104:107], v[120:123], a[216:219], v[104:107]
v_exp_f32 v29, v29
v_mfma_f32_16x16x32_bf16 v[52:55], a[144:147], v[168:171], v[140:143]
v_cvt_pk_bf16_f32 v82, v28, v29
v_mfma_f32_16x16x32_bf16 v[52:55], a[148:151], v[172:175], v[52:55]
s_add_u32 m0, s37, 0
v_mfma_f32_16x16x32_bf16 v[52:55], a[152:155], v[176:179], v[52:55]
v_exp_f32 v30, v30
v_mfma_f32_16x16x32_bf16 v[52:55], a[156:159], v[180:183], v[52:55]
buffer_load_dwordx4 v230, s[8:11], s38 offen offset:2048 lds
v_mfma_f32_16x16x32_bf16 a[20:23], a[180:183], v[88:91], a[20:23]
v_exp_f32 v31, v31
v_mfma_f32_16x16x32_bf16 a[52:55], a[180:183], v[92:95], a[52:55]
v_cvt_pk_bf16_f32 v83, v30, v31
v_mfma_f32_16x16x32_bf16 a[84:87], a[180:183], v[96:99], a[84:87]
v_exp_f32 v32, v32
v_mfma_f32_16x16x32_bf16 a[116:119], a[180:183], v[100:103], a[116:119]
ds_read_b64_tr_b16 a[180:181], v225 offset:16384
ds_read_b64_tr_b16 a[182:183], v225 offset:20480
v_smfmac_f32_16x16x64_bf16 a[252:255], a[208:211], v[96:103], v235
v_exp_f32 v33, v33
v_mfma_f32_16x16x32_bf16 v[108:111], v[124:127], a[216:219], v[108:111]
s_add_u32 m0, s49, 3072
v_cvt_pk_bf16_f32 v84, v32, v33
v_mfma_f32_16x16x32_bf16 v[60:63], a[144:147], v[184:187], v[144:147]
s_add_u32 s48, s50, 1032192
v_exp_f32 v34, v34
v_mfma_f32_16x16x32_bf16 v[60:63], a[148:151], v[188:191], v[60:63]
buffer_load_dwordx4 v238, s[56:59], s48 offen  lds
v_mfma_f32_16x16x32_bf16 v[60:63], a[152:155], v[192:195], v[60:63]
v_mfma_f32_16x16x32_bf16 v[60:63], a[156:159], v[196:199], v[60:63]
v_exp_f32 v35, v35
v_mfma_f32_16x16x32_bf16 a[24:27], a[184:187], v[88:91], a[24:27]
v_cvt_pk_bf16_f32 v85, v34, v35
v_mfma_f32_16x16x32_bf16 a[56:59], a[184:187], v[92:95], a[56:59]
v_exp_f32 v36, v36
v_mfma_f32_16x16x32_bf16 a[88:91], a[184:187], v[96:99], a[88:91]
v_mfma_f32_16x16x32_bf16 a[120:123], a[184:187], v[100:103], a[120:123]
s_add_u32 m0, s37, 0
v_exp_f32 v37, v37
v_mfma_f32_16x16x32_bf16 v[112:115], v[128:131], a[216:219], v[112:115]
buffer_load_dwordx4 v231, s[8:11], s38 offen offset:3072 lds
v_mfma_f32_16x16x32_bf16 v[68:71], a[144:147], v[200:203], v[148:151]
v_exp_f32 v38, v38
v_mfma_f32_16x16x32_bf16 v[68:71], a[148:151], v[204:207], v[68:71]
ds_read_b64_tr_b16 a[184:185], v226 offset:16384
ds_read_b64_tr_b16 a[186:187], v226 offset:20480
v_mfma_f32_16x16x32_bf16 v[68:71], a[152:155], v[208:211], v[68:71]
v_exp_f32 v39, v39
v_mfma_f32_16x16x32_bf16 v[68:71], a[156:159], v[212:215], v[68:71]
s_waitcnt lgkmcnt(2)
ds_read_b128 a[144:147], v216 offset:36864
ds_read_b128 a[148:151], v217 offset:36864
v_mfma_f32_16x16x32_bf16 a[28:31], a[188:191], v[88:91], a[28:31]
ds_read_b128 a[152:155], v218 offset:36864
ds_read_b128 a[156:159], v219 offset:36864
v_mfma_f32_16x16x32_bf16 a[60:63], a[188:191], v[92:95], a[60:63]
v_cvt_pk_bf16_f32 v86, v36, v37
v_cvt_pk_bf16_f32 v87, v38, v39
v_mfma_f32_16x16x32_bf16 a[92:95], a[188:191], v[96:99], a[92:95]
s_add_u32 s38, s38, 16384
v_mfma_f32_16x16x32_bf16 a[124:127], a[188:191], v[100:103], a[124:127]
ds_read_b64_tr_b16 a[188:189], v227 offset:16384
ds_read_b64_tr_b16 a[190:191], v227 offset:20480
v_mfma_f32_16x16x32_bf16 v[116:119], v[132:135], a[216:219], v[116:119]
v_mfma_f32_16x16x32_bf16 v[8:11], a[128:131], v[152:155], v[136:139]
v_exp_f32 v40, v40
v_mfma_f32_16x16x32_bf16 v[8:11], a[132:135], v[156:159], v[8:11]
s_add_u32 m0, s49, 4096
v_exp_f32 v41, v41
v_mfma_f32_16x16x32_bf16 v[8:11], a[136:139], v[160:163], v[8:11]
s_add_u32 s48, s50, 589824
buffer_load_dwordx4 v238, s[60:63], s48 offen  lds
v_mfma_f32_16x16x32_bf16 v[8:11], a[140:143], v[164:167], v[8:11]
v_exp_f32 v42, v42
v_mfma_f32_16x16x32_bf16 a[0:3], a[160:163], v[72:75], a[0:3]
v_cvt_pk_bf16_f32 v88, v40, v41
v_mfma_f32_16x16x32_bf16 a[32:35], a[160:163], v[76:79], a[32:35]
v_exp_f32 v43, v43
v_mfma_f32_16x16x32_bf16 a[64:67], a[160:163], v[80:83], a[64:67]
v_cvt_pk_bf16_f32 v89, v42, v43
v_mfma_f32_16x16x32_bf16 a[96:99], a[160:163], v[84:87], a[96:99]
v_exp_f32 v44, v44
v_mfma_f32_16x16x32_bf16 v[16:19], a[128:131], v[168:171], v[140:143]
s_add_u32 m0, s49, 5120
ds_read_b64_tr_b16 a[160:161], v220 offset:24576
ds_read_b64_tr_b16 a[162:163], v220 offset:28672
v_mfma_f32_16x16x32_bf16 v[16:19], a[132:135], v[172:175], v[16:19]
s_add_u32 s48, s50, 737280
v_exp_f32 v45, v45
v_mfma_f32_16x16x32_bf16 v[16:19], a[136:139], v[176:179], v[16:19]
buffer_load_dwordx4 v238, s[60:63], s48 offen  lds
v_mfma_f32_16x16x32_bf16 v[16:19], a[140:143], v[180:183], v[16:19]
v_exp_f32 v46, v46
v_mfma_f32_16x16x32_bf16 a[4:7], a[164:167], v[72:75], a[4:7]
v_cvt_pk_bf16_f32 v90, v44, v45
v_mfma_f32_16x16x32_bf16 a[36:39], a[164:167], v[76:79], a[36:39]
v_exp_f32 v47, v47
v_mfma_f32_16x16x32_bf16 a[68:71], a[164:167], v[80:83], a[68:71]
v_cvt_pk_bf16_f32 v91, v46, v47
v_mfma_f32_16x16x32_bf16 a[100:103], a[164:167], v[84:87], a[100:103]
v_exp_f32 v48, v48
v_smfmac_f32_16x16x64_bf16 a[248:251], a[208:211], v[72:79], v235
s_add_u32 m0, s49, 6144
ds_read_b64_tr_b16 a[164:165], v221 offset:24576
ds_read_b64_tr_b16 a[166:167], v221 offset:28672
v_mfma_f32_16x16x32_bf16 v[24:27], a[128:131], v[184:187], v[144:147]
s_add_u32 s48, s50, 884736
v_exp_f32 v49, v49
v_mfma_f32_16x16x32_bf16 v[24:27], a[132:135], v[188:191], v[24:27]
buffer_load_dwordx4 v238, s[60:63], s48 offen  lds
v_mfma_f32_16x16x32_bf16 v[24:27], a[136:139], v[192:195], v[24:27]
v_exp_f32 v50, v50
v_mfma_f32_16x16x32_bf16 v[24:27], a[140:143], v[196:199], v[24:27]
v_cvt_pk_bf16_f32 v92, v48, v49
v_mfma_f32_16x16x32_bf16 a[8:11], a[168:171], v[72:75], a[8:11]
v_exp_f32 v51, v51
v_mfma_f32_16x16x32_bf16 a[40:43], a[168:171], v[76:79], a[40:43]
v_cvt_pk_bf16_f32 v93, v50, v51
v_mfma_f32_16x16x32_bf16 a[72:75], a[168:171], v[80:83], a[72:75]
v_exp_f32 v52, v52
v_mfma_f32_16x16x32_bf16 a[104:107], a[168:171], v[84:87], a[104:107]
s_add_u32 m0, s49, 7168
ds_read_b64_tr_b16 a[168:169], v222 offset:24576
ds_read_b64_tr_b16 a[170:171], v222 offset:28672
v_mfma_f32_16x16x32_bf16 v[32:35], a[128:131], v[200:203], v[148:151]
s_add_u32 s48, s50, 1032192
v_exp_f32 v53, v53
v_mfma_f32_16x16x32_bf16 v[32:35], a[132:135], v[204:207], v[32:35]
buffer_load_dwordx4 v238, s[60:63], s48 offen  lds
v_mfma_f32_16x16x32_bf16 v[32:35], a[136:139], v[208:211], v[32:35]
v_exp_f32 v54, v54
v_mfma_f32_16x16x32_bf16 v[32:35], a[140:143], v[212:215], v[32:35]
ds_read_b128 a[128:131], v216 offset:40960
ds_read_b128 a[132:135], v217 offset:40960
v_mfma_f32_16x16x32_bf16 a[12:15], a[172:175], v[72:75], a[12:15]
v_exp_f32 v55, v55
v_mfma_f32_16x16x32_bf16 a[44:47], a[172:175], v[76:79], a[44:47]
ds_read_b128 a[136:139], v218 offset:40960
ds_read_b128 a[140:143], v219 offset:40960
v_mfma_f32_16x16x32_bf16 a[76:79], a[172:175], v[80:83], a[76:79]
v_exp_f32 v56, v56
v_mfma_f32_16x16x32_bf16 a[108:111], a[172:175], v[84:87], a[108:111]
s_waitcnt lgkmcnt(6)
v_exp_f32 v57, v57
v_mfma_f32_16x16x32_bf16 v[12:15], a[144:147], v[152:155], v[136:139]
buffer_load_dwordx2 v[252:253], v251, s[76:79], s42 offen sc1
v_mfma_f32_16x16x32_bf16 v[12:15], a[148:151], v[156:159], v[12:15]
v_exp_f32 v58, v58
v_mfma_f32_16x16x32_bf16 v[12:15], a[152:155], v[160:163], v[12:15]
ds_read_b64_tr_b16 a[172:173], v223 offset:24576
ds_read_b64_tr_b16 a[174:175], v223 offset:28672
v_mfma_f32_16x16x32_bf16 v[12:15], a[156:159], v[164:167], v[12:15]
v_exp_f32 v59, v59
v_mfma_f32_16x16x32_bf16 a[16:19], a[176:179], v[72:75], a[16:19]
v_cvt_pk_bf16_f32 v94, v52, v53
v_cvt_pk_bf16_f32 v95, v54, v55
v_mfma_f32_16x16x32_bf16 a[48:51], a[176:179], v[76:79], a[48:51]
v_exp_f32 v60, v60
v_mfma_f32_16x16x32_bf16 a[80:83], a[176:179], v[80:83], a[80:83]
s_add_u32 s42, s42, s43
buffer_load_dword v255, v243, s[28:31], s45 offen
v_mfma_f32_16x16x32_bf16 a[112:115], a[176:179], v[84:87], a[112:115]
v_exp_f32 v61, v61
v_mfma_f32_16x16x32_bf16 v[20:23], a[144:147], v[168:171], v[140:143]
ds_read_b64_tr_b16 a[176:177], v224 offset:24576
ds_read_b64_tr_b16 a[178:179], v224 offset:28672
v_mfma_f32_16x16x32_bf16 v[20:23], a[148:151], v[172:175], v[20:23]
v_exp_f32 v62, v62
v_mfma_f32_16x16x32_bf16 v[20:23], a[152:155], v[176:179], v[20:23]
v_cvt_pk_bf16_f32 v96, v56, v57
v_cvt_pk_bf16_f32 v97, v58, v59
v_mfma_f32_16x16x32_bf16 v[20:23], a[156:159], v[180:183], v[20:23]
v_exp_f32 v63, v63
v_mfma_f32_16x16x32_bf16 a[20:23], a[180:183], v[72:75], a[20:23]
v_cvt_pk_bf16_f32 v98, v60, v61
v_cvt_pk_bf16_f32 v99, v62, v63
v_mfma_f32_16x16x32_bf16 a[52:55], a[180:183], v[76:79], a[52:55]
v_exp_f32 v64, v64
v_mfma_f32_16x16x32_bf16 a[84:87], a[180:183], v[80:83], a[84:87]
s_add_u32 s45, s45, 589824
global_load_dword v255, v242, s[72:73]
v_mfma_f32_16x16x32_bf16 a[116:119], a[180:183], v[84:87], a[116:119]
v_exp_f32 v65, v65
v_smfmac_f32_16x16x64_bf16 a[252:255], a[208:211], v[80:87], v235
ds_read_b64_tr_b16 a[180:181], v225 offset:24576
ds_read_b64_tr_b16 a[182:183], v225 offset:28672
v_mfma_f32_16x16x32_bf16 v[28:31], a[144:147], v[184:187], v[144:147]
v_exp_f32 v66, v66
v_mfma_f32_16x16x32_bf16 v[28:31], a[148:151], v[188:191], v[28:31]
v_cvt_pk_bf16_f32 v100, v64, v65
v_mfma_f32_16x16x32_bf16 v[28:31], a[152:155], v[192:195], v[28:31]
v_exp_f32 v67, v67
v_mfma_f32_16x16x32_bf16 v[28:31], a[156:159], v[196:199], v[28:31]
v_cvt_pk_bf16_f32 v101, v66, v67
v_mfma_f32_16x16x32_bf16 a[24:27], a[184:187], v[72:75], a[24:27]
v_exp_f32 v68, v68
v_mfma_f32_16x16x32_bf16 a[56:59], a[184:187], v[76:79], a[56:59]
buffer_load_dword v255, v0, s[24:27], s44 offen
v_mfma_f32_16x16x32_bf16 a[88:91], a[184:187], v[80:83], a[88:91]
v_exp_f32 v69, v69
v_mfma_f32_16x16x32_bf16 a[120:123], a[184:187], v[84:87], a[120:123]
ds_read_b64_tr_b16 a[184:185], v226 offset:24576
ds_read_b64_tr_b16 a[186:187], v226 offset:28672
v_mfma_f32_16x16x32_bf16 v[36:39], a[144:147], v[200:203], v[148:151]
v_exp_f32 v70, v70
v_mfma_f32_16x16x32_bf16 v[36:39], a[148:151], v[204:207], v[36:39]
ds_read_b128 a[144:147], v216 offset:45056
ds_read_b128 a[148:151], v217 offset:45056
v_mfma_f32_16x16x32_bf16 v[36:39], a[152:155], v[208:211], v[36:39]
v_exp_f32 v71, v71
v_mfma_f32_16x16x32_bf16 v[36:39], a[156:159], v[212:215], v[36:39]
ds_read_b128 a[152:155], v218 offset:45056
ds_read_b128 a[156:159], v219 offset:45056
v_mfma_f32_16x16x32_bf16 a[28:31], a[188:191], v[72:75], a[28:31]
v_cvt_pk_bf16_f32 v102, v68, v69
v_cvt_pk_bf16_f32 v103, v70, v71
v_mfma_f32_16x16x32_bf16 a[60:63], a[188:191], v[76:79], a[60:63]
s_add_u32 s44, s44, 4096
v_mfma_f32_16x16x32_bf16 a[92:95], a[188:191], v[80:83], a[92:95]
v_mfma_f32_16x16x32_bf16 a[124:127], a[188:191], v[84:87], a[124:127]
s_waitcnt lgkmcnt(6)
ds_read_b64_tr_b16 a[188:189], v227 offset:24576
ds_read_b64_tr_b16 a[190:191], v227 offset:28672
v_mfma_f32_16x16x32_bf16 v[40:43], a[128:131], v[152:155], v[136:139]
v_exp_f32 v8, v8
v_mfma_f32_16x16x32_bf16 v[40:43], a[132:135], v[156:159], v[40:43]
v_exp_f32 v9, v9
v_mfma_f32_16x16x32_bf16 v[40:43], a[136:139], v[160:163], v[40:43]
v_cvt_pk_bf16_f32 v72, v8, v9
v_mfma_f32_16x16x32_bf16 v[40:43], a[140:143], v[164:167], v[40:43]
v_exp_f32 v10, v10
v_mfma_f32_16x16x32_bf16 a[0:3], a[160:163], v[88:91], a[0:3]
v_mfma_f32_16x16x32_bf16 a[32:35], a[160:163], v[92:95], a[32:35]
v_exp_f32 v11, v11
s_waitcnt vmcnt(8) lgkmcnt(0)
s_barrier
v_mfma_f32_16x16x32_bf16 a[64:67], a[160:163], v[96:99], a[64:67]
v_cvt_pk_bf16_f32 v73, v10, v11
v_mfma_f32_16x16x32_bf16 a[96:99], a[160:163], v[100:103], a[96:99]
s_add_u32 m0, s37, 65536
v_exp_f32 v12, v12
v_mfma_f32_16x16x32_bf16 v[48:51], a[128:131], v[168:171], v[140:143]
buffer_load_dwordx4 v232, s[12:15], s39 offen offset:0 lds
v_mfma_f32_16x16x32_bf16 v[48:51], a[132:135], v[172:175], v[48:51]
v_exp_f32 v13, v13
v_mfma_f32_16x16x32_bf16 v[48:51], a[136:139], v[176:179], v[48:51]
ds_read_b64_tr_b16 a[160:161], v220 offset:32768
ds_read_b64_tr_b16 a[162:163], v220 offset:36864
v_mfma_f32_16x16x32_bf16 v[48:51], a[140:143], v[180:183], v[48:51]
v_exp_f32 v14, v14
v_mfma_f32_16x16x32_bf16 a[4:7], a[164:167], v[88:91], a[4:7]
v_cvt_pk_bf16_f32 v74, v12, v13
v_mfma_f32_16x16x32_bf16 a[36:39], a[164:167], v[92:95], a[36:39]
v_exp_f32 v15, v15
v_mfma_f32_16x16x32_bf16 a[68:71], a[164:167], v[96:99], a[68:71]
v_cvt_pk_bf16_f32 v75, v14, v15
v_mfma_f32_16x16x32_bf16 a[100:103], a[164:167], v[100:103], a[100:103]
v_exp_f32 v16, v16
v_smfmac_f32_16x16x64_bf16 a[248:251], a[208:211], v[88:95], v235
buffer_load_dwordx4 v233, s[12:15], s39 offen offset:1024 lds
v_mfma_f32_16x16x32_bf16 v[56:59], a[128:131], v[184:187], v[144:147]
v_exp_f32 v17, v17
v_mfma_f32_16x16x32_bf16 v[56:59], a[132:135], v[188:191], v[56:59]
ds_read_b64_tr_b16 a[164:165], v221 offset:32768
ds_read_b64_tr_b16 a[166:167], v221 offset:36864
v_mfma_f32_16x16x32_bf16 v[56:59], a[136:139], v[192:195], v[56:59]
v_exp_f32 v18, v18
v_mfma_f32_16x16x32_bf16 v[56:59], a[140:143], v[196:199], v[56:59]
v_cvt_pk_bf16_f32 v76, v16, v17
v_mfma_f32_16x16x32_bf16 a[8:11], a[168:171], v[88:91], a[8:11]
v_exp_f32 v19, v19
v_mfma_f32_16x16x32_bf16 a[40:43], a[168:171], v[92:95], a[40:43]
v_cvt_pk_bf16_f32 v77, v18, v19
v_mfma_f32_16x16x32_bf16 a[72:75], a[168:171], v[96:99], a[72:75]
v_exp_f32 v20, v20
v_mfma_f32_16x16x32_bf16 a[104:107], a[168:171], v[100:103], a[104:107]
ds_read_b64_tr_b16 a[168:169], v222 offset:32768
ds_read_b64_tr_b16 a[170:171], v222 offset:36864
v_mfma_f32_16x16x32_bf16 v[64:67], a[128:131], v[200:203], v[148:151]
v_exp_f32 v21, v21
v_mfma_f32_16x16x32_bf16 v[64:67], a[132:135], v[204:207], v[64:67]
buffer_load_dwordx4 v232, s[12:15], s39 offen offset:2048 lds
v_mfma_f32_16x16x32_bf16 v[64:67], a[136:139], v[208:211], v[64:67]
v_exp_f32 v22, v22
v_mfma_f32_16x16x32_bf16 v[64:67], a[140:143], v[212:215], v[64:67]
ds_read_b128 a[128:131], v216 offset:16384
ds_read_b128 a[132:135], v217 offset:16384
v_mfma_f32_16x16x32_bf16 a[12:15], a[172:175], v[88:91], a[12:15]
v_exp_f32 v23, v23
v_mfma_f32_16x16x32_bf16 a[44:47], a[172:175], v[92:95], a[44:47]
ds_read_b128 a[136:139], v218 offset:16384
ds_read_b128 a[140:143], v219 offset:16384
v_mfma_f32_16x16x32_bf16 a[76:79], a[172:175], v[96:99], a[76:79]
v_exp_f32 v24, v24
v_mfma_f32_16x16x32_bf16 a[108:111], a[172:175], v[100:103], a[108:111]
v_exp_f32 v25, v25
v_mfma_f32_16x16x32_bf16 v[44:47], a[144:147], v[152:155], v[136:139]
ds_read_b64_tr_b16 a[172:173], v223 offset:32768
ds_read_b64_tr_b16 a[174:175], v223 offset:36864
v_mfma_f32_16x16x32_bf16 v[44:47], a[148:151], v[156:159], v[44:47]
v_exp_f32 v26, v26
v_mfma_f32_16x16x32_bf16 v[44:47], a[152:155], v[160:163], v[44:47]
buffer_load_dwordx4 v233, s[12:15], s39 offen offset:3072 lds
v_mfma_f32_16x16x32_bf16 v[44:47], a[156:159], v[164:167], v[44:47]
v_exp_f32 v27, v27
v_mfma_f32_16x16x32_bf16 a[16:19], a[176:179], v[88:91], a[16:19]
v_cvt_pk_bf16_f32 v78, v20, v21
v_cvt_pk_bf16_f32 v79, v22, v23
v_mfma_f32_16x16x32_bf16 a[48:51], a[176:179], v[92:95], a[48:51]
v_exp_f32 v28, v28
v_mfma_f32_16x16x32_bf16 a[80:83], a[176:179], v[96:99], a[80:83]
v_cvt_pk_bf16_f32 v80, v24, v25
v_cvt_pk_bf16_f32 v81, v26, v27
v_mfma_f32_16x16x32_bf16 a[112:115], a[176:179], v[100:103], a[112:115]
v_exp_f32 v29, v29
v_mfma_f32_16x16x32_bf16 v[52:55], a[144:147], v[168:171], v[140:143]
ds_read_b64_tr_b16 a[176:177], v224 offset:32768
ds_read_b64_tr_b16 a[178:179], v224 offset:36864
v_mfma_f32_16x16x32_bf16 v[52:55], a[148:151], v[172:175], v[52:55]
v_exp_f32 v30, v30
v_mfma_f32_16x16x32_bf16 v[52:55], a[152:155], v[176:179], v[52:55]
v_cvt_pk_bf16_f32 v82, v28, v29
v_mfma_f32_16x16x32_bf16 v[52:55], a[156:159], v[180:183], v[52:55]
s_add_u32 s39, s39, 16384
v_exp_f32 v31, v31
v_mfma_f32_16x16x32_bf16 a[20:23], a[180:183], v[88:91], a[20:23]
s_add_u32 m0, s37, 49152
v_cvt_pk_bf16_f32 v83, v30, v31
v_mfma_f32_16x16x32_bf16 a[52:55], a[180:183], v[92:95], a[52:55]
v_exp_f32 v32, v32
v_mfma_f32_16x16x32_bf16 a[84:87], a[180:183], v[96:99], a[84:87]
buffer_load_dwordx4 v228, s[8:11], s38 offen offset:0 lds
v_mfma_f32_16x16x32_bf16 a[116:119], a[180:183], v[100:103], a[116:119]
v_exp_f32 v33, v33
v_smfmac_f32_16x16x64_bf16 a[252:255], a[208:211], v[96:103], v235
ds_read_b64_tr_b16 a[180:181], v225 offset:32768
ds_read_b64_tr_b16 a[182:183], v225 offset:36864
v_mfma_f32_16x16x32_bf16 v[60:63], a[144:147], v[184:187], v[144:147]
v_exp_f32 v34, v34
v_mfma_f32_16x16x32_bf16 v[60:63], a[148:151], v[188:191], v[60:63]
v_cvt_pk_bf16_f32 v84, v32, v33
v_mfma_f32_16x16x32_bf16 v[60:63], a[152:155], v[192:195], v[60:63]
v_exp_f32 v35, v35
v_mfma_f32_16x16x32_bf16 v[60:63], a[156:159], v[196:199], v[60:63]
buffer_load_dwordx4 v229, s[8:11], s38 offen offset:1024 lds
v_mfma_f32_16x16x32_bf16 a[24:27], a[184:187], v[88:91], a[24:27]
v_exp_f32 v36, v36
v_mfma_f32_16x16x32_bf16 a[56:59], a[184:187], v[92:95], a[56:59]
v_cvt_pk_bf16_f32 v85, v34, v35
v_mfma_f32_16x16x32_bf16 a[88:91], a[184:187], v[96:99], a[88:91]
v_exp_f32 v37, v37
v_mfma_f32_16x16x32_bf16 a[120:123], a[184:187], v[100:103], a[120:123]
ds_read_b64_tr_b16 a[184:185], v226 offset:32768
ds_read_b64_tr_b16 a[186:187], v226 offset:36864
v_mfma_f32_16x16x32_bf16 v[68:71], a[144:147], v[200:203], v[148:151]
v_exp_f32 v38, v38
v_mfma_f32_16x16x32_bf16 v[68:71], a[148:151], v[204:207], v[68:71]
ds_read_b128 a[144:147], v216 offset:20480
ds_read_b128 a[148:151], v217 offset:20480
v_mfma_f32_16x16x32_bf16 v[68:71], a[152:155], v[208:211], v[68:71]
v_exp_f32 v39, v39
v_mfma_f32_16x16x32_bf16 v[68:71], a[156:159], v[212:215], v[68:71]
ds_read_b128 a[152:155], v218 offset:20480
ds_read_b128 a[156:159], v219 offset:20480
v_mfma_f32_16x16x32_bf16 a[28:31], a[188:191], v[88:91], a[28:31]
v_cvt_pk_bf16_f32 v86, v36, v37
v_cvt_pk_bf16_f32 v87, v38, v39
v_mfma_f32_16x16x32_bf16 a[60:63], a[188:191], v[92:95], a[60:63]
v_mfma_f32_16x16x32_bf16 a[92:95], a[188:191], v[96:99], a[92:95]
v_mfma_f32_16x16x32_bf16 a[124:127], a[188:191], v[100:103], a[124:127]
s_waitcnt lgkmcnt(6)
ds_read_b64_tr_b16 a[188:189], v227 offset:32768
ds_read_b64_tr_b16 a[190:191], v227 offset:36864
v_mfma_f32_16x16x32_bf16 v[8:11], a[128:131], v[152:155], v[136:139]
v_exp_f32 v40, v40
v_mfma_f32_16x16x32_bf16 v[8:11], a[132:135], v[156:159], v[8:11]
v_exp_f32 v41, v41
v_mfma_f32_16x16x32_bf16 v[8:11], a[136:139], v[160:163], v[8:11]
buffer_load_dwordx4 v230, s[8:11], s38 offen offset:2048 lds
v_mfma_f32_16x16x32_bf16 v[8:11], a[140:143], v[164:167], v[8:11]
v_exp_f32 v42, v42
v_mfma_f32_16x16x32_bf16 a[0:3], a[160:163], v[72:75], a[0:3]
v_cvt_pk_bf16_f32 v88, v40, v41
v_mfma_f32_16x16x32_bf16 a[32:35], a[160:163], v[76:79], a[32:35]
v_exp_f32 v43, v43
v_mfma_f32_16x16x32_bf16 a[64:67], a[160:163], v[80:83], a[64:67]
v_cvt_pk_bf16_f32 v89, v42, v43
v_mfma_f32_16x16x32_bf16 a[96:99], a[160:163], v[84:87], a[96:99]
v_exp_f32 v44, v44
v_mfma_f32_16x16x32_bf16 v[16:19], a[128:131], v[168:171], v[140:143]
ds_read_b64_tr_b16 a[160:161], v220 offset:40960
ds_read_b64_tr_b16 a[162:163], v220 offset:45056
v_mfma_f32_16x16x32_bf16 v[16:19], a[132:135], v[172:175], v[16:19]
v_exp_f32 v45, v45
v_mfma_f32_16x16x32_bf16 v[16:19], a[136:139], v[176:179], v[16:19]
v_cvt_pk_bf16_f32 v90, v44, v45
v_mfma_f32_16x16x32_bf16 v[16:19], a[140:143], v[180:183], v[16:19]
v_exp_f32 v46, v46
v_mfma_f32_16x16x32_bf16 a[4:7], a[164:167], v[72:75], a[4:7]
v_mfma_f32_16x16x32_bf16 a[36:39], a[164:167], v[76:79], a[36:39]
v_exp_f32 v47, v47
v_mfma_f32_16x16x32_bf16 a[68:71], a[164:167], v[80:83], a[68:71]
buffer_load_dwordx4 v231, s[8:11], s38 offen offset:3072 lds
v_mfma_f32_16x16x32_bf16 a[100:103], a[164:167], v[84:87], a[100:103]
v_exp_f32 v48, v48
v_smfmac_f32_16x16x64_bf16 a[248:251], a[208:211], v[72:79], v235
ds_read_b64_tr_b16 a[164:165], v221 offset:40960
ds_read_b64_tr_b16 a[166:167], v221 offset:45056
v_mfma_f32_16x16x32_bf16 v[24:27], a[128:131], v[184:187], v[144:147]
v_exp_f32 v49, v49
v_mfma_f32_16x16x32_bf16 v[24:27], a[132:135], v[188:191], v[24:27]
v_cvt_pk_bf16_f32 v91, v46, v47
v_cvt_pk_bf16_f32 v92, v48, v49
v_mfma_f32_16x16x32_bf16 v[24:27], a[136:139], v[192:195], v[24:27]
v_exp_f32 v50, v50
v_mfma_f32_16x16x32_bf16 v[24:27], a[140:143], v[196:199], v[24:27]
s_waitcnt vmcnt(12)
s_nop 0
ds_read_b64_tr_b16 a[192:193], v248 offset:0
ds_read_b64_tr_b16 a[194:195], v248 offset:256
v_mfma_f32_16x16x32_bf16 a[8:11], a[168:171], v[72:75], a[8:11]
v_exp_f32 v51, v51
v_mfma_f32_16x16x32_bf16 a[40:43], a[168:171], v[76:79], a[40:43]
ds_read_b64_tr_b16 a[196:197], v248 offset:32
v_cvt_pk_bf16_f32 v93, v50, v51
v_mfma_f32_16x16x32_bf16 a[72:75], a[168:171], v[80:83], a[72:75]
v_exp_f32 v52, v52
v_mfma_f32_16x16x32_bf16 a[104:107], a[168:171], v[84:87], a[104:107]
ds_read_b64_tr_b16 a[168:169], v222 offset:40960
ds_read_b64_tr_b16 a[170:171], v222 offset:45056
v_mfma_f32_16x16x32_bf16 v[32:35], a[128:131], v[200:203], v[148:151]
s_add_u32 s38, s38, 16384
v_exp_f32 v53, v53
v_mfma_f32_16x16x32_bf16 v[32:35], a[132:135], v[204:207], v[32:35]
s_add_u32 m0, s37, 81920
ds_read_b128 a[128:131], v216 offset:24576
ds_read_b128 a[132:135], v217 offset:24576
v_mfma_f32_16x16x32_bf16 v[32:35], a[136:139], v[208:211], v[32:35]
v_exp_f32 v54, v54
v_mfma_f32_16x16x32_bf16 v[32:35], a[140:143], v[212:215], v[32:35]
buffer_load_dwordx4 v232, s[12:15], s39 offen offset:0 lds
v_mfma_f32_16x16x32_bf16 a[12:15], a[172:175], v[72:75], a[12:15]
v_exp_f32 v55, v55
v_mfma_f32_16x16x32_bf16 a[44:47], a[172:175], v[76:79], a[44:47]
ds_read_b128 a[136:139], v218 offset:24576
ds_read_b128 a[140:143], v219 offset:24576
v_mfma_f32_16x16x32_bf16 a[76:79], a[172:175], v[80:83], a[76:79]
v_exp_f32 v56, v56
v_mfma_f32_16x16x32_bf16 a[108:111], a[172:175], v[84:87], a[108:111]
s_waitcnt lgkmcnt(6)
v_exp_f32 v57, v57
v_mfma_f32_16x16x32_bf16 v[12:15], a[144:147], v[152:155], v[136:139]
ds_read_b64_tr_b16 a[172:173], v223 offset:40960
ds_read_b64_tr_b16 a[174:175], v223 offset:45056
v_mfma_f32_16x16x32_bf16 v[12:15], a[148:151], v[156:159], v[12:15]
v_exp_f32 v58, v58
v_mfma_f32_16x16x32_bf16 v[12:15], a[152:155], v[160:163], v[12:15]
v_cvt_pk_bf16_f32 v94, v52, v53
v_cvt_pk_bf16_f32 v95, v54, v55
v_mfma_f32_16x16x32_bf16 v[12:15], a[156:159], v[164:167], v[12:15]
v_exp_f32 v59, v59
v_mfma_f32_16x16x32_bf16 a[16:19], a[176:179], v[72:75], a[16:19]
v_cvt_pk_bf16_f32 v96, v56, v57
v_cvt_pk_bf16_f32 v97, v58, v59
v_mfma_f32_16x16x32_bf16 a[48:51], a[176:179], v[76:79], a[48:51]
v_exp_f32 v60, v60
v_mfma_f32_16x16x32_bf16 a[80:83], a[176:179], v[80:83], a[80:83]
buffer_load_dwordx4 v233, s[12:15], s39 offen offset:1024 lds
v_mfma_f32_16x16x32_bf16 a[112:115], a[176:179], v[84:87], a[112:115]
v_exp_f32 v61, v61
v_mfma_f32_16x16x32_bf16 v[20:23], a[144:147], v[168:171], v[140:143]
ds_read_b64_tr_b16 a[176:177], v224 offset:40960
ds_read_b64_tr_b16 a[178:179], v224 offset:45056
v_mfma_f32_16x16x32_bf16 v[20:23], a[148:151], v[172:175], v[20:23]
v_exp_f32 v62, v62
v_mfma_f32_16x16x32_bf16 v[20:23], a[152:155], v[176:179], v[20:23]
ds_read_b64_tr_b16 a[198:199], v248 offset:288
v_cvt_pk_bf16_f32 v98, v60, v61
v_mfma_f32_16x16x32_bf16 v[20:23], a[156:159], v[180:183], v[20:23]
v_exp_f32 v63, v63
v_mfma_f32_16x16x32_bf16 a[20:23], a[180:183], v[72:75], a[20:23]
ds_read_b64_tr_b16 a[200:201], v248 offset:4096
v_cvt_pk_bf16_f32 v99, v62, v63
v_mfma_f32_16x16x32_bf16 a[52:55], a[180:183], v[76:79], a[52:55]
v_exp_f32 v64, v64
v_mfma_f32_16x16x32_bf16 a[84:87], a[180:183], v[80:83], a[84:87]
ds_read_b64_tr_b16 a[202:203], v248 offset:4352
ds_read_b64_tr_b16 a[204:205], v248 offset:4128
v_mfma_f32_16x16x32_bf16 a[116:119], a[180:183], v[84:87], a[116:119]
v_exp_f32 v65, v65
v_smfmac_f32_16x16x64_bf16 a[252:255], a[208:211], v[80:87], v235
ds_read_b64_tr_b16 a[180:181], v225 offset:40960
ds_read_b64_tr_b16 a[182:183], v225 offset:45056
v_mfma_f32_16x16x32_bf16 v[28:31], a[144:147], v[184:187], v[144:147]
v_exp_f32 v66, v66
v_mfma_f32_16x16x32_bf16 v[28:31], a[148:151], v[188:191], v[28:31]
buffer_load_dwordx4 v232, s[12:15], s39 offen offset:2048 lds
v_mfma_f32_16x16x32_bf16 v[28:31], a[152:155], v[192:195], v[28:31]
v_exp_f32 v67, v67
v_mfma_f32_16x16x32_bf16 v[28:31], a[156:159], v[196:199], v[28:31]
v_cvt_pk_bf16_f32 v100, v64, v65
v_cvt_pk_bf16_f32 v101, v66, v67
v_mfma_f32_16x16x32_bf16 a[24:27], a[184:187], v[72:75], a[24:27]
v_exp_f32 v68, v68
v_mfma_f32_16x16x32_bf16 a[56:59], a[184:187], v[76:79], a[56:59]
ds_read_b64_tr_b16 a[206:207], v248 offset:4384
ds_read_b64_tr_b16 v[120:121], v248 offset:2048
v_mfma_f32_16x16x32_bf16 a[88:91], a[184:187], v[80:83], a[88:91]
v_exp_f32 v69, v69
v_mfma_f32_16x16x32_bf16 a[120:123], a[184:187], v[84:87], a[120:123]
ds_read_b64_tr_b16 a[184:185], v226 offset:40960
ds_read_b64_tr_b16 a[186:187], v226 offset:45056
v_mfma_f32_16x16x32_bf16 v[36:39], a[144:147], v[200:203], v[148:151]
v_exp_f32 v70, v70
v_mfma_f32_16x16x32_bf16 v[36:39], a[148:151], v[204:207], v[36:39]
ds_read_b128 a[144:147], v216 offset:28672
ds_read_b128 a[148:151], v217 offset:28672
v_mfma_f32_16x16x32_bf16 v[36:39], a[152:155], v[208:211], v[36:39]
v_exp_f32 v71, v71
v_mfma_f32_16x16x32_bf16 v[36:39], a[156:159], v[212:215], v[36:39]
ds_read_b128 a[152:155], v218 offset:28672
ds_read_b128 a[156:159], v219 offset:28672
v_mfma_f32_16x16x32_bf16 a[28:31], a[188:191], v[72:75], a[28:31]
v_cvt_pk_bf16_f32 v102, v68, v69
v_cvt_pk_bf16_f32 v103, v70, v71
v_mfma_f32_16x16x32_bf16 a[60:63], a[188:191], v[76:79], a[60:63]
ds_read_b64_tr_b16 v[122:123], v248 offset:2304
v_mfma_f32_16x16x32_bf16 a[92:95], a[188:191], v[80:83], a[92:95]
v_mfma_f32_16x16x32_bf16 a[124:127], a[188:191], v[84:87], a[124:127]
s_waitcnt lgkmcnt(7)
ds_read_b64_tr_b16 a[188:189], v227 offset:40960
ds_read_b64_tr_b16 a[190:191], v227 offset:45056
v_mfma_f32_16x16x32_bf16 v[40:43], a[128:131], v[152:155], v[136:139]
s_sub_u32 s90, s49, 0xf000
v_exp_f32 v8, v8
v_mfma_f32_16x16x32_bf16 v[40:43], a[132:135], v[156:159], v[40:43]
buffer_load_dwordx4 v233, s[12:15], s39 offen offset:3072 lds
v_mfma_f32_16x16x32_bf16 v[40:43], a[136:139], v[160:163], v[40:43]
v_exp_f32 v9, v9
v_mfma_f32_16x16x32_bf16 v[40:43], a[140:143], v[164:167], v[40:43]
ds_read_b64_tr_b16 v[124:125], v248 offset:2080
v_cvt_pk_bf16_f32 v72, v8, v9
v_mfma_f32_16x16x32_bf16 a[0:3], a[160:163], v[88:91], a[0:3]
v_exp_f32 v10, v10
v_mfma_f32_16x16x32_bf16 a[32:35], a[160:163], v[92:95], a[32:35]
ds_read_b64_tr_b16 v[126:127], v248 offset:2336
ds_read_b64_tr_b16 v[128:129], v248 offset:6144
v_mfma_f32_16x16x32_bf16 a[64:67], a[160:163], v[96:99], a[64:67]
v_exp_f32 v11, v11
v_mfma_f32_16x16x32_bf16 a[96:99], a[160:163], v[100:103], a[96:99]
ds_read_b64_tr_b16 a[160:161], v220 offset:49152
ds_read_b64_tr_b16 a[162:163], v220 offset:53248
v_mfma_f32_16x16x32_bf16 v[104:107], a[192:195], a[220:223], v[104:107]
v_exp_f32 v12, v12
v_mfma_f32_16x16x32_bf16 v[48:51], a[128:131], v[168:171], v[140:143]
ds_read_b64_tr_b16 v[130:131], v248 offset:6400
v_cvt_pk_bf16_f32 v73, v10, v11
v_mfma_f32_16x16x32_bf16 v[48:51], a[132:135], v[172:175], v[48:51]
v_exp_f32 v13, v13
v_mfma_f32_16x16x32_bf16 v[48:51], a[136:139], v[176:179], v[48:51]
ds_read_b64_tr_b16 v[132:133], v248 offset:6176
v_cvt_pk_bf16_f32 v74, v12, v13
v_mfma_f32_16x16x32_bf16 v[48:51], a[140:143], v[180:183], v[48:51]
ds_read_b64_tr_b16 v[134:135], v248 offset:6432
v_mfma_f32_16x16x32_bf16 a[4:7], a[164:167], v[88:91], a[4:7]
v_exp_f32 v14, v14
v_mfma_f32_16x16x32_bf16 a[36:39], a[164:167], v[92:95], a[36:39]
v_mfma_f32_16x16x32_bf16 a[68:71], a[164:167], v[96:99], a[68:71]
s_add_u32 s39, s39, 16384
v_exp_f32 v15, v15
v_mfma_f32_16x16x32_bf16 a[100:103], a[164:167], v[100:103], a[100:103]
s_add_u32 m0, s37, 32768
ds_read_b64_tr_b16 a[164:165], v221 offset:49152
ds_read_b64_tr_b16 a[166:167], v221 offset:53248
v_smfmac_f32_16x16x64_bf16 a[248:251], a[208:211], v[88:95], v235
v_exp_f32 v16, v16
v_mfma_f32_16x16x32_bf16 v[108:111], a[196:199], a[220:223], v[108:111]
buffer_load_dwordx4 v228, s[8:11], s38 offen offset:0 lds
v_mfma_f32_16x16x32_bf16 v[56:59], a[128:131], v[184:187], v[144:147]
v_exp_f32 v17, v17
v_mfma_f32_16x16x32_bf16 v[56:59], a[132:135], v[188:191], v[56:59]
v_cvt_pk_bf16_f32 v75, v14, v15
v_cvt_pk_bf16_f32 v76, v16, v17
v_mfma_f32_16x16x32_bf16 v[56:59], a[136:139], v[192:195], v[56:59]
v_exp_f32 v18, v18
v_mfma_f32_16x16x32_bf16 v[56:59], a[140:143], v[196:199], v[56:59]
v_mfma_f32_16x16x32_bf16 a[8:11], a[168:171], v[88:91], a[8:11]
v_mfma_f32_16x16x32_bf16 a[40:43], a[168:171], v[92:95], a[40:43]
v_exp_f32 v19, v19
v_mfma_f32_16x16x32_bf16 a[72:75], a[168:171], v[96:99], a[72:75]
v_cvt_pk_bf16_f32 v77, v18, v19
v_mfma_f32_16x16x32_bf16 a[104:107], a[168:171], v[100:103], a[104:107]
v_exp_f32 v20, v20
v_mfma_f32_16x16x32_bf16 v[112:115], a[200:203], a[220:223], v[112:115]
ds_read_b64_tr_b16 a[168:169], v222 offset:49152
ds_read_b64_tr_b16 a[170:171], v222 offset:53248
v_mfma_f32_16x16x32_bf16 v[64:67], a[128:131], v[200:203], v[148:151]
v_exp_f32 v21, v21
v_mfma_f32_16x16x32_bf16 v[64:67], a[132:135], v[204:207], v[64:67]
buffer_load_dwordx4 v229, s[8:11], s38 offen offset:1024 lds
v_mfma_f32_16x16x32_bf16 v[64:67], a[136:139], v[208:211], v[64:67]
v_exp_f32 v22, v22
v_mfma_f32_16x16x32_bf16 v[64:67], a[140:143], v[212:215], v[64:67]
ds_read_b128 a[128:131], v216 offset:0
ds_read_b128 a[132:135], v217 offset:0
v_mfma_f32_16x16x32_bf16 a[12:15], a[172:175], v[88:91], a[12:15]
v_exp_f32 v23, v23
v_mfma_f32_16x16x32_bf16 a[44:47], a[172:175], v[92:95], a[44:47]
ds_read_b128 a[136:139], v218 offset:0
ds_read_b128 a[140:143], v219 offset:0
v_mfma_f32_16x16x32_bf16 a[76:79], a[172:175], v[96:99], a[76:79]
v_cvt_pk_bf16_f32 v78, v20, v21
v_cvt_pk_bf16_f32 v79, v22, v23
v_mfma_f32_16x16x32_bf16 a[108:111], a[172:175], v[100:103], a[108:111]
v_exp_f32 v24, v24
v_mfma_f32_16x16x32_bf16 v[116:119], a[204:207], a[220:223], v[116:119]
s_waitcnt lgkmcnt(6)
ds_read_b64_tr_b16 a[172:173], v223 offset:49152
ds_read_b64_tr_b16 a[174:175], v223 offset:53248
v_mfma_f32_16x16x32_bf16 v[44:47], a[144:147], v[152:155], v[136:139]
v_exp_f32 v25, v25
v_mfma_f32_16x16x32_bf16 v[44:47], a[148:151], v[156:159], v[44:47]
v_cvt_pk_bf16_f32 v80, v24, v25
v_mfma_f32_16x16x32_bf16 v[44:47], a[152:155], v[160:163], v[44:47]
v_exp_f32 v26, v26
v_mfma_f32_16x16x32_bf16 v[44:47], a[156:159], v[164:167], v[44:47]
v_mfma_f32_16x16x32_bf16 a[16:19], a[176:179], v[88:91], a[16:19]
v_exp_f32 v27, v27
v_mfma_f32_16x16x32_bf16 a[48:51], a[176:179], v[92:95], a[48:51]
v_cvt_pk_bf16_f32 v81, v26, v27
v_mfma_f32_16x16x32_bf16 a[80:83], a[176:179], v[96:99], a[80:83]
v_exp_f32 v28, v28
v_mfma_f32_16x16x32_bf16 a[112:115], a[176:179], v[100:103], a[112:115]
buffer_load_dwordx4 v230, s[8:11], s38 offen offset:2048 lds
v_mfma_f32_16x16x32_bf16 v[52:55], a[144:147], v[168:171], v[140:143]
v_exp_f32 v29, v29
v_mfma_f32_16x16x32_bf16 v[52:55], a[148:151], v[172:175], v[52:55]
ds_read_b64_tr_b16 a[176:177], v224 offset:49152
ds_read_b64_tr_b16 a[178:179], v224 offset:53248
v_mfma_f32_16x16x32_bf16 v[52:55], a[152:155], v[176:179], v[52:55]
v_cvt_pk_bf16_f32 v82, v28, v29
v_mfma_f32_16x16x32_bf16 v[52:55], a[156:159], v[180:183], v[52:55]
v_exp_f32 v30, v30
v_mfma_f32_16x16x32_bf16 a[20:23], a[180:183], v[88:91], a[20:23]
v_mfma_f32_16x16x32_bf16 a[52:55], a[180:183], v[92:95], a[52:55]
v_exp_f32 v31, v31
v_mfma_f32_16x16x32_bf16 a[84:87], a[180:183], v[96:99], a[84:87]
v_cvt_pk_bf16_f32 v83, v30, v31
v_mfma_f32_16x16x32_bf16 a[116:119], a[180:183], v[100:103], a[116:119]
v_exp_f32 v32, v32
v_smfmac_f32_16x16x64_bf16 a[252:255], a[208:211], v[96:103], v235
ds_read_b64_tr_b16 a[180:181], v225 offset:49152
ds_read_b64_tr_b16 a[182:183], v225 offset:53248
v_mfma_f32_16x16x32_bf16 v[104:107], v[120:123], a[224:227], v[104:107]
v_exp_f32 v33, v33
v_mfma_f32_16x16x32_bf16 v[60:63], a[144:147], v[184:187], v[144:147]
v_cvt_pk_bf16_f32 v84, v32, v33
v_mfma_f32_16x16x32_bf16 v[60:63], a[148:151], v[188:191], v[60:63]
v_exp_f32 v34, v34
v_mfma_f32_16x16x32_bf16 v[60:63], a[152:155], v[192:195], v[60:63]
buffer_load_dwordx4 v231, s[8:11], s38 offen offset:3072 lds
v_mfma_f32_16x16x32_bf16 v[60:63], a[156:159], v[196:199], v[60:63]
v_mfma_f32_16x16x32_bf16 a[24:27], a[184:187], v[88:91], a[24:27]
v_exp_f32 v35, v35
v_mfma_f32_16x16x32_bf16 a[56:59], a[184:187], v[92:95], a[56:59]
v_cvt_pk_bf16_f32 v85, v34, v35
v_mfma_f32_16x16x32_bf16 a[88:91], a[184:187], v[96:99], a[88:91]
v_exp_f32 v36, v36
v_mfma_f32_16x16x32_bf16 a[120:123], a[184:187], v[100:103], a[120:123]
ds_read_b64_tr_b16 a[184:185], v226 offset:49152
ds_read_b64_tr_b16 a[186:187], v226 offset:53248
v_mfma_f32_16x16x32_bf16 v[108:111], v[124:127], a[224:227], v[108:111]
v_exp_f32 v37, v37
v_mfma_f32_16x16x32_bf16 v[68:71], a[144:147], v[200:203], v[148:151]
ds_read_b128 a[144:147], v216 offset:4096
v_cvt_pk_bf16_f32 v86, v36, v37
v_mfma_f32_16x16x32_bf16 v[68:71], a[148:151], v[204:207], v[68:71]
v_exp_f32 v38, v38
v_mfma_f32_16x16x32_bf16 v[68:71], a[152:155], v[208:211], v[68:71]
ds_read_b128 a[148:151], v217 offset:4096
ds_read_b128 a[152:155], v218 offset:4096
v_mfma_f32_16x16x32_bf16 v[68:71], a[156:159], v[212:215], v[68:71]
v_exp_f32 v39, v39
v_mfma_f32_16x16x32_bf16 a[28:31], a[188:191], v[88:91], a[28:31]
ds_read_b128 a[156:159], v219 offset:4096
v_cvt_pk_bf16_f32 v87, v38, v39
v_mfma_f32_16x16x32_bf16 a[60:63], a[188:191], v[92:95], a[60:63]
v_mfma_f32_16x16x32_bf16 a[92:95], a[188:191], v[96:99], a[92:95]
v_mfma_f32_16x16x32_bf16 a[124:127], a[188:191], v[100:103], a[124:127]
s_add_u32 s38, s38, 16384
ds_read_b64_tr_b16 a[188:189], v227 offset:49152
ds_read_b64_tr_b16 a[190:191], v227 offset:53248
v_mfma_f32_16x16x32_bf16 v[112:115], v[128:131], a[224:227], v[112:115]
v_mfma_f32_16x16x32_bf16 v[116:119], v[132:135], a[224:227], v[116:119]
s_waitcnt lgkmcnt(6)
v_mfma_f32_16x16x32_bf16 v[8:11], a[128:131], v[152:155], v[136:139]
v_exp_f32 v40, v40
v_mfma_f32_16x16x32_bf16 v[8:11], a[132:135], v[156:159], v[8:11]
s_add_u32 m0, s49, 4096
v_exp_f32 v41, v41
v_mfma_f32_16x16x32_bf16 v[8:11], a[136:139], v[160:163], v[8:11]
s_add_u32 s48, s91, 0
buffer_load_dwordx4 v249, s[64:67], s48 offen  lds
v_mfma_f32_16x16x32_bf16 v[8:11], a[140:143], v[164:167], v[8:11]
v_exp_f32 v42, v42
v_mfma_f32_16x16x32_bf16 a[0:3], a[160:163], v[72:75], a[0:3]
v_cvt_pk_bf16_f32 v88, v40, v41
v_add_u32 v131, s90, v223
v_mfma_f32_16x16x32_bf16 a[32:35], a[160:163], v[76:79], a[32:35]
v_exp_f32 v43, v43
v_mfma_f32_16x16x32_bf16 a[64:67], a[160:163], v[80:83], a[64:67]
v_cvt_pk_bf16_f32 v89, v42, v43
v_add_u32 v132, s90, v224
v_mfma_f32_16x16x32_bf16 a[96:99], a[160:163], v[84:87], a[96:99]
v_exp_f32 v44, v44
v_mfma_f32_16x16x32_bf16 v[16:19], a[128:131], v[168:171], v[140:143]
s_add_u32 m0, s49, 5120
ds_read_b64_tr_b16 a[160:161], v220 offset:57344
ds_read_b64_tr_b16 a[162:163], v220 offset:61440
v_mfma_f32_16x16x32_bf16 v[16:19], a[132:135], v[172:175], v[16:19]
s_add_u32 s48, s91, 4608
v_exp_f32 v45, v45
v_mfma_f32_16x16x32_bf16 v[16:19], a[136:139], v[176:179], v[16:19]
buffer_load_dwordx4 v250, s[64:67], s48 offen  lds
v_mfma_f32_16x16x32_bf16 v[16:19], a[140:143], v[180:183], v[16:19]
v_exp_f32 v46, v46
v_mfma_f32_16x16x32_bf16 a[4:7], a[164:167], v[72:75], a[4:7]
v_cvt_pk_bf16_f32 v90, v44, v45
v_add_u32 v133, s90, v225
v_mfma_f32_16x16x32_bf16 a[36:39], a[164:167], v[76:79], a[36:39]
v_exp_f32 v47, v47
v_mfma_f32_16x16x32_bf16 a[68:71], a[164:167], v[80:83], a[68:71]
v_cvt_pk_bf16_f32 v91, v46, v47
v_add_u32 v134, s90, v226
v_mfma_f32_16x16x32_bf16 a[100:103], a[164:167], v[84:87], a[100:103]
v_exp_f32 v48, v48
v_smfmac_f32_16x16x64_bf16 a[248:251], a[208:211], v[72:79], v235
s_add_u32 m0, s49, 6144
ds_read_b64_tr_b16 a[164:165], v221 offset:57344
ds_read_b64_tr_b16 a[166:167], v221 offset:61440
v_mfma_f32_16x16x32_bf16 v[24:27], a[128:131], v[184:187], v[144:147]
s_add_u32 s48, s91, 9216
v_exp_f32 v49, v49
v_mfma_f32_16x16x32_bf16 v[24:27], a[132:135], v[188:191], v[24:27]
buffer_load_dwordx4 v249, s[64:67], s48 offen  lds
v_mfma_f32_16x16x32_bf16 v[24:27], a[136:139], v[192:195], v[24:27]
v_exp_f32 v50, v50
v_mfma_f32_16x16x32_bf16 v[24:27], a[140:143], v[196:199], v[24:27]
v_cvt_pk_bf16_f32 v92, v48, v49
v_add_u32 v135, s90, v227
v_mfma_f32_16x16x32_bf16 a[8:11], a[168:171], v[72:75], a[8:11]
v_exp_f32 v51, v51
v_mfma_f32_16x16x32_bf16 a[40:43], a[168:171], v[76:79], a[40:43]
v_cvt_pk_bf16_f32 v93, v50, v51
v_mfma_f32_16x16x32_bf16 a[72:75], a[168:171], v[80:83], a[72:75]
v_exp_f32 v52, v52
v_mfma_f32_16x16x32_bf16 a[104:107], a[168:171], v[84:87], a[104:107]
s_add_u32 m0, s49, 7168
ds_read_b64_tr_b16 a[168:169], v222 offset:57344
ds_read_b64_tr_b16 a[170:171], v222 offset:61440
v_mfma_f32_16x16x32_bf16 v[32:35], a[128:131], v[200:203], v[148:151]
s_add_u32 s48, s91, 13824
v_exp_f32 v53, v53
v_mfma_f32_16x16x32_bf16 v[32:35], a[132:135], v[204:207], v[32:35]
buffer_load_dwordx4 v250, s[64:67], s48 offen  lds
v_mfma_f32_16x16x32_bf16 v[32:35], a[136:139], v[208:211], v[32:35]
v_exp_f32 v54, v54
v_mfma_f32_16x16x32_bf16 v[32:35], a[140:143], v[212:215], v[32:35]
ds_read_b128 a[128:131], v216 offset:8192
ds_read_b128 a[132:135], v217 offset:8192
v_mfma_f32_16x16x32_bf16 a[12:15], a[172:175], v[72:75], a[12:15]
v_exp_f32 v55, v55
v_mfma_f32_16x16x32_bf16 a[44:47], a[172:175], v[76:79], a[44:47]
ds_read_b128 a[136:139], v218 offset:8192
ds_read_b128 a[140:143], v219 offset:8192
v_mfma_f32_16x16x32_bf16 a[76:79], a[172:175], v[80:83], a[76:79]
v_exp_f32 v56, v56
v_mfma_f32_16x16x32_bf16 a[108:111], a[172:175], v[84:87], a[108:111]
s_waitcnt lgkmcnt(6)
v_exp_f32 v57, v57
v_mfma_f32_16x16x32_bf16 v[12:15], a[144:147], v[152:155], v[136:139]
buffer_load_dwordx2 v[252:253], v251, s[76:79], s42 offen sc1
v_mfma_f32_16x16x32_bf16 v[12:15], a[148:151], v[156:159], v[12:15]
v_exp_f32 v58, v58
v_mfma_f32_16x16x32_bf16 v[12:15], a[152:155], v[160:163], v[12:15]
ds_read_b64_tr_b16 a[172:173], v223 offset:57344
ds_read_b64_tr_b16 a[174:175], v223 offset:61440
v_mfma_f32_16x16x32_bf16 v[12:15], a[156:159], v[164:167], v[12:15]
v_exp_f32 v59, v59
v_mfma_f32_16x16x32_bf16 a[16:19], a[176:179], v[72:75], a[16:19]
v_cvt_pk_bf16_f32 v94, v52, v53
v_cvt_pk_bf16_f32 v95, v54, v55
v_mfma_f32_16x16x32_bf16 a[48:51], a[176:179], v[76:79], a[48:51]
v_exp_f32 v60, v60
v_mfma_f32_16x16x32_bf16 a[80:83], a[176:179], v[80:83], a[80:83]
s_add_u32 s42, s42, s43
buffer_load_dword v255, v243, s[28:31], s45 offen
v_mfma_f32_16x16x32_bf16 a[112:115], a[176:179], v[84:87], a[112:115]
v_exp_f32 v61, v61
v_mfma_f32_16x16x32_bf16 v[20:23], a[144:147], v[168:171], v[140:143]
ds_read_b64_tr_b16 a[176:177], v224 offset:57344
ds_read_b64_tr_b16 a[178:179], v224 offset:61440
v_mfma_f32_16x16x32_bf16 v[20:23], a[148:151], v[172:175], v[20:23]
v_exp_f32 v62, v62
v_mfma_f32_16x16x32_bf16 v[20:23], a[152:155], v[176:179], v[20:23]
v_cvt_pk_bf16_f32 v96, v56, v57
v_cvt_pk_bf16_f32 v97, v58, v59
v_mfma_f32_16x16x32_bf16 v[20:23], a[156:159], v[180:183], v[20:23]
v_exp_f32 v63, v63
v_mfma_f32_16x16x32_bf16 a[20:23], a[180:183], v[72:75], a[20:23]
v_cvt_pk_bf16_f32 v98, v60, v61
v_cvt_pk_bf16_f32 v99, v62, v63
v_mfma_f32_16x16x32_bf16 a[52:55], a[180:183], v[76:79], a[52:55]
v_exp_f32 v64, v64
v_mfma_f32_16x16x32_bf16 a[84:87], a[180:183], v[80:83], a[84:87]
s_add_u32 s45, s45, 589824
global_load_dword v255, v242, s[72:73]
v_mfma_f32_16x16x32_bf16 a[116:119], a[180:183], v[84:87], a[116:119]
v_exp_f32 v65, v65
v_smfmac_f32_16x16x64_bf16 a[252:255], a[208:211], v[80:87], v235
ds_read_b64_tr_b16 a[180:181], v225 offset:57344
ds_read_b64_tr_b16 a[182:183], v225 offset:61440
v_mfma_f32_16x16x32_bf16 v[28:31], a[144:147], v[184:187], v[144:147]
v_exp_f32 v66, v66
v_mfma_f32_16x16x32_bf16 v[28:31], a[148:151], v[188:191], v[28:31]
v_cvt_pk_bf16_f32 v100, v64, v65
v_mfma_f32_16x16x32_bf16 v[28:31], a[152:155], v[192:195], v[28:31]
v_exp_f32 v67, v67
v_mfma_f32_16x16x32_bf16 v[28:31], a[156:159], v[196:199], v[28:31]
v_cvt_pk_bf16_f32 v101, v66, v67
v_mfma_f32_16x16x32_bf16 a[24:27], a[184:187], v[72:75], a[24:27]
v_exp_f32 v68, v68
v_mfma_f32_16x16x32_bf16 a[56:59], a[184:187], v[76:79], a[56:59]
buffer_load_dword v255, v0, s[24:27], s44 offen
v_mfma_f32_16x16x32_bf16 a[88:91], a[184:187], v[80:83], a[88:91]
v_exp_f32 v69, v69
v_mfma_f32_16x16x32_bf16 a[120:123], a[184:187], v[84:87], a[120:123]
ds_read_b64_tr_b16 a[184:185], v226 offset:57344
ds_read_b64_tr_b16 a[186:187], v226 offset:61440
v_mfma_f32_16x16x32_bf16 v[36:39], a[144:147], v[200:203], v[148:151]
v_exp_f32 v70, v70
v_mfma_f32_16x16x32_bf16 v[36:39], a[148:151], v[204:207], v[36:39]
ds_read_b128 a[144:147], v216 offset:12288
ds_read_b128 a[148:151], v217 offset:12288
v_mfma_f32_16x16x32_bf16 v[36:39], a[152:155], v[208:211], v[36:39]
v_exp_f32 v71, v71
v_mfma_f32_16x16x32_bf16 v[36:39], a[156:159], v[212:215], v[36:39]
ds_read_b128 a[152:155], v218 offset:12288
ds_read_b128 a[156:159], v219 offset:12288
v_mfma_f32_16x16x32_bf16 a[28:31], a[188:191], v[72:75], a[28:31]
v_cvt_pk_bf16_f32 v102, v68, v69
v_cvt_pk_bf16_f32 v103, v70, v71
v_mfma_f32_16x16x32_bf16 a[60:63], a[188:191], v[76:79], a[60:63]
s_add_u32 s44, s44, 4096
ds_write_b128 v5, v[104:107] offset:0
v_mfma_f32_16x16x32_bf16 a[92:95], a[188:191], v[80:83], a[92:95]
ds_write_b128 v5, v[108:111] offset:1024
v_mfma_f32_16x16x32_bf16 a[124:127], a[188:191], v[84:87], a[124:127]
s_waitcnt lgkmcnt(8)
ds_read_b64_tr_b16 a[188:189], v227 offset:57344
ds_read_b64_tr_b16 a[190:191], v227 offset:61440
ds_write_b128 v5, v[112:115] offset:2048
ds_write_b128 v5, v[116:119] offset:3072
s_sub_u32 s46, s49, 0xf000
v_mfma_f32_16x16x32_bf16 v[40:43], a[128:131], v[152:155], v[136:139]
v_exp_f32 v8, v8
v_mfma_f32_16x16x32_bf16 v[40:43], a[132:135], v[156:159], v[40:43]
v_exp_f32 v9, v9
v_mfma_f32_16x16x32_bf16 v[40:43], a[136:139], v[160:163], v[40:43]
v_cvt_pk_bf16_f32 v72, v8, v9
v_add_u32 v128, s46, v220
v_mfma_f32_16x16x32_bf16 v[40:43], a[140:143], v[164:167], v[40:43]
v_exp_f32 v10, v10
v_mfma_f32_16x16x32_bf16 a[0:3], a[160:163], v[88:91], a[0:3]
v_add_u32 v129, s46, v221
v_add_u32 v130, s46, v222
v_mfma_f32_16x16x32_bf16 a[32:35], a[160:163], v[92:95], a[32:35]
v_exp_f32 v11, v11
s_waitcnt vmcnt(8) lgkmcnt(0)
s_barrier
v_mfma_f32_16x16x32_bf16 a[64:67], a[160:163], v[96:99], a[64:67]
ds_read_b128 v[104:107], v6 offset:0
v_cvt_pk_bf16_f32 v73, v10, v11
v_mfma_f32_16x16x32_bf16 a[96:99], a[160:163], v[100:103], a[96:99]
s_add_u32 m0, s37, 98304
v_exp_f32 v12, v12
v_mfma_f32_16x16x32_bf16 v[48:51], a[128:131], v[168:171], v[140:143]
buffer_load_dwordx4 v232, s[12:15], s39 offen offset:0 lds
v_mfma_f32_16x16x32_bf16 v[48:51], a[132:135], v[172:175], v[48:51]
v_exp_f32 v13, v13
v_mfma_f32_16x16x32_bf16 v[48:51], a[136:139], v[176:179], v[48:51]
ds_read_b64_tr_b16 a[160:161], v220 offset:0
ds_read_b64_tr_b16 a[162:163], v220 offset:4096
v_mfma_f32_16x16x32_bf16 v[48:51], a[140:143], v[180:183], v[48:51]
v_exp_f32 v14, v14
v_mfma_f32_16x16x32_bf16 a[4:7], a[164:167], v[88:91], a[4:7]
ds_read_b128 v[108:111], v6 offset:8192
v_cvt_pk_bf16_f32 v74, v12, v13
v_mfma_f32_16x16x32_bf16 a[36:39], a[164:167], v[92:95], a[36:39]
v_exp_f32 v15, v15
v_mfma_f32_16x16x32_bf16 a[68:71], a[164:167], v[96:99], a[68:71]
ds_read_b128 v[112:115], v6 offset:16384
v_cvt_pk_bf16_f32 v75, v14, v15
v_mfma_f32_16x16x32_bf16 a[100:103], a[164:167], v[100:103], a[100:103]
v_exp_f32 v16, v16
v_smfmac_f32_16x16x64_bf16 a[248:251], a[208:211], v[88:95], v235
buffer_load_dwordx4 v233, s[12:15], s39 offen offset:1024 lds
v_mfma_f32_16x16x32_bf16 v[56:59], a[128:131], v[184:187], v[144:147]
v_exp_f32 v17, v17
v_mfma_f32_16x16x32_bf16 v[56:59], a[132:135], v[188:191], v[56:59]
ds_read_b64_tr_b16 a[164:165], v221 offset:0
ds_read_b64_tr_b16 a[166:167], v221 offset:4096
v_mfma_f32_16x16x32_bf16 v[56:59], a[136:139], v[192:195], v[56:59]
v_exp_f32 v18, v18
v_mfma_f32_16x16x32_bf16 v[56:59], a[140:143], v[196:199], v[56:59]
ds_read_b128 v[116:119], v6 offset:24576
v_cvt_pk_bf16_f32 v76, v16, v17
v_mfma_f32_16x16x32_bf16 a[8:11], a[168:171], v[88:91], a[8:11]
v_exp_f32 v19, v19
v_mfma_f32_16x16x32_bf16 a[40:43], a[168:171], v[92:95], a[40:43]
v_cvt_pk_bf16_f32 v77, v18, v19
v_mfma_f32_16x16x32_bf16 a[72:75], a[168:171], v[96:99], a[72:75]
v_exp_f32 v20, v20
v_mfma_f32_16x16x32_bf16 a[104:107], a[168:171], v[100:103], a[104:107]
ds_read_b64_tr_b16 a[168:169], v222 offset:0
ds_read_b64_tr_b16 a[170:171], v222 offset:4096
v_mfma_f32_16x16x32_bf16 v[64:67], a[128:131], v[200:203], v[148:151]
v_exp_f32 v21, v21
v_mfma_f32_16x16x32_bf16 v[64:67], a[132:135], v[204:207], v[64:67]
buffer_load_dwordx4 v232, s[12:15], s39 offen offset:2048 lds
v_mfma_f32_16x16x32_bf16 v[64:67], a[136:139], v[208:211], v[64:67]
v_exp_f32 v22, v22
v_mfma_f32_16x16x32_bf16 v[64:67], a[140:143], v[212:215], v[64:67]
ds_read_b128 a[128:131], v216 offset:49152
ds_read_b128 a[132:135], v217 offset:49152
v_mfma_f32_16x16x32_bf16 a[12:15], a[172:175], v[88:91], a[12:15]
v_exp_f32 v23, v23
v_mfma_f32_16x16x32_bf16 a[44:47], a[172:175], v[92:95], a[44:47]
ds_read_b128 a[136:139], v218 offset:49152
ds_read_b128 a[140:143], v219 offset:49152
v_mfma_f32_16x16x32_bf16 a[76:79], a[172:175], v[96:99], a[76:79]
v_exp_f32 v24, v24
v_mfma_f32_16x16x32_bf16 a[108:111], a[172:175], v[100:103], a[108:111]
v_exp_f32 v25, v25
v_mfma_f32_16x16x32_bf16 v[44:47], a[144:147], v[152:155], v[136:139]
ds_read_b64_tr_b16 a[172:173], v223 offset:0
ds_read_b64_tr_b16 a[174:175], v223 offset:4096
v_mfma_f32_16x16x32_bf16 v[44:47], a[148:151], v[156:159], v[44:47]
v_exp_f32 v26, v26
v_mfma_f32_16x16x32_bf16 v[44:47], a[152:155], v[160:163], v[44:47]
buffer_load_dwordx4 v233, s[12:15], s39 offen offset:3072 lds
v_mfma_f32_16x16x32_bf16 v[44:47], a[156:159], v[164:167], v[44:47]
v_exp_f32 v27, v27
v_mfma_f32_16x16x32_bf16 a[16:19], a[176:179], v[88:91], a[16:19]
v_cvt_pk_bf16_f32 v78, v20, v21
v_cvt_pk_bf16_f32 v79, v22, v23
v_mfma_f32_16x16x32_bf16 a[48:51], a[176:179], v[92:95], a[48:51]
v_exp_f32 v28, v28
v_mfma_f32_16x16x32_bf16 a[80:83], a[176:179], v[96:99], a[80:83]
v_cvt_pk_bf16_f32 v80, v24, v25
v_cvt_pk_bf16_f32 v81, v26, v27
v_mfma_f32_16x16x32_bf16 a[112:115], a[176:179], v[100:103], a[112:115]
v_exp_f32 v29, v29
v_mfma_f32_16x16x32_bf16 v[52:55], a[144:147], v[168:171], v[140:143]
ds_read_b64_tr_b16 a[176:177], v224 offset:0
ds_read_b64_tr_b16 a[178:179], v224 offset:4096
v_mfma_f32_16x16x32_bf16 v[52:55], a[148:151], v[172:175], v[52:55]
v_exp_f32 v30, v30
v_mfma_f32_16x16x32_bf16 v[52:55], a[152:155], v[176:179], v[52:55]
v_cvt_pk_bf16_f32 v82, v28, v29
s_waitcnt lgkmcnt(2)
v_add_f32 v104, v104, v108
v_mfma_f32_16x16x32_bf16 v[52:55], a[156:159], v[180:183], v[52:55]
s_add_u32 s39, s39, 16384
v_exp_f32 v31, v31
v_mfma_f32_16x16x32_bf16 a[20:23], a[180:183], v[88:91], a[20:23]
s_add_u32 m0, s37, 16384
v_cvt_pk_bf16_f32 v83, v30, v31
v_add_f32 v112, v112, v116
v_mfma_f32_16x16x32_bf16 a[52:55], a[180:183], v[92:95], a[52:55]
v_exp_f32 v32, v32
v_mfma_f32_16x16x32_bf16 a[84:87], a[180:183], v[96:99], a[84:87]
buffer_load_dwordx4 v228, s[8:11], s38 offen offset:0 lds
v_mfma_f32_16x16x32_bf16 a[116:119], a[180:183], v[100:103], a[116:119]
v_exp_f32 v33, v33
v_smfmac_f32_16x16x64_bf16 a[252:255], a[208:211], v[96:103], v235
ds_read_b64_tr_b16 a[180:181], v225 offset:0
ds_read_b64_tr_b16 a[182:183], v225 offset:4096
v_mfma_f32_16x16x32_bf16 v[60:63], a[144:147], v[184:187], v[144:147]
v_exp_f32 v34, v34
v_mfma_f32_16x16x32_bf16 v[60:63], a[148:151], v[188:191], v[60:63]
v_cvt_pk_bf16_f32 v84, v32, v33
v_add_f32 v105, v105, v109
v_mfma_f32_16x16x32_bf16 v[60:63], a[152:155], v[192:195], v[60:63]
v_exp_f32 v35, v35
v_mfma_f32_16x16x32_bf16 v[60:63], a[156:159], v[196:199], v[60:63]
buffer_load_dwordx4 v229, s[8:11], s38 offen offset:1024 lds
v_mfma_f32_16x16x32_bf16 a[24:27], a[184:187], v[88:91], a[24:27]
v_exp_f32 v36, v36
v_mfma_f32_16x16x32_bf16 a[56:59], a[184:187], v[92:95], a[56:59]
v_cvt_pk_bf16_f32 v85, v34, v35
v_add_f32 v113, v113, v117
v_mfma_f32_16x16x32_bf16 a[88:91], a[184:187], v[96:99], a[88:91]
v_exp_f32 v37, v37
v_mfma_f32_16x16x32_bf16 a[120:123], a[184:187], v[100:103], a[120:123]
ds_read_b64_tr_b16 a[184:185], v226 offset:0
ds_read_b64_tr_b16 a[186:187], v226 offset:4096
v_mfma_f32_16x16x32_bf16 v[68:71], a[144:147], v[200:203], v[148:151]
v_exp_f32 v38, v38
v_mfma_f32_16x16x32_bf16 v[68:71], a[148:151], v[204:207], v[68:71]
ds_read_b128 a[144:147], v216 offset:53248
ds_read_b128 a[148:151], v217 offset:53248
v_mfma_f32_16x16x32_bf16 v[68:71], a[152:155], v[208:211], v[68:71]
v_exp_f32 v39, v39
v_mfma_f32_16x16x32_bf16 v[68:71], a[156:159], v[212:215], v[68:71]
ds_read_b128 a[152:155], v218 offset:53248
ds_read_b128 a[156:159], v219 offset:53248
v_mfma_f32_16x16x32_bf16 a[28:31], a[188:191], v[88:91], a[28:31]
v_cvt_pk_bf16_f32 v86, v36, v37
v_cvt_pk_bf16_f32 v87, v38, v39
v_mfma_f32_16x16x32_bf16 a[60:63], a[188:191], v[92:95], a[60:63]
v_add_f32 v106, v106, v110
v_add_f32 v114, v114, v118
v_mfma_f32_16x16x32_bf16 a[92:95], a[188:191], v[96:99], a[92:95]
v_add_f32 v107, v107, v111
v_add_f32 v115, v115, v119
v_mfma_f32_16x16x32_bf16 a[124:127], a[188:191], v[100:103], a[124:127]
ds_read_b64_tr_b16 a[188:189], v227 offset:0
ds_read_b64_tr_b16 a[190:191], v227 offset:4096
v_mfma_f32_16x16x32_bf16 v[8:11], a[128:131], v[152:155], v[136:139]
v_exp_f32 v40, v40
v_mfma_f32_16x16x32_bf16 v[8:11], a[132:135], v[156:159], v[8:11]
v_exp_f32 v41, v41
v_mfma_f32_16x16x32_bf16 v[8:11], a[136:139], v[160:163], v[8:11]
buffer_load_dwordx4 v230, s[8:11], s38 offen offset:2048 lds
v_mfma_f32_16x16x32_bf16 v[8:11], a[140:143], v[164:167], v[8:11]
v_exp_f32 v42, v42
v_mfma_f32_16x16x32_bf16 a[0:3], a[160:163], v[72:75], a[0:3]
v_cvt_pk_bf16_f32 v88, v40, v41
v_add_f32 v104, v104, v112
v_mfma_f32_16x16x32_bf16 a[32:35], a[160:163], v[76:79], a[32:35]
v_exp_f32 v43, v43
v_mfma_f32_16x16x32_bf16 a[64:67], a[160:163], v[80:83], a[64:67]
v_cvt_pk_bf16_f32 v89, v42, v43
v_add_f32 v105, v105, v113
v_mfma_f32_16x16x32_bf16 a[96:99], a[160:163], v[84:87], a[96:99]
v_exp_f32 v44, v44
v_mfma_f32_16x16x32_bf16 v[16:19], a[128:131], v[168:171], v[140:143]
ds_read_b64_tr_b16 a[160:161], v220 offset:8192
ds_read_b64_tr_b16 a[162:163], v220 offset:12288
v_mfma_f32_16x16x32_bf16 v[16:19], a[132:135], v[172:175], v[16:19]
v_exp_f32 v45, v45
v_mfma_f32_16x16x32_bf16 v[16:19], a[136:139], v[176:179], v[16:19]
v_cvt_pk_bf16_f32 v90, v44, v45
v_add_f32 v106, v106, v114
v_mfma_f32_16x16x32_bf16 v[16:19], a[140:143], v[180:183], v[16:19]
v_exp_f32 v46, v46
v_mfma_f32_16x16x32_bf16 a[4:7], a[164:167], v[72:75], a[4:7]
v_add_f32 v107, v107, v115
v_cvt_pk_bf16_f32 v244, v104, v105
v_mfma_f32_16x16x32_bf16 a[36:39], a[164:167], v[76:79], a[36:39]
v_exp_f32 v47, v47
v_mfma_f32_16x16x32_bf16 a[68:71], a[164:167], v[80:83], a[68:71]
buffer_load_dwordx4 v231, s[8:11], s38 offen offset:3072 lds
v_mfma_f32_16x16x32_bf16 a[100:103], a[164:167], v[84:87], a[100:103]
v_exp_f32 v48, v48
v_smfmac_f32_16x16x64_bf16 a[248:251], a[208:211], v[72:79], v235
ds_read_b64_tr_b16 a[164:165], v221 offset:8192
ds_read_b64_tr_b16 a[166:167], v221 offset:12288
v_mfma_f32_16x16x32_bf16 v[24:27], a[128:131], v[184:187], v[144:147]
v_exp_f32 v49, v49
v_mfma_f32_16x16x32_bf16 v[24:27], a[132:135], v[188:191], v[24:27]
v_cvt_pk_bf16_f32 v91, v46, v47
v_cvt_pk_bf16_f32 v92, v48, v49
v_mfma_f32_16x16x32_bf16 v[24:27], a[136:139], v[192:195], v[24:27]
v_exp_f32 v50, v50
v_mfma_f32_16x16x32_bf16 v[24:27], a[140:143], v[196:199], v[24:27]
v_cvt_pk_bf16_f32 v245, v106, v107
v_lshlrev_b32 v104, 16, v244
v_mfma_f32_16x16x32_bf16 a[8:11], a[168:171], v[72:75], a[8:11]
v_exp_f32 v51, v51
v_mfma_f32_16x16x32_bf16 a[40:43], a[168:171], v[76:79], a[40:43]
v_cvt_pk_bf16_f32 v93, v50, v51
v_and_b32 v105, 0xffff0000, v244
v_mfma_f32_16x16x32_bf16 a[72:75], a[168:171], v[80:83], a[72:75]
v_exp_f32 v52, v52
v_mfma_f32_16x16x32_bf16 a[104:107], a[168:171], v[84:87], a[104:107]
ds_read_b64_tr_b16 a[168:169], v222 offset:8192
ds_read_b64_tr_b16 a[170:171], v222 offset:12288
v_mfma_f32_16x16x32_bf16 v[32:35], a[128:131], v[200:203], v[148:151]
s_add_u32 s38, s38, 16384
v_exp_f32 v53, v53
v_mfma_f32_16x16x32_bf16 v[32:35], a[132:135], v[204:207], v[32:35]
s_add_u32 m0, s37, 114688
ds_read_b128 a[128:131], v216 offset:57344
ds_read_b128 a[132:135], v217 offset:57344
v_mfma_f32_16x16x32_bf16 v[32:35], a[136:139], v[208:211], v[32:35]
v_exp_f32 v54, v54
v_mfma_f32_16x16x32_bf16 v[32:35], a[140:143], v[212:215], v[32:35]
buffer_load_dwordx4 v232, s[12:15], s39 offen offset:0 lds
v_mfma_f32_16x16x32_bf16 a[12:15], a[172:175], v[72:75], a[12:15]
v_exp_f32 v55, v55
v_mfma_f32_16x16x32_bf16 a[44:47], a[172:175], v[76:79], a[44:47]
ds_read_b128 a[136:139], v218 offset:57344
ds_read_b128 a[140:143], v219 offset:57344
v_mfma_f32_16x16x32_bf16 a[76:79], a[172:175], v[80:83], a[76:79]
v_exp_f32 v56, v56
v_mfma_f32_16x16x32_bf16 a[108:111], a[172:175], v[84:87], a[108:111]
s_waitcnt lgkmcnt(6)
v_exp_f32 v57, v57
v_mfma_f32_16x16x32_bf16 v[12:15], a[144:147], v[152:155], v[136:139]
ds_read_b64_tr_b16 a[172:173], v223 offset:8192
ds_read_b64_tr_b16 a[174:175], v223 offset:12288
v_mfma_f32_16x16x32_bf16 v[12:15], a[148:151], v[156:159], v[12:15]
v_exp_f32 v58, v58
v_mfma_f32_16x16x32_bf16 v[12:15], a[152:155], v[160:163], v[12:15]
v_cvt_pk_bf16_f32 v94, v52, v53
v_cvt_pk_bf16_f32 v95, v54, v55
v_mfma_f32_16x16x32_bf16 v[12:15], a[156:159], v[164:167], v[12:15]
v_exp_f32 v59, v59
v_mfma_f32_16x16x32_bf16 a[16:19], a[176:179], v[72:75], a[16:19]
v_cvt_pk_bf16_f32 v96, v56, v57
v_cvt_pk_bf16_f32 v97, v58, v59
v_mfma_f32_16x16x32_bf16 a[48:51], a[176:179], v[76:79], a[48:51]
v_exp_f32 v60, v60
v_mfma_f32_16x16x32_bf16 a[80:83], a[176:179], v[80:83], a[80:83]
buffer_load_dwordx4 v233, s[12:15], s39 offen offset:1024 lds
v_mfma_f32_16x16x32_bf16 a[112:115], a[176:179], v[84:87], a[112:115]
v_exp_f32 v61, v61
v_mfma_f32_16x16x32_bf16 v[20:23], a[144:147], v[168:171], v[140:143]
ds_read_b64_tr_b16 a[176:177], v224 offset:8192
ds_read_b64_tr_b16 a[178:179], v224 offset:12288
v_mfma_f32_16x16x32_bf16 v[20:23], a[148:151], v[172:175], v[20:23]
v_exp_f32 v62, v62
v_mfma_f32_16x16x32_bf16 v[20:23], a[152:155], v[176:179], v[20:23]
v_cvt_pk_bf16_f32 v98, v60, v61
v_lshlrev_b32 v106, 16, v245
v_mfma_f32_16x16x32_bf16 v[20:23], a[156:159], v[180:183], v[20:23]
v_exp_f32 v63, v63
v_mfma_f32_16x16x32_bf16 a[20:23], a[180:183], v[72:75], a[20:23]
v_cvt_pk_bf16_f32 v99, v62, v63
v_and_b32 v107, 0xffff0000, v245
v_mfma_f32_16x16x32_bf16 a[52:55], a[180:183], v[76:79], a[52:55]
v_exp_f32 v64, v64
v_mfma_f32_16x16x32_bf16 a[84:87], a[180:183], v[80:83], a[84:87]
v_mul_f32 v120, 0xbfb8aa3b, v104
v_mul_f32 v121, 0xbfb8aa3b, v105
v_mfma_f32_16x16x32_bf16 a[116:119], a[180:183], v[84:87], a[116:119]
v_exp_f32 v65, v65
v_smfmac_f32_16x16x64_bf16 a[252:255], a[208:211], v[80:87], v235
ds_read_b64_tr_b16 a[180:181], v225 offset:8192
ds_read_b64_tr_b16 a[182:183], v225 offset:12288
v_mfma_f32_16x16x32_bf16 v[28:31], a[144:147], v[184:187], v[144:147]
v_exp_f32 v66, v66
v_mfma_f32_16x16x32_bf16 v[28:31], a[148:151], v[188:191], v[28:31]
buffer_load_dwordx4 v232, s[12:15], s39 offen offset:2048 lds
v_mfma_f32_16x16x32_bf16 v[28:31], a[152:155], v[192:195], v[28:31]
v_exp_f32 v67, v67
v_mfma_f32_16x16x32_bf16 v[28:31], a[156:159], v[196:199], v[28:31]
v_cvt_pk_bf16_f32 v100, v64, v65
v_cvt_pk_bf16_f32 v101, v66, v67
v_mfma_f32_16x16x32_bf16 a[24:27], a[184:187], v[72:75], a[24:27]
v_exp_f32 v68, v68
v_mfma_f32_16x16x32_bf16 a[56:59], a[184:187], v[76:79], a[56:59]
v_mul_f32 v122, 0xbfb8aa3b, v106
v_mul_f32 v123, 0xbfb8aa3b, v107
v_mfma_f32_16x16x32_bf16 a[88:91], a[184:187], v[80:83], a[88:91]
v_exp_f32 v69, v69
v_mfma_f32_16x16x32_bf16 a[120:123], a[184:187], v[84:87], a[120:123]
ds_read_b64_tr_b16 a[184:185], v226 offset:8192
ds_read_b64_tr_b16 a[186:187], v226 offset:12288
v_mfma_f32_16x16x32_bf16 v[36:39], a[144:147], v[200:203], v[148:151]
v_exp_f32 v70, v70
v_mfma_f32_16x16x32_bf16 v[36:39], a[148:151], v[204:207], v[36:39]
ds_read_b128 a[144:147], v216 offset:61440
ds_read_b128 a[148:151], v217 offset:61440
v_mfma_f32_16x16x32_bf16 v[36:39], a[152:155], v[208:211], v[36:39]
v_exp_f32 v71, v71
v_mfma_f32_16x16x32_bf16 v[36:39], a[156:159], v[212:215], v[36:39]
ds_read_b128 a[152:155], v218 offset:61440
ds_read_b128 a[156:159], v219 offset:61440
v_mfma_f32_16x16x32_bf16 a[28:31], a[188:191], v[72:75], a[28:31]
v_cvt_pk_bf16_f32 v102, v68, v69
v_cvt_pk_bf16_f32 v103, v70, v71
v_mfma_f32_16x16x32_bf16 a[60:63], a[188:191], v[76:79], a[60:63]
v_exp_f32 v120, v120
v_mfma_f32_16x16x32_bf16 a[92:95], a[188:191], v[80:83], a[92:95]
v_exp_f32 v121, v121
v_mfma_f32_16x16x32_bf16 a[124:127], a[188:191], v[84:87], a[124:127]
s_waitcnt lgkmcnt(6)
ds_read_b64_tr_b16 a[188:189], v227 offset:8192
ds_read_b64_tr_b16 a[190:191], v227 offset:12288
v_mfma_f32_16x16x32_bf16 v[40:43], a[128:131], v[152:155], v[136:139]
v_exp_f32 v8, v8
v_mfma_f32_16x16x32_bf16 v[40:43], a[132:135], v[156:159], v[40:43]
v_exp_f32 v9, v9
v_mfma_f32_16x16x32_bf16 v[40:43], a[136:139], v[160:163], v[40:43]
buffer_load_dwordx4 v233, s[12:15], s39 offen offset:3072 lds
v_mfma_f32_16x16x32_bf16 v[40:43], a[140:143], v[164:167], v[40:43]
v_exp_f32 v10, v10
v_mfma_f32_16x16x32_bf16 a[0:3], a[160:163], v[88:91], a[0:3]
s_waitcnt vmcnt(16)
ds_read_b64_tr_b16 a[192:193], v128
v_cvt_pk_bf16_f32 v72, v8, v9
v_mfma_f32_16x16x32_bf16 a[32:35], a[160:163], v[92:95], a[32:35]
v_exp_f32 v11, v11
v_mfma_f32_16x16x32_bf16 a[64:67], a[160:163], v[96:99], a[64:67]
ds_read_b64_tr_b16 a[196:197], v129
v_cvt_pk_bf16_f32 v73, v10, v11
v_mfma_f32_16x16x32_bf16 a[96:99], a[160:163], v[100:103], a[96:99]
v_exp_f32 v12, v12
v_mfma_f32_16x16x32_bf16 v[48:51], a[128:131], v[168:171], v[140:143]
ds_read_b64_tr_b16 a[160:161], v220 offset:16384
ds_read_b64_tr_b16 a[162:163], v220 offset:20480
v_mfma_f32_16x16x32_bf16 v[48:51], a[132:135], v[172:175], v[48:51]
v_exp_f32 v13, v13
v_mfma_f32_16x16x32_bf16 v[48:51], a[136:139], v[176:179], v[48:51]
ds_read_b64_tr_b16 a[200:201], v130
v_cvt_pk_bf16_f32 v74, v12, v13
v_mfma_f32_16x16x32_bf16 v[48:51], a[140:143], v[180:183], v[48:51]
v_exp_f32 v14, v14
v_mfma_f32_16x16x32_bf16 a[4:7], a[164:167], v[88:91], a[4:7]
v_exp_f32 v122, v122
v_mfma_f32_16x16x32_bf16 a[36:39], a[164:167], v[92:95], a[36:39]
s_add_u32 s39, s39, 16384
v_exp_f32 v15, v15
v_mfma_f32_16x16x32_bf16 a[68:71], a[164:167], v[96:99], a[68:71]
s_add_u32 m0, s37, 0
ds_read_b64_tr_b16 a[204:205], v131
v_cvt_pk_bf16_f32 v75, v14, v15
v_mfma_f32_16x16x32_bf16 a[100:103], a[164:167], v[100:103], a[100:103]
v_exp_f32 v16, v16
v_smfmac_f32_16x16x64_bf16 a[248:251], a[208:211], v[88:95], v235
buffer_load_dwordx4 v228, s[8:11], s38 offen offset:0 lds
v_mfma_f32_16x16x32_bf16 v[56:59], a[128:131], v[184:187], v[144:147]
v_exp_f32 v17, v17
v_mfma_f32_16x16x32_bf16 v[56:59], a[132:135], v[188:191], v[56:59]
ds_read_b64_tr_b16 a[164:165], v221 offset:16384
ds_read_b64_tr_b16 a[166:167], v221 offset:20480
v_mfma_f32_16x16x32_bf16 v[56:59], a[136:139], v[192:195], v[56:59]
v_exp_f32 v18, v18
v_mfma_f32_16x16x32_bf16 v[56:59], a[140:143], v[196:199], v[56:59]
v_cvt_pk_bf16_f32 v76, v16, v17
v_mfma_f32_16x16x32_bf16 a[8:11], a[168:171], v[88:91], a[8:11]
v_exp_f32 v19, v19
v_mfma_f32_16x16x32_bf16 a[40:43], a[168:171], v[92:95], a[40:43]
v_cvt_pk_bf16_f32 v77, v18, v19
v_mfma_f32_16x16x32_bf16 a[72:75], a[168:171], v[96:99], a[72:75]
v_exp_f32 v20, v20
v_mfma_f32_16x16x32_bf16 a[104:107], a[168:171], v[100:103], a[104:107]
ds_read_b64_tr_b16 a[168:169], v222 offset:16384
ds_read_b64_tr_b16 a[170:171], v222 offset:20480
v_mfma_f32_16x16x32_bf16 v[64:67], a[128:131], v[200:203], v[148:151]
v_exp_f32 v21, v21
v_mfma_f32_16x16x32_bf16 v[64:67], a[132:135], v[204:207], v[64:67]
buffer_load_dwordx4 v229, s[8:11], s38 offen offset:1024 lds
v_mfma_f32_16x16x32_bf16 v[64:67], a[136:139], v[208:211], v[64:67]
v_exp_f32 v22, v22
v_mfma_f32_16x16x32_bf16 v[64:67], a[140:143], v[212:215], v[64:67]
ds_read_b128 a[128:131], v216 offset:32768
ds_read_b128 a[132:135], v217 offset:32768
v_mfma_f32_16x16x32_bf16 a[12:15], a[172:175], v[88:91], a[12:15]
v_exp_f32 v23, v23
v_mfma_f32_16x16x32_bf16 a[44:47], a[172:175], v[92:95], a[44:47]
ds_read_b128 a[136:139], v218 offset:32768
ds_read_b128 a[140:143], v219 offset:32768
v_mfma_f32_16x16x32_bf16 a[76:79], a[172:175], v[96:99], a[76:79]
v_exp_f32 v24, v24
v_mfma_f32_16x16x32_bf16 a[108:111], a[172:175], v[100:103], a[108:111]
s_waitcnt lgkmcnt(6)
v_exp_f32 v25, v25
v_mfma_f32_16x16x32_bf16 v[44:47], a[144:147], v[152:155], v[136:139]
ds_read_b64_tr_b16 a[172:173], v223 offset:16384
ds_read_b64_tr_b16 a[174:175], v223 offset:20480
v_mfma_f32_16x16x32_bf16 v[44:47], a[148:151], v[156:159], v[44:47]
v_exp_f32 v26, v26
v_mfma_f32_16x16x32_bf16 v[44:47], a[152:155], v[160:163], v[44:47]
v_cvt_pk_bf16_f32 v78, v20, v21
v_cvt_pk_bf16_f32 v79, v22, v23
v_mfma_f32_16x16x32_bf16 v[44:47], a[156:159], v[164:167], v[44:47]
v_exp_f32 v27, v27
v_mfma_f32_16x16x32_bf16 a[16:19], a[176:179], v[88:91], a[16:19]
v_cvt_pk_bf16_f32 v80, v24, v25
v_cvt_pk_bf16_f32 v81, v26, v27
v_mfma_f32_16x16x32_bf16 a[48:51], a[176:179], v[92:95], a[48:51]
v_exp_f32 v28, v28
v_mfma_f32_16x16x32_bf16 a[80:83], a[176:179], v[96:99], a[80:83]
buffer_load_dwordx4 v230, s[8:11], s38 offen offset:2048 lds
v_mfma_f32_16x16x32_bf16 a[112:115], a[176:179], v[100:103], a[112:115]
v_exp_f32 v29, v29
v_mfma_f32_16x16x32_bf16 v[52:55], a[144:147], v[168:171], v[140:143]
ds_read_b64_tr_b16 a[176:177], v224 offset:16384
ds_read_b64_tr_b16 a[178:179], v224 offset:20480
v_mfma_f32_16x16x32_bf16 v[52:55], a[148:151], v[172:175], v[52:55]
v_exp_f32 v30, v30
v_mfma_f32_16x16x32_bf16 v[52:55], a[152:155], v[176:179], v[52:55]
v_cvt_pk_bf16_f32 v82, v28, v29
v_mfma_f32_16x16x32_bf16 v[52:55], a[156:159], v[180:183], v[52:55]
v_exp_f32 v31, v31
v_mfma_f32_16x16x32_bf16 a[20:23], a[180:183], v[88:91], a[20:23]
v_cvt_pk_bf16_f32 v83, v30, v31
v_mfma_f32_16x16x32_bf16 a[52:55], a[180:183], v[92:95], a[52:55]
v_exp_f32 v32, v32
v_mfma_f32_16x16x32_bf16 a[84:87], a[180:183], v[96:99], a[84:87]
v_exp_f32 v123, v123
v_mfma_f32_16x16x32_bf16 a[116:119], a[180:183], v[100:103], a[116:119]
v_exp_f32 v33, v33
v_smfmac_f32_16x16x64_bf16 a[252:255], a[208:211], v[96:103], v235
ds_read_b64_tr_b16 a[180:181], v225 offset:16384
ds_read_b64_tr_b16 a[182:183], v225 offset:20480
v_mfma_f32_16x16x32_bf16 v[60:63], a[144:147], v[184:187], v[144:147]
v_exp_f32 v34, v34
v_mfma_f32_16x16x32_bf16 v[60:63], a[148:151], v[188:191], v[60:63]
buffer_load_dwordx4 v231, s[8:11], s38 offen offset:3072 lds
v_mfma_f32_16x16x32_bf16 v[60:63], a[152:155], v[192:195], v[60:63]
v_exp_f32 v35, v35
v_mfma_f32_16x16x32_bf16 v[60:63], a[156:159], v[196:199], v[60:63]
v_cvt_pk_bf16_f32 v84, v32, v33
v_cvt_pk_bf16_f32 v85, v34, v35
v_mfma_f32_16x16x32_bf16 a[24:27], a[184:187], v[88:91], a[24:27]
v_exp_f32 v36, v36
v_mfma_f32_16x16x32_bf16 a[56:59], a[184:187], v[92:95], a[56:59]
v_add_f32 v120, 1.0, v120
v_add_f32 v121, 1.0, v121
v_mfma_f32_16x16x32_bf16 a[88:91], a[184:187], v[96:99], a[88:91]
v_exp_f32 v37, v37
v_mfma_f32_16x16x32_bf16 a[120:123], a[184:187], v[100:103], a[120:123]
ds_read_b64_tr_b16 a[184:185], v226 offset:16384
ds_read_b64_tr_b16 a[186:187], v226 offset:20480
v_mfma_f32_16x16x32_bf16 v[68:71], a[144:147], v[200:203], v[148:151]
v_exp_f32 v38, v38
v_mfma_f32_16x16x32_bf16 v[68:71], a[148:151], v[204:207], v[68:71]
ds_read_b128 a[144:147], v216 offset:36864
ds_read_b128 a[148:151], v217 offset:36864
v_mfma_f32_16x16x32_bf16 v[68:71], a[152:155], v[208:211], v[68:71]
v_exp_f32 v39, v39
v_mfma_f32_16x16x32_bf16 v[68:71], a[156:159], v[212:215], v[68:71]
ds_read_b128 a[152:155], v218 offset:36864
ds_read_b128 a[156:159], v219 offset:36864
v_mfma_f32_16x16x32_bf16 a[28:31], a[188:191], v[88:91], a[28:31]
v_cvt_pk_bf16_f32 v86, v36, v37
v_cvt_pk_bf16_f32 v87, v38, v39
v_mfma_f32_16x16x32_bf16 a[60:63], a[188:191], v[92:95], a[60:63]
s_add_u32 s38, s38, 16384
v_add_f32 v122, 1.0, v122
v_add_f32 v123, 1.0, v123
v_mfma_f32_16x16x32_bf16 a[92:95], a[188:191], v[96:99], a[92:95]
v_rcp_f32 v120, v120
v_mfma_f32_16x16x32_bf16 a[124:127], a[188:191], v[100:103], a[124:127]
s_waitcnt lgkmcnt(6)
ds_read_b64_tr_b16 a[188:189], v227 offset:16384
ds_read_b64_tr_b16 a[190:191], v227 offset:20480
v_rcp_f32 v121, v121
v_rcp_f32 v122, v122
v_mfma_f32_16x16x32_bf16 v[8:11], a[128:131], v[152:155], v[136:139]
v_exp_f32 v40, v40
v_mfma_f32_16x16x32_bf16 v[8:11], a[132:135], v[156:159], v[8:11]
v_exp_f32 v41, v41
v_mfma_f32_16x16x32_bf16 v[8:11], a[136:139], v[160:163], v[8:11]
buffer_load_dwordx2 v[252:253], v251, s[76:79], s42 offen sc1
v_mfma_f32_16x16x32_bf16 v[8:11], a[140:143], v[164:167], v[8:11]
v_exp_f32 v42, v42
v_mfma_f32_16x16x32_bf16 a[0:3], a[160:163], v[72:75], a[0:3]
ds_read_b64_tr_b16 a[212:213], v132
v_cvt_pk_bf16_f32 v88, v40, v41
v_mfma_f32_16x16x32_bf16 a[32:35], a[160:163], v[76:79], a[32:35]
v_exp_f32 v43, v43
v_mfma_f32_16x16x32_bf16 a[64:67], a[160:163], v[80:83], a[64:67]
ds_read_b64_tr_b16 a[216:217], v133
v_cvt_pk_bf16_f32 v89, v42, v43
v_mfma_f32_16x16x32_bf16 a[96:99], a[160:163], v[84:87], a[96:99]
v_exp_f32 v44, v44
v_mfma_f32_16x16x32_bf16 v[16:19], a[128:131], v[168:171], v[140:143]
ds_read_b64_tr_b16 a[160:161], v220 offset:24576
ds_read_b64_tr_b16 a[162:163], v220 offset:28672
v_mfma_f32_16x16x32_bf16 v[16:19], a[132:135], v[172:175], v[16:19]
v_exp_f32 v45, v45
v_mfma_f32_16x16x32_bf16 v[16:19], a[136:139], v[176:179], v[16:19]
ds_read_b64_tr_b16 a[220:221], v134
v_cvt_pk_bf16_f32 v90, v44, v45
v_mfma_f32_16x16x32_bf16 v[16:19], a[140:143], v[180:183], v[16:19]
v_exp_f32 v46, v46
v_mfma_f32_16x16x32_bf16 a[4:7], a[164:167], v[72:75], a[4:7]
v_rcp_f32 v123, v123
v_mfma_f32_16x16x32_bf16 a[36:39], a[164:167], v[76:79], a[36:39]
v_exp_f32 v47, v47
v_mfma_f32_16x16x32_bf16 a[68:71], a[164:167], v[80:83], a[68:71]
v_cvt_pk_bf16_f32 v91, v46, v47
v_mul_f32 v104, v104, v120
v_mfma_f32_16x16x32_bf16 a[100:103], a[164:167], v[84:87], a[100:103]
v_exp_f32 v48, v48
v_smfmac_f32_16x16x64_bf16 a[248:251], a[208:211], v[72:79], v235
s_add_u32 s42, s42, s43
buffer_load_dword v255, v243, s[28:31], s45 offen
v_mfma_f32_16x16x32_bf16 v[24:27], a[128:131], v[184:187], v[144:147]
v_exp_f32 v49, v49
v_mfma_f32_16x16x32_bf16 v[24:27], a[132:135], v[188:191], v[24:27]
ds_read_b64_tr_b16 a[164:165], v221 offset:24576
ds_read_b64_tr_b16 a[166:167], v221 offset:28672
v_mfma_f32_16x16x32_bf16 v[24:27], a[136:139], v[192:195], v[24:27]
v_exp_f32 v50, v50
v_mfma_f32_16x16x32_bf16 v[24:27], a[140:143], v[196:199], v[24:27]
v_cvt_pk_bf16_f32 v92, v48, v49
v_mul_f32 v105, v105, v121
v_mfma_f32_16x16x32_bf16 a[8:11], a[168:171], v[72:75], a[8:11]
v_exp_f32 v51, v51
v_mfma_f32_16x16x32_bf16 a[40:43], a[168:171], v[76:79], a[40:43]
v_cvt_pk_bf16_f32 v93, v50, v51
v_mul_f32 v106, v106, v122
v_mfma_f32_16x16x32_bf16 a[72:75], a[168:171], v[80:83], a[72:75]
v_exp_f32 v52, v52
v_mfma_f32_16x16x32_bf16 a[104:107], a[168:171], v[84:87], a[104:107]
ds_read_b64_tr_b16 a[168:169], v222 offset:24576
ds_read_b64_tr_b16 a[170:171], v222 offset:28672
v_mfma_f32_16x16x32_bf16 v[32:35], a[128:131], v[200:203], v[148:151]
v_exp_f32 v53, v53
v_mfma_f32_16x16x32_bf16 v[32:35], a[132:135], v[204:207], v[32:35]
ds_read_b128 a[128:131], v216 offset:40960
ds_read_b128 a[132:135], v217 offset:40960
v_mfma_f32_16x16x32_bf16 v[32:35], a[136:139], v[208:211], v[32:35]
v_exp_f32 v54, v54
v_mfma_f32_16x16x32_bf16 v[32:35], a[140:143], v[212:215], v[32:35]
ds_read_b128 a[136:139], v218 offset:40960
ds_read_b128 a[140:143], v219 offset:40960
v_mfma_f32_16x16x32_bf16 a[12:15], a[172:175], v[72:75], a[12:15]
v_exp_f32 v55, v55
v_mfma_f32_16x16x32_bf16 a[44:47], a[172:175], v[76:79], a[44:47]
v_cvt_pk_bf16_f32 v94, v52, v53
v_cvt_pk_bf16_f32 v95, v54, v55
v_mfma_f32_16x16x32_bf16 a[76:79], a[172:175], v[80:83], a[76:79]
s_waitcnt lgkmcnt(6)
v_exp_f32 v56, v56
v_mfma_f32_16x16x32_bf16 a[108:111], a[172:175], v[84:87], a[108:111]
s_add_u32 s45, s45, 589824
v_exp_f32 v57, v57
v_mfma_f32_16x16x32_bf16 v[12:15], a[144:147], v[152:155], v[136:139]
global_load_dword v255, v242, s[72:73]
v_mfma_f32_16x16x32_bf16 v[12:15], a[148:151], v[156:159], v[12:15]
v_exp_f32 v58, v58
v_mfma_f32_16x16x32_bf16 v[12:15], a[152:155], v[160:163], v[12:15]
ds_read_b64_tr_b16 a[172:173], v223 offset:24576
ds_read_b64_tr_b16 a[174:175], v223 offset:28672
v_mfma_f32_16x16x32_bf16 v[12:15], a[156:159], v[164:167], v[12:15]
v_exp_f32 v59, v59
v_mfma_f32_16x16x32_bf16 a[16:19], a[176:179], v[72:75], a[16:19]
v_cvt_pk_bf16_f32 v96, v56, v57
v_cvt_pk_bf16_f32 v97, v58, v59
v_mfma_f32_16x16x32_bf16 a[48:51], a[176:179], v[76:79], a[48:51]
v_exp_f32 v60, v60
v_mfma_f32_16x16x32_bf16 a[80:83], a[176:179], v[80:83], a[80:83]
v_mul_f32 v107, v107, v123
v_cvt_pk_bf16_f32 v120, v104, v105
v_mfma_f32_16x16x32_bf16 a[112:115], a[176:179], v[84:87], a[112:115]
v_exp_f32 v61, v61
v_mfma_f32_16x16x32_bf16 v[20:23], a[144:147], v[168:171], v[140:143]
ds_read_b64_tr_b16 a[176:177], v224 offset:24576
ds_read_b64_tr_b16 a[178:179], v224 offset:28672
v_mfma_f32_16x16x32_bf16 v[20:23], a[148:151], v[172:175], v[20:23]
v_exp_f32 v62, v62
v_mfma_f32_16x16x32_bf16 v[20:23], a[152:155], v[176:179], v[20:23]
v_cvt_pk_bf16_f32 v98, v60, v61
v_cvt_pk_bf16_f32 v121, v106, v107
v_mfma_f32_16x16x32_bf16 v[20:23], a[156:159], v[180:183], v[20:23]
v_exp_f32 v63, v63
v_mfma_f32_16x16x32_bf16 a[20:23], a[180:183], v[72:75], a[20:23]
v_cvt_pk_bf16_f32 v99, v62, v63
v_cndmask_b32 v244, v244, v120, s[88:89]
v_mfma_f32_16x16x32_bf16 a[52:55], a[180:183], v[76:79], a[52:55]
v_exp_f32 v64, v64
v_mfma_f32_16x16x32_bf16 a[84:87], a[180:183], v[80:83], a[84:87]
buffer_load_dword v255, v0, s[24:27], s44 offen
v_mfma_f32_16x16x32_bf16 a[116:119], a[180:183], v[84:87], a[116:119]
v_exp_f32 v65, v65
v_smfmac_f32_16x16x64_bf16 a[252:255], a[208:211], v[80:87], v235
ds_read_b64_tr_b16 a[180:181], v225 offset:24576
ds_read_b64_tr_b16 a[182:183], v225 offset:28672
v_mfma_f32_16x16x32_bf16 v[28:31], a[144:147], v[184:187], v[144:147]
v_exp_f32 v66, v66
v_mfma_f32_16x16x32_bf16 v[28:31], a[148:151], v[188:191], v[28:31]
v_cvt_pk_bf16_f32 v100, v64, v65
v_cndmask_b32 v245, v245, v121, s[88:89]
v_mfma_f32_16x16x32_bf16 v[28:31], a[152:155], v[192:195], v[28:31]
v_exp_f32 v67, v67
v_mfma_f32_16x16x32_bf16 v[28:31], a[156:159], v[196:199], v[28:31]
ds_write_b64 v6, v[244:245] offset:0
v_cvt_pk_bf16_f32 v101, v66, v67
v_mfma_f32_16x16x32_bf16 a[24:27], a[184:187], v[72:75], a[24:27]
v_exp_f32 v68, v68
v_mfma_f32_16x16x32_bf16 a[56:59], a[184:187], v[76:79], a[56:59]
ds_write_b64 v6, v[244:245] offset:8192
ds_write_b64 v6, v[244:245] offset:16384
v_mfma_f32_16x16x32_bf16 a[88:91], a[184:187], v[80:83], a[88:91]
v_exp_f32 v69, v69
v_mfma_f32_16x16x32_bf16 a[120:123], a[184:187], v[84:87], a[120:123]
ds_read_b64_tr_b16 a[184:185], v226 offset:24576
ds_read_b64_tr_b16 a[186:187], v226 offset:28672
v_mfma_f32_16x16x32_bf16 v[36:39], a[144:147], v[200:203], v[148:151]
v_exp_f32 v70, v70
v_mfma_f32_16x16x32_bf16 v[36:39], a[148:151], v[204:207], v[36:39]
ds_read_b128 a[144:147], v216 offset:45056
ds_read_b128 a[148:151], v217 offset:45056
v_mfma_f32_16x16x32_bf16 v[36:39], a[152:155], v[208:211], v[36:39]
v_exp_f32 v71, v71
v_mfma_f32_16x16x32_bf16 v[36:39], a[156:159], v[212:215], v[36:39]
ds_read_b128 a[152:155], v218 offset:45056
ds_read_b128 a[156:159], v219 offset:45056
v_mfma_f32_16x16x32_bf16 a[28:31], a[188:191], v[72:75], a[28:31]
v_cvt_pk_bf16_f32 v102, v68, v69
v_cvt_pk_bf16_f32 v103, v70, v71
v_mfma_f32_16x16x32_bf16 a[60:63], a[188:191], v[76:79], a[60:63]
s_add_u32 s44, s44, 4096
ds_write_b64 v6, v[244:245] offset:24576
ds_read_b64_tr_b16 a[224:225], v135
v_mfma_f32_16x16x32_bf16 a[92:95], a[188:191], v[80:83], a[92:95]
v_mfma_f32_16x16x32_bf16 a[124:127], a[188:191], v[84:87], a[124:127]
s_waitcnt lgkmcnt(8)
ds_read_b64_tr_b16 a[188:189], v227 offset:24576
ds_read_b64_tr_b16 a[190:191], v227 offset:28672
v_mfma_f32_16x16x32_bf16 v[40:43], a[128:131], v[152:155], v[136:139]
s_lshl_b32 s90, s52, 7
v_exp_f32 v8, v8
v_mfma_f32_16x16x32_bf16 v[40:43], a[132:135], v[156:159], v[40:43]
s_add_u32 s90, s90, 0x2400000
v_exp_f32 v9, v9
v_mfma_f32_16x16x32_bf16 v[40:43], a[136:139], v[160:163], v[40:43]
s_add_u32 s47, s32, 32
v_cvt_pk_bf16_f32 v72, v8, v9
v_mfma_f32_16x16x32_bf16 v[40:43], a[140:143], v[164:167], v[40:43]
s_mul_i32 s92, s47, 74240
v_exp_f32 v10, v10
v_mfma_f32_16x16x32_bf16 a[0:3], a[160:163], v[88:91], a[0:3]
s_add_u32 s92, s92, s90
v_mfma_f32_16x16x32_bf16 a[32:35], a[160:163], v[92:95], a[32:35]
s_mul_i32 s47, s32, 593920
v_exp_f32 v11, v11
s_waitcnt vmcnt(4) lgkmcnt(0)
s_barrier
v_mfma_f32_16x16x32_bf16 a[64:67], a[160:163], v[96:99], a[64:67]
s_add_u32 s90, s90, s47
ds_read_b64 v[104:105], v5 offset:0
v_cvt_pk_bf16_f32 v73, v10, v11
v_mfma_f32_16x16x32_bf16 a[96:99], a[160:163], v[100:103], a[96:99]
s_add_u32 m0, s49, 4096
v_exp_f32 v12, v12
v_mfma_f32_16x16x32_bf16 v[48:51], a[128:131], v[168:171], v[140:143]
s_add_u32 s48, s91, 18432
buffer_load_dwordx4 v249, s[64:67], s48 offen  lds
v_mfma_f32_16x16x32_bf16 v[48:51], a[132:135], v[172:175], v[48:51]
v_exp_f32 v13, v13
v_mfma_f32_16x16x32_bf16 v[48:51], a[136:139], v[176:179], v[48:51]
ds_read_b64_tr_b16 a[160:161], v220 offset:32768
ds_read_b64_tr_b16 a[162:163], v220 offset:36864
v_mfma_f32_16x16x32_bf16 v[48:51], a[140:143], v[180:183], v[48:51]
v_exp_f32 v14, v14
v_mfma_f32_16x16x32_bf16 a[4:7], a[164:167], v[88:91], a[4:7]
s_add_u32 m0, s49, 5120
ds_read_b64 v[106:107], v5 offset:1024
v_cvt_pk_bf16_f32 v74, v12, v13
v_mfma_f32_16x16x32_bf16 a[36:39], a[164:167], v[92:95], a[36:39]
s_add_u32 s48, s91, 23040
v_exp_f32 v15, v15
v_mfma_f32_16x16x32_bf16 a[68:71], a[164:167], v[96:99], a[68:71]
buffer_load_dwordx4 v250, s[64:67], s48 offen  lds
v_mfma_f32_16x16x32_bf16 a[100:103], a[164:167], v[100:103], a[100:103]
v_exp_f32 v16, v16
v_smfmac_f32_16x16x64_bf16 a[248:251], a[208:211], v[88:95], v235
ds_read_b64_tr_b16 a[164:165], v221 offset:32768
ds_read_b64_tr_b16 a[166:167], v221 offset:36864
v_mfma_f32_16x16x32_bf16 v[56:59], a[128:131], v[184:187], v[144:147]
v_exp_f32 v17, v17
v_mfma_f32_16x16x32_bf16 v[56:59], a[132:135], v[188:191], v[56:59]
s_add_u32 m0, s49, 6144
v_cvt_pk_bf16_f32 v75, v14, v15
v_cvt_pk_bf16_f32 v76, v16, v17
v_mfma_f32_16x16x32_bf16 v[56:59], a[136:139], v[192:195], v[56:59]
s_add_u32 s48, s91, 27648
v_exp_f32 v18, v18
v_mfma_f32_16x16x32_bf16 v[56:59], a[140:143], v[196:199], v[56:59]
buffer_load_dwordx4 v249, s[64:67], s48 offen  lds
v_mfma_f32_16x16x32_bf16 a[8:11], a[168:171], v[88:91], a[8:11]
v_exp_f32 v19, v19
v_mfma_f32_16x16x32_bf16 a[40:43], a[168:171], v[92:95], a[40:43]
ds_read_b64 v[108:109], v5 offset:2048
v_cvt_pk_bf16_f32 v77, v18, v19
v_mfma_f32_16x16x32_bf16 a[72:75], a[168:171], v[96:99], a[72:75]
s_add_u32 m0, s49, 7168
v_exp_f32 v20, v20
v_mfma_f32_16x16x32_bf16 a[104:107], a[168:171], v[100:103], a[104:107]
s_add_u32 s48, s91, 32256
buffer_load_dwordx4 v250, s[64:67], s48 offen  lds
v_mfma_f32_16x16x32_bf16 v[64:67], a[128:131], v[200:203], v[148:151]
v_exp_f32 v21, v21
v_mfma_f32_16x16x32_bf16 v[64:67], a[132:135], v[204:207], v[64:67]
ds_read_b64_tr_b16 a[168:169], v222 offset:32768
ds_read_b64_tr_b16 a[170:171], v222 offset:36864
v_mfma_f32_16x16x32_bf16 v[64:67], a[136:139], v[208:211], v[64:67]
v_exp_f32 v22, v22
v_mfma_f32_16x16x32_bf16 v[64:67], a[140:143], v[212:215], v[64:67]
ds_read_b128 a[128:131], v216 offset:16384
ds_read_b128 a[132:135], v217 offset:16384
v_mfma_f32_16x16x32_bf16 a[12:15], a[172:175], v[88:91], a[12:15]
s_add_u32 m0, s37, 65536
v_exp_f32 v23, v23
v_mfma_f32_16x16x32_bf16 a[44:47], a[172:175], v[92:95], a[44:47]
buffer_load_dwordx4 v232, s[12:15], s39 offen offset:0 lds
v_mfma_f32_16x16x32_bf16 a[76:79], a[172:175], v[96:99], a[76:79]
v_exp_f32 v24, v24
v_mfma_f32_16x16x32_bf16 a[108:111], a[172:175], v[100:103], a[108:111]
v_exp_f32 v25, v25
v_mfma_f32_16x16x32_bf16 v[44:47], a[144:147], v[152:155], v[136:139]
ds_read_b128 a[136:139], v218 offset:16384
ds_read_b128 a[140:143], v219 offset:16384
v_mfma_f32_16x16x32_bf16 v[44:47], a[148:151], v[156:159], v[44:47]
v_exp_f32 v26, v26
v_mfma_f32_16x16x32_bf16 v[44:47], a[152:155], v[160:163], v[44:47]
buffer_load_dwordx4 v233, s[12:15], s39 offen offset:1024 lds
v_mfma_f32_16x16x32_bf16 v[44:47], a[156:159], v[164:167], v[44:47]
v_exp_f32 v27, v27
v_mfma_f32_16x16x32_bf16 a[16:19], a[176:179], v[88:91], a[16:19]
ds_read_b64_tr_b16 a[172:173], v223 offset:32768
ds_read_b64_tr_b16 a[174:175], v223 offset:36864
v_mfma_f32_16x16x32_bf16 a[48:51], a[176:179], v[92:95], a[48:51]
v_exp_f32 v28, v28
v_mfma_f32_16x16x32_bf16 a[80:83], a[176:179], v[96:99], a[80:83]
v_cvt_pk_bf16_f32 v78, v20, v21
v_cvt_pk_bf16_f32 v79, v22, v23
v_mfma_f32_16x16x32_bf16 a[112:115], a[176:179], v[100:103], a[112:115]
v_exp_f32 v29, v29
v_mfma_f32_16x16x32_bf16 v[52:55], a[144:147], v[168:171], v[140:143]
buffer_load_dwordx4 v232, s[12:15], s39 offen offset:2048 lds
v_mfma_f32_16x16x32_bf16 v[52:55], a[148:151], v[172:175], v[52:55]
v_exp_f32 v30, v30
v_mfma_f32_16x16x32_bf16 v[52:55], a[152:155], v[176:179], v[52:55]
ds_read_b64_tr_b16 a[176:177], v224 offset:32768
ds_read_b64_tr_b16 a[178:179], v224 offset:36864
v_mfma_f32_16x16x32_bf16 v[52:55], a[156:159], v[180:183], v[52:55]
v_exp_f32 v31, v31
v_mfma_f32_16x16x32_bf16 a[20:23], a[180:183], v[88:91], a[20:23]
v_cvt_pk_bf16_f32 v80, v24, v25
v_cvt_pk_bf16_f32 v81, v26, v27
v_mfma_f32_16x16x32_bf16 a[52:55], a[180:183], v[92:95], a[52:55]
v_exp_f32 v32, v32
v_mfma_f32_16x16x32_bf16 a[84:87], a[180:183], v[96:99], a[84:87]
buffer_load_dwordx4 v233, s[12:15], s39 offen offset:3072 lds
v_mfma_f32_16x16x32_bf16 a[116:119], a[180:183], v[100:103], a[116:119]
v_exp_f32 v33, v33
v_smfmac_f32_16x16x64_bf16 a[252:255], a[208:211], v[96:103], v235
ds_read_b64_tr_b16 a[180:181], v225 offset:32768
ds_read_b64_tr_b16 a[182:183], v225 offset:36864
v_mfma_f32_16x16x32_bf16 v[60:63], a[144:147], v[184:187], v[144:147]
v_exp_f32 v34, v34
v_mfma_f32_16x16x32_bf16 v[60:63], a[148:151], v[188:191], v[60:63]
s_add_u32 s39, s39, 16384
v_cvt_pk_bf16_f32 v82, v28, v29
v_cvt_pk_bf16_f32 v83, v30, v31
v_mfma_f32_16x16x32_bf16 v[60:63], a[152:155], v[192:195], v[60:63]
s_add_u32 m0, s37, 49152
v_exp_f32 v35, v35
v_mfma_f32_16x16x32_bf16 v[60:63], a[156:159], v[196:199], v[60:63]
buffer_load_dwordx4 v228, s[8:11], s38 offen offset:0 lds
v_mfma_f32_16x16x32_bf16 a[24:27], a[184:187], v[88:91], a[24:27]
v_exp_f32 v36, v36
v_mfma_f32_16x16x32_bf16 a[56:59], a[184:187], v[92:95], a[56:59]
v_cvt_pk_bf16_f32 v84, v32, v33
v_cvt_pk_bf16_f32 v85, v34, v35
v_mfma_f32_16x16x32_bf16 a[88:91], a[184:187], v[96:99], a[88:91]
v_exp_f32 v37, v37
v_mfma_f32_16x16x32_bf16 a[120:123], a[184:187], v[100:103], a[120:123]
buffer_load_dwordx4 v229, s[8:11], s38 offen offset:1024 lds
v_mfma_f32_16x16x32_bf16 v[68:71], a[144:147], v[200:203], v[148:151]
v_exp_f32 v38, v38
v_mfma_f32_16x16x32_bf16 v[68:71], a[148:151], v[204:207], v[68:71]
ds_read_b64_tr_b16 a[184:185], v226 offset:32768
ds_read_b64_tr_b16 a[186:187], v226 offset:36864
v_mfma_f32_16x16x32_bf16 v[68:71], a[152:155], v[208:211], v[68:71]
v_exp_f32 v39, v39
v_mfma_f32_16x16x32_bf16 v[68:71], a[156:159], v[212:215], v[68:71]
ds_read_b128 a[144:147], v216 offset:20480
ds_read_b128 a[148:151], v217 offset:20480
v_mfma_f32_16x16x32_bf16 a[28:31], a[188:191], v[88:91], a[28:31]
ds_read_b128 a[152:155], v218 offset:20480
ds_read_b128 a[156:159], v219 offset:20480
v_mfma_f32_16x16x32_bf16 a[60:63], a[188:191], v[92:95], a[60:63]
v_cvt_pk_bf16_f32 v86, v36, v37
v_cvt_pk_bf16_f32 v87, v38, v39
v_mfma_f32_16x16x32_bf16 a[92:95], a[188:191], v[96:99], a[92:95]
ds_read_b64 v[110:111], v5 offset:3072
v_and_b32 v7, 7, v1
v_mfma_f32_16x16x32_bf16 a[124:127], a[188:191], v[100:103], a[124:127]
s_waitcnt lgkmcnt(7)
ds_read_b64_tr_b16 a[188:189], v227 offset:32768
ds_read_b64_tr_b16 a[190:191], v227 offset:36864
v_mul_u32_u24 v248, 18560, v4
v_lshl_add_u32 v248, v7, 4, v248
v_mfma_f32_16x16x32_bf16 v[8:11], a[128:131], v[152:155], v[136:139]
v_exp_f32 v40, v40
v_mfma_f32_16x16x32_bf16 v[8:11], a[132:135], v[156:159], v[8:11]
v_exp_f32 v41, v41
v_mfma_f32_16x16x32_bf16 v[8:11], a[136:139], v[160:163], v[8:11]
buffer_load_dwordx4 v230, s[8:11], s38 offen offset:2048 lds
v_mfma_f32_16x16x32_bf16 v[8:11], a[140:143], v[164:167], v[8:11]
v_exp_f32 v42, v42
v_mfma_f32_16x16x32_bf16 a[0:3], a[160:163], v[72:75], a[0:3]
v_cvt_pk_bf16_f32 v88, v40, v41
s_waitcnt lgkmcnt(2)
v_lshlrev_b32 v112, 16, v104
v_mfma_f32_16x16x32_bf16 a[32:35], a[160:163], v[76:79], a[32:35]
v_exp_f32 v43, v43
v_mfma_f32_16x16x32_bf16 a[64:67], a[160:163], v[80:83], a[64:67]
v_cvt_pk_bf16_f32 v89, v42, v43
v_and_b32 v113, 0xffff0000, v104
v_mfma_f32_16x16x32_bf16 a[96:99], a[160:163], v[84:87], a[96:99]
v_exp_f32 v44, v44
v_mfma_f32_16x16x32_bf16 v[16:19], a[128:131], v[168:171], v[140:143]
ds_read_b64_tr_b16 a[160:161], v220 offset:40960
ds_read_b64_tr_b16 a[162:163], v220 offset:45056
v_mfma_f32_16x16x32_bf16 v[16:19], a[132:135], v[172:175], v[16:19]
v_exp_f32 v45, v45
v_mfma_f32_16x16x32_bf16 v[16:19], a[136:139], v[176:179], v[16:19]
v_cvt_pk_bf16_f32 v90, v44, v45
v_lshlrev_b32 v114, 16, v105
v_mfma_f32_16x16x32_bf16 v[16:19], a[140:143], v[180:183], v[16:19]
v_exp_f32 v46, v46
v_mfma_f32_16x16x32_bf16 a[4:7], a[164:167], v[72:75], a[4:7]
v_and_b32 v115, 0xffff0000, v105
v_lshlrev_b32 v116, 16, v106
v_mfma_f32_16x16x32_bf16 a[36:39], a[164:167], v[76:79], a[36:39]
v_exp_f32 v47, v47
v_mfma_f32_16x16x32_bf16 a[68:71], a[164:167], v[80:83], a[68:71]
buffer_load_dwordx4 v231, s[8:11], s38 offen offset:3072 lds
v_mfma_f32_16x16x32_bf16 a[100:103], a[164:167], v[84:87], a[100:103]
v_exp_f32 v48, v48
v_smfmac_f32_16x16x64_bf16 a[248:251], a[208:211], v[72:79], v235
ds_read_b64_tr_b16 a[164:165], v221 offset:40960
ds_read_b64_tr_b16 a[166:167], v221 offset:45056
v_mfma_f32_16x16x32_bf16 v[24:27], a[128:131], v[184:187], v[144:147]
v_exp_f32 v49, v49
v_mfma_f32_16x16x32_bf16 v[24:27], a[132:135], v[188:191], v[24:27]
v_cvt_pk_bf16_f32 v91, v46, v47
v_cvt_pk_bf16_f32 v92, v48, v49
v_mfma_f32_16x16x32_bf16 v[24:27], a[136:139], v[192:195], v[24:27]
v_exp_f32 v50, v50
v_mfma_f32_16x16x32_bf16 v[24:27], a[140:143], v[196:199], v[24:27]
v_and_b32 v117, 0xffff0000, v106
v_lshlrev_b32 v118, 16, v107
v_mfma_f32_16x16x32_bf16 a[8:11], a[168:171], v[72:75], a[8:11]
v_exp_f32 v51, v51
v_mfma_f32_16x16x32_bf16 a[40:43], a[168:171], v[76:79], a[40:43]
v_cvt_pk_bf16_f32 v93, v50, v51
v_and_b32 v119, 0xffff0000, v107
v_mfma_f32_16x16x32_bf16 a[72:75], a[168:171], v[80:83], a[72:75]
v_exp_f32 v52, v52
v_mfma_f32_16x16x32_bf16 a[104:107], a[168:171], v[84:87], a[104:107]
ds_read_b64_tr_b16 a[168:169], v222 offset:40960
ds_read_b64_tr_b16 a[170:171], v222 offset:45056
v_mfma_f32_16x16x32_bf16 v[32:35], a[128:131], v[200:203], v[148:151]
s_add_u32 s38, s38, 16384
v_exp_f32 v53, v53
v_mfma_f32_16x16x32_bf16 v[32:35], a[132:135], v[204:207], v[32:35]
s_add_u32 m0, s37, 81920
ds_read_b128 a[128:131], v216 offset:24576
ds_read_b128 a[132:135], v217 offset:24576
v_mfma_f32_16x16x32_bf16 v[32:35], a[136:139], v[208:211], v[32:35]
v_exp_f32 v54, v54
v_mfma_f32_16x16x32_bf16 v[32:35], a[140:143], v[212:215], v[32:35]
buffer_load_dwordx4 v232, s[12:15], s39 offen offset:0 lds
v_mfma_f32_16x16x32_bf16 a[12:15], a[172:175], v[72:75], a[12:15]
v_exp_f32 v55, v55
v_mfma_f32_16x16x32_bf16 a[44:47], a[172:175], v[76:79], a[44:47]
ds_read_b128 a[136:139], v218 offset:24576
ds_read_b128 a[140:143], v219 offset:24576
v_mfma_f32_16x16x32_bf16 a[76:79], a[172:175], v[80:83], a[76:79]
v_exp_f32 v56, v56
v_mfma_f32_16x16x32_bf16 a[108:111], a[172:175], v[84:87], a[108:111]
v_exp_f32 v57, v57
v_mfma_f32_16x16x32_bf16 v[12:15], a[144:147], v[152:155], v[136:139]
ds_read_b64_tr_b16 a[172:173], v223 offset:40960
ds_read_b64_tr_b16 a[174:175], v223 offset:45056
v_mfma_f32_16x16x32_bf16 v[12:15], a[148:151], v[156:159], v[12:15]
v_exp_f32 v58, v58
v_mfma_f32_16x16x32_bf16 v[12:15], a[152:155], v[160:163], v[12:15]
v_cvt_pk_bf16_f32 v94, v52, v53
v_cvt_pk_bf16_f32 v95, v54, v55
v_mfma_f32_16x16x32_bf16 v[12:15], a[156:159], v[164:167], v[12:15]
v_exp_f32 v59, v59
v_mfma_f32_16x16x32_bf16 a[16:19], a[176:179], v[72:75], a[16:19]
v_cvt_pk_bf16_f32 v96, v56, v57
v_cvt_pk_bf16_f32 v97, v58, v59
v_mfma_f32_16x16x32_bf16 a[48:51], a[176:179], v[76:79], a[48:51]
v_exp_f32 v60, v60
v_mfma_f32_16x16x32_bf16 a[80:83], a[176:179], v[80:83], a[80:83]
buffer_load_dwordx4 v233, s[12:15], s39 offen offset:1024 lds
v_mfma_f32_16x16x32_bf16 a[112:115], a[176:179], v[84:87], a[112:115]
v_exp_f32 v61, v61
v_mfma_f32_16x16x32_bf16 v[20:23], a[144:147], v[168:171], v[140:143]
ds_read_b64_tr_b16 a[176:177], v224 offset:40960
ds_read_b64_tr_b16 a[178:179], v224 offset:45056
v_mfma_f32_16x16x32_bf16 v[20:23], a[148:151], v[172:175], v[20:23]
v_exp_f32 v62, v62
v_mfma_f32_16x16x32_bf16 v[20:23], a[152:155], v[176:179], v[20:23]
v_cvt_pk_bf16_f32 v98, v60, v61
v_lshlrev_b32 v120, 16, v108
v_mfma_f32_16x16x32_bf16 v[20:23], a[156:159], v[180:183], v[20:23]
v_exp_f32 v63, v63
v_mfma_f32_16x16x32_bf16 a[20:23], a[180:183], v[72:75], a[20:23]
v_cvt_pk_bf16_f32 v99, v62, v63
v_and_b32 v121, 0xffff0000, v108
v_mfma_f32_16x16x32_bf16 a[52:55], a[180:183], v[76:79], a[52:55]
v_exp_f32 v64, v64
v_mfma_f32_16x16x32_bf16 a[84:87], a[180:183], v[80:83], a[84:87]
v_lshlrev_b32 v122, 16, v109
v_and_b32 v123, 0xffff0000, v109
v_mfma_f32_16x16x32_bf16 a[116:119], a[180:183], v[84:87], a[116:119]
v_exp_f32 v65, v65
v_smfmac_f32_16x16x64_bf16 a[252:255], a[208:211], v[80:87], v235
ds_read_b64_tr_b16 a[180:181], v225 offset:40960
ds_read_b64_tr_b16 a[182:183], v225 offset:45056
v_mfma_f32_16x16x32_bf16 v[28:31], a[144:147], v[184:187], v[144:147]
v_exp_f32 v66, v66
v_mfma_f32_16x16x32_bf16 v[28:31], a[148:151], v[188:191], v[28:31]
buffer_load_dwordx4 v232, s[12:15], s39 offen offset:2048 lds
v_mfma_f32_16x16x32_bf16 v[28:31], a[152:155], v[192:195], v[28:31]
v_exp_f32 v67, v67
v_mfma_f32_16x16x32_bf16 v[28:31], a[156:159], v[196:199], v[28:31]
v_cvt_pk_bf16_f32 v100, v64, v65
v_cvt_pk_bf16_f32 v101, v66, v67
v_mfma_f32_16x16x32_bf16 a[24:27], a[184:187], v[72:75], a[24:27]
v_exp_f32 v68, v68
v_mfma_f32_16x16x32_bf16 a[56:59], a[184:187], v[76:79], a[56:59]
v_lshlrev_b32 v124, 16, v110
v_and_b32 v125, 0xffff0000, v110
v_mfma_f32_16x16x32_bf16 a[88:91], a[184:187], v[80:83], a[88:91]
v_exp_f32 v69, v69
v_mfma_f32_16x16x32_bf16 a[120:123], a[184:187], v[84:87], a[120:123]
ds_read_b64_tr_b16 a[184:185], v226 offset:40960
ds_read_b64_tr_b16 a[186:187], v226 offset:45056
v_mfma_f32_16x16x32_bf16 v[36:39], a[144:147], v[200:203], v[148:151]
v_exp_f32 v70, v70
v_mfma_f32_16x16x32_bf16 v[36:39], a[148:151], v[204:207], v[36:39]
ds_read_b128 a[144:147], v216 offset:28672
ds_read_b128 a[148:151], v217 offset:28672
v_mfma_f32_16x16x32_bf16 v[36:39], a[152:155], v[208:211], v[36:39]
v_exp_f32 v71, v71
v_mfma_f32_16x16x32_bf16 v[36:39], a[156:159], v[212:215], v[36:39]
s_waitcnt lgkmcnt(4)
ds_read_b128 a[152:155], v218 offset:28672
ds_read_b128 a[156:159], v219 offset:28672
v_mfma_f32_16x16x32_bf16 a[28:31], a[188:191], v[72:75], a[28:31]
v_cvt_pk_bf16_f32 v102, v68, v69
v_cvt_pk_bf16_f32 v103, v70, v71
v_mfma_f32_16x16x32_bf16 a[60:63], a[188:191], v[76:79], a[60:63]
v_lshlrev_b32 v126, 16, v111
v_and_b32 v127, 0xffff0000, v111
v_mfma_f32_16x16x32_bf16 a[92:95], a[188:191], v[80:83], a[92:95]
v_mul_f32 v112, v112, v120
v_mul_f32 v113, v113, v121
v_mfma_f32_16x16x32_bf16 a[124:127], a[188:191], v[84:87], a[124:127]
ds_read_b64_tr_b16 a[188:189], v227 offset:40960
ds_read_b64_tr_b16 a[190:191], v227 offset:45056
v_mfma_f32_16x16x32_bf16 v[40:43], a[128:131], v[152:155], v[136:139]
v_exp_f32 v8, v8
v_mfma_f32_16x16x32_bf16 v[40:43], a[132:135], v[156:159], v[40:43]
v_exp_f32 v9, v9
v_mfma_f32_16x16x32_bf16 v[40:43], a[136:139], v[160:163], v[40:43]
buffer_load_dwordx4 v233, s[12:15], s39 offen offset:3072 lds
v_mfma_f32_16x16x32_bf16 v[40:43], a[140:143], v[164:167], v[40:43]
v_exp_f32 v10, v10
v_mfma_f32_16x16x32_bf16 a[0:3], a[160:163], v[88:91], a[0:3]
v_cvt_pk_bf16_f32 v72, v8, v9
v_mul_f32 v114, v114, v122
v_mfma_f32_16x16x32_bf16 a[32:35], a[160:163], v[92:95], a[32:35]
v_exp_f32 v11, v11
v_mfma_f32_16x16x32_bf16 a[64:67], a[160:163], v[96:99], a[64:67]
v_cvt_pk_bf16_f32 v73, v10, v11
v_mul_f32 v115, v115, v123
v_mfma_f32_16x16x32_bf16 a[96:99], a[160:163], v[100:103], a[96:99]
v_exp_f32 v12, v12
v_mfma_f32_16x16x32_bf16 v[48:51], a[128:131], v[168:171], v[140:143]
ds_read_b64_tr_b16 a[160:161], v220 offset:49152
ds_read_b64_tr_b16 a[162:163], v220 offset:53248
v_mfma_f32_16x16x32_bf16 v[48:51], a[132:135], v[172:175], v[48:51]
v_exp_f32 v13, v13
v_mfma_f32_16x16x32_bf16 v[48:51], a[136:139], v[176:179], v[48:51]
v_cvt_pk_bf16_f32 v74, v12, v13
v_mul_f32 v116, v116, v124
v_mfma_f32_16x16x32_bf16 v[48:51], a[140:143], v[180:183], v[48:51]
v_exp_f32 v14, v14
v_mfma_f32_16x16x32_bf16 a[4:7], a[164:167], v[88:91], a[4:7]
v_mul_f32 v117, v117, v125
v_mul_f32 v118, v118, v126
v_mfma_f32_16x16x32_bf16 a[36:39], a[164:167], v[92:95], a[36:39]
s_add_u32 s39, s39, 16384
v_exp_f32 v15, v15
v_mfma_f32_16x16x32_bf16 a[68:71], a[164:167], v[96:99], a[68:71]
s_add_u32 m0, s37, 32768
v_cvt_pk_bf16_f32 v75, v14, v15
v_mul_f32 v119, v119, v127
v_mfma_f32_16x16x32_bf16 a[100:103], a[164:167], v[100:103], a[100:103]
v_exp_f32 v16, v16
v_smfmac_f32_16x16x64_bf16 a[248:251], a[208:211], v[88:95], v235
buffer_load_dwordx4 v228, s[8:11], s38 offen offset:0 lds
v_mfma_f32_16x16x32_bf16 v[56:59], a[128:131], v[184:187], v[144:147]
v_exp_f32 v17, v17
v_mfma_f32_16x16x32_bf16 v[56:59], a[132:135], v[188:191], v[56:59]
ds_read_b64_tr_b16 a[164:165], v221 offset:49152
ds_read_b64_tr_b16 a[166:167], v221 offset:53248
v_mfma_f32_16x16x32_bf16 v[56:59], a[136:139], v[192:195], v[56:59]
v_exp_f32 v18, v18
v_mfma_f32_16x16x32_bf16 v[56:59], a[140:143], v[196:199], v[56:59]
v_cvt_pk_bf16_f32 v76, v16, v17
v_cvt_pk_bf16_f32 v244, v112, v113
v_mfma_f32_16x16x32_bf16 a[8:11], a[168:171], v[88:91], a[8:11]
v_exp_f32 v19, v19
v_mfma_f32_16x16x32_bf16 a[40:43], a[168:171], v[92:95], a[40:43]
v_cvt_pk_bf16_f32 v77, v18, v19
v_cvt_pk_bf16_f32 v245, v114, v115
v_mfma_f32_16x16x32_bf16 a[72:75], a[168:171], v[96:99], a[72:75]
v_exp_f32 v20, v20
v_mfma_f32_16x16x32_bf16 a[104:107], a[168:171], v[100:103], a[104:107]
ds_read_b64_tr_b16 a[168:169], v222 offset:49152
ds_read_b64_tr_b16 a[170:171], v222 offset:53248
v_mfma_f32_16x16x32_bf16 v[64:67], a[128:131], v[200:203], v[148:151]
v_exp_f32 v21, v21
v_mfma_f32_16x16x32_bf16 v[64:67], a[132:135], v[204:207], v[64:67]
buffer_load_dwordx4 v229, s[8:11], s38 offen offset:1024 lds
v_mfma_f32_16x16x32_bf16 v[64:67], a[136:139], v[208:211], v[64:67]
v_exp_f32 v22, v22
v_mfma_f32_16x16x32_bf16 v[64:67], a[140:143], v[212:215], v[64:67]
ds_read_b128 a[128:131], v216 offset:0
ds_read_b128 a[132:135], v217 offset:0
v_mfma_f32_16x16x32_bf16 a[12:15], a[172:175], v[88:91], a[12:15]
v_exp_f32 v23, v23
v_mfma_f32_16x16x32_bf16 a[44:47], a[172:175], v[92:95], a[44:47]
ds_read_b128 a[136:139], v218 offset:0
ds_read_b128 a[140:143], v219 offset:0
v_mfma_f32_16x16x32_bf16 a[76:79], a[172:175], v[96:99], a[76:79]
v_exp_f32 v24, v24
v_mfma_f32_16x16x32_bf16 a[108:111], a[172:175], v[100:103], a[108:111]
s_waitcnt lgkmcnt(6)
v_exp_f32 v25, v25
v_mfma_f32_16x16x32_bf16 v[44:47], a[144:147], v[152:155], v[136:139]
ds_read_b64_tr_b16 a[172:173], v223 offset:49152
ds_read_b64_tr_b16 a[174:175], v223 offset:53248
v_mfma_f32_16x16x32_bf16 v[44:47], a[148:151], v[156:159], v[44:47]
v_exp_f32 v26, v26
v_mfma_f32_16x16x32_bf16 v[44:47], a[152:155], v[160:163], v[44:47]
v_cvt_pk_bf16_f32 v78, v20, v21
v_cvt_pk_bf16_f32 v79, v22, v23
v_mfma_f32_16x16x32_bf16 v[44:47], a[156:159], v[164:167], v[44:47]
v_exp_f32 v27, v27
v_mfma_f32_16x16x32_bf16 a[16:19], a[176:179], v[88:91], a[16:19]
v_cvt_pk_bf16_f32 v80, v24, v25
v_cvt_pk_bf16_f32 v81, v26, v27
v_mfma_f32_16x16x32_bf16 a[48:51], a[176:179], v[92:95], a[48:51]
v_exp_f32 v28, v28
v_mfma_f32_16x16x32_bf16 a[80:83], a[176:179], v[96:99], a[80:83]
buffer_load_dwordx4 v230, s[8:11], s38 offen offset:2048 lds
v_mfma_f32_16x16x32_bf16 a[112:115], a[176:179], v[100:103], a[112:115]
v_exp_f32 v29, v29
v_mfma_f32_16x16x32_bf16 v[52:55], a[144:147], v[168:171], v[140:143]
ds_read_b64_tr_b16 a[176:177], v224 offset:49152
ds_read_b64_tr_b16 a[178:179], v224 offset:53248
v_mfma_f32_16x16x32_bf16 v[52:55], a[148:151], v[172:175], v[52:55]
v_exp_f32 v30, v30
v_mfma_f32_16x16x32_bf16 v[52:55], a[152:155], v[176:179], v[52:55]
v_cvt_pk_bf16_f32 v82, v28, v29
v_cvt_pk_bf16_f32 v246, v116, v117
v_mfma_f32_16x16x32_bf16 v[52:55], a[156:159], v[180:183], v[52:55]
v_exp_f32 v31, v31
v_mfma_f32_16x16x32_bf16 a[20:23], a[180:183], v[88:91], a[20:23]
v_cvt_pk_bf16_f32 v83, v30, v31
v_cvt_pk_bf16_f32 v247, v118, v119
v_mfma_f32_16x16x32_bf16 a[52:55], a[180:183], v[92:95], a[52:55]
v_exp_f32 v32, v32
v_mfma_f32_16x16x32_bf16 a[84:87], a[180:183], v[96:99], a[84:87]
s_waitcnt vmcnt(15)
ds_read_b64_tr_b16 a[194:195], v128
ds_read_b64_tr_b16 a[198:199], v129
v_mfma_f32_16x16x32_bf16 a[116:119], a[180:183], v[100:103], a[116:119]
v_exp_f32 v33, v33
v_smfmac_f32_16x16x64_bf16 a[252:255], a[208:211], v[96:103], v235
ds_read_b64_tr_b16 a[180:181], v225 offset:49152
ds_read_b64_tr_b16 a[182:183], v225 offset:53248
v_mfma_f32_16x16x32_bf16 v[60:63], a[144:147], v[184:187], v[144:147]
v_exp_f32 v34, v34
v_mfma_f32_16x16x32_bf16 v[60:63], a[148:151], v[188:191], v[60:63]
buffer_load_dwordx4 v231, s[8:11], s38 offen offset:3072 lds
v_mfma_f32_16x16x32_bf16 v[60:63], a[152:155], v[192:195], v[60:63]
v_exp_f32 v35, v35
v_mfma_f32_16x16x32_bf16 v[60:63], a[156:159], v[196:199], v[60:63]
v_cvt_pk_bf16_f32 v84, v32, v33
v_cvt_pk_bf16_f32 v85, v34, v35
v_mfma_f32_16x16x32_bf16 a[24:27], a[184:187], v[88:91], a[24:27]
v_exp_f32 v36, v36
v_mfma_f32_16x16x32_bf16 a[56:59], a[184:187], v[92:95], a[56:59]
ds_read_b64_tr_b16 a[202:203], v130
ds_read_b64_tr_b16 a[206:207], v131
v_mfma_f32_16x16x32_bf16 a[88:91], a[184:187], v[96:99], a[88:91]
v_exp_f32 v37, v37
v_mfma_f32_16x16x32_bf16 a[120:123], a[184:187], v[100:103], a[120:123]
ds_read_b64_tr_b16 a[184:185], v226 offset:49152
ds_read_b64_tr_b16 a[186:187], v226 offset:53248
v_mfma_f32_16x16x32_bf16 v[68:71], a[144:147], v[200:203], v[148:151]
v_exp_f32 v38, v38
v_mfma_f32_16x16x32_bf16 v[68:71], a[148:151], v[204:207], v[68:71]
ds_read_b128 a[144:147], v216 offset:4096
ds_read_b128 a[148:151], v217 offset:4096
v_mfma_f32_16x16x32_bf16 v[68:71], a[152:155], v[208:211], v[68:71]
v_exp_f32 v39, v39
v_mfma_f32_16x16x32_bf16 v[68:71], a[156:159], v[212:215], v[68:71]
ds_read_b128 a[152:155], v218 offset:4096
ds_read_b128 a[156:159], v219 offset:4096
v_mfma_f32_16x16x32_bf16 a[28:31], a[188:191], v[88:91], a[28:31]
v_cvt_pk_bf16_f32 v86, v36, v37
v_cvt_pk_bf16_f32 v87, v38, v39
v_mfma_f32_16x16x32_bf16 a[60:63], a[188:191], v[92:95], a[60:63]
s_add_u32 s38, s38, 16384
ds_read_b64_tr_b16 a[214:215], v132
ds_read_b64_tr_b16 a[218:219], v133
v_mfma_f32_16x16x32_bf16 a[92:95], a[188:191], v[96:99], a[92:95]
ds_read_b64_tr_b16 a[222:223], v134
ds_read_b64_tr_b16 a[226:227], v135
v_mfma_f32_16x16x32_bf16 a[124:127], a[188:191], v[100:103], a[124:127]
s_waitcnt lgkmcnt(10)
ds_read_b64_tr_b16 a[188:189], v227 offset:49152
ds_read_b64_tr_b16 a[190:191], v227 offset:53248
v_mfma_f32_16x16x32_bf16 v[8:11], a[128:131], v[152:155], v[136:139]
s_mov_b32 s40, 6
v_exp_f32 v40, v40
v_mfma_f32_16x16x32_bf16 v[8:11], a[132:135], v[156:159], v[8:11]
s_mov_b32 s74, 0x180
buffer_load_dwordx2 v[252:253], v251, s[76:79], s42 offen sc1
v_mfma_f32_16x16x32_bf16 v[8:11], a[136:139], v[160:163], v[8:11]
s_add_u32 s52, s52, 1
v_exp_f32 v41, v41
v_mfma_f32_16x16x32_bf16 v[8:11], a[140:143], v[164:167], v[8:11]
v_cvt_pk_bf16_f32 v88, v40, v41
v_mov_b32 v5, 0
v_mfma_f32_16x16x32_bf16 a[0:3], a[160:163], v[72:75], a[0:3]
s_lshl_b32 s46, s32, 2
v_exp_f32 v42, v42
v_mfma_f32_16x16x32_bf16 a[32:35], a[160:163], v[76:79], a[32:35]
s_add_u32 s46, s46, 163776
v_mov_b32 v6, s46
v_and_b32 v7, 12, v1
v_mfma_f32_16x16x32_bf16 a[64:67], a[160:163], v[80:83], a[64:67]
s_add_u32 s42, s42, s43
v_exp_f32 v43, v43
v_mfma_f32_16x16x32_bf16 a[96:99], a[160:163], v[84:87], a[96:99]
buffer_load_dword v255, v243, s[28:31], s45 offen
v_mfma_f32_16x16x32_bf16 a[228:231], a[232:235], v[244:247], 0
v_exp_f32 v44, v44
v_mfma_f32_16x16x32_bf16 v[104:107], a[192:195], v[244:247], 0
ds_read_b64_tr_b16 a[160:161], v220 offset:57344
ds_read_b64_tr_b16 a[162:163], v220 offset:61440
v_mfma_f32_16x16x32_bf16 v[108:111], a[196:199], v[244:247], 0
v_cvt_pk_bf16_f32 v89, v42, v43
v_add_u32 v7, 163776, v7
v_mfma_f32_16x16x32_bf16 v[112:115], a[200:203], v[244:247], 0
s_add_u32 s45, s45, 589824
v_exp_f32 v45, v45
v_mfma_f32_16x16x32_bf16 v[116:119], a[204:207], v[244:247], 0
global_load_dword v255, v242, s[72:73]
v_mfma_f32_16x16x32_bf16 v[16:19], a[128:131], v[168:171], v[140:143]
v_exp_f32 v46, v46
v_mfma_f32_16x16x32_bf16 v[16:19], a[132:135], v[172:175], v[16:19]
v_cvt_pk_bf16_f32 v90, v44, v45
v_mfma_f32_16x16x32_bf16 v[16:19], a[136:139], v[176:179], v[16:19]
v_exp_f32 v47, v47
v_mfma_f32_16x16x32_bf16 v[16:19], a[140:143], v[180:183], v[16:19]
v_cvt_pk_bf16_f32 v91, v46, v47
v_mfma_f32_16x16x32_bf16 a[4:7], a[164:167], v[72:75], a[4:7]
v_exp_f32 v48, v48
v_mfma_f32_16x16x32_bf16 a[36:39], a[164:167], v[76:79], a[36:39]
buffer_load_dword v255, v0, s[24:27], s44 offen
v_mfma_f32_16x16x32_bf16 a[68:71], a[164:167], v[80:83], a[68:71]
v_exp_f32 v49, v49
v_mfma_f32_16x16x32_bf16 a[100:103], a[164:167], v[84:87], a[100:103]
ds_read_b64_tr_b16 a[164:165], v221 offset:57344
ds_read_b64_tr_b16 a[166:167], v221 offset:61440
v_smfmac_f32_16x16x64_bf16 a[248:251], a[208:211], v[72:79], v235
s_waitcnt lgkmcnt(2)
v_cvt_pk_bf16_f32 v92, v48, v49
v_mfma_f32_16x16x32_bf16 v[120:123], a[212:215], v[244:247], 0
s_add_u32 s44, s44, 4096
v_exp_f32 v50, v50
v_mfma_f32_16x16x32_bf16 v[124:127], a[216:219], v[244:247], 0
buffer_store_dwordx4 a[228:231], v248, s[20:23], s92 offen sc0 sc1
v_mfma_f32_16x16x32_bf16 v[128:131], a[220:223], v[244:247], 0
v_exp_f32 v51, v51
v_mfma_f32_16x16x32_bf16 v[132:135], a[224:227], v[244:247], 0
v_cvt_pk_bf16_f32 v93, v50, v51
v_mfma_f32_16x16x32_bf16 v[24:27], a[128:131], v[184:187], v[144:147]
v_exp_f32 v52, v52
v_mfma_f32_16x16x32_bf16 v[24:27], a[132:135], v[188:191], v[24:27]
v_mfma_f32_16x16x32_bf16 v[24:27], a[136:139], v[192:195], v[24:27]
s_add_u32 s48, s90, 0
v_exp_f32 v53, v53
v_mfma_f32_16x16x32_bf16 v[24:27], a[140:143], v[196:199], v[24:27]
buffer_store_dwordx4 v[104:107], v248, s[20:23], s48 offen sc0 sc1
v_mfma_f32_16x16x32_bf16 a[8:11], a[168:171], v[72:75], a[8:11]
v_cvt_pk_bf16_f32 v94, v52, v53
v_mfma_f32_16x16x32_bf16 a[40:43], a[168:171], v[76:79], a[40:43]
v_exp_f32 v54, v54
v_mfma_f32_16x16x32_bf16 a[72:75], a[168:171], v[80:83], a[72:75]
v_mfma_f32_16x16x32_bf16 a[104:107], a[168:171], v[84:87], a[104:107]
s_add_u32 s48, s90, 74240
v_exp_f32 v55, v55
v_mfma_f32_16x16x32_bf16 v[32:35], a[128:131], v[200:203], v[148:151]
buffer_store_dwordx4 v[108:111], v248, s[20:23], s48 offen sc0 sc1
v_mfma_f32_16x16x32_bf16 v[32:35], a[132:135], v[204:207], v[32:35]
v_exp_f32 v56, v56
v_mfma_f32_16x16x32_bf16 v[32:35], a[136:139], v[208:211], v[32:35]
ds_read_b64_tr_b16 a[168:169], v222 offset:57344
ds_read_b64_tr_b16 a[170:171], v222 offset:61440
v_mfma_f32_16x16x32_bf16 v[32:35], a[140:143], v[212:215], v[32:35]
v_exp_f32 v57, v57
v_mfma_f32_16x16x32_bf16 a[12:15], a[172:175], v[72:75], a[12:15]
ds_read_b128 a[128:131], v216 offset:8192
ds_read_b128 a[132:135], v217 offset:8192
v_mfma_f32_16x16x32_bf16 a[44:47], a[172:175], v[76:79], a[44:47]
s_add_u32 s48, s90, 148480
v_exp_f32 v58, v58
v_mfma_f32_16x16x32_bf16 a[76:79], a[172:175], v[80:83], a[76:79]
buffer_store_dwordx4 v[112:115], v248, s[20:23], s48 offen sc0 sc1
v_mfma_f32_16x16x32_bf16 a[108:111], a[172:175], v[84:87], a[108:111]
ds_read_b128 a[136:139], v218 offset:8192
ds_read_b128 a[140:143], v219 offset:8192
v_mfma_f32_16x16x32_bf16 v[12:15], a[144:147], v[152:155], v[136:139]
v_exp_f32 v59, v59
v_mfma_f32_16x16x32_bf16 v[12:15], a[148:151], v[156:159], v[12:15]
ds_read_b64_tr_b16 a[172:173], v223 offset:57344
ds_read_b64_tr_b16 a[174:175], v223 offset:61440
v_mfma_f32_16x16x32_bf16 v[12:15], a[152:155], v[160:163], v[12:15]
s_add_u32 s48, s90, 222720
v_exp_f32 v60, v60
v_mfma_f32_16x16x32_bf16 v[12:15], a[156:159], v[164:167], v[12:15]
buffer_store_dwordx4 v[116:119], v248, s[20:23], s48 offen sc0 sc1
v_mfma_f32_16x16x32_bf16 a[16:19], a[176:179], v[72:75], a[16:19]
v_exp_f32 v61, v61
v_mfma_f32_16x16x32_bf16 a[48:51], a[176:179], v[76:79], a[48:51]
v_cvt_pk_bf16_f32 v95, v54, v55
v_cvt_pk_bf16_f32 v96, v56, v57
v_mfma_f32_16x16x32_bf16 a[80:83], a[176:179], v[80:83], a[80:83]
v_exp_f32 v62, v62
v_mfma_f32_16x16x32_bf16 a[112:115], a[176:179], v[84:87], a[112:115]
ds_read_b64_tr_b16 a[176:177], v224 offset:57344
ds_read_b64_tr_b16 a[178:179], v224 offset:61440
v_mfma_f32_16x16x32_bf16 v[20:23], a[144:147], v[168:171], v[140:143]
s_add_u32 s48, s90, 296960
buffer_store_dwordx4 v[120:123], v248, s[20:23], s48 offen sc0 sc1
v_mfma_f32_16x16x32_bf16 v[20:23], a[148:151], v[172:175], v[20:23]
v_exp_f32 v63, v63
v_mfma_f32_16x16x32_bf16 v[20:23], a[152:155], v[176:179], v[20:23]
v_cvt_pk_bf16_f32 v97, v58, v59
v_cvt_pk_bf16_f32 v98, v60, v61
v_mfma_f32_16x16x32_bf16 v[20:23], a[156:159], v[180:183], v[20:23]
v_exp_f32 v64, v64
v_mfma_f32_16x16x32_bf16 a[20:23], a[180:183], v[72:75], a[20:23]
ds_write_b32 v6, v5
v_cvt_pk_bf16_f32 v99, v62, v63
v_mfma_f32_16x16x32_bf16 a[52:55], a[180:183], v[76:79], a[52:55]
s_add_u32 s48, s90, 371200
v_exp_f32 v65, v65
v_mfma_f32_16x16x32_bf16 a[84:87], a[180:183], v[80:83], a[84:87]
buffer_store_dwordx4 v[124:127], v248, s[20:23], s48 offen sc0 sc1
v_mfma_f32_16x16x32_bf16 a[116:119], a[180:183], v[84:87], a[116:119]
v_exp_f32 v66, v66
v_smfmac_f32_16x16x64_bf16 a[252:255], a[208:211], v[80:87], v235
ds_read_b64_tr_b16 a[180:181], v225 offset:57344
ds_read_b64_tr_b16 a[182:183], v225 offset:61440
v_mfma_f32_16x16x32_bf16 v[28:31], a[144:147], v[184:187], v[144:147]
v_exp_f32 v67, v67
v_mfma_f32_16x16x32_bf16 v[28:31], a[148:151], v[188:191], v[28:31]
v_cvt_pk_bf16_f32 v100, v64, v65
v_cvt_pk_bf16_f32 v101, v66, v67
v_mfma_f32_16x16x32_bf16 v[28:31], a[152:155], v[192:195], v[28:31]
s_add_u32 s48, s90, 445440
buffer_store_dwordx4 v[128:131], v248, s[20:23], s48 offen sc0 sc1
v_mfma_f32_16x16x32_bf16 v[28:31], a[156:159], v[196:199], v[28:31]
v_exp_f32 v68, v68
v_mfma_f32_16x16x32_bf16 a[24:27], a[184:187], v[72:75], a[24:27]
v_mfma_f32_16x16x32_bf16 a[56:59], a[184:187], v[76:79], a[56:59]
v_exp_f32 v69, v69
v_mfma_f32_16x16x32_bf16 a[88:91], a[184:187], v[80:83], a[88:91]
v_cvt_pk_bf16_f32 v102, v68, v69
v_mfma_f32_16x16x32_bf16 a[120:123], a[184:187], v[84:87], a[120:123]
s_add_u32 s48, s90, 519680
v_exp_f32 v70, v70
v_mfma_f32_16x16x32_bf16 v[36:39], a[144:147], v[200:203], v[148:151]
buffer_store_dwordx4 v[132:135], v248, s[20:23], s48 offen sc0 sc1
v_mfma_f32_16x16x32_bf16 v[36:39], a[148:151], v[204:207], v[36:39]
v_exp_f32 v71, v71
v_mfma_f32_16x16x32_bf16 v[36:39], a[152:155], v[208:211], v[36:39]
ds_read_b64_tr_b16 a[184:185], v226 offset:57344
ds_read_b64_tr_b16 a[186:187], v226 offset:61440
v_mfma_f32_16x16x32_bf16 v[36:39], a[156:159], v[212:215], v[36:39]
ds_read_b128 a[144:147], v216 offset:12288
ds_read_b128 a[148:151], v217 offset:12288
v_mfma_f32_16x16x32_bf16 a[28:31], a[188:191], v[72:75], a[28:31]
ds_read_b128 a[152:155], v218 offset:12288
ds_read_b128 a[156:159], v219 offset:12288
v_mfma_f32_16x16x32_bf16 a[60:63], a[188:191], v[76:79], a[60:63]
v_cvt_pk_bf16_f32 v103, v70, v71
v_mfma_f32_16x16x32_bf16 a[92:95], a[188:191], v[80:83], a[92:95]
v_mfma_f32_16x16x32_bf16 a[124:127], a[188:191], v[84:87], a[124:127]
s_waitcnt lgkmcnt(6)
ds_read_b64_tr_b16 a[188:189], v227 offset:57344
ds_read_b64_tr_b16 a[190:191], v227 offset:61440
v_mfma_f32_16x16x32_bf16 v[40:43], a[128:131], v[152:155], v[136:139]
v_exp_f32 v8, v8
v_mfma_f32_16x16x32_bf16 v[40:43], a[132:135], v[156:159], v[40:43]
v_exp_f32 v9, v9
v_mfma_f32_16x16x32_bf16 v[40:43], a[136:139], v[160:163], v[40:43]
v_cvt_pk_bf16_f32 v72, v8, v9
v_mfma_f32_16x16x32_bf16 v[40:43], a[140:143], v[164:167], v[40:43]
v_exp_f32 v10, v10
v_mfma_f32_16x16x32_bf16 a[0:3], a[160:163], v[88:91], a[0:3]
v_mfma_f32_16x16x32_bf16 a[32:35], a[160:163], v[92:95], a[32:35]
v_exp_f32 v11, v11
s_waitcnt vmcnt(13) lgkmcnt(0)
s_barrier
v_mfma_f32_16x16x32_bf16 a[64:67], a[160:163], v[96:99], a[64:67]
v_cvt_pk_bf16_f32 v73, v10, v11
v_mfma_f32_16x16x32_bf16 a[96:99], a[160:163], v[100:103], a[96:99]
s_add_u32 m0, s37, 98304
v_exp_f32 v12, v12
v_mfma_f32_16x16x32_bf16 v[48:51], a[128:131], v[168:171], v[140:143]
buffer_load_dwordx4 v232, s[12:15], s39 offen offset:0 lds
v_mfma_f32_16x16x32_bf16 v[48:51], a[132:135], v[172:175], v[48:51]
v_exp_f32 v13, v13
v_mfma_f32_16x16x32_bf16 v[48:51], a[136:139], v[176:179], v[48:51]
ds_read_b64_tr_b16 a[160:161], v220 offset:0
ds_read_b64_tr_b16 a[162:163], v220 offset:4096
v_mfma_f32_16x16x32_bf16 v[48:51], a[140:143], v[180:183], v[48:51]
v_exp_f32 v14, v14
v_mfma_f32_16x16x32_bf16 a[4:7], a[164:167], v[88:91], a[4:7]
v_cvt_pk_bf16_f32 v74, v12, v13
v_mfma_f32_16x16x32_bf16 a[36:39], a[164:167], v[92:95], a[36:39]
v_exp_f32 v15, v15
v_mfma_f32_16x16x32_bf16 a[68:71], a[164:167], v[96:99], a[68:71]
v_cvt_pk_bf16_f32 v75, v14, v15
v_mfma_f32_16x16x32_bf16 a[100:103], a[164:167], v[100:103], a[100:103]
v_exp_f32 v16, v16
v_smfmac_f32_16x16x64_bf16 a[248:251], a[208:211], v[88:95], v235
buffer_load_dwordx4 v233, s[12:15], s39 offen offset:1024 lds
v_mfma_f32_16x16x32_bf16 v[56:59], a[128:131], v[184:187], v[144:147]
v_exp_f32 v17, v17
v_mfma_f32_16x16x32_bf16 v[56:59], a[132:135], v[188:191], v[56:59]
ds_read_b64_tr_b16 a[164:165], v221 offset:0
ds_read_b64_tr_b16 a[166:167], v221 offset:4096
v_mfma_f32_16x16x32_bf16 v[56:59], a[136:139], v[192:195], v[56:59]
v_exp_f32 v18, v18
v_mfma_f32_16x16x32_bf16 v[56:59], a[140:143], v[196:199], v[56:59]
v_cvt_pk_bf16_f32 v76, v16, v17
v_mfma_f32_16x16x32_bf16 a[8:11], a[168:171], v[88:91], a[8:11]
v_exp_f32 v19, v19
v_mfma_f32_16x16x32_bf16 a[40:43], a[168:171], v[92:95], a[40:43]
v_cvt_pk_bf16_f32 v77, v18, v19
v_mfma_f32_16x16x32_bf16 a[72:75], a[168:171], v[96:99], a[72:75]
v_exp_f32 v20, v20
v_mfma_f32_16x16x32_bf16 a[104:107], a[168:171], v[100:103], a[104:107]
ds_read_b64_tr_b16 a[168:169], v222 offset:0
ds_read_b64_tr_b16 a[170:171], v222 offset:4096
v_mfma_f32_16x16x32_bf16 v[64:67], a[128:131], v[200:203], v[148:151]
v_exp_f32 v21, v21
v_mfma_f32_16x16x32_bf16 v[64:67], a[132:135], v[204:207], v[64:67]
buffer_load_dwordx4 v232, s[12:15], s39 offen offset:2048 lds
v_mfma_f32_16x16x32_bf16 v[64:67], a[136:139], v[208:211], v[64:67]
v_exp_f32 v22, v22
v_mfma_f32_16x16x32_bf16 v[64:67], a[140:143], v[212:215], v[64:67]
ds_read_b128 a[128:131], v216 offset:49152
ds_read_b128 a[132:135], v217 offset:49152
v_mfma_f32_16x16x32_bf16 a[12:15], a[172:175], v[88:91], a[12:15]
v_exp_f32 v23, v23
v_mfma_f32_16x16x32_bf16 a[44:47], a[172:175], v[92:95], a[44:47]
ds_read_b128 a[136:139], v218 offset:49152
ds_read_b128 a[140:143], v219 offset:49152
v_mfma_f32_16x16x32_bf16 a[76:79], a[172:175], v[96:99], a[76:79]
v_exp_f32 v24, v24
v_mfma_f32_16x16x32_bf16 a[108:111], a[172:175], v[100:103], a[108:111]
v_exp_f32 v25, v25
v_mfma_f32_16x16x32_bf16 v[44:47], a[144:147], v[152:155], v[136:139]
ds_read_b64_tr_b16 a[172:173], v223 offset:0
ds_read_b64_tr_b16 a[174:175], v223 offset:4096
v_mfma_f32_16x16x32_bf16 v[44:47], a[148:151], v[156:159], v[44:47]
v_exp_f32 v26, v26
v_mfma_f32_16x16x32_bf16 v[44:47], a[152:155], v[160:163], v[44:47]
buffer_load_dwordx4 v233, s[12:15], s39 offen offset:3072 lds
v_mfma_f32_16x16x32_bf16 v[44:47], a[156:159], v[164:167], v[44:47]
v_exp_f32 v27, v27
v_mfma_f32_16x16x32_bf16 a[16:19], a[176:179], v[88:91], a[16:19]
v_cvt_pk_bf16_f32 v78, v20, v21
v_cvt_pk_bf16_f32 v79, v22, v23
v_mfma_f32_16x16x32_bf16 a[48:51], a[176:179], v[92:95], a[48:51]
v_exp_f32 v28, v28
v_mfma_f32_16x16x32_bf16 a[80:83], a[176:179], v[96:99], a[80:83]
v_cvt_pk_bf16_f32 v80, v24, v25
v_cvt_pk_bf16_f32 v81, v26, v27
v_mfma_f32_16x16x32_bf16 a[112:115], a[176:179], v[100:103], a[112:115]
v_exp_f32 v29, v29
v_mfma_f32_16x16x32_bf16 v[52:55], a[144:147], v[168:171], v[140:143]
ds_read_b64_tr_b16 a[176:177], v224 offset:0
ds_read_b64_tr_b16 a[178:179], v224 offset:4096
v_mfma_f32_16x16x32_bf16 v[52:55], a[148:151], v[172:175], v[52:55]
v_exp_f32 v30, v30
v_mfma_f32_16x16x32_bf16 v[52:55], a[152:155], v[176:179], v[52:55]
v_cvt_pk_bf16_f32 v82, v28, v29
v_mfma_f32_16x16x32_bf16 v[52:55], a[156:159], v[180:183], v[52:55]
s_add_u32 s39, s39, 16384
v_exp_f32 v31, v31
v_mfma_f32_16x16x32_bf16 a[20:23], a[180:183], v[88:91], a[20:23]
s_add_u32 m0, s37, 16384
v_cvt_pk_bf16_f32 v83, v30, v31
v_mfma_f32_16x16x32_bf16 a[52:55], a[180:183], v[92:95], a[52:55]
v_exp_f32 v32, v32
v_mfma_f32_16x16x32_bf16 a[84:87], a[180:183], v[96:99], a[84:87]
buffer_load_dwordx4 v228, s[8:11], s38 offen offset:0 lds
v_mfma_f32_16x16x32_bf16 a[116:119], a[180:183], v[100:103], a[116:119]
v_exp_f32 v33, v33
v_smfmac_f32_16x16x64_bf16 a[252:255], a[208:211], v[96:103], v235
ds_read_b64_tr_b16 a[180:181], v225 offset:0
ds_read_b64_tr_b16 a[182:183], v225 offset:4096
v_mfma_f32_16x16x32_bf16 v[60:63], a[144:147], v[184:187], v[144:147]
v_exp_f32 v34, v34
v_mfma_f32_16x16x32_bf16 v[60:63], a[148:151], v[188:191], v[60:63]
v_cvt_pk_bf16_f32 v84, v32, v33
v_mfma_f32_16x16x32_bf16 v[60:63], a[152:155], v[192:195], v[60:63]
v_exp_f32 v35, v35
v_mfma_f32_16x16x32_bf16 v[60:63], a[156:159], v[196:199], v[60:63]
buffer_load_dwordx4 v229, s[8:11], s38 offen offset:1024 lds
v_mfma_f32_16x16x32_bf16 a[24:27], a[184:187], v[88:91], a[24:27]
v_exp_f32 v36, v36
v_mfma_f32_16x16x32_bf16 a[56:59], a[184:187], v[92:95], a[56:59]
v_cvt_pk_bf16_f32 v85, v34, v35
v_mfma_f32_16x16x32_bf16 a[88:91], a[184:187], v[96:99], a[88:91]
v_exp_f32 v37, v37
v_mfma_f32_16x16x32_bf16 a[120:123], a[184:187], v[100:103], a[120:123]
ds_read_b64_tr_b16 a[184:185], v226 offset:0
ds_read_b64_tr_b16 a[186:187], v226 offset:4096
v_mfma_f32_16x16x32_bf16 v[68:71], a[144:147], v[200:203], v[148:151]
v_exp_f32 v38, v38
v_mfma_f32_16x16x32_bf16 v[68:71], a[148:151], v[204:207], v[68:71]
ds_read_b128 a[144:147], v216 offset:53248
ds_read_b128 a[148:151], v217 offset:53248
v_mfma_f32_16x16x32_bf16 v[68:71], a[152:155], v[208:211], v[68:71]
v_exp_f32 v39, v39
v_mfma_f32_16x16x32_bf16 v[68:71], a[156:159], v[212:215], v[68:71]
ds_read_b128 a[152:155], v218 offset:53248
ds_read_b128 a[156:159], v219 offset:53248
v_mfma_f32_16x16x32_bf16 a[28:31], a[188:191], v[88:91], a[28:31]
v_cvt_pk_bf16_f32 v86, v36, v37
v_cvt_pk_bf16_f32 v87, v38, v39
v_mfma_f32_16x16x32_bf16 a[60:63], a[188:191], v[92:95], a[60:63]
v_mfma_f32_16x16x32_bf16 a[92:95], a[188:191], v[96:99], a[92:95]
v_mfma_f32_16x16x32_bf16 a[124:127], a[188:191], v[100:103], a[124:127]
s_waitcnt lgkmcnt(6)
ds_read_b64_tr_b16 a[188:189], v227 offset:0
ds_read_b64_tr_b16 a[190:191], v227 offset:4096
s_waitcnt lgkmcnt(8)
s_branch K_B5
K_PUB:
s_mov_b32 s78, 0x4000
v_lshlrev_b32 v251, 7, v3
s_mov_b32 s42, 0x2000
s_mov_b32 s43, 0
s_cmp_lg_u32 s32, 0
s_cbranch_scc1 K_B4
v_mov_b32 v244, 1
s_and_b32 s46, s52, 15
s_lshl_b32 s46, s46, 7
s_add_u32 s46, s46, 0x272000
s_mov_b64 exec, 1
buffer_atomic_add v244, v234, s[20:23], s46 offen sc1
s_mov_b64 exec, -1
s_branch K_B4
K_RANK:
s_mov_b32 s46, 2
K_RANK1:
v_cmp_lt_u32 vcc, s92, v255
s_bcnt1_i32_b64 s48, vcc
s_cmp_lt_u32 s48, 8
s_cbranch_scc0 K_RANK2
v_mov_b32 v246, 0
v_cmp_lt_u32 vcc, s92, v104
v_addc_co_u32 v246, vcc, 0, v246, vcc
v_cmp_lt_u32 vcc, s92, v105
v_addc_co_u32 v246, vcc, 0, v246, vcc
v_cmp_lt_u32 vcc, s92, v106
v_addc_co_u32 v246, vcc, 0, v246, vcc
v_cmp_lt_u32 vcc, s92, v107
v_addc_co_u32 v246, vcc, 0, v246, vcc
v_cmp_lt_u32 vcc, s92, v108
v_addc_co_u32 v246, vcc, 0, v246, vcc
v_cmp_lt_u32 vcc, s92, v109
v_addc_co_u32 v246, vcc, 0, v246, vcc
v_cmp_lt_u32 vcc, s92, v110
v_addc_co_u32 v246, vcc, 0, v246, vcc
v_cmp_lt_u32 vcc, s92, v111
v_addc_co_u32 v246, vcc, 0, v246, vcc
v_cmp_lt_u32 vcc, s92, v112
v_addc_co_u32 v246, vcc, 0, v246, vcc
v_cmp_lt_u32 vcc, s92, v113
v_addc_co_u32 v246, vcc, 0, v246, vcc
v_cmp_lt_u32 vcc, s92, v114
v_addc_co_u32 v246, vcc, 0, v246, vcc
v_cmp_lt_u32 vcc, s92, v115
v_addc_co_u32 v246, vcc, 0, v246, vcc
v_cmp_lt_u32 vcc, s92, v116
v_addc_co_u32 v246, vcc, 0, v246, vcc
v_cmp_lt_u32 vcc, s92, v117
v_addc_co_u32 v246, vcc, 0, v246, vcc
v_cmp_lt_u32 vcc, s92, v118
v_addc_co_u32 v246, vcc, 0, v246, vcc
v_cmp_lt_u32 vcc, s92, v119
v_addc_co_u32 v246, vcc, 0, v246, vcc
v_cmp_lt_u32 vcc, s92, v120
v_addc_co_u32 v246, vcc, 0, v246, vcc
v_cmp_lt_u32 vcc, s92, v121
v_addc_co_u32 v246, vcc, 0, v246, vcc
v_cmp_lt_u32 vcc, s92, v122
v_addc_co_u32 v246, vcc, 0, v246, vcc
v_cmp_lt_u32 vcc, s92, v123
v_addc_co_u32 v246, vcc, 0, v246, vcc
v_cmp_lt_u32 vcc, s92, v124
v_addc_co_u32 v246, vcc, 0, v246, vcc
v_cmp_lt_u32 vcc, s92, v125
v_addc_co_u32 v246, vcc, 0, v246, vcc
v_cmp_lt_u32 vcc, s92, v126
v_addc_co_u32 v246, vcc, 0, v246, vcc
v_cmp_lt_u32 vcc, s92, v127
v_addc_co_u32 v246, vcc, 0, v246, vcc
v_cmp_lt_u32 vcc, s92, v128
v_addc_co_u32 v246, vcc, 0, v246, vcc
v_cmp_lt_u32 vcc, s92, v129
v_addc_co_u32 v246, vcc, 0, v246, vcc
v_cmp_lt_u32 vcc, s92, v130
v_addc_co_u32 v246, vcc, 0, v246, vcc
v_cmp_lt_u32 vcc, s92, v131
v_addc_co_u32 v246, vcc, 0, v246, vcc
v_cmp_lt_u32 vcc, s92, v132
v_addc_co_u32 v246, vcc, 0, v246, vcc
v_cmp_lt_u32 vcc, s92, v133
v_addc_co_u32 v246, vcc, 0, v246, vcc
v_cmp_lt_u32 vcc, s92, v134
v_addc_co_u32 v246, vcc, 0, v246, vcc
v_cmp_lt_u32 vcc, s92, v135
v_addc_co_u32 v246, vcc, 0, v246, vcc
s_mov_b32 s48, 0
v_cmp_lt_u32 vcc, 0, v246
s_bcnt1_i32_b64 s47, vcc
s_add_u32 s48, s48, s47
v_cmp_lt_u32 vcc, 1, v246
s_bcnt1_i32_b64 s47, vcc
s_add_u32 s48, s48, s47
v_cmp_lt_u32 vcc, 2, v246
s_bcnt1_i32_b64 s47, vcc
s_add_u32 s48, s48, s47
v_cmp_lt_u32 vcc, 3, v246
s_bcnt1_i32_b64 s47, vcc
s_add_u32 s48, s48, s47
v_cmp_lt_u32 vcc, 4, v246
s_bcnt1_i32_b64 s47, vcc
s_add_u32 s48, s48, s47
v_cmp_lt_u32 vcc, 5, v246
s_bcnt1_i32_b64 s47, vcc
s_add_u32 s48, s48, s47
v_cmp_lt_u32 vcc, 6, v246
s_bcnt1_i32_b64 s47, vcc
s_add_u32 s48, s48, s47
v_cmp_lt_u32 vcc, 7, v246
s_bcnt1_i32_b64 s47, vcc
s_add_u32 s48, s48, s47
s_cmp_lt_u32 s48, 8
s_cbranch_scc0 K_RANK2
s_and_b32 s47, s92, 0xffff
s_sub_u32 s47, 2048, s47
s_ashr_i32 s94, s92, 31
s_not_b32 s94, s94
s_or_b32 s94, s94, 0x80000000
s_xor_b32 s94, s94, s92
s_and_b32 s94, s94, 0xffff0000
v_mov_b32 v247, s94
v_mul_f32 v247, 0xbfb8aa3b, v247
v_exp_f32 v247, v247
s_nop 0
v_add_f32 v247, 1.0, v247
v_rcp_f32 v247, v247
s_nop 0
v_cvt_pk_bf16_f32 v247, v247, v247
v_lshlrev_b32 v247, 16, v247
v_or_b32 v247, 1, v247
v_mov_b32 v246, s47
s_lshl_b32 s48, s48, 3
s_add_u32 s48, s48, 0x270000
s_mov_b64 exec, 1
buffer_store_dword v246, v234, s[20:23], s48 offen offset:4 sc0 sc1
buffer_store_dword v247, v234, s[20:23], s48 offen offset:68 sc0 sc1
s_mov_b64 exec, -1
K_RANK2:
s_mov_b32 s92, s93
s_sub_u32 s46, s46, 1
s_cmp_lg_u32 s46, 0
s_cbranch_scc1 K_RANK1
s_branch K_RANKED
K_XP0:
s_cmp_eq_u32 s83, 0
s_cbranch_scc1 K_XM0
ds_read_b64 a[244:245], v156 offset:0
s_branch K_XP0D
K_XM0:
ds_read_b64 a[236:237], v152 offset:0
ds_read_b64 a[238:239], v153 offset:0
ds_read_b64 a[240:241], v154 offset:0
ds_read_b64 a[242:243], v155 offset:0
s_branch K_XP0D
K_XP1:
v_add_u32 v160, 0x10000, v152
v_add_u32 v161, 0x10000, v153
v_add_u32 v162, 0x10000, v154
v_add_u32 v163, 0x10000, v155
v_add_u32 v164, 0x10000, v156
s_cmp_eq_u32 s83, 1
s_cbranch_scc1 K_XM1
ds_read_b64 a[244:245], v164 offset:32768
s_branch K_XP1D
K_XM1:
ds_read_b64 a[236:237], v160 offset:32768
ds_read_b64 a[238:239], v161 offset:32768
ds_read_b64 a[240:241], v162 offset:32768
ds_read_b64 a[242:243], v163 offset:32768
s_branch K_XP1D
K_XP2:
s_cmp_eq_u32 s83, 2
s_cbranch_scc1 K_XM2
ds_read_b64 a[244:245], v156 offset:49152
s_branch K_XP2D
K_XM2:
ds_read_b64 a[236:237], v152 offset:49152
ds_read_b64 a[238:239], v153 offset:49152
ds_read_b64 a[240:241], v154 offset:49152
ds_read_b64 a[242:243], v155 offset:49152
s_branch K_XP2D
K_XP3:
s_cmp_eq_u32 s83, 3
s_cbranch_scc1 K_XM3
ds_read_b64 a[244:245], v156 offset:0
s_branch K_XP3D
K_XM3:
ds_read_b64 a[236:237], v152 offset:0
ds_read_b64 a[238:239], v153 offset:0
ds_read_b64 a[240:241], v154 offset:0
ds_read_b64 a[242:243], v155 offset:0
s_branch K_XP3D
K_XP4:
v_add_u32 v160, 0x10000, v152
v_add_u32 v161, 0x10000, v153
v_add_u32 v162, 0x10000, v154
v_add_u32 v163, 0x10000, v155
v_add_u32 v164, 0x10000, v156
s_cmp_eq_u32 s83, 4
s_cbranch_scc1 K_XM4
ds_read_b64 a[244:245], v164 offset:32768
s_branch K_XP4D
K_XM4:
ds_read_b64 a[236:237], v160 offset:32768
ds_read_b64 a[238:239], v161 offset:32768
ds_read_b64 a[240:241], v162 offset:32768
ds_read_b64 a[242:243], v163 offset:32768
s_branch K_XP4D
K_XP5:
s_cmp_eq_u32 s83, 5
s_cbranch_scc1 K_XM5
ds_read_b64 a[244:245], v156 offset:49152
s_branch K_XP5D
K_XM5:
ds_read_b64 a[236:237], v152 offset:49152
ds_read_b64 a[238:239], v153 offset:49152
ds_read_b64 a[240:241], v154 offset:49152
ds_read_b64 a[242:243], v155 offset:49152
s_branch K_XP5D
K_XP6:
s_cmp_eq_u32 s83, 6
s_cbranch_scc1 K_XM6
ds_read_b64 a[244:245], v156 offset:0
s_branch K_XP6D
K_XM6:
ds_read_b64 a[236:237], v152 offset:0
ds_read_b64 a[238:239], v153 offset:0
ds_read_b64 a[240:241], v154 offset:0
ds_read_b64 a[242:243], v155 offset:0
s_branch K_XP6D
K_XP7:
v_add_u32 v160, 0x10000, v152
v_add_u32 v161, 0x10000, v153
v_add_u32 v162, 0x10000, v154
v_add_u32 v163, 0x10000, v155
v_add_u32 v164, 0x10000, v156
s_cmp_eq_u32 s83, 7
s_cbranch_scc1 K_XM7
ds_read_b64 a[244:245], v164 offset:32768
s_branch K_XP7D
K_XM7:
ds_read_b64 a[236:237], v160 offset:32768
ds_read_b64 a[238:239], v161 offset:32768
ds_read_b64 a[240:241], v162 offset:32768
ds_read_b64 a[242:243], v163 offset:32768
s_branch K_XP7D
K_XP8:
s_cmp_eq_u32 s83, 8
s_cbranch_scc1 K_XM8
ds_read_b64 a[244:245], v156 offset:49152
s_branch K_XP8D
K_XM8:
ds_read_b64 a[236:237], v152 offset:49152
ds_read_b64 a[238:239], v153 offset:49152
ds_read_b64 a[240:241], v154 offset:49152
ds_read_b64 a[242:243], v155 offset:49152
s_branch K_XP8D
K_CODE_END:
K_FB:
s_mov_b32 s41, 1
s_waitcnt vmcnt(0) lgkmcnt(0)
s_barrier
v_mov_b32 v136, 0xff800000
v_mov_b32 v140, 0xff800000
v_mov_b32 v144, 0xff800000
v_mov_b32 v148, 0xff800000
s_mov_b32 s38, 0
s_mov_b32 s40, 32
K_FBLOOP:
s_add_u32 m0, s37, 0
s_nop 0
buffer_load_dwordx4 v228, s[8:11], s38 offen offset:0 lds
buffer_load_dwordx4 v229, s[8:11], s38 offen offset:1024 lds
buffer_load_dwordx4 v230, s[8:11], s38 offen offset:2048 lds
buffer_load_dwordx4 v231, s[8:11], s38 offen offset:3072 lds
s_add_u32 s38, s38, 16384
s_waitcnt vmcnt(0)
s_barrier
ds_read_b128 a[128:131], v216 offset:0
ds_read_b128 a[132:135], v217 offset:0
ds_read_b128 a[136:139], v218 offset:0
ds_read_b128 a[140:143], v219 offset:0
ds_read_b128 a[144:147], v216 offset:4096
ds_read_b128 a[148:151], v217 offset:4096
ds_read_b128 a[152:155], v218 offset:4096
ds_read_b128 a[156:159], v219 offset:4096
s_waitcnt lgkmcnt(0)
v_mfma_f32_16x16x32_bf16 v[8:11], a[128:131], v[152:155], 0
v_mfma_f32_16x16x32_bf16 v[8:11], a[132:135], v[156:159], v[8:11]
v_mfma_f32_16x16x32_bf16 v[8:11], a[136:139], v[160:163], v[8:11]
v_mfma_f32_16x16x32_bf16 v[8:11], a[140:143], v[164:167], v[8:11]
v_mfma_f32_16x16x32_bf16 v[12:15], a[144:147], v[152:155], 0
v_mfma_f32_16x16x32_bf16 v[12:15], a[148:151], v[156:159], v[12:15]
v_mfma_f32_16x16x32_bf16 v[12:15], a[152:155], v[160:163], v[12:15]
v_mfma_f32_16x16x32_bf16 v[12:15], a[156:159], v[164:167], v[12:15]
v_mfma_f32_16x16x32_bf16 v[16:19], a[128:131], v[168:171], 0
v_mfma_f32_16x16x32_bf16 v[16:19], a[132:135], v[172:175], v[16:19]
v_mfma_f32_16x16x32_bf16 v[16:19], a[136:139], v[176:179], v[16:19]
v_mfma_f32_16x16x32_bf16 v[16:19], a[140:143], v[180:183], v[16:19]
v_mfma_f32_16x16x32_bf16 v[20:23], a[144:147], v[168:171], 0
v_mfma_f32_16x16x32_bf16 v[20:23], a[148:151], v[172:175], v[20:23]
v_mfma_f32_16x16x32_bf16 v[20:23], a[152:155], v[176:179], v[20:23]
v_mfma_f32_16x16x32_bf16 v[20:23], a[156:159], v[180:183], v[20:23]
v_mfma_f32_16x16x32_bf16 v[24:27], a[128:131], v[184:187], 0
v_mfma_f32_16x16x32_bf16 v[24:27], a[132:135], v[188:191], v[24:27]
v_mfma_f32_16x16x32_bf16 v[24:27], a[136:139], v[192:195], v[24:27]
v_mfma_f32_16x16x32_bf16 v[24:27], a[140:143], v[196:199], v[24:27]
v_mfma_f32_16x16x32_bf16 v[28:31], a[144:147], v[184:187], 0
v_mfma_f32_16x16x32_bf16 v[28:31], a[148:151], v[188:191], v[28:31]
v_mfma_f32_16x16x32_bf16 v[28:31], a[152:155], v[192:195], v[28:31]
v_mfma_f32_16x16x32_bf16 v[28:31], a[156:159], v[196:199], v[28:31]
v_mfma_f32_16x16x32_bf16 v[32:35], a[128:131], v[200:203], 0
v_mfma_f32_16x16x32_bf16 v[32:35], a[132:135], v[204:207], v[32:35]
v_mfma_f32_16x16x32_bf16 v[32:35], a[136:139], v[208:211], v[32:35]
v_mfma_f32_16x16x32_bf16 v[32:35], a[140:143], v[212:215], v[32:35]
v_mfma_f32_16x16x32_bf16 v[36:39], a[144:147], v[200:203], 0
v_mfma_f32_16x16x32_bf16 v[36:39], a[148:151], v[204:207], v[36:39]
v_mfma_f32_16x16x32_bf16 v[36:39], a[152:155], v[208:211], v[36:39]
v_mfma_f32_16x16x32_bf16 v[36:39], a[156:159], v[212:215], v[36:39]
s_nop 7
v_max3_f32 v136, v136, v8, v9
v_max3_f32 v136, v136, v10, v11
v_max3_f32 v136, v136, v12, v13
v_max3_f32 v136, v136, v14, v15
v_max3_f32 v140, v140, v16, v17
v_max3_f32 v140, v140, v18, v19
v_max3_f32 v140, v140, v20, v21
v_max3_f32 v140, v140, v22, v23
v_max3_f32 v144, v144, v24, v25
v_max3_f32 v144, v144, v26, v27
v_max3_f32 v144, v144, v28, v29
v_max3_f32 v144, v144, v30, v31
v_max3_f32 v148, v148, v32, v33
v_max3_f32 v148, v148, v34, v35
v_max3_f32 v148, v148, v36, v37
v_max3_f32 v148, v148, v38, v39
ds_read_b128 a[128:131], v216 offset:8192
ds_read_b128 a[132:135], v217 offset:8192
ds_read_b128 a[136:139], v218 offset:8192
ds_read_b128 a[140:143], v219 offset:8192
ds_read_b128 a[144:147], v216 offset:12288
ds_read_b128 a[148:151], v217 offset:12288
ds_read_b128 a[152:155], v218 offset:12288
ds_read_b128 a[156:159], v219 offset:12288
s_waitcnt lgkmcnt(0)
v_mfma_f32_16x16x32_bf16 v[8:11], a[128:131], v[152:155], 0
v_mfma_f32_16x16x32_bf16 v[8:11], a[132:135], v[156:159], v[8:11]
v_mfma_f32_16x16x32_bf16 v[8:11], a[136:139], v[160:163], v[8:11]
v_mfma_f32_16x16x32_bf16 v[8:11], a[140:143], v[164:167], v[8:11]
v_mfma_f32_16x16x32_bf16 v[12:15], a[144:147], v[152:155], 0
v_mfma_f32_16x16x32_bf16 v[12:15], a[148:151], v[156:159], v[12:15]
v_mfma_f32_16x16x32_bf16 v[12:15], a[152:155], v[160:163], v[12:15]
v_mfma_f32_16x16x32_bf16 v[12:15], a[156:159], v[164:167], v[12:15]
v_mfma_f32_16x16x32_bf16 v[16:19], a[128:131], v[168:171], 0
v_mfma_f32_16x16x32_bf16 v[16:19], a[132:135], v[172:175], v[16:19]
v_mfma_f32_16x16x32_bf16 v[16:19], a[136:139], v[176:179], v[16:19]
v_mfma_f32_16x16x32_bf16 v[16:19], a[140:143], v[180:183], v[16:19]
v_mfma_f32_16x16x32_bf16 v[20:23], a[144:147], v[168:171], 0
v_mfma_f32_16x16x32_bf16 v[20:23], a[148:151], v[172:175], v[20:23]
v_mfma_f32_16x16x32_bf16 v[20:23], a[152:155], v[176:179], v[20:23]
v_mfma_f32_16x16x32_bf16 v[20:23], a[156:159], v[180:183], v[20:23]
v_mfma_f32_16x16x32_bf16 v[24:27], a[128:131], v[184:187], 0
v_mfma_f32_16x16x32_bf16 v[24:27], a[132:135], v[188:191], v[24:27]
v_mfma_f32_16x16x32_bf16 v[24:27], a[136:139], v[192:195], v[24:27]
v_mfma_f32_16x16x32_bf16 v[24:27], a[140:143], v[196:199], v[24:27]
v_mfma_f32_16x16x32_bf16 v[28:31], a[144:147], v[184:187], 0
v_mfma_f32_16x16x32_bf16 v[28:31], a[148:151], v[188:191], v[28:31]
v_mfma_f32_16x16x32_bf16 v[28:31], a[152:155], v[192:195], v[28:31]
v_mfma_f32_16x16x32_bf16 v[28:31], a[156:159], v[196:199], v[28:31]
v_mfma_f32_16x16x32_bf16 v[32:35], a[128:131], v[200:203], 0
v_mfma_f32_16x16x32_bf16 v[32:35], a[132:135], v[204:207], v[32:35]
v_mfma_f32_16x16x32_bf16 v[32:35], a[136:139], v[208:211], v[32:35]
v_mfma_f32_16x16x32_bf16 v[32:35], a[140:143], v[212:215], v[32:35]
v_mfma_f32_16x16x32_bf16 v[36:39], a[144:147], v[200:203], 0
v_mfma_f32_16x16x32_bf16 v[36:39], a[148:151], v[204:207], v[36:39]
v_mfma_f32_16x16x32_bf16 v[36:39], a[152:155], v[208:211], v[36:39]
v_mfma_f32_16x16x32_bf16 v[36:39], a[156:159], v[212:215], v[36:39]
s_nop 7
v_max3_f32 v136, v136, v8, v9
v_max3_f32 v136, v136, v10, v11
v_max3_f32 v136, v136, v12, v13
v_max3_f32 v136, v136, v14, v15
v_max3_f32 v140, v140, v16, v17
v_max3_f32 v140, v140, v18, v19
v_max3_f32 v140, v140, v20, v21
v_max3_f32 v140, v140, v22, v23
v_max3_f32 v144, v144, v24, v25
v_max3_f32 v144, v144, v26, v27
v_max3_f32 v144, v144, v28, v29
v_max3_f32 v144, v144, v30, v31
v_max3_f32 v148, v148, v32, v33
v_max3_f32 v148, v148, v34, v35
v_max3_f32 v148, v148, v36, v37
v_max3_f32 v148, v148, v38, v39
s_barrier
s_sub_u32 s40, s40, 1
s_cmp_lg_u32 s40, 0
s_cbranch_scc1 K_FBLOOP
v_mov_b32 v137, v136
s_nop 1
v_permlane16_swap_b32 v136, v137
v_max_f32 v136, v136, v137
v_mov_b32 v137, v136
s_nop 1
v_permlane32_swap_b32 v136, v137
v_max_f32 v136, v136, v137
v_sub_f32 v139, 0, v136
v_sub_f32 v138, 0, v136
v_sub_f32 v137, 0, v136
v_sub_f32 v136, 0, v136
v_mov_b32 v141, v140
s_nop 1
v_permlane16_swap_b32 v140, v141
v_max_f32 v140, v140, v141
v_mov_b32 v141, v140
s_nop 1
v_permlane32_swap_b32 v140, v141
v_max_f32 v140, v140, v141
v_sub_f32 v143, 0, v140
v_sub_f32 v142, 0, v140
v_sub_f32 v141, 0, v140
v_sub_f32 v140, 0, v140
v_mov_b32 v145, v144
s_nop 1
v_permlane16_swap_b32 v144, v145
v_max_f32 v144, v144, v145
v_mov_b32 v145, v144
s_nop 1
v_permlane32_swap_b32 v144, v145
v_max_f32 v144, v144, v145
v_sub_f32 v147, 0, v144
v_sub_f32 v146, 0, v144
v_sub_f32 v145, 0, v144
v_sub_f32 v144, 0, v144
v_mov_b32 v149, v148
s_nop 1
v_permlane16_swap_b32 v148, v149
v_max_f32 v148, v148, v149
v_mov_b32 v149, v148
s_nop 1
v_permlane32_swap_b32 v148, v149
v_max_f32 v148, v148, v149
v_sub_f32 v151, 0, v148
v_sub_f32 v150, 0, v148
v_sub_f32 v149, 0, v148
v_sub_f32 v148, 0, v148
s_mov_b32 s38, 0
s_add_u32 m0, s37, 32768
s_nop 0
buffer_load_dwordx4 v228, s[8:11], s38 offen offset:0 lds
buffer_load_dwordx4 v229, s[8:11], s38 offen offset:1024 lds
buffer_load_dwordx4 v230, s[8:11], s38 offen offset:2048 lds
buffer_load_dwordx4 v231, s[8:11], s38 offen offset:3072 lds
s_add_u32 s38, s38, 16384
s_add_u32 m0, s37, 16384
s_nop 0
buffer_load_dwordx4 v228, s[8:11], s38 offen offset:0 lds
buffer_load_dwordx4 v229, s[8:11], s38 offen offset:1024 lds
buffer_load_dwordx4 v230, s[8:11], s38 offen offset:2048 lds
buffer_load_dwordx4 v231, s[8:11], s38 offen offset:3072 lds
s_add_u32 s38, s38, 16384
s_add_u32 m0, s37, 0
s_nop 0
buffer_load_dwordx4 v228, s[8:11], s38 offen offset:0 lds
buffer_load_dwordx4 v229, s[8:11], s38 offen offset:1024 lds
buffer_load_dwordx4 v230, s[8:11], s38 offen offset:2048 lds
buffer_load_dwordx4 v231, s[8:11], s38 offen offset:3072 lds
s_add_u32 s38, s38, 16384
s_mov_b32 s39, 0
s_add_u32 m0, s37, 98304
s_nop 0
buffer_load_dwordx4 v232, s[12:15], s39 offen offset:0 lds
buffer_load_dwordx4 v233, s[12:15], s39 offen offset:1024 lds
buffer_load_dwordx4 v232, s[12:15], s39 offen offset:2048 lds
buffer_load_dwordx4 v233, s[12:15], s39 offen offset:3072 lds
s_add_u32 s39, s39, 16384
s_add_u32 m0, s37, 114688
s_nop 0
buffer_load_dwordx4 v232, s[12:15], s39 offen offset:0 lds
buffer_load_dwordx4 v233, s[12:15], s39 offen offset:1024 lds
buffer_load_dwordx4 v232, s[12:15], s39 offen offset:2048 lds
buffer_load_dwordx4 v233, s[12:15], s39 offen offset:3072 lds
s_add_u32 s39, s39, 16384
s_mov_b32 s78, 0
s_mov_b32 s42, 0
s_mov_b32 s43, 0
s_mov_b32 s44, 0x100000
s_mov_b32 s74, 0x100
s_mov_b32 s40, 0
v_accvgpr_write_b32 a0, 0
v_accvgpr_write_b32 a1, 0
v_accvgpr_write_b32 a2, 0
v_accvgpr_write_b32 a3, 0
v_accvgpr_write_b32 a4, 0
v_accvgpr_write_b32 a5, 0
v_accvgpr_write_b32 a6, 0
v_accvgpr_write_b32 a7, 0
v_accvgpr_write_b32 a8, 0
v_accvgpr_write_b32 a9, 0
v_accvgpr_write_b32 a10, 0
v_accvgpr_write_b32 a11, 0
v_accvgpr_write_b32 a12, 0
v_accvgpr_write_b32 a13, 0
v_accvgpr_write_b32 a14, 0
v_accvgpr_write_b32 a15, 0
v_accvgpr_write_b32 a16, 0
v_accvgpr_write_b32 a17, 0
v_accvgpr_write_b32 a18, 0
v_accvgpr_write_b32 a19, 0
v_accvgpr_write_b32 a20, 0
v_accvgpr_write_b32 a21, 0
v_accvgpr_write_b32 a22, 0
v_accvgpr_write_b32 a23, 0
v_accvgpr_write_b32 a24, 0
v_accvgpr_write_b32 a25, 0
v_accvgpr_write_b32 a26, 0
v_accvgpr_write_b32 a27, 0
v_accvgpr_write_b32 a28, 0
v_accvgpr_write_b32 a29, 0
v_accvgpr_write_b32 a30, 0
v_accvgpr_write_b32 a31, 0
v_accvgpr_write_b32 a32, 0
v_accvgpr_write_b32 a33, 0
v_accvgpr_write_b32 a34, 0
v_accvgpr_write_b32 a35, 0
v_accvgpr_write_b32 a36, 0
v_accvgpr_write_b32 a37, 0
v_accvgpr_write_b32 a38, 0
v_accvgpr_write_b32 a39, 0
v_accvgpr_write_b32 a40, 0
v_accvgpr_write_b32 a41, 0
v_accvgpr_write_b32 a42, 0
v_accvgpr_write_b32 a43, 0
v_accvgpr_write_b32 a44, 0
v_accvgpr_write_b32 a45, 0
v_accvgpr_write_b32 a46, 0
v_accvgpr_write_b32 a47, 0
v_accvgpr_write_b32 a48, 0
v_accvgpr_write_b32 a49, 0
v_accvgpr_write_b32 a50, 0
v_accvgpr_write_b32 a51, 0
v_accvgpr_write_b32 a52, 0
v_accvgpr_write_b32 a53, 0
v_accvgpr_write_b32 a54, 0
v_accvgpr_write_b32 a55, 0
v_accvgpr_write_b32 a56, 0
v_accvgpr_write_b32 a57, 0
v_accvgpr_write_b32 a58, 0
v_accvgpr_write_b32 a59, 0
v_accvgpr_write_b32 a60, 0
v_accvgpr_write_b32 a61, 0
v_accvgpr_write_b32 a62, 0
v_accvgpr_write_b32 a63, 0
v_accvgpr_write_b32 a64, 0
v_accvgpr_write_b32 a65, 0
v_accvgpr_write_b32 a66, 0
v_accvgpr_write_b32 a67, 0
v_accvgpr_write_b32 a68, 0
v_accvgpr_write_b32 a69, 0
v_accvgpr_write_b32 a70, 0
v_accvgpr_write_b32 a71, 0
v_accvgpr_write_b32 a72, 0
v_accvgpr_write_b32 a73, 0
v_accvgpr_write_b32 a74, 0
v_accvgpr_write_b32 a75, 0
v_accvgpr_write_b32 a76, 0
v_accvgpr_write_b32 a77, 0
v_accvgpr_write_b32 a78, 0
v_accvgpr_write_b32 a79, 0
v_accvgpr_write_b32 a80, 0
v_accvgpr_write_b32 a81, 0
v_accvgpr_write_b32 a82, 0
v_accvgpr_write_b32 a83, 0
v_accvgpr_write_b32 a84, 0
v_accvgpr_write_b32 a85, 0
v_accvgpr_write_b32 a86, 0
v_accvgpr_write_b32 a87, 0
v_accvgpr_write_b32 a88, 0
v_accvgpr_write_b32 a89, 0
v_accvgpr_write_b32 a90, 0
v_accvgpr_write_b32 a91, 0
v_accvgpr_write_b32 a92, 0
v_accvgpr_write_b32 a93, 0
v_accvgpr_write_b32 a94, 0
v_accvgpr_write_b32 a95, 0
v_accvgpr_write_b32 a96, 0
v_accvgpr_write_b32 a97, 0
v_accvgpr_write_b32 a98, 0
v_accvgpr_write_b32 a99, 0
v_accvgpr_write_b32 a100, 0
v_accvgpr_write_b32 a101, 0
v_accvgpr_write_b32 a102, 0
v_accvgpr_write_b32 a103, 0
v_accvgpr_write_b32 a104, 0
v_accvgpr_write_b32 a105, 0
v_accvgpr_write_b32 a106, 0
v_accvgpr_write_b32 a107, 0
v_accvgpr_write_b32 a108, 0
v_accvgpr_write_b32 a109, 0
v_accvgpr_write_b32 a110, 0
v_accvgpr_write_b32 a111, 0
v_accvgpr_write_b32 a112, 0
v_accvgpr_write_b32 a113, 0
v_accvgpr_write_b32 a114, 0
v_accvgpr_write_b32 a115, 0
v_accvgpr_write_b32 a116, 0
v_accvgpr_write_b32 a117, 0
v_accvgpr_write_b32 a118, 0
v_accvgpr_write_b32 a119, 0
v_accvgpr_write_b32 a120, 0
v_accvgpr_write_b32 a121, 0
v_accvgpr_write_b32 a122, 0
v_accvgpr_write_b32 a123, 0
v_accvgpr_write_b32 a124, 0
v_accvgpr_write_b32 a125, 0
v_accvgpr_write_b32 a126, 0
v_accvgpr_write_b32 a127, 0
v_accvgpr_write_b32 a248, 0
v_accvgpr_write_b32 a249, 0
v_accvgpr_write_b32 a250, 0
v_accvgpr_write_b32 a251, 0
v_accvgpr_write_b32 a252, 0
v_accvgpr_write_b32 a253, 0
v_accvgpr_write_b32 a254, 0
v_accvgpr_write_b32 a255, 0
s_waitcnt vmcnt(0)
s_barrier
ds_read_b128 a[128:131], v216 offset:32768
ds_read_b128 a[132:135], v217 offset:32768
ds_read_b128 a[136:139], v218 offset:32768
ds_read_b128 a[140:143], v219 offset:32768
ds_read_b128 a[144:147], v216 offset:36864
ds_read_b128 a[148:151], v217 offset:36864
ds_read_b128 a[152:155], v218 offset:36864
ds_read_b128 a[156:159], v219 offset:36864
s_waitcnt lgkmcnt(0)
v_mfma_f32_16x16x32_bf16 v[8:11], a[128:131], v[152:155], 0
v_mfma_f32_16x16x32_bf16 v[8:11], a[132:135], v[156:159], v[8:11]
v_mfma_f32_16x16x32_bf16 v[8:11], a[136:139], v[160:163], v[8:11]
v_mfma_f32_16x16x32_bf16 v[8:11], a[140:143], v[164:167], v[8:11]
v_mfma_f32_16x16x32_bf16 v[12:15], a[144:147], v[152:155], 0
v_mfma_f32_16x16x32_bf16 v[12:15], a[148:151], v[156:159], v[12:15]
v_mfma_f32_16x16x32_bf16 v[12:15], a[152:155], v[160:163], v[12:15]
v_mfma_f32_16x16x32_bf16 v[12:15], a[156:159], v[164:167], v[12:15]
v_mfma_f32_16x16x32_bf16 v[16:19], a[128:131], v[168:171], 0
v_mfma_f32_16x16x32_bf16 v[16:19], a[132:135], v[172:175], v[16:19]
v_mfma_f32_16x16x32_bf16 v[16:19], a[136:139], v[176:179], v[16:19]
v_mfma_f32_16x16x32_bf16 v[16:19], a[140:143], v[180:183], v[16:19]
v_mfma_f32_16x16x32_bf16 v[20:23], a[144:147], v[168:171], 0
v_mfma_f32_16x16x32_bf16 v[20:23], a[148:151], v[172:175], v[20:23]
v_mfma_f32_16x16x32_bf16 v[20:23], a[152:155], v[176:179], v[20:23]
v_mfma_f32_16x16x32_bf16 v[20:23], a[156:159], v[180:183], v[20:23]
v_mfma_f32_16x16x32_bf16 v[24:27], a[128:131], v[184:187], 0
v_mfma_f32_16x16x32_bf16 v[24:27], a[132:135], v[188:191], v[24:27]
v_mfma_f32_16x16x32_bf16 v[24:27], a[136:139], v[192:195], v[24:27]
v_mfma_f32_16x16x32_bf16 v[24:27], a[140:143], v[196:199], v[24:27]
v_mfma_f32_16x16x32_bf16 v[28:31], a[144:147], v[184:187], 0
v_mfma_f32_16x16x32_bf16 v[28:31], a[148:151], v[188:191], v[28:31]
v_mfma_f32_16x16x32_bf16 v[28:31], a[152:155], v[192:195], v[28:31]
v_mfma_f32_16x16x32_bf16 v[28:31], a[156:159], v[196:199], v[28:31]
v_mfma_f32_16x16x32_bf16 v[32:35], a[128:131], v[200:203], 0
v_mfma_f32_16x16x32_bf16 v[32:35], a[132:135], v[204:207], v[32:35]
v_mfma_f32_16x16x32_bf16 v[32:35], a[136:139], v[208:211], v[32:35]
v_mfma_f32_16x16x32_bf16 v[32:35], a[140:143], v[212:215], v[32:35]
v_mfma_f32_16x16x32_bf16 v[36:39], a[144:147], v[200:203], 0
v_mfma_f32_16x16x32_bf16 v[36:39], a[148:151], v[204:207], v[36:39]
v_mfma_f32_16x16x32_bf16 v[36:39], a[152:155], v[208:211], v[36:39]
v_mfma_f32_16x16x32_bf16 v[36:39], a[156:159], v[212:215], v[36:39]
ds_read_b128 a[128:131], v216 offset:40960
ds_read_b128 a[132:135], v217 offset:40960
ds_read_b128 a[136:139], v218 offset:40960
ds_read_b128 a[140:143], v219 offset:40960
ds_read_b128 a[144:147], v216 offset:45056
ds_read_b128 a[148:151], v217 offset:45056
ds_read_b128 a[152:155], v218 offset:45056
ds_read_b128 a[156:159], v219 offset:45056
s_waitcnt lgkmcnt(0)
s_branch K_HAVEMAX
.section .rodata,"a"
.p2align 6
.amdhsa_kernel recurrent_scan__gqa_block_cached__moe_arch_mod__prompt_kernel
  .amdhsa_next_free_vgpr 512
  .amdhsa_next_free_sgpr 102
  .amdhsa_accum_offset 256
  .amdhsa_group_segment_fixed_size 0
  .amdhsa_kernarg_size 104
  .amdhsa_user_sgpr_count 2
  .amdhsa_user_sgpr_kernarg_segment_ptr 1
  .amdhsa_system_sgpr_workgroup_id_x 1
  .amdhsa_float_denorm_mode_32 3
.end_amdhsa_kernel
```

```asm
; @launch grid=(256,1,1) block=(256,1,1) lds=163840
.amdgcn_target "amdgcn-amd-amdhsa--gfx950"
.text
.globl recurrent_scan__gqa_block_cached__moe_arch_mod__prompt_kernel
.p2align 8
.type recurrent_scan__gqa_block_cached__moe_arch_mod__prompt_kernel,@function
recurrent_scan__gqa_block_cached__moe_arch_mod__prompt_kernel:
s_cmp_ge_u32 s2, 256
s_cbranch_scc1 K_END
s_getpc_b64 s[96:97]
v_lshlrev_b32 v7, 5, v0
global_load_dword a4, v7, s[96:97]
s_load_dwordx8 s[88:95], s[0:1], 0
s_load_dwordx2 s[86:87], s[0:1], 48
s_load_dwordx4 s[4:7], s[0:1], 88
v_and_b32 v1, 63, v0
v_lshrrev_b32 v5, 6, v0
s_bfe_u32 s35, s2, 0x20001
s_bfe_u32 s36, s2, 0x20003
v_readfirstlane_b32 s32, v5
s_lshl_b32 s33, s35, 2
s_add_u32 s33, s33, s36
s_and_b32 s34, s2, 1
s_lshl_b32 s34, s34, 3
s_lshr_b32 s46, s2, 5
s_add_u32 s34, s34, s46
s_lshl_b32 s46, s34, 7
s_lshl_b32 s47, s33, 3
s_add_u32 s3, s46, s47
v_lshrrev_b32 v8, 5, v0
v_add_u32 v8, s3, v8
v_and_b32 v9, 31, v0
v_mul_u32_u24 v11, 12, v9
v_mul_u32_u24 v10, 0x480, v8
v_add_u32 v10, v10, v11
v_lshrrev_b32 v5, 3, v1
v_and_b32 v6, 7, v1
v_xor_b32 v6, v6, v5
v_mul_u32_u24 v5, 0x480, v5
v_lshl_add_u32 v144, v6, 4, v5
v_add_u32 v145, 8192, v144
v_add_u32 v146, 18432, v144
v_add_u32 v147, 26624, v144
s_lshl_b32 s47, s32, 5
s_add_u32 s55, s46, s47
s_mul_i32 s43, s55, 1152
s_and_b32 s74, s34, 7
s_mul_i32 s74, s74, 1
s_mul_i32 s47, s36, 2
s_add_u32 s74, s74, s47
s_mul_i32 s47, s74, 57
s_lshr_b32 s47, s47, 9
s_mul_i32 s47, s47, 9
s_sub_u32 s74, s74, s47
s_movk_i32 s73, -1024
s_lshl_b32 s47, s74, 7
s_add_u32 s43, s43, s47
s_lshl_b32 s37, s32, 12
s_lshr_b32 s46, s35, 1
s_lshl_b32 s47, s46, 11
s_or_b32 s45, s37, s47
s_xor_b32 s85, s45, 2048
s_lshl_b32 s46, s46, 4
s_add_u32 s55, s55, s46
s_mov_b32 s26, 0x240000
s_mov_b32 s27, 0x00020000
s_waitcnt lgkmcnt(0)
s_mov_b32 s24, s88
s_and_b32 s25, s89, 0xffff
buffer_load_dwordx3 v[12:14], v10, s[24:27], 0 offen offset:0
buffer_load_dwordx3 v[16:18], v10, s[24:27], 0 offen offset:384
buffer_load_dwordx3 v[20:22], v10, s[24:27], 0 offen offset:768
s_mov_b32 s28, s86
s_and_b32 s29, s87, 0xffff
s_mov_b32 s30, 0x480
s_mov_b32 s31, 0x00020000
s_add_u32 m0, s45, 32768
s_nop 0
buffer_load_dwordx4 v144, s[24:27], s43 offen offset:0 lds
buffer_load_dwordx4 v145, s[24:27], s43 offen offset:1024 lds
s_add_u32 m0, s85, 32768
s_nop 0
buffer_load_dwordx4 v146, s[24:27], s43 offen offset:0 lds
buffer_load_dwordx4 v147, s[24:27], s43 offen offset:1024 lds
s_cmp_eq_u32 s74, 8
s_cselect_b32 s72, s73, 128
s_add_u32 s43, s43, s72
s_mov_b32 s16, s94
s_and_b32 s17, s95, 0xffff
s_mov_b32 s18, 0x480000
s_mov_b32 s19, 0x00020000
v_lshrrev_b32 v5, 5, v1
v_and_b32 v6, 31, v1
v_lshlrev_b32 v7, 1, v5
v_xor_b32 v6, v6, v7
v_lshlrev_b32 v6, 4, v6
v_lshl_add_u32 v136, v5, 13, v6
s_lshl_b32 s42, s33, 9
s_lshl_b32 s46, s32, 17
s_add_u32 s42, s42, s46
s_lshl_b32 s44, s32, 13
s_lshl_b32 s46, s74, 19
s_add_u32 s42, s42, s46
v_xor_b32 v137, 64, v136
v_add_u32 v137, 15360, v137
v_add_u32 v138, 30720, v136
v_xor_b32 v139, 64, v136
v_add_u32 v139, 46080, v139
v_xor_b32 v140, 128, v136
v_add_u32 v140, 65536, v140
v_xor_b32 v141, 192, v136
v_add_u32 v141, 80896, v141
v_xor_b32 v142, 128, v136
v_add_u32 v142, 96256, v142
v_xor_b32 v143, 192, v136
v_add_u32 v143, 111616, v143
s_add_u32 m0, s44, 0
s_nop 0
buffer_load_dwordx4 v136, s[16:19], s42 offen offset:0 lds
buffer_load_dwordx4 v137, s[16:19], s42 offen offset:1024 lds
buffer_load_dwordx4 v138, s[16:19], s42 offen offset:2048 lds
buffer_load_dwordx4 v139, s[16:19], s42 offen offset:3072 lds
s_add_u32 m0, s44, 4096
s_nop 0
buffer_load_dwordx4 v140, s[16:19], s42 offen offset:0 lds
s_load_dwordx2 s[68:69], s[0:1], 32
s_load_dwordx4 s[56:59], s[0:1], 56
s_load_dwordx4 s[64:67], s[0:1], 72
s_mov_b32 s100, 0
v_and_b32 v3, 15, v1
v_lshrrev_b32 v4, 4, v1
v_lshlrev_b32 v234, 4, v1
v_mov_b32 v255, 1
s_lshl_b32 s46, s33, 19
s_add_u32 s8, s90, s46
s_addc_u32 s9, s91, 0
s_and_b32 s9, s9, 0xffff
s_mov_b32 s10, 0x80000
s_mov_b32 s11, 0x00020000
s_add_u32 s12, s92, s46
s_addc_u32 s13, s93, 0
s_and_b32 s13, s13, 0xffff
s_mov_b32 s14, 0x80000
s_mov_b32 s15, 0x00020000
s_mov_b32 s20, s6
s_and_b32 s21, s7, 0xffff
s_mov_b32 s22, 0x4000000
s_mov_b32 s23, 0x00020000
v_bfe_u32 v248, v1, 2, 2
v_and_b32 v249, 3, v1
v_and_b32 v5, 1, v4
v_lshl_add_u32 v5, v5, 2, v248
s_lshl_b32 s46, s32, 1
v_xor_b32 v5, s46, v5
v_lshlrev_b32 v5, 5, v5
v_lshl_add_u32 v6, v4, 3, v248
v_lshl_add_u32 v5, v6, 9, v5
v_lshl_add_u32 v184, v249, 3, v5
v_xor_b32 v185, 32, v184
v_xor_b32 v186, 64, v184
v_xor_b32 v187, 96, v184
v_xor_b32 v188, 128, v184
v_xor_b32 v189, 160, v184
v_xor_b32 v190, 192, v184
v_xor_b32 v191, 224, v184
v_and_b32 v5, 7, v3
v_xor_b32 v5, v5, v4
v_lshlrev_b32 v5, 4, v5
v_lshl_add_u32 v5, v3, 7, v5
v_add_u32 v5, s37, v5
v_add_u32 v192, 0x8000, v5
v_xor_b32 v193, 64, v192
v_add_u32 v194, 0x18000, v184
v_add_u32 v195, 0x18000, v185
v_add_u32 v196, 0x18000, v186
v_add_u32 v197, 0x18000, v187
v_add_u32 v198, 0x18000, v188
v_add_u32 v199, 0x18000, v189
v_add_u32 v200, 0x18000, v190
v_add_u32 v201, 0x18000, v191
v_add_u32 v202, 0x18000, v192
v_add_u32 v203, 0x18000, v193
v_add_u32 v204, 0xc000, v184
v_add_u32 v205, 0xc000, v185
v_add_u32 v206, 0xc000, v186
v_add_u32 v207, 0xc000, v187
v_add_u32 v208, 0xc000, v188
v_add_u32 v209, 0xc000, v189
v_add_u32 v210, 0xc000, v190
v_add_u32 v211, 0xc000, v191
v_add_u32 v212, 0xc000, v192
v_add_u32 v213, 0xc000, v193
v_lshrrev_b32 v5, 1, v4
v_and_b32 v6, 7, v3
v_xor_b32 v5, v5, v6
v_lshlrev_b32 v5, 4, v5
v_lshl_add_u32 v5, v3, 7, v5
v_and_b32 v6, 1, v4
v_lshl_add_u32 v241, v6, 3, v5
s_lshl_b32 s83, s32, 11
s_add_u32 s83, s83, 155648
v_add_u32 v152, s83, v241
v_xor_b32 v153, 32, v152
v_xor_b32 v154, 64, v152
v_xor_b32 v155, 96, v152
v_bfe_u32 v5, v1, 1, 1
v_bfe_u32 v6, v1, 5, 1
v_cmp_eq_u32 vcc, v5, v6
v_mov_b32 v7, 0x3f803f80
v_and_b32 v5, 1, v1
v_cndmask_b32 v7, 0, v7, vcc
v_accvgpr_write_b32 a208, v7
v_accvgpr_write_b32 a209, v7
v_accvgpr_write_b32 a210, v7
v_accvgpr_write_b32 a211, v7
v_mul_u32_u24 v5, 0xaaaa, v5
v_add_u32 v235, 0x4444, v5
v_accvgpr_write_b32 a248, 0
v_accvgpr_write_b32 a249, 0
v_accvgpr_write_b32 a250, 0
v_accvgpr_write_b32 a251, 0
v_accvgpr_write_b32 a252, 0
v_accvgpr_write_b32 a253, 0
v_accvgpr_write_b32 a254, 0
v_accvgpr_write_b32 a255, 0
s_lshl_b32 s46, s34, 2
s_add_u32 s47, s46, s35
s_lshl_b32 s47, s47, 2
s_add_u32 s47, s47, s32
s_lshl_b32 s54, s47, 7
s_add_u32 s54, s54, 0x250000
s_add_u32 s47, s46, s36
s_lshl_b32 s47, s47, 2
s_add_u32 s47, s47, s32
s_lshl_b32 s47, s47, 7
s_add_u32 s47, s47, s35
s_lshl_b32 s47, s47, 2
s_add_u32 s38, s47, 0x280000
s_add_u32 s46, s46, s32
s_lshl_b32 s46, s46, 5
s_add_u32 s46, s46, s33
s_lshl_b32 s46, s46, 2
s_add_u32 s39, s46, 0x260000
s_lshl_b32 s46, s36, 3
s_add_u32 s46, s46, s54
s_add_u32 s47, s46, 4
v_lshl_add_u32 v60, v1, 7, s38
v_mov_b32 v61, 0
v_writelane_b32 v60, s46, 4
buffer_load_dwordx4 v141, s[16:19], s42 offen offset:1024 lds
v_writelane_b32 v60, s47, 5
v_writelane_b32 v60, s39, 6
s_lshl_b32 s46, s34, 2
s_add_u32 s46, s46, s35
s_lshl_b32 s46, s46, 3
s_add_u32 s46, s46, 0x270000
s_or_b32 s47, s36, s32
s_cselect_b32 s46, 0x7f000000, s46
v_writelane_b32 v60, s46, 7
s_add_u32 s46, s46, 4
v_writelane_b32 v60, s46, 8
s_lshl_b32 s47, s32, 8
s_or_b32 s47, s47, s2
s_lshl_b32 s46, s2, 7
s_add_u32 s46, s46, 0x272000
s_cmp_lt_u32 s47, 32
s_cselect_b32 s46, s46, 0x7f000000
v_writelane_b32 v60, s46, 9
s_getpc_b64 s[96:97]
PC_a:
s_sub_u32 s96, s96, PC_a-recurrent_scan__gqa_block_cached__moe_arch_mod__prompt_kernel
s_subb_u32 s97, s97, 0
s_lshr_b32 s46, s2, 3
s_lshl_b32 s46, s46, 2
s_add_u32 s46, s46, s32
s_min_u32 s46, s46, (K_CODE_END-recurrent_scan__gqa_block_cached__moe_arch_mod__prompt_kernel)>>10
s_lshl_b32 s46, s46, 10
v_lshlrev_b32 v7, 4, v1
buffer_load_dwordx4 v142, s[16:19], s42 offen offset:2048 lds
v_add_u32 v7, s46, v7
global_load_dwordx4 a[0:3], v7, s[96:97]
s_waitcnt lgkmcnt(0)
s_lshl_b32 s46, s32, 2
v_bfrev_b32 v5, v4
v_lshrrev_b32 v5, 30, v5
v_xor_b32 v5, s46, v5
v_xor_b32 v5, v5, v3
v_lshlrev_b32 v5, 4, v5
v_lshl_add_u32 v216, v3, 8, v5
v_xor_b32 v217, 64, v216
v_xor_b32 v218, 128, v216
v_xor_b32 v219, 192, v216
v_lshl_add_u32 v6, v4, 2, v248
v_and_b32 v5, 7, v6
v_lshlrev_b32 v5, 5, v5
v_lshl_add_u32 v5, v6, 8, v5
v_lshl_add_u32 v5, v249, 3, v5
v_add_u32 v220, 0x10000, v5
v_xor_b32 v221, 32, v220
v_xor_b32 v222, 64, v220
v_xor_b32 v223, 96, v220
v_xor_b32 v224, 128, v220
v_xor_b32 v225, 160, v220
buffer_load_dwordx4 v143, s[16:19], s42 offen offset:3072 lds
v_xor_b32 v226, 192, v220
v_xor_b32 v227, 224, v220
v_xor_b32 v5, v4, v3
v_lshlrev_b32 v5, 4, v5
v_lshl_add_u32 v5, v4, 8, v5
v_add_u32 v228, s37, v5
v_xor_b32 v229, 64, v228
v_xor_b32 v230, 128, v228
v_xor_b32 v231, 192, v228
v_lshlrev_b32 v5, 1, v4
v_xor_b32 v5, v5, v3
v_lshlrev_b32 v5, 4, v5
v_lshl_add_u32 v5, v4, 8, v5
v_add_u32 v232, s37, v5
v_xor_b32 v233, 128, v232
s_mov_b32 s41, 0
s_lshl_b32 s49, s32, 13
s_add_u32 s49, s49, 131072
s_lshl_b32 s3, s32, 10
s_lshl_b32 s53, s34, 4
s_add_u32 s53, s53, s33
s_lshl_b32 s53, s53, 2
s_add_u32 s53, s53, s32
s_lshl_b32 s53, s53, 14
s_add_u32 s53, s53, 0x400000
v_add_u32 v5, s46, v4
s_lshl_b32 s72, s72, 12
s_add_u32 s42, s42, s72
s_nop 0
buffer_load_dwordx3 v[24:26], v11, s[28:31], 0 offen offset:0
v_and_b32 v6, 7, v5
v_lshlrev_b32 v6, 1, v6
v_xor_b32 v6, v6, v3
v_mul_u32_u24 v5, 0x480, v5
v_lshl_add_u32 v236, v6, 4, v5
v_lshrrev_b32 v5, 3, v0
v_and_b32 v6, 6, v5
v_and_b32 v7, 7, v1
v_xor_b32 v6, v6, v7
v_mul_u32_u24 v5, 0x480, v5
v_lshl_add_u32 v237, v6, 4, v5
v_lshrrev_b32 v5, 2, v1
v_mul_u32_u24 v5, 0x2400, v5
v_lshl_add_u32 v238, v249, 4, v5
s_lshl_b32 s47, s36, 8
s_mul_i32 s84, s35, 1179648
s_add_u32 s84, s84, s47
s_mul_i32 s75, s33, 294912
s_add_u32 s51, s75, s47
s_add_u32 s75, s75, 1024
s_mov_b64 s[86:87], s[68:69]
s_mov_b64 s[88:89], s[56:57]
s_mov_b64 s[90:91], s[58:59]
s_mov_b32 s68, s66
s_and_b32 s69, s67, 0xffff
s_mov_b32 s70, 0x240000
s_mov_b32 s71, 0x00020000
s_mov_b32 s64, s64
s_and_b32 s65, s65, 0xffff
s_mov_b32 s66, 0x510000
s_mov_b32 s67, 0x00020000
s_mov_b32 s56, s88
s_and_b32 s57, s89, 0xffff
s_mov_b32 s58, 0x510000
s_mov_b32 s59, 0x00020000
s_mov_b32 s60, s90
s_and_b32 s61, s91, 0xffff
s_mov_b32 s62, 0x510000
s_mov_b32 s63, 0x00020000
s_mov_b32 s52, 0
s_and_b32 s82, s35, 1
s_lshl_b32 s82, s82, 7
s_mul_i32 s80, s55, 1152
s_lshl_b32 s46, s36, 5
s_add_u32 s81, s80, s46
s_add_u32 s81, s81, 1024
s_add_u32 s80, s80, s47
s_add_u32 s80, s80, s82
s_bitcmp1_b32 s35, 0
s_cselect_b32 s81, 0x7f000000, s81
v_mov_b32 v239, v144
buffer_load_dwordx3 v[28:30], v11, s[28:31], 0 offen offset:384
v_mul_u32_u24 v5, 0x480, v3
v_lshl_add_u32 v240, v4, 3, v5
v_min_u32 v243, 35, v1
v_lshlrev_b32 v243, 7, v243
v_lshlrev_b32 v251, 3, v1
s_mov_b32 s92, 0x3ae38e39
s_mov_b32 s93, 0x3727c5ac
s_mov_b32 s94, 0xffff0000
v_and_b32 v5, 3, v1
v_lshlrev_b32 v5, 21, v5
buffer_load_dword a7, v61, s[8:11], 0 offen
buffer_load_dwordx4 v[160:163], v234, s[12:15], 0 offen
buffer_load_dword a9, v5, s[16:19], 0 offen
s_mov_b64 exec, 0x3ff
buffer_store_dword v61, v60, s[20:23], 0 offen sc0 sc1
s_mov_b64 exec, -1
s_waitcnt vmcnt(19)
v_lshlrev_b32 v40, 16, v12
v_and_b32 v41, s94, v12
v_lshlrev_b32 v42, 16, v13
v_and_b32 v43, s94, v13
v_lshlrev_b32 v44, 16, v14
v_and_b32 v45, s94, v14
v_lshlrev_b32 v46, 16, v16
buffer_load_dwordx3 v[32:34], v11, s[28:31], 0 offen offset:768
v_and_b32 v47, s94, v16
v_lshlrev_b32 v48, 16, v17
v_and_b32 v49, s94, v17
v_lshlrev_b32 v50, 16, v18
v_and_b32 v51, s94, v18
v_lshlrev_b32 v52, 16, v20
v_and_b32 v53, s94, v20
v_lshlrev_b32 v54, 16, v21
v_and_b32 v55, s94, v21
v_lshlrev_b32 v56, 16, v22
v_and_b32 v57, s94, v22
v_pk_add_f32 v[64:65], v[40:41], v[42:43]
v_pk_add_f32 v[66:67], v[44:45], v[46:47]
v_pk_add_f32 v[64:65], v[64:65], v[48:49]
v_pk_add_f32 v[66:67], v[66:67], v[50:51]
v_pk_add_f32 v[64:65], v[64:65], v[52:53]
v_pk_add_f32 v[66:67], v[66:67], v[54:55]
v_pk_add_f32 v[64:65], v[64:65], v[56:57]
v_pk_add_f32 v[64:65], v[64:65], v[66:67]
v_add_f32 v64, v64, v65
s_nop 1
v_add_f32_dpp v65, v64, v64 row_ror:8 row_mask:0xf bank_mask:0xf
s_nop 1
v_add_f32_dpp v64, v65, v65 row_ror:4 row_mask:0xf bank_mask:0xf
s_add_u32 m0, s45, 131072
s_nop 0
buffer_load_dwordx4 v144, s[24:27], s43 offen offset:0 lds
s_nop 1
v_add_f32_dpp v65, v64, v64 row_ror:2 row_mask:0xf bank_mask:0xf
s_nop 1
v_add_f32_dpp v64, v65, v65 row_ror:1 row_mask:0xf bank_mask:0xf
v_mov_b32 v65, v64
s_nop 1
v_permlane16_swap_b32 v64, v65
v_add_f32 v64, v64, v65
v_mul_f32 v64, s92, v64
v_pk_add_f32 v[72:73], v[40:41], v[64:65] op_sel_hi:[1,0] neg_lo:[0,1] neg_hi:[0,1]
v_pk_add_f32 v[74:75], v[42:43], v[64:65] op_sel_hi:[1,0] neg_lo:[0,1] neg_hi:[0,1]
v_pk_add_f32 v[76:77], v[44:45], v[64:65] op_sel_hi:[1,0] neg_lo:[0,1] neg_hi:[0,1]
v_pk_add_f32 v[78:79], v[46:47], v[64:65] op_sel_hi:[1,0] neg_lo:[0,1] neg_hi:[0,1]
v_pk_add_f32 v[80:81], v[48:49], v[64:65] op_sel_hi:[1,0] neg_lo:[0,1] neg_hi:[0,1]
v_pk_add_f32 v[82:83], v[50:51], v[64:65] op_sel_hi:[1,0] neg_lo:[0,1] neg_hi:[0,1]
v_pk_add_f32 v[84:85], v[52:53], v[64:65] op_sel_hi:[1,0] neg_lo:[0,1] neg_hi:[0,1]
v_pk_add_f32 v[86:87], v[54:55], v[64:65] op_sel_hi:[1,0] neg_lo:[0,1] neg_hi:[0,1]
v_pk_add_f32 v[88:89], v[56:57], v[64:65] op_sel_hi:[1,0] neg_lo:[0,1] neg_hi:[0,1]
v_pk_mul_f32 v[66:67], v[72:73], v[72:73]
v_pk_mul_f32 v[68:69], v[74:75], v[74:75]
v_pk_fma_f32 v[66:67], v[76:77], v[76:77], v[66:67]
v_pk_fma_f32 v[68:69], v[78:79], v[78:79], v[68:69]
v_pk_fma_f32 v[66:67], v[80:81], v[80:81], v[66:67]
v_pk_fma_f32 v[68:69], v[82:83], v[82:83], v[68:69]
buffer_load_dwordx4 v145, s[24:27], s43 offen offset:1024 lds
v_pk_fma_f32 v[66:67], v[84:85], v[84:85], v[66:67]
v_pk_fma_f32 v[68:69], v[86:87], v[86:87], v[68:69]
v_pk_fma_f32 v[66:67], v[88:89], v[88:89], v[66:67]
v_pk_add_f32 v[66:67], v[66:67], v[68:69]
v_add_f32 v69, v66, v67
v_cvt_pk_bf16_f32 v64, v64, v64
v_lshlrev_b32 v64, 16, v64
v_pk_add_f32 v[40:41], v[40:41], v[64:65] op_sel_hi:[1,0] neg_lo:[0,1] neg_hi:[0,1]
v_cvt_pk_bf16_f32 v12, v40, v41
v_add_f32_dpp v68, v69, v69 row_ror:8 row_mask:0xf bank_mask:0xf
v_pk_add_f32 v[42:43], v[42:43], v[64:65] op_sel_hi:[1,0] neg_lo:[0,1] neg_hi:[0,1]
v_cvt_pk_bf16_f32 v13, v42, v43
v_add_f32_dpp v69, v68, v68 row_ror:4 row_mask:0xf bank_mask:0xf
v_pk_add_f32 v[44:45], v[44:45], v[64:65] op_sel_hi:[1,0] neg_lo:[0,1] neg_hi:[0,1]
v_cvt_pk_bf16_f32 v14, v44, v45
v_add_f32_dpp v68, v69, v69 row_ror:2 row_mask:0xf bank_mask:0xf
v_pk_add_f32 v[46:47], v[46:47], v[64:65] op_sel_hi:[1,0] neg_lo:[0,1] neg_hi:[0,1]
v_cvt_pk_bf16_f32 v16, v46, v47
v_add_f32_dpp v69, v68, v68 row_ror:1 row_mask:0xf bank_mask:0xf
v_mov_b32 v68, v69
v_pk_add_f32 v[48:49], v[48:49], v[64:65] op_sel_hi:[1,0] neg_lo:[0,1] neg_hi:[0,1]
v_cvt_pk_bf16_f32 v17, v48, v49
v_permlane16_swap_b32 v69, v68
v_add_f32 v69, v69, v68
s_add_u32 m0, s85, 131072
s_nop 0
buffer_load_dwordx4 v146, s[24:27], s43 offen offset:0 lds
v_mul_f32 v69, s92, v69
v_cvt_pk_bf16_f32 v69, v69, v69
v_lshlrev_b32 v69, 16, v69
v_add_f32 v69, s93, v69
v_cvt_pk_bf16_f32 v69, v69, v69
v_lshlrev_b32 v69, 16, v69
v_sqrt_f32 v69, v69
v_pk_add_f32 v[50:51], v[50:51], v[64:65] op_sel_hi:[1,0] neg_lo:[0,1] neg_hi:[0,1]
v_cvt_pk_bf16_f32 v18, v50, v51
v_cvt_pk_bf16_f32 v65, v69, v69
v_lshlrev_b32 v65, 16, v65
v_rcp_f32 v66, v65
v_pk_add_f32 v[52:53], v[52:53], v[64:65] op_sel_hi:[1,0] neg_lo:[0,1] neg_hi:[0,1]
v_cvt_pk_bf16_f32 v20, v52, v53
v_pk_add_f32 v[54:55], v[54:55], v[64:65] op_sel_hi:[1,0] neg_lo:[0,1] neg_hi:[0,1]
v_cvt_pk_bf16_f32 v21, v54, v55
v_pk_add_f32 v[56:57], v[56:57], v[64:65] op_sel_hi:[1,0] neg_lo:[0,1] neg_hi:[0,1]
v_cvt_pk_bf16_f32 v22, v56, v57
v_lshlrev_b32 v40, 16, v12
v_and_b32 v41, s94, v12
v_lshlrev_b32 v42, 16, v13
v_and_b32 v43, s94, v13
v_lshlrev_b32 v44, 16, v14
v_and_b32 v45, s94, v14
buffer_load_dwordx4 v147, s[24:27], s43 offen offset:1024 lds
v_lshlrev_b32 v46, 16, v16
v_and_b32 v47, s94, v16
v_lshlrev_b32 v48, 16, v17
v_and_b32 v49, s94, v17
v_lshlrev_b32 v50, 16, v18
v_and_b32 v51, s94, v18
v_lshlrev_b32 v52, 16, v20
v_and_b32 v53, s94, v20
v_lshlrev_b32 v54, 16, v21
v_and_b32 v55, s94, v21
v_lshlrev_b32 v56, 16, v22
v_and_b32 v57, s94, v22
v_lshlrev_b32 v5, 3, v8
s_mov_b32 s46, 0x240000
s_mov_b32 exec_lo, 1
s_mov_b32 exec_hi, 1
buffer_store_dwordx2 v[64:65], v5, s[20:23], s46 offen sc0 sc1
s_mov_b64 exec, -1
v_mov_b32 v70, 0
s_waitcnt lgkmcnt(0)
v_pk_mul_f32 v[72:73], v[40:41], v[66:67] op_sel_hi:[1,0]
v_pk_fma_f32 v[40:41], v[72:73], v[64:65], v[40:41] op_sel:[0,1,0] op_sel_hi:[1,1,1] neg_lo:[1,0,0] neg_hi:[1,0,0]
v_pk_fma_f32 v[72:73], v[40:41], v[66:67], v[72:73] op_sel_hi:[1,0,1]
v_cvt_pk_bf16_f32 v12, v72, v73
s_cmp_eq_u32 s74, 7
s_cselect_b32 s72, s73, 128
s_add_u32 s43, s43, s72
s_add_u32 m0, s44, 98304
s_nop 0
buffer_load_dwordx4 v136, s[16:19], s42 offen offset:0 lds
v_pk_mul_f32 v[74:75], v[42:43], v[66:67] op_sel_hi:[1,0]
v_pk_fma_f32 v[42:43], v[74:75], v[64:65], v[42:43] op_sel:[0,1,0] op_sel_hi:[1,1,1] neg_lo:[1,0,0] neg_hi:[1,0,0]
v_pk_fma_f32 v[74:75], v[42:43], v[66:67], v[74:75] op_sel_hi:[1,0,1]
v_cvt_pk_bf16_f32 v13, v74, v75
v_pk_mul_f32 v[76:77], v[44:45], v[66:67] op_sel_hi:[1,0]
v_pk_fma_f32 v[44:45], v[76:77], v[64:65], v[44:45] op_sel:[0,1,0] op_sel_hi:[1,1,1] neg_lo:[1,0,0] neg_hi:[1,0,0]
v_pk_fma_f32 v[76:77], v[44:45], v[66:67], v[76:77] op_sel_hi:[1,0,1]
v_cvt_pk_bf16_f32 v14, v76, v77
buffer_store_dwordx3 v[12:14], v10, s[20:23], 0 offen offset:0 sc0 sc1
v_pk_mul_f32 v[78:79], v[46:47], v[66:67] op_sel_hi:[1,0]
v_pk_fma_f32 v[46:47], v[78:79], v[64:65], v[46:47] op_sel:[0,1,0] op_sel_hi:[1,1,1] neg_lo:[1,0,0] neg_hi:[1,0,0]
v_pk_fma_f32 v[78:79], v[46:47], v[66:67], v[78:79] op_sel_hi:[1,0,1]
v_cvt_pk_bf16_f32 v16, v78, v79
v_pk_mul_f32 v[80:81], v[48:49], v[66:67] op_sel_hi:[1,0]
v_pk_fma_f32 v[48:49], v[80:81], v[64:65], v[48:49] op_sel:[0,1,0] op_sel_hi:[1,1,1] neg_lo:[1,0,0] neg_hi:[1,0,0]
v_pk_fma_f32 v[80:81], v[48:49], v[66:67], v[80:81] op_sel_hi:[1,0,1]
v_cvt_pk_bf16_f32 v17, v80, v81
v_pk_mul_f32 v[82:83], v[50:51], v[66:67] op_sel_hi:[1,0]
v_pk_fma_f32 v[50:51], v[82:83], v[64:65], v[50:51] op_sel:[0,1,0] op_sel_hi:[1,1,1] neg_lo:[1,0,0] neg_hi:[1,0,0]
v_pk_fma_f32 v[82:83], v[50:51], v[66:67], v[82:83] op_sel_hi:[1,0,1]
v_cvt_pk_bf16_f32 v18, v82, v83
buffer_store_dwordx3 v[16:18], v10, s[20:23], 0 offen offset:384 sc0 sc1
v_pk_mul_f32 v[84:85], v[52:53], v[66:67] op_sel_hi:[1,0]
v_pk_fma_f32 v[52:53], v[84:85], v[64:65], v[52:53] op_sel:[0,1,0] op_sel_hi:[1,1,1] neg_lo:[1,0,0] neg_hi:[1,0,0]
buffer_load_dwordx4 v137, s[16:19], s42 offen offset:1024 lds
v_pk_fma_f32 v[84:85], v[52:53], v[66:67], v[84:85] op_sel_hi:[1,0,1]
v_cvt_pk_bf16_f32 v20, v84, v85
v_pk_mul_f32 v[86:87], v[54:55], v[66:67] op_sel_hi:[1,0]
v_pk_fma_f32 v[54:55], v[86:87], v[64:65], v[54:55] op_sel:[0,1,0] op_sel_hi:[1,1,1] neg_lo:[1,0,0] neg_hi:[1,0,0]
v_pk_fma_f32 v[86:87], v[54:55], v[66:67], v[86:87] op_sel_hi:[1,0,1]
v_cvt_pk_bf16_f32 v21, v86, v87
v_pk_mul_f32 v[88:89], v[56:57], v[66:67] op_sel_hi:[1,0]
v_pk_fma_f32 v[56:57], v[88:89], v[64:65], v[56:57] op_sel:[0,1,0] op_sel_hi:[1,1,1] neg_lo:[1,0,0] neg_hi:[1,0,0]
v_pk_fma_f32 v[88:89], v[56:57], v[66:67], v[88:89] op_sel_hi:[1,0,1]
v_cvt_pk_bf16_f32 v22, v88, v89
buffer_store_dwordx3 v[20:22], v10, s[20:23], 0 offen offset:768 sc0 sc1
s_waitcnt vmcnt(10)
v_dot2_f32_bf16 v70, v12, v24, v70
v_dot2_f32_bf16 v70, v13, v25, v70
v_dot2_f32_bf16 v70, v14, v26, v70
v_dot2_f32_bf16 v70, v16, v28, v70
v_dot2_f32_bf16 v70, v17, v29, v70
v_dot2_f32_bf16 v70, v18, v30, v70
v_dot2_f32_bf16 v70, v20, v32, v70
v_dot2_f32_bf16 v70, v21, v33, v70
v_dot2_f32_bf16 v70, v22, v34, v70
v_sub_u32 v68, 2047, v8
v_lshlrev_b32 v5, 2, v8
s_nop 1
v_add_f32_dpp v71, v70, v70 row_ror:8 row_mask:0xf bank_mask:0xf
buffer_load_dwordx4 v138, s[16:19], s42 offen offset:2048 lds
s_nop 1
v_add_f32_dpp v70, v71, v71 row_ror:4 row_mask:0xf bank_mask:0xf
s_nop 1
v_add_f32_dpp v71, v70, v70 row_ror:2 row_mask:0xf bank_mask:0xf
s_nop 1
v_add_f32_dpp v70, v71, v71 row_ror:1 row_mask:0xf bank_mask:0xf
v_mov_b32 v71, v70
s_nop 1
v_permlane16_swap_b32 v70, v71
v_add_f32 v70, v70, v71
v_cvt_pk_bf16_f32 v70, v70, v70
v_ashrrev_i32 v71, 31, v70
v_or_b32 v71, 0x80000000, v71
v_xor_b32 v70, v70, v71
v_and_or_b32 v214, v70, s94, v68
buffer_load_dwordx4 v139, s[16:19], s42 offen offset:3072 lds
s_add_u32 m0, s44, 102400
s_nop 0
buffer_load_dwordx4 v140, s[16:19], s42 offen offset:0 lds
buffer_load_dwordx4 v141, s[16:19], s42 offen offset:1024 lds
buffer_load_dwordx4 v142, s[16:19], s42 offen offset:2048 lds
buffer_load_dwordx4 v143, s[16:19], s42 offen offset:3072 lds
s_lshl_b32 s72, s72, 12
s_add_u32 s42, s42, s72
s_mov_b32 s46, 0x244000
s_mov_b32 exec_lo, 1
s_mov_b32 exec_hi, 1
buffer_store_dword v214, v5, s[20:23], s46 offen sc0 sc1
s_mov_b64 exec, -1
s_mov_b32 s28, s4
s_and_b32 s29, s5, 0xffff
s_mov_b32 s30, 0x100
s_mov_b32 s31, 0x00020000
s_waitcnt vmcnt(24)
s_barrier
ds_read_b128 a[192:195], v192 offset:0
ds_read_b128 a[196:199], v192 offset:2048
ds_read_b64_tr_b16 a[128:129], v184 offset:0
ds_read_b64_tr_b16 a[130:131], v184 offset:2048
ds_read_b64_tr_b16 a[132:133], v185 offset:0
ds_read_b64_tr_b16 a[134:135], v185 offset:2048
ds_read_b64_tr_b16 a[160:161], v184 offset:256
ds_read_b64_tr_b16 a[162:163], v184 offset:2304
ds_read_b64_tr_b16 a[164:165], v185 offset:256
ds_read_b64_tr_b16 a[166:167], v185 offset:2304
ds_read_b64_tr_b16 a[136:137], v186 offset:0
ds_read_b64_tr_b16 a[138:139], v186 offset:2048
ds_read_b64_tr_b16 a[140:141], v187 offset:0
ds_read_b64_tr_b16 a[142:143], v187 offset:2048
ds_read_b64_tr_b16 a[144:145], v188 offset:0
ds_read_b64_tr_b16 a[146:147], v188 offset:2048
ds_read_b64_tr_b16 a[148:149], v189 offset:0
ds_read_b64_tr_b16 a[150:151], v189 offset:2048
ds_read_b64_tr_b16 a[152:153], v190 offset:0
ds_read_b64_tr_b16 a[154:155], v190 offset:2048
ds_read_b64_tr_b16 a[156:157], v191 offset:0
ds_read_b64_tr_b16 a[158:159], v191 offset:2048
ds_read_b64_tr_b16 a[168:169], v186 offset:256
ds_read_b64_tr_b16 a[170:171], v186 offset:2304
ds_read_b64_tr_b16 a[172:173], v187 offset:256
ds_read_b64_tr_b16 a[174:175], v187 offset:2304
ds_read_b64_tr_b16 a[176:177], v188 offset:256
ds_read_b64_tr_b16 a[178:179], v188 offset:2304
ds_read_b64_tr_b16 a[180:181], v189 offset:256
ds_read_b64_tr_b16 a[182:183], v189 offset:2304
ds_read_b64_tr_b16 a[184:185], v190 offset:256
ds_read_b64_tr_b16 a[186:187], v190 offset:2304
ds_read_b64_tr_b16 a[188:189], v191 offset:256
ds_read_b64_tr_b16 a[190:191], v191 offset:2304
s_waitcnt lgkmcnt(15)
v_mfma_f32_16x16x32_bf16 v[8:11], a[128:131], a[192:195], 0
ds_read_b128 a[200:203], v193 offset:0
ds_read_b128 a[204:207], v193 offset:2048
v_mfma_f32_16x16x32_bf16 v[40:43], a[128:131], a[196:199], 0
s_add_u32 m0, s45, 81920
v_mfma_f32_16x16x32_bf16 v[12:15], a[132:135], a[192:195], 0
buffer_load_dwordx4 v144, s[24:27], s43 offen offset:0 lds
v_mfma_f32_16x16x32_bf16 v[44:47], a[132:135], a[196:199], 0
v_smfmac_f32_16x16x64_bf16 a[248:251], a[208:211], a[128:135], v235
ds_read_b64_tr_b16 a[128:129], v184 offset:16384
ds_read_b64_tr_b16 a[130:131], v184 offset:18432
v_mfma_f32_16x16x32_bf16 v[72:75], a[160:163], a[192:195], 0
ds_read_b64_tr_b16 a[132:133], v185 offset:16384
ds_read_b64_tr_b16 a[134:135], v185 offset:18432
v_mfma_f32_16x16x32_bf16 v[104:107], a[160:163], a[196:199], 0
buffer_load_dwordx4 v145, s[24:27], s43 offen offset:1024 lds
v_mfma_f32_16x16x32_bf16 v[76:79], a[164:167], a[192:195], 0
v_mfma_f32_16x16x32_bf16 v[108:111], a[164:167], a[196:199], 0
v_smfmac_f32_16x16x64_bf16 a[252:255], a[208:211], a[160:167], v235
s_add_u32 m0, s85, 81920
ds_read_b64_tr_b16 a[160:161], v184 offset:16640
ds_read_b64_tr_b16 a[162:163], v184 offset:18688
v_mfma_f32_16x16x32_bf16 v[16:19], a[136:139], a[192:195], 0
buffer_load_dwordx4 v146, s[24:27], s43 offen offset:0 lds
v_mfma_f32_16x16x32_bf16 v[48:51], a[136:139], a[196:199], 0
ds_read_b64_tr_b16 a[164:165], v185 offset:16640
ds_read_b64_tr_b16 a[166:167], v185 offset:18688
v_mfma_f32_16x16x32_bf16 v[20:23], a[140:143], a[192:195], 0
ds_read_b64_tr_b16 a[136:137], v186 offset:16384
ds_read_b64_tr_b16 a[138:139], v186 offset:18432
v_mfma_f32_16x16x32_bf16 v[52:55], a[140:143], a[196:199], 0
ds_read_b64_tr_b16 a[140:141], v187 offset:16384
ds_read_b64_tr_b16 a[142:143], v187 offset:18432
v_mfma_f32_16x16x32_bf16 v[24:27], a[144:147], a[192:195], 0
buffer_load_dwordx4 v147, s[24:27], s43 offen offset:1024 lds
v_mfma_f32_16x16x32_bf16 v[56:59], a[144:147], a[196:199], 0
s_cmp_eq_u32 s74, 6
s_cselect_b32 s72, s73, 128
ds_read_b64_tr_b16 a[144:145], v188 offset:16384
ds_read_b64_tr_b16 a[146:147], v188 offset:18432
v_mfma_f32_16x16x32_bf16 v[28:31], a[148:151], a[192:195], 0
s_add_u32 s43, s43, s72
v_mfma_f32_16x16x32_bf16 v[60:63], a[148:151], a[196:199], 0
s_waitcnt lgkmcnt(10)
s_add_u32 m0, s44, 49152
ds_read_b64_tr_b16 a[148:149], v189 offset:16384
ds_read_b64_tr_b16 a[150:151], v189 offset:18432
v_mfma_f32_16x16x32_bf16 v[32:35], a[152:155], a[192:195], 0
buffer_load_dwordx4 v136, s[16:19], s42 offen offset:0 lds
v_mfma_f32_16x16x32_bf16 v[64:67], a[152:155], a[196:199], 0
ds_read_b64_tr_b16 a[152:153], v190 offset:16384
ds_read_b64_tr_b16 a[154:155], v190 offset:18432
v_mfma_f32_16x16x32_bf16 v[36:39], a[156:159], a[192:195], 0
v_mfma_f32_16x16x32_bf16 v[68:71], a[156:159], a[196:199], 0
ds_read_b64_tr_b16 a[156:157], v191 offset:16384
ds_read_b64_tr_b16 a[158:159], v191 offset:18432
v_mfma_f32_16x16x32_bf16 v[80:83], a[168:171], a[192:195], 0
v_mfma_f32_16x16x32_bf16 v[112:115], a[168:171], a[196:199], 0
buffer_load_dwordx4 v137, s[16:19], s42 offen offset:1024 lds
v_mfma_f32_16x16x32_bf16 v[84:87], a[172:175], a[192:195], 0
ds_read_b64_tr_b16 a[168:169], v186 offset:16640
ds_read_b64_tr_b16 a[170:171], v186 offset:18688
v_mfma_f32_16x16x32_bf16 v[116:119], a[172:175], a[196:199], 0
ds_read_b64_tr_b16 a[172:173], v187 offset:16640
ds_read_b64_tr_b16 a[174:175], v187 offset:18688
v_mfma_f32_16x16x32_bf16 v[88:91], a[176:179], a[192:195], 0
v_mfma_f32_16x16x32_bf16 v[120:123], a[176:179], a[196:199], 0
buffer_load_dwordx4 v138, s[16:19], s42 offen offset:2048 lds
v_mfma_f32_16x16x32_bf16 v[92:95], a[180:183], a[192:195], 0
ds_read_b64_tr_b16 a[176:177], v188 offset:16640
ds_read_b64_tr_b16 a[178:179], v188 offset:18688
v_mfma_f32_16x16x32_bf16 v[124:127], a[180:183], a[196:199], 0
ds_read_b64_tr_b16 a[180:181], v189 offset:16640
ds_read_b64_tr_b16 a[182:183], v189 offset:18688
v_mfma_f32_16x16x32_bf16 v[96:99], a[184:187], a[192:195], 0
v_mfma_f32_16x16x32_bf16 v[128:131], a[184:187], a[196:199], 0
buffer_load_dwordx4 v139, s[16:19], s42 offen offset:3072 lds
v_mfma_f32_16x16x32_bf16 v[100:103], a[188:191], a[192:195], 0
ds_read_b64_tr_b16 a[184:185], v190 offset:16640
ds_read_b64_tr_b16 a[186:187], v190 offset:18688
v_mfma_f32_16x16x32_bf16 v[132:135], a[188:191], a[196:199], 0
ds_read_b64_tr_b16 a[188:189], v191 offset:16640
ds_read_b64_tr_b16 a[190:191], v191 offset:18688
v_mfma_f32_16x16x32_bf16 v[8:11], a[128:131], a[200:203], v[8:11]
s_add_u32 m0, s44, 53248
v_mfma_f32_16x16x32_bf16 v[40:43], a[128:131], a[204:207], v[40:43]
buffer_load_dwordx4 v140, s[16:19], s42 offen offset:0 lds
v_mfma_f32_16x16x32_bf16 v[12:15], a[132:135], a[200:203], v[12:15]
v_mfma_f32_16x16x32_bf16 v[44:47], a[132:135], a[204:207], v[44:47]
v_smfmac_f32_16x16x64_bf16 a[248:251], a[208:211], a[128:135], v235
s_waitcnt lgkmcnt(6)
v_mfma_f32_16x16x32_bf16 v[72:75], a[160:163], a[200:203], v[72:75]
v_mfma_f32_16x16x32_bf16 v[104:107], a[160:163], a[204:207], v[104:107]
s_waitcnt vmcnt(10) lgkmcnt(0)
s_barrier
v_mfma_f32_16x16x32_bf16 v[76:79], a[164:167], a[200:203], v[76:79]
ds_read_b128 a[192:195], v202 offset:0
ds_read_b128 a[196:199], v202 offset:2048
v_mfma_f32_16x16x32_bf16 v[108:111], a[164:167], a[204:207], v[108:111]
buffer_load_dwordx4 v141, s[16:19], s42 offen offset:1024 lds
v_smfmac_f32_16x16x64_bf16 a[252:255], a[208:211], a[160:167], v235
ds_read_b64_tr_b16 a[128:129], v194 offset:0
ds_read_b64_tr_b16 a[130:131], v194 offset:2048
v_mfma_f32_16x16x32_bf16 v[16:19], a[136:139], a[200:203], v[16:19]
ds_read_b64_tr_b16 a[132:133], v195 offset:0
ds_read_b64_tr_b16 a[134:135], v195 offset:2048
v_mfma_f32_16x16x32_bf16 v[48:51], a[136:139], a[204:207], v[48:51]
ds_read_b64_tr_b16 a[160:161], v194 offset:256
ds_read_b64_tr_b16 a[162:163], v194 offset:2304
v_mfma_f32_16x16x32_bf16 v[20:23], a[140:143], a[200:203], v[20:23]
ds_read_b64_tr_b16 a[164:165], v195 offset:256
ds_read_b64_tr_b16 a[166:167], v195 offset:2304
v_mfma_f32_16x16x32_bf16 v[52:55], a[140:143], a[204:207], v[52:55]
buffer_load_dwordx4 v142, s[16:19], s42 offen offset:2048 lds
v_mfma_f32_16x16x32_bf16 v[24:27], a[144:147], a[200:203], v[24:27]
ds_read_b64_tr_b16 a[136:137], v196 offset:0
ds_read_b64_tr_b16 a[138:139], v196 offset:2048
v_mfma_f32_16x16x32_bf16 v[56:59], a[144:147], a[204:207], v[56:59]
ds_read_b64_tr_b16 a[140:141], v197 offset:0
ds_read_b64_tr_b16 a[142:143], v197 offset:2048
v_mfma_f32_16x16x32_bf16 v[28:31], a[148:151], a[200:203], v[28:31]
ds_read_b64_tr_b16 a[144:145], v198 offset:0
ds_read_b64_tr_b16 a[146:147], v198 offset:2048
v_mfma_f32_16x16x32_bf16 v[60:63], a[148:151], a[204:207], v[60:63]
buffer_load_dwordx4 v143, s[16:19], s42 offen offset:3072 lds
v_mfma_f32_16x16x32_bf16 v[32:35], a[152:155], a[200:203], v[32:35]
s_lshl_b32 s72, s72, 12
ds_read_b64_tr_b16 a[148:149], v199 offset:0
ds_read_b64_tr_b16 a[150:151], v199 offset:2048
v_mfma_f32_16x16x32_bf16 v[64:67], a[152:155], a[204:207], v[64:67]
s_add_u32 s42, s42, s72
ds_read_b64_tr_b16 a[152:153], v200 offset:0
ds_read_b64_tr_b16 a[154:155], v200 offset:2048
v_mfma_f32_16x16x32_bf16 v[36:39], a[156:159], a[200:203], v[36:39]
s_add_u32 m0, s45, 32768
v_mfma_f32_16x16x32_bf16 v[68:71], a[156:159], a[204:207], v[68:71]
buffer_load_dwordx4 v144, s[24:27], s43 offen offset:0 lds
v_mfma_f32_16x16x32_bf16 v[80:83], a[168:171], a[200:203], v[80:83]
ds_read_b64_tr_b16 a[156:157], v201 offset:0
ds_read_b64_tr_b16 a[158:159], v201 offset:2048
v_mfma_f32_16x16x32_bf16 v[112:115], a[168:171], a[204:207], v[112:115]
ds_read_b64_tr_b16 a[168:169], v196 offset:256
ds_read_b64_tr_b16 a[170:171], v196 offset:2304
v_mfma_f32_16x16x32_bf16 v[84:87], a[172:175], a[200:203], v[84:87]
v_mfma_f32_16x16x32_bf16 v[116:119], a[172:175], a[204:207], v[116:119]
buffer_load_dwordx4 v145, s[24:27], s43 offen offset:1024 lds
v_mfma_f32_16x16x32_bf16 v[88:91], a[176:179], a[200:203], v[88:91]
ds_read_b64_tr_b16 a[172:173], v197 offset:256
ds_read_b64_tr_b16 a[174:175], v197 offset:2304
v_mfma_f32_16x16x32_bf16 v[120:123], a[176:179], a[204:207], v[120:123]
ds_read_b64_tr_b16 a[176:177], v198 offset:256
ds_read_b64_tr_b16 a[178:179], v198 offset:2304
v_mfma_f32_16x16x32_bf16 v[92:95], a[180:183], a[200:203], v[92:95]
s_add_u32 m0, s85, 32768
v_mfma_f32_16x16x32_bf16 v[124:127], a[180:183], a[204:207], v[124:127]
buffer_load_dwordx4 v146, s[24:27], s43 offen offset:0 lds
v_mfma_f32_16x16x32_bf16 v[96:99], a[184:187], a[200:203], v[96:99]
ds_read_b64_tr_b16 a[180:181], v199 offset:256
ds_read_b64_tr_b16 a[182:183], v199 offset:2304
v_mfma_f32_16x16x32_bf16 v[128:131], a[184:187], a[204:207], v[128:131]
ds_read_b64_tr_b16 a[184:185], v200 offset:256
ds_read_b64_tr_b16 a[186:187], v200 offset:2304
v_mfma_f32_16x16x32_bf16 v[100:103], a[188:191], a[200:203], v[100:103]
v_mfma_f32_16x16x32_bf16 v[132:135], a[188:191], a[204:207], v[132:135]
s_waitcnt lgkmcnt(8)
ds_read_b64_tr_b16 a[188:189], v201 offset:256
ds_read_b64_tr_b16 a[190:191], v201 offset:2304
v_mfma_f32_16x16x32_bf16 v[8:11], a[128:131], a[192:195], v[8:11]
buffer_load_dwordx4 v147, s[24:27], s43 offen offset:1024 lds
v_mfma_f32_16x16x32_bf16 v[40:43], a[128:131], a[196:199], v[40:43]
s_cmp_eq_u32 s74, 5
s_cselect_b32 s72, s73, 128
ds_read_b128 a[200:203], v203 offset:0
ds_read_b128 a[204:207], v203 offset:2048
v_mfma_f32_16x16x32_bf16 v[12:15], a[132:135], a[192:195], v[12:15]
s_add_u32 s43, s43, s72
v_mfma_f32_16x16x32_bf16 v[44:47], a[132:135], a[196:199], v[44:47]
s_add_u32 m0, s44, 0
v_smfmac_f32_16x16x64_bf16 a[248:251], a[208:211], a[128:135], v235
buffer_load_dwordx4 v136, s[16:19], s42 offen offset:0 lds
v_mfma_f32_16x16x32_bf16 v[72:75], a[160:163], a[192:195], v[72:75]
ds_read_b64_tr_b16 a[128:129], v194 offset:16384
ds_read_b64_tr_b16 a[130:131], v194 offset:18432
v_mfma_f32_16x16x32_bf16 v[104:107], a[160:163], a[196:199], v[104:107]
ds_read_b64_tr_b16 a[132:133], v195 offset:16384
ds_read_b64_tr_b16 a[134:135], v195 offset:18432
v_mfma_f32_16x16x32_bf16 v[76:79], a[164:167], a[192:195], v[76:79]
v_mfma_f32_16x16x32_bf16 v[108:111], a[164:167], a[196:199], v[108:111]
buffer_load_dwordx4 v137, s[16:19], s42 offen offset:1024 lds
v_smfmac_f32_16x16x64_bf16 a[252:255], a[208:211], a[160:167], v235
ds_read_b64_tr_b16 a[160:161], v194 offset:16640
ds_read_b64_tr_b16 a[162:163], v194 offset:18688
v_mfma_f32_16x16x32_bf16 v[16:19], a[136:139], a[192:195], v[16:19]
ds_read_b64_tr_b16 a[164:165], v195 offset:16640
ds_read_b64_tr_b16 a[166:167], v195 offset:18688
v_mfma_f32_16x16x32_bf16 v[48:51], a[136:139], a[196:199], v[48:51]
ds_read_b64_tr_b16 a[136:137], v196 offset:16384
ds_read_b64_tr_b16 a[138:139], v196 offset:18432
v_mfma_f32_16x16x32_bf16 v[20:23], a[140:143], a[192:195], v[20:23]
buffer_load_dwordx4 v138, s[16:19], s42 offen offset:2048 lds
v_mfma_f32_16x16x32_bf16 v[52:55], a[140:143], a[196:199], v[52:55]
ds_read_b64_tr_b16 a[140:141], v197 offset:16384
ds_read_b64_tr_b16 a[142:143], v197 offset:18432
v_mfma_f32_16x16x32_bf16 v[24:27], a[144:147], a[192:195], v[24:27]
v_mfma_f32_16x16x32_bf16 v[56:59], a[144:147], a[196:199], v[56:59]
ds_read_b64_tr_b16 a[144:145], v198 offset:16384
ds_read_b64_tr_b16 a[146:147], v198 offset:18432
v_mfma_f32_16x16x32_bf16 v[28:31], a[148:151], a[192:195], v[28:31]
buffer_load_dwordx4 v139, s[16:19], s42 offen offset:3072 lds
v_mfma_f32_16x16x32_bf16 v[60:63], a[148:151], a[196:199], v[60:63]
ds_read_b64_tr_b16 a[148:149], v199 offset:16384
ds_read_b64_tr_b16 a[150:151], v199 offset:18432
v_mfma_f32_16x16x32_bf16 v[32:35], a[152:155], a[192:195], v[32:35]
v_mfma_f32_16x16x32_bf16 v[64:67], a[152:155], a[196:199], v[64:67]
ds_read_b64_tr_b16 a[152:153], v200 offset:16384
ds_read_b64_tr_b16 a[154:155], v200 offset:18432
v_mfma_f32_16x16x32_bf16 v[36:39], a[156:159], a[192:195], v[36:39]
s_add_u32 m0, s44, 4096
v_mfma_f32_16x16x32_bf16 v[68:71], a[156:159], a[196:199], v[68:71]
buffer_load_dwordx4 v140, s[16:19], s42 offen offset:0 lds
v_mfma_f32_16x16x32_bf16 v[80:83], a[168:171], a[192:195], v[80:83]
ds_read_b64_tr_b16 a[156:157], v201 offset:16384
ds_read_b64_tr_b16 a[158:159], v201 offset:18432
v_mfma_f32_16x16x32_bf16 v[112:115], a[168:171], a[196:199], v[112:115]
s_waitcnt lgkmcnt(8)
ds_read_b64_tr_b16 a[168:169], v196 offset:16640
ds_read_b64_tr_b16 a[170:171], v196 offset:18688
v_mfma_f32_16x16x32_bf16 v[84:87], a[172:175], a[192:195], v[84:87]
v_mfma_f32_16x16x32_bf16 v[116:119], a[172:175], a[196:199], v[116:119]
buffer_load_dwordx4 v141, s[16:19], s42 offen offset:1024 lds
v_mfma_f32_16x16x32_bf16 v[88:91], a[176:179], a[192:195], v[88:91]
ds_read_b64_tr_b16 a[172:173], v197 offset:16640
ds_read_b64_tr_b16 a[174:175], v197 offset:18688
v_mfma_f32_16x16x32_bf16 v[120:123], a[176:179], a[196:199], v[120:123]
ds_read_b64_tr_b16 a[176:177], v198 offset:16640
ds_read_b64_tr_b16 a[178:179], v198 offset:18688
v_mfma_f32_16x16x32_bf16 v[92:95], a[180:183], a[192:195], v[92:95]
v_mfma_f32_16x16x32_bf16 v[124:127], a[180:183], a[196:199], v[124:127]
buffer_load_dwordx4 v142, s[16:19], s42 offen offset:2048 lds
v_mfma_f32_16x16x32_bf16 v[96:99], a[184:187], a[192:195], v[96:99]
ds_read_b64_tr_b16 a[180:181], v199 offset:16640
ds_read_b64_tr_b16 a[182:183], v199 offset:18688
v_mfma_f32_16x16x32_bf16 v[128:131], a[184:187], a[196:199], v[128:131]
ds_read_b64_tr_b16 a[184:185], v200 offset:16640
ds_read_b64_tr_b16 a[186:187], v200 offset:18688
v_mfma_f32_16x16x32_bf16 v[100:103], a[188:191], a[192:195], v[100:103]
v_mfma_f32_16x16x32_bf16 v[132:135], a[188:191], a[196:199], v[132:135]
ds_read_b64_tr_b16 a[188:189], v201 offset:16640
ds_read_b64_tr_b16 a[190:191], v201 offset:18688
v_mfma_f32_16x16x32_bf16 v[8:11], a[128:131], a[200:203], v[8:11]
buffer_load_dwordx4 v143, s[16:19], s42 offen offset:3072 lds
v_mfma_f32_16x16x32_bf16 v[40:43], a[128:131], a[204:207], v[40:43]
v_mfma_f32_16x16x32_bf16 v[12:15], a[132:135], a[200:203], v[12:15]
s_lshl_b32 s72, s72, 12
v_mfma_f32_16x16x32_bf16 v[44:47], a[132:135], a[204:207], v[44:47]
s_add_u32 s42, s42, s72
v_smfmac_f32_16x16x64_bf16 a[248:251], a[208:211], a[128:135], v235
v_mfma_f32_16x16x32_bf16 v[72:75], a[160:163], a[200:203], v[72:75]
v_mfma_f32_16x16x32_bf16 v[104:107], a[160:163], a[204:207], v[104:107]
s_waitcnt vmcnt(12) lgkmcnt(0)
s_barrier
s_cmp_lg_u32 s32, 0
s_cbranch_scc1 K_W0_3
s_lshl_b32 s48, s34, 4
s_mov_b64 exec, 1
buffer_atomic_add v255, v234, s[28:31], s48 offen sc1
s_mov_b64 exec, -1
K_W0_3:
v_mfma_f32_16x16x32_bf16 v[76:79], a[164:167], a[200:203], v[76:79]
s_add_u32 m0, s45, 131072
ds_read_b128 a[192:195], v212 offset:0
ds_read_b128 a[196:199], v212 offset:2048
v_mfma_f32_16x16x32_bf16 v[108:111], a[164:167], a[204:207], v[108:111]
buffer_load_dwordx4 v144, s[24:27], s43 offen offset:0 lds
v_smfmac_f32_16x16x64_bf16 a[252:255], a[208:211], a[160:167], v235
ds_read_b64_tr_b16 a[128:129], v204 offset:0
ds_read_b64_tr_b16 a[130:131], v204 offset:2048
v_mfma_f32_16x16x32_bf16 v[16:19], a[136:139], a[200:203], v[16:19]
ds_read_b64_tr_b16 a[132:133], v205 offset:0
ds_read_b64_tr_b16 a[134:135], v205 offset:2048
v_mfma_f32_16x16x32_bf16 v[48:51], a[136:139], a[204:207], v[48:51]
ds_read_b64_tr_b16 a[160:161], v204 offset:256
ds_read_b64_tr_b16 a[162:163], v204 offset:2304
v_mfma_f32_16x16x32_bf16 v[20:23], a[140:143], a[200:203], v[20:23]
ds_read_b64_tr_b16 a[164:165], v205 offset:256
ds_read_b64_tr_b16 a[166:167], v205 offset:2304
v_mfma_f32_16x16x32_bf16 v[52:55], a[140:143], a[204:207], v[52:55]
buffer_load_dwordx4 v145, s[24:27], s43 offen offset:1024 lds
v_mfma_f32_16x16x32_bf16 v[24:27], a[144:147], a[200:203], v[24:27]
ds_read_b64_tr_b16 a[136:137], v206 offset:0
ds_read_b64_tr_b16 a[138:139], v206 offset:2048
v_mfma_f32_16x16x32_bf16 v[56:59], a[144:147], a[204:207], v[56:59]
ds_read_b64_tr_b16 a[140:141], v207 offset:0
ds_read_b64_tr_b16 a[142:143], v207 offset:2048
v_mfma_f32_16x16x32_bf16 v[28:31], a[148:151], a[200:203], v[28:31]
s_add_u32 m0, s85, 131072
ds_read_b64_tr_b16 a[144:145], v208 offset:0
ds_read_b64_tr_b16 a[146:147], v208 offset:2048
v_mfma_f32_16x16x32_bf16 v[60:63], a[148:151], a[204:207], v[60:63]
buffer_load_dwordx4 v146, s[24:27], s43 offen offset:0 lds
v_mfma_f32_16x16x32_bf16 v[32:35], a[152:155], a[200:203], v[32:35]
ds_read_b64_tr_b16 a[148:149], v209 offset:0
ds_read_b64_tr_b16 a[150:151], v209 offset:2048
v_mfma_f32_16x16x32_bf16 v[64:67], a[152:155], a[204:207], v[64:67]
ds_read_b64_tr_b16 a[152:153], v210 offset:0
ds_read_b64_tr_b16 a[154:155], v210 offset:2048
v_mfma_f32_16x16x32_bf16 v[36:39], a[156:159], a[200:203], v[36:39]
v_mfma_f32_16x16x32_bf16 v[68:71], a[156:159], a[204:207], v[68:71]
buffer_load_dwordx4 v147, s[24:27], s43 offen offset:1024 lds
v_mfma_f32_16x16x32_bf16 v[80:83], a[168:171], a[200:203], v[80:83]
s_cmp_eq_u32 s74, 4
s_cselect_b32 s72, s73, 128
ds_read_b64_tr_b16 a[156:157], v211 offset:0
ds_read_b64_tr_b16 a[158:159], v211 offset:2048
v_mfma_f32_16x16x32_bf16 v[112:115], a[168:171], a[204:207], v[112:115]
s_add_u32 s43, s43, s72
ds_read_b64_tr_b16 a[168:169], v206 offset:256
ds_read_b64_tr_b16 a[170:171], v206 offset:2304
v_mfma_f32_16x16x32_bf16 v[84:87], a[172:175], a[200:203], v[84:87]
s_add_u32 m0, s44, 98304
v_mfma_f32_16x16x32_bf16 v[116:119], a[172:175], a[204:207], v[116:119]
buffer_load_dwordx4 v136, s[16:19], s42 offen offset:0 lds
v_mfma_f32_16x16x32_bf16 v[88:91], a[176:179], a[200:203], v[88:91]
ds_read_b64_tr_b16 a[172:173], v207 offset:256
ds_read_b64_tr_b16 a[174:175], v207 offset:2304
v_mfma_f32_16x16x32_bf16 v[120:123], a[176:179], a[204:207], v[120:123]
ds_read_b64_tr_b16 a[176:177], v208 offset:256
ds_read_b64_tr_b16 a[178:179], v208 offset:2304
v_mfma_f32_16x16x32_bf16 v[92:95], a[180:183], a[200:203], v[92:95]
v_mfma_f32_16x16x32_bf16 v[124:127], a[180:183], a[204:207], v[124:127]
buffer_load_dwordx4 v137, s[16:19], s42 offen offset:1024 lds
v_mfma_f32_16x16x32_bf16 v[96:99], a[184:187], a[200:203], v[96:99]
ds_read_b64_tr_b16 a[180:181], v209 offset:256
ds_read_b64_tr_b16 a[182:183], v209 offset:2304
v_mfma_f32_16x16x32_bf16 v[128:131], a[184:187], a[204:207], v[128:131]
ds_read_b64_tr_b16 a[184:185], v210 offset:256
ds_read_b64_tr_b16 a[186:187], v210 offset:2304
v_mfma_f32_16x16x32_bf16 v[100:103], a[188:191], a[200:203], v[100:103]
v_mfma_f32_16x16x32_bf16 v[132:135], a[188:191], a[204:207], v[132:135]
s_waitcnt lgkmcnt(8)
ds_read_b64_tr_b16 a[188:189], v211 offset:256
ds_read_b64_tr_b16 a[190:191], v211 offset:2304
v_mfma_f32_16x16x32_bf16 v[8:11], a[128:131], a[192:195], v[8:11]
buffer_load_dwordx4 v138, s[16:19], s42 offen offset:2048 lds
v_mfma_f32_16x16x32_bf16 v[40:43], a[128:131], a[196:199], v[40:43]
ds_read_b128 a[200:203], v213 offset:0
ds_read_b128 a[204:207], v213 offset:2048
v_mfma_f32_16x16x32_bf16 v[12:15], a[132:135], a[192:195], v[12:15]
s_waitcnt vmcnt(51)
v_and_b32 v160, 0x7f807f80, v160
v_and_b32 v161, 0x7f807f80, v161
v_mfma_f32_16x16x32_bf16 v[44:47], a[132:135], a[196:199], v[44:47]
v_and_b32 v162, 0x7f807f80, v162
v_and_b32 v163, 0x7f807f80, v163
v_smfmac_f32_16x16x64_bf16 a[248:251], a[208:211], a[128:135], v235
buffer_load_dwordx4 v139, s[16:19], s42 offen offset:3072 lds
v_mfma_f32_16x16x32_bf16 v[72:75], a[160:163], a[192:195], v[72:75]
ds_read_b64_tr_b16 a[128:129], v204 offset:16384
ds_read_b64_tr_b16 a[130:131], v204 offset:18432
v_mfma_f32_16x16x32_bf16 v[104:107], a[160:163], a[196:199], v[104:107]
ds_read_b64_tr_b16 a[132:133], v205 offset:16384
ds_read_b64_tr_b16 a[134:135], v205 offset:18432
v_mfma_f32_16x16x32_bf16 v[76:79], a[164:167], a[192:195], v[76:79]
s_add_u32 m0, s44, 102400
v_pk_max_u16 v160, v160, v161
v_pk_max_u16 v162, v162, v163
v_mfma_f32_16x16x32_bf16 v[108:111], a[164:167], a[196:199], v[108:111]
buffer_load_dwordx4 v140, s[16:19], s42 offen offset:0 lds
v_smfmac_f32_16x16x64_bf16 a[252:255], a[208:211], a[160:167], v235
ds_read_b64_tr_b16 a[160:161], v204 offset:16640
ds_read_b64_tr_b16 a[162:163], v204 offset:18688
v_mfma_f32_16x16x32_bf16 v[16:19], a[136:139], a[192:195], v[16:19]
ds_read_b64_tr_b16 a[164:165], v205 offset:16640
ds_read_b64_tr_b16 a[166:167], v205 offset:18688
v_mfma_f32_16x16x32_bf16 v[48:51], a[136:139], a[196:199], v[48:51]
ds_read_b64_tr_b16 a[136:137], v206 offset:16384
ds_read_b64_tr_b16 a[138:139], v206 offset:18432
v_mfma_f32_16x16x32_bf16 v[20:23], a[140:143], a[192:195], v[20:23]
buffer_load_dwordx4 v141, s[16:19], s42 offen offset:1024 lds
v_mfma_f32_16x16x32_bf16 v[52:55], a[140:143], a[196:199], v[52:55]
ds_read_b64_tr_b16 a[140:141], v207 offset:16384
ds_read_b64_tr_b16 a[142:143], v207 offset:18432
v_mfma_f32_16x16x32_bf16 v[24:27], a[144:147], a[192:195], v[24:27]
v_pk_max_u16 v160, v160, v162
v_lshlrev_b32 v161, 16, v160
v_mfma_f32_16x16x32_bf16 v[56:59], a[144:147], a[196:199], v[56:59]
ds_read_b64_tr_b16 a[144:145], v208 offset:16384
ds_read_b64_tr_b16 a[146:147], v208 offset:18432
v_mfma_f32_16x16x32_bf16 v[28:31], a[148:151], a[192:195], v[28:31]
buffer_load_dwordx4 v142, s[16:19], s42 offen offset:2048 lds
v_mfma_f32_16x16x32_bf16 v[60:63], a[148:151], a[196:199], v[60:63]
ds_read_b64_tr_b16 a[148:149], v209 offset:16384
ds_read_b64_tr_b16 a[150:151], v209 offset:18432
v_mfma_f32_16x16x32_bf16 v[32:35], a[152:155], a[192:195], v[32:35]
v_max_u32 v160, v160, v161
v_and_b32 v160, 0x7f800000, v160
v_mfma_f32_16x16x32_bf16 v[64:67], a[152:155], a[196:199], v[64:67]
ds_read_b64_tr_b16 a[152:153], v210 offset:16384
ds_read_b64_tr_b16 a[154:155], v210 offset:18432
v_mfma_f32_16x16x32_bf16 v[36:39], a[156:159], a[192:195], v[36:39]
v_nop
v_nop
v_mfma_f32_16x16x32_bf16 v[68:71], a[156:159], a[196:199], v[68:71]
buffer_load_dwordx4 v143, s[16:19], s42 offen offset:3072 lds
v_mfma_f32_16x16x32_bf16 v[80:83], a[168:171], a[192:195], v[80:83]
s_waitcnt lgkmcnt(8)
ds_read_b64_tr_b16 a[156:157], v211 offset:16384
ds_read_b64_tr_b16 a[158:159], v211 offset:18432
v_mfma_f32_16x16x32_bf16 v[112:115], a[168:171], a[196:199], v[112:115]
s_lshl_b32 s72, s72, 12
ds_read_b64_tr_b16 a[168:169], v206 offset:16640
ds_read_b64_tr_b16 a[170:171], v206 offset:18688
v_mfma_f32_16x16x32_bf16 v[84:87], a[172:175], a[192:195], v[84:87]
s_add_u32 s42, s42, s72
v_min_u32_dpp v160, v160, v160 row_ror:8 row_mask:0xf bank_mask:0xf
v_nop
v_mfma_f32_16x16x32_bf16 v[116:119], a[172:175], a[196:199], v[116:119]
ds_read_b64_tr_b16 a[172:173], v207 offset:16640
ds_read_b64_tr_b16 a[174:175], v207 offset:18688
v_mfma_f32_16x16x32_bf16 v[88:91], a[176:179], a[192:195], v[88:91]
v_nop
v_min_u32_dpp v160, v160, v160 row_ror:4 row_mask:0xf bank_mask:0xf
v_mfma_f32_16x16x32_bf16 v[120:123], a[176:179], a[196:199], v[120:123]
ds_read_b64_tr_b16 a[176:177], v208 offset:16640
ds_read_b64_tr_b16 a[178:179], v208 offset:18688
v_mfma_f32_16x16x32_bf16 v[92:95], a[180:183], a[192:195], v[92:95]
v_nop
v_nop
v_mfma_f32_16x16x32_bf16 v[124:127], a[180:183], a[196:199], v[124:127]
ds_read_b64_tr_b16 a[180:181], v209 offset:16640
ds_read_b64_tr_b16 a[182:183], v209 offset:18688
v_mfma_f32_16x16x32_bf16 v[96:99], a[184:187], a[192:195], v[96:99]
v_min_u32_dpp v160, v160, v160 row_ror:2 row_mask:0xf bank_mask:0xf
v_nop
v_mfma_f32_16x16x32_bf16 v[128:131], a[184:187], a[196:199], v[128:131]
ds_read_b64_tr_b16 a[184:185], v210 offset:16640
ds_read_b64_tr_b16 a[186:187], v210 offset:18688
v_mfma_f32_16x16x32_bf16 v[100:103], a[188:191], a[192:195], v[100:103]
v_mfma_f32_16x16x32_bf16 v[132:135], a[188:191], a[196:199], v[132:135]
ds_read_b64_tr_b16 a[188:189], v211 offset:16640
ds_read_b64_tr_b16 a[190:191], v211 offset:18688
v_mfma_f32_16x16x32_bf16 v[8:11], a[128:131], a[200:203], v[8:11]
v_nop
v_min_u32_dpp v160, v160, v160 row_ror:1 row_mask:0xf bank_mask:0xf
v_mfma_f32_16x16x32_bf16 v[40:43], a[128:131], a[204:207], v[40:43]
v_nop
v_readlane_b32 s97, v160, 0
v_mfma_f32_16x16x32_bf16 v[12:15], a[132:135], a[200:203], v[12:15]
v_readlane_b32 s46, v160, 16
v_readlane_b32 s47, v160, 32
v_mfma_f32_16x16x32_bf16 v[44:47], a[132:135], a[204:207], v[44:47]
s_min_u32 s97, s97, s46
v_readlane_b32 s46, v160, 48
v_smfmac_f32_16x16x64_bf16 a[248:251], a[208:211], a[128:135], v235
s_min_u32 s97, s97, s47
v_mfma_f32_16x16x32_bf16 v[72:75], a[160:163], a[200:203], v[72:75]
s_min_u32 s97, s97, s46
v_mfma_f32_16x16x32_bf16 v[104:107], a[160:163], a[204:207], v[104:107]
s_waitcnt vmcnt(12) lgkmcnt(0)
s_barrier
s_min_u32 s97, s97, 0x70000000
v_mfma_f32_16x16x32_bf16 v[76:79], a[164:167], a[200:203], v[76:79]
s_add_u32 m0, s45, 81920
ds_read_b128 a[192:195], v192 offset:0
ds_read_b128 a[196:199], v192 offset:2048
v_mfma_f32_16x16x32_bf16 v[108:111], a[164:167], a[204:207], v[108:111]
s_add_u32 s46, s97, 0x2400000
buffer_load_dwordx4 v144, s[24:27], s43 offen offset:0 lds
v_smfmac_f32_16x16x64_bf16 a[252:255], a[208:211], a[160:167], v235
s_cmp_lg_u32 s97, 0
s_cselect_b32 s97, s46, 0
ds_read_b64_tr_b16 a[128:129], v184 offset:0
ds_read_b64_tr_b16 a[130:131], v184 offset:2048
v_mfma_f32_16x16x32_bf16 v[16:19], a[136:139], a[200:203], v[16:19]
ds_read_b64_tr_b16 a[132:133], v185 offset:0
ds_read_b64_tr_b16 a[134:135], v185 offset:2048
v_mfma_f32_16x16x32_bf16 v[48:51], a[136:139], a[204:207], v[48:51]
ds_read_b64_tr_b16 a[160:161], v184 offset:256
ds_read_b64_tr_b16 a[162:163], v184 offset:2304
v_mfma_f32_16x16x32_bf16 v[20:23], a[140:143], a[200:203], v[20:23]
buffer_load_dwordx4 v145, s[24:27], s43 offen offset:1024 lds
v_mfma_f32_16x16x32_bf16 v[52:55], a[140:143], a[204:207], v[52:55]
ds_read_b64_tr_b16 a[164:165], v185 offset:256
ds_read_b64_tr_b16 a[166:167], v185 offset:2304
v_mfma_f32_16x16x32_bf16 v[24:27], a[144:147], a[200:203], v[24:27]
ds_read_b64_tr_b16 a[136:137], v186 offset:0
ds_read_b64_tr_b16 a[138:139], v186 offset:2048
v_mfma_f32_16x16x32_bf16 v[56:59], a[144:147], a[204:207], v[56:59]
s_add_u32 m0, s85, 81920
ds_read_b64_tr_b16 a[140:141], v187 offset:0
ds_read_b64_tr_b16 a[142:143], v187 offset:2048
v_mfma_f32_16x16x32_bf16 v[28:31], a[148:151], a[200:203], v[28:31]
buffer_load_dwordx4 v146, s[24:27], s43 offen offset:0 lds
v_mfma_f32_16x16x32_bf16 v[60:63], a[148:151], a[204:207], v[60:63]
ds_read_b64_tr_b16 a[144:145], v188 offset:0
ds_read_b64_tr_b16 a[146:147], v188 offset:2048
v_mfma_f32_16x16x32_bf16 v[32:35], a[152:155], a[200:203], v[32:35]
ds_read_b64_tr_b16 a[148:149], v189 offset:0
ds_read_b64_tr_b16 a[150:151], v189 offset:2048
v_mfma_f32_16x16x32_bf16 v[64:67], a[152:155], a[204:207], v[64:67]
ds_read_b64_tr_b16 a[152:153], v190 offset:0
ds_read_b64_tr_b16 a[154:155], v190 offset:2048
v_mfma_f32_16x16x32_bf16 v[36:39], a[156:159], a[200:203], v[36:39]
buffer_load_dwordx4 v147, s[24:27], s43 offen offset:1024 lds
v_mfma_f32_16x16x32_bf16 v[68:71], a[156:159], a[204:207], v[68:71]
ds_read_b64_tr_b16 a[156:157], v191 offset:0
ds_read_b64_tr_b16 a[158:159], v191 offset:2048
v_mfma_f32_16x16x32_bf16 v[80:83], a[168:171], a[200:203], v[80:83]
s_cmp_eq_u32 s74, 3
s_cselect_b32 s72, s73, 128
v_mov_b32 v160, s97
v_accvgpr_write_b32 a0, v160
v_mfma_f32_16x16x32_bf16 v[112:115], a[168:171], a[204:207], v[112:115]
s_add_u32 s43, s43, s72
ds_read_b64_tr_b16 a[168:169], v186 offset:256
ds_read_b64_tr_b16 a[170:171], v186 offset:2304
v_mfma_f32_16x16x32_bf16 v[84:87], a[172:175], a[200:203], v[84:87]
s_add_u32 m0, s44, 49152
v_accvgpr_write_b32 a1, v160
v_accvgpr_write_b32 a2, v160
v_mfma_f32_16x16x32_bf16 v[116:119], a[172:175], a[204:207], v[116:119]
buffer_load_dwordx4 v136, s[16:19], s42 offen offset:0 lds
v_mfma_f32_16x16x32_bf16 v[88:91], a[176:179], a[200:203], v[88:91]
ds_read_b64_tr_b16 a[172:173], v187 offset:256
ds_read_b64_tr_b16 a[174:175], v187 offset:2304
v_mfma_f32_16x16x32_bf16 v[120:123], a[176:179], a[204:207], v[120:123]
ds_read_b64_tr_b16 a[176:177], v188 offset:256
ds_read_b64_tr_b16 a[178:179], v188 offset:2304
v_mfma_f32_16x16x32_bf16 v[92:95], a[180:183], a[200:203], v[92:95]
v_accvgpr_write_b32 a3, v160
v_mfma_f32_16x16x32_bf16 v[124:127], a[180:183], a[204:207], v[124:127]
buffer_load_dwordx4 v137, s[16:19], s42 offen offset:1024 lds
v_mfma_f32_16x16x32_bf16 v[96:99], a[184:187], a[200:203], v[96:99]
ds_read_b64_tr_b16 a[180:181], v189 offset:256
ds_read_b64_tr_b16 a[182:183], v189 offset:2304
v_mfma_f32_16x16x32_bf16 v[128:131], a[184:187], a[204:207], v[128:131]
ds_read_b64_tr_b16 a[184:185], v190 offset:256
ds_read_b64_tr_b16 a[186:187], v190 offset:2304
v_mfma_f32_16x16x32_bf16 v[100:103], a[188:191], a[200:203], v[100:103]
v_mfma_f32_16x16x32_bf16 v[132:135], a[188:191], a[204:207], v[132:135]
s_waitcnt lgkmcnt(8)
ds_read_b64_tr_b16 a[188:189], v191 offset:256
ds_read_b64_tr_b16 a[190:191], v191 offset:2304
v_mfma_f32_16x16x32_bf16 v[8:11], a[128:131], a[192:195], v[8:11]
buffer_load_dwordx4 v138, s[16:19], s42 offen offset:2048 lds
v_mfma_f32_16x16x32_bf16 v[40:43], a[128:131], a[196:199], v[40:43]
ds_read_b128 a[200:203], v193 offset:0
ds_read_b128 a[204:207], v193 offset:2048
v_mfma_f32_16x16x32_bf16 v[12:15], a[132:135], a[192:195], v[12:15]
v_accvgpr_write_b32 a4, v160
v_accvgpr_write_b32 a5, v160
v_mfma_f32_16x16x32_bf16 v[44:47], a[132:135], a[196:199], v[44:47]
v_accvgpr_write_b32 a6, v160
v_accvgpr_write_b32 a7, v160
v_smfmac_f32_16x16x64_bf16 a[248:251], a[208:211], a[128:135], v235
buffer_load_dwordx4 v139, s[16:19], s42 offen offset:3072 lds
v_mfma_f32_16x16x32_bf16 v[72:75], a[160:163], a[192:195], v[72:75]
ds_read_b64_tr_b16 a[128:129], v184 offset:16384
ds_read_b64_tr_b16 a[130:131], v184 offset:18432
v_mfma_f32_16x16x32_bf16 v[104:107], a[160:163], a[196:199], v[104:107]
ds_read_b64_tr_b16 a[132:133], v185 offset:16384
ds_read_b64_tr_b16 a[134:135], v185 offset:18432
v_mfma_f32_16x16x32_bf16 v[76:79], a[164:167], a[192:195], v[76:79]
s_add_u32 m0, s44, 53248
v_accvgpr_write_b32 a8, v160
v_accvgpr_write_b32 a9, v160
v_mfma_f32_16x16x32_bf16 v[108:111], a[164:167], a[196:199], v[108:111]
buffer_load_dwordx4 v140, s[16:19], s42 offen offset:0 lds
v_smfmac_f32_16x16x64_bf16 a[252:255], a[208:211], a[160:167], v235
ds_read_b64_tr_b16 a[160:161], v184 offset:16640
ds_read_b64_tr_b16 a[162:163], v184 offset:18688
v_mfma_f32_16x16x32_bf16 v[16:19], a[136:139], a[192:195], v[16:19]
ds_read_b64_tr_b16 a[164:165], v185 offset:16640
ds_read_b64_tr_b16 a[166:167], v185 offset:18688
v_mfma_f32_16x16x32_bf16 v[48:51], a[136:139], a[196:199], v[48:51]
ds_read_b64_tr_b16 a[136:137], v186 offset:16384
ds_read_b64_tr_b16 a[138:139], v186 offset:18432
v_mfma_f32_16x16x32_bf16 v[20:23], a[140:143], a[192:195], v[20:23]
v_accvgpr_write_b32 a10, v160
v_accvgpr_write_b32 a11, v160
v_mfma_f32_16x16x32_bf16 v[52:55], a[140:143], a[196:199], v[52:55]
buffer_load_dwordx4 v141, s[16:19], s42 offen offset:1024 lds
v_mfma_f32_16x16x32_bf16 v[24:27], a[144:147], a[192:195], v[24:27]
ds_read_b64_tr_b16 a[140:141], v187 offset:16384
ds_read_b64_tr_b16 a[142:143], v187 offset:18432
v_mfma_f32_16x16x32_bf16 v[56:59], a[144:147], a[196:199], v[56:59]
ds_read_b64_tr_b16 a[144:145], v188 offset:16384
ds_read_b64_tr_b16 a[146:147], v188 offset:18432
v_mfma_f32_16x16x32_bf16 v[28:31], a[148:151], a[192:195], v[28:31]
v_accvgpr_write_b32 a12, v160
v_accvgpr_write_b32 a13, v160
v_mfma_f32_16x16x32_bf16 v[60:63], a[148:151], a[196:199], v[60:63]
buffer_load_dwordx4 v142, s[16:19], s42 offen offset:2048 lds
v_mfma_f32_16x16x32_bf16 v[32:35], a[152:155], a[192:195], v[32:35]
ds_read_b64_tr_b16 a[148:149], v189 offset:16384
ds_read_b64_tr_b16 a[150:151], v189 offset:18432
v_mfma_f32_16x16x32_bf16 v[64:67], a[152:155], a[196:199], v[64:67]
ds_read_b64_tr_b16 a[152:153], v190 offset:16384
ds_read_b64_tr_b16 a[154:155], v190 offset:18432
v_mfma_f32_16x16x32_bf16 v[36:39], a[156:159], a[192:195], v[36:39]
v_accvgpr_write_b32 a14, v160
v_accvgpr_write_b32 a15, v160
v_mfma_f32_16x16x32_bf16 v[68:71], a[156:159], a[196:199], v[68:71]
buffer_load_dwordx4 v143, s[16:19], s42 offen offset:3072 lds
v_mfma_f32_16x16x32_bf16 v[80:83], a[168:171], a[192:195], v[80:83]
s_waitcnt lgkmcnt(8)
ds_read_b64_tr_b16 a[156:157], v191 offset:16384
ds_read_b64_tr_b16 a[158:159], v191 offset:18432
v_mfma_f32_16x16x32_bf16 v[112:115], a[168:171], a[196:199], v[112:115]
s_lshl_b32 s72, s72, 12
ds_read_b64_tr_b16 a[168:169], v186 offset:16640
ds_read_b64_tr_b16 a[170:171], v186 offset:18688
v_mfma_f32_16x16x32_bf16 v[84:87], a[172:175], a[192:195], v[84:87]
s_add_u32 s42, s42, s72
v_accvgpr_write_b32 a16, v160
v_accvgpr_write_b32 a17, v160
v_mfma_f32_16x16x32_bf16 v[116:119], a[172:175], a[196:199], v[116:119]
ds_read_b64_tr_b16 a[172:173], v187 offset:16640
ds_read_b64_tr_b16 a[174:175], v187 offset:18688
v_mfma_f32_16x16x32_bf16 v[88:91], a[176:179], a[192:195], v[88:91]
v_accvgpr_write_b32 a18, v160
v_accvgpr_write_b32 a19, v160
v_mfma_f32_16x16x32_bf16 v[120:123], a[176:179], a[196:199], v[120:123]
ds_read_b64_tr_b16 a[176:177], v188 offset:16640
ds_read_b64_tr_b16 a[178:179], v188 offset:18688
v_mfma_f32_16x16x32_bf16 v[92:95], a[180:183], a[192:195], v[92:95]
v_accvgpr_write_b32 a20, v160
v_accvgpr_write_b32 a21, v160
v_mfma_f32_16x16x32_bf16 v[124:127], a[180:183], a[196:199], v[124:127]
ds_read_b64_tr_b16 a[180:181], v189 offset:16640
ds_read_b64_tr_b16 a[182:183], v189 offset:18688
v_mfma_f32_16x16x32_bf16 v[96:99], a[184:187], a[192:195], v[96:99]
v_accvgpr_write_b32 a22, v160
v_accvgpr_write_b32 a23, v160
v_mfma_f32_16x16x32_bf16 v[128:131], a[184:187], a[196:199], v[128:131]
ds_read_b64_tr_b16 a[184:185], v190 offset:16640
ds_read_b64_tr_b16 a[186:187], v190 offset:18688
v_mfma_f32_16x16x32_bf16 v[100:103], a[188:191], a[192:195], v[100:103]
v_mfma_f32_16x16x32_bf16 v[132:135], a[188:191], a[196:199], v[132:135]
ds_read_b64_tr_b16 a[188:189], v191 offset:16640
ds_read_b64_tr_b16 a[190:191], v191 offset:18688
v_mfma_f32_16x16x32_bf16 v[8:11], a[128:131], a[200:203], v[8:11]
v_accvgpr_write_b32 a24, v160
v_accvgpr_write_b32 a25, v160
v_mfma_f32_16x16x32_bf16 v[40:43], a[128:131], a[204:207], v[40:43]
v_accvgpr_write_b32 a26, v160
v_accvgpr_write_b32 a27, v160
v_mfma_f32_16x16x32_bf16 v[12:15], a[132:135], a[200:203], v[12:15]
v_accvgpr_write_b32 a28, v160
v_accvgpr_write_b32 a29, v160
v_mfma_f32_16x16x32_bf16 v[44:47], a[132:135], a[204:207], v[44:47]
v_accvgpr_write_b32 a30, v160
v_accvgpr_write_b32 a31, v160
v_smfmac_f32_16x16x64_bf16 a[248:251], a[208:211], a[128:135], v235
v_accvgpr_write_b32 a32, v160
v_accvgpr_write_b32 a33, v160
v_mfma_f32_16x16x32_bf16 v[72:75], a[160:163], a[200:203], v[72:75]
v_accvgpr_write_b32 a34, v160
v_accvgpr_write_b32 a35, v160
v_mfma_f32_16x16x32_bf16 v[104:107], a[160:163], a[204:207], v[104:107]
s_waitcnt vmcnt(12) lgkmcnt(0)
s_barrier
v_mfma_f32_16x16x32_bf16 v[76:79], a[164:167], a[200:203], v[76:79]
s_add_u32 m0, s45, 32768
ds_read_b128 a[192:195], v202 offset:0
ds_read_b128 a[196:199], v202 offset:2048
v_mfma_f32_16x16x32_bf16 v[108:111], a[164:167], a[204:207], v[108:111]
buffer_load_dwordx4 v144, s[24:27], s43 offen offset:0 lds
v_smfmac_f32_16x16x64_bf16 a[252:255], a[208:211], a[160:167], v235
ds_read_b64_tr_b16 a[128:129], v194 offset:0
ds_read_b64_tr_b16 a[130:131], v194 offset:2048
v_mfma_f32_16x16x32_bf16 v[16:19], a[136:139], a[200:203], v[16:19]
ds_read_b64_tr_b16 a[132:133], v195 offset:0
ds_read_b64_tr_b16 a[134:135], v195 offset:2048
v_mfma_f32_16x16x32_bf16 v[48:51], a[136:139], a[204:207], v[48:51]
ds_read_b64_tr_b16 a[160:161], v194 offset:256
ds_read_b64_tr_b16 a[162:163], v194 offset:2304
v_mfma_f32_16x16x32_bf16 v[20:23], a[140:143], a[200:203], v[20:23]
buffer_load_dwordx4 v145, s[24:27], s43 offen offset:1024 lds
v_mfma_f32_16x16x32_bf16 v[52:55], a[140:143], a[204:207], v[52:55]
ds_read_b64_tr_b16 a[164:165], v195 offset:256
ds_read_b64_tr_b16 a[166:167], v195 offset:2304
v_mfma_f32_16x16x32_bf16 v[24:27], a[144:147], a[200:203], v[24:27]
ds_read_b64_tr_b16 a[136:137], v196 offset:0
ds_read_b64_tr_b16 a[138:139], v196 offset:2048
v_mfma_f32_16x16x32_bf16 v[56:59], a[144:147], a[204:207], v[56:59]
ds_read_b64_tr_b16 a[140:141], v197 offset:0
ds_read_b64_tr_b16 a[142:143], v197 offset:2048
v_mfma_f32_16x16x32_bf16 v[28:31], a[148:151], a[200:203], v[28:31]
s_add_u32 m0, s85, 32768
ds_read_b64_tr_b16 a[144:145], v198 offset:0
ds_read_b64_tr_b16 a[146:147], v198 offset:2048
v_mfma_f32_16x16x32_bf16 v[60:63], a[148:151], a[204:207], v[60:63]
buffer_load_dwordx4 v146, s[24:27], s43 offen offset:0 lds
v_mfma_f32_16x16x32_bf16 v[32:35], a[152:155], a[200:203], v[32:35]
ds_read_b64_tr_b16 a[148:149], v199 offset:0
ds_read_b64_tr_b16 a[150:151], v199 offset:2048
v_mfma_f32_16x16x32_bf16 v[64:67], a[152:155], a[204:207], v[64:67]
ds_read_b64_tr_b16 a[152:153], v200 offset:0
ds_read_b64_tr_b16 a[154:155], v200 offset:2048
v_mfma_f32_16x16x32_bf16 v[36:39], a[156:159], a[200:203], v[36:39]
v_accvgpr_write_b32 a36, v160
v_accvgpr_write_b32 a37, v160
v_mfma_f32_16x16x32_bf16 v[68:71], a[156:159], a[204:207], v[68:71]
buffer_load_dwordx4 v147, s[24:27], s43 offen offset:1024 lds
v_mfma_f32_16x16x32_bf16 v[80:83], a[168:171], a[200:203], v[80:83]
s_cmp_eq_u32 s74, 2
s_cselect_b32 s72, s73, 128
ds_read_b64_tr_b16 a[156:157], v201 offset:0
ds_read_b64_tr_b16 a[158:159], v201 offset:2048
v_mfma_f32_16x16x32_bf16 v[112:115], a[168:171], a[204:207], v[112:115]
s_add_u32 s43, s43, s72
ds_read_b64_tr_b16 a[168:169], v196 offset:256
ds_read_b64_tr_b16 a[170:171], v196 offset:2304
v_mfma_f32_16x16x32_bf16 v[84:87], a[172:175], a[200:203], v[84:87]
s_add_u32 m0, s44, 0
v_accvgpr_write_b32 a38, v160
v_accvgpr_write_b32 a39, v160
v_mfma_f32_16x16x32_bf16 v[116:119], a[172:175], a[204:207], v[116:119]
buffer_load_dwordx4 v136, s[16:19], s42 offen offset:0 lds
v_mfma_f32_16x16x32_bf16 v[88:91], a[176:179], a[200:203], v[88:91]
ds_read_b64_tr_b16 a[172:173], v197 offset:256
ds_read_b64_tr_b16 a[174:175], v197 offset:2304
v_mfma_f32_16x16x32_bf16 v[120:123], a[176:179], a[204:207], v[120:123]
ds_read_b64_tr_b16 a[176:177], v198 offset:256
ds_read_b64_tr_b16 a[178:179], v198 offset:2304
v_mfma_f32_16x16x32_bf16 v[92:95], a[180:183], a[200:203], v[92:95]
v_accvgpr_write_b32 a40, v160
v_accvgpr_write_b32 a41, v160
v_mfma_f32_16x16x32_bf16 v[124:127], a[180:183], a[204:207], v[124:127]
buffer_load_dwordx4 v137, s[16:19], s42 offen offset:1024 lds
v_mfma_f32_16x16x32_bf16 v[96:99], a[184:187], a[200:203], v[96:99]
ds_read_b64_tr_b16 a[180:181], v199 offset:256
ds_read_b64_tr_b16 a[182:183], v199 offset:2304
v_mfma_f32_16x16x32_bf16 v[128:131], a[184:187], a[204:207], v[128:131]
ds_read_b64_tr_b16 a[184:185], v200 offset:256
ds_read_b64_tr_b16 a[186:187], v200 offset:2304
v_mfma_f32_16x16x32_bf16 v[100:103], a[188:191], a[200:203], v[100:103]
v_mfma_f32_16x16x32_bf16 v[132:135], a[188:191], a[204:207], v[132:135]
s_waitcnt lgkmcnt(8)
ds_read_b64_tr_b16 a[188:189], v201 offset:256
ds_read_b64_tr_b16 a[190:191], v201 offset:2304
v_mfma_f32_16x16x32_bf16 v[8:11], a[128:131], a[192:195], v[8:11]
buffer_load_dwordx4 v138, s[16:19], s42 offen offset:2048 lds
v_mfma_f32_16x16x32_bf16 v[40:43], a[128:131], a[196:199], v[40:43]
ds_read_b128 a[200:203], v203 offset:0
ds_read_b128 a[204:207], v203 offset:2048
v_mfma_f32_16x16x32_bf16 v[12:15], a[132:135], a[192:195], v[12:15]
v_accvgpr_write_b32 a42, v160
v_accvgpr_write_b32 a43, v160
v_mfma_f32_16x16x32_bf16 v[44:47], a[132:135], a[196:199], v[44:47]
v_accvgpr_write_b32 a44, v160
v_accvgpr_write_b32 a45, v160
v_smfmac_f32_16x16x64_bf16 a[248:251], a[208:211], a[128:135], v235
ds_read_b64_tr_b16 a[128:129], v194 offset:16384
ds_read_b64_tr_b16 a[130:131], v194 offset:18432
v_mfma_f32_16x16x32_bf16 v[72:75], a[160:163], a[192:195], v[72:75]
buffer_load_dwordx4 v139, s[16:19], s42 offen offset:3072 lds
v_mfma_f32_16x16x32_bf16 v[104:107], a[160:163], a[196:199], v[104:107]
ds_read_b64_tr_b16 a[132:133], v195 offset:16384
ds_read_b64_tr_b16 a[134:135], v195 offset:18432
v_mfma_f32_16x16x32_bf16 v[76:79], a[164:167], a[192:195], v[76:79]
v_accvgpr_write_b32 a46, v160
v_accvgpr_write_b32 a47, v160
v_mfma_f32_16x16x32_bf16 v[108:111], a[164:167], a[196:199], v[108:111]
s_add_u32 m0, s44, 4096
v_accvgpr_write_b32 a48, v160
v_accvgpr_write_b32 a49, v160
v_smfmac_f32_16x16x64_bf16 a[252:255], a[208:211], a[160:167], v235
buffer_load_dwordx4 v140, s[16:19], s42 offen offset:0 lds
v_mfma_f32_16x16x32_bf16 v[16:19], a[136:139], a[192:195], v[16:19]
ds_read_b64_tr_b16 a[160:161], v194 offset:16640
ds_read_b64_tr_b16 a[162:163], v194 offset:18688
v_mfma_f32_16x16x32_bf16 v[48:51], a[136:139], a[196:199], v[48:51]
ds_read_b64_tr_b16 a[164:165], v195 offset:16640
ds_read_b64_tr_b16 a[166:167], v195 offset:18688
v_mfma_f32_16x16x32_bf16 v[20:23], a[140:143], a[192:195], v[20:23]
ds_read_b64_tr_b16 a[136:137], v196 offset:16384
ds_read_b64_tr_b16 a[138:139], v196 offset:18432
v_mfma_f32_16x16x32_bf16 v[52:55], a[140:143], a[196:199], v[52:55]
buffer_load_dwordx4 v141, s[16:19], s42 offen offset:1024 lds
v_mfma_f32_16x16x32_bf16 v[24:27], a[144:147], a[192:195], v[24:27]
ds_read_b64_tr_b16 a[140:141], v197 offset:16384
ds_read_b64_tr_b16 a[142:143], v197 offset:18432
v_mfma_f32_16x16x32_bf16 v[56:59], a[144:147], a[196:199], v[56:59]
ds_read_b64_tr_b16 a[144:145], v198 offset:16384
ds_read_b64_tr_b16 a[146:147], v198 offset:18432
v_mfma_f32_16x16x32_bf16 v[28:31], a[148:151], a[192:195], v[28:31]
v_accvgpr_write_b32 a50, v160
v_accvgpr_write_b32 a51, v160
v_mfma_f32_16x16x32_bf16 v[60:63], a[148:151], a[196:199], v[60:63]
buffer_load_dwordx4 v142, s[16:19], s42 offen offset:2048 lds
v_mfma_f32_16x16x32_bf16 v[32:35], a[152:155], a[192:195], v[32:35]
ds_read_b64_tr_b16 a[148:149], v199 offset:16384
ds_read_b64_tr_b16 a[150:151], v199 offset:18432
v_mfma_f32_16x16x32_bf16 v[64:67], a[152:155], a[196:199], v[64:67]
ds_read_b64_tr_b16 a[152:153], v200 offset:16384
ds_read_b64_tr_b16 a[154:155], v200 offset:18432
v_mfma_f32_16x16x32_bf16 v[36:39], a[156:159], a[192:195], v[36:39]
v_accvgpr_write_b32 a52, v160
v_accvgpr_write_b32 a53, v160
v_mfma_f32_16x16x32_bf16 v[68:71], a[156:159], a[196:199], v[68:71]
buffer_load_dwordx4 v143, s[16:19], s42 offen offset:3072 lds
v_mfma_f32_16x16x32_bf16 v[80:83], a[168:171], a[192:195], v[80:83]
s_lshl_b32 s72, s72, 12
ds_read_b64_tr_b16 a[156:157], v201 offset:16384
ds_read_b64_tr_b16 a[158:159], v201 offset:18432
v_mfma_f32_16x16x32_bf16 v[112:115], a[168:171], a[196:199], v[112:115]
s_waitcnt lgkmcnt(10)
s_add_u32 s42, s42, s72
ds_read_b64_tr_b16 a[168:169], v196 offset:16640
ds_read_b64_tr_b16 a[170:171], v196 offset:18688
v_mfma_f32_16x16x32_bf16 v[84:87], a[172:175], a[192:195], v[84:87]
s_lshr_b32 s48, s2, 5
v_accvgpr_write_b32 a54, v160
v_accvgpr_write_b32 a55, v160
v_mfma_f32_16x16x32_bf16 v[116:119], a[172:175], a[196:199], v[116:119]
s_lshl_b32 s48, s48, 13
ds_read_b64_tr_b16 a[172:173], v197 offset:16640
v_lshlrev_b32 v254, 5, v0
v_mfma_f32_16x16x32_bf16 v[88:91], a[176:179], a[192:195], v[88:91]
buffer_load_dword v252, v254, s[8:11], s48 offen
v_mfma_f32_16x16x32_bf16 v[120:123], a[176:179], a[196:199], v[120:123]
ds_read_b64_tr_b16 a[174:175], v197 offset:18688
ds_read_b64_tr_b16 a[176:177], v198 offset:16640
v_mfma_f32_16x16x32_bf16 v[92:95], a[180:183], a[192:195], v[92:95]
ds_read_b64_tr_b16 a[178:179], v198 offset:18688
v_accvgpr_write_b32 a56, v160
v_mfma_f32_16x16x32_bf16 v[124:127], a[180:183], a[196:199], v[124:127]
ds_read_b64_tr_b16 a[180:181], v199 offset:16640
ds_read_b64_tr_b16 a[182:183], v199 offset:18688
v_mfma_f32_16x16x32_bf16 v[96:99], a[184:187], a[192:195], v[96:99]
buffer_load_dword v253, v254, s[12:15], s48 offen
v_mfma_f32_16x16x32_bf16 v[128:131], a[184:187], a[196:199], v[128:131]
ds_read_b64_tr_b16 a[184:185], v200 offset:16640
ds_read_b64_tr_b16 a[186:187], v200 offset:18688
v_mfma_f32_16x16x32_bf16 v[100:103], a[188:191], a[192:195], v[100:103]
v_accvgpr_write_b32 a57, v160
v_mfma_f32_16x16x32_bf16 v[132:135], a[188:191], a[196:199], v[132:135]
ds_read_b64_tr_b16 a[188:189], v201 offset:16640
ds_read_b64_tr_b16 a[190:191], v201 offset:18688
v_mfma_f32_16x16x32_bf16 v[8:11], a[128:131], a[200:203], v[8:11]
v_accvgpr_write_b32 a58, v160
v_accvgpr_write_b32 a59, v160
v_mfma_f32_16x16x32_bf16 v[40:43], a[128:131], a[204:207], v[40:43]
v_accvgpr_write_b32 a60, v160
v_accvgpr_write_b32 a61, v160
v_mfma_f32_16x16x32_bf16 v[12:15], a[132:135], a[200:203], v[12:15]
v_accvgpr_write_b32 a62, v160
v_accvgpr_write_b32 a63, v160
v_mfma_f32_16x16x32_bf16 v[44:47], a[132:135], a[204:207], v[44:47]
v_accvgpr_write_b32 a64, v160
v_accvgpr_write_b32 a65, v160
v_smfmac_f32_16x16x64_bf16 a[248:251], a[208:211], a[128:135], v235
v_accvgpr_write_b32 a66, v160
v_accvgpr_write_b32 a67, v160
v_mfma_f32_16x16x32_bf16 v[72:75], a[160:163], a[200:203], v[72:75]
v_accvgpr_write_b32 a68, v160
v_accvgpr_write_b32 a69, v160
v_mfma_f32_16x16x32_bf16 v[104:107], a[160:163], a[204:207], v[104:107]
s_waitcnt vmcnt(14) lgkmcnt(0)
s_barrier
v_mfma_f32_16x16x32_bf16 v[76:79], a[164:167], a[200:203], v[76:79]
s_add_u32 m0, s45, 131072
ds_read_b128 a[192:195], v212 offset:0
ds_read_b128 a[196:199], v212 offset:2048
v_mfma_f32_16x16x32_bf16 v[108:111], a[164:167], a[204:207], v[108:111]
buffer_load_dwordx4 v144, s[24:27], s43 offen offset:0 lds
v_smfmac_f32_16x16x64_bf16 a[252:255], a[208:211], a[160:167], v235
ds_read_b64_tr_b16 a[128:129], v204 offset:0
ds_read_b64_tr_b16 a[130:131], v204 offset:2048
v_mfma_f32_16x16x32_bf16 v[16:19], a[136:139], a[200:203], v[16:19]
ds_read_b64_tr_b16 a[132:133], v205 offset:0
ds_read_b64_tr_b16 a[134:135], v205 offset:2048
v_mfma_f32_16x16x32_bf16 v[48:51], a[136:139], a[204:207], v[48:51]
ds_read_b64_tr_b16 a[160:161], v204 offset:256
ds_read_b64_tr_b16 a[162:163], v204 offset:2304
v_mfma_f32_16x16x32_bf16 v[20:23], a[140:143], a[200:203], v[20:23]
buffer_load_dwordx4 v145, s[24:27], s43 offen offset:1024 lds
v_mfma_f32_16x16x32_bf16 v[52:55], a[140:143], a[204:207], v[52:55]
ds_read_b64_tr_b16 a[164:165], v205 offset:256
ds_read_b64_tr_b16 a[166:167], v205 offset:2304
v_mfma_f32_16x16x32_bf16 v[24:27], a[144:147], a[200:203], v[24:27]
ds_read_b64_tr_b16 a[136:137], v206 offset:0
ds_read_b64_tr_b16 a[138:139], v206 offset:2048
v_mfma_f32_16x16x32_bf16 v[56:59], a[144:147], a[204:207], v[56:59]
s_add_u32 m0, s85, 131072
ds_read_b64_tr_b16 a[140:141], v207 offset:0
ds_read_b64_tr_b16 a[142:143], v207 offset:2048
v_mfma_f32_16x16x32_bf16 v[28:31], a[148:151], a[200:203], v[28:31]
buffer_load_dwordx4 v146, s[24:27], s43 offen offset:0 lds
v_mfma_f32_16x16x32_bf16 v[60:63], a[148:151], a[204:207], v[60:63]
ds_read_b64_tr_b16 a[144:145], v208 offset:0
ds_read_b64_tr_b16 a[146:147], v208 offset:2048
v_mfma_f32_16x16x32_bf16 v[32:35], a[152:155], a[200:203], v[32:35]
ds_read_b64_tr_b16 a[148:149], v209 offset:0
ds_read_b64_tr_b16 a[150:151], v209 offset:2048
v_mfma_f32_16x16x32_bf16 v[64:67], a[152:155], a[204:207], v[64:67]
ds_read_b64_tr_b16 a[152:153], v210 offset:0
ds_read_b64_tr_b16 a[154:155], v210 offset:2048
v_mfma_f32_16x16x32_bf16 v[36:39], a[156:159], a[200:203], v[36:39]
v_accvgpr_write_b32 a70, v160
v_accvgpr_write_b32 a71, v160
v_mfma_f32_16x16x32_bf16 v[68:71], a[156:159], a[204:207], v[68:71]
buffer_load_dwordx4 v147, s[24:27], s43 offen offset:1024 lds
v_mfma_f32_16x16x32_bf16 v[80:83], a[168:171], a[200:203], v[80:83]
s_cmp_eq_u32 s74, 1
s_cselect_b32 s72, s73, 128
ds_read_b64_tr_b16 a[156:157], v211 offset:0
ds_read_b64_tr_b16 a[158:159], v211 offset:2048
v_mfma_f32_16x16x32_bf16 v[112:115], a[168:171], a[204:207], v[112:115]
s_add_u32 s43, s43, s72
ds_read_b64_tr_b16 a[168:169], v206 offset:256
ds_read_b64_tr_b16 a[170:171], v206 offset:2304
v_mfma_f32_16x16x32_bf16 v[84:87], a[172:175], a[200:203], v[84:87]
s_add_u32 m0, s44, 98304
v_accvgpr_write_b32 a72, v160
v_accvgpr_write_b32 a73, v160
v_mfma_f32_16x16x32_bf16 v[116:119], a[172:175], a[204:207], v[116:119]
buffer_load_dwordx4 v136, s[16:19], s42 offen offset:0 lds
v_mfma_f32_16x16x32_bf16 v[88:91], a[176:179], a[200:203], v[88:91]
ds_read_b64_tr_b16 a[172:173], v207 offset:256
ds_read_b64_tr_b16 a[174:175], v207 offset:2304
v_mfma_f32_16x16x32_bf16 v[120:123], a[176:179], a[204:207], v[120:123]
ds_read_b64_tr_b16 a[176:177], v208 offset:256
ds_read_b64_tr_b16 a[178:179], v208 offset:2304
v_mfma_f32_16x16x32_bf16 v[92:95], a[180:183], a[200:203], v[92:95]
v_accvgpr_write_b32 a74, v160
v_accvgpr_write_b32 a75, v160
v_mfma_f32_16x16x32_bf16 v[124:127], a[180:183], a[204:207], v[124:127]
buffer_load_dwordx4 v137, s[16:19], s42 offen offset:1024 lds
v_mfma_f32_16x16x32_bf16 v[96:99], a[184:187], a[200:203], v[96:99]
ds_read_b64_tr_b16 a[180:181], v209 offset:256
ds_read_b64_tr_b16 a[182:183], v209 offset:2304
v_mfma_f32_16x16x32_bf16 v[128:131], a[184:187], a[204:207], v[128:131]
ds_read_b64_tr_b16 a[184:185], v210 offset:256
ds_read_b64_tr_b16 a[186:187], v210 offset:2304
v_mfma_f32_16x16x32_bf16 v[100:103], a[188:191], a[200:203], v[100:103]
v_mfma_f32_16x16x32_bf16 v[132:135], a[188:191], a[204:207], v[132:135]
s_waitcnt lgkmcnt(8)
ds_read_b64_tr_b16 a[188:189], v211 offset:256
ds_read_b64_tr_b16 a[190:191], v211 offset:2304
v_mfma_f32_16x16x32_bf16 v[8:11], a[128:131], a[192:195], v[8:11]
buffer_load_dwordx4 v138, s[16:19], s42 offen offset:2048 lds
v_mfma_f32_16x16x32_bf16 v[40:43], a[128:131], a[196:199], v[40:43]
ds_read_b128 a[200:203], v213 offset:0
ds_read_b128 a[204:207], v213 offset:2048
v_mfma_f32_16x16x32_bf16 v[12:15], a[132:135], a[192:195], v[12:15]
v_accvgpr_write_b32 a76, v160
v_accvgpr_write_b32 a77, v160
v_mfma_f32_16x16x32_bf16 v[44:47], a[132:135], a[196:199], v[44:47]
v_accvgpr_write_b32 a78, v160
v_accvgpr_write_b32 a79, v160
v_smfmac_f32_16x16x64_bf16 a[248:251], a[208:211], a[128:135], v235
buffer_load_dwordx4 v139, s[16:19], s42 offen offset:3072 lds
v_mfma_f32_16x16x32_bf16 v[72:75], a[160:163], a[192:195], v[72:75]
ds_read_b64_tr_b16 a[128:129], v204 offset:16384
ds_read_b64_tr_b16 a[130:131], v204 offset:18432
v_mfma_f32_16x16x32_bf16 v[104:107], a[160:163], a[196:199], v[104:107]
ds_read_b64_tr_b16 a[132:133], v205 offset:16384
ds_read_b64_tr_b16 a[134:135], v205 offset:18432
v_mfma_f32_16x16x32_bf16 v[76:79], a[164:167], a[192:195], v[76:79]
v_accvgpr_write_b32 a80, v160
v_accvgpr_write_b32 a81, v160
v_mfma_f32_16x16x32_bf16 v[108:111], a[164:167], a[196:199], v[108:111]
s_add_u32 m0, s44, 102400
v_accvgpr_write_b32 a82, v160
v_accvgpr_write_b32 a83, v160
v_smfmac_f32_16x16x64_bf16 a[252:255], a[208:211], a[160:167], v235
buffer_load_dwordx4 v140, s[16:19], s42 offen offset:0 lds
v_mfma_f32_16x16x32_bf16 v[16:19], a[136:139], a[192:195], v[16:19]
ds_read_b64_tr_b16 a[160:161], v204 offset:16640
ds_read_b64_tr_b16 a[162:163], v204 offset:18688
v_mfma_f32_16x16x32_bf16 v[48:51], a[136:139], a[196:199], v[48:51]
ds_read_b64_tr_b16 a[164:165], v205 offset:16640
ds_read_b64_tr_b16 a[166:167], v205 offset:18688
v_mfma_f32_16x16x32_bf16 v[20:23], a[140:143], a[192:195], v[20:23]
ds_read_b64_tr_b16 a[136:137], v206 offset:16384
ds_read_b64_tr_b16 a[138:139], v206 offset:18432
v_mfma_f32_16x16x32_bf16 v[52:55], a[140:143], a[196:199], v[52:55]
buffer_load_dwordx4 v141, s[16:19], s42 offen offset:1024 lds
v_mfma_f32_16x16x32_bf16 v[24:27], a[144:147], a[192:195], v[24:27]
ds_read_b64_tr_b16 a[140:141], v207 offset:16384
ds_read_b64_tr_b16 a[142:143], v207 offset:18432
v_mfma_f32_16x16x32_bf16 v[56:59], a[144:147], a[196:199], v[56:59]
ds_read_b64_tr_b16 a[144:145], v208 offset:16384
ds_read_b64_tr_b16 a[146:147], v208 offset:18432
v_mfma_f32_16x16x32_bf16 v[28:31], a[148:151], a[192:195], v[28:31]
v_accvgpr_write_b32 a84, v160
v_accvgpr_write_b32 a85, v160
v_mfma_f32_16x16x32_bf16 v[60:63], a[148:151], a[196:199], v[60:63]
buffer_load_dwordx4 v142, s[16:19], s42 offen offset:2048 lds
v_mfma_f32_16x16x32_bf16 v[32:35], a[152:155], a[192:195], v[32:35]
ds_read_b64_tr_b16 a[148:149], v209 offset:16384
ds_read_b64_tr_b16 a[150:151], v209 offset:18432
v_mfma_f32_16x16x32_bf16 v[64:67], a[152:155], a[196:199], v[64:67]
ds_read_b64_tr_b16 a[152:153], v210 offset:16384
ds_read_b64_tr_b16 a[154:155], v210 offset:18432
v_mfma_f32_16x16x32_bf16 v[36:39], a[156:159], a[192:195], v[36:39]
v_accvgpr_write_b32 a86, v160
v_accvgpr_write_b32 a87, v160
v_mfma_f32_16x16x32_bf16 v[68:71], a[156:159], a[196:199], v[68:71]
buffer_load_dwordx4 v143, s[16:19], s42 offen offset:3072 lds
v_mfma_f32_16x16x32_bf16 v[80:83], a[168:171], a[192:195], v[80:83]
s_lshl_b32 s72, s72, 12
ds_read_b64_tr_b16 a[156:157], v211 offset:16384
ds_read_b64_tr_b16 a[158:159], v211 offset:18432
v_mfma_f32_16x16x32_bf16 v[112:115], a[168:171], a[196:199], v[112:115]
s_waitcnt lgkmcnt(10)
s_add_u32 s42, s42, s72
ds_read_b64_tr_b16 a[168:169], v206 offset:16640
ds_read_b64_tr_b16 a[170:171], v206 offset:18688
v_mfma_f32_16x16x32_bf16 v[84:87], a[172:175], a[192:195], v[84:87]
s_mov_b32 m0, s83
v_accvgpr_write_b32 a88, v160
v_accvgpr_write_b32 a89, v160
v_mfma_f32_16x16x32_bf16 v[116:119], a[172:175], a[196:199], v[116:119]
buffer_load_dwordx4 v144, s[24:27], s80 offen lds
v_mfma_f32_16x16x32_bf16 v[88:91], a[176:179], a[192:195], v[88:91]
ds_read_b64_tr_b16 a[172:173], v207 offset:16640
ds_read_b64_tr_b16 a[174:175], v207 offset:18688
v_mfma_f32_16x16x32_bf16 v[120:123], a[176:179], a[196:199], v[120:123]
ds_read_b64_tr_b16 a[176:177], v208 offset:16640
ds_read_b64_tr_b16 a[178:179], v208 offset:18688
v_mfma_f32_16x16x32_bf16 v[92:95], a[180:183], a[192:195], v[92:95]
v_accvgpr_write_b32 a90, v160
v_accvgpr_write_b32 a91, v160
v_mfma_f32_16x16x32_bf16 v[124:127], a[180:183], a[196:199], v[124:127]
ds_read_b64_tr_b16 a[180:181], v209 offset:16640
ds_read_b64_tr_b16 a[182:183], v209 offset:18688
v_mfma_f32_16x16x32_bf16 v[96:99], a[184:187], a[192:195], v[96:99]
buffer_load_dwordx4 v145, s[24:27], s80 offen offset:1024 lds
v_mfma_f32_16x16x32_bf16 v[128:131], a[184:187], a[196:199], v[128:131]
ds_read_b64_tr_b16 a[184:185], v210 offset:16640
ds_read_b64_tr_b16 a[186:187], v210 offset:18688
v_mfma_f32_16x16x32_bf16 v[100:103], a[188:191], a[192:195], v[100:103]
v_mfma_f32_16x16x32_bf16 v[132:135], a[188:191], a[196:199], v[132:135]
ds_read_b64_tr_b16 a[188:189], v211 offset:16640
ds_read_b64_tr_b16 a[190:191], v211 offset:18688
v_mfma_f32_16x16x32_bf16 v[8:11], a[128:131], a[200:203], v[8:11]
buffer_load_dwordx2 a[244:245], v240, s[24:27], s81 offen
v_mfma_f32_16x16x32_bf16 v[40:43], a[128:131], a[204:207], v[40:43]
v_accvgpr_write_b32 a92, v160
v_accvgpr_write_b32 a93, v160
v_mfma_f32_16x16x32_bf16 v[12:15], a[132:135], a[200:203], v[12:15]
v_accvgpr_write_b32 a94, v160
v_accvgpr_write_b32 a95, v160
v_mfma_f32_16x16x32_bf16 v[44:47], a[132:135], a[204:207], v[44:47]
v_accvgpr_write_b32 a96, v160
v_accvgpr_write_b32 a97, v160
v_smfmac_f32_16x16x64_bf16 a[248:251], a[208:211], a[128:135], v235
v_accvgpr_write_b32 a98, v160
v_accvgpr_write_b32 a99, v160
v_mfma_f32_16x16x32_bf16 v[72:75], a[160:163], a[200:203], v[72:75]
v_accvgpr_write_b32 a100, v160
v_accvgpr_write_b32 a101, v160
v_mfma_f32_16x16x32_bf16 v[104:107], a[160:163], a[204:207], v[104:107]
s_waitcnt vmcnt(17) lgkmcnt(0)
s_barrier
s_cmp_lg_u32 s32, 0
s_cbranch_scc1 K_W0_11
v_lshlrev_b32 v255, 4, v3
buffer_load_dword v254, v255, s[28:31], 0 offen sc0 sc1
K_W0_11:
v_mfma_f32_16x16x32_bf16 v[76:79], a[164:167], a[200:203], v[76:79]
s_add_u32 m0, s45, 81920
ds_read_b128 a[192:195], v192 offset:0
ds_read_b128 a[196:199], v192 offset:2048
v_mfma_f32_16x16x32_bf16 v[108:111], a[164:167], a[204:207], v[108:111]
buffer_load_dwordx4 v144, s[24:27], s43 offen offset:0 lds
v_smfmac_f32_16x16x64_bf16 a[252:255], a[208:211], a[160:167], v235
ds_read_b64_tr_b16 a[128:129], v184 offset:0
ds_read_b64_tr_b16 a[130:131], v184 offset:2048
v_mfma_f32_16x16x32_bf16 v[16:19], a[136:139], a[200:203], v[16:19]
ds_read_b64_tr_b16 a[132:133], v185 offset:0
ds_read_b64_tr_b16 a[134:135], v185 offset:2048
v_mfma_f32_16x16x32_bf16 v[48:51], a[136:139], a[204:207], v[48:51]
ds_read_b64_tr_b16 a[160:161], v184 offset:256
ds_read_b64_tr_b16 a[162:163], v184 offset:2304
v_mfma_f32_16x16x32_bf16 v[20:23], a[140:143], a[200:203], v[20:23]
buffer_load_dwordx4 v145, s[24:27], s43 offen offset:1024 lds
v_mfma_f32_16x16x32_bf16 v[52:55], a[140:143], a[204:207], v[52:55]
ds_read_b64_tr_b16 a[164:165], v185 offset:256
ds_read_b64_tr_b16 a[166:167], v185 offset:2304
v_mfma_f32_16x16x32_bf16 v[24:27], a[144:147], a[200:203], v[24:27]
ds_read_b64_tr_b16 a[136:137], v186 offset:0
ds_read_b64_tr_b16 a[138:139], v186 offset:2048
v_mfma_f32_16x16x32_bf16 v[56:59], a[144:147], a[204:207], v[56:59]
s_add_u32 m0, s85, 81920
ds_read_b64_tr_b16 a[140:141], v187 offset:0
ds_read_b64_tr_b16 a[142:143], v187 offset:2048
v_mfma_f32_16x16x32_bf16 v[28:31], a[148:151], a[200:203], v[28:31]
buffer_load_dwordx4 v146, s[24:27], s43 offen offset:0 lds
v_mfma_f32_16x16x32_bf16 v[60:63], a[148:151], a[204:207], v[60:63]
ds_read_b64_tr_b16 a[144:145], v188 offset:0
ds_read_b64_tr_b16 a[146:147], v188 offset:2048
v_mfma_f32_16x16x32_bf16 v[32:35], a[152:155], a[200:203], v[32:35]
ds_read_b64_tr_b16 a[148:149], v189 offset:0
ds_read_b64_tr_b16 a[150:151], v189 offset:2048
v_mfma_f32_16x16x32_bf16 v[64:67], a[152:155], a[204:207], v[64:67]
ds_read_b64_tr_b16 a[152:153], v190 offset:0
ds_read_b64_tr_b16 a[154:155], v190 offset:2048
v_mfma_f32_16x16x32_bf16 v[36:39], a[156:159], a[200:203], v[36:39]
v_accvgpr_write_b32 a102, v160
v_accvgpr_write_b32 a103, v160
v_mfma_f32_16x16x32_bf16 v[68:71], a[156:159], a[204:207], v[68:71]
buffer_load_dwordx4 v147, s[24:27], s43 offen offset:1024 lds
v_mfma_f32_16x16x32_bf16 v[80:83], a[168:171], a[200:203], v[80:83]
s_cmp_eq_u32 s74, 0
s_cselect_b32 s72, s73, 128
ds_read_b64_tr_b16 a[156:157], v191 offset:0
ds_read_b64_tr_b16 a[158:159], v191 offset:2048
v_mfma_f32_16x16x32_bf16 v[112:115], a[168:171], a[204:207], v[112:115]
s_add_u32 s43, s43, s72
ds_read_b64_tr_b16 a[168:169], v186 offset:256
ds_read_b64_tr_b16 a[170:171], v186 offset:2304
v_mfma_f32_16x16x32_bf16 v[84:87], a[172:175], a[200:203], v[84:87]
s_add_u32 m0, s44, 49152
v_accvgpr_write_b32 a104, v160
v_accvgpr_write_b32 a105, v160
v_mfma_f32_16x16x32_bf16 v[116:119], a[172:175], a[204:207], v[116:119]
buffer_load_dwordx4 v136, s[16:19], s42 offen offset:0 lds
v_mfma_f32_16x16x32_bf16 v[88:91], a[176:179], a[200:203], v[88:91]
ds_read_b64_tr_b16 a[172:173], v187 offset:256
ds_read_b64_tr_b16 a[174:175], v187 offset:2304
v_mfma_f32_16x16x32_bf16 v[120:123], a[176:179], a[204:207], v[120:123]
ds_read_b64_tr_b16 a[176:177], v188 offset:256
ds_read_b64_tr_b16 a[178:179], v188 offset:2304
v_mfma_f32_16x16x32_bf16 v[92:95], a[180:183], a[200:203], v[92:95]
v_accvgpr_write_b32 a106, v160
v_accvgpr_write_b32 a107, v160
v_mfma_f32_16x16x32_bf16 v[124:127], a[180:183], a[204:207], v[124:127]
buffer_load_dwordx4 v137, s[16:19], s42 offen offset:1024 lds
v_mfma_f32_16x16x32_bf16 v[96:99], a[184:187], a[200:203], v[96:99]
ds_read_b64_tr_b16 a[180:181], v189 offset:256
ds_read_b64_tr_b16 a[182:183], v189 offset:2304
v_mfma_f32_16x16x32_bf16 v[128:131], a[184:187], a[204:207], v[128:131]
ds_read_b64_tr_b16 a[184:185], v190 offset:256
ds_read_b64_tr_b16 a[186:187], v190 offset:2304
v_mfma_f32_16x16x32_bf16 v[100:103], a[188:191], a[200:203], v[100:103]
v_mfma_f32_16x16x32_bf16 v[132:135], a[188:191], a[204:207], v[132:135]
s_waitcnt lgkmcnt(8)
ds_read_b64_tr_b16 a[188:189], v191 offset:256
ds_read_b64_tr_b16 a[190:191], v191 offset:2304
v_mfma_f32_16x16x32_bf16 v[8:11], a[128:131], a[192:195], v[8:11]
buffer_load_dwordx4 v138, s[16:19], s42 offen offset:2048 lds
v_mfma_f32_16x16x32_bf16 v[40:43], a[128:131], a[196:199], v[40:43]
ds_read_b128 a[200:203], v193 offset:0
ds_read_b128 a[204:207], v193 offset:2048
v_mfma_f32_16x16x32_bf16 v[12:15], a[132:135], a[192:195], v[12:15]
v_accvgpr_write_b32 a108, v160
v_accvgpr_write_b32 a109, v160
v_mfma_f32_16x16x32_bf16 v[44:47], a[132:135], a[196:199], v[44:47]
v_accvgpr_write_b32 a110, v160
v_accvgpr_write_b32 a111, v160
v_smfmac_f32_16x16x64_bf16 a[248:251], a[208:211], a[128:135], v235
buffer_load_dwordx4 v139, s[16:19], s42 offen offset:3072 lds
v_mfma_f32_16x16x32_bf16 v[72:75], a[160:163], a[192:195], v[72:75]
ds_read_b64_tr_b16 a[128:129], v184 offset:16384
ds_read_b64_tr_b16 a[130:131], v184 offset:18432
v_mfma_f32_16x16x32_bf16 v[104:107], a[160:163], a[196:199], v[104:107]
ds_read_b64_tr_b16 a[132:133], v185 offset:16384
ds_read_b64_tr_b16 a[134:135], v185 offset:18432
v_mfma_f32_16x16x32_bf16 v[76:79], a[164:167], a[192:195], v[76:79]
v_accvgpr_write_b32 a112, v160
v_accvgpr_write_b32 a113, v160
v_mfma_f32_16x16x32_bf16 v[108:111], a[164:167], a[196:199], v[108:111]
s_add_u32 m0, s44, 53248
v_accvgpr_write_b32 a114, v160
v_accvgpr_write_b32 a115, v160
v_smfmac_f32_16x16x64_bf16 a[252:255], a[208:211], a[160:167], v235
buffer_load_dwordx4 v140, s[16:19], s42 offen offset:0 lds
v_mfma_f32_16x16x32_bf16 v[16:19], a[136:139], a[192:195], v[16:19]
ds_read_b64_tr_b16 a[160:161], v184 offset:16640
ds_read_b64_tr_b16 a[162:163], v184 offset:18688
v_mfma_f32_16x16x32_bf16 v[48:51], a[136:139], a[196:199], v[48:51]
ds_read_b64_tr_b16 a[164:165], v185 offset:16640
ds_read_b64_tr_b16 a[166:167], v185 offset:18688
v_mfma_f32_16x16x32_bf16 v[20:23], a[140:143], a[192:195], v[20:23]
ds_read_b64_tr_b16 a[136:137], v186 offset:16384
ds_read_b64_tr_b16 a[138:139], v186 offset:18432
v_mfma_f32_16x16x32_bf16 v[52:55], a[140:143], a[196:199], v[52:55]
buffer_load_dwordx4 v141, s[16:19], s42 offen offset:1024 lds
v_mfma_f32_16x16x32_bf16 v[24:27], a[144:147], a[192:195], v[24:27]
ds_read_b64_tr_b16 a[140:141], v187 offset:16384
ds_read_b64_tr_b16 a[142:143], v187 offset:18432
v_mfma_f32_16x16x32_bf16 v[56:59], a[144:147], a[196:199], v[56:59]
ds_read_b64_tr_b16 a[144:145], v188 offset:16384
ds_read_b64_tr_b16 a[146:147], v188 offset:18432
v_mfma_f32_16x16x32_bf16 v[28:31], a[148:151], a[192:195], v[28:31]
v_accvgpr_write_b32 a116, v160
v_accvgpr_write_b32 a117, v160
v_mfma_f32_16x16x32_bf16 v[60:63], a[148:151], a[196:199], v[60:63]
buffer_load_dwordx4 v142, s[16:19], s42 offen offset:2048 lds
v_mfma_f32_16x16x32_bf16 v[32:35], a[152:155], a[192:195], v[32:35]
ds_read_b64_tr_b16 a[148:149], v189 offset:16384
ds_read_b64_tr_b16 a[150:151], v189 offset:18432
v_mfma_f32_16x16x32_bf16 v[64:67], a[152:155], a[196:199], v[64:67]
ds_read_b64_tr_b16 a[152:153], v190 offset:16384
ds_read_b64_tr_b16 a[154:155], v190 offset:18432
v_mfma_f32_16x16x32_bf16 v[36:39], a[156:159], a[192:195], v[36:39]
v_accvgpr_write_b32 a118, v160
v_accvgpr_write_b32 a119, v160
v_mfma_f32_16x16x32_bf16 v[68:71], a[156:159], a[196:199], v[68:71]
buffer_load_dwordx4 v143, s[16:19], s42 offen offset:3072 lds
v_mfma_f32_16x16x32_bf16 v[80:83], a[168:171], a[192:195], v[80:83]
s_waitcnt lgkmcnt(8)
ds_read_b64_tr_b16 a[156:157], v191 offset:16384
ds_read_b64_tr_b16 a[158:159], v191 offset:18432
v_mfma_f32_16x16x32_bf16 v[112:115], a[168:171], a[196:199], v[112:115]
s_lshl_b32 s72, s72, 12
ds_read_b64_tr_b16 a[168:169], v186 offset:16640
ds_read_b64_tr_b16 a[170:171], v186 offset:18688
v_mfma_f32_16x16x32_bf16 v[84:87], a[172:175], a[192:195], v[84:87]
s_add_u32 s42, s42, s72
v_accvgpr_write_b32 a120, v160
v_accvgpr_write_b32 a121, v160
v_mfma_f32_16x16x32_bf16 v[116:119], a[172:175], a[196:199], v[116:119]
ds_read_b64_tr_b16 a[172:173], v187 offset:16640
ds_read_b64_tr_b16 a[174:175], v187 offset:18688
v_mfma_f32_16x16x32_bf16 v[88:91], a[176:179], a[192:195], v[88:91]
v_accvgpr_write_b32 a122, v160
v_accvgpr_write_b32 a123, v160
v_mfma_f32_16x16x32_bf16 v[120:123], a[176:179], a[196:199], v[120:123]
ds_read_b64_tr_b16 a[176:177], v188 offset:16640
ds_read_b64_tr_b16 a[178:179], v188 offset:18688
v_mfma_f32_16x16x32_bf16 v[92:95], a[180:183], a[192:195], v[92:95]
v_accvgpr_write_b32 a124, v160
v_accvgpr_write_b32 a125, v160
v_mfma_f32_16x16x32_bf16 v[124:127], a[180:183], a[196:199], v[124:127]
ds_read_b64_tr_b16 a[180:181], v189 offset:16640
ds_read_b64_tr_b16 a[182:183], v189 offset:18688
v_mfma_f32_16x16x32_bf16 v[96:99], a[184:187], a[192:195], v[96:99]
v_accvgpr_write_b32 a126, v160
v_accvgpr_write_b32 a127, v160
v_mfma_f32_16x16x32_bf16 v[128:131], a[184:187], a[196:199], v[128:131]
ds_read_b64_tr_b16 a[184:185], v190 offset:16640
ds_read_b64_tr_b16 a[186:187], v190 offset:18688
v_mfma_f32_16x16x32_bf16 v[100:103], a[188:191], a[192:195], v[100:103]
v_mfma_f32_16x16x32_bf16 v[132:135], a[188:191], a[196:199], v[132:135]
ds_read_b64_tr_b16 a[188:189], v191 offset:16640
ds_read_b64_tr_b16 a[190:191], v191 offset:18688
v_mfma_f32_16x16x32_bf16 v[8:11], a[128:131], a[200:203], v[8:11]
v_mfma_f32_16x16x32_bf16 v[40:43], a[128:131], a[204:207], v[40:43]
v_mfma_f32_16x16x32_bf16 v[12:15], a[132:135], a[200:203], v[12:15]
v_mfma_f32_16x16x32_bf16 v[44:47], a[132:135], a[204:207], v[44:47]
v_smfmac_f32_16x16x64_bf16 a[248:251], a[208:211], a[128:135], v235
v_mfma_f32_16x16x32_bf16 v[72:75], a[160:163], a[200:203], v[72:75]
v_mfma_f32_16x16x32_bf16 v[104:107], a[160:163], a[204:207], v[104:107]
s_cmp_lg_u32 s32, 0
s_cbranch_scc1 K_CNTOK
s_waitcnt vmcnt(12)
v_cmp_gt_u32 vcc, 16, v254
s_cbranch_vccz K_CNTOK
K_CNTSPIN:
s_sleep 2
s_add_u32 s100, s100, 1
s_bitcmp1_b32 s100, 19
s_cbranch_scc1 K_END
buffer_load_dword v254, v255, s[28:31], 0 offen sc0 sc1
s_waitcnt vmcnt(0)
v_cmp_gt_u32 vcc, 16, v254
s_cbranch_vccnz K_CNTSPIN
K_CNTOK:
s_waitcnt vmcnt(15) lgkmcnt(0)
s_barrier
v_mfma_f32_16x16x32_bf16 v[76:79], a[164:167], a[200:203], v[76:79]
s_mov_b32 s38, 0
ds_read_b128 a[192:195], v202 offset:0
ds_read_b128 a[196:199], v202 offset:2048
v_mfma_f32_16x16x32_bf16 v[108:111], a[164:167], a[204:207], v[108:111]
s_add_u32 m0, s37, 32768
ds_read_b64_tr_b16 a[128:129], v194 offset:0
ds_read_b64_tr_b16 a[130:131], v194 offset:2048
v_smfmac_f32_16x16x64_bf16 a[252:255], a[208:211], a[160:167], v235
buffer_load_dwordx4 v228, s[8:11], s38 offen offset:0 lds
v_mfma_f32_16x16x32_bf16 v[16:19], a[136:139], a[200:203], v[16:19]
ds_read_b64_tr_b16 a[132:133], v195 offset:0
ds_read_b64_tr_b16 a[134:135], v195 offset:2048
v_mfma_f32_16x16x32_bf16 v[48:51], a[136:139], a[204:207], v[48:51]
ds_read_b64_tr_b16 a[160:161], v194 offset:256
ds_read_b64_tr_b16 a[162:163], v194 offset:2304
v_mfma_f32_16x16x32_bf16 v[20:23], a[140:143], a[200:203], v[20:23]
ds_read_b64_tr_b16 a[164:165], v195 offset:256
ds_read_b64_tr_b16 a[166:167], v195 offset:2304
v_mfma_f32_16x16x32_bf16 v[52:55], a[140:143], a[204:207], v[52:55]
ds_read_b64_tr_b16 a[136:137], v196 offset:0
ds_read_b64_tr_b16 a[138:139], v196 offset:2048
v_mfma_f32_16x16x32_bf16 v[24:27], a[144:147], a[200:203], v[24:27]
buffer_load_dwordx4 v229, s[8:11], s38 offen offset:1024 lds
v_mfma_f32_16x16x32_bf16 v[56:59], a[144:147], a[204:207], v[56:59]
ds_read_b64_tr_b16 a[140:141], v197 offset:0
ds_read_b64_tr_b16 a[142:143], v197 offset:2048
v_mfma_f32_16x16x32_bf16 v[28:31], a[148:151], a[200:203], v[28:31]
ds_read_b64_tr_b16 a[144:145], v198 offset:0
ds_read_b64_tr_b16 a[146:147], v198 offset:2048
v_mfma_f32_16x16x32_bf16 v[60:63], a[148:151], a[204:207], v[60:63]
ds_read_b64_tr_b16 a[148:149], v199 offset:0
ds_read_b64_tr_b16 a[150:151], v199 offset:2048
v_mfma_f32_16x16x32_bf16 v[32:35], a[152:155], a[200:203], v[32:35]
buffer_load_dwordx4 v230, s[8:11], s38 offen offset:2048 lds
v_mfma_f32_16x16x32_bf16 v[64:67], a[152:155], a[204:207], v[64:67]
ds_read_b64_tr_b16 a[152:153], v200 offset:0
ds_read_b64_tr_b16 a[154:155], v200 offset:2048
v_mfma_f32_16x16x32_bf16 v[36:39], a[156:159], a[200:203], v[36:39]
v_mfma_f32_16x16x32_bf16 v[68:71], a[156:159], a[204:207], v[68:71]
ds_read_b64_tr_b16 a[156:157], v201 offset:0
ds_read_b64_tr_b16 a[158:159], v201 offset:2048
v_mfma_f32_16x16x32_bf16 v[80:83], a[168:171], a[200:203], v[80:83]
buffer_load_dwordx4 v231, s[8:11], s38 offen offset:3072 lds
v_mfma_f32_16x16x32_bf16 v[112:115], a[168:171], a[204:207], v[112:115]
ds_read_b64_tr_b16 a[168:169], v196 offset:256
ds_read_b64_tr_b16 a[170:171], v196 offset:2304
v_mfma_f32_16x16x32_bf16 v[84:87], a[172:175], a[200:203], v[84:87]
s_add_u32 s38, s38, 16384
v_mfma_f32_16x16x32_bf16 v[116:119], a[172:175], a[204:207], v[116:119]
s_add_u32 m0, s37, 16384
ds_read_b64_tr_b16 a[172:173], v197 offset:256
ds_read_b64_tr_b16 a[174:175], v197 offset:2304
v_mfma_f32_16x16x32_bf16 v[88:91], a[176:179], a[200:203], v[88:91]
buffer_load_dwordx4 v228, s[8:11], s38 offen offset:0 lds
v_mfma_f32_16x16x32_bf16 v[120:123], a[176:179], a[204:207], v[120:123]
ds_read_b64_tr_b16 a[176:177], v198 offset:256
ds_read_b64_tr_b16 a[178:179], v198 offset:2304
v_mfma_f32_16x16x32_bf16 v[92:95], a[180:183], a[200:203], v[92:95]
v_mfma_f32_16x16x32_bf16 v[124:127], a[180:183], a[204:207], v[124:127]
ds_read_b64_tr_b16 a[180:181], v199 offset:256
ds_read_b64_tr_b16 a[182:183], v199 offset:2304
v_mfma_f32_16x16x32_bf16 v[96:99], a[184:187], a[200:203], v[96:99]
buffer_load_dwordx4 v229, s[8:11], s38 offen offset:1024 lds
v_mfma_f32_16x16x32_bf16 v[128:131], a[184:187], a[204:207], v[128:131]
ds_read_b64_tr_b16 a[184:185], v200 offset:256
ds_read_b64_tr_b16 a[186:187], v200 offset:2304
v_mfma_f32_16x16x32_bf16 v[100:103], a[188:191], a[200:203], v[100:103]
v_mfma_f32_16x16x32_bf16 v[132:135], a[188:191], a[204:207], v[132:135]
s_waitcnt lgkmcnt(8)
ds_read_b64_tr_b16 a[188:189], v201 offset:256
ds_read_b64_tr_b16 a[190:191], v201 offset:2304
v_mfma_f32_16x16x32_bf16 v[8:11], a[128:131], a[192:195], v[8:11]
s_add_u32 s76, s6, 0x270000
s_addc_u32 s77, s7, 0
ds_read_b128 a[200:203], v203 offset:0
ds_read_b128 a[204:207], v203 offset:2048
v_mfma_f32_16x16x32_bf16 v[40:43], a[128:131], a[196:199], v[40:43]
s_and_b32 s77, s77, 0xffff
buffer_load_dwordx4 v230, s[8:11], s38 offen offset:2048 lds
v_mfma_f32_16x16x32_bf16 v[12:15], a[132:135], a[192:195], v[12:15]
s_mov_b32 s78, 512
v_mfma_f32_16x16x32_bf16 v[44:47], a[132:135], a[196:199], v[44:47]
s_mov_b32 s79, 0x00020000
v_smfmac_f32_16x16x64_bf16 a[248:251], a[208:211], a[128:135], v235
s_mov_b32 s16, s86
ds_read_b64_tr_b16 a[128:129], v194 offset:16384
ds_read_b64_tr_b16 a[130:131], v194 offset:18432
v_mfma_f32_16x16x32_bf16 v[72:75], a[160:163], a[192:195], v[72:75]
s_and_b32 s17, s87, 0xffff
buffer_load_dwordx4 v231, s[8:11], s38 offen offset:3072 lds
v_mfma_f32_16x16x32_bf16 v[104:107], a[160:163], a[196:199], v[104:107]
s_mov_b32 s18, 4718592
ds_read_b64_tr_b16 a[132:133], v195 offset:16384
ds_read_b64_tr_b16 a[134:135], v195 offset:18432
v_mfma_f32_16x16x32_bf16 v[76:79], a[164:167], a[192:195], v[76:79]
s_add_u32 s38, s38, 16384
v_mfma_f32_16x16x32_bf16 v[108:111], a[164:167], a[196:199], v[108:111]
s_add_u32 m0, s37, 0
v_smfmac_f32_16x16x64_bf16 a[252:255], a[208:211], a[160:167], v235
s_mul_i32 s47, s35, 1179648
buffer_load_dwordx4 v228, s[8:11], s38 offen offset:0 lds
v_mfma_f32_16x16x32_bf16 v[16:19], a[136:139], a[192:195], v[16:19]
s_add_u32 s28, s86, s47
s_addc_u32 s29, s87, 0
ds_read_b64_tr_b16 a[160:161], v194 offset:16640
ds_read_b64_tr_b16 a[162:163], v194 offset:18688
v_mfma_f32_16x16x32_bf16 v[48:51], a[136:139], a[196:199], v[48:51]
s_and_b32 s29, s29, 0xffff
ds_read_b64_tr_b16 a[164:165], v195 offset:16640
ds_read_b64_tr_b16 a[166:167], v195 offset:18688
v_mfma_f32_16x16x32_bf16 v[20:23], a[140:143], a[192:195], v[20:23]
s_mov_b32 s30, 1179648
ds_read_b64_tr_b16 a[136:137], v196 offset:16384
ds_read_b64_tr_b16 a[138:139], v196 offset:18432
v_mfma_f32_16x16x32_bf16 v[52:55], a[140:143], a[196:199], v[52:55]
s_mov_b32 s42, 0xffc00000
buffer_load_dwordx4 v229, s[8:11], s38 offen offset:1024 lds
v_mfma_f32_16x16x32_bf16 v[24:27], a[144:147], a[192:195], v[24:27]
s_mov_b32 s43, 0x100000
ds_read_b64_tr_b16 a[140:141], v197 offset:16384
ds_read_b64_tr_b16 a[142:143], v197 offset:18432
v_mfma_f32_16x16x32_bf16 v[56:59], a[144:147], a[196:199], v[56:59]
s_lshr_b32 s46, s2, 3
ds_read_b64_tr_b16 a[144:145], v198 offset:16384
ds_read_b64_tr_b16 a[146:147], v198 offset:18432
v_mfma_f32_16x16x32_bf16 v[28:31], a[148:151], a[192:195], v[28:31]
s_lshl_b32 s46, s46, 2
v_mfma_f32_16x16x32_bf16 v[60:63], a[148:151], a[196:199], v[60:63]
s_add_u32 s46, s46, s32
buffer_load_dwordx4 v230, s[8:11], s38 offen offset:2048 lds
v_mfma_f32_16x16x32_bf16 v[32:35], a[152:155], a[192:195], v[32:35]
s_mul_i32 s45, s46, 4608
ds_read_b64_tr_b16 a[148:149], v199 offset:16384
ds_read_b64_tr_b16 a[150:151], v199 offset:18432
v_mfma_f32_16x16x32_bf16 v[64:67], a[152:155], a[196:199], v[64:67]
s_sub_u32 s45, s45, 6488064
ds_read_b64_tr_b16 a[152:153], v200 offset:16384
ds_read_b64_tr_b16 a[154:155], v200 offset:18432
v_mfma_f32_16x16x32_bf16 v[36:39], a[156:159], a[192:195], v[36:39]
s_min_u32 s46, s46, (K_CODE_END-K_LAST)>>10
v_mfma_f32_16x16x32_bf16 v[68:71], a[156:159], a[196:199], v[68:71]
s_lshl_b32 s46, s46, 10
ds_read_b64_tr_b16 a[156:157], v201 offset:16384
ds_read_b64_tr_b16 a[158:159], v201 offset:18432
v_mfma_f32_16x16x32_bf16 v[80:83], a[168:171], a[192:195], v[80:83]
s_waitcnt lgkmcnt(10)
buffer_load_dwordx4 v231, s[8:11], s38 offen offset:3072 lds
v_mfma_f32_16x16x32_bf16 v[112:115], a[168:171], a[196:199], v[112:115]
s_add_u32 s38, s38, 16384
ds_read_b64_tr_b16 a[168:169], v196 offset:16640
v_lshlrev_b32 v255, 3, v3
v_mfma_f32_16x16x32_bf16 v[84:87], a[172:175], a[192:195], v[84:87]
s_lshl_b32 s48, s55, 3
ds_read_b64_tr_b16 a[170:171], v196 offset:18688
v_add_u32 v242, s46, v234
v_mfma_f32_16x16x32_bf16 v[116:119], a[172:175], a[196:199], v[116:119]
s_add_u32 s48, s48, 0x240000
ds_read_b64_tr_b16 a[172:173], v197 offset:16640
ds_read_b64_tr_b16 a[174:175], v197 offset:18688
v_mfma_f32_16x16x32_bf16 v[88:91], a[176:179], a[192:195], v[88:91]
s_lshl_b32 s47, s2, 2
buffer_load_dwordx2 v[148:149], v255, s[20:23], s48 offen sc0 sc1
v_mfma_f32_16x16x32_bf16 v[120:123], a[176:179], a[196:199], v[120:123]
s_add_u32 s47, s47, s32
ds_read_b64_tr_b16 a[176:177], v198 offset:16640
ds_read_b64_tr_b16 a[178:179], v198 offset:18688
v_mfma_f32_16x16x32_bf16 v[92:95], a[180:183], a[192:195], v[92:95]
s_cmp_ge_u32 s47, 324
s_cselect_b64 s[24:25], s[60:61], s[56:57]
s_cselect_b32 s46, 324, 0
v_mfma_f32_16x16x32_bf16 v[124:127], a[180:183], a[196:199], v[124:127]
s_xor_b32 s48, s48, 128
ds_read_b64_tr_b16 a[180:181], v199 offset:16640
ds_read_b64_tr_b16 a[182:183], v199 offset:18688
v_mfma_f32_16x16x32_bf16 v[96:99], a[184:187], a[192:195], v[96:99]
s_cmp_ge_u32 s47, 648
s_cselect_b64 s[24:25], s[64:65], s[24:25]
s_cselect_b32 s46, 648, s46
buffer_load_dwordx2 v[150:151], v255, s[20:23], s48 offen sc0 sc1
v_mfma_f32_16x16x32_bf16 v[128:131], a[184:187], a[196:199], v[128:131]
s_sub_u32 s47, s47, s46
ds_read_b64_tr_b16 a[184:185], v200 offset:16640
ds_read_b64_tr_b16 a[186:187], v200 offset:18688
v_mfma_f32_16x16x32_bf16 v[100:103], a[188:191], a[192:195], v[100:103]
s_min_u32 s47, s47, 323
v_mfma_f32_16x16x32_bf16 v[132:135], a[188:191], a[196:199], v[132:135]
s_lshl_b32 s47, s47, 14
ds_read_b64_tr_b16 a[188:189], v201 offset:16640
ds_read_b64_tr_b16 a[190:191], v201 offset:18688
s_add_u32 s24, s24, s47
s_addc_u32 s25, s25, 0
s_mov_b32 s26, 16384
v_mfma_f32_16x16x32_bf16 v[8:11], a[128:131], a[200:203], v[8:11]
s_mov_b32 s44, 0
v_lshlrev_b32 v0, 6, v1
v_mfma_f32_16x16x32_bf16 v[40:43], a[128:131], a[204:207], v[40:43]
s_or_b32 s46, s32, s36
s_cselect_b32 s74, 8, 12
v_mfma_f32_16x16x32_bf16 v[12:15], a[132:135], a[200:203], v[12:15]
s_bitset1_b32 s74, 8
v_mfma_f32_16x16x32_bf16 v[44:47], a[132:135], a[204:207], v[44:47]
s_getpc_b64 s[72:73]
PC_c:
s_add_u32 s72, s72, K_LAST-PC_c
s_addc_u32 s73, s73, 0
v_smfmac_f32_16x16x64_bf16 a[248:251], a[208:211], a[128:135], v235
v_mfma_f32_16x16x32_bf16 v[72:75], a[160:163], a[200:203], v[72:75]
v_mfma_f32_16x16x32_bf16 v[104:107], a[160:163], a[204:207], v[104:107]
s_waitcnt vmcnt(2) lgkmcnt(0)
s_barrier
v_mfma_f32_16x16x32_bf16 v[76:79], a[164:167], a[200:203], v[76:79]
s_mov_b32 s39, 0
ds_read_b128 a[192:195], v212 offset:0
ds_read_b128 a[196:199], v212 offset:2048
v_mfma_f32_16x16x32_bf16 v[108:111], a[164:167], a[204:207], v[108:111]
s_add_u32 m0, s37, 98304
ds_read_b64_tr_b16 a[128:129], v204 offset:0
ds_read_b64_tr_b16 a[130:131], v204 offset:2048
v_smfmac_f32_16x16x64_bf16 a[252:255], a[208:211], a[160:167], v235
buffer_load_dwordx4 v232, s[12:15], s39 offen offset:0 lds
v_mfma_f32_16x16x32_bf16 v[16:19], a[136:139], a[200:203], v[16:19]
ds_read_b64_tr_b16 a[132:133], v205 offset:0
ds_read_b64_tr_b16 a[134:135], v205 offset:2048
v_mfma_f32_16x16x32_bf16 v[48:51], a[136:139], a[204:207], v[48:51]
ds_read_b64_tr_b16 a[160:161], v204 offset:256
ds_read_b64_tr_b16 a[162:163], v204 offset:2304
v_mfma_f32_16x16x32_bf16 v[20:23], a[140:143], a[200:203], v[20:23]
ds_read_b64_tr_b16 a[164:165], v205 offset:256
ds_read_b64_tr_b16 a[166:167], v205 offset:2304
v_mfma_f32_16x16x32_bf16 v[52:55], a[140:143], a[204:207], v[52:55]
buffer_load_dwordx4 v233, s[12:15], s39 offen offset:1024 lds
v_mfma_f32_16x16x32_bf16 v[24:27], a[144:147], a[200:203], v[24:27]
ds_read_b64_tr_b16 a[136:137], v206 offset:0
ds_read_b64_tr_b16 a[138:139], v206 offset:2048
v_mfma_f32_16x16x32_bf16 v[56:59], a[144:147], a[204:207], v[56:59]
ds_read_b64_tr_b16 a[140:141], v207 offset:0
ds_read_b64_tr_b16 a[142:143], v207 offset:2048
v_mfma_f32_16x16x32_bf16 v[28:31], a[148:151], a[200:203], v[28:31]
ds_read_b64_tr_b16 a[144:145], v208 offset:0
ds_read_b64_tr_b16 a[146:147], v208 offset:2048
v_mfma_f32_16x16x32_bf16 v[60:63], a[148:151], a[204:207], v[60:63]
ds_read_b64_tr_b16 a[148:149], v209 offset:0
ds_read_b64_tr_b16 a[150:151], v209 offset:2048
v_mfma_f32_16x16x32_bf16 v[32:35], a[152:155], a[200:203], v[32:35]
buffer_load_dwordx4 v232, s[12:15], s39 offen offset:2048 lds
v_mfma_f32_16x16x32_bf16 v[64:67], a[152:155], a[204:207], v[64:67]
ds_read_b64_tr_b16 a[152:153], v210 offset:0
ds_read_b64_tr_b16 a[154:155], v210 offset:2048
v_mfma_f32_16x16x32_bf16 v[36:39], a[156:159], a[200:203], v[36:39]
v_mfma_f32_16x16x32_bf16 v[68:71], a[156:159], a[204:207], v[68:71]
ds_read_b64_tr_b16 a[156:157], v211 offset:0
ds_read_b64_tr_b16 a[158:159], v211 offset:2048
v_mfma_f32_16x16x32_bf16 v[80:83], a[168:171], a[200:203], v[80:83]
buffer_load_dwordx4 v233, s[12:15], s39 offen offset:3072 lds
v_mfma_f32_16x16x32_bf16 v[112:115], a[168:171], a[204:207], v[112:115]
ds_read_b64_tr_b16 a[168:169], v206 offset:256
ds_read_b64_tr_b16 a[170:171], v206 offset:2304
v_mfma_f32_16x16x32_bf16 v[84:87], a[172:175], a[200:203], v[84:87]
s_add_u32 s39, s39, 16384
v_mfma_f32_16x16x32_bf16 v[116:119], a[172:175], a[204:207], v[116:119]
s_add_u32 m0, s37, 114688
ds_read_b64_tr_b16 a[172:173], v207 offset:256
ds_read_b64_tr_b16 a[174:175], v207 offset:2304
v_mfma_f32_16x16x32_bf16 v[88:91], a[176:179], a[200:203], v[88:91]
buffer_load_dwordx4 v232, s[12:15], s39 offen offset:0 lds
v_mfma_f32_16x16x32_bf16 v[120:123], a[176:179], a[204:207], v[120:123]
ds_read_b64_tr_b16 a[176:177], v208 offset:256
ds_read_b64_tr_b16 a[178:179], v208 offset:2304
v_mfma_f32_16x16x32_bf16 v[92:95], a[180:183], a[200:203], v[92:95]
v_mfma_f32_16x16x32_bf16 v[124:127], a[180:183], a[204:207], v[124:127]
ds_read_b64_tr_b16 a[180:181], v209 offset:256
ds_read_b64_tr_b16 a[182:183], v209 offset:2304
v_mfma_f32_16x16x32_bf16 v[96:99], a[184:187], a[200:203], v[96:99]
buffer_load_dwordx4 v233, s[12:15], s39 offen offset:1024 lds
v_mfma_f32_16x16x32_bf16 v[128:131], a[184:187], a[204:207], v[128:131]
ds_read_b64_tr_b16 a[184:185], v210 offset:256
ds_read_b64_tr_b16 a[186:187], v210 offset:2304
v_mfma_f32_16x16x32_bf16 v[100:103], a[188:191], a[200:203], v[100:103]
v_mfma_f32_16x16x32_bf16 v[132:135], a[188:191], a[204:207], v[132:135]
s_waitcnt lgkmcnt(8)
ds_read_b64_tr_b16 a[188:189], v211 offset:256
ds_read_b64_tr_b16 a[190:191], v211 offset:2304
v_mfma_f32_16x16x32_bf16 v[8:11], a[128:131], a[192:195], v[8:11]
s_lshl_b32 s46, s32, 7
buffer_load_dwordx4 v232, s[12:15], s39 offen offset:2048 lds
v_mfma_f32_16x16x32_bf16 v[40:43], a[128:131], a[196:199], v[40:43]
s_add_u32 s46, s46, 147456
ds_read_b128 a[200:203], v213 offset:0
ds_read_b128 a[204:207], v213 offset:2048
v_mfma_f32_16x16x32_bf16 v[12:15], a[132:135], a[192:195], v[12:15]
v_lshl_add_u32 v144, v3, 2, s46
v_lshl_add_u32 v5, v4, 4, s46
v_mfma_f32_16x16x32_bf16 v[44:47], a[132:135], a[196:199], v[44:47]
v_xor_b32 v6, 128, v5
v_xor_b32 v7, 256, v5
v_smfmac_f32_16x16x64_bf16 a[248:251], a[208:211], a[128:135], v235
ds_read_b64_tr_b16 a[128:129], v204 offset:16384
ds_read_b64_tr_b16 a[130:131], v204 offset:18432
v_mfma_f32_16x16x32_bf16 v[72:75], a[160:163], a[192:195], v[72:75]
buffer_load_dwordx4 v233, s[12:15], s39 offen offset:3072 lds
v_mfma_f32_16x16x32_bf16 v[104:107], a[160:163], a[196:199], v[104:107]
ds_read_b64_tr_b16 a[132:133], v205 offset:16384
ds_read_b64_tr_b16 a[134:135], v205 offset:18432
v_mfma_f32_16x16x32_bf16 v[76:79], a[164:167], a[192:195], v[76:79]
v_xor_b32 v254, 384, v5
v_mfma_f32_16x16x32_bf16 v[108:111], a[164:167], a[196:199], v[108:111]
s_add_u32 s39, s39, 16384
ds_read_b64 a[236:237], v152
ds_read_b64 a[238:239], v153
v_smfmac_f32_16x16x64_bf16 a[252:255], a[208:211], a[160:167], v235
ds_read_b64_tr_b16 a[160:161], v204 offset:16640
ds_read_b64_tr_b16 a[162:163], v204 offset:18688
v_mfma_f32_16x16x32_bf16 v[16:19], a[136:139], a[192:195], v[16:19]
ds_read_b64_tr_b16 a[164:165], v205 offset:16640
ds_read_b64_tr_b16 a[166:167], v205 offset:18688
v_mfma_f32_16x16x32_bf16 v[48:51], a[136:139], a[196:199], v[48:51]
ds_read_b64_tr_b16 a[136:137], v206 offset:16384
ds_read_b64_tr_b16 a[138:139], v206 offset:18432
v_mfma_f32_16x16x32_bf16 v[20:23], a[140:143], a[192:195], v[20:23]
ds_read_b64 a[240:241], v154
ds_read_b64 a[242:243], v155
v_mfma_f32_16x16x32_bf16 v[52:55], a[140:143], a[196:199], v[52:55]
ds_read_b64_tr_b16 a[140:141], v207 offset:16384
ds_read_b64_tr_b16 a[142:143], v207 offset:18432
v_mfma_f32_16x16x32_bf16 v[24:27], a[144:147], a[192:195], v[24:27]
v_readlane_b32 s92, v214, 0
v_readlane_b32 s93, v214, 32
v_mfma_f32_16x16x32_bf16 v[56:59], a[144:147], a[196:199], v[56:59]
ds_read_b64_tr_b16 a[144:145], v208 offset:16384
ds_read_b64_tr_b16 a[146:147], v208 offset:18432
v_mfma_f32_16x16x32_bf16 v[28:31], a[148:151], a[192:195], v[28:31]
v_mfma_f32_16x16x32_bf16 v[60:63], a[148:151], a[196:199], v[60:63]
ds_read_b64_tr_b16 a[148:149], v209 offset:16384
ds_read_b64_tr_b16 a[150:151], v209 offset:18432
v_mfma_f32_16x16x32_bf16 v[32:35], a[152:155], a[192:195], v[32:35]
v_mfma_f32_16x16x32_bf16 v[64:67], a[152:155], a[196:199], v[64:67]
ds_read_b64_tr_b16 a[152:153], v210 offset:16384
ds_read_b64_tr_b16 a[154:155], v210 offset:18432
v_mfma_f32_16x16x32_bf16 v[36:39], a[156:159], a[192:195], v[36:39]
v_mfma_f32_16x16x32_bf16 v[68:71], a[156:159], a[196:199], v[68:71]
ds_read_b64_tr_b16 a[156:157], v211 offset:16384
ds_read_b64_tr_b16 a[158:159], v211 offset:18432
v_mfma_f32_16x16x32_bf16 v[80:83], a[168:171], a[192:195], v[80:83]
v_mfma_f32_16x16x32_bf16 v[112:115], a[168:171], a[196:199], v[112:115]
s_waitcnt lgkmcnt(8)
ds_read_b64_tr_b16 a[168:169], v206 offset:16640
ds_read_b64_tr_b16 a[170:171], v206 offset:18688
v_mfma_f32_16x16x32_bf16 v[84:87], a[172:175], a[192:195], v[84:87]
v_mfma_f32_16x16x32_bf16 v[116:119], a[172:175], a[196:199], v[116:119]
ds_read_b64_tr_b16 a[172:173], v207 offset:16640
ds_read_b64_tr_b16 a[174:175], v207 offset:18688
v_mfma_f32_16x16x32_bf16 v[88:91], a[176:179], a[192:195], v[88:91]
v_mfma_f32_16x16x32_bf16 v[120:123], a[176:179], a[196:199], v[120:123]
ds_read_b64_tr_b16 a[176:177], v208 offset:16640
ds_read_b64_tr_b16 a[178:179], v208 offset:18688
v_mfma_f32_16x16x32_bf16 v[92:95], a[180:183], a[192:195], v[92:95]
v_mfma_f32_16x16x32_bf16 v[124:127], a[180:183], a[196:199], v[124:127]
ds_read_b64_tr_b16 a[180:181], v209 offset:16640
ds_read_b64_tr_b16 a[182:183], v209 offset:18688
v_mfma_f32_16x16x32_bf16 v[96:99], a[184:187], a[192:195], v[96:99]
v_mfma_f32_16x16x32_bf16 v[128:131], a[184:187], a[196:199], v[128:131]
ds_read_b64_tr_b16 a[184:185], v210 offset:16640
ds_read_b64_tr_b16 a[186:187], v210 offset:18688
v_mfma_f32_16x16x32_bf16 v[100:103], a[188:191], a[192:195], v[100:103]
v_mfma_f32_16x16x32_bf16 v[132:135], a[188:191], a[196:199], v[132:135]
ds_read_b64_tr_b16 a[188:189], v211 offset:16640
ds_read_b64_tr_b16 a[190:191], v211 offset:18688
v_mfma_f32_16x16x32_bf16 v[8:11], a[128:131], a[200:203], v[8:11]
v_mfma_f32_16x16x32_bf16 v[40:43], a[128:131], a[204:207], v[40:43]
v_mfma_f32_16x16x32_bf16 v[12:15], a[132:135], a[200:203], v[12:15]
v_mfma_f32_16x16x32_bf16 v[44:47], a[132:135], a[204:207], v[44:47]
v_smfmac_f32_16x16x64_bf16 a[248:251], a[208:211], a[128:135], v235
ds_read_b128 a[128:131], v216 offset:32768
ds_read_b128 a[132:135], v217 offset:32768
v_mfma_f32_16x16x32_bf16 v[72:75], a[160:163], a[200:203], v[72:75]
v_mfma_f32_16x16x32_bf16 v[104:107], a[160:163], a[204:207], v[104:107]
v_mfma_f32_16x16x32_bf16 v[76:79], a[164:167], a[200:203], v[76:79]
v_mfma_f32_16x16x32_bf16 v[108:111], a[164:167], a[204:207], v[108:111]
v_smfmac_f32_16x16x64_bf16 a[252:255], a[208:211], a[160:167], v235
v_mfma_f32_16x16x32_bf16 v[16:19], a[136:139], a[200:203], v[16:19]
v_accvgpr_read_b32 v136, a248
v_accvgpr_read_b32 v137, a249
v_mfma_f32_16x16x32_bf16 v[48:51], a[136:139], a[204:207], v[48:51]
v_accvgpr_read_b32 v138, a250
v_accvgpr_read_b32 v139, a251
v_mfma_f32_16x16x32_bf16 v[20:23], a[140:143], a[200:203], v[20:23]
ds_read_b128 a[136:139], v218 offset:32768
v_mfma_f32_16x16x32_bf16 v[52:55], a[140:143], a[204:207], v[52:55]
s_waitcnt lgkmcnt(3)
ds_read_b128 a[140:143], v219 offset:32768
v_mfma_f32_16x16x32_bf16 v[24:27], a[144:147], a[200:203], v[24:27]
v_mfma_f32_16x16x32_bf16 v[56:59], a[144:147], a[204:207], v[56:59]
v_accvgpr_read_b32 v140, a252
v_accvgpr_read_b32 v141, a253
v_mfma_f32_16x16x32_bf16 v[28:31], a[148:151], a[200:203], v[28:31]
v_accvgpr_read_b32 v142, a254
v_accvgpr_read_b32 v143, a255
v_mfma_f32_16x16x32_bf16 v[60:63], a[148:151], a[204:207], v[60:63]
v_add_f32 v136, v136, v137
v_add_f32 v138, v138, v139
v_mfma_f32_16x16x32_bf16 v[32:35], a[152:155], a[200:203], v[32:35]
v_add_f32 v140, v140, v141
v_add_f32 v142, v142, v143
v_mfma_f32_16x16x32_bf16 v[64:67], a[152:155], a[204:207], v[64:67]
ds_write_b32 v144, v136 offset:0
ds_write_b32 v144, v138 offset:64
v_mfma_f32_16x16x32_bf16 v[36:39], a[156:159], a[200:203], v[36:39]
ds_write_b32 v144, v140 offset:512
ds_write_b32 v144, v142 offset:576
v_mfma_f32_16x16x32_bf16 v[68:71], a[156:159], a[204:207], v[68:71]
s_waitcnt vmcnt(8)
s_nop 0
ds_read_b128 a[144:147], v216 offset:36864
ds_read_b128 a[148:151], v217 offset:36864
v_mfma_f32_16x16x32_bf16 v[80:83], a[168:171], a[200:203], v[80:83]
ds_read_b128 a[152:155], v218 offset:36864
ds_read_b128 a[156:159], v219 offset:36864
v_mfma_f32_16x16x32_bf16 v[112:115], a[168:171], a[204:207], v[112:115]
v_accvgpr_write_b32 a246, v148
v_accvgpr_write_b32 a247, v149
v_mfma_f32_16x16x32_bf16 v[84:87], a[172:175], a[200:203], v[84:87]
v_rcp_f32 v149, v149
v_mfma_f32_16x16x32_bf16 v[116:119], a[172:175], a[204:207], v[116:119]
s_waitcnt lgkmcnt(0)
s_barrier
v_mfma_f32_16x16x32_bf16 v[88:91], a[176:179], a[200:203], v[88:91]
ds_read_b128 v[184:187], v5 offset:0
ds_read_b128 v[188:191], v5 offset:64
v_mfma_f32_16x16x32_bf16 v[120:123], a[176:179], a[204:207], v[120:123]
ds_read_b128 v[192:195], v6 offset:0
ds_read_b128 v[196:199], v6 offset:64
v_mfma_f32_16x16x32_bf16 v[92:95], a[180:183], a[200:203], v[92:95]
ds_read_b128 v[200:203], v7 offset:0
ds_read_b128 v[204:207], v7 offset:64
v_mfma_f32_16x16x32_bf16 v[124:127], a[180:183], a[204:207], v[124:127]
ds_read_b128 v[208:211], v254 offset:0
ds_read_b128 v[212:215], v254 offset:64
v_mfma_f32_16x16x32_bf16 v[96:99], a[184:187], a[200:203], v[96:99]
v_rcp_f32 v151, v151
v_mfma_f32_16x16x32_bf16 v[128:131], a[184:187], a[204:207], v[128:131]
v_sub_f32 v148, 0, v148
v_sub_f32 v150, 0, v150
v_mfma_f32_16x16x32_bf16 v[100:103], a[188:191], a[200:203], v[100:103]
v_mul_f32 v149, 0x3e0293ee, v149
v_mul_f32 v151, 0x3e0293ee, v151
v_mfma_f32_16x16x32_bf16 v[132:135], a[188:191], a[204:207], v[132:135]
v_accvgpr_write_b32 a248, 0
v_accvgpr_write_b32 a249, 0
v_accvgpr_write_b32 a250, 0
v_accvgpr_write_b32 a251, 0
v_accvgpr_write_b32 a252, 0
v_accvgpr_write_b32 a253, 0
v_accvgpr_write_b32 a254, 0
v_accvgpr_write_b32 a255, 0
s_waitcnt lgkmcnt(0)
v_pk_fma_f32 v[8:9], v[184:185], v[148:149], v[8:9] op_sel:[0,0,0] op_sel_hi:[1,0,1]
v_pk_fma_f32 v[10:11], v[186:187], v[148:149], v[10:11] op_sel:[0,0,0] op_sel_hi:[1,0,1]
v_pk_mul_f32 v[8:9], v[8:9], v[148:149] op_sel:[0,1] op_sel_hi:[1,1]
v_pk_mul_f32 v[10:11], v[10:11], v[148:149] op_sel:[0,1] op_sel_hi:[1,1]
v_pk_fma_f32 v[12:13], v[188:189], v[148:149], v[12:13] op_sel:[0,0,0] op_sel_hi:[1,0,1]
v_pk_fma_f32 v[14:15], v[190:191], v[148:149], v[14:15] op_sel:[0,0,0] op_sel_hi:[1,0,1]
v_pk_mul_f32 v[12:13], v[12:13], v[148:149] op_sel:[0,1] op_sel_hi:[1,1]
v_pk_mul_f32 v[14:15], v[14:15], v[148:149] op_sel:[0,1] op_sel_hi:[1,1]
v_pk_fma_f32 v[16:17], v[192:193], v[148:149], v[16:17] op_sel:[0,0,0] op_sel_hi:[1,0,1]
v_pk_fma_f32 v[18:19], v[194:195], v[148:149], v[18:19] op_sel:[0,0,0] op_sel_hi:[1,0,1]
v_pk_mul_f32 v[16:17], v[16:17], v[148:149] op_sel:[0,1] op_sel_hi:[1,1]
v_pk_mul_f32 v[18:19], v[18:19], v[148:149] op_sel:[0,1] op_sel_hi:[1,1]
v_pk_fma_f32 v[20:21], v[196:197], v[148:149], v[20:21] op_sel:[0,0,0] op_sel_hi:[1,0,1]
v_pk_fma_f32 v[22:23], v[198:199], v[148:149], v[22:23] op_sel:[0,0,0] op_sel_hi:[1,0,1]
v_pk_mul_f32 v[20:21], v[20:21], v[148:149] op_sel:[0,1] op_sel_hi:[1,1]
v_pk_mul_f32 v[22:23], v[22:23], v[148:149] op_sel:[0,1] op_sel_hi:[1,1]
v_pk_fma_f32 v[24:25], v[200:201], v[148:149], v[24:25] op_sel:[0,0,0] op_sel_hi:[1,0,1]
v_pk_fma_f32 v[26:27], v[202:203], v[148:149], v[26:27] op_sel:[0,0,0] op_sel_hi:[1,0,1]
v_pk_mul_f32 v[24:25], v[24:25], v[148:149] op_sel:[0,1] op_sel_hi:[1,1]
v_pk_mul_f32 v[26:27], v[26:27], v[148:149] op_sel:[0,1] op_sel_hi:[1,1]
v_pk_fma_f32 v[28:29], v[204:205], v[148:149], v[28:29] op_sel:[0,0,0] op_sel_hi:[1,0,1]
v_pk_fma_f32 v[30:31], v[206:207], v[148:149], v[30:31] op_sel:[0,0,0] op_sel_hi:[1,0,1]
v_pk_mul_f32 v[28:29], v[28:29], v[148:149] op_sel:[0,1] op_sel_hi:[1,1]
v_pk_mul_f32 v[30:31], v[30:31], v[148:149] op_sel:[0,1] op_sel_hi:[1,1]
v_pk_fma_f32 v[32:33], v[208:209], v[148:149], v[32:33] op_sel:[0,0,0] op_sel_hi:[1,0,1]
v_pk_fma_f32 v[34:35], v[210:211], v[148:149], v[34:35] op_sel:[0,0,0] op_sel_hi:[1,0,1]
v_pk_mul_f32 v[32:33], v[32:33], v[148:149] op_sel:[0,1] op_sel_hi:[1,1]
v_pk_mul_f32 v[34:35], v[34:35], v[148:149] op_sel:[0,1] op_sel_hi:[1,1]
v_pk_fma_f32 v[36:37], v[212:213], v[148:149], v[36:37] op_sel:[0,0,0] op_sel_hi:[1,0,1]
v_pk_fma_f32 v[38:39], v[214:215], v[148:149], v[38:39] op_sel:[0,0,0] op_sel_hi:[1,0,1]
v_pk_mul_f32 v[36:37], v[36:37], v[148:149] op_sel:[0,1] op_sel_hi:[1,1]
v_pk_mul_f32 v[38:39], v[38:39], v[148:149] op_sel:[0,1] op_sel_hi:[1,1]
v_cvt_pk_bf16_f32 v152, v8, v9
v_cvt_pk_bf16_f32 v153, v10, v11
v_cvt_pk_bf16_f32 v154, v12, v13
v_cvt_pk_bf16_f32 v155, v14, v15
v_cvt_pk_bf16_f32 v156, v16, v17
v_cvt_pk_bf16_f32 v157, v18, v19
v_cvt_pk_bf16_f32 v158, v20, v21
v_cvt_pk_bf16_f32 v159, v22, v23
v_cvt_pk_bf16_f32 v160, v24, v25
v_cvt_pk_bf16_f32 v161, v26, v27
v_cvt_pk_bf16_f32 v162, v28, v29
v_cvt_pk_bf16_f32 v163, v30, v31
v_cvt_pk_bf16_f32 v164, v32, v33
v_cvt_pk_bf16_f32 v165, v34, v35
v_cvt_pk_bf16_f32 v166, v36, v37
v_cvt_pk_bf16_f32 v167, v38, v39
v_permlane16_swap_b32 v152, v154
v_permlane16_swap_b32 v153, v155
v_permlane16_swap_b32 v156, v158
v_permlane16_swap_b32 v157, v159
v_permlane16_swap_b32 v160, v162
v_permlane16_swap_b32 v161, v163
v_permlane16_swap_b32 v164, v166
v_permlane16_swap_b32 v165, v167
v_pk_fma_f32 v[40:41], v[184:185], v[150:151], v[40:41] op_sel:[0,0,0] op_sel_hi:[1,0,1]
v_pk_fma_f32 v[42:43], v[186:187], v[150:151], v[42:43] op_sel:[0,0,0] op_sel_hi:[1,0,1]
v_pk_mul_f32 v[40:41], v[40:41], v[150:151] op_sel:[0,1] op_sel_hi:[1,1]
v_pk_mul_f32 v[42:43], v[42:43], v[150:151] op_sel:[0,1] op_sel_hi:[1,1]
v_pk_fma_f32 v[44:45], v[188:189], v[150:151], v[44:45] op_sel:[0,0,0] op_sel_hi:[1,0,1]
v_pk_fma_f32 v[46:47], v[190:191], v[150:151], v[46:47] op_sel:[0,0,0] op_sel_hi:[1,0,1]
v_pk_mul_f32 v[44:45], v[44:45], v[150:151] op_sel:[0,1] op_sel_hi:[1,1]
v_pk_mul_f32 v[46:47], v[46:47], v[150:151] op_sel:[0,1] op_sel_hi:[1,1]
v_pk_fma_f32 v[48:49], v[192:193], v[150:151], v[48:49] op_sel:[0,0,0] op_sel_hi:[1,0,1]
v_pk_fma_f32 v[50:51], v[194:195], v[150:151], v[50:51] op_sel:[0,0,0] op_sel_hi:[1,0,1]
v_pk_mul_f32 v[48:49], v[48:49], v[150:151] op_sel:[0,1] op_sel_hi:[1,1]
v_pk_mul_f32 v[50:51], v[50:51], v[150:151] op_sel:[0,1] op_sel_hi:[1,1]
v_pk_fma_f32 v[52:53], v[196:197], v[150:151], v[52:53] op_sel:[0,0,0] op_sel_hi:[1,0,1]
v_pk_fma_f32 v[54:55], v[198:199], v[150:151], v[54:55] op_sel:[0,0,0] op_sel_hi:[1,0,1]
v_pk_mul_f32 v[52:53], v[52:53], v[150:151] op_sel:[0,1] op_sel_hi:[1,1]
v_pk_mul_f32 v[54:55], v[54:55], v[150:151] op_sel:[0,1] op_sel_hi:[1,1]
v_pk_fma_f32 v[56:57], v[200:201], v[150:151], v[56:57] op_sel:[0,0,0] op_sel_hi:[1,0,1]
v_pk_fma_f32 v[58:59], v[202:203], v[150:151], v[58:59] op_sel:[0,0,0] op_sel_hi:[1,0,1]
v_pk_mul_f32 v[56:57], v[56:57], v[150:151] op_sel:[0,1] op_sel_hi:[1,1]
v_pk_mul_f32 v[58:59], v[58:59], v[150:151] op_sel:[0,1] op_sel_hi:[1,1]
v_pk_fma_f32 v[60:61], v[204:205], v[150:151], v[60:61] op_sel:[0,0,0] op_sel_hi:[1,0,1]
v_pk_fma_f32 v[62:63], v[206:207], v[150:151], v[62:63] op_sel:[0,0,0] op_sel_hi:[1,0,1]
v_pk_mul_f32 v[60:61], v[60:61], v[150:151] op_sel:[0,1] op_sel_hi:[1,1]
v_pk_mul_f32 v[62:63], v[62:63], v[150:151] op_sel:[0,1] op_sel_hi:[1,1]
v_pk_fma_f32 v[64:65], v[208:209], v[150:151], v[64:65] op_sel:[0,0,0] op_sel_hi:[1,0,1]
v_pk_fma_f32 v[66:67], v[210:211], v[150:151], v[66:67] op_sel:[0,0,0] op_sel_hi:[1,0,1]
v_pk_mul_f32 v[64:65], v[64:65], v[150:151] op_sel:[0,1] op_sel_hi:[1,1]
v_pk_mul_f32 v[66:67], v[66:67], v[150:151] op_sel:[0,1] op_sel_hi:[1,1]
v_pk_fma_f32 v[68:69], v[212:213], v[150:151], v[68:69] op_sel:[0,0,0] op_sel_hi:[1,0,1]
v_pk_fma_f32 v[70:71], v[214:215], v[150:151], v[70:71] op_sel:[0,0,0] op_sel_hi:[1,0,1]
v_pk_mul_f32 v[68:69], v[68:69], v[150:151] op_sel:[0,1] op_sel_hi:[1,1]
v_pk_mul_f32 v[70:71], v[70:71], v[150:151] op_sel:[0,1] op_sel_hi:[1,1]
v_mfma_f32_16x16x32_bf16 v[8:11], a[128:131], v[152:155], 0
ds_read_b128 v[24:27], v5 offset:512
v_cvt_pk_bf16_f32 v168, v40, v41
v_mfma_f32_16x16x32_bf16 v[8:11], a[132:135], v[156:159], v[8:11]
ds_read_b128 v[28:31], v5 offset:576
v_cvt_pk_bf16_f32 v169, v42, v43
v_mfma_f32_16x16x32_bf16 v[8:11], a[136:139], v[160:163], v[8:11]
ds_read_b128 v[32:35], v6 offset:512
v_cvt_pk_bf16_f32 v170, v44, v45
v_mfma_f32_16x16x32_bf16 v[8:11], a[140:143], v[164:167], v[8:11]
ds_read_b128 v[36:39], v6 offset:576
v_cvt_pk_bf16_f32 v171, v46, v47
v_mfma_f32_16x16x32_bf16 v[12:15], a[144:147], v[152:155], 0
ds_read_b128 v[136:139], v7 offset:512
v_cvt_pk_bf16_f32 v172, v48, v49
v_mfma_f32_16x16x32_bf16 v[12:15], a[148:151], v[156:159], v[12:15]
ds_read_b128 v[140:143], v7 offset:576
v_cvt_pk_bf16_f32 v173, v50, v51
v_mfma_f32_16x16x32_bf16 v[12:15], a[152:155], v[160:163], v[12:15]
ds_read_b128 v[144:147], v254 offset:512
v_cvt_pk_bf16_f32 v174, v52, v53
v_mfma_f32_16x16x32_bf16 v[12:15], a[156:159], v[164:167], v[12:15]
ds_read_b128 v[244:247], v254 offset:576
v_cvt_pk_bf16_f32 v175, v54, v55
v_cvt_pk_bf16_f32 v176, v56, v57
v_cvt_pk_bf16_f32 v177, v58, v59
v_cvt_pk_bf16_f32 v178, v60, v61
v_cvt_pk_bf16_f32 v179, v62, v63
v_cvt_pk_bf16_f32 v180, v64, v65
v_cvt_pk_bf16_f32 v181, v66, v67
v_cvt_pk_bf16_f32 v182, v68, v69
v_cvt_pk_bf16_f32 v183, v70, v71
v_permlane16_swap_b32 v168, v170
v_permlane16_swap_b32 v169, v171
v_permlane16_swap_b32 v172, v174
v_permlane16_swap_b32 v173, v175
v_permlane16_swap_b32 v176, v178
v_permlane16_swap_b32 v177, v179
v_permlane16_swap_b32 v180, v182
v_permlane16_swap_b32 v181, v183
s_waitcnt lgkmcnt(0)
v_pk_fma_f32 v[72:73], v[24:25], v[148:149], v[72:73] op_sel:[0,0,0] op_sel_hi:[1,0,1]
v_pk_fma_f32 v[74:75], v[26:27], v[148:149], v[74:75] op_sel:[0,0,0] op_sel_hi:[1,0,1]
v_pk_mul_f32 v[72:73], v[72:73], v[148:149] op_sel:[0,1] op_sel_hi:[1,1]
v_pk_mul_f32 v[74:75], v[74:75], v[148:149] op_sel:[0,1] op_sel_hi:[1,1]
v_pk_fma_f32 v[76:77], v[28:29], v[148:149], v[76:77] op_sel:[0,0,0] op_sel_hi:[1,0,1]
v_pk_fma_f32 v[78:79], v[30:31], v[148:149], v[78:79] op_sel:[0,0,0] op_sel_hi:[1,0,1]
v_pk_mul_f32 v[76:77], v[76:77], v[148:149] op_sel:[0,1] op_sel_hi:[1,1]
v_pk_mul_f32 v[78:79], v[78:79], v[148:149] op_sel:[0,1] op_sel_hi:[1,1]
v_pk_fma_f32 v[80:81], v[32:33], v[148:149], v[80:81] op_sel:[0,0,0] op_sel_hi:[1,0,1]
v_pk_fma_f32 v[82:83], v[34:35], v[148:149], v[82:83] op_sel:[0,0,0] op_sel_hi:[1,0,1]
v_pk_mul_f32 v[80:81], v[80:81], v[148:149] op_sel:[0,1] op_sel_hi:[1,1]
v_pk_mul_f32 v[82:83], v[82:83], v[148:149] op_sel:[0,1] op_sel_hi:[1,1]
v_pk_fma_f32 v[84:85], v[36:37], v[148:149], v[84:85] op_sel:[0,0,0] op_sel_hi:[1,0,1]
v_pk_fma_f32 v[86:87], v[38:39], v[148:149], v[86:87] op_sel:[0,0,0] op_sel_hi:[1,0,1]
v_pk_mul_f32 v[84:85], v[84:85], v[148:149] op_sel:[0,1] op_sel_hi:[1,1]
v_pk_mul_f32 v[86:87], v[86:87], v[148:149] op_sel:[0,1] op_sel_hi:[1,1]
v_pk_fma_f32 v[88:89], v[136:137], v[148:149], v[88:89] op_sel:[0,0,0] op_sel_hi:[1,0,1]
v_pk_fma_f32 v[90:91], v[138:139], v[148:149], v[90:91] op_sel:[0,0,0] op_sel_hi:[1,0,1]
v_pk_mul_f32 v[88:89], v[88:89], v[148:149] op_sel:[0,1] op_sel_hi:[1,1]
v_pk_mul_f32 v[90:91], v[90:91], v[148:149] op_sel:[0,1] op_sel_hi:[1,1]
v_pk_fma_f32 v[92:93], v[140:141], v[148:149], v[92:93] op_sel:[0,0,0] op_sel_hi:[1,0,1]
v_pk_fma_f32 v[94:95], v[142:143], v[148:149], v[94:95] op_sel:[0,0,0] op_sel_hi:[1,0,1]
v_pk_mul_f32 v[92:93], v[92:93], v[148:149] op_sel:[0,1] op_sel_hi:[1,1]
v_pk_mul_f32 v[94:95], v[94:95], v[148:149] op_sel:[0,1] op_sel_hi:[1,1]
v_pk_fma_f32 v[96:97], v[144:145], v[148:149], v[96:97] op_sel:[0,0,0] op_sel_hi:[1,0,1]
v_pk_fma_f32 v[98:99], v[146:147], v[148:149], v[98:99] op_sel:[0,0,0] op_sel_hi:[1,0,1]
v_pk_mul_f32 v[96:97], v[96:97], v[148:149] op_sel:[0,1] op_sel_hi:[1,1]
v_pk_mul_f32 v[98:99], v[98:99], v[148:149] op_sel:[0,1] op_sel_hi:[1,1]
v_pk_fma_f32 v[100:101], v[244:245], v[148:149], v[100:101] op_sel:[0,0,0] op_sel_hi:[1,0,1]
v_pk_fma_f32 v[102:103], v[246:247], v[148:149], v[102:103] op_sel:[0,0,0] op_sel_hi:[1,0,1]
v_pk_mul_f32 v[100:101], v[100:101], v[148:149] op_sel:[0,1] op_sel_hi:[1,1]
v_pk_mul_f32 v[102:103], v[102:103], v[148:149] op_sel:[0,1] op_sel_hi:[1,1]
v_mfma_f32_16x16x32_bf16 v[16:19], a[128:131], v[168:171], 0
v_cvt_pk_bf16_f32 v184, v72, v73
v_cvt_pk_bf16_f32 v185, v74, v75
v_mfma_f32_16x16x32_bf16 v[16:19], a[132:135], v[172:175], v[16:19]
v_cvt_pk_bf16_f32 v186, v76, v77
v_cvt_pk_bf16_f32 v187, v78, v79
v_mfma_f32_16x16x32_bf16 v[16:19], a[136:139], v[176:179], v[16:19]
v_cvt_pk_bf16_f32 v188, v80, v81
v_cvt_pk_bf16_f32 v189, v82, v83
v_mfma_f32_16x16x32_bf16 v[16:19], a[140:143], v[180:183], v[16:19]
v_cvt_pk_bf16_f32 v190, v84, v85
v_cvt_pk_bf16_f32 v191, v86, v87
v_mfma_f32_16x16x32_bf16 v[20:23], a[144:147], v[168:171], 0
v_cvt_pk_bf16_f32 v192, v88, v89
v_cvt_pk_bf16_f32 v193, v90, v91
v_mfma_f32_16x16x32_bf16 v[20:23], a[148:151], v[172:175], v[20:23]
v_cvt_pk_bf16_f32 v194, v92, v93
v_cvt_pk_bf16_f32 v195, v94, v95
v_mfma_f32_16x16x32_bf16 v[20:23], a[152:155], v[176:179], v[20:23]
v_cvt_pk_bf16_f32 v196, v96, v97
v_cvt_pk_bf16_f32 v197, v98, v99
v_mfma_f32_16x16x32_bf16 v[20:23], a[156:159], v[180:183], v[20:23]
v_cvt_pk_bf16_f32 v198, v100, v101
v_cvt_pk_bf16_f32 v199, v102, v103
v_permlane16_swap_b32 v184, v186
v_permlane16_swap_b32 v185, v187
v_permlane16_swap_b32 v188, v190
v_permlane16_swap_b32 v189, v191
v_permlane16_swap_b32 v192, v194
v_permlane16_swap_b32 v193, v195
v_permlane16_swap_b32 v196, v198
v_permlane16_swap_b32 v197, v199
v_pk_fma_f32 v[104:105], v[24:25], v[150:151], v[104:105] op_sel:[0,0,0] op_sel_hi:[1,0,1]
v_pk_fma_f32 v[106:107], v[26:27], v[150:151], v[106:107] op_sel:[0,0,0] op_sel_hi:[1,0,1]
v_pk_mul_f32 v[104:105], v[104:105], v[150:151] op_sel:[0,1] op_sel_hi:[1,1]
v_pk_mul_f32 v[106:107], v[106:107], v[150:151] op_sel:[0,1] op_sel_hi:[1,1]
v_pk_fma_f32 v[108:109], v[28:29], v[150:151], v[108:109] op_sel:[0,0,0] op_sel_hi:[1,0,1]
v_pk_fma_f32 v[110:111], v[30:31], v[150:151], v[110:111] op_sel:[0,0,0] op_sel_hi:[1,0,1]
v_pk_mul_f32 v[108:109], v[108:109], v[150:151] op_sel:[0,1] op_sel_hi:[1,1]
v_pk_mul_f32 v[110:111], v[110:111], v[150:151] op_sel:[0,1] op_sel_hi:[1,1]
v_pk_fma_f32 v[112:113], v[32:33], v[150:151], v[112:113] op_sel:[0,0,0] op_sel_hi:[1,0,1]
v_pk_fma_f32 v[114:115], v[34:35], v[150:151], v[114:115] op_sel:[0,0,0] op_sel_hi:[1,0,1]
v_pk_mul_f32 v[112:113], v[112:113], v[150:151] op_sel:[0,1] op_sel_hi:[1,1]
v_pk_mul_f32 v[114:115], v[114:115], v[150:151] op_sel:[0,1] op_sel_hi:[1,1]
v_pk_fma_f32 v[116:117], v[36:37], v[150:151], v[116:117] op_sel:[0,0,0] op_sel_hi:[1,0,1]
v_pk_fma_f32 v[118:119], v[38:39], v[150:151], v[118:119] op_sel:[0,0,0] op_sel_hi:[1,0,1]
v_pk_mul_f32 v[116:117], v[116:117], v[150:151] op_sel:[0,1] op_sel_hi:[1,1]
v_pk_mul_f32 v[118:119], v[118:119], v[150:151] op_sel:[0,1] op_sel_hi:[1,1]
v_pk_fma_f32 v[120:121], v[136:137], v[150:151], v[120:121] op_sel:[0,0,0] op_sel_hi:[1,0,1]
v_pk_fma_f32 v[122:123], v[138:139], v[150:151], v[122:123] op_sel:[0,0,0] op_sel_hi:[1,0,1]
v_pk_mul_f32 v[120:121], v[120:121], v[150:151] op_sel:[0,1] op_sel_hi:[1,1]
v_pk_mul_f32 v[122:123], v[122:123], v[150:151] op_sel:[0,1] op_sel_hi:[1,1]
v_pk_fma_f32 v[124:125], v[140:141], v[150:151], v[124:125] op_sel:[0,0,0] op_sel_hi:[1,0,1]
v_pk_fma_f32 v[126:127], v[142:143], v[150:151], v[126:127] op_sel:[0,0,0] op_sel_hi:[1,0,1]
v_pk_mul_f32 v[124:125], v[124:125], v[150:151] op_sel:[0,1] op_sel_hi:[1,1]
v_pk_mul_f32 v[126:127], v[126:127], v[150:151] op_sel:[0,1] op_sel_hi:[1,1]
v_pk_fma_f32 v[128:129], v[144:145], v[150:151], v[128:129] op_sel:[0,0,0] op_sel_hi:[1,0,1]
v_pk_fma_f32 v[130:131], v[146:147], v[150:151], v[130:131] op_sel:[0,0,0] op_sel_hi:[1,0,1]
v_pk_mul_f32 v[128:129], v[128:129], v[150:151] op_sel:[0,1] op_sel_hi:[1,1]
v_pk_mul_f32 v[130:131], v[130:131], v[150:151] op_sel:[0,1] op_sel_hi:[1,1]
v_pk_fma_f32 v[132:133], v[244:245], v[150:151], v[132:133] op_sel:[0,0,0] op_sel_hi:[1,0,1]
v_pk_fma_f32 v[134:135], v[246:247], v[150:151], v[134:135] op_sel:[0,0,0] op_sel_hi:[1,0,1]
v_pk_mul_f32 v[132:133], v[132:133], v[150:151] op_sel:[0,1] op_sel_hi:[1,1]
v_pk_mul_f32 v[134:135], v[134:135], v[150:151] op_sel:[0,1] op_sel_hi:[1,1]
v_mfma_f32_16x16x32_bf16 v[24:27], a[128:131], v[184:187], 0
v_cvt_pk_bf16_f32 v200, v104, v105
v_cvt_pk_bf16_f32 v201, v106, v107
v_mfma_f32_16x16x32_bf16 v[24:27], a[132:135], v[188:191], v[24:27]
v_cvt_pk_bf16_f32 v202, v108, v109
v_cvt_pk_bf16_f32 v203, v110, v111
v_mfma_f32_16x16x32_bf16 v[24:27], a[136:139], v[192:195], v[24:27]
v_cvt_pk_bf16_f32 v204, v112, v113
v_cvt_pk_bf16_f32 v205, v114, v115
v_mfma_f32_16x16x32_bf16 v[24:27], a[140:143], v[196:199], v[24:27]
v_cvt_pk_bf16_f32 v206, v116, v117
v_cvt_pk_bf16_f32 v207, v118, v119
v_mfma_f32_16x16x32_bf16 v[28:31], a[144:147], v[184:187], 0
v_cvt_pk_bf16_f32 v208, v120, v121
v_cvt_pk_bf16_f32 v209, v122, v123
v_mfma_f32_16x16x32_bf16 v[28:31], a[148:151], v[188:191], v[28:31]
v_cvt_pk_bf16_f32 v210, v124, v125
v_cvt_pk_bf16_f32 v211, v126, v127
v_mfma_f32_16x16x32_bf16 v[28:31], a[152:155], v[192:195], v[28:31]
v_cvt_pk_bf16_f32 v212, v128, v129
v_cvt_pk_bf16_f32 v213, v130, v131
v_mfma_f32_16x16x32_bf16 v[28:31], a[156:159], v[196:199], v[28:31]
v_cvt_pk_bf16_f32 v214, v132, v133
v_cvt_pk_bf16_f32 v215, v134, v135
v_permlane16_swap_b32 v200, v202
v_permlane16_swap_b32 v201, v203
v_permlane16_swap_b32 v204, v206
v_permlane16_swap_b32 v205, v207
v_permlane16_swap_b32 v208, v210
v_permlane16_swap_b32 v209, v211
v_permlane16_swap_b32 v212, v214
v_permlane16_swap_b32 v213, v215
v_max3_f32 v136, v8, v9, v10
v_max3_f32 v136, v136, v11, v12
v_mfma_f32_16x16x32_bf16 v[32:35], a[128:131], v[200:203], 0
ds_read_b128 a[128:131], v216 offset:40960
v_max3_f32 v136, v136, v13, v14
v_mfma_f32_16x16x32_bf16 v[32:35], a[132:135], v[204:207], v[32:35]
ds_read_b128 a[132:135], v217 offset:40960
v_max_f32 v136, v136, v15
v_mfma_f32_16x16x32_bf16 v[32:35], a[136:139], v[208:211], v[32:35]
ds_read_b128 a[136:139], v218 offset:40960
v_mov_b32 v137, v136
v_mfma_f32_16x16x32_bf16 v[32:35], a[140:143], v[212:215], v[32:35]
ds_read_b128 a[140:143], v219 offset:40960
v_max3_f32 v140, v16, v17, v18
v_mfma_f32_16x16x32_bf16 v[36:39], a[144:147], v[200:203], 0
ds_read_b128 a[144:147], v216 offset:45056
v_max3_f32 v140, v140, v19, v20
v_mfma_f32_16x16x32_bf16 v[36:39], a[148:151], v[204:207], v[36:39]
ds_read_b128 a[148:151], v217 offset:45056
v_max3_f32 v140, v140, v21, v22
v_mfma_f32_16x16x32_bf16 v[36:39], a[152:155], v[208:211], v[36:39]
ds_read_b128 a[152:155], v218 offset:45056
v_max_f32 v140, v140, v23
v_mfma_f32_16x16x32_bf16 v[36:39], a[156:159], v[212:215], v[36:39]
ds_read_b128 a[156:159], v219 offset:45056
v_mov_b32 v141, v140
s_mov_b32 s48, 0x244000
buffer_load_dwordx4 v[104:107], v234, s[20:23], s48 offen offset:0 sc0 sc1
buffer_load_dwordx4 v[108:111], v234, s[20:23], s48 offen offset:1024 sc0 sc1
buffer_load_dwordx4 v[112:115], v234, s[20:23], s48 offen offset:2048 sc0 sc1
buffer_load_dwordx4 v[116:119], v234, s[20:23], s48 offen offset:3072 sc0 sc1
v_max3_f32 v144, v24, v25, v26
v_max3_f32 v144, v144, v27, v28
v_max3_f32 v144, v144, v29, v30
v_max_f32 v144, v144, v31
v_mov_b32 v145, v144
s_mov_b32 s48, 0x245000
buffer_load_dwordx4 v[120:123], v234, s[20:23], s48 offen offset:0 sc0 sc1
buffer_load_dwordx4 v[124:127], v234, s[20:23], s48 offen offset:1024 sc0 sc1
buffer_load_dwordx4 v[128:131], v234, s[20:23], s48 offen offset:2048 sc0 sc1
buffer_load_dwordx4 v[132:135], v234, s[20:23], s48 offen offset:3072 sc0 sc1
v_max3_f32 v148, v32, v33, v34
v_max3_f32 v148, v148, v35, v36
v_max3_f32 v148, v148, v37, v38
v_max_f32 v148, v148, v39
v_mov_b32 v149, v148
v_permlane16_swap_b32 v136, v137
v_permlane16_swap_b32 v140, v141
v_permlane16_swap_b32 v144, v145
v_permlane16_swap_b32 v148, v149
v_max_f32 v136, v136, v137
v_mov_b32 v137, v136
v_max_f32 v140, v140, v141
v_mov_b32 v141, v140
v_max_f32 v144, v144, v145
v_mov_b32 v145, v144
v_max_f32 v148, v148, v149
v_mov_b32 v149, v148
v_permlane32_swap_b32 v136, v137
v_permlane32_swap_b32 v140, v141
v_permlane32_swap_b32 v144, v145
v_permlane32_swap_b32 v148, v149
v_max_f32 v136, v136, v137
v_max_f32 v140, v140, v141
v_max_f32 v144, v144, v145
v_max_f32 v148, v148, v149
v_sub_f32 v139, -4.0, v136
v_sub_f32 v138, -4.0, v136
v_sub_f32 v137, -4.0, v136
v_sub_f32 v136, -4.0, v136
v_sub_f32 v143, -4.0, v140
v_sub_f32 v142, -4.0, v140
v_sub_f32 v141, -4.0, v140
v_sub_f32 v140, -4.0, v140
v_sub_f32 v147, -4.0, v144
v_sub_f32 v146, -4.0, v144
v_sub_f32 v145, -4.0, v144
v_sub_f32 v144, -4.0, v144
v_sub_f32 v151, -4.0, v148
v_sub_f32 v150, -4.0, v148
v_sub_f32 v149, -4.0, v148
v_sub_f32 v148, -4.0, v148
K_HAVEMAX:
v_pk_add_f32 v[8:9], v[8:9], v[136:137]
v_pk_add_f32 v[10:11], v[10:11], v[136:137]
v_pk_add_f32 v[12:13], v[12:13], v[136:137]
v_pk_add_f32 v[14:15], v[14:15], v[136:137]
v_pk_add_f32 v[16:17], v[16:17], v[140:141]
v_pk_add_f32 v[18:19], v[18:19], v[140:141]
v_pk_add_f32 v[20:21], v[20:21], v[140:141]
v_pk_add_f32 v[22:23], v[22:23], v[140:141]
v_pk_add_f32 v[24:25], v[24:25], v[144:145]
v_pk_add_f32 v[26:27], v[26:27], v[144:145]
v_pk_add_f32 v[28:29], v[28:29], v[144:145]
v_pk_add_f32 v[30:31], v[30:31], v[144:145]
v_pk_add_f32 v[32:33], v[32:33], v[148:149]
v_pk_add_f32 v[34:35], v[34:35], v[148:149]
v_pk_add_f32 v[36:37], v[36:37], v[148:149]
v_pk_add_f32 v[38:39], v[38:39], v[148:149]
v_mov_b32 v5, 0
s_lshl_b32 s46, s32, 2
s_add_u32 s46, s46, 163776
v_mov_b32 v6, s46
v_and_b32 v7, 12, v1
v_add_u32 v7, 163776, v7
ds_write_b32 v6, v5
s_waitcnt lgkmcnt(8)
v_mfma_f32_16x16x32_bf16 v[40:43], a[128:131], v[152:155], v[136:139]
s_waitcnt lgkmcnt(7)
v_exp_f32 v8, v8
v_exp_f32 v9, v9
v_mfma_f32_16x16x32_bf16 v[40:43], a[132:135], v[156:159], v[40:43]
s_waitcnt lgkmcnt(6)
v_cvt_pk_bf16_f32 v72, v8, v9
v_exp_f32 v10, v10
v_mfma_f32_16x16x32_bf16 v[40:43], a[136:139], v[160:163], v[40:43]
s_waitcnt lgkmcnt(5)
v_exp_f32 v11, v11
v_mfma_f32_16x16x32_bf16 v[40:43], a[140:143], v[164:167], v[40:43]
v_cvt_pk_bf16_f32 v73, v10, v11
v_exp_f32 v12, v12
v_mfma_f32_16x16x32_bf16 v[48:51], a[128:131], v[168:171], v[140:143]
v_exp_f32 v13, v13
v_mfma_f32_16x16x32_bf16 v[48:51], a[132:135], v[172:175], v[48:51]
v_cvt_pk_bf16_f32 v74, v12, v13
v_exp_f32 v14, v14
s_waitcnt vmcnt(8) lgkmcnt(0)
s_barrier
v_mfma_f32_16x16x32_bf16 v[48:51], a[136:139], v[176:179], v[48:51]
ds_read_b64_tr_b16 a[160:161], v220 offset:32768
ds_read_b64_tr_b16 a[162:163], v220 offset:36864
v_exp_f32 v15, v15
v_mfma_f32_16x16x32_bf16 v[48:51], a[140:143], v[180:183], v[48:51]
s_add_u32 m0, s37, 65536
v_exp_f32 v16, v16
v_exp_f32 v17, v17
v_mfma_f32_16x16x32_bf16 v[56:59], a[128:131], v[184:187], v[144:147]
buffer_load_dwordx4 v232, s[12:15], s39 offen offset:0 lds
v_exp_f32 v18, v18
v_mfma_f32_16x16x32_bf16 v[56:59], a[132:135], v[188:191], v[56:59]
ds_read_b64_tr_b16 a[164:165], v221 offset:32768
ds_read_b64_tr_b16 a[166:167], v221 offset:36864
v_exp_f32 v19, v19
v_mfma_f32_16x16x32_bf16 v[56:59], a[136:139], v[192:195], v[56:59]
buffer_load_dwordx4 v233, s[12:15], s39 offen offset:1024 lds
v_exp_f32 v20, v20
v_mfma_f32_16x16x32_bf16 v[56:59], a[140:143], v[196:199], v[56:59]
ds_read_b64_tr_b16 a[168:169], v222 offset:32768
ds_read_b64_tr_b16 a[170:171], v222 offset:36864
v_exp_f32 v21, v21
v_mfma_f32_16x16x32_bf16 v[64:67], a[128:131], v[200:203], v[148:151]
ds_read_b64_tr_b16 a[172:173], v223 offset:32768
ds_read_b64_tr_b16 a[174:175], v223 offset:36864
v_exp_f32 v22, v22
v_mfma_f32_16x16x32_bf16 v[64:67], a[132:135], v[204:207], v[64:67]
ds_read_b128 a[128:131], v216 offset:16384
ds_read_b64_tr_b16 a[176:177], v224 offset:32768
v_exp_f32 v23, v23
v_mfma_f32_16x16x32_bf16 v[64:67], a[136:139], v[208:211], v[64:67]
v_exp_f32 v24, v24
v_exp_f32 v25, v25
v_mfma_f32_16x16x32_bf16 v[64:67], a[140:143], v[212:215], v[64:67]
buffer_load_dwordx4 v232, s[12:15], s39 offen offset:2048 lds
v_exp_f32 v26, v26
v_mfma_f32_16x16x32_bf16 v[44:47], a[144:147], v[152:155], v[136:139]
ds_read_b64_tr_b16 a[178:179], v224 offset:36864
ds_read_b128 a[132:135], v217 offset:16384
v_exp_f32 v27, v27
v_mfma_f32_16x16x32_bf16 v[44:47], a[148:151], v[156:159], v[44:47]
ds_read_b128 a[136:139], v218 offset:16384
ds_read_b128 a[140:143], v219 offset:16384
v_exp_f32 v28, v28
v_mfma_f32_16x16x32_bf16 v[44:47], a[152:155], v[160:163], v[44:47]
buffer_load_dwordx4 v233, s[12:15], s39 offen offset:3072 lds
v_exp_f32 v29, v29
v_mfma_f32_16x16x32_bf16 v[44:47], a[156:159], v[164:167], v[44:47]
ds_read_b64_tr_b16 a[180:181], v225 offset:32768
ds_read_b64_tr_b16 a[182:183], v225 offset:36864
v_exp_f32 v30, v30
v_mfma_f32_16x16x32_bf16 v[52:55], a[144:147], v[168:171], v[140:143]
ds_read_b64_tr_b16 a[184:185], v226 offset:32768
ds_read_b64_tr_b16 a[186:187], v226 offset:36864
v_exp_f32 v31, v31
v_mfma_f32_16x16x32_bf16 v[52:55], a[148:151], v[172:175], v[52:55]
s_add_u32 s39, s39, 16384
v_exp_f32 v32, v32
v_exp_f32 v33, v33
v_mfma_f32_16x16x32_bf16 v[52:55], a[152:155], v[176:179], v[52:55]
s_add_u32 m0, s37, 49152
ds_read_b64_tr_b16 a[188:189], v227 offset:32768
ds_read_b64_tr_b16 a[190:191], v227 offset:36864
v_exp_f32 v34, v34
v_mfma_f32_16x16x32_bf16 v[52:55], a[156:159], v[180:183], v[52:55]
buffer_load_dwordx4 v228, s[8:11], s38 offen offset:0 lds
v_exp_f32 v35, v35
v_mfma_f32_16x16x32_bf16 v[60:63], a[144:147], v[184:187], v[144:147]
v_cvt_pk_bf16_f32 v75, v14, v15
v_cvt_pk_bf16_f32 v76, v16, v17
v_exp_f32 v36, v36
v_mfma_f32_16x16x32_bf16 v[60:63], a[148:151], v[188:191], v[60:63]
buffer_load_dwordx4 v229, s[8:11], s38 offen offset:1024 lds
v_exp_f32 v37, v37
v_mfma_f32_16x16x32_bf16 v[60:63], a[152:155], v[192:195], v[60:63]
v_cvt_pk_bf16_f32 v77, v18, v19
v_cvt_pk_bf16_f32 v78, v20, v21
v_exp_f32 v38, v38
v_mfma_f32_16x16x32_bf16 v[60:63], a[156:159], v[196:199], v[60:63]
v_cvt_pk_bf16_f32 v79, v22, v23
v_cvt_pk_bf16_f32 v80, v24, v25
v_exp_f32 v39, v39
v_mfma_f32_16x16x32_bf16 v[68:71], a[144:147], v[200:203], v[148:151]
ds_read_b128 a[144:147], v216 offset:20480
v_cvt_pk_bf16_f32 v81, v26, v27
v_cvt_pk_bf16_f32 v82, v28, v29
v_cvt_pk_bf16_f32 v83, v30, v31
v_mfma_f32_16x16x32_bf16 v[68:71], a[148:151], v[204:207], v[68:71]
ds_read_b128 a[148:151], v217 offset:20480
v_cvt_pk_bf16_f32 v84, v32, v33
v_cvt_pk_bf16_f32 v85, v34, v35
v_cvt_pk_bf16_f32 v86, v36, v37
v_mfma_f32_16x16x32_bf16 v[68:71], a[152:155], v[208:211], v[68:71]
ds_read_b128 a[152:155], v218 offset:20480
v_cvt_pk_bf16_f32 v87, v38, v39
v_mfma_f32_16x16x32_bf16 v[68:71], a[156:159], v[212:215], v[68:71]
ds_read_b128 a[156:159], v219 offset:20480
s_cmp_lg_u32 s41, 0
s_cbranch_scc1 K_RANKED
s_waitcnt vmcnt(6)
v_max3_u32 v255, v104, v105, v106
s_max_u32 s48, s92, s93
v_max3_u32 v255, v255, v107, v108
v_max3_u32 v255, v255, v109, v110
v_max3_u32 v255, v255, v111, v112
v_max3_u32 v255, v255, v113, v114
v_max3_u32 v255, v255, v115, v116
v_max3_u32 v255, v255, v117, v118
v_max3_u32 v255, v255, v119, v120
v_max3_u32 v255, v255, v121, v122
v_max3_u32 v255, v255, v123, v124
v_max3_u32 v255, v255, v125, v126
v_max3_u32 v255, v255, v127, v128
v_max3_u32 v255, v255, v129, v130
v_max3_u32 v255, v255, v131, v132
v_max3_u32 v255, v255, v133, v134
v_max_u32 v255, v255, v135
v_cmp_lt_u32 vcc, s48, v255
s_bcnt1_i32_b64 s48, vcc
s_cmp_lt_u32 s48, 8
s_cbranch_scc1 K_RANK
K_RANKED:
s_memrealtime s[94:95]
s_waitcnt lgkmcnt(0)
s_mov_b32 s40, 0
.p2align 6
K_LOOP:
v_mfma_f32_16x16x32_bf16 v[8:11], a[128:131], v[152:155], v[136:139]
v_exp_f32 v40, v40
v_mfma_f32_16x16x32_bf16 v[8:11], a[132:135], v[156:159], v[8:11]
v_exp_f32 v41, v41
v_mfma_f32_16x16x32_bf16 v[8:11], a[136:139], v[160:163], v[8:11]
buffer_load_dwordx4 v230, s[8:11], s38 offen offset:2048 lds
v_mfma_f32_16x16x32_bf16 v[8:11], a[140:143], v[164:167], v[8:11]
v_exp_f32 v42, v42
v_mfma_f32_16x16x32_bf16 a[0:3], a[160:163], v[72:75], a[0:3]
v_cvt_pk_bf16_f32 v88, v40, v41
v_mfma_f32_16x16x32_bf16 a[32:35], a[160:163], v[76:79], a[32:35]
v_exp_f32 v43, v43
v_mfma_f32_16x16x32_bf16 a[64:67], a[160:163], v[80:83], a[64:67]
v_cvt_pk_bf16_f32 v89, v42, v43
v_mfma_f32_16x16x32_bf16 a[96:99], a[160:163], v[84:87], a[96:99]
v_exp_f32 v44, v44
v_mfma_f32_16x16x32_bf16 v[16:19], a[128:131], v[168:171], v[140:143]
ds_read_b64_tr_b16 a[160:161], v220 offset:40960
ds_read_b64_tr_b16 a[162:163], v220 offset:45056
v_mfma_f32_16x16x32_bf16 v[16:19], a[132:135], v[172:175], v[16:19]
v_exp_f32 v45, v45
v_mfma_f32_16x16x32_bf16 v[16:19], a[136:139], v[176:179], v[16:19]
v_cvt_pk_bf16_f32 v90, v44, v45
v_mfma_f32_16x16x32_bf16 v[16:19], a[140:143], v[180:183], v[16:19]
v_exp_f32 v46, v46
v_mfma_f32_16x16x32_bf16 a[4:7], a[164:167], v[72:75], a[4:7]
v_mfma_f32_16x16x32_bf16 a[36:39], a[164:167], v[76:79], a[36:39]
v_exp_f32 v47, v47
v_mfma_f32_16x16x32_bf16 a[68:71], a[164:167], v[80:83], a[68:71]
buffer_load_dwordx4 v231, s[8:11], s38 offen offset:3072 lds
v_mfma_f32_16x16x32_bf16 a[100:103], a[164:167], v[84:87], a[100:103]
v_exp_f32 v48, v48
v_smfmac_f32_16x16x64_bf16 a[248:251], a[208:211], v[72:79], v235
ds_read_b64_tr_b16 a[164:165], v221 offset:40960
ds_read_b64_tr_b16 a[166:167], v221 offset:45056
v_mfma_f32_16x16x32_bf16 v[24:27], a[128:131], v[184:187], v[144:147]
v_exp_f32 v49, v49
v_mfma_f32_16x16x32_bf16 v[24:27], a[132:135], v[188:191], v[24:27]
v_cvt_pk_bf16_f32 v91, v46, v47
v_cvt_pk_bf16_f32 v92, v48, v49
v_mfma_f32_16x16x32_bf16 v[24:27], a[136:139], v[192:195], v[24:27]
v_exp_f32 v50, v50
v_mfma_f32_16x16x32_bf16 v[24:27], a[140:143], v[196:199], v[24:27]
v_mfma_f32_16x16x32_bf16 a[8:11], a[168:171], v[72:75], a[8:11]
v_exp_f32 v51, v51
v_mfma_f32_16x16x32_bf16 a[40:43], a[168:171], v[76:79], a[40:43]
v_cvt_pk_bf16_f32 v93, v50, v51
v_mfma_f32_16x16x32_bf16 a[72:75], a[168:171], v[80:83], a[72:75]
v_exp_f32 v52, v52
v_mfma_f32_16x16x32_bf16 a[104:107], a[168:171], v[84:87], a[104:107]
ds_read_b64_tr_b16 a[168:169], v222 offset:40960
ds_read_b64_tr_b16 a[170:171], v222 offset:45056
v_mfma_f32_16x16x32_bf16 v[32:35], a[128:131], v[200:203], v[148:151]
s_add_u32 s38, s38, 16384
v_exp_f32 v53, v53
v_mfma_f32_16x16x32_bf16 v[32:35], a[132:135], v[204:207], v[32:35]
s_add_u32 m0, s37, 81920
ds_read_b128 a[128:131], v216 offset:24576
ds_read_b128 a[132:135], v217 offset:24576
v_mfma_f32_16x16x32_bf16 v[32:35], a[136:139], v[208:211], v[32:35]
v_exp_f32 v54, v54
v_mfma_f32_16x16x32_bf16 v[32:35], a[140:143], v[212:215], v[32:35]
buffer_load_dwordx4 v232, s[12:15], s39 offen offset:0 lds
v_mfma_f32_16x16x32_bf16 a[12:15], a[172:175], v[72:75], a[12:15]
v_exp_f32 v55, v55
v_mfma_f32_16x16x32_bf16 a[44:47], a[172:175], v[76:79], a[44:47]
ds_read_b128 a[136:139], v218 offset:24576
ds_read_b128 a[140:143], v219 offset:24576
v_mfma_f32_16x16x32_bf16 a[76:79], a[172:175], v[80:83], a[76:79]
v_exp_f32 v56, v56
v_mfma_f32_16x16x32_bf16 a[108:111], a[172:175], v[84:87], a[108:111]
s_waitcnt lgkmcnt(6)
v_exp_f32 v57, v57
v_mfma_f32_16x16x32_bf16 v[12:15], a[144:147], v[152:155], v[136:139]
ds_read_b64_tr_b16 a[172:173], v223 offset:40960
ds_read_b64_tr_b16 a[174:175], v223 offset:45056
v_mfma_f32_16x16x32_bf16 v[12:15], a[148:151], v[156:159], v[12:15]
v_exp_f32 v58, v58
v_mfma_f32_16x16x32_bf16 v[12:15], a[152:155], v[160:163], v[12:15]
v_cvt_pk_bf16_f32 v94, v52, v53
v_cvt_pk_bf16_f32 v95, v54, v55
v_mfma_f32_16x16x32_bf16 v[12:15], a[156:159], v[164:167], v[12:15]
v_exp_f32 v59, v59
v_mfma_f32_16x16x32_bf16 a[16:19], a[176:179], v[72:75], a[16:19]
v_cvt_pk_bf16_f32 v96, v56, v57
v_cvt_pk_bf16_f32 v97, v58, v59
v_mfma_f32_16x16x32_bf16 a[48:51], a[176:179], v[76:79], a[48:51]
v_exp_f32 v60, v60
v_mfma_f32_16x16x32_bf16 a[80:83], a[176:179], v[80:83], a[80:83]
buffer_load_dwordx4 v233, s[12:15], s39 offen offset:1024 lds
v_mfma_f32_16x16x32_bf16 a[112:115], a[176:179], v[84:87], a[112:115]
v_exp_f32 v61, v61
v_mfma_f32_16x16x32_bf16 v[20:23], a[144:147], v[168:171], v[140:143]
ds_read_b64_tr_b16 a[176:177], v224 offset:40960
ds_read_b64_tr_b16 a[178:179], v224 offset:45056
v_mfma_f32_16x16x32_bf16 v[20:23], a[148:151], v[172:175], v[20:23]
v_exp_f32 v62, v62
v_mfma_f32_16x16x32_bf16 v[20:23], a[152:155], v[176:179], v[20:23]
v_cvt_pk_bf16_f32 v98, v60, v61
v_mfma_f32_16x16x32_bf16 v[20:23], a[156:159], v[180:183], v[20:23]
v_exp_f32 v63, v63
v_mfma_f32_16x16x32_bf16 a[20:23], a[180:183], v[72:75], a[20:23]
v_cvt_pk_bf16_f32 v99, v62, v63
v_mfma_f32_16x16x32_bf16 a[52:55], a[180:183], v[76:79], a[52:55]
v_exp_f32 v64, v64
v_mfma_f32_16x16x32_bf16 a[84:87], a[180:183], v[80:83], a[84:87]
v_mfma_f32_16x16x32_bf16 a[116:119], a[180:183], v[84:87], a[116:119]
v_exp_f32 v65, v65
v_smfmac_f32_16x16x64_bf16 a[252:255], a[208:211], v[80:87], v235
ds_read_b64_tr_b16 a[180:181], v225 offset:40960
ds_read_b64_tr_b16 a[182:183], v225 offset:45056
v_mfma_f32_16x16x32_bf16 v[28:31], a[144:147], v[184:187], v[144:147]
v_exp_f32 v66, v66
v_mfma_f32_16x16x32_bf16 v[28:31], a[148:151], v[188:191], v[28:31]
buffer_load_dwordx4 v232, s[12:15], s39 offen offset:2048 lds
v_mfma_f32_16x16x32_bf16 v[28:31], a[152:155], v[192:195], v[28:31]
v_exp_f32 v67, v67
v_mfma_f32_16x16x32_bf16 v[28:31], a[156:159], v[196:199], v[28:31]
v_cvt_pk_bf16_f32 v100, v64, v65
v_cvt_pk_bf16_f32 v101, v66, v67
v_mfma_f32_16x16x32_bf16 a[24:27], a[184:187], v[72:75], a[24:27]
v_exp_f32 v68, v68
v_mfma_f32_16x16x32_bf16 a[56:59], a[184:187], v[76:79], a[56:59]
v_mfma_f32_16x16x32_bf16 a[88:91], a[184:187], v[80:83], a[88:91]
v_exp_f32 v69, v69
v_mfma_f32_16x16x32_bf16 a[120:123], a[184:187], v[84:87], a[120:123]
ds_read_b64_tr_b16 a[184:185], v226 offset:40960
ds_read_b64_tr_b16 a[186:187], v226 offset:45056
v_mfma_f32_16x16x32_bf16 v[36:39], a[144:147], v[200:203], v[148:151]
v_exp_f32 v70, v70
v_mfma_f32_16x16x32_bf16 v[36:39], a[148:151], v[204:207], v[36:39]
ds_read_b128 a[144:147], v216 offset:28672
ds_read_b128 a[148:151], v217 offset:28672
v_mfma_f32_16x16x32_bf16 v[36:39], a[152:155], v[208:211], v[36:39]
v_exp_f32 v71, v71
v_mfma_f32_16x16x32_bf16 v[36:39], a[156:159], v[212:215], v[36:39]
ds_read_b128 a[152:155], v218 offset:28672
ds_read_b128 a[156:159], v219 offset:28672
v_mfma_f32_16x16x32_bf16 a[28:31], a[188:191], v[72:75], a[28:31]
v_cvt_pk_bf16_f32 v102, v68, v69
v_cvt_pk_bf16_f32 v103, v70, v71
v_mfma_f32_16x16x32_bf16 a[60:63], a[188:191], v[76:79], a[60:63]
v_mfma_f32_16x16x32_bf16 a[92:95], a[188:191], v[80:83], a[92:95]
v_mfma_f32_16x16x32_bf16 a[124:127], a[188:191], v[84:87], a[124:127]
s_waitcnt lgkmcnt(6)
ds_read_b64_tr_b16 a[188:189], v227 offset:40960
ds_read_b64_tr_b16 a[190:191], v227 offset:45056
v_mfma_f32_16x16x32_bf16 v[40:43], a[128:131], v[152:155], v[136:139]
v_exp_f32 v8, v8
v_mfma_f32_16x16x32_bf16 v[40:43], a[132:135], v[156:159], v[40:43]
v_exp_f32 v9, v9
v_mfma_f32_16x16x32_bf16 v[40:43], a[136:139], v[160:163], v[40:43]
buffer_load_dwordx4 v233, s[12:15], s39 offen offset:3072 lds
v_mfma_f32_16x16x32_bf16 v[40:43], a[140:143], v[164:167], v[40:43]
v_exp_f32 v10, v10
v_mfma_f32_16x16x32_bf16 a[0:3], a[160:163], v[88:91], a[0:3]
v_cvt_pk_bf16_f32 v72, v8, v9
v_mfma_f32_16x16x32_bf16 a[32:35], a[160:163], v[92:95], a[32:35]
v_exp_f32 v11, v11
v_mfma_f32_16x16x32_bf16 a[64:67], a[160:163], v[96:99], a[64:67]
v_cvt_pk_bf16_f32 v73, v10, v11
v_mfma_f32_16x16x32_bf16 a[96:99], a[160:163], v[100:103], a[96:99]
v_exp_f32 v12, v12
v_mfma_f32_16x16x32_bf16 v[48:51], a[128:131], v[168:171], v[140:143]
ds_read_b64_tr_b16 a[160:161], v220 offset:49152
ds_read_b64_tr_b16 a[162:163], v220 offset:53248
v_mfma_f32_16x16x32_bf16 v[48:51], a[132:135], v[172:175], v[48:51]
v_exp_f32 v13, v13
v_mfma_f32_16x16x32_bf16 v[48:51], a[136:139], v[176:179], v[48:51]
v_cvt_pk_bf16_f32 v74, v12, v13
v_mfma_f32_16x16x32_bf16 v[48:51], a[140:143], v[180:183], v[48:51]
v_exp_f32 v14, v14
v_mfma_f32_16x16x32_bf16 a[4:7], a[164:167], v[88:91], a[4:7]
v_mfma_f32_16x16x32_bf16 a[36:39], a[164:167], v[92:95], a[36:39]
s_add_u32 s39, s39, 16384
v_exp_f32 v15, v15
v_mfma_f32_16x16x32_bf16 a[68:71], a[164:167], v[96:99], a[68:71]
s_add_u32 m0, s37, 32768
v_cvt_pk_bf16_f32 v75, v14, v15
v_mfma_f32_16x16x32_bf16 a[100:103], a[164:167], v[100:103], a[100:103]
v_exp_f32 v16, v16
v_smfmac_f32_16x16x64_bf16 a[248:251], a[208:211], v[88:95], v235
buffer_load_dwordx4 v228, s[8:11], s38 offen offset:0 lds
v_mfma_f32_16x16x32_bf16 v[56:59], a[128:131], v[184:187], v[144:147]
v_exp_f32 v17, v17
v_mfma_f32_16x16x32_bf16 v[56:59], a[132:135], v[188:191], v[56:59]
ds_read_b64_tr_b16 a[164:165], v221 offset:49152
ds_read_b64_tr_b16 a[166:167], v221 offset:53248
v_mfma_f32_16x16x32_bf16 v[56:59], a[136:139], v[192:195], v[56:59]
v_exp_f32 v18, v18
v_mfma_f32_16x16x32_bf16 v[56:59], a[140:143], v[196:199], v[56:59]
v_cvt_pk_bf16_f32 v76, v16, v17
v_mfma_f32_16x16x32_bf16 a[8:11], a[168:171], v[88:91], a[8:11]
v_exp_f32 v19, v19
v_mfma_f32_16x16x32_bf16 a[40:43], a[168:171], v[92:95], a[40:43]
v_cvt_pk_bf16_f32 v77, v18, v19
v_mfma_f32_16x16x32_bf16 a[72:75], a[168:171], v[96:99], a[72:75]
v_exp_f32 v20, v20
v_mfma_f32_16x16x32_bf16 a[104:107], a[168:171], v[100:103], a[104:107]
ds_read_b64_tr_b16 a[168:169], v222 offset:49152
ds_read_b64_tr_b16 a[170:171], v222 offset:53248
v_mfma_f32_16x16x32_bf16 v[64:67], a[128:131], v[200:203], v[148:151]
v_exp_f32 v21, v21
v_mfma_f32_16x16x32_bf16 v[64:67], a[132:135], v[204:207], v[64:67]
buffer_load_dwordx4 v229, s[8:11], s38 offen offset:1024 lds
v_mfma_f32_16x16x32_bf16 v[64:67], a[136:139], v[208:211], v[64:67]
v_exp_f32 v22, v22
v_mfma_f32_16x16x32_bf16 v[64:67], a[140:143], v[212:215], v[64:67]
ds_read_b128 a[128:131], v216 offset:0
ds_read_b128 a[132:135], v217 offset:0
v_mfma_f32_16x16x32_bf16 a[12:15], a[172:175], v[88:91], a[12:15]
v_exp_f32 v23, v23
v_mfma_f32_16x16x32_bf16 a[44:47], a[172:175], v[92:95], a[44:47]
ds_read_b128 a[136:139], v218 offset:0
ds_read_b128 a[140:143], v219 offset:0
v_mfma_f32_16x16x32_bf16 a[76:79], a[172:175], v[96:99], a[76:79]
v_exp_f32 v24, v24
v_mfma_f32_16x16x32_bf16 a[108:111], a[172:175], v[100:103], a[108:111]
s_waitcnt lgkmcnt(6)
v_exp_f32 v25, v25
v_mfma_f32_16x16x32_bf16 v[44:47], a[144:147], v[152:155], v[136:139]
ds_read_b64_tr_b16 a[172:173], v223 offset:49152
ds_read_b64_tr_b16 a[174:175], v223 offset:53248
v_mfma_f32_16x16x32_bf16 v[44:47], a[148:151], v[156:159], v[44:47]
v_exp_f32 v26, v26
v_mfma_f32_16x16x32_bf16 v[44:47], a[152:155], v[160:163], v[44:47]
v_cvt_pk_bf16_f32 v78, v20, v21
v_cvt_pk_bf16_f32 v79, v22, v23
v_mfma_f32_16x16x32_bf16 v[44:47], a[156:159], v[164:167], v[44:47]
v_exp_f32 v27, v27
v_mfma_f32_16x16x32_bf16 a[16:19], a[176:179], v[88:91], a[16:19]
v_cvt_pk_bf16_f32 v80, v24, v25
v_cvt_pk_bf16_f32 v81, v26, v27
v_mfma_f32_16x16x32_bf16 a[48:51], a[176:179], v[92:95], a[48:51]
v_exp_f32 v28, v28
v_mfma_f32_16x16x32_bf16 a[80:83], a[176:179], v[96:99], a[80:83]
buffer_load_dwordx4 v230, s[8:11], s38 offen offset:2048 lds
v_mfma_f32_16x16x32_bf16 a[112:115], a[176:179], v[100:103], a[112:115]
v_exp_f32 v29, v29
v_mfma_f32_16x16x32_bf16 v[52:55], a[144:147], v[168:171], v[140:143]
ds_read_b64_tr_b16 a[176:177], v224 offset:49152
ds_read_b64_tr_b16 a[178:179], v224 offset:53248
v_mfma_f32_16x16x32_bf16 v[52:55], a[148:151], v[172:175], v[52:55]
v_exp_f32 v30, v30
v_mfma_f32_16x16x32_bf16 v[52:55], a[152:155], v[176:179], v[52:55]
v_cvt_pk_bf16_f32 v82, v28, v29
v_mfma_f32_16x16x32_bf16 v[52:55], a[156:159], v[180:183], v[52:55]
v_exp_f32 v31, v31
v_mfma_f32_16x16x32_bf16 a[20:23], a[180:183], v[88:91], a[20:23]
v_cvt_pk_bf16_f32 v83, v30, v31
v_mfma_f32_16x16x32_bf16 a[52:55], a[180:183], v[92:95], a[52:55]
v_exp_f32 v32, v32
v_mfma_f32_16x16x32_bf16 a[84:87], a[180:183], v[96:99], a[84:87]
v_mfma_f32_16x16x32_bf16 a[116:119], a[180:183], v[100:103], a[116:119]
v_exp_f32 v33, v33
v_smfmac_f32_16x16x64_bf16 a[252:255], a[208:211], v[96:103], v235
ds_read_b64_tr_b16 a[180:181], v225 offset:49152
ds_read_b64_tr_b16 a[182:183], v225 offset:53248
v_mfma_f32_16x16x32_bf16 v[60:63], a[144:147], v[184:187], v[144:147]
v_exp_f32 v34, v34
v_mfma_f32_16x16x32_bf16 v[60:63], a[148:151], v[188:191], v[60:63]
buffer_load_dwordx4 v231, s[8:11], s38 offen offset:3072 lds
v_mfma_f32_16x16x32_bf16 v[60:63], a[152:155], v[192:195], v[60:63]
v_exp_f32 v35, v35
v_mfma_f32_16x16x32_bf16 v[60:63], a[156:159], v[196:199], v[60:63]
v_cvt_pk_bf16_f32 v84, v32, v33
v_cvt_pk_bf16_f32 v85, v34, v35
v_mfma_f32_16x16x32_bf16 a[24:27], a[184:187], v[88:91], a[24:27]
v_exp_f32 v36, v36
v_mfma_f32_16x16x32_bf16 a[56:59], a[184:187], v[92:95], a[56:59]
v_mfma_f32_16x16x32_bf16 a[88:91], a[184:187], v[96:99], a[88:91]
v_exp_f32 v37, v37
v_mfma_f32_16x16x32_bf16 a[120:123], a[184:187], v[100:103], a[120:123]
ds_read_b64_tr_b16 a[184:185], v226 offset:49152
ds_read_b64_tr_b16 a[186:187], v226 offset:53248
v_mfma_f32_16x16x32_bf16 v[68:71], a[144:147], v[200:203], v[148:151]
v_exp_f32 v38, v38
v_mfma_f32_16x16x32_bf16 v[68:71], a[148:151], v[204:207], v[68:71]
ds_read_b128 a[144:147], v216 offset:4096
ds_read_b128 a[148:151], v217 offset:4096
v_mfma_f32_16x16x32_bf16 v[68:71], a[152:155], v[208:211], v[68:71]
v_exp_f32 v39, v39
v_mfma_f32_16x16x32_bf16 v[68:71], a[156:159], v[212:215], v[68:71]
ds_read_b128 a[152:155], v218 offset:4096
ds_read_b128 a[156:159], v219 offset:4096
v_mfma_f32_16x16x32_bf16 a[28:31], a[188:191], v[88:91], a[28:31]
v_cvt_pk_bf16_f32 v86, v36, v37
v_cvt_pk_bf16_f32 v87, v38, v39
v_mfma_f32_16x16x32_bf16 a[60:63], a[188:191], v[92:95], a[60:63]
s_add_u32 s38, s38, 16384
v_mfma_f32_16x16x32_bf16 a[92:95], a[188:191], v[96:99], a[92:95]
v_mfma_f32_16x16x32_bf16 a[124:127], a[188:191], v[100:103], a[124:127]
s_waitcnt lgkmcnt(6)
ds_read_b64_tr_b16 a[188:189], v227 offset:49152
ds_read_b64_tr_b16 a[190:191], v227 offset:53248
v_mfma_f32_16x16x32_bf16 v[8:11], a[128:131], v[152:155], v[136:139]
v_exp_f32 v40, v40
v_mfma_f32_16x16x32_bf16 v[8:11], a[132:135], v[156:159], v[8:11]
v_exp_f32 v41, v41
v_mfma_f32_16x16x32_bf16 v[8:11], a[136:139], v[160:163], v[8:11]
buffer_load_dwordx2 v[252:253], v251, s[76:79], s42 offen sc1
v_mfma_f32_16x16x32_bf16 v[8:11], a[140:143], v[164:167], v[8:11]
v_exp_f32 v42, v42
v_mfma_f32_16x16x32_bf16 a[0:3], a[160:163], v[72:75], a[0:3]
v_cvt_pk_bf16_f32 v88, v40, v41
v_mfma_f32_16x16x32_bf16 a[32:35], a[160:163], v[76:79], a[32:35]
v_exp_f32 v43, v43
v_mfma_f32_16x16x32_bf16 a[64:67], a[160:163], v[80:83], a[64:67]
v_cvt_pk_bf16_f32 v89, v42, v43
v_mfma_f32_16x16x32_bf16 a[96:99], a[160:163], v[84:87], a[96:99]
v_exp_f32 v44, v44
v_mfma_f32_16x16x32_bf16 v[16:19], a[128:131], v[168:171], v[140:143]
ds_read_b64_tr_b16 a[160:161], v220 offset:57344
ds_read_b64_tr_b16 a[162:163], v220 offset:61440
v_mfma_f32_16x16x32_bf16 v[16:19], a[132:135], v[172:175], v[16:19]
v_exp_f32 v45, v45
v_mfma_f32_16x16x32_bf16 v[16:19], a[136:139], v[176:179], v[16:19]
s_add_u32 s42, s42, s43
buffer_load_dword v255, v243, s[28:31], s45 offen
v_mfma_f32_16x16x32_bf16 v[16:19], a[140:143], v[180:183], v[16:19]
v_exp_f32 v46, v46
v_mfma_f32_16x16x32_bf16 a[4:7], a[164:167], v[72:75], a[4:7]
v_cvt_pk_bf16_f32 v90, v44, v45
v_mfma_f32_16x16x32_bf16 a[36:39], a[164:167], v[76:79], a[36:39]
v_exp_f32 v47, v47
v_mfma_f32_16x16x32_bf16 a[68:71], a[164:167], v[80:83], a[68:71]
v_cvt_pk_bf16_f32 v91, v46, v47
v_mfma_f32_16x16x32_bf16 a[100:103], a[164:167], v[84:87], a[100:103]
v_exp_f32 v48, v48
v_smfmac_f32_16x16x64_bf16 a[248:251], a[208:211], v[72:79], v235
ds_read_b64_tr_b16 a[164:165], v221 offset:57344
ds_read_b64_tr_b16 a[166:167], v221 offset:61440
v_mfma_f32_16x16x32_bf16 v[24:27], a[128:131], v[184:187], v[144:147]
v_exp_f32 v49, v49
v_mfma_f32_16x16x32_bf16 v[24:27], a[132:135], v[188:191], v[24:27]
v_cvt_pk_bf16_f32 v92, v48, v49
v_mfma_f32_16x16x32_bf16 v[24:27], a[136:139], v[192:195], v[24:27]
s_add_u32 s45, s45, 589824
v_exp_f32 v50, v50
v_mfma_f32_16x16x32_bf16 v[24:27], a[140:143], v[196:199], v[24:27]
global_load_dword v255, v242, s[72:73]
v_mfma_f32_16x16x32_bf16 a[8:11], a[168:171], v[72:75], a[8:11]
v_exp_f32 v51, v51
v_mfma_f32_16x16x32_bf16 a[40:43], a[168:171], v[76:79], a[40:43]
v_cvt_pk_bf16_f32 v93, v50, v51
v_mfma_f32_16x16x32_bf16 a[72:75], a[168:171], v[80:83], a[72:75]
v_exp_f32 v52, v52
v_mfma_f32_16x16x32_bf16 a[104:107], a[168:171], v[84:87], a[104:107]
ds_read_b64_tr_b16 a[168:169], v222 offset:57344
ds_read_b64_tr_b16 a[170:171], v222 offset:61440
v_mfma_f32_16x16x32_bf16 v[32:35], a[128:131], v[200:203], v[148:151]
v_exp_f32 v53, v53
v_mfma_f32_16x16x32_bf16 v[32:35], a[132:135], v[204:207], v[32:35]
ds_read_b128 a[128:131], v216 offset:8192
ds_read_b128 a[132:135], v217 offset:8192
v_mfma_f32_16x16x32_bf16 v[32:35], a[136:139], v[208:211], v[32:35]
v_exp_f32 v54, v54
v_mfma_f32_16x16x32_bf16 v[32:35], a[140:143], v[212:215], v[32:35]
buffer_load_dword v255, v0, s[24:27], s44 offen
v_mfma_f32_16x16x32_bf16 a[12:15], a[172:175], v[72:75], a[12:15]
v_exp_f32 v55, v55
v_mfma_f32_16x16x32_bf16 a[44:47], a[172:175], v[76:79], a[44:47]
ds_read_b128 a[136:139], v218 offset:8192
ds_read_b128 a[140:143], v219 offset:8192
v_mfma_f32_16x16x32_bf16 a[76:79], a[172:175], v[80:83], a[76:79]
v_exp_f32 v56, v56
v_mfma_f32_16x16x32_bf16 a[108:111], a[172:175], v[84:87], a[108:111]
s_waitcnt lgkmcnt(6)
v_exp_f32 v57, v57
v_mfma_f32_16x16x32_bf16 v[12:15], a[144:147], v[152:155], v[136:139]
ds_read_b64_tr_b16 a[172:173], v223 offset:57344
ds_read_b64_tr_b16 a[174:175], v223 offset:61440
v_mfma_f32_16x16x32_bf16 v[12:15], a[148:151], v[156:159], v[12:15]
v_exp_f32 v58, v58
v_mfma_f32_16x16x32_bf16 v[12:15], a[152:155], v[160:163], v[12:15]
v_cvt_pk_bf16_f32 v94, v52, v53
v_cvt_pk_bf16_f32 v95, v54, v55
v_mfma_f32_16x16x32_bf16 v[12:15], a[156:159], v[164:167], v[12:15]
v_exp_f32 v59, v59
v_mfma_f32_16x16x32_bf16 a[16:19], a[176:179], v[72:75], a[16:19]
s_add_u32 s44, s44, 4096
v_cvt_pk_bf16_f32 v96, v56, v57
v_cvt_pk_bf16_f32 v97, v58, v59
v_mfma_f32_16x16x32_bf16 a[48:51], a[176:179], v[76:79], a[48:51]
v_exp_f32 v60, v60
v_mfma_f32_16x16x32_bf16 a[80:83], a[176:179], v[80:83], a[80:83]
v_mfma_f32_16x16x32_bf16 a[112:115], a[176:179], v[84:87], a[112:115]
v_exp_f32 v61, v61
v_mfma_f32_16x16x32_bf16 v[20:23], a[144:147], v[168:171], v[140:143]
ds_read_b64_tr_b16 a[176:177], v224 offset:57344
ds_read_b64_tr_b16 a[178:179], v224 offset:61440
v_mfma_f32_16x16x32_bf16 v[20:23], a[148:151], v[172:175], v[20:23]
v_exp_f32 v62, v62
v_mfma_f32_16x16x32_bf16 v[20:23], a[152:155], v[176:179], v[20:23]
v_cvt_pk_bf16_f32 v98, v60, v61
v_mfma_f32_16x16x32_bf16 v[20:23], a[156:159], v[180:183], v[20:23]
v_exp_f32 v63, v63
v_mfma_f32_16x16x32_bf16 a[20:23], a[180:183], v[72:75], a[20:23]
v_cvt_pk_bf16_f32 v99, v62, v63
v_mfma_f32_16x16x32_bf16 a[52:55], a[180:183], v[76:79], a[52:55]
v_exp_f32 v64, v64
v_mfma_f32_16x16x32_bf16 a[84:87], a[180:183], v[80:83], a[84:87]
v_mfma_f32_16x16x32_bf16 a[116:119], a[180:183], v[84:87], a[116:119]
v_exp_f32 v65, v65
v_smfmac_f32_16x16x64_bf16 a[252:255], a[208:211], v[80:87], v235
ds_read_b64_tr_b16 a[180:181], v225 offset:57344
ds_read_b64_tr_b16 a[182:183], v225 offset:61440
v_mfma_f32_16x16x32_bf16 v[28:31], a[144:147], v[184:187], v[144:147]
v_exp_f32 v66, v66
v_mfma_f32_16x16x32_bf16 v[28:31], a[148:151], v[188:191], v[28:31]
v_cvt_pk_bf16_f32 v100, v64, v65
v_mfma_f32_16x16x32_bf16 v[28:31], a[152:155], v[192:195], v[28:31]
v_exp_f32 v67, v67
v_mfma_f32_16x16x32_bf16 v[28:31], a[156:159], v[196:199], v[28:31]
v_cvt_pk_bf16_f32 v101, v66, v67
v_mfma_f32_16x16x32_bf16 a[24:27], a[184:187], v[72:75], a[24:27]
v_exp_f32 v68, v68
v_mfma_f32_16x16x32_bf16 a[56:59], a[184:187], v[76:79], a[56:59]
v_mfma_f32_16x16x32_bf16 a[88:91], a[184:187], v[80:83], a[88:91]
v_exp_f32 v69, v69
v_mfma_f32_16x16x32_bf16 a[120:123], a[184:187], v[84:87], a[120:123]
ds_read_b64_tr_b16 a[184:185], v226 offset:57344
ds_read_b64_tr_b16 a[186:187], v226 offset:61440
v_mfma_f32_16x16x32_bf16 v[36:39], a[144:147], v[200:203], v[148:151]
v_exp_f32 v70, v70
v_mfma_f32_16x16x32_bf16 v[36:39], a[148:151], v[204:207], v[36:39]
ds_read_b128 a[144:147], v216 offset:12288
ds_read_b128 a[148:151], v217 offset:12288
v_mfma_f32_16x16x32_bf16 v[36:39], a[152:155], v[208:211], v[36:39]
v_exp_f32 v71, v71
v_mfma_f32_16x16x32_bf16 v[36:39], a[156:159], v[212:215], v[36:39]
ds_read_b128 a[152:155], v218 offset:12288
ds_read_b128 a[156:159], v219 offset:12288
v_mfma_f32_16x16x32_bf16 a[28:31], a[188:191], v[72:75], a[28:31]
s_add_u32 s40, s40, 1
v_cvt_pk_bf16_f32 v102, v68, v69
v_cvt_pk_bf16_f32 v103, v70, v71
v_mfma_f32_16x16x32_bf16 a[60:63], a[188:191], v[76:79], a[60:63]
s_bitcmp1_b32 s74, s40
v_mfma_f32_16x16x32_bf16 a[92:95], a[188:191], v[80:83], a[92:95]
v_mfma_f32_16x16x32_bf16 a[124:127], a[188:191], v[84:87], a[124:127]
s_waitcnt lgkmcnt(6)
ds_read_b64_tr_b16 a[188:189], v227 offset:57344
ds_read_b64_tr_b16 a[190:191], v227 offset:61440
s_cbranch_scc1 K_EXIT
K_B4:
v_mfma_f32_16x16x32_bf16 v[40:43], a[128:131], v[152:155], v[136:139]
v_exp_f32 v8, v8
v_mfma_f32_16x16x32_bf16 v[40:43], a[132:135], v[156:159], v[40:43]
v_exp_f32 v9, v9
v_mfma_f32_16x16x32_bf16 v[40:43], a[136:139], v[160:163], v[40:43]
v_cvt_pk_bf16_f32 v72, v8, v9
v_mfma_f32_16x16x32_bf16 v[40:43], a[140:143], v[164:167], v[40:43]
v_exp_f32 v10, v10
v_mfma_f32_16x16x32_bf16 a[0:3], a[160:163], v[88:91], a[0:3]
v_mfma_f32_16x16x32_bf16 a[32:35], a[160:163], v[92:95], a[32:35]
v_exp_f32 v11, v11
s_waitcnt vmcnt(4) lgkmcnt(0)
s_barrier
v_mfma_f32_16x16x32_bf16 a[64:67], a[160:163], v[96:99], a[64:67]
v_cvt_pk_bf16_f32 v73, v10, v11
v_mfma_f32_16x16x32_bf16 a[96:99], a[160:163], v[100:103], a[96:99]
s_add_u32 m0, s37, 98304
v_exp_f32 v12, v12
v_mfma_f32_16x16x32_bf16 v[48:51], a[128:131], v[168:171], v[140:143]
buffer_load_dwordx4 v232, s[12:15], s39 offen offset:0 lds
v_mfma_f32_16x16x32_bf16 v[48:51], a[132:135], v[172:175], v[48:51]
v_exp_f32 v13, v13
v_mfma_f32_16x16x32_bf16 v[48:51], a[136:139], v[176:179], v[48:51]
ds_read_b64_tr_b16 a[160:161], v220 offset:0
ds_read_b64_tr_b16 a[162:163], v220 offset:4096
v_mfma_f32_16x16x32_bf16 v[48:51], a[140:143], v[180:183], v[48:51]
v_exp_f32 v14, v14
v_mfma_f32_16x16x32_bf16 a[4:7], a[164:167], v[88:91], a[4:7]
v_cvt_pk_bf16_f32 v74, v12, v13
v_mfma_f32_16x16x32_bf16 a[36:39], a[164:167], v[92:95], a[36:39]
v_exp_f32 v15, v15
v_mfma_f32_16x16x32_bf16 a[68:71], a[164:167], v[96:99], a[68:71]
v_cvt_pk_bf16_f32 v75, v14, v15
v_mfma_f32_16x16x32_bf16 a[100:103], a[164:167], v[100:103], a[100:103]
v_exp_f32 v16, v16
v_smfmac_f32_16x16x64_bf16 a[248:251], a[208:211], v[88:95], v235
buffer_load_dwordx4 v233, s[12:15], s39 offen offset:1024 lds
v_mfma_f32_16x16x32_bf16 v[56:59], a[128:131], v[184:187], v[144:147]
v_exp_f32 v17, v17
v_mfma_f32_16x16x32_bf16 v[56:59], a[132:135], v[188:191], v[56:59]
ds_read_b64_tr_b16 a[164:165], v221 offset:0
ds_read_b64_tr_b16 a[166:167], v221 offset:4096
v_mfma_f32_16x16x32_bf16 v[56:59], a[136:139], v[192:195], v[56:59]
v_exp_f32 v18, v18
v_mfma_f32_16x16x32_bf16 v[56:59], a[140:143], v[196:199], v[56:59]
v_cvt_pk_bf16_f32 v76, v16, v17
v_mfma_f32_16x16x32_bf16 a[8:11], a[168:171], v[88:91], a[8:11]
v_exp_f32 v19, v19
v_mfma_f32_16x16x32_bf16 a[40:43], a[168:171], v[92:95], a[40:43]
v_cvt_pk_bf16_f32 v77, v18, v19
v_mfma_f32_16x16x32_bf16 a[72:75], a[168:171], v[96:99], a[72:75]
v_exp_f32 v20, v20
v_mfma_f32_16x16x32_bf16 a[104:107], a[168:171], v[100:103], a[104:107]
ds_read_b64_tr_b16 a[168:169], v222 offset:0
ds_read_b64_tr_b16 a[170:171], v222 offset:4096
v_mfma_f32_16x16x32_bf16 v[64:67], a[128:131], v[200:203], v[148:151]
v_exp_f32 v21, v21
v_mfma_f32_16x16x32_bf16 v[64:67], a[132:135], v[204:207], v[64:67]
buffer_load_dwordx4 v232, s[12:15], s39 offen offset:2048 lds
v_mfma_f32_16x16x32_bf16 v[64:67], a[136:139], v[208:211], v[64:67]
v_exp_f32 v22, v22
v_mfma_f32_16x16x32_bf16 v[64:67], a[140:143], v[212:215], v[64:67]
ds_read_b128 a[128:131], v216 offset:49152
ds_read_b128 a[132:135], v217 offset:49152
v_mfma_f32_16x16x32_bf16 a[12:15], a[172:175], v[88:91], a[12:15]
v_exp_f32 v23, v23
v_mfma_f32_16x16x32_bf16 a[44:47], a[172:175], v[92:95], a[44:47]
ds_read_b128 a[136:139], v218 offset:49152
ds_read_b128 a[140:143], v219 offset:49152
v_mfma_f32_16x16x32_bf16 a[76:79], a[172:175], v[96:99], a[76:79]
v_exp_f32 v24, v24
v_mfma_f32_16x16x32_bf16 a[108:111], a[172:175], v[100:103], a[108:111]
v_exp_f32 v25, v25
v_mfma_f32_16x16x32_bf16 v[44:47], a[144:147], v[152:155], v[136:139]
ds_read_b64_tr_b16 a[172:173], v223 offset:0
ds_read_b64_tr_b16 a[174:175], v223 offset:4096
v_mfma_f32_16x16x32_bf16 v[44:47], a[148:151], v[156:159], v[44:47]
v_exp_f32 v26, v26
v_mfma_f32_16x16x32_bf16 v[44:47], a[152:155], v[160:163], v[44:47]
buffer_load_dwordx4 v233, s[12:15], s39 offen offset:3072 lds
v_mfma_f32_16x16x32_bf16 v[44:47], a[156:159], v[164:167], v[44:47]
v_exp_f32 v27, v27
v_mfma_f32_16x16x32_bf16 a[16:19], a[176:179], v[88:91], a[16:19]
v_cvt_pk_bf16_f32 v78, v20, v21
v_cvt_pk_bf16_f32 v79, v22, v23
v_mfma_f32_16x16x32_bf16 a[48:51], a[176:179], v[92:95], a[48:51]
v_exp_f32 v28, v28
v_mfma_f32_16x16x32_bf16 a[80:83], a[176:179], v[96:99], a[80:83]
v_cvt_pk_bf16_f32 v80, v24, v25
v_cvt_pk_bf16_f32 v81, v26, v27
v_mfma_f32_16x16x32_bf16 a[112:115], a[176:179], v[100:103], a[112:115]
v_exp_f32 v29, v29
v_mfma_f32_16x16x32_bf16 v[52:55], a[144:147], v[168:171], v[140:143]
ds_read_b64_tr_b16 a[176:177], v224 offset:0
ds_read_b64_tr_b16 a[178:179], v224 offset:4096
v_mfma_f32_16x16x32_bf16 v[52:55], a[148:151], v[172:175], v[52:55]
v_exp_f32 v30, v30
v_mfma_f32_16x16x32_bf16 v[52:55], a[152:155], v[176:179], v[52:55]
v_cvt_pk_bf16_f32 v82, v28, v29
v_mfma_f32_16x16x32_bf16 v[52:55], a[156:159], v[180:183], v[52:55]
s_add_u32 s39, s39, 16384
v_exp_f32 v31, v31
v_mfma_f32_16x16x32_bf16 a[20:23], a[180:183], v[88:91], a[20:23]
s_add_u32 m0, s37, 16384
v_cvt_pk_bf16_f32 v83, v30, v31
v_mfma_f32_16x16x32_bf16 a[52:55], a[180:183], v[92:95], a[52:55]
v_exp_f32 v32, v32
v_mfma_f32_16x16x32_bf16 a[84:87], a[180:183], v[96:99], a[84:87]
buffer_load_dwordx4 v228, s[8:11], s38 offen offset:0 lds
v_mfma_f32_16x16x32_bf16 a[116:119], a[180:183], v[100:103], a[116:119]
v_exp_f32 v33, v33
v_smfmac_f32_16x16x64_bf16 a[252:255], a[208:211], v[96:103], v235
ds_read_b64_tr_b16 a[180:181], v225 offset:0
ds_read_b64_tr_b16 a[182:183], v225 offset:4096
v_mfma_f32_16x16x32_bf16 v[60:63], a[144:147], v[184:187], v[144:147]
v_exp_f32 v34, v34
v_mfma_f32_16x16x32_bf16 v[60:63], a[148:151], v[188:191], v[60:63]
v_cvt_pk_bf16_f32 v84, v32, v33
v_mfma_f32_16x16x32_bf16 v[60:63], a[152:155], v[192:195], v[60:63]
v_exp_f32 v35, v35
v_mfma_f32_16x16x32_bf16 v[60:63], a[156:159], v[196:199], v[60:63]
buffer_load_dwordx4 v229, s[8:11], s38 offen offset:1024 lds
v_mfma_f32_16x16x32_bf16 a[24:27], a[184:187], v[88:91], a[24:27]
v_exp_f32 v36, v36
v_mfma_f32_16x16x32_bf16 a[56:59], a[184:187], v[92:95], a[56:59]
v_cvt_pk_bf16_f32 v85, v34, v35
v_mfma_f32_16x16x32_bf16 a[88:91], a[184:187], v[96:99], a[88:91]
v_exp_f32 v37, v37
v_mfma_f32_16x16x32_bf16 a[120:123], a[184:187], v[100:103], a[120:123]
ds_read_b64_tr_b16 a[184:185], v226 offset:0
ds_read_b64_tr_b16 a[186:187], v226 offset:4096
v_mfma_f32_16x16x32_bf16 v[68:71], a[144:147], v[200:203], v[148:151]
v_exp_f32 v38, v38
v_mfma_f32_16x16x32_bf16 v[68:71], a[148:151], v[204:207], v[68:71]
ds_read_b128 a[144:147], v216 offset:53248
ds_read_b128 a[148:151], v217 offset:53248
v_mfma_f32_16x16x32_bf16 v[68:71], a[152:155], v[208:211], v[68:71]
v_exp_f32 v39, v39
v_mfma_f32_16x16x32_bf16 v[68:71], a[156:159], v[212:215], v[68:71]
ds_read_b128 a[152:155], v218 offset:53248
ds_read_b128 a[156:159], v219 offset:53248
v_mfma_f32_16x16x32_bf16 a[28:31], a[188:191], v[88:91], a[28:31]
v_cvt_pk_bf16_f32 v86, v36, v37
v_cvt_pk_bf16_f32 v87, v38, v39
v_mfma_f32_16x16x32_bf16 a[60:63], a[188:191], v[92:95], a[60:63]
v_mfma_f32_16x16x32_bf16 a[92:95], a[188:191], v[96:99], a[92:95]
v_mfma_f32_16x16x32_bf16 a[124:127], a[188:191], v[100:103], a[124:127]
s_waitcnt lgkmcnt(6)
ds_read_b64_tr_b16 a[188:189], v227 offset:0
ds_read_b64_tr_b16 a[190:191], v227 offset:4096
K_B5:
v_mfma_f32_16x16x32_bf16 v[8:11], a[128:131], v[152:155], v[136:139]
v_exp_f32 v40, v40
v_mfma_f32_16x16x32_bf16 v[8:11], a[132:135], v[156:159], v[8:11]
v_exp_f32 v41, v41
v_mfma_f32_16x16x32_bf16 v[8:11], a[136:139], v[160:163], v[8:11]
buffer_load_dwordx4 v230, s[8:11], s38 offen offset:2048 lds
v_mfma_f32_16x16x32_bf16 v[8:11], a[140:143], v[164:167], v[8:11]
v_exp_f32 v42, v42
v_mfma_f32_16x16x32_bf16 a[0:3], a[160:163], v[72:75], a[0:3]
v_cvt_pk_bf16_f32 v88, v40, v41
v_mfma_f32_16x16x32_bf16 a[32:35], a[160:163], v[76:79], a[32:35]
v_exp_f32 v43, v43
v_mfma_f32_16x16x32_bf16 a[64:67], a[160:163], v[80:83], a[64:67]
v_cvt_pk_bf16_f32 v89, v42, v43
v_mfma_f32_16x16x32_bf16 a[96:99], a[160:163], v[84:87], a[96:99]
v_exp_f32 v44, v44
v_mfma_f32_16x16x32_bf16 v[16:19], a[128:131], v[168:171], v[140:143]
ds_read_b64_tr_b16 a[160:161], v220 offset:8192
ds_read_b64_tr_b16 a[162:163], v220 offset:12288
v_mfma_f32_16x16x32_bf16 v[16:19], a[132:135], v[172:175], v[16:19]
v_exp_f32 v45, v45
v_mfma_f32_16x16x32_bf16 v[16:19], a[136:139], v[176:179], v[16:19]
v_cvt_pk_bf16_f32 v90, v44, v45
v_mfma_f32_16x16x32_bf16 v[16:19], a[140:143], v[180:183], v[16:19]
v_exp_f32 v46, v46
v_mfma_f32_16x16x32_bf16 a[4:7], a[164:167], v[72:75], a[4:7]
v_mfma_f32_16x16x32_bf16 a[36:39], a[164:167], v[76:79], a[36:39]
v_exp_f32 v47, v47
v_mfma_f32_16x16x32_bf16 a[68:71], a[164:167], v[80:83], a[68:71]
buffer_load_dwordx4 v231, s[8:11], s38 offen offset:3072 lds
v_mfma_f32_16x16x32_bf16 a[100:103], a[164:167], v[84:87], a[100:103]
v_exp_f32 v48, v48
v_smfmac_f32_16x16x64_bf16 a[248:251], a[208:211], v[72:79], v235
ds_read_b64_tr_b16 a[164:165], v221 offset:8192
ds_read_b64_tr_b16 a[166:167], v221 offset:12288
v_mfma_f32_16x16x32_bf16 v[24:27], a[128:131], v[184:187], v[144:147]
v_exp_f32 v49, v49
v_mfma_f32_16x16x32_bf16 v[24:27], a[132:135], v[188:191], v[24:27]
v_cvt_pk_bf16_f32 v91, v46, v47
v_cvt_pk_bf16_f32 v92, v48, v49
v_mfma_f32_16x16x32_bf16 v[24:27], a[136:139], v[192:195], v[24:27]
v_exp_f32 v50, v50
v_mfma_f32_16x16x32_bf16 v[24:27], a[140:143], v[196:199], v[24:27]
v_mfma_f32_16x16x32_bf16 a[8:11], a[168:171], v[72:75], a[8:11]
v_exp_f32 v51, v51
v_mfma_f32_16x16x32_bf16 a[40:43], a[168:171], v[76:79], a[40:43]
v_cvt_pk_bf16_f32 v93, v50, v51
v_mfma_f32_16x16x32_bf16 a[72:75], a[168:171], v[80:83], a[72:75]
v_exp_f32 v52, v52
v_mfma_f32_16x16x32_bf16 a[104:107], a[168:171], v[84:87], a[104:107]
ds_read_b64_tr_b16 a[168:169], v222 offset:8192
ds_read_b64_tr_b16 a[170:171], v222 offset:12288
v_mfma_f32_16x16x32_bf16 v[32:35], a[128:131], v[200:203], v[148:151]
s_add_u32 s38, s38, 16384
v_exp_f32 v53, v53
v_mfma_f32_16x16x32_bf16 v[32:35], a[132:135], v[204:207], v[32:35]
s_add_u32 m0, s37, 114688
ds_read_b128 a[128:131], v216 offset:57344
ds_read_b128 a[132:135], v217 offset:57344
v_mfma_f32_16x16x32_bf16 v[32:35], a[136:139], v[208:211], v[32:35]
v_exp_f32 v54, v54
v_mfma_f32_16x16x32_bf16 v[32:35], a[140:143], v[212:215], v[32:35]
buffer_load_dwordx4 v232, s[12:15], s39 offen offset:0 lds
v_mfma_f32_16x16x32_bf16 a[12:15], a[172:175], v[72:75], a[12:15]
v_exp_f32 v55, v55
v_mfma_f32_16x16x32_bf16 a[44:47], a[172:175], v[76:79], a[44:47]
ds_read_b128 a[136:139], v218 offset:57344
ds_read_b128 a[140:143], v219 offset:57344
v_mfma_f32_16x16x32_bf16 a[76:79], a[172:175], v[80:83], a[76:79]
v_exp_f32 v56, v56
v_mfma_f32_16x16x32_bf16 a[108:111], a[172:175], v[84:87], a[108:111]
s_waitcnt lgkmcnt(6)
v_exp_f32 v57, v57
v_mfma_f32_16x16x32_bf16 v[12:15], a[144:147], v[152:155], v[136:139]
ds_read_b64_tr_b16 a[172:173], v223 offset:8192
ds_read_b64_tr_b16 a[174:175], v223 offset:12288
v_mfma_f32_16x16x32_bf16 v[12:15], a[148:151], v[156:159], v[12:15]
v_exp_f32 v58, v58
v_mfma_f32_16x16x32_bf16 v[12:15], a[152:155], v[160:163], v[12:15]
v_cvt_pk_bf16_f32 v94, v52, v53
v_cvt_pk_bf16_f32 v95, v54, v55
v_mfma_f32_16x16x32_bf16 v[12:15], a[156:159], v[164:167], v[12:15]
v_exp_f32 v59, v59
v_mfma_f32_16x16x32_bf16 a[16:19], a[176:179], v[72:75], a[16:19]
v_cvt_pk_bf16_f32 v96, v56, v57
v_cvt_pk_bf16_f32 v97, v58, v59
v_mfma_f32_16x16x32_bf16 a[48:51], a[176:179], v[76:79], a[48:51]
v_exp_f32 v60, v60
v_mfma_f32_16x16x32_bf16 a[80:83], a[176:179], v[80:83], a[80:83]
buffer_load_dwordx4 v233, s[12:15], s39 offen offset:1024 lds
v_mfma_f32_16x16x32_bf16 a[112:115], a[176:179], v[84:87], a[112:115]
v_exp_f32 v61, v61
v_mfma_f32_16x16x32_bf16 v[20:23], a[144:147], v[168:171], v[140:143]
ds_read_b64_tr_b16 a[176:177], v224 offset:8192
ds_read_b64_tr_b16 a[178:179], v224 offset:12288
v_mfma_f32_16x16x32_bf16 v[20:23], a[148:151], v[172:175], v[20:23]
v_exp_f32 v62, v62
v_mfma_f32_16x16x32_bf16 v[20:23], a[152:155], v[176:179], v[20:23]
v_cvt_pk_bf16_f32 v98, v60, v61
v_mfma_f32_16x16x32_bf16 v[20:23], a[156:159], v[180:183], v[20:23]
v_exp_f32 v63, v63
v_mfma_f32_16x16x32_bf16 a[20:23], a[180:183], v[72:75], a[20:23]
v_cvt_pk_bf16_f32 v99, v62, v63
v_mfma_f32_16x16x32_bf16 a[52:55], a[180:183], v[76:79], a[52:55]
v_exp_f32 v64, v64
v_mfma_f32_16x16x32_bf16 a[84:87], a[180:183], v[80:83], a[84:87]
v_mfma_f32_16x16x32_bf16 a[116:119], a[180:183], v[84:87], a[116:119]
v_exp_f32 v65, v65
v_smfmac_f32_16x16x64_bf16 a[252:255], a[208:211], v[80:87], v235
ds_read_b64_tr_b16 a[180:181], v225 offset:8192
ds_read_b64_tr_b16 a[182:183], v225 offset:12288
v_mfma_f32_16x16x32_bf16 v[28:31], a[144:147], v[184:187], v[144:147]
v_exp_f32 v66, v66
v_mfma_f32_16x16x32_bf16 v[28:31], a[148:151], v[188:191], v[28:31]
buffer_load_dwordx4 v232, s[12:15], s39 offen offset:2048 lds
v_mfma_f32_16x16x32_bf16 v[28:31], a[152:155], v[192:195], v[28:31]
v_exp_f32 v67, v67
v_mfma_f32_16x16x32_bf16 v[28:31], a[156:159], v[196:199], v[28:31]
v_cvt_pk_bf16_f32 v100, v64, v65
v_cvt_pk_bf16_f32 v101, v66, v67
v_mfma_f32_16x16x32_bf16 a[24:27], a[184:187], v[72:75], a[24:27]
v_exp_f32 v68, v68
v_mfma_f32_16x16x32_bf16 a[56:59], a[184:187], v[76:79], a[56:59]
v_mfma_f32_16x16x32_bf16 a[88:91], a[184:187], v[80:83], a[88:91]
v_exp_f32 v69, v69
v_mfma_f32_16x16x32_bf16 a[120:123], a[184:187], v[84:87], a[120:123]
ds_read_b64_tr_b16 a[184:185], v226 offset:8192
ds_read_b64_tr_b16 a[186:187], v226 offset:12288
v_mfma_f32_16x16x32_bf16 v[36:39], a[144:147], v[200:203], v[148:151]
v_exp_f32 v70, v70
v_mfma_f32_16x16x32_bf16 v[36:39], a[148:151], v[204:207], v[36:39]
ds_read_b128 a[144:147], v216 offset:61440
ds_read_b128 a[148:151], v217 offset:61440
v_mfma_f32_16x16x32_bf16 v[36:39], a[152:155], v[208:211], v[36:39]
v_exp_f32 v71, v71
v_mfma_f32_16x16x32_bf16 v[36:39], a[156:159], v[212:215], v[36:39]
ds_read_b128 a[152:155], v218 offset:61440
ds_read_b128 a[156:159], v219 offset:61440
v_mfma_f32_16x16x32_bf16 a[28:31], a[188:191], v[72:75], a[28:31]
v_cvt_pk_bf16_f32 v102, v68, v69
v_cvt_pk_bf16_f32 v103, v70, v71
v_mfma_f32_16x16x32_bf16 a[60:63], a[188:191], v[76:79], a[60:63]
v_mfma_f32_16x16x32_bf16 a[92:95], a[188:191], v[80:83], a[92:95]
v_mfma_f32_16x16x32_bf16 a[124:127], a[188:191], v[84:87], a[124:127]
s_waitcnt lgkmcnt(6)
ds_read_b64_tr_b16 a[188:189], v227 offset:8192
ds_read_b64_tr_b16 a[190:191], v227 offset:12288
v_mfma_f32_16x16x32_bf16 v[40:43], a[128:131], v[152:155], v[136:139]
v_exp_f32 v8, v8
v_mfma_f32_16x16x32_bf16 v[40:43], a[132:135], v[156:159], v[40:43]
v_exp_f32 v9, v9
v_mfma_f32_16x16x32_bf16 v[40:43], a[136:139], v[160:163], v[40:43]
buffer_load_dwordx4 v233, s[12:15], s39 offen offset:3072 lds
v_mfma_f32_16x16x32_bf16 v[40:43], a[140:143], v[164:167], v[40:43]
v_exp_f32 v10, v10
v_mfma_f32_16x16x32_bf16 a[0:3], a[160:163], v[88:91], a[0:3]
v_cvt_pk_bf16_f32 v72, v8, v9
v_mfma_f32_16x16x32_bf16 a[32:35], a[160:163], v[92:95], a[32:35]
v_exp_f32 v11, v11
v_mfma_f32_16x16x32_bf16 a[64:67], a[160:163], v[96:99], a[64:67]
v_cvt_pk_bf16_f32 v73, v10, v11
v_mfma_f32_16x16x32_bf16 a[96:99], a[160:163], v[100:103], a[96:99]
v_exp_f32 v12, v12
v_mfma_f32_16x16x32_bf16 v[48:51], a[128:131], v[168:171], v[140:143]
ds_read_b64_tr_b16 a[160:161], v220 offset:16384
ds_read_b64_tr_b16 a[162:163], v220 offset:20480
v_mfma_f32_16x16x32_bf16 v[48:51], a[132:135], v[172:175], v[48:51]
v_exp_f32 v13, v13
v_mfma_f32_16x16x32_bf16 v[48:51], a[136:139], v[176:179], v[48:51]
v_cvt_pk_bf16_f32 v74, v12, v13
v_mfma_f32_16x16x32_bf16 v[48:51], a[140:143], v[180:183], v[48:51]
v_exp_f32 v14, v14
v_mfma_f32_16x16x32_bf16 a[4:7], a[164:167], v[88:91], a[4:7]
v_mfma_f32_16x16x32_bf16 a[36:39], a[164:167], v[92:95], a[36:39]
s_add_u32 s39, s39, 16384
v_exp_f32 v15, v15
v_mfma_f32_16x16x32_bf16 a[68:71], a[164:167], v[96:99], a[68:71]
s_add_u32 m0, s37, 0
v_cvt_pk_bf16_f32 v75, v14, v15
v_mfma_f32_16x16x32_bf16 a[100:103], a[164:167], v[100:103], a[100:103]
v_exp_f32 v16, v16
v_smfmac_f32_16x16x64_bf16 a[248:251], a[208:211], v[88:95], v235
buffer_load_dwordx4 v228, s[8:11], s38 offen offset:0 lds
v_mfma_f32_16x16x32_bf16 v[56:59], a[128:131], v[184:187], v[144:147]
v_exp_f32 v17, v17
v_mfma_f32_16x16x32_bf16 v[56:59], a[132:135], v[188:191], v[56:59]
ds_read_b64_tr_b16 a[164:165], v221 offset:16384
ds_read_b64_tr_b16 a[166:167], v221 offset:20480
v_mfma_f32_16x16x32_bf16 v[56:59], a[136:139], v[192:195], v[56:59]
v_exp_f32 v18, v18
v_mfma_f32_16x16x32_bf16 v[56:59], a[140:143], v[196:199], v[56:59]
v_cvt_pk_bf16_f32 v76, v16, v17
v_mfma_f32_16x16x32_bf16 a[8:11], a[168:171], v[88:91], a[8:11]
v_exp_f32 v19, v19
v_mfma_f32_16x16x32_bf16 a[40:43], a[168:171], v[92:95], a[40:43]
v_cvt_pk_bf16_f32 v77, v18, v19
v_mfma_f32_16x16x32_bf16 a[72:75], a[168:171], v[96:99], a[72:75]
v_exp_f32 v20, v20
v_mfma_f32_16x16x32_bf16 a[104:107], a[168:171], v[100:103], a[104:107]
ds_read_b64_tr_b16 a[168:169], v222 offset:16384
ds_read_b64_tr_b16 a[170:171], v222 offset:20480
v_mfma_f32_16x16x32_bf16 v[64:67], a[128:131], v[200:203], v[148:151]
v_exp_f32 v21, v21
v_mfma_f32_16x16x32_bf16 v[64:67], a[132:135], v[204:207], v[64:67]
buffer_load_dwordx4 v229, s[8:11], s38 offen offset:1024 lds
v_mfma_f32_16x16x32_bf16 v[64:67], a[136:139], v[208:211], v[64:67]
v_exp_f32 v22, v22
v_mfma_f32_16x16x32_bf16 v[64:67], a[140:143], v[212:215], v[64:67]
ds_read_b128 a[128:131], v216 offset:32768
ds_read_b128 a[132:135], v217 offset:32768
v_mfma_f32_16x16x32_bf16 a[12:15], a[172:175], v[88:91], a[12:15]
v_exp_f32 v23, v23
v_mfma_f32_16x16x32_bf16 a[44:47], a[172:175], v[92:95], a[44:47]
ds_read_b128 a[136:139], v218 offset:32768
ds_read_b128 a[140:143], v219 offset:32768
v_mfma_f32_16x16x32_bf16 a[76:79], a[172:175], v[96:99], a[76:79]
v_exp_f32 v24, v24
v_mfma_f32_16x16x32_bf16 a[108:111], a[172:175], v[100:103], a[108:111]
s_waitcnt lgkmcnt(6)
v_exp_f32 v25, v25
v_mfma_f32_16x16x32_bf16 v[44:47], a[144:147], v[152:155], v[136:139]
ds_read_b64_tr_b16 a[172:173], v223 offset:16384
ds_read_b64_tr_b16 a[174:175], v223 offset:20480
v_mfma_f32_16x16x32_bf16 v[44:47], a[148:151], v[156:159], v[44:47]
v_exp_f32 v26, v26
v_mfma_f32_16x16x32_bf16 v[44:47], a[152:155], v[160:163], v[44:47]
v_cvt_pk_bf16_f32 v78, v20, v21
v_cvt_pk_bf16_f32 v79, v22, v23
v_mfma_f32_16x16x32_bf16 v[44:47], a[156:159], v[164:167], v[44:47]
v_exp_f32 v27, v27
v_mfma_f32_16x16x32_bf16 a[16:19], a[176:179], v[88:91], a[16:19]
v_cvt_pk_bf16_f32 v80, v24, v25
v_cvt_pk_bf16_f32 v81, v26, v27
v_mfma_f32_16x16x32_bf16 a[48:51], a[176:179], v[92:95], a[48:51]
v_exp_f32 v28, v28
v_mfma_f32_16x16x32_bf16 a[80:83], a[176:179], v[96:99], a[80:83]
buffer_load_dwordx4 v230, s[8:11], s38 offen offset:2048 lds
v_mfma_f32_16x16x32_bf16 a[112:115], a[176:179], v[100:103], a[112:115]
v_exp_f32 v29, v29
v_mfma_f32_16x16x32_bf16 v[52:55], a[144:147], v[168:171], v[140:143]
ds_read_b64_tr_b16 a[176:177], v224 offset:16384
ds_read_b64_tr_b16 a[178:179], v224 offset:20480
v_mfma_f32_16x16x32_bf16 v[52:55], a[148:151], v[172:175], v[52:55]
v_exp_f32 v30, v30
v_mfma_f32_16x16x32_bf16 v[52:55], a[152:155], v[176:179], v[52:55]
v_cvt_pk_bf16_f32 v82, v28, v29
v_mfma_f32_16x16x32_bf16 v[52:55], a[156:159], v[180:183], v[52:55]
v_exp_f32 v31, v31
v_mfma_f32_16x16x32_bf16 a[20:23], a[180:183], v[88:91], a[20:23]
v_cvt_pk_bf16_f32 v83, v30, v31
v_mfma_f32_16x16x32_bf16 a[52:55], a[180:183], v[92:95], a[52:55]
v_exp_f32 v32, v32
v_mfma_f32_16x16x32_bf16 a[84:87], a[180:183], v[96:99], a[84:87]
v_mfma_f32_16x16x32_bf16 a[116:119], a[180:183], v[100:103], a[116:119]
v_exp_f32 v33, v33
v_smfmac_f32_16x16x64_bf16 a[252:255], a[208:211], v[96:103], v235
ds_read_b64_tr_b16 a[180:181], v225 offset:16384
ds_read_b64_tr_b16 a[182:183], v225 offset:20480
v_mfma_f32_16x16x32_bf16 v[60:63], a[144:147], v[184:187], v[144:147]
v_exp_f32 v34, v34
v_mfma_f32_16x16x32_bf16 v[60:63], a[148:151], v[188:191], v[60:63]
buffer_load_dwordx4 v231, s[8:11], s38 offen offset:3072 lds
v_mfma_f32_16x16x32_bf16 v[60:63], a[152:155], v[192:195], v[60:63]
v_exp_f32 v35, v35
v_mfma_f32_16x16x32_bf16 v[60:63], a[156:159], v[196:199], v[60:63]
v_cvt_pk_bf16_f32 v84, v32, v33
v_cvt_pk_bf16_f32 v85, v34, v35
v_mfma_f32_16x16x32_bf16 a[24:27], a[184:187], v[88:91], a[24:27]
v_exp_f32 v36, v36
v_mfma_f32_16x16x32_bf16 a[56:59], a[184:187], v[92:95], a[56:59]
v_mfma_f32_16x16x32_bf16 a[88:91], a[184:187], v[96:99], a[88:91]
v_exp_f32 v37, v37
v_mfma_f32_16x16x32_bf16 a[120:123], a[184:187], v[100:103], a[120:123]
ds_read_b64_tr_b16 a[184:185], v226 offset:16384
ds_read_b64_tr_b16 a[186:187], v226 offset:20480
v_mfma_f32_16x16x32_bf16 v[68:71], a[144:147], v[200:203], v[148:151]
v_exp_f32 v38, v38
v_mfma_f32_16x16x32_bf16 v[68:71], a[148:151], v[204:207], v[68:71]
ds_read_b128 a[144:147], v216 offset:36864
ds_read_b128 a[148:151], v217 offset:36864
v_mfma_f32_16x16x32_bf16 v[68:71], a[152:155], v[208:211], v[68:71]
v_exp_f32 v39, v39
v_mfma_f32_16x16x32_bf16 v[68:71], a[156:159], v[212:215], v[68:71]
ds_read_b128 a[152:155], v218 offset:36864
ds_read_b128 a[156:159], v219 offset:36864
v_mfma_f32_16x16x32_bf16 a[28:31], a[188:191], v[88:91], a[28:31]
v_cvt_pk_bf16_f32 v86, v36, v37
v_cvt_pk_bf16_f32 v87, v38, v39
v_mfma_f32_16x16x32_bf16 a[60:63], a[188:191], v[92:95], a[60:63]
s_add_u32 s38, s38, 16384
v_mfma_f32_16x16x32_bf16 a[92:95], a[188:191], v[96:99], a[92:95]
v_mfma_f32_16x16x32_bf16 a[124:127], a[188:191], v[100:103], a[124:127]
s_waitcnt lgkmcnt(6)
ds_read_b64_tr_b16 a[188:189], v227 offset:16384
ds_read_b64_tr_b16 a[190:191], v227 offset:20480
v_mfma_f32_16x16x32_bf16 v[8:11], a[128:131], v[152:155], v[136:139]
v_exp_f32 v40, v40
v_mfma_f32_16x16x32_bf16 v[8:11], a[132:135], v[156:159], v[8:11]
v_exp_f32 v41, v41
v_mfma_f32_16x16x32_bf16 v[8:11], a[136:139], v[160:163], v[8:11]
buffer_load_dwordx2 v[252:253], v251, s[76:79], s42 offen sc1
v_mfma_f32_16x16x32_bf16 v[8:11], a[140:143], v[164:167], v[8:11]
v_exp_f32 v42, v42
v_mfma_f32_16x16x32_bf16 a[0:3], a[160:163], v[72:75], a[0:3]
v_cvt_pk_bf16_f32 v88, v40, v41
v_mfma_f32_16x16x32_bf16 a[32:35], a[160:163], v[76:79], a[32:35]
v_exp_f32 v43, v43
v_mfma_f32_16x16x32_bf16 a[64:67], a[160:163], v[80:83], a[64:67]
v_cvt_pk_bf16_f32 v89, v42, v43
v_mfma_f32_16x16x32_bf16 a[96:99], a[160:163], v[84:87], a[96:99]
v_exp_f32 v44, v44
v_mfma_f32_16x16x32_bf16 v[16:19], a[128:131], v[168:171], v[140:143]
ds_read_b64_tr_b16 a[160:161], v220 offset:24576
ds_read_b64_tr_b16 a[162:163], v220 offset:28672
v_mfma_f32_16x16x32_bf16 v[16:19], a[132:135], v[172:175], v[16:19]
v_exp_f32 v45, v45
v_mfma_f32_16x16x32_bf16 v[16:19], a[136:139], v[176:179], v[16:19]
s_add_u32 s42, s42, s43
buffer_load_dword v255, v243, s[28:31], s45 offen
v_mfma_f32_16x16x32_bf16 v[16:19], a[140:143], v[180:183], v[16:19]
v_exp_f32 v46, v46
v_mfma_f32_16x16x32_bf16 a[4:7], a[164:167], v[72:75], a[4:7]
v_cvt_pk_bf16_f32 v90, v44, v45
v_mfma_f32_16x16x32_bf16 a[36:39], a[164:167], v[76:79], a[36:39]
v_exp_f32 v47, v47
v_mfma_f32_16x16x32_bf16 a[68:71], a[164:167], v[80:83], a[68:71]
v_cvt_pk_bf16_f32 v91, v46, v47
v_mfma_f32_16x16x32_bf16 a[100:103], a[164:167], v[84:87], a[100:103]
v_exp_f32 v48, v48
v_smfmac_f32_16x16x64_bf16 a[248:251], a[208:211], v[72:79], v235
ds_read_b64_tr_b16 a[164:165], v221 offset:24576
ds_read_b64_tr_b16 a[166:167], v221 offset:28672
v_mfma_f32_16x16x32_bf16 v[24:27], a[128:131], v[184:187], v[144:147]
v_exp_f32 v49, v49
v_mfma_f32_16x16x32_bf16 v[24:27], a[132:135], v[188:191], v[24:27]
v_cvt_pk_bf16_f32 v92, v48, v49
v_mfma_f32_16x16x32_bf16 v[24:27], a[136:139], v[192:195], v[24:27]
s_add_u32 s45, s45, 589824
v_exp_f32 v50, v50
v_mfma_f32_16x16x32_bf16 v[24:27], a[140:143], v[196:199], v[24:27]
global_load_dword v255, v242, s[72:73]
v_mfma_f32_16x16x32_bf16 a[8:11], a[168:171], v[72:75], a[8:11]
v_exp_f32 v51, v51
v_mfma_f32_16x16x32_bf16 a[40:43], a[168:171], v[76:79], a[40:43]
v_cvt_pk_bf16_f32 v93, v50, v51
v_mfma_f32_16x16x32_bf16 a[72:75], a[168:171], v[80:83], a[72:75]
v_exp_f32 v52, v52
v_mfma_f32_16x16x32_bf16 a[104:107], a[168:171], v[84:87], a[104:107]
ds_read_b64_tr_b16 a[168:169], v222 offset:24576
ds_read_b64_tr_b16 a[170:171], v222 offset:28672
v_mfma_f32_16x16x32_bf16 v[32:35], a[128:131], v[200:203], v[148:151]
v_exp_f32 v53, v53
v_mfma_f32_16x16x32_bf16 v[32:35], a[132:135], v[204:207], v[32:35]
ds_read_b128 a[128:131], v216 offset:40960
ds_read_b128 a[132:135], v217 offset:40960
v_mfma_f32_16x16x32_bf16 v[32:35], a[136:139], v[208:211], v[32:35]
v_exp_f32 v54, v54
v_mfma_f32_16x16x32_bf16 v[32:35], a[140:143], v[212:215], v[32:35]
buffer_load_dword v255, v0, s[24:27], s44 offen
v_mfma_f32_16x16x32_bf16 a[12:15], a[172:175], v[72:75], a[12:15]
v_exp_f32 v55, v55
v_mfma_f32_16x16x32_bf16 a[44:47], a[172:175], v[76:79], a[44:47]
ds_read_b128 a[136:139], v218 offset:40960
ds_read_b128 a[140:143], v219 offset:40960
v_mfma_f32_16x16x32_bf16 a[76:79], a[172:175], v[80:83], a[76:79]
v_exp_f32 v56, v56
v_mfma_f32_16x16x32_bf16 a[108:111], a[172:175], v[84:87], a[108:111]
s_waitcnt lgkmcnt(6)
v_exp_f32 v57, v57
v_mfma_f32_16x16x32_bf16 v[12:15], a[144:147], v[152:155], v[136:139]
ds_read_b64_tr_b16 a[172:173], v223 offset:24576
ds_read_b64_tr_b16 a[174:175], v223 offset:28672
v_mfma_f32_16x16x32_bf16 v[12:15], a[148:151], v[156:159], v[12:15]
v_exp_f32 v58, v58
v_mfma_f32_16x16x32_bf16 v[12:15], a[152:155], v[160:163], v[12:15]
v_cvt_pk_bf16_f32 v94, v52, v53
v_cvt_pk_bf16_f32 v95, v54, v55
v_mfma_f32_16x16x32_bf16 v[12:15], a[156:159], v[164:167], v[12:15]
v_exp_f32 v59, v59
v_mfma_f32_16x16x32_bf16 a[16:19], a[176:179], v[72:75], a[16:19]
s_add_u32 s44, s44, 4096
v_cvt_pk_bf16_f32 v96, v56, v57
v_cvt_pk_bf16_f32 v97, v58, v59
v_mfma_f32_16x16x32_bf16 a[48:51], a[176:179], v[76:79], a[48:51]
v_exp_f32 v60, v60
v_mfma_f32_16x16x32_bf16 a[80:83], a[176:179], v[80:83], a[80:83]
v_mfma_f32_16x16x32_bf16 a[112:115], a[176:179], v[84:87], a[112:115]
v_exp_f32 v61, v61
v_mfma_f32_16x16x32_bf16 v[20:23], a[144:147], v[168:171], v[140:143]
ds_read_b64_tr_b16 a[176:177], v224 offset:24576
ds_read_b64_tr_b16 a[178:179], v224 offset:28672
v_mfma_f32_16x16x32_bf16 v[20:23], a[148:151], v[172:175], v[20:23]
v_exp_f32 v62, v62
v_mfma_f32_16x16x32_bf16 v[20:23], a[152:155], v[176:179], v[20:23]
v_cvt_pk_bf16_f32 v98, v60, v61
v_mfma_f32_16x16x32_bf16 v[20:23], a[156:159], v[180:183], v[20:23]
v_exp_f32 v63, v63
v_mfma_f32_16x16x32_bf16 a[20:23], a[180:183], v[72:75], a[20:23]
v_cvt_pk_bf16_f32 v99, v62, v63
v_mfma_f32_16x16x32_bf16 a[52:55], a[180:183], v[76:79], a[52:55]
v_exp_f32 v64, v64
v_mfma_f32_16x16x32_bf16 a[84:87], a[180:183], v[80:83], a[84:87]
v_mfma_f32_16x16x32_bf16 a[116:119], a[180:183], v[84:87], a[116:119]
v_exp_f32 v65, v65
v_smfmac_f32_16x16x64_bf16 a[252:255], a[208:211], v[80:87], v235
ds_read_b64_tr_b16 a[180:181], v225 offset:24576
ds_read_b64_tr_b16 a[182:183], v225 offset:28672
v_mfma_f32_16x16x32_bf16 v[28:31], a[144:147], v[184:187], v[144:147]
v_exp_f32 v66, v66
v_mfma_f32_16x16x32_bf16 v[28:31], a[148:151], v[188:191], v[28:31]
v_cvt_pk_bf16_f32 v100, v64, v65
v_mfma_f32_16x16x32_bf16 v[28:31], a[152:155], v[192:195], v[28:31]
v_exp_f32 v67, v67
v_mfma_f32_16x16x32_bf16 v[28:31], a[156:159], v[196:199], v[28:31]
v_cvt_pk_bf16_f32 v101, v66, v67
v_mfma_f32_16x16x32_bf16 a[24:27], a[184:187], v[72:75], a[24:27]
v_exp_f32 v68, v68
v_mfma_f32_16x16x32_bf16 a[56:59], a[184:187], v[76:79], a[56:59]
v_mfma_f32_16x16x32_bf16 a[88:91], a[184:187], v[80:83], a[88:91]
v_exp_f32 v69, v69
v_mfma_f32_16x16x32_bf16 a[120:123], a[184:187], v[84:87], a[120:123]
ds_read_b64_tr_b16 a[184:185], v226 offset:24576
ds_read_b64_tr_b16 a[186:187], v226 offset:28672
v_mfma_f32_16x16x32_bf16 v[36:39], a[144:147], v[200:203], v[148:151]
v_exp_f32 v70, v70
v_mfma_f32_16x16x32_bf16 v[36:39], a[148:151], v[204:207], v[36:39]
ds_read_b128 a[144:147], v216 offset:45056
ds_read_b128 a[148:151], v217 offset:45056
v_mfma_f32_16x16x32_bf16 v[36:39], a[152:155], v[208:211], v[36:39]
v_exp_f32 v71, v71
v_mfma_f32_16x16x32_bf16 v[36:39], a[156:159], v[212:215], v[36:39]
ds_read_b128 a[152:155], v218 offset:45056
ds_read_b128 a[156:159], v219 offset:45056
v_mfma_f32_16x16x32_bf16 a[28:31], a[188:191], v[72:75], a[28:31]
v_cvt_pk_bf16_f32 v102, v68, v69
v_cvt_pk_bf16_f32 v103, v70, v71
v_mfma_f32_16x16x32_bf16 a[60:63], a[188:191], v[76:79], a[60:63]
v_mfma_f32_16x16x32_bf16 a[92:95], a[188:191], v[80:83], a[92:95]
v_mfma_f32_16x16x32_bf16 a[124:127], a[188:191], v[84:87], a[124:127]
s_waitcnt lgkmcnt(6)
ds_read_b64_tr_b16 a[188:189], v227 offset:24576
ds_read_b64_tr_b16 a[190:191], v227 offset:28672
v_mfma_f32_16x16x32_bf16 v[40:43], a[128:131], v[152:155], v[136:139]
v_exp_f32 v8, v8
v_mfma_f32_16x16x32_bf16 v[40:43], a[132:135], v[156:159], v[40:43]
v_exp_f32 v9, v9
v_mfma_f32_16x16x32_bf16 v[40:43], a[136:139], v[160:163], v[40:43]
v_cvt_pk_bf16_f32 v72, v8, v9
v_mfma_f32_16x16x32_bf16 v[40:43], a[140:143], v[164:167], v[40:43]
v_exp_f32 v10, v10
v_mfma_f32_16x16x32_bf16 a[0:3], a[160:163], v[88:91], a[0:3]
v_mfma_f32_16x16x32_bf16 a[32:35], a[160:163], v[92:95], a[32:35]
v_exp_f32 v11, v11
s_waitcnt vmcnt(4) lgkmcnt(0)
s_barrier
v_mfma_f32_16x16x32_bf16 a[64:67], a[160:163], v[96:99], a[64:67]
v_cvt_pk_bf16_f32 v73, v10, v11
v_mfma_f32_16x16x32_bf16 a[96:99], a[160:163], v[100:103], a[96:99]
s_add_u32 m0, s37, 65536
v_exp_f32 v12, v12
v_mfma_f32_16x16x32_bf16 v[48:51], a[128:131], v[168:171], v[140:143]
buffer_load_dwordx4 v232, s[12:15], s39 offen offset:0 lds
v_mfma_f32_16x16x32_bf16 v[48:51], a[132:135], v[172:175], v[48:51]
v_exp_f32 v13, v13
v_mfma_f32_16x16x32_bf16 v[48:51], a[136:139], v[176:179], v[48:51]
ds_read_b64_tr_b16 a[160:161], v220 offset:32768
ds_read_b64_tr_b16 a[162:163], v220 offset:36864
v_mfma_f32_16x16x32_bf16 v[48:51], a[140:143], v[180:183], v[48:51]
v_exp_f32 v14, v14
v_mfma_f32_16x16x32_bf16 a[4:7], a[164:167], v[88:91], a[4:7]
v_cvt_pk_bf16_f32 v74, v12, v13
v_mfma_f32_16x16x32_bf16 a[36:39], a[164:167], v[92:95], a[36:39]
v_exp_f32 v15, v15
v_mfma_f32_16x16x32_bf16 a[68:71], a[164:167], v[96:99], a[68:71]
v_cvt_pk_bf16_f32 v75, v14, v15
v_mfma_f32_16x16x32_bf16 a[100:103], a[164:167], v[100:103], a[100:103]
v_exp_f32 v16, v16
v_smfmac_f32_16x16x64_bf16 a[248:251], a[208:211], v[88:95], v235
buffer_load_dwordx4 v233, s[12:15], s39 offen offset:1024 lds
v_mfma_f32_16x16x32_bf16 v[56:59], a[128:131], v[184:187], v[144:147]
v_exp_f32 v17, v17
v_mfma_f32_16x16x32_bf16 v[56:59], a[132:135], v[188:191], v[56:59]
ds_read_b64_tr_b16 a[164:165], v221 offset:32768
ds_read_b64_tr_b16 a[166:167], v221 offset:36864
v_mfma_f32_16x16x32_bf16 v[56:59], a[136:139], v[192:195], v[56:59]
v_exp_f32 v18, v18
v_mfma_f32_16x16x32_bf16 v[56:59], a[140:143], v[196:199], v[56:59]
v_cvt_pk_bf16_f32 v76, v16, v17
v_mfma_f32_16x16x32_bf16 a[8:11], a[168:171], v[88:91], a[8:11]
v_exp_f32 v19, v19
v_mfma_f32_16x16x32_bf16 a[40:43], a[168:171], v[92:95], a[40:43]
v_cvt_pk_bf16_f32 v77, v18, v19
v_mfma_f32_16x16x32_bf16 a[72:75], a[168:171], v[96:99], a[72:75]
v_exp_f32 v20, v20
v_mfma_f32_16x16x32_bf16 a[104:107], a[168:171], v[100:103], a[104:107]
ds_read_b64_tr_b16 a[168:169], v222 offset:32768
ds_read_b64_tr_b16 a[170:171], v222 offset:36864
v_mfma_f32_16x16x32_bf16 v[64:67], a[128:131], v[200:203], v[148:151]
v_exp_f32 v21, v21
v_mfma_f32_16x16x32_bf16 v[64:67], a[132:135], v[204:207], v[64:67]
buffer_load_dwordx4 v232, s[12:15], s39 offen offset:2048 lds
v_mfma_f32_16x16x32_bf16 v[64:67], a[136:139], v[208:211], v[64:67]
v_exp_f32 v22, v22
v_mfma_f32_16x16x32_bf16 v[64:67], a[140:143], v[212:215], v[64:67]
ds_read_b128 a[128:131], v216 offset:16384
ds_read_b128 a[132:135], v217 offset:16384
v_mfma_f32_16x16x32_bf16 a[12:15], a[172:175], v[88:91], a[12:15]
v_exp_f32 v23, v23
v_mfma_f32_16x16x32_bf16 a[44:47], a[172:175], v[92:95], a[44:47]
ds_read_b128 a[136:139], v218 offset:16384
ds_read_b128 a[140:143], v219 offset:16384
v_mfma_f32_16x16x32_bf16 a[76:79], a[172:175], v[96:99], a[76:79]
v_exp_f32 v24, v24
v_mfma_f32_16x16x32_bf16 a[108:111], a[172:175], v[100:103], a[108:111]
v_exp_f32 v25, v25
v_mfma_f32_16x16x32_bf16 v[44:47], a[144:147], v[152:155], v[136:139]
ds_read_b64_tr_b16 a[172:173], v223 offset:32768
ds_read_b64_tr_b16 a[174:175], v223 offset:36864
v_mfma_f32_16x16x32_bf16 v[44:47], a[148:151], v[156:159], v[44:47]
v_exp_f32 v26, v26
v_mfma_f32_16x16x32_bf16 v[44:47], a[152:155], v[160:163], v[44:47]
buffer_load_dwordx4 v233, s[12:15], s39 offen offset:3072 lds
v_mfma_f32_16x16x32_bf16 v[44:47], a[156:159], v[164:167], v[44:47]
v_exp_f32 v27, v27
v_mfma_f32_16x16x32_bf16 a[16:19], a[176:179], v[88:91], a[16:19]
v_cvt_pk_bf16_f32 v78, v20, v21
v_cvt_pk_bf16_f32 v79, v22, v23
v_mfma_f32_16x16x32_bf16 a[48:51], a[176:179], v[92:95], a[48:51]
v_exp_f32 v28, v28
v_mfma_f32_16x16x32_bf16 a[80:83], a[176:179], v[96:99], a[80:83]
v_cvt_pk_bf16_f32 v80, v24, v25
v_cvt_pk_bf16_f32 v81, v26, v27
v_mfma_f32_16x16x32_bf16 a[112:115], a[176:179], v[100:103], a[112:115]
v_exp_f32 v29, v29
v_mfma_f32_16x16x32_bf16 v[52:55], a[144:147], v[168:171], v[140:143]
ds_read_b64_tr_b16 a[176:177], v224 offset:32768
ds_read_b64_tr_b16 a[178:179], v224 offset:36864
v_mfma_f32_16x16x32_bf16 v[52:55], a[148:151], v[172:175], v[52:55]
v_exp_f32 v30, v30
v_mfma_f32_16x16x32_bf16 v[52:55], a[152:155], v[176:179], v[52:55]
v_cvt_pk_bf16_f32 v82, v28, v29
v_mfma_f32_16x16x32_bf16 v[52:55], a[156:159], v[180:183], v[52:55]
s_add_u32 s39, s39, 16384
v_exp_f32 v31, v31
v_mfma_f32_16x16x32_bf16 a[20:23], a[180:183], v[88:91], a[20:23]
s_add_u32 m0, s37, 49152
v_cvt_pk_bf16_f32 v83, v30, v31
v_mfma_f32_16x16x32_bf16 a[52:55], a[180:183], v[92:95], a[52:55]
v_exp_f32 v32, v32
v_mfma_f32_16x16x32_bf16 a[84:87], a[180:183], v[96:99], a[84:87]
buffer_load_dwordx4 v228, s[8:11], s38 offen offset:0 lds
v_mfma_f32_16x16x32_bf16 a[116:119], a[180:183], v[100:103], a[116:119]
v_exp_f32 v33, v33
v_smfmac_f32_16x16x64_bf16 a[252:255], a[208:211], v[96:103], v235
ds_read_b64_tr_b16 a[180:181], v225 offset:32768
ds_read_b64_tr_b16 a[182:183], v225 offset:36864
v_mfma_f32_16x16x32_bf16 v[60:63], a[144:147], v[184:187], v[144:147]
v_exp_f32 v34, v34
v_mfma_f32_16x16x32_bf16 v[60:63], a[148:151], v[188:191], v[60:63]
v_cvt_pk_bf16_f32 v84, v32, v33
v_mfma_f32_16x16x32_bf16 v[60:63], a[152:155], v[192:195], v[60:63]
v_exp_f32 v35, v35
v_mfma_f32_16x16x32_bf16 v[60:63], a[156:159], v[196:199], v[60:63]
buffer_load_dwordx4 v229, s[8:11], s38 offen offset:1024 lds
v_mfma_f32_16x16x32_bf16 a[24:27], a[184:187], v[88:91], a[24:27]
v_exp_f32 v36, v36
v_mfma_f32_16x16x32_bf16 a[56:59], a[184:187], v[92:95], a[56:59]
v_cvt_pk_bf16_f32 v85, v34, v35
v_mfma_f32_16x16x32_bf16 a[88:91], a[184:187], v[96:99], a[88:91]
v_exp_f32 v37, v37
v_mfma_f32_16x16x32_bf16 a[120:123], a[184:187], v[100:103], a[120:123]
ds_read_b64_tr_b16 a[184:185], v226 offset:32768
ds_read_b64_tr_b16 a[186:187], v226 offset:36864
v_mfma_f32_16x16x32_bf16 v[68:71], a[144:147], v[200:203], v[148:151]
v_exp_f32 v38, v38
v_mfma_f32_16x16x32_bf16 v[68:71], a[148:151], v[204:207], v[68:71]
ds_read_b128 a[144:147], v216 offset:20480
ds_read_b128 a[148:151], v217 offset:20480
v_mfma_f32_16x16x32_bf16 v[68:71], a[152:155], v[208:211], v[68:71]
v_exp_f32 v39, v39
v_mfma_f32_16x16x32_bf16 v[68:71], a[156:159], v[212:215], v[68:71]
ds_read_b128 a[152:155], v218 offset:20480
ds_read_b128 a[156:159], v219 offset:20480
v_mfma_f32_16x16x32_bf16 a[28:31], a[188:191], v[88:91], a[28:31]
v_cvt_pk_bf16_f32 v86, v36, v37
v_cvt_pk_bf16_f32 v87, v38, v39
v_mfma_f32_16x16x32_bf16 a[60:63], a[188:191], v[92:95], a[60:63]
v_mfma_f32_16x16x32_bf16 a[92:95], a[188:191], v[96:99], a[92:95]
v_mfma_f32_16x16x32_bf16 a[124:127], a[188:191], v[100:103], a[124:127]
s_waitcnt lgkmcnt(6)
ds_read_b64_tr_b16 a[188:189], v227 offset:32768
ds_read_b64_tr_b16 a[190:191], v227 offset:36864
s_branch K_LOOP
K_EXIT:
s_cmp_lg_u32 s40, 8
s_cbranch_scc1 K_HOOK
s_cmp_lg_u32 s52, 0
s_cbranch_scc1 K_YR0
K_LAST:
v_mfma_f32_16x16x32_bf16 v[40:43], a[128:131], v[152:155], v[136:139]
s_add_u32 s46, s36, 1
v_exp_f32 v8, v8
v_mfma_f32_16x16x32_bf16 v[40:43], a[132:135], v[156:159], v[40:43]
s_and_b32 s46, s46, 3
v_exp_f32 v9, v9
v_mfma_f32_16x16x32_bf16 v[40:43], a[136:139], v[160:163], v[40:43]
s_mul_i32 s42, s46, 294912
v_cvt_pk_bf16_f32 v72, v8, v9
v_mfma_f32_16x16x32_bf16 v[40:43], a[140:143], v[164:167], v[40:43]
s_add_u32 s42, s42, s84
v_exp_f32 v10, v10
v_mfma_f32_16x16x32_bf16 a[0:3], a[160:163], v[88:91], a[0:3]
s_add_u32 s46, s36, 2
v_mfma_f32_16x16x32_bf16 a[32:35], a[160:163], v[92:95], a[32:35]
s_and_b32 s46, s46, 3
v_exp_f32 v11, v11
s_waitcnt vmcnt(4) lgkmcnt(0)
s_barrier
v_mfma_f32_16x16x32_bf16 a[64:67], a[160:163], v[96:99], a[64:67]
s_mul_i32 s43, s46, 294912
v_cvt_pk_bf16_f32 v73, v10, v11
v_mfma_f32_16x16x32_bf16 a[96:99], a[160:163], v[100:103], a[96:99]
s_add_u32 m0, s3, 98304
v_exp_f32 v12, v12
v_mfma_f32_16x16x32_bf16 v[48:51], a[128:131], v[168:171], v[140:143]
s_add_u32 s48, s51, 0
buffer_load_dwordx4 v236, s[16:19], s48 offen lds
v_mfma_f32_16x16x32_bf16 v[48:51], a[132:135], v[172:175], v[48:51]
s_add_u32 s43, s43, s84
v_exp_f32 v13, v13
v_mfma_f32_16x16x32_bf16 v[48:51], a[136:139], v[176:179], v[48:51]
s_add_u32 s46, s36, 3
ds_read_b64_tr_b16 a[160:161], v220 offset:0
ds_read_b64_tr_b16 a[162:163], v220 offset:4096
v_mfma_f32_16x16x32_bf16 v[48:51], a[140:143], v[180:183], v[48:51]
s_and_b32 s46, s46, 3
v_exp_f32 v14, v14
v_mfma_f32_16x16x32_bf16 a[4:7], a[164:167], v[88:91], a[4:7]
s_add_u32 m0, s3, 102400
v_cvt_pk_bf16_f32 v74, v12, v13
v_mfma_f32_16x16x32_bf16 a[36:39], a[164:167], v[92:95], a[36:39]
s_add_u32 s48, s51, 18432
v_exp_f32 v15, v15
v_mfma_f32_16x16x32_bf16 a[68:71], a[164:167], v[96:99], a[68:71]
s_mul_i32 s44, s46, 294912
buffer_load_dwordx4 v236, s[16:19], s48 offen lds
v_mfma_f32_16x16x32_bf16 a[100:103], a[164:167], v[100:103], a[100:103]
s_add_u32 s44, s44, s84
v_exp_f32 v16, v16
v_smfmac_f32_16x16x64_bf16 a[248:251], a[208:211], v[88:95], v235
s_cmp_eq_u32 s32, s36
s_cselect_b32 s83, s52, 0
ds_read_b64_tr_b16 a[164:165], v221 offset:0
ds_read_b64_tr_b16 a[166:167], v221 offset:4096
v_mfma_f32_16x16x32_bf16 v[56:59], a[128:131], v[184:187], v[144:147]
v_exp_f32 v17, v17
v_mfma_f32_16x16x32_bf16 v[56:59], a[132:135], v[188:191], v[56:59]
s_add_u32 m0, s3, 106496
v_cvt_pk_bf16_f32 v75, v14, v15
v_cvt_pk_bf16_f32 v76, v16, v17
v_mfma_f32_16x16x32_bf16 v[56:59], a[136:139], v[192:195], v[56:59]
s_add_u32 s48, s51, 36864
v_exp_f32 v18, v18
v_mfma_f32_16x16x32_bf16 v[56:59], a[140:143], v[196:199], v[56:59]
buffer_load_dwordx4 v236, s[16:19], s48 offen lds
v_mfma_f32_16x16x32_bf16 a[8:11], a[168:171], v[88:91], a[8:11]
v_exp_f32 v19, v19
v_mfma_f32_16x16x32_bf16 a[40:43], a[168:171], v[92:95], a[40:43]
v_cvt_pk_bf16_f32 v77, v18, v19
v_mfma_f32_16x16x32_bf16 a[72:75], a[168:171], v[96:99], a[72:75]
s_add_u32 m0, s3, 110592
v_exp_f32 v20, v20
v_mfma_f32_16x16x32_bf16 a[104:107], a[168:171], v[100:103], a[104:107]
s_add_u32 s48, s51, 55296
buffer_load_dwordx4 v236, s[16:19], s48 offen lds
v_mfma_f32_16x16x32_bf16 v[64:67], a[128:131], v[200:203], v[148:151]
v_exp_f32 v21, v21
v_mfma_f32_16x16x32_bf16 v[64:67], a[132:135], v[204:207], v[64:67]
ds_read_b64_tr_b16 a[168:169], v222 offset:0
ds_read_b64_tr_b16 a[170:171], v222 offset:4096
v_mfma_f32_16x16x32_bf16 v[64:67], a[136:139], v[208:211], v[64:67]
v_exp_f32 v22, v22
v_mfma_f32_16x16x32_bf16 v[64:67], a[140:143], v[212:215], v[64:67]
ds_read_b128 a[128:131], v216 offset:49152
ds_read_b128 a[132:135], v217 offset:49152
v_mfma_f32_16x16x32_bf16 a[12:15], a[172:175], v[88:91], a[12:15]
s_add_u32 m0, s3, 114688
v_exp_f32 v23, v23
v_mfma_f32_16x16x32_bf16 a[44:47], a[172:175], v[92:95], a[44:47]
s_add_u32 s48, s51, 73728
buffer_load_dwordx4 v236, s[16:19], s48 offen lds
v_mfma_f32_16x16x32_bf16 a[76:79], a[172:175], v[96:99], a[76:79]
v_exp_f32 v24, v24
v_mfma_f32_16x16x32_bf16 a[108:111], a[172:175], v[100:103], a[108:111]
v_exp_f32 v25, v25
v_mfma_f32_16x16x32_bf16 v[44:47], a[144:147], v[152:155], v[136:139]
ds_read_b128 a[136:139], v218 offset:49152
ds_read_b128 a[140:143], v219 offset:49152
v_mfma_f32_16x16x32_bf16 v[44:47], a[148:151], v[156:159], v[44:47]
v_exp_f32 v26, v26
v_mfma_f32_16x16x32_bf16 v[44:47], a[152:155], v[160:163], v[44:47]
s_add_u32 m0, s3, 118784
ds_read_b64_tr_b16 a[172:173], v223 offset:0
ds_read_b64_tr_b16 a[174:175], v223 offset:4096
v_mfma_f32_16x16x32_bf16 v[44:47], a[156:159], v[164:167], v[44:47]
s_add_u32 s48, s51, 92160
v_exp_f32 v27, v27
v_mfma_f32_16x16x32_bf16 a[16:19], a[176:179], v[88:91], a[16:19]
buffer_load_dwordx4 v236, s[16:19], s48 offen lds
v_mfma_f32_16x16x32_bf16 a[48:51], a[176:179], v[92:95], a[48:51]
v_exp_f32 v28, v28
v_mfma_f32_16x16x32_bf16 a[80:83], a[176:179], v[96:99], a[80:83]
v_cvt_pk_bf16_f32 v78, v20, v21
v_cvt_pk_bf16_f32 v79, v22, v23
v_mfma_f32_16x16x32_bf16 a[112:115], a[176:179], v[100:103], a[112:115]
s_add_u32 m0, s3, 122880
v_exp_f32 v29, v29
v_mfma_f32_16x16x32_bf16 v[52:55], a[144:147], v[168:171], v[140:143]
s_add_u32 s48, s51, 110592
buffer_load_dwordx4 v236, s[16:19], s48 offen lds
v_mfma_f32_16x16x32_bf16 v[52:55], a[148:151], v[172:175], v[52:55]
v_exp_f32 v30, v30
v_mfma_f32_16x16x32_bf16 v[52:55], a[152:155], v[176:179], v[52:55]
ds_read_b64_tr_b16 a[176:177], v224 offset:0
ds_read_b64_tr_b16 a[178:179], v224 offset:4096
v_mfma_f32_16x16x32_bf16 v[52:55], a[156:159], v[180:183], v[52:55]
v_exp_f32 v31, v31
v_mfma_f32_16x16x32_bf16 a[20:23], a[180:183], v[88:91], a[20:23]
v_cvt_pk_bf16_f32 v80, v24, v25
v_cvt_pk_bf16_f32 v81, v26, v27
v_mfma_f32_16x16x32_bf16 a[52:55], a[180:183], v[92:95], a[52:55]
s_add_u32 m0, s3, 126976
v_exp_f32 v32, v32
v_mfma_f32_16x16x32_bf16 a[84:87], a[180:183], v[96:99], a[84:87]
s_add_u32 s48, s51, 129024
buffer_load_dwordx4 v236, s[16:19], s48 offen lds
v_mfma_f32_16x16x32_bf16 a[116:119], a[180:183], v[100:103], a[116:119]
v_exp_f32 v33, v33
v_smfmac_f32_16x16x64_bf16 a[252:255], a[208:211], v[96:103], v235
ds_read_b64_tr_b16 a[180:181], v225 offset:0
ds_read_b64_tr_b16 a[182:183], v225 offset:4096
v_mfma_f32_16x16x32_bf16 v[60:63], a[144:147], v[184:187], v[144:147]
v_exp_f32 v34, v34
v_mfma_f32_16x16x32_bf16 v[60:63], a[148:151], v[188:191], v[60:63]
s_add_u32 m0, s3, 0
v_cvt_pk_bf16_f32 v82, v28, v29
v_cvt_pk_bf16_f32 v83, v30, v31
v_mfma_f32_16x16x32_bf16 v[60:63], a[152:155], v[192:195], v[60:63]
s_add_u32 s48, s75, 0
v_exp_f32 v35, v35
v_mfma_f32_16x16x32_bf16 v[60:63], a[156:159], v[196:199], v[60:63]
buffer_load_dwordx4 v237, s[16:19], s48 offen lds
v_mfma_f32_16x16x32_bf16 a[24:27], a[184:187], v[88:91], a[24:27]
v_exp_f32 v36, v36
v_mfma_f32_16x16x32_bf16 a[56:59], a[184:187], v[92:95], a[56:59]
v_cvt_pk_bf16_f32 v84, v32, v33
v_cvt_pk_bf16_f32 v85, v34, v35
v_mfma_f32_16x16x32_bf16 a[88:91], a[184:187], v[96:99], a[88:91]
v_exp_f32 v37, v37
v_mfma_f32_16x16x32_bf16 a[120:123], a[184:187], v[100:103], a[120:123]
s_add_u32 m0, s3, 4096
ds_read_b64_tr_b16 a[184:185], v226 offset:0
ds_read_b64_tr_b16 a[186:187], v226 offset:4096
v_mfma_f32_16x16x32_bf16 v[68:71], a[144:147], v[200:203], v[148:151]
s_add_u32 s48, s75, 36864
v_exp_f32 v38, v38
v_mfma_f32_16x16x32_bf16 v[68:71], a[148:151], v[204:207], v[68:71]
buffer_load_dwordx4 v237, s[16:19], s48 offen lds
v_mfma_f32_16x16x32_bf16 v[68:71], a[152:155], v[208:211], v[68:71]
v_exp_f32 v39, v39
v_mfma_f32_16x16x32_bf16 v[68:71], a[156:159], v[212:215], v[68:71]
ds_read_b128 a[144:147], v216 offset:53248
ds_read_b128 a[148:151], v217 offset:53248
v_mfma_f32_16x16x32_bf16 a[28:31], a[188:191], v[88:91], a[28:31]
ds_read_b128 a[152:155], v218 offset:53248
ds_read_b128 a[156:159], v219 offset:53248
v_mfma_f32_16x16x32_bf16 a[60:63], a[188:191], v[92:95], a[60:63]
v_cvt_pk_bf16_f32 v86, v36, v37
v_cvt_pk_bf16_f32 v87, v38, v39
v_mfma_f32_16x16x32_bf16 a[92:95], a[188:191], v[96:99], a[92:95]
v_mfma_f32_16x16x32_bf16 a[124:127], a[188:191], v[100:103], a[124:127]
s_waitcnt lgkmcnt(6)
ds_read_b64_tr_b16 a[188:189], v227 offset:0
ds_read_b64_tr_b16 a[190:191], v227 offset:4096
v_mfma_f32_16x16x32_bf16 v[8:11], a[128:131], v[152:155], v[136:139]
v_exp_f32 v40, v40
v_mfma_f32_16x16x32_bf16 v[8:11], a[132:135], v[156:159], v[8:11]
s_add_u32 m0, s3, 8192
v_exp_f32 v41, v41
v_mfma_f32_16x16x32_bf16 v[8:11], a[136:139], v[160:163], v[8:11]
s_add_u32 s48, s75, 73728
buffer_load_dwordx4 v237, s[16:19], s48 offen lds
v_mfma_f32_16x16x32_bf16 v[8:11], a[140:143], v[164:167], v[8:11]
v_exp_f32 v42, v42
v_mfma_f32_16x16x32_bf16 a[0:3], a[160:163], v[72:75], a[0:3]
v_cvt_pk_bf16_f32 v88, v40, v41
v_mfma_f32_16x16x32_bf16 a[32:35], a[160:163], v[76:79], a[32:35]
v_exp_f32 v43, v43
v_mfma_f32_16x16x32_bf16 a[64:67], a[160:163], v[80:83], a[64:67]
s_add_u32 m0, s3, 12288
v_cvt_pk_bf16_f32 v89, v42, v43
v_mfma_f32_16x16x32_bf16 a[96:99], a[160:163], v[84:87], a[96:99]
s_add_u32 s48, s75, 110592
v_exp_f32 v44, v44
v_mfma_f32_16x16x32_bf16 v[16:19], a[128:131], v[168:171], v[140:143]
buffer_load_dwordx4 v237, s[16:19], s48 offen lds
v_mfma_f32_16x16x32_bf16 v[16:19], a[132:135], v[172:175], v[16:19]
v_exp_f32 v45, v45
v_mfma_f32_16x16x32_bf16 v[16:19], a[136:139], v[176:179], v[16:19]
ds_read_b64_tr_b16 a[160:161], v220 offset:8192
ds_read_b64_tr_b16 a[162:163], v220 offset:12288
v_mfma_f32_16x16x32_bf16 v[16:19], a[140:143], v[180:183], v[16:19]
s_add_u32 m0, s3, 16384
v_exp_f32 v46, v46
v_mfma_f32_16x16x32_bf16 a[4:7], a[164:167], v[72:75], a[4:7]
s_add_u32 s48, s75, 147456
buffer_load_dwordx4 v237, s[16:19], s48 offen lds
v_mfma_f32_16x16x32_bf16 a[36:39], a[164:167], v[76:79], a[36:39]
v_exp_f32 v47, v47
v_mfma_f32_16x16x32_bf16 a[68:71], a[164:167], v[80:83], a[68:71]
v_cvt_pk_bf16_f32 v90, v44, v45
v_cvt_pk_bf16_f32 v91, v46, v47
v_mfma_f32_16x16x32_bf16 a[100:103], a[164:167], v[84:87], a[100:103]
v_exp_f32 v48, v48
v_smfmac_f32_16x16x64_bf16 a[248:251], a[208:211], v[72:79], v235
s_add_u32 m0, s3, 20480
ds_read_b64_tr_b16 a[164:165], v221 offset:8192
ds_read_b64_tr_b16 a[166:167], v221 offset:12288
v_mfma_f32_16x16x32_bf16 v[24:27], a[128:131], v[184:187], v[144:147]
s_add_u32 s48, s75, 184320
v_exp_f32 v49, v49
v_mfma_f32_16x16x32_bf16 v[24:27], a[132:135], v[188:191], v[24:27]
buffer_load_dwordx4 v237, s[16:19], s48 offen lds
v_mfma_f32_16x16x32_bf16 v[24:27], a[136:139], v[192:195], v[24:27]
v_exp_f32 v50, v50
v_mfma_f32_16x16x32_bf16 v[24:27], a[140:143], v[196:199], v[24:27]
v_cvt_pk_bf16_f32 v92, v48, v49
v_mfma_f32_16x16x32_bf16 a[8:11], a[168:171], v[72:75], a[8:11]
s_add_u32 m0, s3, 24576
v_exp_f32 v51, v51
v_mfma_f32_16x16x32_bf16 a[40:43], a[168:171], v[76:79], a[40:43]
s_add_u32 s48, s75, 221184
buffer_load_dwordx4 v237, s[16:19], s48 offen lds
v_mfma_f32_16x16x32_bf16 a[72:75], a[168:171], v[80:83], a[72:75]
v_exp_f32 v52, v52
v_mfma_f32_16x16x32_bf16 a[104:107], a[168:171], v[84:87], a[104:107]
ds_read_b64_tr_b16 a[168:169], v222 offset:8192
ds_read_b64_tr_b16 a[170:171], v222 offset:12288
v_mfma_f32_16x16x32_bf16 v[32:35], a[128:131], v[200:203], v[148:151]
v_exp_f32 v53, v53
v_mfma_f32_16x16x32_bf16 v[32:35], a[132:135], v[204:207], v[32:35]
s_add_u32 m0, s3, 28672
ds_read_b128 a[128:131], v216 offset:57344
ds_read_b128 a[132:135], v217 offset:57344
v_mfma_f32_16x16x32_bf16 v[32:35], a[136:139], v[208:211], v[32:35]
s_add_u32 s48, s75, 258048
v_exp_f32 v54, v54
v_mfma_f32_16x16x32_bf16 v[32:35], a[140:143], v[212:215], v[32:35]
buffer_load_dwordx4 v237, s[16:19], s48 offen lds
v_mfma_f32_16x16x32_bf16 a[12:15], a[172:175], v[72:75], a[12:15]
v_exp_f32 v55, v55
v_mfma_f32_16x16x32_bf16 a[44:47], a[172:175], v[76:79], a[44:47]
ds_read_b128 a[136:139], v218 offset:57344
ds_read_b128 a[140:143], v219 offset:57344
v_mfma_f32_16x16x32_bf16 a[76:79], a[172:175], v[80:83], a[76:79]
s_waitcnt lgkmcnt(6)
v_exp_f32 v56, v56
v_mfma_f32_16x16x32_bf16 a[108:111], a[172:175], v[84:87], a[108:111]
s_add_u32 m0, s3, 131072
v_exp_f32 v57, v57
v_mfma_f32_16x16x32_bf16 v[12:15], a[144:147], v[152:155], v[136:139]
s_add_u32 s48, s51, 147456
buffer_load_dwordx4 v236, s[16:19], s48 offen lds
v_mfma_f32_16x16x32_bf16 v[12:15], a[148:151], v[156:159], v[12:15]
v_exp_f32 v58, v58
v_mfma_f32_16x16x32_bf16 v[12:15], a[152:155], v[160:163], v[12:15]
ds_read_b64_tr_b16 a[172:173], v223 offset:8192
ds_read_b64_tr_b16 a[174:175], v223 offset:12288
v_mfma_f32_16x16x32_bf16 v[12:15], a[156:159], v[164:167], v[12:15]
v_exp_f32 v59, v59
v_mfma_f32_16x16x32_bf16 a[16:19], a[176:179], v[72:75], a[16:19]
s_add_u32 m0, s3, 135168
v_cvt_pk_bf16_f32 v93, v50, v51
v_cvt_pk_bf16_f32 v94, v52, v53
v_mfma_f32_16x16x32_bf16 a[48:51], a[176:179], v[76:79], a[48:51]
s_add_u32 s48, s51, 165888
v_exp_f32 v60, v60
v_mfma_f32_16x16x32_bf16 a[80:83], a[176:179], v[80:83], a[80:83]
buffer_load_dwordx4 v236, s[16:19], s48 offen lds
v_mfma_f32_16x16x32_bf16 a[112:115], a[176:179], v[84:87], a[112:115]
v_exp_f32 v61, v61
v_mfma_f32_16x16x32_bf16 v[20:23], a[144:147], v[168:171], v[140:143]
ds_read_b64_tr_b16 a[176:177], v224 offset:8192
ds_read_b64_tr_b16 a[178:179], v224 offset:12288
v_mfma_f32_16x16x32_bf16 v[20:23], a[148:151], v[172:175], v[20:23]
s_add_u32 m0, s3, 139264
v_exp_f32 v62, v62
v_mfma_f32_16x16x32_bf16 v[20:23], a[152:155], v[176:179], v[20:23]
s_add_u32 s48, s51, 184320
buffer_load_dwordx4 v236, s[16:19], s48 offen lds
v_mfma_f32_16x16x32_bf16 v[20:23], a[156:159], v[180:183], v[20:23]
v_exp_f32 v63, v63
v_mfma_f32_16x16x32_bf16 a[20:23], a[180:183], v[72:75], a[20:23]
v_cvt_pk_bf16_f32 v95, v54, v55
v_cvt_pk_bf16_f32 v96, v56, v57
v_mfma_f32_16x16x32_bf16 a[52:55], a[180:183], v[76:79], a[52:55]
v_exp_f32 v64, v64
v_mfma_f32_16x16x32_bf16 a[84:87], a[180:183], v[80:83], a[84:87]
s_add_u32 m0, s3, 143360
v_cvt_pk_bf16_f32 v97, v58, v59
v_cvt_pk_bf16_f32 v98, v60, v61
v_mfma_f32_16x16x32_bf16 a[116:119], a[180:183], v[84:87], a[116:119]
s_add_u32 s48, s51, 202752
v_exp_f32 v65, v65
v_smfmac_f32_16x16x64_bf16 a[252:255], a[208:211], v[80:87], v235
buffer_load_dwordx4 v236, s[16:19], s48 offen lds
v_mfma_f32_16x16x32_bf16 v[28:31], a[144:147], v[184:187], v[144:147]
v_exp_f32 v66, v66
v_mfma_f32_16x16x32_bf16 v[28:31], a[148:151], v[188:191], v[28:31]
ds_read_b64_tr_b16 a[180:181], v225 offset:8192
ds_read_b64_tr_b16 a[182:183], v225 offset:12288
v_mfma_f32_16x16x32_bf16 v[28:31], a[152:155], v[192:195], v[28:31]
s_add_u32 m0, s3, 147456
v_exp_f32 v67, v67
v_mfma_f32_16x16x32_bf16 v[28:31], a[156:159], v[196:199], v[28:31]
s_add_u32 s48, s51, 221184
buffer_load_dwordx4 v236, s[16:19], s48 offen lds
v_mfma_f32_16x16x32_bf16 a[24:27], a[184:187], v[72:75], a[24:27]
v_exp_f32 v68, v68
v_mfma_f32_16x16x32_bf16 a[56:59], a[184:187], v[76:79], a[56:59]
v_cvt_pk_bf16_f32 v99, v62, v63
v_cvt_pk_bf16_f32 v100, v64, v65
v_mfma_f32_16x16x32_bf16 a[88:91], a[184:187], v[80:83], a[88:91]
v_exp_f32 v69, v69
v_mfma_f32_16x16x32_bf16 a[120:123], a[184:187], v[84:87], a[120:123]
s_add_u32 m0, s3, 151552
ds_read_b64_tr_b16 a[184:185], v226 offset:8192
ds_read_b64_tr_b16 a[186:187], v226 offset:12288
v_mfma_f32_16x16x32_bf16 v[36:39], a[144:147], v[200:203], v[148:151]
s_add_u32 s48, s51, 239616
v_exp_f32 v70, v70
v_mfma_f32_16x16x32_bf16 v[36:39], a[148:151], v[204:207], v[36:39]
buffer_load_dwordx4 v236, s[16:19], s48 offen lds
v_mfma_f32_16x16x32_bf16 v[36:39], a[152:155], v[208:211], v[36:39]
v_exp_f32 v71, v71
v_mfma_f32_16x16x32_bf16 v[36:39], a[156:159], v[212:215], v[36:39]
ds_read_b128 a[144:147], v216 offset:61440
ds_read_b128 a[148:151], v217 offset:61440
v_mfma_f32_16x16x32_bf16 a[28:31], a[188:191], v[72:75], a[28:31]
ds_read_b128 a[152:155], v218 offset:61440
ds_read_b128 a[156:159], v219 offset:61440
v_mfma_f32_16x16x32_bf16 a[60:63], a[188:191], v[76:79], a[60:63]
v_cvt_pk_bf16_f32 v101, v66, v67
v_cvt_pk_bf16_f32 v102, v68, v69
v_mfma_f32_16x16x32_bf16 a[92:95], a[188:191], v[80:83], a[92:95]
v_cvt_pk_bf16_f32 v103, v70, v71
v_mfma_f32_16x16x32_bf16 a[124:127], a[188:191], v[84:87], a[124:127]
s_waitcnt lgkmcnt(6)
ds_read_b64_tr_b16 a[188:189], v227 offset:8192
ds_read_b64_tr_b16 a[190:191], v227 offset:12288
v_mfma_f32_16x16x32_bf16 v[40:43], a[128:131], v[152:155], v[136:139]
v_exp_f32 v8, v8
v_mfma_f32_16x16x32_bf16 v[40:43], a[132:135], v[156:159], v[40:43]
v_exp_f32 v9, v9
v_mfma_f32_16x16x32_bf16 v[40:43], a[136:139], v[160:163], v[40:43]
v_cvt_pk_bf16_f32 v72, v8, v9
v_mfma_f32_16x16x32_bf16 v[40:43], a[140:143], v[164:167], v[40:43]
v_exp_f32 v10, v10
v_mfma_f32_16x16x32_bf16 a[0:3], a[160:163], v[88:91], a[0:3]
v_mfma_f32_16x16x32_bf16 a[32:35], a[160:163], v[92:95], a[32:35]
v_exp_f32 v11, v11
s_waitcnt lgkmcnt(0)
s_barrier
v_mfma_f32_16x16x32_bf16 a[64:67], a[160:163], v[96:99], a[64:67]
v_cvt_pk_bf16_f32 v73, v10, v11
v_mfma_f32_16x16x32_bf16 a[96:99], a[160:163], v[100:103], a[96:99]
s_add_u32 m0, s3, 155648
v_exp_f32 v12, v12
v_mfma_f32_16x16x32_bf16 v[48:51], a[128:131], v[168:171], v[140:143]
s_add_u32 s48, s51, 258048
buffer_load_dwordx4 v236, s[16:19], s48 offen lds
v_mfma_f32_16x16x32_bf16 v[48:51], a[132:135], v[172:175], v[48:51]
v_exp_f32 v13, v13
v_mfma_f32_16x16x32_bf16 v[48:51], a[136:139], v[176:179], v[48:51]
ds_read_b64_tr_b16 a[160:161], v220 offset:16384
ds_read_b64_tr_b16 a[162:163], v220 offset:20480
v_mfma_f32_16x16x32_bf16 v[48:51], a[140:143], v[180:183], v[48:51]
s_add_u32 m0, s3, 159744
v_exp_f32 v14, v14
v_mfma_f32_16x16x32_bf16 a[4:7], a[164:167], v[88:91], a[4:7]
s_add_u32 s48, s51, 276480
buffer_load_dwordx4 v236, s[16:19], s48 offen lds
v_mfma_f32_16x16x32_bf16 a[36:39], a[164:167], v[92:95], a[36:39]
v_exp_f32 v15, v15
v_mfma_f32_16x16x32_bf16 a[68:71], a[164:167], v[96:99], a[68:71]
v_cvt_pk_bf16_f32 v74, v12, v13
v_cvt_pk_bf16_f32 v75, v14, v15
v_mfma_f32_16x16x32_bf16 a[100:103], a[164:167], v[100:103], a[100:103]
s_add_u32 m0, s3, 32768
v_exp_f32 v16, v16
v_smfmac_f32_16x16x64_bf16 a[248:251], a[208:211], v[88:95], v235
s_add_u32 s48, s42, 0
buffer_load_dwordx4 v236, s[16:19], s48 offen lds
v_mfma_f32_16x16x32_bf16 v[56:59], a[128:131], v[184:187], v[144:147]
v_exp_f32 v17, v17
v_mfma_f32_16x16x32_bf16 v[56:59], a[132:135], v[188:191], v[56:59]
ds_read_b64_tr_b16 a[164:165], v221 offset:16384
ds_read_b64_tr_b16 a[166:167], v221 offset:20480
v_mfma_f32_16x16x32_bf16 v[56:59], a[136:139], v[192:195], v[56:59]
s_add_u32 m0, s3, 36864
v_exp_f32 v18, v18
v_mfma_f32_16x16x32_bf16 v[56:59], a[140:143], v[196:199], v[56:59]
s_add_u32 s48, s42, 18432
buffer_load_dwordx4 v236, s[16:19], s48 offen lds
v_mfma_f32_16x16x32_bf16 a[8:11], a[168:171], v[88:91], a[8:11]
v_exp_f32 v19, v19
v_mfma_f32_16x16x32_bf16 a[40:43], a[168:171], v[92:95], a[40:43]
v_cvt_pk_bf16_f32 v76, v16, v17
v_cvt_pk_bf16_f32 v77, v18, v19
v_mfma_f32_16x16x32_bf16 a[72:75], a[168:171], v[96:99], a[72:75]
v_exp_f32 v20, v20
v_mfma_f32_16x16x32_bf16 a[104:107], a[168:171], v[100:103], a[104:107]
s_add_u32 m0, s3, 40960
ds_read_b64_tr_b16 a[168:169], v222 offset:16384
ds_read_b64_tr_b16 a[170:171], v222 offset:20480
v_mfma_f32_16x16x32_bf16 v[64:67], a[128:131], v[200:203], v[148:151]
s_add_u32 s48, s42, 36864
v_exp_f32 v21, v21
v_mfma_f32_16x16x32_bf16 v[64:67], a[132:135], v[204:207], v[64:67]
buffer_load_dwordx4 v236, s[16:19], s48 offen lds
v_mfma_f32_16x16x32_bf16 v[64:67], a[136:139], v[208:211], v[64:67]
v_exp_f32 v22, v22
v_mfma_f32_16x16x32_bf16 v[64:67], a[140:143], v[212:215], v[64:67]
s_add_u32 m0, s3, 45056
v_cvt_pk_bf16_f32 v78, v20, v21
v_mfma_f32_16x16x32_bf16 a[12:15], a[172:175], v[88:91], a[12:15]
s_add_u32 s48, s42, 55296
v_exp_f32 v23, v23
v_mfma_f32_16x16x32_bf16 a[44:47], a[172:175], v[92:95], a[44:47]
buffer_load_dwordx4 v236, s[16:19], s48 offen lds
v_mfma_f32_16x16x32_bf16 a[76:79], a[172:175], v[96:99], a[76:79]
v_exp_f32 v24, v24
v_mfma_f32_16x16x32_bf16 a[108:111], a[172:175], v[100:103], a[108:111]
s_add_u32 m0, s3, 49152
v_exp_f32 v25, v25
v_mfma_f32_16x16x32_bf16 v[44:47], a[144:147], v[152:155], v[136:139]
s_add_u32 s48, s42, 73728
buffer_load_dwordx4 v236, s[16:19], s48 offen lds
v_mfma_f32_16x16x32_bf16 v[44:47], a[148:151], v[156:159], v[44:47]
v_exp_f32 v26, v26
v_mfma_f32_16x16x32_bf16 v[44:47], a[152:155], v[160:163], v[44:47]
ds_read_b64_tr_b16 a[172:173], v223 offset:16384
ds_read_b64_tr_b16 a[174:175], v223 offset:20480
v_mfma_f32_16x16x32_bf16 v[44:47], a[156:159], v[164:167], v[44:47]
v_exp_f32 v27, v27
v_mfma_f32_16x16x32_bf16 a[16:19], a[176:179], v[88:91], a[16:19]
s_add_u32 m0, s3, 53248
v_cvt_pk_bf16_f32 v79, v22, v23
v_cvt_pk_bf16_f32 v80, v24, v25
v_mfma_f32_16x16x32_bf16 a[48:51], a[176:179], v[92:95], a[48:51]
s_add_u32 s48, s42, 92160
v_exp_f32 v28, v28
v_mfma_f32_16x16x32_bf16 a[80:83], a[176:179], v[96:99], a[80:83]
buffer_load_dwordx4 v236, s[16:19], s48 offen lds
v_mfma_f32_16x16x32_bf16 a[112:115], a[176:179], v[100:103], a[112:115]
v_exp_f32 v29, v29
v_mfma_f32_16x16x32_bf16 v[52:55], a[144:147], v[168:171], v[140:143]
s_add_u32 m0, s3, 57344
ds_read_b64_tr_b16 a[176:177], v224 offset:16384
ds_read_b64_tr_b16 a[178:179], v224 offset:20480
v_mfma_f32_16x16x32_bf16 v[52:55], a[148:151], v[172:175], v[52:55]
s_add_u32 s48, s42, 110592
v_exp_f32 v30, v30
v_mfma_f32_16x16x32_bf16 v[52:55], a[152:155], v[176:179], v[52:55]
buffer_load_dwordx4 v236, s[16:19], s48 offen lds
v_mfma_f32_16x16x32_bf16 v[52:55], a[156:159], v[180:183], v[52:55]
v_exp_f32 v31, v31
v_mfma_f32_16x16x32_bf16 a[20:23], a[180:183], v[88:91], a[20:23]
s_add_u32 m0, s3, 61440
v_cvt_pk_bf16_f32 v81, v26, v27
v_cvt_pk_bf16_f32 v82, v28, v29
v_mfma_f32_16x16x32_bf16 a[52:55], a[180:183], v[92:95], a[52:55]
s_add_u32 s48, s42, 129024
v_exp_f32 v32, v32
v_mfma_f32_16x16x32_bf16 a[84:87], a[180:183], v[96:99], a[84:87]
buffer_load_dwordx4 v236, s[16:19], s48 offen lds
v_mfma_f32_16x16x32_bf16 a[116:119], a[180:183], v[100:103], a[116:119]
v_exp_f32 v33, v33
v_smfmac_f32_16x16x64_bf16 a[252:255], a[208:211], v[96:103], v235
ds_read_b64_tr_b16 a[180:181], v225 offset:16384
ds_read_b64_tr_b16 a[182:183], v225 offset:20480
v_mfma_f32_16x16x32_bf16 v[60:63], a[144:147], v[184:187], v[144:147]
s_add_u32 m0, s3, 65536
v_exp_f32 v34, v34
v_mfma_f32_16x16x32_bf16 v[60:63], a[148:151], v[188:191], v[60:63]
s_add_u32 s48, s43, 0
buffer_load_dwordx4 v236, s[16:19], s48 offen lds
v_mfma_f32_16x16x32_bf16 v[60:63], a[152:155], v[192:195], v[60:63]
v_exp_f32 v35, v35
v_mfma_f32_16x16x32_bf16 v[60:63], a[156:159], v[196:199], v[60:63]
v_cvt_pk_bf16_f32 v83, v30, v31
v_cvt_pk_bf16_f32 v84, v32, v33
v_mfma_f32_16x16x32_bf16 a[24:27], a[184:187], v[88:91], a[24:27]
s_add_u32 m0, s3, 69632
v_exp_f32 v36, v36
v_mfma_f32_16x16x32_bf16 a[56:59], a[184:187], v[92:95], a[56:59]
s_add_u32 s48, s43, 18432
buffer_load_dwordx4 v236, s[16:19], s48 offen lds
v_mfma_f32_16x16x32_bf16 a[88:91], a[184:187], v[96:99], a[88:91]
v_exp_f32 v37, v37
v_mfma_f32_16x16x32_bf16 a[120:123], a[184:187], v[100:103], a[120:123]
ds_read_b64_tr_b16 a[184:185], v226 offset:16384
ds_read_b64_tr_b16 a[186:187], v226 offset:20480
v_mfma_f32_16x16x32_bf16 v[68:71], a[144:147], v[200:203], v[148:151]
s_add_u32 m0, s3, 73728
v_exp_f32 v38, v38
v_mfma_f32_16x16x32_bf16 v[68:71], a[148:151], v[204:207], v[68:71]
s_add_u32 s48, s43, 36864
buffer_load_dwordx4 v236, s[16:19], s48 offen lds
v_mfma_f32_16x16x32_bf16 v[68:71], a[152:155], v[208:211], v[68:71]
v_exp_f32 v39, v39
v_mfma_f32_16x16x32_bf16 v[68:71], a[156:159], v[212:215], v[68:71]
v_cvt_pk_bf16_f32 v85, v34, v35
v_cvt_pk_bf16_f32 v86, v36, v37
v_mfma_f32_16x16x32_bf16 a[28:31], a[188:191], v[88:91], a[28:31]
v_cvt_pk_bf16_f32 v87, v38, v39
v_mfma_f32_16x16x32_bf16 a[60:63], a[188:191], v[92:95], a[60:63]
v_mfma_f32_16x16x32_bf16 a[92:95], a[188:191], v[96:99], a[92:95]
v_mfma_f32_16x16x32_bf16 a[124:127], a[188:191], v[100:103], a[124:127]
ds_read_b64_tr_b16 a[188:189], v227 offset:16384
ds_read_b64_tr_b16 a[190:191], v227 offset:20480
s_waitcnt lgkmcnt(4)
v_mfma_f32_16x16x32_bf16 a[0:3], a[160:163], v[72:75], a[0:3]
v_exp_f32 v40, v40
v_exp_f32 v41, v41
v_mfma_f32_16x16x32_bf16 a[32:35], a[160:163], v[76:79], a[32:35]
v_cvt_pk_bf16_f32 v88, v40, v41
v_exp_f32 v42, v42
v_mfma_f32_16x16x32_bf16 a[64:67], a[160:163], v[80:83], a[64:67]
v_exp_f32 v43, v43
v_mfma_f32_16x16x32_bf16 a[96:99], a[160:163], v[84:87], a[96:99]
ds_read_b64_tr_b16 a[160:161], v220 offset:24576
ds_read_b64_tr_b16 a[162:163], v220 offset:28672
v_exp_f32 v44, v44
v_mfma_f32_16x16x32_bf16 a[4:7], a[164:167], v[72:75], a[4:7]
v_cvt_pk_bf16_f32 v89, v42, v43
v_exp_f32 v45, v45
v_mfma_f32_16x16x32_bf16 a[36:39], a[164:167], v[76:79], a[36:39]
v_cvt_pk_bf16_f32 v90, v44, v45
v_exp_f32 v46, v46
v_mfma_f32_16x16x32_bf16 a[68:71], a[164:167], v[80:83], a[68:71]
v_exp_f32 v47, v47
v_mfma_f32_16x16x32_bf16 a[100:103], a[164:167], v[84:87], a[100:103]
ds_read_b64_tr_b16 a[164:165], v221 offset:24576
ds_read_b64_tr_b16 a[166:167], v221 offset:28672
v_exp_f32 v48, v48
v_smfmac_f32_16x16x64_bf16 a[248:251], a[208:211], v[72:79], v235
v_cvt_pk_bf16_f32 v91, v46, v47
v_exp_f32 v49, v49
v_mfma_f32_16x16x32_bf16 a[8:11], a[168:171], v[72:75], a[8:11]
v_cvt_pk_bf16_f32 v92, v48, v49
v_exp_f32 v50, v50
v_mfma_f32_16x16x32_bf16 a[40:43], a[168:171], v[76:79], a[40:43]
v_exp_f32 v51, v51
v_mfma_f32_16x16x32_bf16 a[72:75], a[168:171], v[80:83], a[72:75]
v_cvt_pk_bf16_f32 v93, v50, v51
v_exp_f32 v52, v52
v_mfma_f32_16x16x32_bf16 a[104:107], a[168:171], v[84:87], a[104:107]
ds_read_b64_tr_b16 a[168:169], v222 offset:24576
ds_read_b64_tr_b16 a[170:171], v222 offset:28672
v_exp_f32 v53, v53
v_mfma_f32_16x16x32_bf16 a[12:15], a[172:175], v[72:75], a[12:15]
v_cvt_pk_bf16_f32 v94, v52, v53
v_exp_f32 v54, v54
v_mfma_f32_16x16x32_bf16 a[44:47], a[172:175], v[76:79], a[44:47]
v_exp_f32 v55, v55
v_mfma_f32_16x16x32_bf16 a[76:79], a[172:175], v[80:83], a[76:79]
v_exp_f32 v56, v56
v_exp_f32 v57, v57
v_mfma_f32_16x16x32_bf16 a[108:111], a[172:175], v[84:87], a[108:111]
ds_read_b64_tr_b16 a[172:173], v223 offset:24576
ds_read_b64_tr_b16 a[174:175], v223 offset:28672
v_exp_f32 v58, v58
v_mfma_f32_16x16x32_bf16 a[16:19], a[176:179], v[72:75], a[16:19]
v_cvt_pk_bf16_f32 v95, v54, v55
v_cvt_pk_bf16_f32 v96, v56, v57
v_exp_f32 v59, v59
v_mfma_f32_16x16x32_bf16 a[48:51], a[176:179], v[76:79], a[48:51]
v_cvt_pk_bf16_f32 v97, v58, v59
v_exp_f32 v60, v60
v_mfma_f32_16x16x32_bf16 a[80:83], a[176:179], v[80:83], a[80:83]
v_exp_f32 v61, v61
v_mfma_f32_16x16x32_bf16 a[112:115], a[176:179], v[84:87], a[112:115]
ds_read_b64_tr_b16 a[176:177], v224 offset:24576
ds_read_b64_tr_b16 a[178:179], v224 offset:28672
v_exp_f32 v62, v62
v_mfma_f32_16x16x32_bf16 a[20:23], a[180:183], v[72:75], a[20:23]
v_cvt_pk_bf16_f32 v98, v60, v61
v_exp_f32 v63, v63
v_mfma_f32_16x16x32_bf16 a[52:55], a[180:183], v[76:79], a[52:55]
v_cvt_pk_bf16_f32 v99, v62, v63
v_exp_f32 v64, v64
v_mfma_f32_16x16x32_bf16 a[84:87], a[180:183], v[80:83], a[84:87]
v_exp_f32 v65, v65
v_mfma_f32_16x16x32_bf16 a[116:119], a[180:183], v[84:87], a[116:119]
ds_read_b64_tr_b16 a[180:181], v225 offset:24576
ds_read_b64_tr_b16 a[182:183], v225 offset:28672
v_exp_f32 v66, v66
v_smfmac_f32_16x16x64_bf16 a[252:255], a[208:211], v[80:87], v235
s_waitcnt lgkmcnt(6)
v_cvt_pk_bf16_f32 v100, v64, v65
v_exp_f32 v67, v67
v_mfma_f32_16x16x32_bf16 a[24:27], a[184:187], v[72:75], a[24:27]
v_cvt_pk_bf16_f32 v101, v66, v67
v_exp_f32 v68, v68
v_mfma_f32_16x16x32_bf16 a[56:59], a[184:187], v[76:79], a[56:59]
v_exp_f32 v69, v69
v_mfma_f32_16x16x32_bf16 a[88:91], a[184:187], v[80:83], a[88:91]
v_cvt_pk_bf16_f32 v102, v68, v69
v_exp_f32 v70, v70
v_mfma_f32_16x16x32_bf16 a[120:123], a[184:187], v[84:87], a[120:123]
ds_read_b64_tr_b16 a[184:185], v226 offset:24576
ds_read_b64_tr_b16 a[186:187], v226 offset:28672
v_exp_f32 v71, v71
v_mfma_f32_16x16x32_bf16 a[28:31], a[188:191], v[72:75], a[28:31]
v_cvt_pk_bf16_f32 v103, v70, v71
v_mfma_f32_16x16x32_bf16 a[60:63], a[188:191], v[76:79], a[60:63]
v_mfma_f32_16x16x32_bf16 a[92:95], a[188:191], v[80:83], a[92:95]
v_mfma_f32_16x16x32_bf16 a[124:127], a[188:191], v[84:87], a[124:127]
ds_read_b64_tr_b16 a[188:189], v227 offset:24576
ds_read_b64_tr_b16 a[190:191], v227 offset:28672
v_smfmac_f32_16x16x64_bf16 a[248:251], a[208:211], v[88:95], v235
s_lshl_b32 s46, s32, 2
v_and_b32 v138, 3, v1
v_smfmac_f32_16x16x64_bf16 a[252:255], a[208:211], v[96:103], v235
s_add_u32 s46, s46, 77824
v_lshlrev_b32 v138, 10, v138
v_mfma_f32_16x16x32_bf16 a[0:3], a[160:163], v[88:91], a[0:3]
s_add_u32 s47, s3, 77824
v_add_u32 v138, s46, v138
v_mfma_f32_16x16x32_bf16 a[4:7], a[164:167], v[88:91], a[4:7]
v_mov_b32 v139, s47
v_mfma_f32_16x16x32_bf16 a[8:11], a[168:171], v[88:91], a[8:11]
s_nop 0
s_nop 0
s_waitcnt lgkmcnt(4)
v_mfma_f32_16x16x32_bf16 a[12:15], a[172:175], v[88:91], a[12:15]
v_accvgpr_read_b32 v104, a248
v_accvgpr_read_b32 v105, a249
v_mfma_f32_16x16x32_bf16 a[16:19], a[176:179], v[88:91], a[16:19]
v_accvgpr_read_b32 v106, a250
v_accvgpr_read_b32 v107, a251
v_mfma_f32_16x16x32_bf16 a[20:23], a[180:183], v[88:91], a[20:23]
v_accvgpr_read_b32 v108, a252
v_accvgpr_read_b32 v109, a253
s_waitcnt lgkmcnt(2)
v_mfma_f32_16x16x32_bf16 a[24:27], a[184:187], v[88:91], a[24:27]
v_accvgpr_read_b32 v110, a254
v_accvgpr_read_b32 v111, a255
s_waitcnt lgkmcnt(0)
v_mfma_f32_16x16x32_bf16 a[28:31], a[188:191], v[88:91], a[28:31]
v_add_f32 v104, v104, v105
v_add_f32 v106, v106, v107
v_mfma_f32_16x16x32_bf16 a[32:35], a[160:163], v[92:95], a[32:35]
v_add_f32 v108, v108, v109
v_add_f32 v110, v110, v111
v_mfma_f32_16x16x32_bf16 a[36:39], a[164:167], v[92:95], a[36:39]
v_max3_f32 v136, v104, v106, v108
v_add_f32 v137, v104, v106
v_mfma_f32_16x16x32_bf16 a[40:43], a[168:171], v[92:95], a[40:43]
v_max_f32 v136, v136, v110
v_add_f32 v137, v137, v108
v_mfma_f32_16x16x32_bf16 a[44:47], a[172:175], v[92:95], a[44:47]
v_cmp_nge_f32 vcc, 0x5f800000, v136
v_add_f32 v137, v137, v110
v_mfma_f32_16x16x32_bf16 a[48:51], a[176:179], v[92:95], a[48:51]
v_cmp_u_f32 s[94:95], v137, v137
v_mfma_f32_16x16x32_bf16 a[52:55], a[180:183], v[92:95], a[52:55]
v_mfma_f32_16x16x32_bf16 a[56:59], a[184:187], v[92:95], a[56:59]
v_mfma_f32_16x16x32_bf16 a[60:63], a[188:191], v[92:95], a[60:63]
s_or_b64 vcc, vcc, s[94:95]
s_cmp_lg_u64 vcc, 0
s_cselect_b32 s48, 1, 0
v_mov_b32 v136, s48
ds_write_b32 v138, v136
s_cmp_lg_u32 s52, 0
s_cbranch_scc1 K_YRA
K_YRAD:
v_rcp_f32 v104, v104
v_rcp_f32 v106, v106
v_rcp_f32 v108, v108
v_rcp_f32 v110, v110
v_mul_f32 v105, -s97, v104
v_mul_f32 v107, -s97, v106
v_mul_f32 v109, -s97, v108
v_mul_f32 v111, -s97, v110
s_waitcnt vmcnt(0) lgkmcnt(0)
s_barrier
ds_read_b128 v[140:143], v139
v_mfma_f32_16x16x32_bf16 a[64:67], a[160:163], v[96:99], a[64:67]
v_accvgpr_read_b32 v40, a0
v_accvgpr_read_b32 v41, a1
v_mfma_f32_16x16x32_bf16 a[68:71], a[164:167], v[96:99], a[68:71]
v_accvgpr_read_b32 v42, a2
v_accvgpr_read_b32 v43, a3
v_mfma_f32_16x16x32_bf16 a[72:75], a[168:171], v[96:99], a[72:75]
v_accvgpr_read_b32 v44, a4
v_accvgpr_read_b32 v45, a5
v_mfma_f32_16x16x32_bf16 a[76:79], a[172:175], v[96:99], a[76:79]
v_accvgpr_read_b32 v46, a6
v_accvgpr_read_b32 v47, a7
v_mfma_f32_16x16x32_bf16 a[80:83], a[176:179], v[96:99], a[80:83]
v_accvgpr_read_b32 v48, a8
v_accvgpr_read_b32 v49, a9
v_mfma_f32_16x16x32_bf16 a[84:87], a[180:183], v[96:99], a[84:87]
v_accvgpr_read_b32 v50, a10
v_accvgpr_read_b32 v51, a11
v_mfma_f32_16x16x32_bf16 a[88:91], a[184:187], v[96:99], a[88:91]
v_accvgpr_read_b32 v52, a12
v_accvgpr_read_b32 v53, a13
v_mfma_f32_16x16x32_bf16 a[92:95], a[188:191], v[96:99], a[92:95]
v_accvgpr_read_b32 v54, a14
v_accvgpr_read_b32 v55, a15
v_mfma_f32_16x16x32_bf16 a[96:99], a[160:163], v[100:103], a[96:99]
v_accvgpr_read_b32 v56, a16
v_accvgpr_read_b32 v57, a17
v_mfma_f32_16x16x32_bf16 a[100:103], a[164:167], v[100:103], a[100:103]
v_accvgpr_read_b32 v58, a18
v_accvgpr_read_b32 v59, a19
v_mfma_f32_16x16x32_bf16 a[104:107], a[168:171], v[100:103], a[104:107]
v_accvgpr_read_b32 v60, a20
v_accvgpr_read_b32 v61, a21
v_mfma_f32_16x16x32_bf16 a[108:111], a[172:175], v[100:103], a[108:111]
v_accvgpr_read_b32 v62, a22
v_accvgpr_read_b32 v63, a23
v_mfma_f32_16x16x32_bf16 a[112:115], a[176:179], v[100:103], a[112:115]
v_accvgpr_read_b32 v64, a24
v_accvgpr_read_b32 v65, a25
v_mfma_f32_16x16x32_bf16 a[116:119], a[180:183], v[100:103], a[116:119]
v_accvgpr_read_b32 v66, a26
v_accvgpr_read_b32 v67, a27
v_mfma_f32_16x16x32_bf16 a[120:123], a[184:187], v[100:103], a[120:123]
v_accvgpr_read_b32 v68, a28
v_accvgpr_read_b32 v69, a29
v_mfma_f32_16x16x32_bf16 a[124:127], a[188:191], v[100:103], a[124:127]
v_accvgpr_read_b32 v70, a30
v_accvgpr_read_b32 v71, a31
v_pk_fma_f32 v[40:41], v[40:41], v[104:105], v[104:105] op_sel:[0,0,1] op_sel_hi:[1,0,1]
v_pk_fma_f32 v[42:43], v[42:43], v[104:105], v[104:105] op_sel:[0,0,1] op_sel_hi:[1,0,1]
v_pk_fma_f32 v[44:45], v[44:45], v[104:105], v[104:105] op_sel:[0,0,1] op_sel_hi:[1,0,1]
v_pk_fma_f32 v[46:47], v[46:47], v[104:105], v[104:105] op_sel:[0,0,1] op_sel_hi:[1,0,1]
v_cvt_pk_bf16_f32 v8, v40, v41
v_cvt_pk_bf16_f32 v9, v42, v43
v_cvt_pk_bf16_f32 v10, v44, v45
v_cvt_pk_bf16_f32 v11, v46, v47
s_add_u32 s94, s53, 0
buffer_store_dwordx4 v[8:11], v234, s[20:23], s94 offen offset:0 sc0 sc1
v_pk_fma_f32 v[48:49], v[48:49], v[104:105], v[104:105] op_sel:[0,0,1] op_sel_hi:[1,0,1]
v_pk_fma_f32 v[50:51], v[50:51], v[104:105], v[104:105] op_sel:[0,0,1] op_sel_hi:[1,0,1]
v_pk_fma_f32 v[52:53], v[52:53], v[104:105], v[104:105] op_sel:[0,0,1] op_sel_hi:[1,0,1]
v_pk_fma_f32 v[54:55], v[54:55], v[104:105], v[104:105] op_sel:[0,0,1] op_sel_hi:[1,0,1]
v_cvt_pk_bf16_f32 v16, v48, v49
v_cvt_pk_bf16_f32 v17, v50, v51
v_cvt_pk_bf16_f32 v18, v52, v53
v_cvt_pk_bf16_f32 v19, v54, v55
s_add_u32 s94, s53, 0
buffer_store_dwordx4 v[16:19], v234, s[20:23], s94 offen offset:2048 sc0 sc1
v_pk_fma_f32 v[56:57], v[56:57], v[104:105], v[104:105] op_sel:[0,0,1] op_sel_hi:[1,0,1]
v_pk_fma_f32 v[58:59], v[58:59], v[104:105], v[104:105] op_sel:[0,0,1] op_sel_hi:[1,0,1]
v_pk_fma_f32 v[60:61], v[60:61], v[104:105], v[104:105] op_sel:[0,0,1] op_sel_hi:[1,0,1]
v_pk_fma_f32 v[62:63], v[62:63], v[104:105], v[104:105] op_sel:[0,0,1] op_sel_hi:[1,0,1]
v_cvt_pk_bf16_f32 v24, v56, v57
v_cvt_pk_bf16_f32 v25, v58, v59
v_cvt_pk_bf16_f32 v26, v60, v61
v_cvt_pk_bf16_f32 v27, v62, v63
s_add_u32 s94, s53, 4096
buffer_store_dwordx4 v[24:27], v234, s[20:23], s94 offen offset:0 sc0 sc1
v_pk_fma_f32 v[64:65], v[64:65], v[104:105], v[104:105] op_sel:[0,0,1] op_sel_hi:[1,0,1]
v_pk_fma_f32 v[66:67], v[66:67], v[104:105], v[104:105] op_sel:[0,0,1] op_sel_hi:[1,0,1]
v_pk_fma_f32 v[68:69], v[68:69], v[104:105], v[104:105] op_sel:[0,0,1] op_sel_hi:[1,0,1]
v_pk_fma_f32 v[70:71], v[70:71], v[104:105], v[104:105] op_sel:[0,0,1] op_sel_hi:[1,0,1]
v_cvt_pk_bf16_f32 v32, v64, v65
v_cvt_pk_bf16_f32 v33, v66, v67
v_cvt_pk_bf16_f32 v34, v68, v69
v_cvt_pk_bf16_f32 v35, v70, v71
s_add_u32 s94, s53, 4096
buffer_store_dwordx4 v[32:35], v234, s[20:23], s94 offen offset:2048 sc0 sc1
v_accvgpr_read_b32 v72, a32
v_accvgpr_read_b32 v73, a33
v_accvgpr_read_b32 v74, a34
v_accvgpr_read_b32 v75, a35
v_accvgpr_read_b32 v76, a36
v_accvgpr_read_b32 v77, a37
v_accvgpr_read_b32 v78, a38
v_accvgpr_read_b32 v79, a39
v_accvgpr_read_b32 v80, a40
v_accvgpr_read_b32 v81, a41
v_accvgpr_read_b32 v82, a42
v_accvgpr_read_b32 v83, a43
v_accvgpr_read_b32 v84, a44
v_accvgpr_read_b32 v85, a45
v_accvgpr_read_b32 v86, a46
v_accvgpr_read_b32 v87, a47
v_accvgpr_read_b32 v88, a48
v_accvgpr_read_b32 v89, a49
v_accvgpr_read_b32 v90, a50
v_accvgpr_read_b32 v91, a51
v_accvgpr_read_b32 v92, a52
v_accvgpr_read_b32 v93, a53
v_accvgpr_read_b32 v94, a54
v_accvgpr_read_b32 v95, a55
v_accvgpr_read_b32 v96, a56
v_accvgpr_read_b32 v97, a57
v_accvgpr_read_b32 v98, a58
v_accvgpr_read_b32 v99, a59
v_accvgpr_read_b32 v100, a60
v_accvgpr_read_b32 v101, a61
v_accvgpr_read_b32 v102, a62
v_accvgpr_read_b32 v103, a63
v_pk_fma_f32 v[72:73], v[72:73], v[106:107], v[106:107] op_sel:[0,0,1] op_sel_hi:[1,0,1]
v_pk_fma_f32 v[74:75], v[74:75], v[106:107], v[106:107] op_sel:[0,0,1] op_sel_hi:[1,0,1]
v_pk_fma_f32 v[76:77], v[76:77], v[106:107], v[106:107] op_sel:[0,0,1] op_sel_hi:[1,0,1]
v_pk_fma_f32 v[78:79], v[78:79], v[106:107], v[106:107] op_sel:[0,0,1] op_sel_hi:[1,0,1]
v_cvt_pk_bf16_f32 v12, v72, v73
v_cvt_pk_bf16_f32 v13, v74, v75
v_cvt_pk_bf16_f32 v14, v76, v77
v_cvt_pk_bf16_f32 v15, v78, v79
s_add_u32 s94, s53, 0
buffer_store_dwordx4 v[12:15], v234, s[20:23], s94 offen offset:1024 sc0 sc1
v_pk_fma_f32 v[80:81], v[80:81], v[106:107], v[106:107] op_sel:[0,0,1] op_sel_hi:[1,0,1]
v_pk_fma_f32 v[82:83], v[82:83], v[106:107], v[106:107] op_sel:[0,0,1] op_sel_hi:[1,0,1]
v_pk_fma_f32 v[84:85], v[84:85], v[106:107], v[106:107] op_sel:[0,0,1] op_sel_hi:[1,0,1]
v_pk_fma_f32 v[86:87], v[86:87], v[106:107], v[106:107] op_sel:[0,0,1] op_sel_hi:[1,0,1]
v_cvt_pk_bf16_f32 v20, v80, v81
v_cvt_pk_bf16_f32 v21, v82, v83
v_cvt_pk_bf16_f32 v22, v84, v85
v_cvt_pk_bf16_f32 v23, v86, v87
s_add_u32 s94, s53, 0
buffer_store_dwordx4 v[20:23], v234, s[20:23], s94 offen offset:3072 sc0 sc1
v_pk_fma_f32 v[88:89], v[88:89], v[106:107], v[106:107] op_sel:[0,0,1] op_sel_hi:[1,0,1]
v_pk_fma_f32 v[90:91], v[90:91], v[106:107], v[106:107] op_sel:[0,0,1] op_sel_hi:[1,0,1]
v_pk_fma_f32 v[92:93], v[92:93], v[106:107], v[106:107] op_sel:[0,0,1] op_sel_hi:[1,0,1]
v_pk_fma_f32 v[94:95], v[94:95], v[106:107], v[106:107] op_sel:[0,0,1] op_sel_hi:[1,0,1]
v_cvt_pk_bf16_f32 v28, v88, v89
v_cvt_pk_bf16_f32 v29, v90, v91
v_cvt_pk_bf16_f32 v30, v92, v93
v_cvt_pk_bf16_f32 v31, v94, v95
s_add_u32 s94, s53, 4096
buffer_store_dwordx4 v[28:31], v234, s[20:23], s94 offen offset:1024 sc0 sc1
v_pk_fma_f32 v[96:97], v[96:97], v[106:107], v[106:107] op_sel:[0,0,1] op_sel_hi:[1,0,1]
v_pk_fma_f32 v[98:99], v[98:99], v[106:107], v[106:107] op_sel:[0,0,1] op_sel_hi:[1,0,1]
v_pk_fma_f32 v[100:101], v[100:101], v[106:107], v[106:107] op_sel:[0,0,1] op_sel_hi:[1,0,1]
v_pk_fma_f32 v[102:103], v[102:103], v[106:107], v[106:107] op_sel:[0,0,1] op_sel_hi:[1,0,1]
v_cvt_pk_bf16_f32 v36, v96, v97
v_cvt_pk_bf16_f32 v37, v98, v99
v_cvt_pk_bf16_f32 v38, v100, v101
v_cvt_pk_bf16_f32 v39, v102, v103
s_add_u32 s94, s53, 4096
buffer_store_dwordx4 v[36:39], v234, s[20:23], s94 offen offset:3072 sc0 sc1
s_waitcnt lgkmcnt(0)
v_or3_b32 v140, v140, v141, v142
v_or_b32 v140, v140, v143
s_nop 0
v_readfirstlane_b32 s46, v140
s_andn2_b32 s46, s46, s41
s_cbranch_scc1 K_FB
s_cmp_lg_u32 s83, 0
s_cbranch_scc1 K_YR1
K_YR1D:
v_accvgpr_read_b32 v120, a236
v_accvgpr_read_b32 v121, a237
v_accvgpr_read_b32 v122, a238
v_accvgpr_read_b32 v123, a239
v_accvgpr_read_b32 v124, a240
v_accvgpr_read_b32 v125, a241
v_accvgpr_read_b32 v126, a242
v_accvgpr_read_b32 v127, a243
v_accvgpr_read_b32 v128, a244
v_accvgpr_read_b32 v129, a245
v_accvgpr_read_b32 v130, a246
v_accvgpr_read_b32 v131, a247
v_xor_b32 v220, s82, v220
v_xor_b32 v221, s82, v221
v_xor_b32 v222, s82, v222
v_xor_b32 v223, s82, v223
v_xor_b32 v224, s82, v224
v_xor_b32 v225, s82, v225
v_xor_b32 v226, s82, v226
v_xor_b32 v227, s82, v227
v_bfe_u32 v5, v1, 2, 2
v_lshl_add_u32 v5, v4, 2, v5
v_bfe_u32 v6, v5, 1, 2
v_lshlrev_b32 v6, 5, v6
v_lshl_add_u32 v6, v5, 7, v6
v_and_b32 v5, 3, v1
v_lshl_add_u32 v216, v5, 3, v6
v_xor_b32 v217, 32, v216
v_xor_b32 v218, 64, v216
v_xor_b32 v219, 96, v216
ds_read_b64_tr_b16 a[192:193], v220 offset:32768
ds_read_b64_tr_b16 a[194:195], v220 offset:36864
ds_read_b64_tr_b16 a[196:197], v221 offset:32768
ds_read_b64_tr_b16 a[198:199], v221 offset:36864
ds_read_b64_tr_b16 a[200:201], v222 offset:32768
ds_read_b64_tr_b16 a[202:203], v222 offset:36864
ds_read_b64_tr_b16 a[204:205], v223 offset:32768
ds_read_b64_tr_b16 a[206:207], v223 offset:36864
ds_read_b64_tr_b16 a[208:209], v224 offset:32768
ds_read_b64_tr_b16 a[210:211], v224 offset:36864
ds_read_b64_tr_b16 a[212:213], v225 offset:32768
ds_read_b64_tr_b16 a[214:215], v225 offset:36864
ds_read_b64_tr_b16 a[216:217], v226 offset:32768
ds_read_b64_tr_b16 a[218:219], v226 offset:36864
ds_read_b64_tr_b16 a[220:221], v227 offset:32768
ds_read_b64_tr_b16 a[222:223], v227 offset:36864
ds_read_b64_tr_b16 a[224:225], v216 offset:0
ds_read_b64_tr_b16 a[226:227], v216 offset:2048
ds_read_b64_tr_b16 a[228:229], v217 offset:0
ds_read_b64_tr_b16 a[230:231], v217 offset:2048
ds_read_b64_tr_b16 a[232:233], v218 offset:0
ds_read_b64_tr_b16 a[234:235], v218 offset:2048
ds_read_b64_tr_b16 a[236:237], v219 offset:0
ds_read_b64_tr_b16 a[238:239], v219 offset:2048
v_accvgpr_read_b32 v112, a64
v_accvgpr_read_b32 v113, a65
v_accvgpr_read_b32 v114, a66
v_accvgpr_read_b32 v115, a67
v_accvgpr_read_b32 v116, a68
v_accvgpr_read_b32 v117, a69
v_accvgpr_read_b32 v118, a70
v_accvgpr_read_b32 v119, a71
v_pk_fma_f32 v[112:113], v[112:113], v[108:109], v[108:109] op_sel:[0,0,1] op_sel_hi:[1,0,1]
v_pk_fma_f32 v[114:115], v[114:115], v[108:109], v[108:109] op_sel:[0,0,1] op_sel_hi:[1,0,1]
v_pk_fma_f32 v[116:117], v[116:117], v[108:109], v[108:109] op_sel:[0,0,1] op_sel_hi:[1,0,1]
v_pk_fma_f32 v[118:119], v[118:119], v[108:109], v[108:109] op_sel:[0,0,1] op_sel_hi:[1,0,1]
v_cvt_pk_bf16_f32 v40, v112, v113
v_cvt_pk_bf16_f32 v41, v114, v115
v_cvt_pk_bf16_f32 v42, v116, v117
v_cvt_pk_bf16_f32 v43, v118, v119
v_accvgpr_read_b32 v112, a96
v_accvgpr_read_b32 v113, a97
v_accvgpr_read_b32 v114, a98
v_accvgpr_read_b32 v115, a99
v_accvgpr_read_b32 v116, a100
v_accvgpr_read_b32 v117, a101
v_accvgpr_read_b32 v118, a102
v_accvgpr_read_b32 v119, a103
v_pk_fma_f32 v[112:113], v[112:113], v[110:111], v[110:111] op_sel:[0,0,1] op_sel_hi:[1,0,1]
v_pk_fma_f32 v[114:115], v[114:115], v[110:111], v[110:111] op_sel:[0,0,1] op_sel_hi:[1,0,1]
v_pk_fma_f32 v[116:117], v[116:117], v[110:111], v[110:111] op_sel:[0,0,1] op_sel_hi:[1,0,1]
v_pk_fma_f32 v[118:119], v[118:119], v[110:111], v[110:111] op_sel:[0,0,1] op_sel_hi:[1,0,1]
v_cvt_pk_bf16_f32 v44, v112, v113
v_cvt_pk_bf16_f32 v45, v114, v115
v_cvt_pk_bf16_f32 v46, v116, v117
v_cvt_pk_bf16_f32 v47, v118, v119
v_accvgpr_read_b32 v112, a72
v_accvgpr_read_b32 v113, a73
v_accvgpr_read_b32 v114, a74
v_accvgpr_read_b32 v115, a75
v_accvgpr_read_b32 v116, a76
v_accvgpr_read_b32 v117, a77
v_accvgpr_read_b32 v118, a78
v_accvgpr_read_b32 v119, a79
v_pk_fma_f32 v[112:113], v[112:113], v[108:109], v[108:109] op_sel:[0,0,1] op_sel_hi:[1,0,1]
v_pk_fma_f32 v[114:115], v[114:115], v[108:109], v[108:109] op_sel:[0,0,1] op_sel_hi:[1,0,1]
v_pk_fma_f32 v[116:117], v[116:117], v[108:109], v[108:109] op_sel:[0,0,1] op_sel_hi:[1,0,1]
v_pk_fma_f32 v[118:119], v[118:119], v[108:109], v[108:109] op_sel:[0,0,1] op_sel_hi:[1,0,1]
v_cvt_pk_bf16_f32 v48, v112, v113
v_cvt_pk_bf16_f32 v49, v114, v115
v_cvt_pk_bf16_f32 v50, v116, v117
v_cvt_pk_bf16_f32 v51, v118, v119
v_accvgpr_read_b32 v112, a104
v_accvgpr_read_b32 v113, a105
v_accvgpr_read_b32 v114, a106
v_accvgpr_read_b32 v115, a107
v_accvgpr_read_b32 v116, a108
v_accvgpr_read_b32 v117, a109
v_accvgpr_read_b32 v118, a110
v_accvgpr_read_b32 v119, a111
v_pk_fma_f32 v[112:113], v[112:113], v[110:111], v[110:111] op_sel:[0,0,1] op_sel_hi:[1,0,1]
v_pk_fma_f32 v[114:115], v[114:115], v[110:111], v[110:111] op_sel:[0,0,1] op_sel_hi:[1,0,1]
v_pk_fma_f32 v[116:117], v[116:117], v[110:111], v[110:111] op_sel:[0,0,1] op_sel_hi:[1,0,1]
v_pk_fma_f32 v[118:119], v[118:119], v[110:111], v[110:111] op_sel:[0,0,1] op_sel_hi:[1,0,1]
v_cvt_pk_bf16_f32 v52, v112, v113
v_cvt_pk_bf16_f32 v53, v114, v115
v_cvt_pk_bf16_f32 v54, v116, v117
v_cvt_pk_bf16_f32 v55, v118, v119
v_accvgpr_read_b32 v112, a80
v_accvgpr_read_b32 v113, a81
v_accvgpr_read_b32 v114, a82
v_accvgpr_read_b32 v115, a83
v_accvgpr_read_b32 v116, a84
v_accvgpr_read_b32 v117, a85
v_accvgpr_read_b32 v118, a86
v_accvgpr_read_b32 v119, a87
v_pk_fma_f32 v[112:113], v[112:113], v[108:109], v[108:109] op_sel:[0,0,1] op_sel_hi:[1,0,1]
v_pk_fma_f32 v[114:115], v[114:115], v[108:109], v[108:109] op_sel:[0,0,1] op_sel_hi:[1,0,1]
v_pk_fma_f32 v[116:117], v[116:117], v[108:109], v[108:109] op_sel:[0,0,1] op_sel_hi:[1,0,1]
v_pk_fma_f32 v[118:119], v[118:119], v[108:109], v[108:109] op_sel:[0,0,1] op_sel_hi:[1,0,1]
v_cvt_pk_bf16_f32 v56, v112, v113
v_cvt_pk_bf16_f32 v57, v114, v115
v_cvt_pk_bf16_f32 v58, v116, v117
v_cvt_pk_bf16_f32 v59, v118, v119
v_accvgpr_read_b32 v112, a112
v_accvgpr_read_b32 v113, a113
v_accvgpr_read_b32 v114, a114
v_accvgpr_read_b32 v115, a115
v_accvgpr_read_b32 v116, a116
v_accvgpr_read_b32 v117, a117
v_accvgpr_read_b32 v118, a118
v_accvgpr_read_b32 v119, a119
v_pk_fma_f32 v[112:113], v[112:113], v[110:111], v[110:111] op_sel:[0,0,1] op_sel_hi:[1,0,1]
v_pk_fma_f32 v[114:115], v[114:115], v[110:111], v[110:111] op_sel:[0,0,1] op_sel_hi:[1,0,1]
v_pk_fma_f32 v[116:117], v[116:117], v[110:111], v[110:111] op_sel:[0,0,1] op_sel_hi:[1,0,1]
v_pk_fma_f32 v[118:119], v[118:119], v[110:111], v[110:111] op_sel:[0,0,1] op_sel_hi:[1,0,1]
v_cvt_pk_bf16_f32 v60, v112, v113
v_cvt_pk_bf16_f32 v61, v114, v115
v_cvt_pk_bf16_f32 v62, v116, v117
v_cvt_pk_bf16_f32 v63, v118, v119
v_accvgpr_read_b32 v112, a88
v_accvgpr_read_b32 v113, a89
v_accvgpr_read_b32 v114, a90
v_accvgpr_read_b32 v115, a91
v_accvgpr_read_b32 v116, a92
v_accvgpr_read_b32 v117, a93
v_accvgpr_read_b32 v118, a94
v_accvgpr_read_b32 v119, a95
v_pk_fma_f32 v[112:113], v[112:113], v[108:109], v[108:109] op_sel:[0,0,1] op_sel_hi:[1,0,1]
v_pk_fma_f32 v[114:115], v[114:115], v[108:109], v[108:109] op_sel:[0,0,1] op_sel_hi:[1,0,1]
v_pk_fma_f32 v[116:117], v[116:117], v[108:109], v[108:109] op_sel:[0,0,1] op_sel_hi:[1,0,1]
v_pk_fma_f32 v[118:119], v[118:119], v[108:109], v[108:109] op_sel:[0,0,1] op_sel_hi:[1,0,1]
v_cvt_pk_bf16_f32 v64, v112, v113
v_cvt_pk_bf16_f32 v65, v114, v115
v_cvt_pk_bf16_f32 v66, v116, v117
v_cvt_pk_bf16_f32 v67, v118, v119
v_accvgpr_read_b32 v112, a120
v_accvgpr_read_b32 v113, a121
v_accvgpr_read_b32 v114, a122
v_accvgpr_read_b32 v115, a123
v_accvgpr_read_b32 v116, a124
v_accvgpr_read_b32 v117, a125
v_accvgpr_read_b32 v118, a126
v_accvgpr_read_b32 v119, a127
v_pk_fma_f32 v[112:113], v[112:113], v[110:111], v[110:111] op_sel:[0,0,1] op_sel_hi:[1,0,1]
v_pk_fma_f32 v[114:115], v[114:115], v[110:111], v[110:111] op_sel:[0,0,1] op_sel_hi:[1,0,1]
v_pk_fma_f32 v[116:117], v[116:117], v[110:111], v[110:111] op_sel:[0,0,1] op_sel_hi:[1,0,1]
v_pk_fma_f32 v[118:119], v[118:119], v[110:111], v[110:111] op_sel:[0,0,1] op_sel_hi:[1,0,1]
v_cvt_pk_bf16_f32 v68, v112, v113
v_cvt_pk_bf16_f32 v69, v114, v115
v_cvt_pk_bf16_f32 v70, v116, v117
v_cvt_pk_bf16_f32 v71, v118, v119
s_lshl_b32 s95, s36, 3
v_mov_b32 v5, 1
v_and_b32 v6, 7, v1
s_add_u32 s95, s95, s54
v_lshlrev_b32 v6, 2, v6
v_lshlrev_b32 v250, 3, v1
s_waitcnt lgkmcnt(15)
v_mfma_f32_16x16x32_bf16 v[136:139], a[192:195], v[8:11], 0
s_add_u32 s67, s36, 1
v_add_u32 v208, 0x10000, v220
v_add_u32 v209, 0x10000, v221
v_mfma_f32_16x16x32_bf16 v[168:171], a[192:195], v[12:15], 0
s_and_b32 s67, s67, 3
ds_read_b64_tr_b16 a[192:193], v220 offset:40960
ds_read_b64_tr_b16 a[194:195], v220 offset:45056
v_mfma_f32_16x16x32_bf16 v[140:143], a[196:199], v[8:11], 0
s_sub_u32 s67, s67, s36
v_add_u32 v210, 0x10000, v222
v_add_u32 v211, 0x10000, v223
v_mfma_f32_16x16x32_bf16 v[172:175], a[196:199], v[12:15], 0
s_lshl_b32 s67, s67, 16
ds_read_b64_tr_b16 a[196:197], v221 offset:40960
ds_read_b64_tr_b16 a[198:199], v221 offset:45056
v_mfma_f32_16x16x32_bf16 v[144:147], a[200:203], v[8:11], 0
s_add_u32 s90, s53, s67
v_add_u32 v212, 0x10000, v224
v_add_u32 v213, 0x10000, v225
v_mfma_f32_16x16x32_bf16 v[176:179], a[200:203], v[12:15], 0
s_add_u32 s67, s36, 2
ds_read_b64_tr_b16 a[200:201], v222 offset:40960
ds_read_b64_tr_b16 a[202:203], v222 offset:45056
v_mfma_f32_16x16x32_bf16 v[148:151], a[204:207], v[8:11], 0
s_add_u32 m0, s3, 77824
v_add_u32 v214, 0x10000, v226
v_add_u32 v215, 0x10000, v227
v_mfma_f32_16x16x32_bf16 v[180:183], a[204:207], v[12:15], 0
s_waitcnt lgkmcnt(15)
s_add_u32 s48, s43, 55296
ds_read_b64_tr_b16 a[204:205], v223 offset:40960
ds_read_b64_tr_b16 a[206:207], v223 offset:45056
v_mfma_f32_16x16x32_bf16 v[152:155], a[208:211], v[8:11], 0
s_and_b32 s67, s67, 3
buffer_load_dwordx4 v236, s[16:19], s48 offen lds
v_mfma_f32_16x16x32_bf16 v[184:187], a[208:211], v[12:15], 0
s_sub_u32 s67, s67, s36
ds_read_b64_tr_b16 a[208:209], v224 offset:40960
ds_read_b64_tr_b16 a[210:211], v224 offset:45056
v_mfma_f32_16x16x32_bf16 v[156:159], a[212:215], v[8:11], 0
s_add_u32 m0, s3, 81920
v_subrev_u32 v200, 0x10000, v220
v_subrev_u32 v201, 0x10000, v221
v_mfma_f32_16x16x32_bf16 v[188:191], a[212:215], v[12:15], 0
s_add_u32 s48, s43, 73728
ds_read_b64_tr_b16 a[212:213], v225 offset:40960
ds_read_b64_tr_b16 a[214:215], v225 offset:45056
v_mfma_f32_16x16x32_bf16 v[160:163], a[216:219], v[8:11], 0
s_lshl_b32 s67, s67, 16
buffer_load_dwordx4 v236, s[16:19], s48 offen lds
v_mfma_f32_16x16x32_bf16 v[192:195], a[216:219], v[12:15], 0
s_waitcnt lgkmcnt(8)
s_add_u32 s91, s53, s67
ds_read_b64_tr_b16 a[216:217], v226 offset:40960
ds_read_b64_tr_b16 a[218:219], v226 offset:45056
v_mfma_f32_16x16x32_bf16 v[164:167], a[220:223], v[8:11], 0
s_add_u32 m0, s3, 86016
v_subrev_u32 v202, 0x10000, v222
v_subrev_u32 v203, 0x10000, v223
v_mfma_f32_16x16x32_bf16 v[196:199], a[220:223], v[12:15], 0
s_add_u32 s48, s43, 92160
ds_read_b64_tr_b16 a[220:221], v227 offset:40960
ds_read_b64_tr_b16 a[222:223], v227 offset:45056
v_mfma_f32_16x16x32_bf16 v[72:75], a[224:227], v[8:11], 0
s_add_u32 s67, s36, 3
buffer_load_dwordx4 v236, s[16:19], s48 offen lds
v_mfma_f32_16x16x32_bf16 v[88:91], a[224:227], v[12:15], 0
s_and_b32 s67, s67, 3
ds_read_b64_tr_b16 a[224:225], v216 offset:4096
ds_read_b64_tr_b16 a[226:227], v216 offset:6144
v_mfma_f32_16x16x32_bf16 v[76:79], a[228:231], v[8:11], 0
s_add_u32 m0, s3, 90112
v_subrev_u32 v204, 0x10000, v224
v_subrev_u32 v205, 0x10000, v225
v_mfma_f32_16x16x32_bf16 v[92:95], a[228:231], v[12:15], 0
s_add_u32 s48, s43, 110592
ds_read_b64_tr_b16 a[228:229], v217 offset:4096
ds_read_b64_tr_b16 a[230:231], v217 offset:6144
v_mfma_f32_16x16x32_bf16 v[80:83], a[232:235], v[8:11], 0
s_sub_u32 s67, s67, s36
buffer_load_dwordx4 v236, s[16:19], s48 offen lds
v_mfma_f32_16x16x32_bf16 v[96:99], a[232:235], v[12:15], 0
ds_read_b64_tr_b16 a[232:233], v218 offset:4096
ds_read_b64_tr_b16 a[234:235], v218 offset:6144
v_mfma_f32_16x16x32_bf16 v[84:87], a[236:239], v[8:11], 0
v_subrev_u32 v206, 0x10000, v226
v_mfma_f32_16x16x32_bf16 v[100:103], a[236:239], v[12:15], 0
ds_read_b64_tr_b16 a[236:237], v219 offset:4096
ds_read_b64_tr_b16 a[238:239], v219 offset:6144
s_waitcnt vmcnt(4)
s_mov_b64 exec, 1
buffer_store_dword v5, v234, s[20:23], s95 offen offset:0 sc0 sc1
s_mov_b64 exec, -1
v_mfma_f32_16x16x32_bf16 v[136:139], a[192:195], v[16:19], v[136:139]
s_add_u32 m0, s3, 94208
v_subrev_u32 v207, 0x10000, v227
v_mfma_f32_16x16x32_bf16 v[168:171], a[192:195], v[20:23], v[168:171]
s_add_u32 s48, s43, 129024
ds_read_b64_tr_b16 a[192:193], v220 offset:49152
ds_read_b64_tr_b16 a[194:195], v220 offset:53248
v_mfma_f32_16x16x32_bf16 v[140:143], a[196:199], v[16:19], v[140:143]
s_lshl_b32 s67, s67, 16
buffer_load_dwordx4 v236, s[16:19], s48 offen lds
v_mfma_f32_16x16x32_bf16 v[172:175], a[196:199], v[20:23], v[172:175]
s_waitcnt lgkmcnt(8)
s_add_u32 s92, s53, s67
ds_read_b64_tr_b16 a[196:197], v221 offset:49152
ds_read_b64_tr_b16 a[198:199], v221 offset:53248
v_mfma_f32_16x16x32_bf16 v[144:147], a[200:203], v[16:19], v[144:147]
s_lshl_b32 s67, s34, 2
v_mfma_f32_16x16x32_bf16 v[176:179], a[200:203], v[20:23], v[176:179]
s_add_u32 s94, s53, 8192
ds_read_b64_tr_b16 a[200:201], v222 offset:49152
ds_read_b64_tr_b16 a[202:203], v222 offset:53248
v_mfma_f32_16x16x32_bf16 v[148:151], a[204:207], v[16:19], v[148:151]
s_add_u32 s67, s67, s32
buffer_store_dwordx4 v[40:43], v234, s[20:23], s94 offen offset:0 sc0 sc1
v_mfma_f32_16x16x32_bf16 v[180:183], a[204:207], v[20:23], v[180:183]
s_lshl_b32 s86, s67, 7
ds_read_b64_tr_b16 a[204:205], v223 offset:49152
ds_read_b64_tr_b16 a[206:207], v223 offset:53248
v_mfma_f32_16x16x32_bf16 v[152:155], a[208:211], v[16:19], v[152:155]
s_add_u32 s86, s86, 0x260000
v_mfma_f32_16x16x32_bf16 v[184:187], a[208:211], v[20:23], v[184:187]
s_lshl_b32 s67, s67, 1
ds_read_b64_tr_b16 a[208:209], v224 offset:49152
ds_read_b64_tr_b16 a[210:211], v224 offset:53248
v_mfma_f32_16x16x32_bf16 v[156:159], a[212:215], v[16:19], v[156:159]
s_lshr_b32 s47, s35, 1
v_mfma_f32_16x16x32_bf16 v[188:191], a[212:215], v[20:23], v[188:191]
s_add_u32 s67, s67, s47
ds_read_b64_tr_b16 a[212:213], v225 offset:49152
ds_read_b64_tr_b16 a[214:215], v225 offset:53248
v_mfma_f32_16x16x32_bf16 v[160:163], a[216:219], v[16:19], v[160:163]
s_lshl_b32 s87, s67, 15
v_mfma_f32_16x16x32_bf16 v[192:195], a[216:219], v[20:23], v[192:195]
s_add_u32 s87, s87, 0x2000000
ds_read_b64_tr_b16 a[216:217], v226 offset:49152
ds_read_b64_tr_b16 a[218:219], v226 offset:53248
v_mfma_f32_16x16x32_bf16 v[164:167], a[220:223], v[16:19], v[164:167]
s_lshl_b32 s67, s33, 9
v_mfma_f32_16x16x32_bf16 v[196:199], a[220:223], v[20:23], v[196:199]
s_add_u32 s88, s87, s67
ds_read_b64_tr_b16 a[220:221], v227 offset:49152
ds_read_b64_tr_b16 a[222:223], v227 offset:53248
v_mfma_f32_16x16x32_bf16 v[72:75], a[224:227], v[16:19], v[72:75]
s_xor_b32 s89, s88, 0x8000
v_mfma_f32_16x16x32_bf16 v[88:91], a[224:227], v[20:23], v[88:91]
s_waitcnt lgkmcnt(8)
s_add_u32 s94, s53, 8192
ds_read_b64_tr_b16 a[224:225], v216 offset:8192
ds_read_b64_tr_b16 a[226:227], v216 offset:10240
v_mfma_f32_16x16x32_bf16 v[76:79], a[228:231], v[16:19], v[76:79]
s_lshl_b32 s47, s34, 2
buffer_store_dwordx4 v[44:47], v234, s[20:23], s94 offen offset:1024 sc0 sc1
v_mfma_f32_16x16x32_bf16 v[92:95], a[228:231], v[20:23], v[92:95]
s_add_u32 s47, s47, s36
ds_read_b64_tr_b16 a[228:229], v217 offset:8192
ds_read_b64_tr_b16 a[230:231], v217 offset:10240
v_mfma_f32_16x16x32_bf16 v[80:83], a[232:235], v[16:19], v[80:83]
s_lshl_b32 s63, s47, 2
v_mfma_f32_16x16x32_bf16 v[96:99], a[232:235], v[20:23], v[96:99]
ds_read_b64_tr_b16 a[232:233], v218 offset:8192
ds_read_b64_tr_b16 a[234:235], v218 offset:10240
v_mfma_f32_16x16x32_bf16 v[84:87], a[236:239], v[16:19], v[84:87]
v_mfma_f32_16x16x32_bf16 v[100:103], a[236:239], v[20:23], v[100:103]
ds_read_b64_tr_b16 a[236:237], v219 offset:8192
ds_read_b64_tr_b16 a[238:239], v219 offset:10240
v_mfma_f32_16x16x32_bf16 v[136:139], a[192:195], v[24:27], v[136:139]
s_add_u32 s63, s63, s32
v_mfma_f32_16x16x32_bf16 v[168:171], a[192:195], v[28:31], v[168:171]
s_lshl_b32 s63, s63, 9
ds_read_b64_tr_b16 a[192:193], v220 offset:57344
ds_read_b64_tr_b16 a[194:195], v220 offset:61440
v_mfma_f32_16x16x32_bf16 v[140:143], a[196:199], v[24:27], v[140:143]
s_add_u32 s63, s63, 0x280000
v_mfma_f32_16x16x32_bf16 v[172:175], a[196:199], v[28:31], v[172:175]
s_lshl_b32 s47, s47, 6
ds_read_b64_tr_b16 a[196:197], v221 offset:57344
ds_read_b64_tr_b16 a[198:199], v221 offset:61440
v_mfma_f32_16x16x32_bf16 v[144:147], a[200:203], v[24:27], v[144:147]
s_add_u32 s47, s47, s32
v_mfma_f32_16x16x32_bf16 v[176:179], a[200:203], v[28:31], v[176:179]
s_add_u32 s94, s53, 8192
ds_read_b64_tr_b16 a[200:201], v222 offset:57344
ds_read_b64_tr_b16 a[202:203], v222 offset:61440
v_mfma_f32_16x16x32_bf16 v[148:151], a[204:207], v[24:27], v[148:151]
s_lshl_b32 s47, s47, 11
buffer_store_dwordx4 v[48:51], v234, s[20:23], s94 offen offset:2048 sc0 sc1
v_mfma_f32_16x16x32_bf16 v[180:183], a[204:207], v[28:31], v[180:183]
s_waitcnt lgkmcnt(8)
s_mul_i32 s67, s35, 40960
ds_read_b64_tr_b16 a[204:205], v223 offset:57344
ds_read_b64_tr_b16 a[206:207], v223 offset:61440
v_mfma_f32_16x16x32_bf16 v[152:155], a[208:211], v[24:27], v[152:155]
s_add_u32 s67, s67, s47
v_mfma_f32_16x16x32_bf16 v[184:187], a[208:211], v[28:31], v[184:187]
s_add_u32 s67, s67, 0x1400000
ds_read_b64_tr_b16 a[208:209], v224 offset:57344
ds_read_b64_tr_b16 a[210:211], v224 offset:61440
v_mfma_f32_16x16x32_bf16 v[156:159], a[212:215], v[24:27], v[156:159]
s_mov_b32 s57, 0xbfb8aa3b
v_mfma_f32_16x16x32_bf16 v[188:191], a[212:215], v[28:31], v[188:191]
s_mov_b32 s56, 0xffff0000
ds_read_b64_tr_b16 a[212:213], v225 offset:57344
ds_read_b64_tr_b16 a[214:215], v225 offset:61440
v_mfma_f32_16x16x32_bf16 v[160:163], a[216:219], v[24:27], v[160:163]
s_mov_b32 s58, 0x00003f80
v_mfma_f32_16x16x32_bf16 v[192:195], a[216:219], v[28:31], v[192:195]
s_mov_b32 s59, 0x3f800000
ds_read_b64_tr_b16 a[216:217], v226 offset:57344
ds_read_b64_tr_b16 a[218:219], v226 offset:61440
v_mfma_f32_16x16x32_bf16 v[164:167], a[220:223], v[24:27], v[164:167]
s_lshl_b32 s47, s36, 13
v_mfma_f32_16x16x32_bf16 v[196:199], a[220:223], v[28:31], v[196:199]
s_add_u32 s87, s87, s47
ds_read_b64_tr_b16 a[220:221], v227 offset:57344
ds_read_b64_tr_b16 a[222:223], v227 offset:61440
v_mfma_f32_16x16x32_bf16 v[72:75], a[224:227], v[24:27], v[72:75]
s_mov_b32 s38, 15
v_mfma_f32_16x16x32_bf16 v[88:91], a[224:227], v[28:31], v[88:91]
s_add_u32 s94, s53, 8192
ds_read_b64_tr_b16 a[224:225], v216 offset:12288
ds_read_b64_tr_b16 a[226:227], v216 offset:14336
v_mfma_f32_16x16x32_bf16 v[76:79], a[228:231], v[24:27], v[76:79]
s_bitset0_b32 s38, s35
buffer_store_dwordx4 v[52:55], v234, s[20:23], s94 offen offset:3072 sc0 sc1
v_mfma_f32_16x16x32_bf16 v[92:95], a[228:231], v[28:31], v[92:95]
s_xor_b32 s60, s67, 8192
ds_read_b64_tr_b16 a[228:229], v217 offset:12288
ds_read_b64_tr_b16 a[230:231], v217 offset:14336
v_mfma_f32_16x16x32_bf16 v[80:83], a[232:235], v[24:27], v[80:83]
s_xor_b32 s64, s67, 32768
v_mfma_f32_16x16x32_bf16 v[96:99], a[232:235], v[28:31], v[96:99]
s_waitcnt lgkmcnt(8)
ds_read_b64_tr_b16 a[232:233], v218 offset:12288
ds_read_b64_tr_b16 a[234:235], v218 offset:14336
v_mfma_f32_16x16x32_bf16 v[84:87], a[236:239], v[24:27], v[84:87]
v_mfma_f32_16x16x32_bf16 v[100:103], a[236:239], v[28:31], v[100:103]
ds_read_b64_tr_b16 a[236:237], v219 offset:12288
ds_read_b64_tr_b16 a[238:239], v219 offset:14336
v_mfma_f32_16x16x32_bf16 v[136:139], a[192:195], v[32:35], v[136:139]
v_mfma_f32_16x16x32_bf16 v[168:171], a[192:195], v[36:39], v[168:171]
v_mfma_f32_16x16x32_bf16 v[140:143], a[196:199], v[32:35], v[140:143]
v_mfma_f32_16x16x32_bf16 v[172:175], a[196:199], v[36:39], v[172:175]
v_mfma_f32_16x16x32_bf16 v[144:147], a[200:203], v[32:35], v[144:147]
s_waitcnt lgkmcnt(0)
s_barrier
v_mfma_f32_16x16x32_bf16 v[176:179], a[200:203], v[36:39], v[176:179]
s_xor_b32 s61, s67, 16384
ds_read_b64_tr_b16 a[192:193], v208 offset:0
ds_read_b64_tr_b16 a[194:195], v208 offset:4096
v_mfma_f32_16x16x32_bf16 v[148:151], a[204:207], v[32:35], v[148:151]
s_add_u32 s94, s53, 12288
ds_read_b64_tr_b16 a[196:197], v209 offset:0
ds_read_b64_tr_b16 a[198:199], v209 offset:4096
v_mfma_f32_16x16x32_bf16 v[180:183], a[204:207], v[36:39], v[180:183]
s_xor_b32 s65, s67, 65536
buffer_store_dwordx4 v[56:59], v234, s[20:23], s94 offen offset:0 sc0 sc1
v_mfma_f32_16x16x32_bf16 v[152:155], a[208:211], v[32:35], v[152:155]
s_xor_b32 s62, s67, 24576
ds_read_b64_tr_b16 a[200:201], v210 offset:0
ds_read_b64_tr_b16 a[202:203], v210 offset:4096
v_mfma_f32_16x16x32_bf16 v[184:187], a[208:211], v[36:39], v[184:187]
s_xor_b32 s66, s67, 98304
ds_read_b64_tr_b16 a[204:205], v211 offset:0
ds_read_b64_tr_b16 a[206:207], v211 offset:4096
v_mfma_f32_16x16x32_bf16 v[156:159], a[212:215], v[32:35], v[156:159]
ds_read_b64_tr_b16 a[208:209], v212 offset:0
ds_read_b64_tr_b16 a[210:211], v212 offset:4096
v_mfma_f32_16x16x32_bf16 v[188:191], a[212:215], v[36:39], v[188:191]
ds_read_b64_tr_b16 a[212:213], v213 offset:0
ds_read_b64_tr_b16 a[214:215], v213 offset:4096
v_mfma_f32_16x16x32_bf16 v[160:163], a[216:219], v[32:35], v[160:163]
v_mfma_f32_16x16x32_bf16 v[192:195], a[216:219], v[36:39], v[192:195]
ds_read_b64_tr_b16 a[216:217], v214 offset:0
ds_read_b64_tr_b16 a[218:219], v214 offset:4096
v_mfma_f32_16x16x32_bf16 v[164:167], a[220:223], v[32:35], v[164:167]
v_mfma_f32_16x16x32_bf16 v[196:199], a[220:223], v[36:39], v[196:199]
ds_read_b64_tr_b16 a[220:221], v215 offset:0
ds_read_b64_tr_b16 a[222:223], v215 offset:4096
v_mfma_f32_16x16x32_bf16 v[72:75], a[224:227], v[32:35], v[72:75]
v_mfma_f32_16x16x32_bf16 v[88:91], a[224:227], v[36:39], v[88:91]
ds_read_b64_tr_b16 a[224:225], v216 offset:16384
ds_read_b64_tr_b16 a[226:227], v216 offset:18432
v_mfma_f32_16x16x32_bf16 v[76:79], a[228:231], v[32:35], v[76:79]
s_add_u32 s94, s53, 12288
v_mfma_f32_16x16x32_bf16 v[92:95], a[228:231], v[36:39], v[92:95]
buffer_store_dwordx4 v[60:63], v234, s[20:23], s94 offen offset:1024 sc0 sc1
v_mfma_f32_16x16x32_bf16 v[80:83], a[232:235], v[32:35], v[80:83]
ds_read_b64_tr_b16 a[228:229], v217 offset:16384
ds_read_b64_tr_b16 a[230:231], v217 offset:18432
v_mfma_f32_16x16x32_bf16 v[96:99], a[232:235], v[36:39], v[96:99]
ds_read_b64_tr_b16 a[232:233], v218 offset:16384
ds_read_b64_tr_b16 a[234:235], v218 offset:18432
v_mfma_f32_16x16x32_bf16 v[84:87], a[236:239], v[32:35], v[84:87]
v_mfma_f32_16x16x32_bf16 v[100:103], a[236:239], v[36:39], v[100:103]
s_waitcnt lgkmcnt(8)
ds_read_b64_tr_b16 a[236:237], v219 offset:16384
ds_read_b64_tr_b16 a[238:239], v219 offset:18432
buffer_load_dword v246, v6, s[20:23], s54 offen sc0 sc1
v_mfma_f32_16x16x32_bf16 v[136:139], a[192:195], v[40:43], v[136:139]
v_mfma_f32_16x16x32_bf16 v[168:171], a[192:195], v[44:47], v[168:171]
ds_read_b64_tr_b16 a[192:193], v208 offset:8192
ds_read_b64_tr_b16 a[194:195], v208 offset:12288
v_mfma_f32_16x16x32_bf16 v[140:143], a[196:199], v[40:43], v[140:143]
v_mfma_f32_16x16x32_bf16 v[172:175], a[196:199], v[44:47], v[172:175]
ds_read_b64_tr_b16 a[196:197], v209 offset:8192
ds_read_b64_tr_b16 a[198:199], v209 offset:12288
v_mfma_f32_16x16x32_bf16 v[144:147], a[200:203], v[40:43], v[144:147]
v_mfma_f32_16x16x32_bf16 v[176:179], a[200:203], v[44:47], v[176:179]
ds_read_b64_tr_b16 a[200:201], v210 offset:8192
ds_read_b64_tr_b16 a[202:203], v210 offset:12288
v_mfma_f32_16x16x32_bf16 v[148:151], a[204:207], v[40:43], v[148:151]
s_add_u32 s94, s53, 12288
v_mfma_f32_16x16x32_bf16 v[180:183], a[204:207], v[44:47], v[180:183]
buffer_store_dwordx4 v[64:67], v234, s[20:23], s94 offen offset:2048 sc0 sc1
v_mfma_f32_16x16x32_bf16 v[152:155], a[208:211], v[40:43], v[152:155]
ds_read_b64_tr_b16 a[204:205], v211 offset:8192
ds_read_b64_tr_b16 a[206:207], v211 offset:12288
v_mfma_f32_16x16x32_bf16 v[184:187], a[208:211], v[44:47], v[184:187]
ds_read_b64_tr_b16 a[208:209], v212 offset:8192
ds_read_b64_tr_b16 a[210:211], v212 offset:12288
v_mfma_f32_16x16x32_bf16 v[156:159], a[212:215], v[40:43], v[156:159]
v_mfma_f32_16x16x32_bf16 v[188:191], a[212:215], v[44:47], v[188:191]
ds_read_b64_tr_b16 a[212:213], v213 offset:8192
ds_read_b64_tr_b16 a[214:215], v213 offset:12288
v_mfma_f32_16x16x32_bf16 v[160:163], a[216:219], v[40:43], v[160:163]
v_mfma_f32_16x16x32_bf16 v[192:195], a[216:219], v[44:47], v[192:195]
s_waitcnt lgkmcnt(8)
ds_read_b64_tr_b16 a[216:217], v214 offset:8192
ds_read_b64_tr_b16 a[218:219], v214 offset:12288
v_mfma_f32_16x16x32_bf16 v[164:167], a[220:223], v[40:43], v[164:167]
v_mfma_f32_16x16x32_bf16 v[196:199], a[220:223], v[44:47], v[196:199]
ds_read_b64_tr_b16 a[220:221], v215 offset:8192
ds_read_b64_tr_b16 a[222:223], v215 offset:12288
v_mfma_f32_16x16x32_bf16 v[72:75], a[224:227], v[40:43], v[72:75]
v_mfma_f32_16x16x32_bf16 v[88:91], a[224:227], v[44:47], v[88:91]
ds_read_b64_tr_b16 a[224:225], v216 offset:20480
ds_read_b64_tr_b16 a[226:227], v216 offset:22528
v_mfma_f32_16x16x32_bf16 v[76:79], a[228:231], v[40:43], v[76:79]
s_add_u32 s94, s53, 12288
v_mfma_f32_16x16x32_bf16 v[92:95], a[228:231], v[44:47], v[92:95]
buffer_store_dwordx4 v[68:71], v234, s[20:23], s94 offen offset:3072 sc0 sc1
v_mfma_f32_16x16x32_bf16 v[80:83], a[232:235], v[40:43], v[80:83]
ds_read_b64_tr_b16 a[228:229], v217 offset:20480
ds_read_b64_tr_b16 a[230:231], v217 offset:22528
v_mfma_f32_16x16x32_bf16 v[96:99], a[232:235], v[44:47], v[96:99]
ds_read_b64_tr_b16 a[232:233], v218 offset:20480
ds_read_b64_tr_b16 a[234:235], v218 offset:22528
v_mfma_f32_16x16x32_bf16 v[84:87], a[236:239], v[40:43], v[84:87]
v_mfma_f32_16x16x32_bf16 v[100:103], a[236:239], v[44:47], v[100:103]
ds_read_b64_tr_b16 a[236:237], v219 offset:20480
ds_read_b64_tr_b16 a[238:239], v219 offset:22528
v_mfma_f32_16x16x32_bf16 v[136:139], a[192:195], v[48:51], v[136:139]
v_mfma_f32_16x16x32_bf16 v[168:171], a[192:195], v[52:55], v[168:171]
ds_read_b64_tr_b16 a[192:193], v208 offset:16384
ds_read_b64_tr_b16 a[194:195], v208 offset:20480
v_mfma_f32_16x16x32_bf16 v[140:143], a[196:199], v[48:51], v[140:143]
v_mfma_f32_16x16x32_bf16 v[172:175], a[196:199], v[52:55], v[172:175]
s_waitcnt lgkmcnt(8)
ds_read_b64_tr_b16 a[196:197], v209 offset:16384
ds_read_b64_tr_b16 a[198:199], v209 offset:20480
v_mfma_f32_16x16x32_bf16 v[144:147], a[200:203], v[48:51], v[144:147]
v_mfma_f32_16x16x32_bf16 v[176:179], a[200:203], v[52:55], v[176:179]
s_add_u32 m0, s3, 98304
ds_read_b64_tr_b16 a[200:201], v210 offset:16384
ds_read_b64_tr_b16 a[202:203], v210 offset:20480
v_mfma_f32_16x16x32_bf16 v[148:151], a[204:207], v[48:51], v[148:151]
s_add_u32 s48, s44, 0
v_mfma_f32_16x16x32_bf16 v[180:183], a[204:207], v[52:55], v[180:183]
buffer_load_dwordx4 v236, s[16:19], s48 offen lds
v_mfma_f32_16x16x32_bf16 v[152:155], a[208:211], v[48:51], v[152:155]
ds_read_b64_tr_b16 a[204:205], v211 offset:16384
ds_read_b64_tr_b16 a[206:207], v211 offset:20480
v_mfma_f32_16x16x32_bf16 v[184:187], a[208:211], v[52:55], v[184:187]
s_add_u32 m0, s3, 102400
ds_read_b64_tr_b16 a[208:209], v212 offset:16384
ds_read_b64_tr_b16 a[210:211], v212 offset:20480
v_mfma_f32_16x16x32_bf16 v[156:159], a[212:215], v[48:51], v[156:159]
s_add_u32 s48, s44, 18432
v_mfma_f32_16x16x32_bf16 v[188:191], a[212:215], v[52:55], v[188:191]
buffer_load_dwordx4 v236, s[16:19], s48 offen lds
v_mfma_f32_16x16x32_bf16 v[160:163], a[216:219], v[48:51], v[160:163]
ds_read_b64_tr_b16 a[212:213], v213 offset:16384
ds_read_b64_tr_b16 a[214:215], v213 offset:20480
v_mfma_f32_16x16x32_bf16 v[192:195], a[216:219], v[52:55], v[192:195]
s_add_u32 m0, s3, 106496
ds_read_b64_tr_b16 a[216:217], v214 offset:16384
ds_read_b64_tr_b16 a[218:219], v214 offset:20480
v_mfma_f32_16x16x32_bf16 v[164:167], a[220:223], v[48:51], v[164:167]
s_add_u32 s48, s44, 36864
v_mfma_f32_16x16x32_bf16 v[196:199], a[220:223], v[52:55], v[196:199]
buffer_load_dwordx4 v236, s[16:19], s48 offen lds
v_mfma_f32_16x16x32_bf16 v[72:75], a[224:227], v[48:51], v[72:75]
s_waitcnt lgkmcnt(8)
ds_read_b64_tr_b16 a[220:221], v215 offset:16384
ds_read_b64_tr_b16 a[222:223], v215 offset:20480
v_mfma_f32_16x16x32_bf16 v[88:91], a[224:227], v[52:55], v[88:91]
s_add_u32 m0, s3, 110592
ds_read_b64_tr_b16 a[224:225], v216 offset:24576
ds_read_b64_tr_b16 a[226:227], v216 offset:26624
v_mfma_f32_16x16x32_bf16 v[76:79], a[228:231], v[48:51], v[76:79]
s_add_u32 s48, s44, 55296
v_mfma_f32_16x16x32_bf16 v[92:95], a[228:231], v[52:55], v[92:95]
buffer_load_dwordx4 v236, s[16:19], s48 offen lds
v_mfma_f32_16x16x32_bf16 v[80:83], a[232:235], v[48:51], v[80:83]
ds_read_b64_tr_b16 a[228:229], v217 offset:24576
ds_read_b64_tr_b16 a[230:231], v217 offset:26624
v_mfma_f32_16x16x32_bf16 v[96:99], a[232:235], v[52:55], v[96:99]
ds_read_b64_tr_b16 a[232:233], v218 offset:24576
ds_read_b64_tr_b16 a[234:235], v218 offset:26624
v_mfma_f32_16x16x32_bf16 v[84:87], a[236:239], v[48:51], v[84:87]
v_mfma_f32_16x16x32_bf16 v[100:103], a[236:239], v[52:55], v[100:103]
ds_read_b64_tr_b16 a[236:237], v219 offset:24576
ds_read_b64_tr_b16 a[238:239], v219 offset:26624
v_rcp_f32 v132, v131
s_waitcnt vmcnt(6)
v_cmp_ne_u32 vcc, 1, v246
s_and_b32 s46, vcc_lo, 85
s_cbranch_scc0 K_F0_OK
K_F0:
s_sleep 1
s_add_u32 s100, s100, 1
s_bitcmp1_b32 s100, 19
s_cbranch_scc1 K_END
buffer_load_dword v246, v6, s[20:23], s54 offen sc0 sc1
s_waitcnt vmcnt(0)
v_cmp_ne_u32 vcc, 1, v246
s_and_b32 s46, vcc_lo, 85
s_cbranch_scc1 K_F0
K_F0_OK:
v_mfma_f32_16x16x32_bf16 v[136:139], a[192:195], v[56:59], v[136:139]
s_add_u32 s94, s90, 0
v_mfma_f32_16x16x32_bf16 v[168:171], a[192:195], v[60:63], v[168:171]
buffer_load_dwordx4 a[0:3], v234, s[20:23], s94 offen offset:0 sc0 sc1
v_mfma_f32_16x16x32_bf16 v[140:143], a[196:199], v[56:59], v[140:143]
ds_read_b64_tr_b16 a[192:193], v208 offset:24576
ds_read_b64_tr_b16 a[194:195], v208 offset:28672
v_mfma_f32_16x16x32_bf16 v[172:175], a[196:199], v[60:63], v[172:175]
s_add_u32 s94, s90, 0
ds_read_b64_tr_b16 a[196:197], v209 offset:24576
ds_read_b64_tr_b16 a[198:199], v209 offset:28672
v_mfma_f32_16x16x32_bf16 v[144:147], a[200:203], v[56:59], v[144:147]
buffer_load_dwordx4 a[4:7], v234, s[20:23], s94 offen offset:1024 sc0 sc1
v_mfma_f32_16x16x32_bf16 v[176:179], a[200:203], v[60:63], v[176:179]
s_waitcnt lgkmcnt(10)
ds_read_b64_tr_b16 a[200:201], v210 offset:24576
ds_read_b64_tr_b16 a[202:203], v210 offset:28672
v_mfma_f32_16x16x32_bf16 v[148:151], a[204:207], v[56:59], v[148:151]
s_add_u32 s94, s90, 0
v_mfma_f32_16x16x32_bf16 v[180:183], a[204:207], v[60:63], v[180:183]
buffer_load_dwordx4 a[8:11], v234, s[20:23], s94 offen offset:2048 sc0 sc1
v_mfma_f32_16x16x32_bf16 v[152:155], a[208:211], v[56:59], v[152:155]
ds_read_b64_tr_b16 a[204:205], v211 offset:24576
ds_read_b64_tr_b16 a[206:207], v211 offset:28672
v_mfma_f32_16x16x32_bf16 v[184:187], a[208:211], v[60:63], v[184:187]
s_add_u32 s94, s90, 0
ds_read_b64_tr_b16 a[208:209], v212 offset:24576
ds_read_b64_tr_b16 a[210:211], v212 offset:28672
v_mfma_f32_16x16x32_bf16 v[156:159], a[212:215], v[56:59], v[156:159]
buffer_load_dwordx4 a[12:15], v234, s[20:23], s94 offen offset:3072 sc0 sc1
v_mfma_f32_16x16x32_bf16 v[188:191], a[212:215], v[60:63], v[188:191]
ds_read_b64_tr_b16 a[212:213], v213 offset:24576
ds_read_b64_tr_b16 a[214:215], v213 offset:28672
v_mfma_f32_16x16x32_bf16 v[160:163], a[216:219], v[56:59], v[160:163]
s_add_u32 s94, s90, 4096
v_mfma_f32_16x16x32_bf16 v[192:195], a[216:219], v[60:63], v[192:195]
buffer_load_dwordx4 a[16:19], v234, s[20:23], s94 offen offset:0 sc0 sc1
v_mfma_f32_16x16x32_bf16 v[164:167], a[220:223], v[56:59], v[164:167]
ds_read_b64_tr_b16 a[216:217], v214 offset:24576
ds_read_b64_tr_b16 a[218:219], v214 offset:28672
v_mfma_f32_16x16x32_bf16 v[196:199], a[220:223], v[60:63], v[196:199]
s_add_u32 s94, s90, 4096
ds_read_b64_tr_b16 a[220:221], v215 offset:24576
ds_read_b64_tr_b16 a[222:223], v215 offset:28672
v_mfma_f32_16x16x32_bf16 v[72:75], a[224:227], v[56:59], v[72:75]
buffer_load_dwordx4 a[20:23], v234, s[20:23], s94 offen offset:1024 sc0 sc1
v_mfma_f32_16x16x32_bf16 v[88:91], a[224:227], v[60:63], v[88:91]
s_waitcnt lgkmcnt(10)
ds_read_b64_tr_b16 a[224:225], v216 offset:28672
ds_read_b64_tr_b16 a[226:227], v216 offset:30720
v_mfma_f32_16x16x32_bf16 v[76:79], a[228:231], v[56:59], v[76:79]
s_add_u32 s94, s90, 4096
v_mfma_f32_16x16x32_bf16 v[92:95], a[228:231], v[60:63], v[92:95]
buffer_load_dwordx4 a[24:27], v234, s[20:23], s94 offen offset:2048 sc0 sc1
v_mfma_f32_16x16x32_bf16 v[80:83], a[232:235], v[56:59], v[80:83]
ds_read_b64_tr_b16 a[228:229], v217 offset:28672
ds_read_b64_tr_b16 a[230:231], v217 offset:30720
v_mfma_f32_16x16x32_bf16 v[96:99], a[232:235], v[60:63], v[96:99]
s_add_u32 s94, s90, 4096
ds_read_b64_tr_b16 a[232:233], v218 offset:28672
ds_read_b64_tr_b16 a[234:235], v218 offset:30720
v_mfma_f32_16x16x32_bf16 v[84:87], a[236:239], v[56:59], v[84:87]
buffer_load_dwordx4 a[28:31], v234, s[20:23], s94 offen offset:3072 sc0 sc1
v_mfma_f32_16x16x32_bf16 v[100:103], a[236:239], v[60:63], v[100:103]
ds_read_b64_tr_b16 a[236:237], v219 offset:28672
ds_read_b64_tr_b16 a[238:239], v219 offset:30720
s_waitcnt vmcnt(12)
s_mov_b64 exec, 1
buffer_store_dword v5, v234, s[20:23], s95 offen offset:4 sc0 sc1
s_mov_b64 exec, -1
v_mfma_f32_16x16x32_bf16 v[136:139], a[192:195], v[64:67], v[136:139]
v_mfma_f32_16x16x32_bf16 v[168:171], a[192:195], v[68:71], v[168:171]
v_mfma_f32_16x16x32_bf16 v[140:143], a[196:199], v[64:67], v[140:143]
v_mfma_f32_16x16x32_bf16 v[172:175], a[196:199], v[68:71], v[172:175]
v_mfma_f32_16x16x32_bf16 v[144:147], a[200:203], v[64:67], v[144:147]
s_waitcnt vmcnt(22) lgkmcnt(0)
s_barrier
v_mfma_f32_16x16x32_bf16 v[176:179], a[200:203], v[68:71], v[176:179]
ds_read_b64_tr_b16 a[192:193], v200 offset:32768
ds_read_b64_tr_b16 a[194:195], v200 offset:36864
v_mfma_f32_16x16x32_bf16 v[148:151], a[204:207], v[64:67], v[148:151]
s_add_u32 s94, s91, 0
ds_read_b64_tr_b16 a[196:197], v201 offset:32768
ds_read_b64_tr_b16 a[198:199], v201 offset:36864
v_mfma_f32_16x16x32_bf16 v[180:183], a[204:207], v[68:71], v[180:183]
buffer_load_dwordx4 a[32:35], v234, s[20:23], s94 offen offset:0 sc0 sc1
v_mfma_f32_16x16x32_bf16 v[152:155], a[208:211], v[64:67], v[152:155]
ds_read_b64_tr_b16 a[200:201], v202 offset:32768
ds_read_b64_tr_b16 a[202:203], v202 offset:36864
v_mfma_f32_16x16x32_bf16 v[184:187], a[208:211], v[68:71], v[184:187]
ds_read_b64_tr_b16 a[204:205], v203 offset:32768
ds_read_b64_tr_b16 a[206:207], v203 offset:36864
v_mfma_f32_16x16x32_bf16 v[156:159], a[212:215], v[64:67], v[156:159]
s_add_u32 s94, s91, 0
ds_read_b64_tr_b16 a[208:209], v204 offset:32768
ds_read_b64_tr_b16 a[210:211], v204 offset:36864
v_mfma_f32_16x16x32_bf16 v[188:191], a[212:215], v[68:71], v[188:191]
buffer_load_dwordx4 a[36:39], v234, s[20:23], s94 offen offset:1024 sc0 sc1
v_mfma_f32_16x16x32_bf16 v[160:163], a[216:219], v[64:67], v[160:163]
ds_read_b64_tr_b16 a[212:213], v205 offset:32768
ds_read_b64_tr_b16 a[214:215], v205 offset:36864
v_mfma_f32_16x16x32_bf16 v[192:195], a[216:219], v[68:71], v[192:195]
ds_read_b64_tr_b16 a[216:217], v206 offset:32768
ds_read_b64_tr_b16 a[218:219], v206 offset:36864
v_mfma_f32_16x16x32_bf16 v[164:167], a[220:223], v[64:67], v[164:167]
s_add_u32 s94, s91, 0
v_mfma_f32_16x16x32_bf16 v[196:199], a[220:223], v[68:71], v[196:199]
buffer_load_dwordx4 a[40:43], v234, s[20:23], s94 offen offset:2048 sc0 sc1
v_mfma_f32_16x16x32_bf16 v[72:75], a[224:227], v[64:67], v[72:75]
ds_read_b64_tr_b16 a[220:221], v207 offset:32768
ds_read_b64_tr_b16 a[222:223], v207 offset:36864
v_mfma_f32_16x16x32_bf16 v[88:91], a[224:227], v[68:71], v[88:91]
v_mfma_f32_16x16x32_bf16 v[76:79], a[228:231], v[64:67], v[76:79]
s_add_u32 s94, s91, 0
v_mfma_f32_16x16x32_bf16 v[92:95], a[228:231], v[68:71], v[92:95]
buffer_load_dwordx4 a[44:47], v234, s[20:23], s94 offen offset:3072 sc0 sc1
v_mfma_f32_16x16x32_bf16 v[80:83], a[232:235], v[64:67], v[80:83]
v_mfma_f32_16x16x32_bf16 v[96:99], a[232:235], v[68:71], v[96:99]
v_mfma_f32_16x16x32_bf16 v[84:87], a[236:239], v[64:67], v[84:87]
v_mfma_f32_16x16x32_bf16 v[100:103], a[236:239], v[68:71], v[100:103]
s_waitcnt lgkmcnt(2)
s_cmp_lg_u32 s83, 0
s_cbranch_scc1 K_YR2
K_YR2D:
s_waitcnt vmcnt(5)
v_mfma_f32_16x16x32_bf16 v[136:139], a[192:195], a[0:3], v[136:139]
s_add_u32 s94, s91, 4096
v_mfma_f32_16x16x32_bf16 v[168:171], a[192:195], a[4:7], v[168:171]
buffer_load_dwordx4 a[48:51], v234, s[20:23], s94 offen offset:0 sc0 sc1
v_mfma_f32_16x16x32_bf16 v[140:143], a[196:199], a[0:3], v[140:143]
ds_read_b64_tr_b16 a[192:193], v200 offset:40960
ds_read_b64_tr_b16 a[194:195], v200 offset:45056
v_mfma_f32_16x16x32_bf16 v[172:175], a[196:199], a[4:7], v[172:175]
ds_read_b64_tr_b16 a[196:197], v201 offset:40960
ds_read_b64_tr_b16 a[198:199], v201 offset:45056
v_mfma_f32_16x16x32_bf16 v[144:147], a[200:203], a[0:3], v[144:147]
s_add_u32 s94, s91, 4096
v_cvt_pk_bf16_f32 v72, v72, v73
v_cvt_pk_bf16_f32 v73, v74, v75
v_mfma_f32_16x16x32_bf16 v[176:179], a[200:203], a[4:7], v[176:179]
buffer_load_dwordx4 a[52:55], v234, s[20:23], s94 offen offset:1024 sc0 sc1
v_mfma_f32_16x16x32_bf16 v[148:151], a[204:207], a[0:3], v[148:151]
ds_read_b64_tr_b16 a[200:201], v202 offset:40960
ds_read_b64_tr_b16 a[202:203], v202 offset:45056
v_mfma_f32_16x16x32_bf16 v[180:183], a[204:207], a[4:7], v[180:183]
ds_read_b64_tr_b16 a[204:205], v203 offset:40960
ds_read_b64_tr_b16 a[206:207], v203 offset:45056
v_mfma_f32_16x16x32_bf16 v[152:155], a[208:211], a[0:3], v[152:155]
s_add_u32 s94, s91, 4096
v_cvt_pk_bf16_f32 v76, v76, v77
v_cvt_pk_bf16_f32 v77, v78, v79
v_mfma_f32_16x16x32_bf16 v[184:187], a[208:211], a[4:7], v[184:187]
buffer_load_dwordx4 a[56:59], v234, s[20:23], s94 offen offset:2048 sc0 sc1
v_mfma_f32_16x16x32_bf16 v[156:159], a[212:215], a[0:3], v[156:159]
ds_read_b64_tr_b16 a[208:209], v204 offset:40960
ds_read_b64_tr_b16 a[210:211], v204 offset:45056
v_mfma_f32_16x16x32_bf16 v[188:191], a[212:215], a[4:7], v[188:191]
ds_read_b64_tr_b16 a[212:213], v205 offset:40960
ds_read_b64_tr_b16 a[214:215], v205 offset:45056
v_mfma_f32_16x16x32_bf16 v[160:163], a[216:219], a[0:3], v[160:163]
s_add_u32 s94, s91, 4096
v_cvt_pk_bf16_f32 v80, v80, v81
v_cvt_pk_bf16_f32 v81, v82, v83
v_mfma_f32_16x16x32_bf16 v[192:195], a[216:219], a[4:7], v[192:195]
s_waitcnt lgkmcnt(8)
buffer_load_dwordx4 a[60:63], v234, s[20:23], s94 offen offset:3072 sc0 sc1
v_mfma_f32_16x16x32_bf16 v[164:167], a[220:223], a[0:3], v[164:167]
ds_read_b64_tr_b16 a[216:217], v206 offset:40960
ds_read_b64_tr_b16 a[218:219], v206 offset:45056
v_mfma_f32_16x16x32_bf16 v[196:199], a[220:223], a[4:7], v[196:199]
ds_read_b64_tr_b16 a[220:221], v207 offset:40960
ds_read_b64_tr_b16 a[222:223], v207 offset:45056
v_mfma_f32_16x16x32_bf16 v[136:139], a[192:195], a[8:11], v[136:139]
s_add_u32 m0, s3, 114688
v_cvt_pk_bf16_f32 v84, v84, v85
v_cvt_pk_bf16_f32 v85, v86, v87
v_mfma_f32_16x16x32_bf16 v[168:171], a[192:195], a[12:15], v[168:171]
s_add_u32 s48, s44, 73728
ds_read_b64_tr_b16 a[192:193], v200 offset:49152
ds_read_b64_tr_b16 a[194:195], v200 offset:53248
v_mfma_f32_16x16x32_bf16 v[140:143], a[196:199], a[8:11], v[140:143]
buffer_load_dwordx4 v236, s[16:19], s48 offen lds
v_mfma_f32_16x16x32_bf16 v[172:175], a[196:199], a[12:15], v[172:175]
s_waitcnt lgkmcnt(10)
ds_read_b64_tr_b16 a[196:197], v201 offset:49152
ds_read_b64_tr_b16 a[198:199], v201 offset:53248
v_mfma_f32_16x16x32_bf16 v[144:147], a[200:203], a[8:11], v[144:147]
s_add_u32 m0, s3, 118784
v_cvt_pk_bf16_f32 v88, v88, v89
v_cvt_pk_bf16_f32 v89, v90, v91
v_mfma_f32_16x16x32_bf16 v[176:179], a[200:203], a[12:15], v[176:179]
s_add_u32 s48, s44, 92160
ds_read_b64_tr_b16 a[200:201], v202 offset:49152
ds_read_b64_tr_b16 a[202:203], v202 offset:53248
v_mfma_f32_16x16x32_bf16 v[148:151], a[204:207], a[8:11], v[148:151]
buffer_load_dwordx4 v236, s[16:19], s48 offen lds
v_mfma_f32_16x16x32_bf16 v[180:183], a[204:207], a[12:15], v[180:183]
s_waitcnt lgkmcnt(10)
ds_read_b64_tr_b16 a[204:205], v203 offset:49152
ds_read_b64_tr_b16 a[206:207], v203 offset:53248
v_mfma_f32_16x16x32_bf16 v[152:155], a[208:211], a[8:11], v[152:155]
s_add_u32 m0, s3, 122880
v_cvt_pk_bf16_f32 v92, v92, v93
v_cvt_pk_bf16_f32 v93, v94, v95
v_mfma_f32_16x16x32_bf16 v[184:187], a[208:211], a[12:15], v[184:187]
s_add_u32 s48, s44, 110592
ds_read_b64_tr_b16 a[208:209], v204 offset:49152
ds_read_b64_tr_b16 a[210:211], v204 offset:53248
v_mfma_f32_16x16x32_bf16 v[156:159], a[212:215], a[8:11], v[156:159]
buffer_load_dwordx4 v236, s[16:19], s48 offen lds
v_mfma_f32_16x16x32_bf16 v[188:191], a[212:215], a[12:15], v[188:191]
s_waitcnt lgkmcnt(8)
ds_read_b64_tr_b16 a[212:213], v205 offset:49152
ds_read_b64_tr_b16 a[214:215], v205 offset:53248
v_mfma_f32_16x16x32_bf16 v[160:163], a[216:219], a[8:11], v[160:163]
s_add_u32 m0, s3, 126976
v_cvt_pk_bf16_f32 v96, v96, v97
v_mfma_f32_16x16x32_bf16 v[192:195], a[216:219], a[12:15], v[192:195]
s_add_u32 s48, s44, 129024
ds_read_b64_tr_b16 a[216:217], v206 offset:49152
ds_read_b64_tr_b16 a[218:219], v206 offset:53248
v_mfma_f32_16x16x32_bf16 v[164:167], a[220:223], a[8:11], v[164:167]
buffer_load_dwordx4 v236, s[16:19], s48 offen lds
v_mfma_f32_16x16x32_bf16 v[196:199], a[220:223], a[12:15], v[196:199]
ds_read_b64_tr_b16 a[220:221], v207 offset:49152
ds_read_b64_tr_b16 a[222:223], v207 offset:53248
v_mfma_f32_16x16x32_bf16 v[136:139], a[192:195], a[16:19], v[136:139]
s_waitcnt lgkmcnt(10)
v_cvt_pk_bf16_f32 v97, v98, v99
v_cvt_pk_bf16_f32 v100, v100, v101
v_mfma_f32_16x16x32_bf16 v[168:171], a[192:195], a[20:23], v[168:171]
s_add_u32 s94, s92, 0
ds_read_b64_tr_b16 a[192:193], v200 offset:57344
ds_read_b64_tr_b16 a[194:195], v200 offset:61440
v_mfma_f32_16x16x32_bf16 v[140:143], a[196:199], a[16:19], v[140:143]
buffer_load_dwordx4 a[64:67], v234, s[20:23], s94 offen offset:0 sc0 sc1
v_mfma_f32_16x16x32_bf16 v[172:175], a[196:199], a[20:23], v[172:175]
ds_read_b64_tr_b16 a[196:197], v201 offset:57344
ds_read_b64_tr_b16 a[198:199], v201 offset:61440
v_mfma_f32_16x16x32_bf16 v[144:147], a[200:203], a[16:19], v[144:147]
s_waitcnt lgkmcnt(10)
v_cvt_pk_bf16_f32 v101, v102, v103
v_lshlrev_b32 v249, 7, v1
v_mfma_f32_16x16x32_bf16 v[176:179], a[200:203], a[20:23], v[176:179]
s_add_u32 s94, s92, 0
ds_read_b64_tr_b16 a[200:201], v202 offset:57344
ds_read_b64_tr_b16 a[202:203], v202 offset:61440
v_mfma_f32_16x16x32_bf16 v[148:151], a[204:207], a[16:19], v[148:151]
buffer_load_dwordx4 a[68:71], v234, s[20:23], s94 offen offset:1024 sc0 sc1
v_mfma_f32_16x16x32_bf16 v[180:183], a[204:207], a[20:23], v[180:183]
ds_read_b64_tr_b16 a[204:205], v203 offset:57344
ds_read_b64_tr_b16 a[206:207], v203 offset:61440
v_mfma_f32_16x16x32_bf16 v[152:155], a[208:211], a[16:19], v[152:155]
s_waitcnt lgkmcnt(10)
v_lshlrev_b32 v7, 2, v3
v_subrev_u32 v248, s55, v254
v_mfma_f32_16x16x32_bf16 v[184:187], a[208:211], a[20:23], v[184:187]
s_add_u32 s94, s92, 0
ds_read_b64_tr_b16 a[208:209], v204 offset:57344
ds_read_b64_tr_b16 a[210:211], v204 offset:61440
v_mfma_f32_16x16x32_bf16 v[156:159], a[212:215], a[16:19], v[156:159]
buffer_load_dwordx4 a[72:75], v234, s[20:23], s94 offen offset:2048 sc0 sc1
v_mfma_f32_16x16x32_bf16 v[188:191], a[212:215], a[20:23], v[188:191]
ds_read_b64_tr_b16 a[212:213], v205 offset:57344
ds_read_b64_tr_b16 a[214:215], v205 offset:61440
v_mfma_f32_16x16x32_bf16 v[160:163], a[216:219], a[16:19], v[160:163]
s_waitcnt lgkmcnt(10)
v_subrev_u32 v248, 1, v248
v_mfma_f32_16x16x32_bf16 v[192:195], a[216:219], a[20:23], v[192:195]
s_add_u32 s94, s92, 0
ds_read_b64_tr_b16 a[216:217], v206 offset:57344
ds_read_b64_tr_b16 a[218:219], v206 offset:61440
v_mfma_f32_16x16x32_bf16 v[164:167], a[220:223], a[16:19], v[164:167]
buffer_load_dwordx4 a[76:79], v234, s[20:23], s94 offen offset:3072 sc0 sc1
v_mfma_f32_16x16x32_bf16 v[196:199], a[220:223], a[20:23], v[196:199]
ds_read_b64_tr_b16 a[220:221], v207 offset:57344
ds_read_b64_tr_b16 a[222:223], v207 offset:61440
buffer_load_dword v246, v6, s[20:23], s54 offen sc0 sc1
v_mfma_f32_16x16x32_bf16 v[136:139], a[192:195], a[24:27], v[136:139]
s_waitcnt lgkmcnt(10)
v_add_u32 v241, s37, v241
v_add_u32 v241, 65536, v241
v_mfma_f32_16x16x32_bf16 v[168:171], a[192:195], a[28:31], v[168:171]
s_add_u32 s94, s92, 4096
ds_read_b64_tr_b16 a[192:193], v220 offset:0
ds_read_b64_tr_b16 a[194:195], v220 offset:4096
v_mfma_f32_16x16x32_bf16 v[140:143], a[196:199], a[24:27], v[140:143]
buffer_load_dwordx4 a[80:83], v234, s[20:23], s94 offen offset:0 sc0 sc1
v_mfma_f32_16x16x32_bf16 v[172:175], a[196:199], a[28:31], v[172:175]
ds_read_b64_tr_b16 a[196:197], v221 offset:0
ds_read_b64_tr_b16 a[198:199], v221 offset:4096
v_mfma_f32_16x16x32_bf16 v[144:147], a[200:203], a[24:27], v[144:147]
s_waitcnt lgkmcnt(10)
v_xor_b32 v242, 32, v241
v_xor_b32 v243, 64, v241
v_mfma_f32_16x16x32_bf16 v[176:179], a[200:203], a[28:31], v[176:179]
s_add_u32 s94, s92, 4096
ds_read_b64_tr_b16 a[200:201], v222 offset:0
ds_read_b64_tr_b16 a[202:203], v222 offset:4096
v_mfma_f32_16x16x32_bf16 v[148:151], a[204:207], a[24:27], v[148:151]
buffer_load_dwordx4 a[84:87], v234, s[20:23], s94 offen offset:1024 sc0 sc1
v_mfma_f32_16x16x32_bf16 v[180:183], a[204:207], a[28:31], v[180:183]
ds_read_b64_tr_b16 a[204:205], v223 offset:0
ds_read_b64_tr_b16 a[206:207], v223 offset:4096
v_mfma_f32_16x16x32_bf16 v[152:155], a[208:211], a[24:27], v[152:155]
s_waitcnt lgkmcnt(10)
v_xor_b32 v244, 96, v241
v_mfma_f32_16x16x32_bf16 v[184:187], a[208:211], a[28:31], v[184:187]
s_add_u32 s94, s92, 4096
ds_read_b64_tr_b16 a[208:209], v224 offset:0
ds_read_b64_tr_b16 a[210:211], v224 offset:4096
v_mfma_f32_16x16x32_bf16 v[156:159], a[212:215], a[24:27], v[156:159]
buffer_load_dwordx4 a[88:91], v234, s[20:23], s94 offen offset:2048 sc0 sc1
v_mfma_f32_16x16x32_bf16 v[188:191], a[212:215], a[28:31], v[188:191]
ds_read_b64_tr_b16 a[212:213], v225 offset:0
ds_read_b64_tr_b16 a[214:215], v225 offset:4096
v_mfma_f32_16x16x32_bf16 v[160:163], a[216:219], a[24:27], v[160:163]
s_waitcnt lgkmcnt(10)
v_mfma_f32_16x16x32_bf16 v[192:195], a[216:219], a[28:31], v[192:195]
s_add_u32 s94, s92, 4096
ds_read_b64_tr_b16 a[216:217], v226 offset:0
ds_read_b64_tr_b16 a[218:219], v226 offset:4096
v_mfma_f32_16x16x32_bf16 v[164:167], a[220:223], a[24:27], v[164:167]
buffer_load_dwordx4 a[92:95], v234, s[20:23], s94 offen offset:3072 sc0 sc1
v_mfma_f32_16x16x32_bf16 v[196:199], a[220:223], a[28:31], v[196:199]
ds_read_b64_tr_b16 a[220:221], v227 offset:0
ds_read_b64_tr_b16 a[222:223], v227 offset:4096
s_waitcnt vmcnt(13)
v_mfma_f32_16x16x32_bf16 v[136:139], a[192:195], a[32:35], v[136:139]
s_add_u32 m0, s3, 131072
v_mfma_f32_16x16x32_bf16 v[168:171], a[192:195], a[36:39], v[168:171]
s_waitcnt lgkmcnt(8)
s_add_u32 s48, s42, 147456
ds_read_b64_tr_b16 a[192:193], v220 offset:8192
ds_read_b64_tr_b16 a[194:195], v220 offset:12288
v_mfma_f32_16x16x32_bf16 v[140:143], a[196:199], a[32:35], v[140:143]
buffer_load_dwordx4 v236, s[16:19], s48 offen lds
v_mfma_f32_16x16x32_bf16 v[172:175], a[196:199], a[36:39], v[172:175]
ds_read_b64_tr_b16 a[196:197], v221 offset:8192
ds_read_b64_tr_b16 a[198:199], v221 offset:12288
v_mfma_f32_16x16x32_bf16 v[144:147], a[200:203], a[32:35], v[144:147]
s_add_u32 m0, s3, 135168
v_mfma_f32_16x16x32_bf16 v[176:179], a[200:203], a[36:39], v[176:179]
s_add_u32 s48, s42, 165888
ds_read_b64_tr_b16 a[200:201], v222 offset:8192
ds_read_b64_tr_b16 a[202:203], v222 offset:12288
v_mfma_f32_16x16x32_bf16 v[148:151], a[204:207], a[32:35], v[148:151]
buffer_load_dwordx4 v236, s[16:19], s48 offen lds
v_mfma_f32_16x16x32_bf16 v[180:183], a[204:207], a[36:39], v[180:183]
s_waitcnt lgkmcnt(8)
ds_read_b64_tr_b16 a[204:205], v223 offset:8192
ds_read_b64_tr_b16 a[206:207], v223 offset:12288
v_mfma_f32_16x16x32_bf16 v[152:155], a[208:211], a[32:35], v[152:155]
s_add_u32 m0, s3, 139264
v_mfma_f32_16x16x32_bf16 v[184:187], a[208:211], a[36:39], v[184:187]
s_add_u32 s48, s42, 184320
ds_read_b64_tr_b16 a[208:209], v224 offset:8192
ds_read_b64_tr_b16 a[210:211], v224 offset:12288
v_mfma_f32_16x16x32_bf16 v[156:159], a[212:215], a[32:35], v[156:159]
buffer_load_dwordx4 v236, s[16:19], s48 offen lds
v_mfma_f32_16x16x32_bf16 v[188:191], a[212:215], a[36:39], v[188:191]
ds_read_b64_tr_b16 a[212:213], v225 offset:8192
ds_read_b64_tr_b16 a[214:215], v225 offset:12288
v_mfma_f32_16x16x32_bf16 v[160:163], a[216:219], a[32:35], v[160:163]
s_add_u32 m0, s3, 143360
v_mfma_f32_16x16x32_bf16 v[192:195], a[216:219], a[36:39], v[192:195]
s_waitcnt lgkmcnt(8)
s_add_u32 s48, s42, 202752
ds_read_b64_tr_b16 a[216:217], v226 offset:8192
ds_read_b64_tr_b16 a[218:219], v226 offset:12288
v_mfma_f32_16x16x32_bf16 v[164:167], a[220:223], a[32:35], v[164:167]
buffer_load_dwordx4 v236, s[16:19], s48 offen lds
v_mfma_f32_16x16x32_bf16 v[196:199], a[220:223], a[36:39], v[196:199]
ds_read_b64_tr_b16 a[220:221], v227 offset:8192
ds_read_b64_tr_b16 a[222:223], v227 offset:12288
v_mfma_f32_16x16x32_bf16 v[136:139], a[192:195], a[40:43], v[136:139]
s_add_u32 m0, s3, 147456
v_mfma_f32_16x16x32_bf16 v[168:171], a[192:195], a[44:47], v[168:171]
s_add_u32 s48, s42, 221184
ds_read_b64_tr_b16 a[192:193], v220 offset:16384
ds_read_b64_tr_b16 a[194:195], v220 offset:20480
v_mfma_f32_16x16x32_bf16 v[140:143], a[196:199], a[40:43], v[140:143]
buffer_load_dwordx4 v236, s[16:19], s48 offen lds
v_mfma_f32_16x16x32_bf16 v[172:175], a[196:199], a[44:47], v[172:175]
s_waitcnt lgkmcnt(8)
ds_read_b64_tr_b16 a[196:197], v221 offset:16384
ds_read_b64_tr_b16 a[198:199], v221 offset:20480
v_mfma_f32_16x16x32_bf16 v[144:147], a[200:203], a[40:43], v[144:147]
s_add_u32 m0, s3, 151552
v_mfma_f32_16x16x32_bf16 v[176:179], a[200:203], a[44:47], v[176:179]
s_add_u32 s48, s42, 239616
ds_read_b64_tr_b16 a[200:201], v222 offset:16384
ds_read_b64_tr_b16 a[202:203], v222 offset:20480
v_mfma_f32_16x16x32_bf16 v[148:151], a[204:207], a[40:43], v[148:151]
buffer_load_dwordx4 v236, s[16:19], s48 offen lds
v_mfma_f32_16x16x32_bf16 v[180:183], a[204:207], a[44:47], v[180:183]
ds_read_b64_tr_b16 a[204:205], v223 offset:16384
ds_read_b64_tr_b16 a[206:207], v223 offset:20480
v_mfma_f32_16x16x32_bf16 v[152:155], a[208:211], a[40:43], v[152:155]
s_add_u32 m0, s3, 155648
v_mfma_f32_16x16x32_bf16 v[184:187], a[208:211], a[44:47], v[184:187]
s_waitcnt lgkmcnt(8)
s_add_u32 s48, s42, 258048
ds_read_b64_tr_b16 a[208:209], v224 offset:16384
ds_read_b64_tr_b16 a[210:211], v224 offset:20480
v_mfma_f32_16x16x32_bf16 v[156:159], a[212:215], a[40:43], v[156:159]
buffer_load_dwordx4 v236, s[16:19], s48 offen lds
v_mfma_f32_16x16x32_bf16 v[188:191], a[212:215], a[44:47], v[188:191]
ds_read_b64_tr_b16 a[212:213], v225 offset:16384
ds_read_b64_tr_b16 a[214:215], v225 offset:20480
v_mfma_f32_16x16x32_bf16 v[160:163], a[216:219], a[40:43], v[160:163]
s_add_u32 m0, s3, 159744
v_mfma_f32_16x16x32_bf16 v[192:195], a[216:219], a[44:47], v[192:195]
s_add_u32 s48, s42, 276480
ds_read_b64_tr_b16 a[216:217], v226 offset:16384
ds_read_b64_tr_b16 a[218:219], v226 offset:20480
v_mfma_f32_16x16x32_bf16 v[164:167], a[220:223], a[40:43], v[164:167]
buffer_load_dwordx4 v236, s[16:19], s48 offen lds
v_mfma_f32_16x16x32_bf16 v[196:199], a[220:223], a[44:47], v[196:199]
s_waitcnt lgkmcnt(8)
ds_read_b64_tr_b16 a[220:221], v227 offset:16384
ds_read_b64_tr_b16 a[222:223], v227 offset:20480
s_waitcnt vmcnt(12)
v_cmp_ne_u32 vcc, 1, v246
s_and_b32 s46, vcc_lo, 170
s_cbranch_scc0 K_F1_OK
K_F1:
s_sleep 1
s_add_u32 s100, s100, 1
s_bitcmp1_b32 s100, 19
s_cbranch_scc1 K_END
buffer_load_dword v246, v6, s[20:23], s54 offen sc0 sc1
s_waitcnt vmcnt(0)
v_cmp_ne_u32 vcc, 1, v246
s_and_b32 s46, vcc_lo, 170
s_cbranch_scc1 K_F1
K_F1_OK:
v_mfma_f32_16x16x32_bf16 v[136:139], a[192:195], a[48:51], v[136:139]
v_mfma_f32_16x16x32_bf16 v[168:171], a[192:195], a[52:55], v[168:171]
s_add_u32 s94, s90, 8192
ds_read_b64_tr_b16 a[192:193], v220 offset:24576
ds_read_b64_tr_b16 a[194:195], v220 offset:28672
v_mfma_f32_16x16x32_bf16 v[140:143], a[196:199], a[48:51], v[140:143]
buffer_load_dwordx4 a[96:99], v234, s[20:23], s94 offen offset:0 sc0 sc1
v_mfma_f32_16x16x32_bf16 v[172:175], a[196:199], a[52:55], v[172:175]
ds_read_b64_tr_b16 a[196:197], v221 offset:24576
ds_read_b64_tr_b16 a[198:199], v221 offset:28672
v_mfma_f32_16x16x32_bf16 v[144:147], a[200:203], a[48:51], v[144:147]
s_add_u32 s94, s90, 8192
v_mfma_f32_16x16x32_bf16 v[176:179], a[200:203], a[52:55], v[176:179]
s_waitcnt lgkmcnt(8)
buffer_load_dwordx4 a[100:103], v234, s[20:23], s94 offen offset:1024 sc0 sc1
v_mfma_f32_16x16x32_bf16 v[148:151], a[204:207], a[48:51], v[148:151]
ds_read_b64_tr_b16 a[200:201], v222 offset:24576
ds_read_b64_tr_b16 a[202:203], v222 offset:28672
v_mfma_f32_16x16x32_bf16 v[180:183], a[204:207], a[52:55], v[180:183]
ds_read_b64_tr_b16 a[204:205], v223 offset:24576
ds_read_b64_tr_b16 a[206:207], v223 offset:28672
v_mfma_f32_16x16x32_bf16 v[152:155], a[208:211], a[48:51], v[152:155]
s_add_u32 s94, s90, 8192
v_mfma_f32_16x16x32_bf16 v[184:187], a[208:211], a[52:55], v[184:187]
buffer_load_dwordx4 a[104:107], v234, s[20:23], s94 offen offset:2048 sc0 sc1
v_mfma_f32_16x16x32_bf16 v[156:159], a[212:215], a[48:51], v[156:159]
s_waitcnt lgkmcnt(8)
ds_read_b64_tr_b16 a[208:209], v224 offset:24576
ds_read_b64_tr_b16 a[210:211], v224 offset:28672
v_mfma_f32_16x16x32_bf16 v[188:191], a[212:215], a[52:55], v[188:191]
s_add_u32 s94, s90, 8192
ds_read_b64_tr_b16 a[212:213], v225 offset:24576
ds_read_b64_tr_b16 a[214:215], v225 offset:28672
v_mfma_f32_16x16x32_bf16 v[160:163], a[216:219], a[48:51], v[160:163]
buffer_load_dwordx4 a[108:111], v234, s[20:23], s94 offen offset:3072 sc0 sc1
v_mfma_f32_16x16x32_bf16 v[192:195], a[216:219], a[52:55], v[192:195]
ds_read_b64_tr_b16 a[216:217], v226 offset:24576
ds_read_b64_tr_b16 a[218:219], v226 offset:28672
v_mfma_f32_16x16x32_bf16 v[164:167], a[220:223], a[48:51], v[164:167]
v_mfma_f32_16x16x32_bf16 v[196:199], a[220:223], a[52:55], v[196:199]
s_waitcnt lgkmcnt(10)
ds_read_b64_tr_b16 a[220:221], v227 offset:24576
ds_read_b64_tr_b16 a[222:223], v227 offset:28672
v_mfma_f32_16x16x32_bf16 v[136:139], a[192:195], a[56:59], v[136:139]
v_mfma_f32_16x16x32_bf16 v[168:171], a[192:195], a[60:63], v[168:171]
v_mfma_f32_16x16x32_bf16 v[140:143], a[196:199], a[56:59], v[140:143]
v_mfma_f32_16x16x32_bf16 v[172:175], a[196:199], a[60:63], v[172:175]
s_waitcnt lgkmcnt(8)
v_mfma_f32_16x16x32_bf16 v[144:147], a[200:203], a[56:59], v[144:147]
s_waitcnt vmcnt(21) lgkmcnt(0)
s_barrier
v_mfma_f32_16x16x32_bf16 v[176:179], a[200:203], a[60:63], v[176:179]
ds_read_b64_tr_b16 a[192:193], v220 offset:32768
ds_read_b64_tr_b16 a[194:195], v220 offset:36864
v_mfma_f32_16x16x32_bf16 v[148:151], a[204:207], a[56:59], v[148:151]
s_add_u32 s94, s90, 12288
ds_read_b64_tr_b16 a[196:197], v221 offset:32768
ds_read_b64_tr_b16 a[198:199], v221 offset:36864
v_mfma_f32_16x16x32_bf16 v[180:183], a[204:207], a[60:63], v[180:183]
buffer_load_dwordx4 a[112:115], v234, s[20:23], s94 offen offset:0 sc0 sc1
v_mfma_f32_16x16x32_bf16 v[152:155], a[208:211], a[56:59], v[152:155]
ds_read_b64_tr_b16 a[200:201], v222 offset:32768
ds_read_b64_tr_b16 a[202:203], v222 offset:36864
v_mfma_f32_16x16x32_bf16 v[184:187], a[208:211], a[60:63], v[184:187]
s_add_u32 s94, s90, 12288
ds_read_b64_tr_b16 a[204:205], v223 offset:32768
ds_read_b64_tr_b16 a[206:207], v223 offset:36864
v_mfma_f32_16x16x32_bf16 v[156:159], a[212:215], a[56:59], v[156:159]
buffer_load_dwordx4 a[116:119], v234, s[20:23], s94 offen offset:1024 sc0 sc1
v_mfma_f32_16x16x32_bf16 v[188:191], a[212:215], a[60:63], v[188:191]
ds_read_b64_tr_b16 a[208:209], v224 offset:32768
ds_read_b64_tr_b16 a[210:211], v224 offset:36864
v_mfma_f32_16x16x32_bf16 v[160:163], a[216:219], a[56:59], v[160:163]
ds_read_b64_tr_b16 a[212:213], v225 offset:32768
ds_read_b64_tr_b16 a[214:215], v225 offset:36864
v_mfma_f32_16x16x32_bf16 v[192:195], a[216:219], a[60:63], v[192:195]
s_add_u32 s94, s90, 12288
ds_read_b64_tr_b16 a[216:217], v226 offset:32768
ds_read_b64_tr_b16 a[218:219], v226 offset:36864
v_mfma_f32_16x16x32_bf16 v[164:167], a[220:223], a[56:59], v[164:167]
buffer_load_dwordx4 a[120:123], v234, s[20:23], s94 offen offset:2048 sc0 sc1
v_mfma_f32_16x16x32_bf16 v[196:199], a[220:223], a[60:63], v[196:199]
s_waitcnt lgkmcnt(12)
ds_read_b64_tr_b16 a[220:221], v227 offset:32768
ds_read_b64_tr_b16 a[222:223], v227 offset:36864
s_waitcnt vmcnt(15)
v_mfma_f32_16x16x32_bf16 v[136:139], a[192:195], a[64:67], v[136:139]
s_add_u32 s94, s90, 12288
v_mfma_f32_16x16x32_bf16 v[168:171], a[192:195], a[68:71], v[168:171]
s_waitcnt lgkmcnt(12)
buffer_load_dwordx4 a[124:127], v234, s[20:23], s94 offen offset:3072 sc0 sc1
v_mfma_f32_16x16x32_bf16 v[140:143], a[196:199], a[64:67], v[140:143]
s_waitcnt lgkmcnt(10)
ds_read_b64_tr_b16 a[192:193], v220 offset:40960
ds_read_b64_tr_b16 a[194:195], v220 offset:45056
v_mfma_f32_16x16x32_bf16 v[172:175], a[196:199], a[68:71], v[172:175]
s_add_u32 m0, s3, 0
ds_read_b64_tr_b16 a[196:197], v221 offset:40960
ds_read_b64_tr_b16 a[198:199], v221 offset:45056
v_mfma_f32_16x16x32_bf16 v[144:147], a[200:203], a[64:67], v[144:147]
s_add_u32 s48, s43, 147456
v_mfma_f32_16x16x32_bf16 v[176:179], a[200:203], a[68:71], v[176:179]
s_waitcnt lgkmcnt(10)
buffer_load_dwordx4 v236, s[16:19], s48 offen lds
v_mfma_f32_16x16x32_bf16 v[148:151], a[204:207], a[64:67], v[148:151]
s_add_u32 m0, s3, 4096
ds_read_b64_tr_b16 a[200:201], v222 offset:40960
ds_read_b64_tr_b16 a[202:203], v222 offset:45056
v_mfma_f32_16x16x32_bf16 v[180:183], a[204:207], a[68:71], v[180:183]
s_add_u32 s48, s43, 165888
ds_read_b64_tr_b16 a[204:205], v223 offset:40960
ds_read_b64_tr_b16 a[206:207], v223 offset:45056
v_mfma_f32_16x16x32_bf16 v[152:155], a[208:211], a[64:67], v[152:155]
s_waitcnt lgkmcnt(10)
buffer_load_dwordx4 v236, s[16:19], s48 offen lds
v_mfma_f32_16x16x32_bf16 v[184:187], a[208:211], a[68:71], v[184:187]
s_add_u32 m0, s3, 8192
ds_read_b64_tr_b16 a[208:209], v224 offset:40960
ds_read_b64_tr_b16 a[210:211], v224 offset:45056
v_mfma_f32_16x16x32_bf16 v[156:159], a[212:215], a[64:67], v[156:159]
s_add_u32 s48, s43, 184320
v_mfma_f32_16x16x32_bf16 v[188:191], a[212:215], a[68:71], v[188:191]
buffer_load_dwordx4 v236, s[16:19], s48 offen lds
v_mfma_f32_16x16x32_bf16 v[160:163], a[216:219], a[64:67], v[160:163]
ds_read_b64_tr_b16 a[212:213], v225 offset:40960
ds_read_b64_tr_b16 a[214:215], v225 offset:45056
v_mfma_f32_16x16x32_bf16 v[192:195], a[216:219], a[68:71], v[192:195]
s_waitcnt lgkmcnt(8)
ds_read_b64_tr_b16 a[216:217], v226 offset:40960
ds_read_b64_tr_b16 a[218:219], v226 offset:45056
v_mfma_f32_16x16x32_bf16 v[164:167], a[220:223], a[64:67], v[164:167]
v_mfma_f32_16x16x32_bf16 v[196:199], a[220:223], a[68:71], v[196:199]
ds_read_b64_tr_b16 a[220:221], v227 offset:40960
ds_read_b64_tr_b16 a[222:223], v227 offset:45056
v_mfma_f32_16x16x32_bf16 v[136:139], a[192:195], a[72:75], v[136:139]
s_add_u32 m0, s3, 12288
v_mfma_f32_16x16x32_bf16 v[168:171], a[192:195], a[76:79], v[168:171]
s_add_u32 s48, s43, 202752
ds_read_b64_tr_b16 a[192:193], v220 offset:49152
ds_read_b64_tr_b16 a[194:195], v220 offset:53248
v_mfma_f32_16x16x32_bf16 v[140:143], a[196:199], a[72:75], v[140:143]
s_waitcnt lgkmcnt(10)
buffer_load_dwordx4 v236, s[16:19], s48 offen lds
v_mfma_f32_16x16x32_bf16 v[172:175], a[196:199], a[76:79], v[172:175]
s_add_u32 m0, s3, 16384
ds_read_b64_tr_b16 a[196:197], v221 offset:49152
ds_read_b64_tr_b16 a[198:199], v221 offset:53248
v_mfma_f32_16x16x32_bf16 v[144:147], a[200:203], a[72:75], v[144:147]
s_add_u32 s48, s43, 221184
v_mfma_f32_16x16x32_bf16 v[176:179], a[200:203], a[76:79], v[176:179]
buffer_load_dwordx4 v236, s[16:19], s48 offen lds
v_mfma_f32_16x16x32_bf16 v[148:151], a[204:207], a[72:75], v[148:151]
s_add_u32 m0, s3, 20480
ds_read_b64_tr_b16 a[200:201], v222 offset:49152
ds_read_b64_tr_b16 a[202:203], v222 offset:53248
v_mfma_f32_16x16x32_bf16 v[180:183], a[204:207], a[76:79], v[180:183]
s_waitcnt lgkmcnt(8)
s_add_u32 s48, s43, 239616
ds_read_b64_tr_b16 a[204:205], v223 offset:49152
ds_read_b64_tr_b16 a[206:207], v223 offset:53248
v_mfma_f32_16x16x32_bf16 v[152:155], a[208:211], a[72:75], v[152:155]
buffer_load_dwordx4 v236, s[16:19], s48 offen lds
v_mfma_f32_16x16x32_bf16 v[184:187], a[208:211], a[76:79], v[184:187]
ds_read_b64_tr_b16 a[208:209], v224 offset:49152
ds_read_b64_tr_b16 a[210:211], v224 offset:53248
v_mfma_f32_16x16x32_bf16 v[156:159], a[212:215], a[72:75], v[156:159]
s_add_u32 m0, s3, 24576
v_mfma_f32_16x16x32_bf16 v[188:191], a[212:215], a[76:79], v[188:191]
s_add_u32 s48, s43, 258048
ds_read_b64_tr_b16 a[212:213], v225 offset:49152
ds_read_b64_tr_b16 a[214:215], v225 offset:53248
v_mfma_f32_16x16x32_bf16 v[160:163], a[216:219], a[72:75], v[160:163]
buffer_load_dwordx4 v236, s[16:19], s48 offen lds
v_mfma_f32_16x16x32_bf16 v[192:195], a[216:219], a[76:79], v[192:195]
s_waitcnt lgkmcnt(8)
ds_read_b64_tr_b16 a[216:217], v226 offset:49152
ds_read_b64_tr_b16 a[218:219], v226 offset:53248
v_mfma_f32_16x16x32_bf16 v[164:167], a[220:223], a[72:75], v[164:167]
v_mfma_f32_16x16x32_bf16 v[196:199], a[220:223], a[76:79], v[196:199]
ds_read_b64_tr_b16 a[220:221], v227 offset:49152
ds_read_b64_tr_b16 a[222:223], v227 offset:53248
v_mfma_f32_16x16x32_bf16 v[136:139], a[192:195], a[80:83], v[136:139]
s_add_u32 m0, s3, 28672
v_mfma_f32_16x16x32_bf16 v[168:171], a[192:195], a[84:87], v[168:171]
s_add_u32 s48, s43, 276480
ds_read_b64_tr_b16 a[192:193], v220 offset:57344
ds_read_b64_tr_b16 a[194:195], v220 offset:61440
v_mfma_f32_16x16x32_bf16 v[140:143], a[196:199], a[80:83], v[140:143]
buffer_load_dwordx4 v236, s[16:19], s48 offen lds
v_mfma_f32_16x16x32_bf16 v[172:175], a[196:199], a[84:87], v[172:175]
s_waitcnt lgkmcnt(8)
ds_read_b64_tr_b16 a[196:197], v221 offset:57344
ds_read_b64_tr_b16 a[198:199], v221 offset:61440
v_mfma_f32_16x16x32_bf16 v[144:147], a[200:203], a[80:83], v[144:147]
s_add_u32 s94, s88, 0
v_mfma_f32_16x16x32_bf16 v[176:179], a[200:203], a[84:87], v[176:179]
buffer_store_dwordx2 v[72:73], v250, s[20:23], s94 offen sc0 sc1
v_mfma_f32_16x16x32_bf16 v[148:151], a[204:207], a[80:83], v[148:151]
ds_read_b64_tr_b16 a[200:201], v222 offset:57344
ds_read_b64_tr_b16 a[202:203], v222 offset:61440
v_mfma_f32_16x16x32_bf16 v[180:183], a[204:207], a[84:87], v[180:183]
ds_read_b64_tr_b16 a[204:205], v223 offset:57344
ds_read_b64_tr_b16 a[206:207], v223 offset:61440
v_mfma_f32_16x16x32_bf16 v[152:155], a[208:211], a[80:83], v[152:155]
s_waitcnt lgkmcnt(10)
v_mfma_f32_16x16x32_bf16 v[184:187], a[208:211], a[84:87], v[184:187]
s_add_u32 s94, s88, 8192
ds_read_b64_tr_b16 a[208:209], v224 offset:57344
ds_read_b64_tr_b16 a[210:211], v224 offset:61440
v_mfma_f32_16x16x32_bf16 v[156:159], a[212:215], a[80:83], v[156:159]
buffer_store_dwordx2 v[76:77], v250, s[20:23], s94 offen sc0 sc1
v_mfma_f32_16x16x32_bf16 v[188:191], a[212:215], a[84:87], v[188:191]
ds_read_b64_tr_b16 a[212:213], v225 offset:57344
ds_read_b64_tr_b16 a[214:215], v225 offset:61440
v_mfma_f32_16x16x32_bf16 v[160:163], a[216:219], a[80:83], v[160:163]
s_waitcnt lgkmcnt(10)
v_mfma_f32_16x16x32_bf16 v[192:195], a[216:219], a[84:87], v[192:195]
s_add_u32 s94, s88, 16384
ds_read_b64_tr_b16 a[216:217], v226 offset:57344
ds_read_b64_tr_b16 a[218:219], v226 offset:61440
v_mfma_f32_16x16x32_bf16 v[164:167], a[220:223], a[80:83], v[164:167]
buffer_store_dwordx2 v[80:81], v250, s[20:23], s94 offen sc0 sc1
v_mfma_f32_16x16x32_bf16 v[196:199], a[220:223], a[84:87], v[196:199]
ds_read_b64_tr_b16 a[220:221], v227 offset:57344
ds_read_b64_tr_b16 a[222:223], v227 offset:61440
v_mfma_f32_16x16x32_bf16 v[136:139], a[192:195], a[88:91], v[136:139]
v_mfma_f32_16x16x32_bf16 v[168:171], a[192:195], a[92:95], v[168:171]
s_waitcnt lgkmcnt(8)
v_mfma_f32_16x16x32_bf16 v[140:143], a[196:199], a[88:91], v[140:143]
v_mfma_f32_16x16x32_bf16 v[172:175], a[196:199], a[92:95], v[172:175]
v_mfma_f32_16x16x32_bf16 v[144:147], a[200:203], a[88:91], v[144:147]
s_waitcnt vmcnt(19) lgkmcnt(0)
s_barrier
v_mfma_f32_16x16x32_bf16 v[176:179], a[200:203], a[92:95], v[176:179]
ds_read_b64_tr_b16 a[192:193], v208 offset:0
ds_read_b64_tr_b16 a[194:195], v208 offset:4096
v_mfma_f32_16x16x32_bf16 v[148:151], a[204:207], a[88:91], v[148:151]
s_add_u32 s94, s88, 24576
ds_read_b64_tr_b16 a[196:197], v209 offset:0
ds_read_b64_tr_b16 a[198:199], v209 offset:4096
v_mfma_f32_16x16x32_bf16 v[180:183], a[204:207], a[92:95], v[180:183]
buffer_store_dwordx2 v[84:85], v250, s[20:23], s94 offen sc0 sc1
v_mfma_f32_16x16x32_bf16 v[152:155], a[208:211], a[88:91], v[152:155]
ds_read_b64_tr_b16 a[200:201], v210 offset:0
ds_read_b64_tr_b16 a[202:203], v210 offset:4096
v_mfma_f32_16x16x32_bf16 v[184:187], a[208:211], a[92:95], v[184:187]
ds_read_b64_tr_b16 a[204:205], v211 offset:0
ds_read_b64_tr_b16 a[206:207], v211 offset:4096
v_mfma_f32_16x16x32_bf16 v[156:159], a[212:215], a[88:91], v[156:159]
s_add_u32 s94, s89, 0
ds_read_b64_tr_b16 a[208:209], v212 offset:0
ds_read_b64_tr_b16 a[210:211], v212 offset:4096
v_mfma_f32_16x16x32_bf16 v[188:191], a[212:215], a[92:95], v[188:191]
buffer_store_dwordx2 v[88:89], v250, s[20:23], s94 offen sc0 sc1
v_mfma_f32_16x16x32_bf16 v[160:163], a[216:219], a[88:91], v[160:163]
ds_read_b64_tr_b16 a[212:213], v213 offset:0
ds_read_b64_tr_b16 a[214:215], v213 offset:4096
v_mfma_f32_16x16x32_bf16 v[192:195], a[216:219], a[92:95], v[192:195]
ds_read_b64_tr_b16 a[216:217], v214 offset:0
ds_read_b64_tr_b16 a[218:219], v214 offset:4096
v_mfma_f32_16x16x32_bf16 v[164:167], a[220:223], a[88:91], v[164:167]
v_mfma_f32_16x16x32_bf16 v[196:199], a[220:223], a[92:95], v[196:199]
s_waitcnt lgkmcnt(12)
ds_read_b64_tr_b16 a[220:221], v215 offset:0
ds_read_b64_tr_b16 a[222:223], v215 offset:4096
s_waitcnt vmcnt(13)
v_mfma_f32_16x16x32_bf16 v[136:139], a[192:195], a[96:99], v[136:139]
s_add_u32 s94, s89, 8192
v_mfma_f32_16x16x32_bf16 v[168:171], a[192:195], a[100:103], v[168:171]
s_waitcnt lgkmcnt(12)
buffer_store_dwordx2 v[92:93], v250, s[20:23], s94 offen sc0 sc1
v_mfma_f32_16x16x32_bf16 v[140:143], a[196:199], a[96:99], v[140:143]
ds_read_b64_tr_b16 a[192:193], v208 offset:8192
ds_read_b64_tr_b16 a[194:195], v208 offset:12288
v_mfma_f32_16x16x32_bf16 v[172:175], a[196:199], a[100:103], v[172:175]
s_waitcnt lgkmcnt(10)
ds_read_b64_tr_b16 a[196:197], v209 offset:8192
ds_read_b64_tr_b16 a[198:199], v209 offset:12288
v_mfma_f32_16x16x32_bf16 v[144:147], a[200:203], a[96:99], v[144:147]
s_add_u32 s94, s89, 16384
v_mfma_f32_16x16x32_bf16 v[176:179], a[200:203], a[100:103], v[176:179]
buffer_store_dwordx2 v[96:97], v250, s[20:23], s94 offen sc0 sc1
v_mfma_f32_16x16x32_bf16 v[148:151], a[204:207], a[96:99], v[148:151]
ds_read_b64_tr_b16 a[200:201], v210 offset:8192
ds_read_b64_tr_b16 a[202:203], v210 offset:12288
v_mfma_f32_16x16x32_bf16 v[180:183], a[204:207], a[100:103], v[180:183]
s_waitcnt lgkmcnt(8)
ds_read_b64_tr_b16 a[204:205], v211 offset:8192
ds_read_b64_tr_b16 a[206:207], v211 offset:12288
v_mfma_f32_16x16x32_bf16 v[152:155], a[208:211], a[96:99], v[152:155]
s_add_u32 s94, s89, 24576
v_mfma_f32_16x16x32_bf16 v[184:187], a[208:211], a[100:103], v[184:187]
buffer_store_dwordx2 v[100:101], v250, s[20:23], s94 offen sc0 sc1
v_mfma_f32_16x16x32_bf16 v[156:159], a[212:215], a[96:99], v[156:159]
ds_read_b64_tr_b16 a[208:209], v212 offset:8192
ds_read_b64_tr_b16 a[210:211], v212 offset:12288
v_mfma_f32_16x16x32_bf16 v[188:191], a[212:215], a[100:103], v[188:191]
ds_read_b64_tr_b16 a[212:213], v213 offset:8192
ds_read_b64_tr_b16 a[214:215], v213 offset:12288
v_mfma_f32_16x16x32_bf16 v[160:163], a[216:219], a[96:99], v[160:163]
s_add_u32 s94, s91, 8192
v_mfma_f32_16x16x32_bf16 v[192:195], a[216:219], a[100:103], v[192:195]
s_waitcnt lgkmcnt(8)
buffer_load_dwordx4 a[128:131], v234, s[20:23], s94 offen offset:0 sc0 sc1
v_mfma_f32_16x16x32_bf16 v[164:167], a[220:223], a[96:99], v[164:167]
ds_read_b64_tr_b16 a[216:217], v214 offset:8192
ds_read_b64_tr_b16 a[218:219], v214 offset:12288
v_mfma_f32_16x16x32_bf16 v[196:199], a[220:223], a[100:103], v[196:199]
ds_read_b64_tr_b16 a[220:221], v215 offset:8192
ds_read_b64_tr_b16 a[222:223], v215 offset:12288
v_mfma_f32_16x16x32_bf16 v[136:139], a[192:195], a[104:107], v[136:139]
s_add_u32 s94, s91, 8192
v_mfma_f32_16x16x32_bf16 v[168:171], a[192:195], a[108:111], v[168:171]
buffer_load_dwordx4 a[132:135], v234, s[20:23], s94 offen offset:1024 sc0 sc1
v_mfma_f32_16x16x32_bf16 v[140:143], a[196:199], a[104:107], v[140:143]
s_waitcnt lgkmcnt(8)
ds_read_b64_tr_b16 a[192:193], v208 offset:16384
ds_read_b64_tr_b16 a[194:195], v208 offset:20480
v_mfma_f32_16x16x32_bf16 v[172:175], a[196:199], a[108:111], v[172:175]
s_add_u32 s94, s91, 8192
ds_read_b64_tr_b16 a[196:197], v209 offset:16384
ds_read_b64_tr_b16 a[198:199], v209 offset:20480
v_mfma_f32_16x16x32_bf16 v[144:147], a[200:203], a[104:107], v[144:147]
buffer_load_dwordx4 a[136:139], v234, s[20:23], s94 offen offset:2048 sc0 sc1
v_mfma_f32_16x16x32_bf16 v[176:179], a[200:203], a[108:111], v[176:179]
s_add_u32 s94, s91, 8192
ds_read_b64_tr_b16 a[200:201], v210 offset:16384
ds_read_b64_tr_b16 a[202:203], v210 offset:20480
v_mfma_f32_16x16x32_bf16 v[148:151], a[204:207], a[104:107], v[148:151]
s_waitcnt lgkmcnt(10)
buffer_load_dwordx4 a[140:143], v234, s[20:23], s94 offen offset:3072 sc0 sc1
v_mfma_f32_16x16x32_bf16 v[180:183], a[204:207], a[108:111], v[180:183]
s_add_u32 s94, s91, 12288
ds_read_b64_tr_b16 a[204:205], v211 offset:16384
ds_read_b64_tr_b16 a[206:207], v211 offset:20480
v_mfma_f32_16x16x32_bf16 v[152:155], a[208:211], a[104:107], v[152:155]
buffer_load_dwordx4 a[144:147], v234, s[20:23], s94 offen offset:0 sc0 sc1
v_mfma_f32_16x16x32_bf16 v[184:187], a[208:211], a[108:111], v[184:187]
ds_read_b64_tr_b16 a[208:209], v212 offset:16384
ds_read_b64_tr_b16 a[210:211], v212 offset:20480
v_mfma_f32_16x16x32_bf16 v[156:159], a[212:215], a[104:107], v[156:159]
s_add_u32 s94, s91, 12288
v_mfma_f32_16x16x32_bf16 v[188:191], a[212:215], a[108:111], v[188:191]
s_waitcnt lgkmcnt(10)
buffer_load_dwordx4 a[148:151], v234, s[20:23], s94 offen offset:1024 sc0 sc1
v_mfma_f32_16x16x32_bf16 v[160:163], a[216:219], a[104:107], v[160:163]
s_add_u32 s94, s91, 12288
ds_read_b64_tr_b16 a[212:213], v213 offset:16384
ds_read_b64_tr_b16 a[214:215], v213 offset:20480
v_mfma_f32_16x16x32_bf16 v[192:195], a[216:219], a[108:111], v[192:195]
buffer_load_dwordx4 a[152:155], v234, s[20:23], s94 offen offset:2048 sc0 sc1
v_mfma_f32_16x16x32_bf16 v[164:167], a[220:223], a[104:107], v[164:167]
ds_read_b64_tr_b16 a[216:217], v214 offset:16384
ds_read_b64_tr_b16 a[218:219], v214 offset:20480
v_mfma_f32_16x16x32_bf16 v[196:199], a[220:223], a[108:111], v[196:199]
s_waitcnt lgkmcnt(8)
ds_read_b64_tr_b16 a[220:221], v215 offset:16384
ds_read_b64_tr_b16 a[222:223], v215 offset:20480
v_mfma_f32_16x16x32_bf16 v[136:139], a[192:195], a[112:115], v[136:139]
s_add_u32 s94, s91, 12288
v_mfma_f32_16x16x32_bf16 v[168:171], a[192:195], a[116:119], v[168:171]
buffer_load_dwordx4 a[156:159], v234, s[20:23], s94 offen offset:3072 sc0 sc1
v_mfma_f32_16x16x32_bf16 v[140:143], a[196:199], a[112:115], v[140:143]
ds_read_b64_tr_b16 a[192:193], v208 offset:24576
ds_read_b64_tr_b16 a[194:195], v208 offset:28672
v_mfma_f32_16x16x32_bf16 v[172:175], a[196:199], a[116:119], v[172:175]
s_add_u32 m0, s3, 32768
ds_read_b64_tr_b16 a[196:197], v209 offset:24576
ds_read_b64_tr_b16 a[198:199], v209 offset:28672
v_mfma_f32_16x16x32_bf16 v[144:147], a[200:203], a[112:115], v[144:147]
s_add_u32 s48, s44, 147456
v_mfma_f32_16x16x32_bf16 v[176:179], a[200:203], a[116:119], v[176:179]
s_waitcnt lgkmcnt(10)
buffer_load_dwordx4 v236, s[16:19], s48 offen lds
v_mfma_f32_16x16x32_bf16 v[148:151], a[204:207], a[112:115], v[148:151]
ds_read_b64_tr_b16 a[200:201], v210 offset:24576
ds_read_b64_tr_b16 a[202:203], v210 offset:28672
v_mfma_f32_16x16x32_bf16 v[180:183], a[204:207], a[116:119], v[180:183]
s_add_u32 m0, s3, 36864
ds_read_b64_tr_b16 a[204:205], v211 offset:24576
ds_read_b64_tr_b16 a[206:207], v211 offset:28672
v_mfma_f32_16x16x32_bf16 v[152:155], a[208:211], a[112:115], v[152:155]
s_add_u32 s48, s44, 165888
v_mfma_f32_16x16x32_bf16 v[184:187], a[208:211], a[116:119], v[184:187]
s_waitcnt lgkmcnt(8)
buffer_load_dwordx4 v236, s[16:19], s48 offen lds
v_mfma_f32_16x16x32_bf16 v[156:159], a[212:215], a[112:115], v[156:159]
ds_read_b64_tr_b16 a[208:209], v212 offset:24576
ds_read_b64_tr_b16 a[210:211], v212 offset:28672
v_mfma_f32_16x16x32_bf16 v[188:191], a[212:215], a[116:119], v[188:191]
s_add_u32 m0, s3, 40960
ds_read_b64_tr_b16 a[212:213], v213 offset:24576
ds_read_b64_tr_b16 a[214:215], v213 offset:28672
v_mfma_f32_16x16x32_bf16 v[160:163], a[216:219], a[112:115], v[160:163]
s_add_u32 s48, s44, 184320
v_mfma_f32_16x16x32_bf16 v[192:195], a[216:219], a[116:119], v[192:195]
buffer_load_dwordx4 v236, s[16:19], s48 offen lds
v_mfma_f32_16x16x32_bf16 v[164:167], a[220:223], a[112:115], v[164:167]
ds_read_b64_tr_b16 a[216:217], v214 offset:24576
ds_read_b64_tr_b16 a[218:219], v214 offset:28672
v_mfma_f32_16x16x32_bf16 v[196:199], a[220:223], a[116:119], v[196:199]
s_waitcnt lgkmcnt(10)
ds_read_b64_tr_b16 a[220:221], v215 offset:24576
ds_read_b64_tr_b16 a[222:223], v215 offset:28672
v_mfma_f32_16x16x32_bf16 v[136:139], a[192:195], a[120:123], v[136:139]
v_mfma_f32_16x16x32_bf16 v[168:171], a[192:195], a[124:127], v[168:171]
v_mfma_f32_16x16x32_bf16 v[140:143], a[196:199], a[120:123], v[140:143]
v_mfma_f32_16x16x32_bf16 v[172:175], a[196:199], a[124:127], v[172:175]
s_waitcnt lgkmcnt(8)
v_mfma_f32_16x16x32_bf16 v[144:147], a[200:203], a[120:123], v[144:147]
s_waitcnt vmcnt(19) lgkmcnt(0)
s_barrier
v_mfma_f32_16x16x32_bf16 v[176:179], a[200:203], a[124:127], v[176:179]
s_add_u32 m0, s3, 45056
ds_read_b64_tr_b16 a[192:193], v200 offset:0
ds_read_b64_tr_b16 a[194:195], v200 offset:4096
v_mfma_f32_16x16x32_bf16 v[148:151], a[204:207], a[120:123], v[148:151]
s_add_u32 s48, s44, 202752
ds_read_b64_tr_b16 a[196:197], v201 offset:0
ds_read_b64_tr_b16 a[198:199], v201 offset:4096
v_mfma_f32_16x16x32_bf16 v[180:183], a[204:207], a[124:127], v[180:183]
buffer_load_dwordx4 v236, s[16:19], s48 offen lds
v_mfma_f32_16x16x32_bf16 v[152:155], a[208:211], a[120:123], v[152:155]
s_add_u32 m0, s3, 49152
ds_read_b64_tr_b16 a[200:201], v202 offset:0
ds_read_b64_tr_b16 a[202:203], v202 offset:4096
v_mfma_f32_16x16x32_bf16 v[184:187], a[208:211], a[124:127], v[184:187]
s_add_u32 s48, s44, 221184
ds_read_b64_tr_b16 a[204:205], v203 offset:0
ds_read_b64_tr_b16 a[206:207], v203 offset:4096
v_mfma_f32_16x16x32_bf16 v[156:159], a[212:215], a[120:123], v[156:159]
buffer_load_dwordx4 v236, s[16:19], s48 offen lds
v_mfma_f32_16x16x32_bf16 v[188:191], a[212:215], a[124:127], v[188:191]
ds_read_b64_tr_b16 a[208:209], v204 offset:0
ds_read_b64_tr_b16 a[210:211], v204 offset:4096
v_mfma_f32_16x16x32_bf16 v[160:163], a[216:219], a[120:123], v[160:163]
s_add_u32 m0, s3, 53248
ds_read_b64_tr_b16 a[212:213], v205 offset:0
ds_read_b64_tr_b16 a[214:215], v205 offset:4096
v_mfma_f32_16x16x32_bf16 v[192:195], a[216:219], a[124:127], v[192:195]
s_add_u32 s48, s44, 239616
ds_read_b64_tr_b16 a[216:217], v206 offset:0
ds_read_b64_tr_b16 a[218:219], v206 offset:4096
v_mfma_f32_16x16x32_bf16 v[164:167], a[220:223], a[120:123], v[164:167]
buffer_load_dwordx4 v236, s[16:19], s48 offen lds
v_mfma_f32_16x16x32_bf16 v[196:199], a[220:223], a[124:127], v[196:199]
s_waitcnt lgkmcnt(12)
ds_read_b64_tr_b16 a[220:221], v207 offset:0
ds_read_b64_tr_b16 a[222:223], v207 offset:4096
s_waitcnt vmcnt(6)
s_waitcnt vmcnt(14)
s_lshl_b32 s46, s33, 2
s_add_u32 s46, s46, s86
s_mov_b64 exec, 1
buffer_store_dword v5, v234, s[20:23], s46 offen sc0 sc1
s_mov_b64 exec, -1
v_mfma_f32_16x16x32_bf16 v[136:139], a[192:195], a[128:131], v[136:139]
s_add_u32 m0, s3, 57344
v_mfma_f32_16x16x32_bf16 v[168:171], a[192:195], a[132:135], v[168:171]
s_waitcnt lgkmcnt(12)
s_add_u32 s48, s44, 258048
ds_read_b64_tr_b16 a[192:193], v200 offset:8192
ds_read_b64_tr_b16 a[194:195], v200 offset:12288
v_mfma_f32_16x16x32_bf16 v[140:143], a[196:199], a[128:131], v[140:143]
s_waitcnt lgkmcnt(12)
buffer_load_dwordx4 v236, s[16:19], s48 offen lds
v_mfma_f32_16x16x32_bf16 v[172:175], a[196:199], a[132:135], v[172:175]
s_add_u32 m0, s3, 61440
ds_read_b64_tr_b16 a[196:197], v201 offset:8192
ds_read_b64_tr_b16 a[198:199], v201 offset:12288
v_mfma_f32_16x16x32_bf16 v[144:147], a[200:203], a[128:131], v[144:147]
s_add_u32 s48, s44, 276480
v_mfma_f32_16x16x32_bf16 v[176:179], a[200:203], a[132:135], v[176:179]
s_waitcnt lgkmcnt(10)
buffer_load_dwordx4 v236, s[16:19], s48 offen lds
v_mfma_f32_16x16x32_bf16 v[148:151], a[204:207], a[128:131], v[148:151]
ds_read_b64_tr_b16 a[200:201], v202 offset:8192
ds_read_b64_tr_b16 a[202:203], v202 offset:12288
v_mfma_f32_16x16x32_bf16 v[180:183], a[204:207], a[132:135], v[180:183]
s_add_u32 s94, s92, 8192
ds_read_b64_tr_b16 a[204:205], v203 offset:8192
ds_read_b64_tr_b16 a[206:207], v203 offset:12288
v_mfma_f32_16x16x32_bf16 v[152:155], a[208:211], a[128:131], v[152:155]
buffer_load_dwordx4 a[160:163], v234, s[20:23], s94 offen offset:0 sc0 sc1
v_mfma_f32_16x16x32_bf16 v[184:187], a[208:211], a[132:135], v[184:187]
s_waitcnt lgkmcnt(8)
ds_read_b64_tr_b16 a[208:209], v204 offset:8192
ds_read_b64_tr_b16 a[210:211], v204 offset:12288
v_mfma_f32_16x16x32_bf16 v[156:159], a[212:215], a[128:131], v[156:159]
s_add_u32 s94, s92, 8192
v_mfma_f32_16x16x32_bf16 v[188:191], a[212:215], a[132:135], v[188:191]
buffer_load_dwordx4 a[164:167], v234, s[20:23], s94 offen offset:1024 sc0 sc1
v_mfma_f32_16x16x32_bf16 v[160:163], a[216:219], a[128:131], v[160:163]
ds_read_b64_tr_b16 a[212:213], v205 offset:8192
ds_read_b64_tr_b16 a[214:215], v205 offset:12288
v_mfma_f32_16x16x32_bf16 v[192:195], a[216:219], a[132:135], v[192:195]
ds_read_b64_tr_b16 a[216:217], v206 offset:8192
ds_read_b64_tr_b16 a[218:219], v206 offset:12288
v_mfma_f32_16x16x32_bf16 v[164:167], a[220:223], a[128:131], v[164:167]
v_mfma_f32_16x16x32_bf16 v[196:199], a[220:223], a[132:135], v[196:199]
s_waitcnt lgkmcnt(10)
ds_read_b64_tr_b16 a[220:221], v207 offset:8192
ds_read_b64_tr_b16 a[222:223], v207 offset:12288
v_mfma_f32_16x16x32_bf16 v[136:139], a[192:195], a[136:139], v[136:139]
s_add_u32 s94, s92, 8192
v_mfma_f32_16x16x32_bf16 v[168:171], a[192:195], a[140:143], v[168:171]
buffer_load_dwordx4 a[168:171], v234, s[20:23], s94 offen offset:2048 sc0 sc1
v_mfma_f32_16x16x32_bf16 v[140:143], a[196:199], a[136:139], v[140:143]
s_add_u32 s94, s92, 8192
ds_read_b64_tr_b16 a[192:193], v200 offset:16384
ds_read_b64_tr_b16 a[194:195], v200 offset:20480
v_mfma_f32_16x16x32_bf16 v[172:175], a[196:199], a[140:143], v[172:175]
s_waitcnt lgkmcnt(8)
buffer_load_dwordx4 a[172:175], v234, s[20:23], s94 offen offset:3072 sc0 sc1
v_mfma_f32_16x16x32_bf16 v[144:147], a[200:203], a[136:139], v[144:147]
ds_read_b64_tr_b16 a[196:197], v201 offset:16384
ds_read_b64_tr_b16 a[198:199], v201 offset:20480
v_mfma_f32_16x16x32_bf16 v[176:179], a[200:203], a[140:143], v[176:179]
s_add_u32 s94, s92, 12288
ds_read_b64_tr_b16 a[200:201], v202 offset:16384
ds_read_b64_tr_b16 a[202:203], v202 offset:20480
v_mfma_f32_16x16x32_bf16 v[148:151], a[204:207], a[136:139], v[148:151]
buffer_load_dwordx4 a[176:179], v234, s[20:23], s94 offen offset:0 sc0 sc1
v_mfma_f32_16x16x32_bf16 v[180:183], a[204:207], a[140:143], v[180:183]
ds_read_b64_tr_b16 a[204:205], v203 offset:16384
ds_read_b64_tr_b16 a[206:207], v203 offset:20480
v_mfma_f32_16x16x32_bf16 v[152:155], a[208:211], a[136:139], v[152:155]
s_add_u32 s94, s92, 12288
v_mfma_f32_16x16x32_bf16 v[184:187], a[208:211], a[140:143], v[184:187]
s_waitcnt lgkmcnt(8)
buffer_load_dwordx4 a[180:183], v234, s[20:23], s94 offen offset:1024 sc0 sc1
v_mfma_f32_16x16x32_bf16 v[156:159], a[212:215], a[136:139], v[156:159]
ds_read_b64_tr_b16 a[208:209], v204 offset:16384
ds_read_b64_tr_b16 a[210:211], v204 offset:20480
v_mfma_f32_16x16x32_bf16 v[188:191], a[212:215], a[140:143], v[188:191]
s_add_u32 s94, s92, 12288
ds_read_b64_tr_b16 a[212:213], v205 offset:16384
ds_read_b64_tr_b16 a[214:215], v205 offset:20480
v_mfma_f32_16x16x32_bf16 v[160:163], a[216:219], a[136:139], v[160:163]
buffer_load_dwordx4 a[184:187], v234, s[20:23], s94 offen offset:2048 sc0 sc1
v_mfma_f32_16x16x32_bf16 v[192:195], a[216:219], a[140:143], v[192:195]
ds_read_b64_tr_b16 a[216:217], v206 offset:16384
ds_read_b64_tr_b16 a[218:219], v206 offset:20480
v_mfma_f32_16x16x32_bf16 v[164:167], a[220:223], a[136:139], v[164:167]
v_mfma_f32_16x16x32_bf16 v[196:199], a[220:223], a[140:143], v[196:199]
s_waitcnt lgkmcnt(8)
ds_read_b64_tr_b16 a[220:221], v207 offset:16384
ds_read_b64_tr_b16 a[222:223], v207 offset:20480
v_mfma_f32_16x16x32_bf16 v[136:139], a[192:195], a[144:147], v[136:139]
s_add_u32 s94, s92, 12288
v_mfma_f32_16x16x32_bf16 v[168:171], a[192:195], a[148:151], v[168:171]
buffer_load_dwordx4 a[188:191], v234, s[20:23], s94 offen offset:3072 sc0 sc1
v_mfma_f32_16x16x32_bf16 v[140:143], a[196:199], a[144:147], v[140:143]
ds_read_b64_tr_b16 a[192:193], v200 offset:24576
ds_read_b64_tr_b16 a[194:195], v200 offset:28672
v_mfma_f32_16x16x32_bf16 v[172:175], a[196:199], a[148:151], v[172:175]
ds_read_b64_tr_b16 a[196:197], v201 offset:24576
ds_read_b64_tr_b16 a[198:199], v201 offset:28672
v_mfma_f32_16x16x32_bf16 v[144:147], a[200:203], a[144:147], v[144:147]
v_mfma_f32_16x16x32_bf16 v[176:179], a[200:203], a[148:151], v[176:179]
s_waitcnt lgkmcnt(8)
ds_read_b64_tr_b16 a[200:201], v202 offset:24576
ds_read_b64_tr_b16 a[202:203], v202 offset:28672
v_mfma_f32_16x16x32_bf16 v[148:151], a[204:207], a[144:147], v[148:151]
v_mfma_f32_16x16x32_bf16 v[180:183], a[204:207], a[148:151], v[180:183]
ds_read_b64_tr_b16 a[204:205], v203 offset:24576
ds_read_b64_tr_b16 a[206:207], v203 offset:28672
v_mfma_f32_16x16x32_bf16 v[152:155], a[208:211], a[144:147], v[152:155]
v_mfma_f32_16x16x32_bf16 v[184:187], a[208:211], a[148:151], v[184:187]
ds_read_b64_tr_b16 a[208:209], v204 offset:24576
ds_read_b64_tr_b16 a[210:211], v204 offset:28672
v_mfma_f32_16x16x32_bf16 v[156:159], a[212:215], a[144:147], v[156:159]
v_mfma_f32_16x16x32_bf16 v[188:191], a[212:215], a[148:151], v[188:191]
s_waitcnt lgkmcnt(10)
ds_read_b64_tr_b16 a[212:213], v205 offset:24576
ds_read_b64_tr_b16 a[214:215], v205 offset:28672
v_mfma_f32_16x16x32_bf16 v[160:163], a[216:219], a[144:147], v[160:163]
v_mfma_f32_16x16x32_bf16 v[192:195], a[216:219], a[148:151], v[192:195]
ds_read_b64_tr_b16 a[216:217], v206 offset:24576
ds_read_b64_tr_b16 a[218:219], v206 offset:28672
v_mfma_f32_16x16x32_bf16 v[164:167], a[220:223], a[144:147], v[164:167]
v_mfma_f32_16x16x32_bf16 v[196:199], a[220:223], a[148:151], v[196:199]
s_waitcnt lgkmcnt(8)
ds_read_b64_tr_b16 a[220:221], v207 offset:24576
ds_read_b64_tr_b16 a[222:223], v207 offset:28672
v_mfma_f32_16x16x32_bf16 v[136:139], a[192:195], a[152:155], v[136:139]
v_mfma_f32_16x16x32_bf16 v[168:171], a[192:195], a[156:159], v[168:171]
v_mfma_f32_16x16x32_bf16 v[140:143], a[196:199], a[152:155], v[140:143]
v_mfma_f32_16x16x32_bf16 v[172:175], a[196:199], a[156:159], v[172:175]
v_mfma_f32_16x16x32_bf16 v[144:147], a[200:203], a[152:155], v[144:147]
s_waitcnt vmcnt(8) lgkmcnt(0)
s_barrier
v_mfma_f32_16x16x32_bf16 v[176:179], a[200:203], a[156:159], v[176:179]
ds_read_b64_tr_b16 a[192:193], v200 offset:32768
ds_read_b64_tr_b16 a[194:195], v200 offset:36864
v_mfma_f32_16x16x32_bf16 v[148:151], a[204:207], a[152:155], v[148:151]
ds_read_b64_tr_b16 a[196:197], v201 offset:32768
ds_read_b64_tr_b16 a[198:199], v201 offset:36864
v_mfma_f32_16x16x32_bf16 v[180:183], a[204:207], a[156:159], v[180:183]
ds_read_b64_tr_b16 a[200:201], v202 offset:32768
ds_read_b64_tr_b16 a[202:203], v202 offset:36864
v_mfma_f32_16x16x32_bf16 v[152:155], a[208:211], a[152:155], v[152:155]
ds_read_b64_tr_b16 a[204:205], v203 offset:32768
ds_read_b64_tr_b16 a[206:207], v203 offset:36864
v_mfma_f32_16x16x32_bf16 v[184:187], a[208:211], a[156:159], v[184:187]
ds_read_b64_tr_b16 a[208:209], v204 offset:32768
ds_read_b64_tr_b16 a[210:211], v204 offset:36864
v_mfma_f32_16x16x32_bf16 v[156:159], a[212:215], a[152:155], v[156:159]
v_mfma_f32_16x16x32_bf16 v[188:191], a[212:215], a[156:159], v[188:191]
ds_read_b64_tr_b16 a[212:213], v205 offset:32768
ds_read_b64_tr_b16 a[214:215], v205 offset:36864
v_mfma_f32_16x16x32_bf16 v[160:163], a[216:219], a[152:155], v[160:163]
v_mfma_f32_16x16x32_bf16 v[192:195], a[216:219], a[156:159], v[192:195]
ds_read_b64_tr_b16 a[216:217], v206 offset:32768
ds_read_b64_tr_b16 a[218:219], v206 offset:36864
v_mfma_f32_16x16x32_bf16 v[164:167], a[220:223], a[152:155], v[164:167]
v_mfma_f32_16x16x32_bf16 v[196:199], a[220:223], a[156:159], v[196:199]
s_waitcnt lgkmcnt(12)
ds_read_b64_tr_b16 a[220:221], v207 offset:32768
ds_read_b64_tr_b16 a[222:223], v207 offset:36864
s_waitcnt vmcnt(0)
v_mfma_f32_16x16x32_bf16 v[136:139], a[192:195], a[160:163], v[136:139]
v_mfma_f32_16x16x32_bf16 v[168:171], a[192:195], a[164:167], v[168:171]
s_waitcnt lgkmcnt(10)
ds_read_b64_tr_b16 a[192:193], v200 offset:40960
ds_read_b64_tr_b16 a[194:195], v200 offset:45056
v_mfma_f32_16x16x32_bf16 v[140:143], a[196:199], a[160:163], v[140:143]
v_mfma_f32_16x16x32_bf16 v[172:175], a[196:199], a[164:167], v[172:175]
ds_read_b64_tr_b16 a[196:197], v201 offset:40960
ds_read_b64_tr_b16 a[198:199], v201 offset:45056
v_mfma_f32_16x16x32_bf16 v[144:147], a[200:203], a[160:163], v[144:147]
v_mfma_f32_16x16x32_bf16 v[176:179], a[200:203], a[164:167], v[176:179]
s_waitcnt lgkmcnt(8)
ds_read_b64_tr_b16 a[200:201], v202 offset:40960
ds_read_b64_tr_b16 a[202:203], v202 offset:45056
v_mfma_f32_16x16x32_bf16 v[148:151], a[204:207], a[160:163], v[148:151]
v_mfma_f32_16x16x32_bf16 v[180:183], a[204:207], a[164:167], v[180:183]
ds_read_b64_tr_b16 a[204:205], v203 offset:40960
ds_read_b64_tr_b16 a[206:207], v203 offset:45056
v_mfma_f32_16x16x32_bf16 v[152:155], a[208:211], a[160:163], v[152:155]
v_mfma_f32_16x16x32_bf16 v[184:187], a[208:211], a[164:167], v[184:187]
ds_read_b64_tr_b16 a[208:209], v204 offset:40960
ds_read_b64_tr_b16 a[210:211], v204 offset:45056
v_mfma_f32_16x16x32_bf16 v[156:159], a[212:215], a[160:163], v[156:159]
v_mfma_f32_16x16x32_bf16 v[188:191], a[212:215], a[164:167], v[188:191]
s_waitcnt lgkmcnt(8)
ds_read_b64_tr_b16 a[212:213], v205 offset:40960
ds_read_b64_tr_b16 a[214:215], v205 offset:45056
v_mfma_f32_16x16x32_bf16 v[160:163], a[216:219], a[160:163], v[160:163]
v_mfma_f32_16x16x32_bf16 v[192:195], a[216:219], a[164:167], v[192:195]
ds_read_b64_tr_b16 a[216:217], v206 offset:40960
ds_read_b64_tr_b16 a[218:219], v206 offset:45056
v_mfma_f32_16x16x32_bf16 v[164:167], a[220:223], a[160:163], v[164:167]
v_mfma_f32_16x16x32_bf16 v[196:199], a[220:223], a[164:167], v[196:199]
ds_read_b64_tr_b16 a[220:221], v207 offset:40960
ds_read_b64_tr_b16 a[222:223], v207 offset:45056
v_cmp_gt_u32 vcc, 16, v248
v_lshlrev_b32 v6, 7, v3
v_add_u32 v6, 0x272800, v6
s_and_b32 s93, vcc_lo, 0xff
s_cselect_b32 s47, 0, 0x7f000000
v_mfma_f32_16x16x32_bf16 v[136:139], a[192:195], a[168:171], v[136:139]
buffer_load_dword v246, v7, s[20:23], s86 offen sc0 sc1
v_mfma_f32_16x16x32_bf16 v[168:171], a[192:195], a[172:175], v[168:171]
s_waitcnt lgkmcnt(8)
ds_read_b64_tr_b16 a[192:193], v200 offset:49152
ds_read_b64_tr_b16 a[194:195], v200 offset:53248
v_mfma_f32_16x16x32_bf16 v[140:143], a[196:199], a[168:171], v[140:143]
v_mfma_f32_16x16x32_bf16 v[172:175], a[196:199], a[172:175], v[172:175]
ds_read_b64_tr_b16 a[196:197], v201 offset:49152
ds_read_b64_tr_b16 a[198:199], v201 offset:53248
v_mfma_f32_16x16x32_bf16 v[144:147], a[200:203], a[168:171], v[144:147]
buffer_load_dword v247, v6, s[20:23], s47 offen sc0 sc1
v_mfma_f32_16x16x32_bf16 v[176:179], a[200:203], a[172:175], v[176:179]
ds_read_b64_tr_b16 a[200:201], v202 offset:49152
ds_read_b64_tr_b16 a[202:203], v202 offset:53248
v_mfma_f32_16x16x32_bf16 v[148:151], a[204:207], a[168:171], v[148:151]
v_mfma_f32_16x16x32_bf16 v[180:183], a[204:207], a[172:175], v[180:183]
s_waitcnt lgkmcnt(8)
ds_read_b64_tr_b16 a[204:205], v203 offset:49152
ds_read_b64_tr_b16 a[206:207], v203 offset:53248
v_mfma_f32_16x16x32_bf16 v[152:155], a[208:211], a[168:171], v[152:155]
v_mfma_f32_16x16x32_bf16 v[184:187], a[208:211], a[172:175], v[184:187]
ds_read_b64_tr_b16 a[208:209], v204 offset:49152
ds_read_b64_tr_b16 a[210:211], v204 offset:53248
v_mfma_f32_16x16x32_bf16 v[156:159], a[212:215], a[168:171], v[156:159]
v_mfma_f32_16x16x32_bf16 v[188:191], a[212:215], a[172:175], v[188:191]
ds_read_b64_tr_b16 a[212:213], v205 offset:49152
ds_read_b64_tr_b16 a[214:215], v205 offset:53248
v_mfma_f32_16x16x32_bf16 v[160:163], a[216:219], a[168:171], v[160:163]
v_mfma_f32_16x16x32_bf16 v[192:195], a[216:219], a[172:175], v[192:195]
s_waitcnt lgkmcnt(8)
ds_read_b64_tr_b16 a[216:217], v206 offset:49152
ds_read_b64_tr_b16 a[218:219], v206 offset:53248
v_mfma_f32_16x16x32_bf16 v[164:167], a[220:223], a[168:171], v[164:167]
v_mfma_f32_16x16x32_bf16 v[196:199], a[220:223], a[172:175], v[196:199]
ds_read_b64_tr_b16 a[220:221], v207 offset:49152
ds_read_b64_tr_b16 a[222:223], v207 offset:53248
v_mfma_f32_16x16x32_bf16 v[136:139], a[192:195], a[176:179], v[136:139]
v_mfma_f32_16x16x32_bf16 v[168:171], a[192:195], a[180:183], v[168:171]
ds_read_b64_tr_b16 a[192:193], v200 offset:57344
ds_read_b64_tr_b16 a[194:195], v200 offset:61440
v_mfma_f32_16x16x32_bf16 v[140:143], a[196:199], a[176:179], v[140:143]
v_mfma_f32_16x16x32_bf16 v[172:175], a[196:199], a[180:183], v[172:175]
s_waitcnt lgkmcnt(8)
ds_read_b64_tr_b16 a[196:197], v201 offset:57344
ds_read_b64_tr_b16 a[198:199], v201 offset:61440
v_mfma_f32_16x16x32_bf16 v[144:147], a[200:203], a[176:179], v[144:147]
v_mfma_f32_16x16x32_bf16 v[176:179], a[200:203], a[180:183], v[176:179]
ds_read_b64_tr_b16 a[200:201], v202 offset:57344
ds_read_b64_tr_b16 a[202:203], v202 offset:61440
v_mfma_f32_16x16x32_bf16 v[148:151], a[204:207], a[176:179], v[148:151]
v_mfma_f32_16x16x32_bf16 v[180:183], a[204:207], a[180:183], v[180:183]
ds_read_b64_tr_b16 a[204:205], v203 offset:57344
ds_read_b64_tr_b16 a[206:207], v203 offset:61440
v_mfma_f32_16x16x32_bf16 v[152:155], a[208:211], a[176:179], v[152:155]
v_mfma_f32_16x16x32_bf16 v[184:187], a[208:211], a[180:183], v[184:187]
s_waitcnt lgkmcnt(8)
ds_read_b64_tr_b16 a[208:209], v204 offset:57344
ds_read_b64_tr_b16 a[210:211], v204 offset:61440
v_mfma_f32_16x16x32_bf16 v[156:159], a[212:215], a[176:179], v[156:159]
v_mfma_f32_16x16x32_bf16 v[188:191], a[212:215], a[180:183], v[188:191]
ds_read_b64_tr_b16 a[212:213], v205 offset:57344
ds_read_b64_tr_b16 a[214:215], v205 offset:61440
v_mfma_f32_16x16x32_bf16 v[160:163], a[216:219], a[176:179], v[160:163]
v_mfma_f32_16x16x32_bf16 v[192:195], a[216:219], a[180:183], v[192:195]
ds_read_b64_tr_b16 a[216:217], v206 offset:57344
ds_read_b64_tr_b16 a[218:219], v206 offset:61440
v_mfma_f32_16x16x32_bf16 v[164:167], a[220:223], a[176:179], v[164:167]
v_mfma_f32_16x16x32_bf16 v[196:199], a[220:223], a[180:183], v[196:199]
s_waitcnt lgkmcnt(8)
ds_read_b64_tr_b16 a[220:221], v207 offset:57344
ds_read_b64_tr_b16 a[222:223], v207 offset:61440
v_mfma_f32_16x16x32_bf16 v[136:139], a[192:195], a[184:187], v[136:139]
v_mfma_f32_16x16x32_bf16 v[168:171], a[192:195], a[188:191], v[168:171]
v_mfma_f32_16x16x32_bf16 v[140:143], a[196:199], a[184:187], v[140:143]
v_mfma_f32_16x16x32_bf16 v[172:175], a[196:199], a[188:191], v[172:175]
v_mfma_f32_16x16x32_bf16 v[144:147], a[200:203], a[184:187], v[144:147]
v_mfma_f32_16x16x32_bf16 v[176:179], a[200:203], a[188:191], v[176:179]
s_waitcnt lgkmcnt(4)
v_mfma_f32_16x16x32_bf16 v[148:151], a[204:207], a[184:187], v[148:151]
v_mfma_f32_16x16x32_bf16 v[180:183], a[204:207], a[188:191], v[180:183]
v_mfma_f32_16x16x32_bf16 v[152:155], a[208:211], a[184:187], v[152:155]
v_mfma_f32_16x16x32_bf16 v[184:187], a[208:211], a[188:191], v[184:187]
v_mfma_f32_16x16x32_bf16 v[156:159], a[212:215], a[184:187], v[156:159]
v_mfma_f32_16x16x32_bf16 v[188:191], a[212:215], a[188:191], v[188:191]
s_waitcnt lgkmcnt(0)
v_mfma_f32_16x16x32_bf16 v[160:163], a[216:219], a[184:187], v[160:163]
v_mfma_f32_16x16x32_bf16 v[192:195], a[216:219], a[188:191], v[192:195]
v_mfma_f32_16x16x32_bf16 v[164:167], a[220:223], a[184:187], v[164:167]
v_mfma_f32_16x16x32_bf16 v[196:199], a[220:223], a[188:191], v[196:199]
s_lshl_b32 s95, s35, 2
s_add_u32 s95, s95, s63
s_lshl_b32 s46, s35, 7
s_add_u32 s63, s63, s46
v_cvt_pk_bf16_f32 v200, v168, v169
v_cvt_pk_bf16_f32 v201, v170, v171
v_cvt_pk_bf16_f32 v202, v172, v173
v_cvt_pk_bf16_f32 v203, v174, v175
buffer_store_dwordx4 v[200:203], v234, s[20:23], s65 offen offset:0 sc0 sc1
v_cvt_pk_bf16_f32 v204, v176, v177
v_cvt_pk_bf16_f32 v205, v178, v179
v_cvt_pk_bf16_f32 v206, v180, v181
v_cvt_pk_bf16_f32 v207, v182, v183
buffer_store_dwordx4 v[204:207], v234, s[20:23], s65 offen offset:1024 sc0 sc1
v_cvt_pk_bf16_f32 v208, v152, v153
v_cvt_pk_bf16_f32 v209, v154, v155
v_cvt_pk_bf16_f32 v210, v156, v157
v_cvt_pk_bf16_f32 v211, v158, v159
buffer_store_dwordx4 v[208:211], v234, s[20:23], s64 offen offset:0 sc0 sc1
v_cvt_pk_bf16_f32 v212, v160, v161
v_cvt_pk_bf16_f32 v213, v162, v163
v_cvt_pk_bf16_f32 v214, v164, v165
v_cvt_pk_bf16_f32 v215, v166, v167
buffer_store_dwordx4 v[212:215], v234, s[20:23], s64 offen offset:1024 sc0 sc1
v_cvt_pk_bf16_f32 v216, v184, v185
v_cvt_pk_bf16_f32 v217, v186, v187
v_cvt_pk_bf16_f32 v218, v188, v189
v_cvt_pk_bf16_f32 v219, v190, v191
buffer_store_dwordx4 v[216:219], v234, s[20:23], s66 offen offset:0 sc0 sc1
v_cvt_pk_bf16_f32 v220, v192, v193
v_cvt_pk_bf16_f32 v221, v194, v195
v_cvt_pk_bf16_f32 v222, v196, v197
v_cvt_pk_bf16_f32 v223, v198, v199
buffer_store_dwordx4 v[220:223], v234, s[20:23], s66 offen offset:1024 sc0 sc1
s_waitcnt vmcnt(6)
v_cmp_ne_u32 vcc, 1, v246
s_and_b32 s46, s35, 1
s_or_b32 s46, s46, vcc_lo
s_cselect_b32 s67, 0, 1
s_cbranch_scc1 K_NOER
s_add_u32 s48, s87, 4096
buffer_load_dwordx2 v[40:41], v250, s[20:23], s87 offen offset:0 sc0 sc1
buffer_load_dwordx2 v[42:43], v250, s[20:23], s87 offen offset:512 sc0 sc1
buffer_load_dwordx2 v[44:45], v250, s[20:23], s87 offen offset:1024 sc0 sc1
buffer_load_dwordx2 v[46:47], v250, s[20:23], s87 offen offset:1536 sc0 sc1
buffer_load_dwordx2 v[48:49], v250, s[20:23], s87 offen offset:2048 sc0 sc1
buffer_load_dwordx2 v[50:51], v250, s[20:23], s87 offen offset:2560 sc0 sc1
buffer_load_dwordx2 v[52:53], v250, s[20:23], s87 offen offset:3072 sc0 sc1
buffer_load_dwordx2 v[54:55], v250, s[20:23], s87 offen offset:3584 sc0 sc1
buffer_load_dwordx2 v[56:57], v250, s[20:23], s48 offen offset:0 sc0 sc1
buffer_load_dwordx2 v[58:59], v250, s[20:23], s48 offen offset:512 sc0 sc1
buffer_load_dwordx2 v[60:61], v250, s[20:23], s48 offen offset:1024 sc0 sc1
buffer_load_dwordx2 v[62:63], v250, s[20:23], s48 offen offset:1536 sc0 sc1
buffer_load_dwordx2 v[64:65], v250, s[20:23], s48 offen offset:2048 sc0 sc1
buffer_load_dwordx2 v[66:67], v250, s[20:23], s48 offen offset:2560 sc0 sc1
buffer_load_dwordx2 v[68:69], v250, s[20:23], s48 offen offset:3072 sc0 sc1
buffer_load_dwordx2 v[70:71], v250, s[20:23], s48 offen offset:3584 sc0 sc1
K_NOER:
v_lshlrev_b32 v30, 16, v120
v_and_b32 v31, s56, v120
v_lshlrev_b32 v32, 16, v121
v_and_b32 v33, s56, v121
v_pk_add_f32 v[30:31], v[30:31], v[130:131] op_sel_hi:[1,0] neg_lo:[0,1] neg_hi:[0,1]
v_pk_add_f32 v[32:33], v[32:33], v[130:131] op_sel_hi:[1,0] neg_lo:[0,1] neg_hi:[0,1]
v_cvt_pk_bf16_f32 v28, v30, v31
v_cvt_pk_bf16_f32 v29, v32, v33
v_lshlrev_b32 v30, 16, v28
v_and_b32 v31, s56, v28
v_lshlrev_b32 v32, 16, v29
v_and_b32 v33, s56, v29
v_pk_mul_f32 v[8:9], v[30:31], v[132:133] op_sel_hi:[1,0]
v_pk_mul_f32 v[10:11], v[32:33], v[132:133] op_sel_hi:[1,0]
v_pk_fma_f32 v[30:31], v[8:9], v[130:131], v[30:31] op_sel:[0,1,0] op_sel_hi:[1,1,1] neg_lo:[1,0,0] neg_hi:[1,0,0]
v_pk_fma_f32 v[32:33], v[10:11], v[130:131], v[32:33] op_sel:[0,1,0] op_sel_hi:[1,1,1] neg_lo:[1,0,0] neg_hi:[1,0,0]
v_pk_fma_f32 v[8:9], v[30:31], v[132:133], v[8:9] op_sel_hi:[1,0,1]
v_pk_fma_f32 v[10:11], v[32:33], v[132:133], v[10:11] op_sel_hi:[1,0,1]
v_cvt_pk_bf16_f32 v28, v8, v9
v_cvt_pk_bf16_f32 v29, v10, v11
v_lshlrev_b32 v8, 16, v28
v_and_b32 v9, s56, v28
v_lshlrev_b32 v10, 16, v29
v_and_b32 v11, s56, v29
v_mul_f32 v30, s57, v8
v_mul_f32 v31, s57, v9
v_mul_f32 v32, s57, v10
v_mul_f32 v33, s57, v11
v_exp_f32 v30, v30
v_exp_f32 v31, v31
v_exp_f32 v32, v32
v_exp_f32 v33, v33
s_nop 0
v_add_f32 v30, 1.0, v30
v_add_f32 v31, 1.0, v31
v_add_f32 v32, 1.0, v32
v_add_f32 v33, 1.0, v33
v_rcp_f32 v30, v30
v_rcp_f32 v31, v31
v_rcp_f32 v32, v32
v_rcp_f32 v33, v33
s_nop 0
v_pk_mul_f32 v[8:9], v[8:9], v[30:31]
v_pk_mul_f32 v[10:11], v[10:11], v[32:33]
v_cvt_pk_bf16_f32 v28, v8, v9
v_cvt_pk_bf16_f32 v29, v10, v11
v_lshlrev_b32 v8, 16, v28
v_and_b32 v9, s56, v28
v_lshlrev_b32 v10, 16, v29
v_and_b32 v11, s56, v29
v_lshlrev_b32 v30, 16, v122
v_and_b32 v31, s56, v122
v_lshlrev_b32 v32, 16, v123
v_and_b32 v33, s56, v123
v_pk_add_f32 v[30:31], v[30:31], v[130:131] op_sel_hi:[1,0] neg_lo:[0,1] neg_hi:[0,1]
v_pk_add_f32 v[32:33], v[32:33], v[130:131] op_sel_hi:[1,0] neg_lo:[0,1] neg_hi:[0,1]
v_cvt_pk_bf16_f32 v28, v30, v31
v_cvt_pk_bf16_f32 v29, v32, v33
v_lshlrev_b32 v30, 16, v28
v_and_b32 v31, s56, v28
v_lshlrev_b32 v32, 16, v29
v_and_b32 v33, s56, v29
v_pk_mul_f32 v[12:13], v[30:31], v[132:133] op_sel_hi:[1,0]
v_pk_mul_f32 v[14:15], v[32:33], v[132:133] op_sel_hi:[1,0]
v_pk_fma_f32 v[30:31], v[12:13], v[130:131], v[30:31] op_sel:[0,1,0] op_sel_hi:[1,1,1] neg_lo:[1,0,0] neg_hi:[1,0,0]
v_pk_fma_f32 v[32:33], v[14:15], v[130:131], v[32:33] op_sel:[0,1,0] op_sel_hi:[1,1,1] neg_lo:[1,0,0] neg_hi:[1,0,0]
v_pk_fma_f32 v[12:13], v[30:31], v[132:133], v[12:13] op_sel_hi:[1,0,1]
v_pk_fma_f32 v[14:15], v[32:33], v[132:133], v[14:15] op_sel_hi:[1,0,1]
v_cvt_pk_bf16_f32 v28, v12, v13
v_cvt_pk_bf16_f32 v29, v14, v15
v_lshlrev_b32 v12, 16, v28
v_and_b32 v13, s56, v28
v_lshlrev_b32 v14, 16, v29
v_and_b32 v15, s56, v29
v_mul_f32 v30, s57, v12
v_mul_f32 v31, s57, v13
v_mul_f32 v32, s57, v14
v_mul_f32 v33, s57, v15
v_exp_f32 v30, v30
v_exp_f32 v31, v31
v_exp_f32 v32, v32
v_exp_f32 v33, v33
s_nop 0
v_add_f32 v30, 1.0, v30
v_add_f32 v31, 1.0, v31
v_add_f32 v32, 1.0, v32
v_add_f32 v33, 1.0, v33
v_rcp_f32 v30, v30
v_rcp_f32 v31, v31
v_rcp_f32 v32, v32
v_rcp_f32 v33, v33
s_nop 0
v_pk_mul_f32 v[12:13], v[12:13], v[30:31]
v_pk_mul_f32 v[14:15], v[14:15], v[32:33]
v_cvt_pk_bf16_f32 v28, v12, v13
v_cvt_pk_bf16_f32 v29, v14, v15
v_lshlrev_b32 v12, 16, v28
v_and_b32 v13, s56, v28
v_lshlrev_b32 v14, 16, v29
v_and_b32 v15, s56, v29
s_mov_b32 s47, s67
s_and_b32 s46, s35, 1
s_or_b32 s67, s67, s46
s_cselect_b32 s46, 0, 16
v_and_b32 v153, 3, v1
v_lshl_add_u32 v153, v153, 2, s63
v_add_u32 v7, s86, v7
v_cmp_gt_u32 vcc, s46, v1
s_add_u32 s48, s35, 16
s_nop 0
v_cndmask_b32 v152, v153, v7, vcc
s_waitcnt vmcnt(16)
s_cmp_lg_u32 s47, 0
s_cbranch_scc1 K_FLAGGED
s_waitcnt vmcnt(0)
K_FLAGGED:
buffer_load_dword v246, v152, s[20:23], 0 offen sc0 sc1
s_mov_b32 exec_lo, s38
s_mov_b32 exec_hi, 0
buffer_store_dword v5, v249, s[20:23], s95 offen sc0 sc1
s_mov_b64 exec, -1
v_lshlrev_b32 v30, 16, v124
v_and_b32 v31, s56, v124
v_lshlrev_b32 v32, 16, v125
v_and_b32 v33, s56, v125
v_pk_add_f32 v[30:31], v[30:31], v[130:131] op_sel_hi:[1,0] neg_lo:[0,1] neg_hi:[0,1]
v_pk_add_f32 v[32:33], v[32:33], v[130:131] op_sel_hi:[1,0] neg_lo:[0,1] neg_hi:[0,1]
v_cvt_pk_bf16_f32 v28, v30, v31
v_cvt_pk_bf16_f32 v29, v32, v33
v_lshlrev_b32 v30, 16, v28
v_and_b32 v31, s56, v28
v_lshlrev_b32 v32, 16, v29
v_and_b32 v33, s56, v29
v_pk_mul_f32 v[16:17], v[30:31], v[132:133] op_sel_hi:[1,0]
v_pk_mul_f32 v[18:19], v[32:33], v[132:133] op_sel_hi:[1,0]
v_pk_fma_f32 v[30:31], v[16:17], v[130:131], v[30:31] op_sel:[0,1,0] op_sel_hi:[1,1,1] neg_lo:[1,0,0] neg_hi:[1,0,0]
v_pk_fma_f32 v[32:33], v[18:19], v[130:131], v[32:33] op_sel:[0,1,0] op_sel_hi:[1,1,1] neg_lo:[1,0,0] neg_hi:[1,0,0]
v_pk_fma_f32 v[16:17], v[30:31], v[132:133], v[16:17] op_sel_hi:[1,0,1]
v_pk_fma_f32 v[18:19], v[32:33], v[132:133], v[18:19] op_sel_hi:[1,0,1]
v_cvt_pk_bf16_f32 v28, v16, v17
v_cvt_pk_bf16_f32 v29, v18, v19
v_lshlrev_b32 v16, 16, v28
v_and_b32 v17, s56, v28
v_lshlrev_b32 v18, 16, v29
v_and_b32 v19, s56, v29
v_mul_f32 v30, s57, v16
v_mul_f32 v31, s57, v17
v_mul_f32 v32, s57, v18
v_mul_f32 v33, s57, v19
v_exp_f32 v30, v30
v_exp_f32 v31, v31
v_exp_f32 v32, v32
v_exp_f32 v33, v33
s_nop 0
v_add_f32 v30, 1.0, v30
v_add_f32 v31, 1.0, v31
v_add_f32 v32, 1.0, v32
v_add_f32 v33, 1.0, v33
v_rcp_f32 v30, v30
v_rcp_f32 v31, v31
v_rcp_f32 v32, v32
v_rcp_f32 v33, v33
s_nop 0
v_pk_mul_f32 v[16:17], v[16:17], v[30:31]
v_pk_mul_f32 v[18:19], v[18:19], v[32:33]
v_cvt_pk_bf16_f32 v28, v16, v17
v_cvt_pk_bf16_f32 v29, v18, v19
v_lshlrev_b32 v16, 16, v28
v_and_b32 v17, s56, v28
v_lshlrev_b32 v18, 16, v29
v_and_b32 v19, s56, v29
v_lshlrev_b32 v30, 16, v126
v_and_b32 v31, s56, v126
v_lshlrev_b32 v32, 16, v127
v_and_b32 v33, s56, v127
v_pk_add_f32 v[30:31], v[30:31], v[130:131] op_sel_hi:[1,0] neg_lo:[0,1] neg_hi:[0,1]
v_pk_add_f32 v[32:33], v[32:33], v[130:131] op_sel_hi:[1,0] neg_lo:[0,1] neg_hi:[0,1]
v_cvt_pk_bf16_f32 v28, v30, v31
v_cvt_pk_bf16_f32 v29, v32, v33
v_lshlrev_b32 v30, 16, v28
v_and_b32 v31, s56, v28
v_lshlrev_b32 v32, 16, v29
v_and_b32 v33, s56, v29
v_pk_mul_f32 v[20:21], v[30:31], v[132:133] op_sel_hi:[1,0]
v_pk_mul_f32 v[22:23], v[32:33], v[132:133] op_sel_hi:[1,0]
v_pk_fma_f32 v[30:31], v[20:21], v[130:131], v[30:31] op_sel:[0,1,0] op_sel_hi:[1,1,1] neg_lo:[1,0,0] neg_hi:[1,0,0]
v_pk_fma_f32 v[32:33], v[22:23], v[130:131], v[32:33] op_sel:[0,1,0] op_sel_hi:[1,1,1] neg_lo:[1,0,0] neg_hi:[1,0,0]
v_pk_fma_f32 v[20:21], v[30:31], v[132:133], v[20:21] op_sel_hi:[1,0,1]
v_pk_fma_f32 v[22:23], v[32:33], v[132:133], v[22:23] op_sel_hi:[1,0,1]
v_cvt_pk_bf16_f32 v28, v20, v21
v_cvt_pk_bf16_f32 v29, v22, v23
v_lshlrev_b32 v20, 16, v28
v_and_b32 v21, s56, v28
v_lshlrev_b32 v22, 16, v29
v_and_b32 v23, s56, v29
v_mul_f32 v30, s57, v20
v_mul_f32 v31, s57, v21
v_mul_f32 v32, s57, v22
v_mul_f32 v33, s57, v23
v_exp_f32 v30, v30
v_exp_f32 v31, v31
v_exp_f32 v32, v32
v_exp_f32 v33, v33
s_nop 0
v_add_f32 v30, 1.0, v30
v_add_f32 v31, 1.0, v31
v_add_f32 v32, 1.0, v32
v_add_f32 v33, 1.0, v33
v_rcp_f32 v30, v30
v_rcp_f32 v31, v31
v_rcp_f32 v32, v32
v_rcp_f32 v33, v33
s_nop 0
v_pk_mul_f32 v[20:21], v[20:21], v[30:31]
v_pk_mul_f32 v[22:23], v[22:23], v[32:33]
v_cvt_pk_bf16_f32 v28, v20, v21
v_cvt_pk_bf16_f32 v29, v22, v23
v_lshlrev_b32 v20, 16, v28
v_and_b32 v21, s56, v28
v_lshlrev_b32 v22, 16, v29
v_and_b32 v23, s56, v29
v_lshlrev_b32 v30, 16, v128
v_and_b32 v31, s56, v128
v_lshlrev_b32 v32, 16, v129
v_and_b32 v33, s56, v129
v_pk_add_f32 v[30:31], v[30:31], v[130:131] op_sel_hi:[1,0] neg_lo:[0,1] neg_hi:[0,1]
v_pk_add_f32 v[32:33], v[32:33], v[130:131] op_sel_hi:[1,0] neg_lo:[0,1] neg_hi:[0,1]
v_cvt_pk_bf16_f32 v28, v30, v31
v_cvt_pk_bf16_f32 v29, v32, v33
v_lshlrev_b32 v30, 16, v28
v_and_b32 v31, s56, v28
v_lshlrev_b32 v32, 16, v29
v_and_b32 v33, s56, v29
v_pk_mul_f32 v[24:25], v[30:31], v[132:133] op_sel_hi:[1,0]
v_pk_mul_f32 v[26:27], v[32:33], v[132:133] op_sel_hi:[1,0]
v_pk_fma_f32 v[30:31], v[24:25], v[130:131], v[30:31] op_sel:[0,1,0] op_sel_hi:[1,1,1] neg_lo:[1,0,0] neg_hi:[1,0,0]
v_pk_fma_f32 v[32:33], v[26:27], v[130:131], v[32:33] op_sel:[0,1,0] op_sel_hi:[1,1,1] neg_lo:[1,0,0] neg_hi:[1,0,0]
v_pk_fma_f32 v[24:25], v[30:31], v[132:133], v[24:25] op_sel_hi:[1,0,1]
v_pk_fma_f32 v[26:27], v[32:33], v[132:133], v[26:27] op_sel_hi:[1,0,1]
v_cvt_pk_bf16_f32 v28, v24, v25
v_cvt_pk_bf16_f32 v29, v26, v27
v_lshlrev_b32 v24, 16, v28
v_and_b32 v25, s56, v28
v_lshlrev_b32 v26, 16, v29
v_and_b32 v27, s56, v29
v_mul_f32 v30, s57, v24
v_mul_f32 v31, s57, v25
v_mul_f32 v32, s57, v26
v_mul_f32 v33, s57, v27
v_exp_f32 v30, v30
v_exp_f32 v31, v31
v_exp_f32 v32, v32
v_exp_f32 v33, v33
s_nop 0
v_add_f32 v30, 1.0, v30
v_add_f32 v31, 1.0, v31
v_add_f32 v32, 1.0, v32
v_add_f32 v33, 1.0, v33
v_rcp_f32 v30, v30
v_rcp_f32 v31, v31
v_rcp_f32 v32, v32
v_rcp_f32 v33, v33
s_nop 0
v_pk_mul_f32 v[24:25], v[24:25], v[30:31]
v_pk_mul_f32 v[26:27], v[26:27], v[32:33]
v_cvt_pk_bf16_f32 v28, v24, v25
v_cvt_pk_bf16_f32 v29, v26, v27
v_lshlrev_b32 v24, 16, v28
v_and_b32 v25, s56, v28
v_lshlrev_b32 v26, 16, v29
v_and_b32 v27, s56, v29
s_waitcnt vmcnt(2)
v_lshlrev_b32 v36, 16, v40
v_and_b32 v37, s56, v40
v_lshlrev_b32 v38, 16, v41
v_and_b32 v39, s56, v41
v_dot2_f32_bf16 v36, v42, s58, v36
v_dot2_f32_bf16 v37, v42, s59, v37
v_dot2_f32_bf16 v38, v43, s58, v38
v_dot2_f32_bf16 v39, v43, s59, v39
v_dot2_f32_bf16 v36, v44, s58, v36
v_dot2_f32_bf16 v37, v44, s59, v37
v_dot2_f32_bf16 v38, v45, s58, v38
v_dot2_f32_bf16 v39, v45, s59, v39
v_dot2_f32_bf16 v36, v46, s58, v36
v_dot2_f32_bf16 v37, v46, s59, v37
v_dot2_f32_bf16 v38, v47, s58, v38
v_dot2_f32_bf16 v39, v47, s59, v39
v_dot2_f32_bf16 v36, v48, s58, v36
v_dot2_f32_bf16 v37, v48, s59, v37
v_dot2_f32_bf16 v38, v49, s58, v38
v_dot2_f32_bf16 v39, v49, s59, v39
v_dot2_f32_bf16 v36, v50, s58, v36
v_dot2_f32_bf16 v37, v50, s59, v37
v_dot2_f32_bf16 v38, v51, s58, v38
v_dot2_f32_bf16 v39, v51, s59, v39
v_dot2_f32_bf16 v36, v52, s58, v36
v_dot2_f32_bf16 v37, v52, s59, v37
v_dot2_f32_bf16 v38, v53, s58, v38
v_dot2_f32_bf16 v39, v53, s59, v39
v_dot2_f32_bf16 v36, v54, s58, v36
v_dot2_f32_bf16 v37, v54, s59, v37
v_dot2_f32_bf16 v38, v55, s58, v38
v_dot2_f32_bf16 v39, v55, s59, v39
v_dot2_f32_bf16 v36, v56, s58, v36
v_dot2_f32_bf16 v37, v56, s59, v37
v_dot2_f32_bf16 v38, v57, s58, v38
v_dot2_f32_bf16 v39, v57, s59, v39
v_dot2_f32_bf16 v36, v58, s58, v36
v_dot2_f32_bf16 v37, v58, s59, v37
v_dot2_f32_bf16 v38, v59, s58, v38
v_dot2_f32_bf16 v39, v59, s59, v39
v_dot2_f32_bf16 v36, v60, s58, v36
v_dot2_f32_bf16 v37, v60, s59, v37
v_dot2_f32_bf16 v38, v61, s58, v38
v_dot2_f32_bf16 v39, v61, s59, v39
v_dot2_f32_bf16 v36, v62, s58, v36
v_dot2_f32_bf16 v37, v62, s59, v37
v_dot2_f32_bf16 v38, v63, s58, v38
v_dot2_f32_bf16 v39, v63, s59, v39
v_dot2_f32_bf16 v36, v64, s58, v36
v_dot2_f32_bf16 v37, v64, s59, v37
v_dot2_f32_bf16 v38, v65, s58, v38
v_dot2_f32_bf16 v39, v65, s59, v39
v_dot2_f32_bf16 v36, v66, s58, v36
v_dot2_f32_bf16 v37, v66, s59, v37
v_dot2_f32_bf16 v38, v67, s58, v38
v_dot2_f32_bf16 v39, v67, s59, v39
v_dot2_f32_bf16 v36, v68, s58, v36
v_dot2_f32_bf16 v37, v68, s59, v37
v_dot2_f32_bf16 v38, v69, s58, v38
v_dot2_f32_bf16 v39, v69, s59, v39
v_dot2_f32_bf16 v36, v70, s58, v36
v_dot2_f32_bf16 v37, v70, s59, v37
v_dot2_f32_bf16 v38, v71, s58, v38
v_dot2_f32_bf16 v39, v71, s59, v39
s_cmp_lg_u32 s93, 0
s_cbranch_scc1 K_YG
K_YGD:
s_waitcnt vmcnt(1)
s_branch K_XW
K_XPOLL:
s_sleep 2
s_add_u32 s100, s100, 1
s_bitcmp1_b32 s100, 19
s_cbranch_scc1 K_END
buffer_load_dword v246, v152, s[20:23], 0 offen sc0 sc1
s_waitcnt vmcnt(0)
K_XW:
v_writelane_b32 v246, 1, s48
v_cmp_ne_u32 vcc, 1, v246
s_cmp_lg_u32 s67, 0
s_cbranch_scc1 K_XW2
s_and_b32 s46, vcc_lo, 0xffff
s_cbranch_scc1 K_XPOLL
s_add_u32 s46, s87, 4096
s_mov_b32 s67, 2
v_mov_b32 v152, v153
buffer_load_dwordx2 v[40:41], v250, s[20:23], s87 offen offset:0 sc0 sc1
buffer_load_dwordx2 v[42:43], v250, s[20:23], s87 offen offset:512 sc0 sc1
buffer_load_dwordx2 v[44:45], v250, s[20:23], s87 offen offset:1024 sc0 sc1
buffer_load_dwordx2 v[46:47], v250, s[20:23], s87 offen offset:1536 sc0 sc1
buffer_load_dwordx2 v[48:49], v250, s[20:23], s87 offen offset:2048 sc0 sc1
buffer_load_dwordx2 v[50:51], v250, s[20:23], s87 offen offset:2560 sc0 sc1
buffer_load_dwordx2 v[52:53], v250, s[20:23], s87 offen offset:3072 sc0 sc1
buffer_load_dwordx2 v[54:55], v250, s[20:23], s87 offen offset:3584 sc0 sc1
buffer_load_dwordx2 v[56:57], v250, s[20:23], s46 offen offset:0 sc0 sc1
buffer_load_dwordx2 v[58:59], v250, s[20:23], s46 offen offset:512 sc0 sc1
buffer_load_dwordx2 v[60:61], v250, s[20:23], s46 offen offset:1024 sc0 sc1
buffer_load_dwordx2 v[62:63], v250, s[20:23], s46 offen offset:1536 sc0 sc1
buffer_load_dwordx2 v[64:65], v250, s[20:23], s46 offen offset:2048 sc0 sc1
buffer_load_dwordx2 v[66:67], v250, s[20:23], s46 offen offset:2560 sc0 sc1
buffer_load_dwordx2 v[68:69], v250, s[20:23], s46 offen offset:3072 sc0 sc1
buffer_load_dwordx2 v[70:71], v250, s[20:23], s46 offen offset:3584 sc0 sc1
K_XW2:
s_and_b32 s46, vcc_lo, 0xf0000
s_cbranch_scc1 K_XPOLL
buffer_load_dwordx4 v[96:99], v234, s[20:23], s60 offen offset:0 sc0 sc1
buffer_load_dwordx4 v[104:107], v234, s[20:23], s61 offen offset:0 sc0 sc1
buffer_load_dwordx4 v[112:115], v234, s[20:23], s62 offen offset:0 sc0 sc1
buffer_load_dwordx4 v[100:103], v234, s[20:23], s60 offen offset:1024 sc0 sc1
buffer_load_dwordx4 v[108:111], v234, s[20:23], s61 offen offset:1024 sc0 sc1
buffer_load_dwordx4 v[116:119], v234, s[20:23], s62 offen offset:1024 sc0 sc1
v_lshlrev_b32 v72, 16, v120
v_and_b32 v73, s56, v120
v_lshlrev_b32 v74, 16, v121
v_and_b32 v75, s56, v121
v_lshlrev_b32 v76, 16, v122
v_and_b32 v77, s56, v122
v_lshlrev_b32 v78, 16, v123
v_and_b32 v79, s56, v123
v_lshlrev_b32 v80, 16, v124
v_and_b32 v81, s56, v124
v_lshlrev_b32 v82, 16, v125
v_and_b32 v83, s56, v125
v_lshlrev_b32 v84, 16, v126
v_and_b32 v85, s56, v126
v_lshlrev_b32 v86, 16, v127
v_and_b32 v87, s56, v127
v_lshlrev_b32 v88, 16, v128
v_and_b32 v89, s56, v128
v_lshlrev_b32 v90, 16, v129
v_and_b32 v91, s56, v129
s_cmp_lg_u32 s67, 2
s_cbranch_scc1 K_EFIN
s_waitcnt vmcnt(6)
v_lshlrev_b32 v36, 16, v40
v_and_b32 v37, s56, v40
v_lshlrev_b32 v38, 16, v41
v_and_b32 v39, s56, v41
v_dot2_f32_bf16 v36, v42, s58, v36
v_dot2_f32_bf16 v37, v42, s59, v37
v_dot2_f32_bf16 v38, v43, s58, v38
v_dot2_f32_bf16 v39, v43, s59, v39
v_dot2_f32_bf16 v36, v44, s58, v36
v_dot2_f32_bf16 v37, v44, s59, v37
v_dot2_f32_bf16 v38, v45, s58, v38
v_dot2_f32_bf16 v39, v45, s59, v39
v_dot2_f32_bf16 v36, v46, s58, v36
v_dot2_f32_bf16 v37, v46, s59, v37
v_dot2_f32_bf16 v38, v47, s58, v38
v_dot2_f32_bf16 v39, v47, s59, v39
v_dot2_f32_bf16 v36, v48, s58, v36
v_dot2_f32_bf16 v37, v48, s59, v37
v_dot2_f32_bf16 v38, v49, s58, v38
v_dot2_f32_bf16 v39, v49, s59, v39
v_dot2_f32_bf16 v36, v50, s58, v36
v_dot2_f32_bf16 v37, v50, s59, v37
v_dot2_f32_bf16 v38, v51, s58, v38
v_dot2_f32_bf16 v39, v51, s59, v39
v_dot2_f32_bf16 v36, v52, s58, v36
v_dot2_f32_bf16 v37, v52, s59, v37
v_dot2_f32_bf16 v38, v53, s58, v38
v_dot2_f32_bf16 v39, v53, s59, v39
v_dot2_f32_bf16 v36, v54, s58, v36
v_dot2_f32_bf16 v37, v54, s59, v37
v_dot2_f32_bf16 v38, v55, s58, v38
v_dot2_f32_bf16 v39, v55, s59, v39
v_dot2_f32_bf16 v36, v56, s58, v36
v_dot2_f32_bf16 v37, v56, s59, v37
v_dot2_f32_bf16 v38, v57, s58, v38
v_dot2_f32_bf16 v39, v57, s59, v39
v_dot2_f32_bf16 v36, v58, s58, v36
v_dot2_f32_bf16 v37, v58, s59, v37
v_dot2_f32_bf16 v38, v59, s58, v38
v_dot2_f32_bf16 v39, v59, s59, v39
v_dot2_f32_bf16 v36, v60, s58, v36
v_dot2_f32_bf16 v37, v60, s59, v37
v_dot2_f32_bf16 v38, v61, s58, v38
v_dot2_f32_bf16 v39, v61, s59, v39
v_dot2_f32_bf16 v36, v62, s58, v36
v_dot2_f32_bf16 v37, v62, s59, v37
v_dot2_f32_bf16 v38, v63, s58, v38
v_dot2_f32_bf16 v39, v63, s59, v39
v_dot2_f32_bf16 v36, v64, s58, v36
v_dot2_f32_bf16 v37, v64, s59, v37
v_dot2_f32_bf16 v38, v65, s58, v38
v_dot2_f32_bf16 v39, v65, s59, v39
v_dot2_f32_bf16 v36, v66, s58, v36
v_dot2_f32_bf16 v37, v66, s59, v37
v_dot2_f32_bf16 v38, v67, s58, v38
v_dot2_f32_bf16 v39, v67, s59, v39
v_dot2_f32_bf16 v36, v68, s58, v36
v_dot2_f32_bf16 v37, v68, s59, v37
v_dot2_f32_bf16 v38, v69, s58, v38
v_dot2_f32_bf16 v39, v69, s59, v39
v_dot2_f32_bf16 v36, v70, s58, v36
v_dot2_f32_bf16 v37, v70, s59, v37
v_dot2_f32_bf16 v38, v71, s58, v38
v_dot2_f32_bf16 v39, v71, s59, v39
s_nop 1
K_EFIN:
v_cvt_pk_bf16_f32 v28, v36, v37
v_cvt_pk_bf16_f32 v29, v38, v39
v_lshlrev_b32 v36, 16, v28
v_and_b32 v37, s56, v28
v_lshlrev_b32 v38, 16, v29
v_and_b32 v39, s56, v29
v_pk_mul_f32 v[36:37], v[36:37], v[24:25]
v_pk_mul_f32 v[38:39], v[38:39], v[26:27]
v_cvt_pk_bf16_f32 v28, v36, v37
v_cvt_pk_bf16_f32 v29, v38, v39
v_lshlrev_b32 v36, 16, v28
v_and_b32 v37, s56, v28
v_lshlrev_b32 v38, 16, v29
v_and_b32 v39, s56, v29
v_pk_add_f32 v[36:37], v[36:37], v[88:89]
v_pk_add_f32 v[38:39], v[38:39], v[90:91]
v_cvt_pk_bf16_f32 v36, v36, v37
v_cvt_pk_bf16_f32 v37, v38, v39
buffer_store_dwordx2 v[36:37], v240, s[68:71], s81 offen sc0 sc1 nt
s_add_u32 s46, s37, 65536
v_add_u32 v5, s46, v234
s_add_u32 s46, s80, 9216
s_waitcnt vmcnt(4)
v_dot2_f32_bf16 v136, v96, s58, v136
v_dot2_f32_bf16 v137, v96, s59, v137
v_dot2_f32_bf16 v138, v97, s58, v138
v_dot2_f32_bf16 v139, v97, s59, v139
v_dot2_f32_bf16 v140, v98, s58, v140
v_dot2_f32_bf16 v141, v98, s59, v141
v_dot2_f32_bf16 v142, v99, s58, v142
v_dot2_f32_bf16 v143, v99, s59, v143
v_dot2_f32_bf16 v136, v104, s58, v136
v_dot2_f32_bf16 v137, v104, s59, v137
v_dot2_f32_bf16 v138, v105, s58, v138
v_dot2_f32_bf16 v139, v105, s59, v139
v_dot2_f32_bf16 v140, v106, s58, v140
v_dot2_f32_bf16 v141, v106, s59, v141
v_dot2_f32_bf16 v142, v107, s58, v142
v_dot2_f32_bf16 v143, v107, s59, v143
v_dot2_f32_bf16 v136, v112, s58, v136
v_dot2_f32_bf16 v137, v112, s59, v137
v_dot2_f32_bf16 v138, v113, s58, v138
v_dot2_f32_bf16 v139, v113, s59, v139
v_dot2_f32_bf16 v140, v114, s58, v140
v_dot2_f32_bf16 v141, v114, s59, v141
v_dot2_f32_bf16 v142, v115, s58, v142
v_dot2_f32_bf16 v143, v115, s59, v143
v_cvt_pk_bf16_f32 v28, v136, v137
v_cvt_pk_bf16_f32 v29, v138, v139
v_lshlrev_b32 v136, 16, v28
v_and_b32 v137, s56, v28
v_lshlrev_b32 v138, 16, v29
v_and_b32 v139, s56, v29
v_pk_mul_f32 v[136:137], v[136:137], v[8:9]
v_pk_mul_f32 v[138:139], v[138:139], v[10:11]
v_cvt_pk_bf16_f32 v28, v136, v137
v_cvt_pk_bf16_f32 v29, v138, v139
v_lshlrev_b32 v136, 16, v28
v_and_b32 v137, s56, v28
v_lshlrev_b32 v138, 16, v29
v_and_b32 v139, s56, v29
v_pk_add_f32 v[136:137], v[136:137], v[72:73]
v_pk_add_f32 v[138:139], v[138:139], v[74:75]
v_cvt_pk_bf16_f32 v136, v136, v137
v_cvt_pk_bf16_f32 v137, v138, v139
ds_write_b64 v241, v[136:137]
v_cvt_pk_bf16_f32 v28, v140, v141
v_cvt_pk_bf16_f32 v29, v142, v143
v_lshlrev_b32 v140, 16, v28
v_and_b32 v141, s56, v28
v_lshlrev_b32 v142, 16, v29
v_and_b32 v143, s56, v29
v_pk_mul_f32 v[140:141], v[140:141], v[12:13]
v_pk_mul_f32 v[142:143], v[142:143], v[14:15]
v_cvt_pk_bf16_f32 v28, v140, v141
v_cvt_pk_bf16_f32 v29, v142, v143
v_lshlrev_b32 v140, 16, v28
v_and_b32 v141, s56, v28
v_lshlrev_b32 v142, 16, v29
v_and_b32 v143, s56, v29
v_pk_add_f32 v[140:141], v[140:141], v[76:77]
v_pk_add_f32 v[142:143], v[142:143], v[78:79]
v_cvt_pk_bf16_f32 v140, v140, v141
v_cvt_pk_bf16_f32 v141, v142, v143
ds_write_b64 v242, v[140:141]
s_waitcnt vmcnt(1)
v_dot2_f32_bf16 v144, v100, s58, v144
v_dot2_f32_bf16 v145, v100, s59, v145
v_dot2_f32_bf16 v146, v101, s58, v146
v_dot2_f32_bf16 v147, v101, s59, v147
v_dot2_f32_bf16 v148, v102, s58, v148
v_dot2_f32_bf16 v149, v102, s59, v149
v_dot2_f32_bf16 v150, v103, s58, v150
v_dot2_f32_bf16 v151, v103, s59, v151
v_dot2_f32_bf16 v144, v108, s58, v144
v_dot2_f32_bf16 v145, v108, s59, v145
v_dot2_f32_bf16 v146, v109, s58, v146
v_dot2_f32_bf16 v147, v109, s59, v147
v_dot2_f32_bf16 v148, v110, s58, v148
v_dot2_f32_bf16 v149, v110, s59, v149
v_dot2_f32_bf16 v150, v111, s58, v150
v_dot2_f32_bf16 v151, v111, s59, v151
v_dot2_f32_bf16 v144, v116, s58, v144
v_dot2_f32_bf16 v145, v116, s59, v145
v_dot2_f32_bf16 v146, v117, s58, v146
v_dot2_f32_bf16 v147, v117, s59, v147
v_dot2_f32_bf16 v148, v118, s58, v148
v_dot2_f32_bf16 v149, v118, s59, v149
v_dot2_f32_bf16 v150, v119, s58, v150
v_dot2_f32_bf16 v151, v119, s59, v151
v_cvt_pk_bf16_f32 v28, v144, v145
v_cvt_pk_bf16_f32 v29, v146, v147
v_lshlrev_b32 v144, 16, v28
v_and_b32 v145, s56, v28
v_lshlrev_b32 v146, 16, v29
v_and_b32 v147, s56, v29
v_pk_mul_f32 v[144:145], v[144:145], v[16:17]
v_pk_mul_f32 v[146:147], v[146:147], v[18:19]
v_cvt_pk_bf16_f32 v28, v144, v145
v_cvt_pk_bf16_f32 v29, v146, v147
v_lshlrev_b32 v144, 16, v28
v_and_b32 v145, s56, v28
v_lshlrev_b32 v146, 16, v29
v_and_b32 v147, s56, v29
v_pk_add_f32 v[144:145], v[144:145], v[80:81]
v_pk_add_f32 v[146:147], v[146:147], v[82:83]
v_cvt_pk_bf16_f32 v144, v144, v145
v_cvt_pk_bf16_f32 v145, v146, v147
ds_write_b64 v243, v[144:145]
v_cvt_pk_bf16_f32 v28, v148, v149
v_cvt_pk_bf16_f32 v29, v150, v151
v_lshlrev_b32 v148, 16, v28
v_and_b32 v149, s56, v28
v_lshlrev_b32 v150, 16, v29
v_and_b32 v151, s56, v29
v_pk_mul_f32 v[148:149], v[148:149], v[20:21]
v_pk_mul_f32 v[150:151], v[150:151], v[22:23]
v_cvt_pk_bf16_f32 v28, v148, v149
v_cvt_pk_bf16_f32 v29, v150, v151
v_lshlrev_b32 v148, 16, v28
v_and_b32 v149, s56, v28
v_lshlrev_b32 v150, 16, v29
v_and_b32 v151, s56, v29
v_pk_add_f32 v[148:149], v[148:149], v[84:85]
v_pk_add_f32 v[150:151], v[150:151], v[86:87]
v_cvt_pk_bf16_f32 v148, v148, v149
v_cvt_pk_bf16_f32 v149, v150, v151
ds_write_b64 v244, v[148:149]
ds_read_b128 v[40:43], v5
ds_read_b128 v[44:47], v5 offset:1024
s_waitcnt lgkmcnt(1)
buffer_store_dwordx4 v[40:43], v239, s[68:71], s80 offen sc0 sc1 nt
s_waitcnt lgkmcnt(0)
buffer_store_dwordx4 v[44:47], v239, s[68:71], s46 offen sc0 sc1 nt
K_END:
s_endpgm
K_YSPIN:
s_sleep 4
s_add_u32 s100, s100, 1
s_bitcmp1_b32 s100, 19
s_cbranch_scc1 K_END
buffer_load_dwordx2 v[252:253], v251, s[76:79], s42 offen sc0 sc1
s_waitcnt vmcnt(0)
K_YR0:
s_cmp_lg_u32 s41, 0
s_cbranch_scc1 K_YR0B
s_waitcnt vmcnt(3)
v_cmp_gt_u32 vcc, 9, v252
s_cbranch_vccnz K_YSPIN
K_YR0B:
s_mul_i32 s48, s52, 18560
s_mul_i32 s46, s32, 4608
s_add_u32 s48, s48, s46
s_add_u32 s48, s48, 0x23fb780
s_add_u32 s46, s48, 4096
buffer_load_dwordx4 v[112:115], v234, s[20:23], s48 offen offset:0 sc0 sc1
buffer_load_dwordx4 v[116:119], v234, s[20:23], s48 offen offset:1024 sc0 sc1
buffer_load_dwordx4 v[120:123], v234, s[20:23], s48 offen offset:2048 sc0 sc1
buffer_load_dwordx4 v[124:127], v234, s[20:23], s48 offen offset:3072 sc0 sc1
v_subrev_u32 v245, 1, v254
v_and_b32 v245, 0x7ff, v245
v_mul_u32_u24 v245, 0x480, v245
v_mov_b64 v[128:129], 0
v_mov_b64 v[130:131], 0
s_lshl_b32 s50, s52, 3
s_sub_u32 s50, s50, 8
s_mov_b32 exec_hi, 0
buffer_load_dwordx4 v[128:131], v234, s[20:23], s46 offen sc0 sc1
s_mov_b32 exec_lo, 0xff
buffer_load_dwordx2 v[134:135], v245, s[20:23], s50 offen sc0 sc1
s_mov_b64 exec, -1
s_branch K_LAST
K_YRA:
s_waitcnt vmcnt(35)
v_pk_add_f32 v[112:113], v[112:113], v[116:117]
v_pk_add_f32 v[114:115], v[114:115], v[118:119]
v_pk_add_f32 v[112:113], v[112:113], v[120:121]
v_pk_add_f32 v[114:115], v[114:115], v[122:123]
v_pk_add_f32 v[112:113], v[112:113], v[124:125]
v_pk_add_f32 v[114:115], v[114:115], v[126:127]
v_pk_add_f32 v[112:113], v[112:113], v[128:129]
v_pk_add_f32 v[114:115], v[114:115], v[130:131]
s_lshl_b32 s46, s36, 10
s_lshl_b32 s47, s32, 7
s_add_u32 s46, s46, s47
v_add_f32_dpp v112, v112, v112 row_ror:8 row_mask:0xf bank_mask:0xf
v_add_f32_dpp v113, v113, v113 row_ror:8 row_mask:0xf bank_mask:0xf
v_add_f32_dpp v114, v114, v114 row_ror:8 row_mask:0xf bank_mask:0xf
v_add_f32_dpp v115, v115, v115 row_ror:8 row_mask:0xf bank_mask:0xf
s_add_u32 s46, s46, 77952
v_and_b32 v120, 0x70, v234
v_add_u32 v120, s46, v120
v_mov_b32 v116, v112
v_mov_b32 v117, v113
v_mov_b32 v118, v114
v_mov_b32 v119, v115
v_permlane16_swap_b32 v112, v116
v_permlane16_swap_b32 v113, v117
v_permlane16_swap_b32 v114, v118
v_permlane16_swap_b32 v115, v119
v_pk_add_f32 v[112:113], v[112:113], v[116:117]
v_pk_add_f32 v[114:115], v[114:115], v[118:119]
v_mov_b32 v116, v112
v_mov_b32 v117, v113
v_mov_b32 v118, v114
v_mov_b32 v119, v115
v_permlane32_swap_b32 v112, v116
v_permlane32_swap_b32 v113, v117
v_permlane32_swap_b32 v114, v118
v_permlane32_swap_b32 v115, v119
v_pk_add_f32 v[112:113], v[112:113], v[116:117]
v_pk_add_f32 v[114:115], v[114:115], v[118:119]
ds_write_b128 v120, v[112:115]
v_subrev_u32 v120, s47, v120
s_branch K_YRAD
K_YR1:
ds_read_b128 v[144:147], v120 offset:0
ds_read_b128 v[148:151], v120 offset:128
ds_read_b128 v[152:155], v120 offset:256
ds_read_b128 v[156:159], v120 offset:384
v_mov_b32_dpp v160, v254 row_ror:8 row_mask:0xf bank_mask:0xf
v_mul_u32_u24 v245, 0x480, v1
s_mov_b32 s57, 0xbfb8aa3b
s_mov_b32 s56, 0xffff0000
v_and_b32 v160, s56, v160
s_waitcnt lgkmcnt(0)
v_pk_add_f32 v[112:113], v[144:145], v[148:149]
v_pk_add_f32 v[116:117], v[152:153], v[156:157]
v_pk_add_f32 v[112:113], v[112:113], v[116:117]
v_pk_add_f32 v[114:115], v[146:147], v[150:151]
v_pk_add_f32 v[118:119], v[154:155], v[158:159]
v_pk_add_f32 v[114:115], v[114:115], v[118:119]
v_cvt_pk_bf16_f32 v162, v112, v113
v_cvt_pk_bf16_f32 v163, v114, v115
v_lshlrev_b32 v112, 16, v162
v_and_b32 v113, s56, v162
v_lshlrev_b32 v114, 16, v163
v_and_b32 v115, s56, v163
v_mul_f32 v112, v160, v112
v_mul_f32 v113, v160, v113
v_mul_f32 v114, v160, v114
v_mul_f32 v115, v160, v115
v_cvt_pk_bf16_f32 v162, v112, v113
v_cvt_pk_bf16_f32 v163, v114, v115
v_lshlrev_b32 v112, 16, v162
v_and_b32 v113, s56, v162
v_lshlrev_b32 v114, 16, v163
v_and_b32 v115, s56, v163
v_lshlrev_b32 v116, 16, v134
v_and_b32 v117, 0xffff0000, v134
v_lshlrev_b32 v118, 16, v135
v_and_b32 v119, 0xffff0000, v135
v_pk_add_f32 v[112:113], v[112:113], v[116:117]
v_pk_add_f32 v[114:115], v[114:115], v[118:119]
v_cvt_pk_bf16_f32 v162, v112, v113
v_cvt_pk_bf16_f32 v163, v114, v115
v_lshlrev_b32 v112, 16, v162
v_and_b32 v113, s56, v162
v_lshlrev_b32 v114, 16, v163
v_and_b32 v115, s56, v163
v_mul_f32 v116, s57, v112
v_mul_f32 v117, s57, v113
v_mul_f32 v118, s57, v114
v_mul_f32 v119, s57, v115
v_exp_f32 v116, v116
v_exp_f32 v117, v117
v_exp_f32 v118, v118
v_exp_f32 v119, v119
s_nop 0
v_add_f32 v116, 1.0, v116
v_add_f32 v117, 1.0, v117
v_add_f32 v118, 1.0, v118
v_add_f32 v119, 1.0, v119
v_rcp_f32 v116, v116
v_rcp_f32 v117, v117
v_rcp_f32 v118, v118
v_rcp_f32 v119, v119
s_add_u32 s46, s50, 0x274000
v_pk_mul_f32 v[112:113], v[112:113], v[116:117]
v_pk_mul_f32 v[114:115], v[114:115], v[118:119]
v_cvt_pk_bf16_f32 v134, v112, v113
v_cvt_pk_bf16_f32 v135, v114, v115
s_mov_b64 exec, 0xff
buffer_store_dwordx2 v[134:135], v245, s[20:23], s46 offen sc0 sc1
s_mov_b64 exec, -1
s_branch K_YR1D
K_YR2:
s_waitcnt vmcnt(32)
s_and_b32 s46, s83, 15
s_lshl_b32 s46, s46, 7
s_add_u32 s46, s46, 0x272800
s_mov_b64 exec, 1
buffer_atomic_add v5, v234, s[20:23], s46 offen sc1
s_mov_b64 exec, -1
s_branch K_YR2D
K_YG:
v_mov_b32 v157, -1
K_YG1:
s_ff1_i32_b32 s46, s93
s_bitset0_b32 s93, s46
v_readlane_b32 s47, v248, s46
v_mov_b32 v158, s46
s_nop 0
v_cmp_eq_u32 vcc, s47, v3
s_cmp_lg_u32 s93, 0
s_nop 0
v_cndmask_b32 v157, v157, v158, vcc
s_cbranch_scc1 K_YG1
v_mul_u32_u24 v158, 0x480, v157
v_lshl_add_u32 v158, v4, 3, v158
s_lshl_b32 s46, s36, 8
s_add_u32 s46, s46, s82
s_add_u32 s46, s46, 0x274000
s_lshl_b32 s47, s36, 5
s_add_u32 s47, s47, 0x274400
s_branch K_YG3
K_YG2:
s_sleep 2
s_add_u32 s100, s100, 1
s_bitcmp1_b32 s100, 19
s_cbranch_scc1 K_END
buffer_load_dword v247, v6, s[20:23], 0 offen sc0 sc1
s_waitcnt vmcnt(0)
K_YG3:
v_cmp_gt_u32 vcc, 9, v247
s_cbranch_vccnz K_YG2
v_cmp_gt_u32 vcc, 8, v157
s_nop 1
s_mov_b64 exec, vcc
buffer_load_dwordx2 v[160:161], v158, s[20:23], s46 offen offset:0 sc0 sc1
buffer_load_dwordx2 v[162:163], v158, s[20:23], s46 offen offset:32 sc0 sc1
buffer_load_dwordx2 v[164:165], v158, s[20:23], s46 offen offset:64 sc0 sc1
buffer_load_dwordx2 v[166:167], v158, s[20:23], s46 offen offset:96 sc0 sc1
buffer_load_dwordx2 v[168:169], v158, s[20:23], s47 offen offset:0 sc0 sc1
s_waitcnt vmcnt(0)
v_lshlrev_b32 v8, 16, v160
v_and_b32 v9, s56, v160
v_lshlrev_b32 v10, 16, v161
v_and_b32 v11, s56, v161
v_lshlrev_b32 v12, 16, v162
v_and_b32 v13, s56, v162
v_lshlrev_b32 v14, 16, v163
v_and_b32 v15, s56, v163
v_lshlrev_b32 v16, 16, v164
v_and_b32 v17, s56, v164
v_lshlrev_b32 v18, 16, v165
v_and_b32 v19, s56, v165
v_lshlrev_b32 v20, 16, v166
v_and_b32 v21, s56, v166
v_lshlrev_b32 v22, 16, v167
v_and_b32 v23, s56, v167
v_lshlrev_b32 v24, 16, v168
v_and_b32 v25, s56, v168
v_lshlrev_b32 v26, 16, v169
v_and_b32 v27, s56, v169
s_mov_b64 exec, -1
s_branch K_YGD
K_TAIL_END:
K_HOOK:
s_lshl_b32 s48, s34, 2
s_add_u32 s48, s48, s35
s_cmp_eq_u32 s40, 3
s_cbranch_scc1 K_QTW
s_cmp_eq_u32 s40, 7
s_cbranch_scc1 K_PUB
s_memrealtime s[46:47]
s_waitcnt lgkmcnt(0)
s_sub_u32 s47, s46, s94
s_mul_i32 s47, s47, 12
s_lshr_b32 s47, s47, 2
s_add_u32 s46, s46, s47
s_lshl_b32 s46, s46, 6
s_or_b32 s46, s46, s48
s_bitset1_b32 s46, 31
v_mov_b32 v244, s46
s_lshl_b32 s48, s48, 3
s_mov_b64 exec, 1
buffer_store_dword v244, v234, s[76:79], s48 offen sc0 sc1
s_mov_b64 exec, -1
s_branch K_B4
K_QTSPIN:
s_sleep 4
s_add_u32 s100, s100, 1
s_bitcmp1_b32 s100, 19
s_cbranch_scc1 K_END
buffer_load_dwordx2 v[252:253], v251, s[76:79], 0 offen sc0 sc1
s_waitcnt vmcnt(0)
K_QTW:
s_waitcnt vmcnt(3)
v_cmp_eq_u32 vcc, 0, v252
v_cmp_eq_u32 s[88:89], 0, v253
v_readlane_b32 s46, v252, s48
v_mov_b32 v254, v253
s_and_b32 s88, s88, 0xffff
s_or_b32 s88, s88, vcc_lo
s_or_b32 s88, s88, vcc_hi
v_cmp_gt_u32 vcc, s46, v252
s_cbranch_scc1 K_QTSPIN
s_bcnt1_i32_b64 s46, vcc
s_cmp_ge_u32 s46, 36
s_cbranch_scc1 K_B4
s_lshl_b32 s52, s46, 2
s_add_u32 s52, s52, s36
s_lshl_b32 s50, s52, 6
s_mul_i32 s90, s32, 294912
s_add_u32 s90, s90, s50
v_mfma_f32_16x16x32_bf16 v[40:43], a[128:131], v[152:155], v[136:139]
v_exp_f32 v8, v8
v_mfma_f32_16x16x32_bf16 v[40:43], a[132:135], v[156:159], v[40:43]
v_exp_f32 v9, v9
v_mfma_f32_16x16x32_bf16 v[40:43], a[136:139], v[160:163], v[40:43]
v_cvt_pk_bf16_f32 v72, v8, v9
v_lshlrev_b32 v5, 2, v4
v_mfma_f32_16x16x32_bf16 v[40:43], a[140:143], v[164:167], v[40:43]
v_exp_f32 v10, v10
v_mfma_f32_16x16x32_bf16 a[0:3], a[160:163], v[88:91], a[0:3]
v_add_u32 v6, 16, v5
v_and_b32 v7, 28, v1
v_mfma_f32_16x16x32_bf16 a[32:35], a[160:163], v[92:95], a[32:35]
v_exp_f32 v11, v11
s_waitcnt vmcnt(4) lgkmcnt(0)
s_barrier
v_mfma_f32_16x16x32_bf16 a[64:67], a[160:163], v[96:99], a[64:67]
ds_bpermute_b32 v5, v5, v254
v_cvt_pk_bf16_f32 v73, v10, v11
v_mfma_f32_16x16x32_bf16 a[96:99], a[160:163], v[100:103], a[96:99]
s_add_u32 m0, s37, 98304
v_exp_f32 v12, v12
v_mfma_f32_16x16x32_bf16 v[48:51], a[128:131], v[168:171], v[140:143]
buffer_load_dwordx4 v232, s[12:15], s39 offen offset:0 lds
v_mfma_f32_16x16x32_bf16 v[48:51], a[132:135], v[172:175], v[48:51]
v_exp_f32 v13, v13
v_mfma_f32_16x16x32_bf16 v[48:51], a[136:139], v[176:179], v[48:51]
ds_read_b64_tr_b16 a[160:161], v220 offset:0
ds_read_b64_tr_b16 a[162:163], v220 offset:4096
v_mfma_f32_16x16x32_bf16 v[48:51], a[140:143], v[180:183], v[48:51]
v_exp_f32 v14, v14
v_mfma_f32_16x16x32_bf16 a[4:7], a[164:167], v[88:91], a[4:7]
s_add_u32 m0, s49, 4096
ds_bpermute_b32 v6, v6, v254
v_cvt_pk_bf16_f32 v74, v12, v13
v_mfma_f32_16x16x32_bf16 a[36:39], a[164:167], v[92:95], a[36:39]
s_add_u32 s48, s90, 4718592
v_exp_f32 v15, v15
v_mfma_f32_16x16x32_bf16 a[68:71], a[164:167], v[96:99], a[68:71]
buffer_load_dwordx4 v238, s[56:59], s48 offen  lds
v_mfma_f32_16x16x32_bf16 a[100:103], a[164:167], v[100:103], a[100:103]
v_exp_f32 v16, v16
v_smfmac_f32_16x16x64_bf16 a[248:251], a[208:211], v[88:95], v235
ds_read_b64_tr_b16 a[164:165], v221 offset:0
ds_read_b64_tr_b16 a[166:167], v221 offset:4096
v_mfma_f32_16x16x32_bf16 v[56:59], a[128:131], v[184:187], v[144:147]
v_exp_f32 v17, v17
v_mfma_f32_16x16x32_bf16 v[56:59], a[132:135], v[188:191], v[56:59]
s_add_u32 m0, s37, 98304
v_cvt_pk_bf16_f32 v75, v14, v15
v_cvt_pk_bf16_f32 v76, v16, v17
v_mfma_f32_16x16x32_bf16 v[56:59], a[136:139], v[192:195], v[56:59]
v_exp_f32 v18, v18
v_mfma_f32_16x16x32_bf16 v[56:59], a[140:143], v[196:199], v[56:59]
buffer_load_dwordx4 v233, s[12:15], s39 offen offset:1024 lds
v_mfma_f32_16x16x32_bf16 a[8:11], a[168:171], v[88:91], a[8:11]
v_exp_f32 v19, v19
v_mfma_f32_16x16x32_bf16 a[40:43], a[168:171], v[92:95], a[40:43]
ds_bpermute_b32 v7, v7, v254
v_cvt_pk_bf16_f32 v77, v18, v19
v_mfma_f32_16x16x32_bf16 a[72:75], a[168:171], v[96:99], a[72:75]
s_add_u32 m0, s49, 5120
v_exp_f32 v20, v20
v_mfma_f32_16x16x32_bf16 a[104:107], a[168:171], v[100:103], a[104:107]
s_add_u32 s48, s90, 4866048
buffer_load_dwordx4 v238, s[56:59], s48 offen  lds
v_mfma_f32_16x16x32_bf16 v[64:67], a[128:131], v[200:203], v[148:151]
s_mul_i32 s91, s52, 36864
v_exp_f32 v21, v21
v_mfma_f32_16x16x32_bf16 v[64:67], a[132:135], v[204:207], v[64:67]
s_lshl_b32 s46, s32, 5
ds_read_b64_tr_b16 a[168:169], v222 offset:0
ds_read_b64_tr_b16 a[170:171], v222 offset:4096
v_mfma_f32_16x16x32_bf16 v[64:67], a[136:139], v[208:211], v[64:67]
s_add_u32 s92, s91, s46
v_exp_f32 v22, v22
v_mfma_f32_16x16x32_bf16 v[64:67], a[140:143], v[212:215], v[64:67]
s_mul_i32 s46, s32, 1179648
ds_read_b128 a[128:131], v216 offset:49152
ds_read_b128 a[132:135], v217 offset:49152
v_mfma_f32_16x16x32_bf16 a[12:15], a[172:175], v[88:91], a[12:15]
s_add_u32 m0, s37, 98304
v_exp_f32 v23, v23
v_mfma_f32_16x16x32_bf16 a[44:47], a[172:175], v[92:95], a[44:47]
s_add_u32 s50, s50, s46
buffer_load_dwordx4 v232, s[12:15], s39 offen offset:2048 lds
v_mfma_f32_16x16x32_bf16 a[76:79], a[172:175], v[96:99], a[76:79]
s_lshl_b32 s46, s32, 8
v_exp_f32 v24, v24
v_mfma_f32_16x16x32_bf16 a[108:111], a[172:175], v[100:103], a[108:111]
s_add_u32 s91, s91, s46
v_exp_f32 v25, v25
v_mfma_f32_16x16x32_bf16 v[44:47], a[144:147], v[152:155], v[136:139]
s_and_b32 s47, s32, 1
ds_read_b128 a[136:139], v218 offset:49152
ds_read_b128 a[140:143], v219 offset:49152
v_mfma_f32_16x16x32_bf16 v[44:47], a[148:151], v[156:159], v[44:47]
s_lshl_b32 s47, s47, 6
v_exp_f32 v26, v26
v_mfma_f32_16x16x32_bf16 v[44:47], a[152:155], v[160:163], v[44:47]
s_add_u32 m0, s49, 6144
ds_read_b64_tr_b16 a[172:173], v223 offset:0
ds_read_b64_tr_b16 a[174:175], v223 offset:4096
v_mfma_f32_16x16x32_bf16 v[44:47], a[156:159], v[164:167], v[44:47]
s_add_u32 s48, s90, 4718592
v_exp_f32 v27, v27
v_mfma_f32_16x16x32_bf16 a[16:19], a[176:179], v[88:91], a[16:19]
s_add_u32 s47, s47, 1024
buffer_load_dwordx4 v238, s[60:63], s48 offen  lds
v_mfma_f32_16x16x32_bf16 a[48:51], a[176:179], v[92:95], a[48:51]
s_mov_b32 s88, 0x480
v_exp_f32 v28, v28
v_mfma_f32_16x16x32_bf16 a[80:83], a[176:179], v[96:99], a[80:83]
v_cvt_pk_bf16_f32 v78, v20, v21
v_cvt_pk_bf16_f32 v79, v22, v23
v_mfma_f32_16x16x32_bf16 a[112:115], a[176:179], v[100:103], a[112:115]
s_add_u32 m0, s37, 98304
v_exp_f32 v29, v29
v_mfma_f32_16x16x32_bf16 v[52:55], a[144:147], v[168:171], v[140:143]
buffer_load_dwordx4 v233, s[12:15], s39 offen offset:3072 lds
v_mfma_f32_16x16x32_bf16 v[52:55], a[148:151], v[172:175], v[52:55]
v_exp_f32 v30, v30
v_mfma_f32_16x16x32_bf16 v[52:55], a[152:155], v[176:179], v[52:55]
ds_read_b64_tr_b16 a[176:177], v224 offset:0
ds_read_b64_tr_b16 a[178:179], v224 offset:4096
v_mfma_f32_16x16x32_bf16 v[52:55], a[156:159], v[180:183], v[52:55]
v_exp_f32 v31, v31
v_mfma_f32_16x16x32_bf16 a[20:23], a[180:183], v[88:91], a[20:23]
v_cvt_pk_bf16_f32 v80, v24, v25
v_cvt_pk_bf16_f32 v81, v26, v27
v_mfma_f32_16x16x32_bf16 a[52:55], a[180:183], v[92:95], a[52:55]
s_add_u32 m0, s49, 7168
v_exp_f32 v32, v32
v_mfma_f32_16x16x32_bf16 a[84:87], a[180:183], v[96:99], a[84:87]
s_add_u32 s48, s90, 4866048
buffer_load_dwordx4 v238, s[60:63], s48 offen  lds
v_mfma_f32_16x16x32_bf16 a[116:119], a[180:183], v[100:103], a[116:119]
v_exp_f32 v33, v33
v_smfmac_f32_16x16x64_bf16 a[252:255], a[208:211], v[96:103], v235
ds_read_b64_tr_b16 a[180:181], v225 offset:0
ds_read_b64_tr_b16 a[182:183], v225 offset:4096
v_mfma_f32_16x16x32_bf16 v[60:63], a[144:147], v[184:187], v[144:147]
v_exp_f32 v34, v34
v_mfma_f32_16x16x32_bf16 v[60:63], a[148:151], v[188:191], v[60:63]
s_add_u32 s39, s39, 16384
v_cvt_pk_bf16_f32 v82, v28, v29
v_cvt_pk_bf16_f32 v83, v30, v31
v_mfma_f32_16x16x32_bf16 v[60:63], a[152:155], v[192:195], v[60:63]
s_add_u32 m0, s37, 16384
v_exp_f32 v35, v35
v_mfma_f32_16x16x32_bf16 v[60:63], a[156:159], v[196:199], v[60:63]
buffer_load_dwordx4 v228, s[8:11], s38 offen offset:0 lds
v_mfma_f32_16x16x32_bf16 a[24:27], a[184:187], v[88:91], a[24:27]
v_exp_f32 v36, v36
v_mfma_f32_16x16x32_bf16 a[56:59], a[184:187], v[92:95], a[56:59]
v_cvt_pk_bf16_f32 v84, v32, v33
v_cvt_pk_bf16_f32 v85, v34, v35
v_mfma_f32_16x16x32_bf16 a[88:91], a[184:187], v[96:99], a[88:91]
v_exp_f32 v37, v37
v_mfma_f32_16x16x32_bf16 a[120:123], a[184:187], v[100:103], a[120:123]
buffer_load_dwordx4 v229, s[8:11], s38 offen offset:1024 lds
v_mfma_f32_16x16x32_bf16 v[68:71], a[144:147], v[200:203], v[148:151]
v_exp_f32 v38, v38
v_mfma_f32_16x16x32_bf16 v[68:71], a[148:151], v[204:207], v[68:71]
ds_read_b64_tr_b16 a[184:185], v226 offset:0
ds_read_b64_tr_b16 a[186:187], v226 offset:4096
v_mfma_f32_16x16x32_bf16 v[68:71], a[152:155], v[208:211], v[68:71]
v_exp_f32 v39, v39
v_mfma_f32_16x16x32_bf16 v[68:71], a[156:159], v[212:215], v[68:71]
ds_read_b128 a[144:147], v216 offset:53248
ds_read_b128 a[148:151], v217 offset:53248
v_mfma_f32_16x16x32_bf16 a[28:31], a[188:191], v[88:91], a[28:31]
ds_read_b128 a[152:155], v218 offset:53248
ds_read_b128 a[156:159], v219 offset:53248
v_mfma_f32_16x16x32_bf16 a[60:63], a[188:191], v[92:95], a[60:63]
v_cvt_pk_bf16_f32 v86, v36, v37
v_cvt_pk_bf16_f32 v87, v38, v39
v_mfma_f32_16x16x32_bf16 a[92:95], a[188:191], v[96:99], a[92:95]
v_and_b32 v250, 3, v1
v_mfma_f32_16x16x32_bf16 a[124:127], a[188:191], v[100:103], a[124:127]
s_waitcnt lgkmcnt(6)
ds_read_b64_tr_b16 a[188:189], v227 offset:0
ds_read_b64_tr_b16 a[190:191], v227 offset:4096
v_mfma_f32_16x16x32_bf16 v[8:11], a[128:131], v[152:155], v[136:139]
v_exp_f32 v40, v40
v_mfma_f32_16x16x32_bf16 v[8:11], a[132:135], v[156:159], v[8:11]
v_exp_f32 v41, v41
v_mfma_f32_16x16x32_bf16 v[8:11], a[136:139], v[160:163], v[8:11]
buffer_load_dwordx4 v230, s[8:11], s38 offen offset:2048 lds
v_mfma_f32_16x16x32_bf16 v[8:11], a[140:143], v[164:167], v[8:11]
v_exp_f32 v42, v42
v_mfma_f32_16x16x32_bf16 a[0:3], a[160:163], v[72:75], a[0:3]
v_cvt_pk_bf16_f32 v88, v40, v41
v_lshlrev_b32 v244, 1, v4
v_mfma_f32_16x16x32_bf16 a[32:35], a[160:163], v[76:79], a[32:35]
v_exp_f32 v43, v43
v_mfma_f32_16x16x32_bf16 a[64:67], a[160:163], v[80:83], a[64:67]
v_cvt_pk_bf16_f32 v89, v42, v43
v_xor_b32 v244, v244, v3
v_mfma_f32_16x16x32_bf16 a[96:99], a[160:163], v[84:87], a[96:99]
v_exp_f32 v44, v44
v_mfma_f32_16x16x32_bf16 v[16:19], a[128:131], v[168:171], v[140:143]
ds_read_b64_tr_b16 a[160:161], v220 offset:8192
ds_read_b64_tr_b16 a[162:163], v220 offset:12288
v_mfma_f32_16x16x32_bf16 v[16:19], a[132:135], v[172:175], v[16:19]
v_exp_f32 v45, v45
v_mfma_f32_16x16x32_bf16 v[16:19], a[136:139], v[176:179], v[16:19]
v_cvt_pk_bf16_f32 v90, v44, v45
v_lshlrev_b32 v244, 4, v244
v_mfma_f32_16x16x32_bf16 v[16:19], a[140:143], v[180:183], v[16:19]
v_exp_f32 v46, v46
v_mfma_f32_16x16x32_bf16 a[4:7], a[164:167], v[72:75], a[4:7]
v_xor_b32 v245, 128, v244
v_subrev_u32 v244, 0x480, v244
v_mfma_f32_16x16x32_bf16 a[36:39], a[164:167], v[76:79], a[36:39]
v_exp_f32 v47, v47
v_mfma_f32_16x16x32_bf16 a[68:71], a[164:167], v[80:83], a[68:71]
buffer_load_dwordx4 v231, s[8:11], s38 offen offset:3072 lds
v_mfma_f32_16x16x32_bf16 a[100:103], a[164:167], v[84:87], a[100:103]
v_exp_f32 v48, v48
v_smfmac_f32_16x16x64_bf16 a[248:251], a[208:211], v[72:79], v235
ds_read_b64_tr_b16 a[164:165], v221 offset:8192
ds_read_b64_tr_b16 a[166:167], v221 offset:12288
v_mfma_f32_16x16x32_bf16 v[24:27], a[128:131], v[184:187], v[144:147]
v_exp_f32 v49, v49
v_mfma_f32_16x16x32_bf16 v[24:27], a[132:135], v[188:191], v[24:27]
v_cvt_pk_bf16_f32 v91, v46, v47
v_cvt_pk_bf16_f32 v92, v48, v49
v_mfma_f32_16x16x32_bf16 v[24:27], a[136:139], v[192:195], v[24:27]
v_exp_f32 v50, v50
v_mfma_f32_16x16x32_bf16 v[24:27], a[140:143], v[196:199], v[24:27]
v_subrev_u32 v245, 0x480, v245
v_lshlrev_b32 v246, 4, v250
v_mfma_f32_16x16x32_bf16 a[8:11], a[168:171], v[72:75], a[8:11]
v_exp_f32 v51, v51
v_mfma_f32_16x16x32_bf16 a[40:43], a[168:171], v[76:79], a[40:43]
v_cvt_pk_bf16_f32 v93, v50, v51
v_subrev_u32 v246, 0x480, v246
v_mfma_f32_16x16x32_bf16 a[72:75], a[168:171], v[80:83], a[72:75]
v_exp_f32 v52, v52
v_mfma_f32_16x16x32_bf16 a[104:107], a[168:171], v[84:87], a[104:107]
ds_read_b64_tr_b16 a[168:169], v222 offset:8192
ds_read_b64_tr_b16 a[170:171], v222 offset:12288
v_mfma_f32_16x16x32_bf16 v[32:35], a[128:131], v[200:203], v[148:151]
s_add_u32 s38, s38, 16384
v_exp_f32 v53, v53
v_mfma_f32_16x16x32_bf16 v[32:35], a[132:135], v[204:207], v[32:35]
s_add_u32 m0, s37, 114688
ds_read_b128 a[128:131], v216 offset:57344
ds_read_b128 a[132:135], v217 offset:57344
v_mfma_f32_16x16x32_bf16 v[32:35], a[136:139], v[208:211], v[32:35]
v_exp_f32 v54, v54
v_mfma_f32_16x16x32_bf16 v[32:35], a[140:143], v[212:215], v[32:35]
buffer_load_dwordx4 v232, s[12:15], s39 offen offset:0 lds
v_mfma_f32_16x16x32_bf16 a[12:15], a[172:175], v[72:75], a[12:15]
v_exp_f32 v55, v55
v_mfma_f32_16x16x32_bf16 a[44:47], a[172:175], v[76:79], a[44:47]
ds_read_b128 a[136:139], v218 offset:57344
ds_read_b128 a[140:143], v219 offset:57344
v_mfma_f32_16x16x32_bf16 a[76:79], a[172:175], v[80:83], a[76:79]
v_exp_f32 v56, v56
v_mfma_f32_16x16x32_bf16 a[108:111], a[172:175], v[84:87], a[108:111]
s_waitcnt lgkmcnt(6)
v_exp_f32 v57, v57
v_mfma_f32_16x16x32_bf16 v[12:15], a[144:147], v[152:155], v[136:139]
ds_read_b64_tr_b16 a[172:173], v223 offset:8192
ds_read_b64_tr_b16 a[174:175], v223 offset:12288
v_mfma_f32_16x16x32_bf16 v[12:15], a[148:151], v[156:159], v[12:15]
v_exp_f32 v58, v58
v_mfma_f32_16x16x32_bf16 v[12:15], a[152:155], v[160:163], v[12:15]
v_cvt_pk_bf16_f32 v94, v52, v53
v_cvt_pk_bf16_f32 v95, v54, v55
v_mfma_f32_16x16x32_bf16 v[12:15], a[156:159], v[164:167], v[12:15]
v_exp_f32 v59, v59
v_mfma_f32_16x16x32_bf16 a[16:19], a[176:179], v[72:75], a[16:19]
v_cvt_pk_bf16_f32 v96, v56, v57
v_cvt_pk_bf16_f32 v97, v58, v59
v_mfma_f32_16x16x32_bf16 a[48:51], a[176:179], v[76:79], a[48:51]
v_exp_f32 v60, v60
v_mfma_f32_16x16x32_bf16 a[80:83], a[176:179], v[80:83], a[80:83]
buffer_load_dwordx4 v233, s[12:15], s39 offen offset:1024 lds
v_mfma_f32_16x16x32_bf16 a[112:115], a[176:179], v[84:87], a[112:115]
v_exp_f32 v61, v61
v_mfma_f32_16x16x32_bf16 v[20:23], a[144:147], v[168:171], v[140:143]
ds_read_b64_tr_b16 a[176:177], v224 offset:8192
ds_read_b64_tr_b16 a[178:179], v224 offset:12288
v_mfma_f32_16x16x32_bf16 v[20:23], a[148:151], v[172:175], v[20:23]
v_exp_f32 v62, v62
v_mfma_f32_16x16x32_bf16 v[20:23], a[152:155], v[176:179], v[20:23]
v_cvt_pk_bf16_f32 v98, v60, v61
v_mad_u32_u24 v5, v5, s88, v244
v_mfma_f32_16x16x32_bf16 v[20:23], a[156:159], v[180:183], v[20:23]
v_exp_f32 v63, v63
v_mfma_f32_16x16x32_bf16 a[20:23], a[180:183], v[72:75], a[20:23]
v_cvt_pk_bf16_f32 v99, v62, v63
v_mad_u32_u24 v6, v6, s88, v245
v_mfma_f32_16x16x32_bf16 a[52:55], a[180:183], v[76:79], a[52:55]
v_exp_f32 v64, v64
v_mfma_f32_16x16x32_bf16 a[84:87], a[180:183], v[80:83], a[84:87]
v_mad_u32_u24 v7, v7, s88, v246
v_lshrrev_b32 v249, 1, v1
v_mfma_f32_16x16x32_bf16 a[116:119], a[180:183], v[84:87], a[116:119]
v_exp_f32 v65, v65
v_smfmac_f32_16x16x64_bf16 a[252:255], a[208:211], v[80:87], v235
ds_read_b64_tr_b16 a[180:181], v225 offset:8192
ds_read_b64_tr_b16 a[182:183], v225 offset:12288
v_mfma_f32_16x16x32_bf16 v[28:31], a[144:147], v[184:187], v[144:147]
v_exp_f32 v66, v66
v_mfma_f32_16x16x32_bf16 v[28:31], a[148:151], v[188:191], v[28:31]
buffer_load_dwordx4 v232, s[12:15], s39 offen offset:2048 lds
v_mfma_f32_16x16x32_bf16 v[28:31], a[152:155], v[192:195], v[28:31]
v_exp_f32 v67, v67
v_mfma_f32_16x16x32_bf16 v[28:31], a[156:159], v[196:199], v[28:31]
v_cvt_pk_bf16_f32 v100, v64, v65
v_cvt_pk_bf16_f32 v101, v66, v67
v_mfma_f32_16x16x32_bf16 a[24:27], a[184:187], v[72:75], a[24:27]
v_exp_f32 v68, v68
v_mfma_f32_16x16x32_bf16 a[56:59], a[184:187], v[76:79], a[56:59]
v_mul_u32_u24 v249, 0x480, v249
v_and_b32 v248, 1, v1
v_mfma_f32_16x16x32_bf16 a[88:91], a[184:187], v[80:83], a[88:91]
v_exp_f32 v69, v69
v_mfma_f32_16x16x32_bf16 a[120:123], a[184:187], v[84:87], a[120:123]
ds_read_b64_tr_b16 a[184:185], v226 offset:8192
ds_read_b64_tr_b16 a[186:187], v226 offset:12288
v_mfma_f32_16x16x32_bf16 v[36:39], a[144:147], v[200:203], v[148:151]
v_exp_f32 v70, v70
v_mfma_f32_16x16x32_bf16 v[36:39], a[148:151], v[204:207], v[36:39]
ds_read_b128 a[144:147], v216 offset:61440
ds_read_b128 a[148:151], v217 offset:61440
v_mfma_f32_16x16x32_bf16 v[36:39], a[152:155], v[208:211], v[36:39]
v_exp_f32 v71, v71
v_mfma_f32_16x16x32_bf16 v[36:39], a[156:159], v[212:215], v[36:39]
ds_read_b128 a[152:155], v218 offset:61440
ds_read_b128 a[156:159], v219 offset:61440
v_mfma_f32_16x16x32_bf16 a[28:31], a[188:191], v[72:75], a[28:31]
v_cvt_pk_bf16_f32 v102, v68, v69
v_cvt_pk_bf16_f32 v103, v70, v71
v_mfma_f32_16x16x32_bf16 a[60:63], a[188:191], v[76:79], a[60:63]
v_lshl_add_u32 v249, v248, 4, v249
v_bfe_u32 v248, v1, 2, 2
v_mfma_f32_16x16x32_bf16 a[92:95], a[188:191], v[80:83], a[92:95]
v_lshl_add_u32 v248, v4, 3, v248
v_lshlrev_b32 v248, 6, v248
v_mfma_f32_16x16x32_bf16 a[124:127], a[188:191], v[84:87], a[124:127]
s_waitcnt lgkmcnt(6)
ds_read_b64_tr_b16 a[188:189], v227 offset:8192
ds_read_b64_tr_b16 a[190:191], v227 offset:12288
v_lshl_add_u32 v248, v250, 3, v248
v_mfma_f32_16x16x32_bf16 v[40:43], a[128:131], v[152:155], v[136:139]
v_exp_f32 v8, v8
v_mfma_f32_16x16x32_bf16 v[40:43], a[132:135], v[156:159], v[40:43]
s_add_u32 m0, s49, 0
v_exp_f32 v9, v9
v_mfma_f32_16x16x32_bf16 v[40:43], a[136:139], v[160:163], v[40:43]
buffer_load_dwordx4 v5, s[20:23], s46 offen sc0 sc1 lds
v_mfma_f32_16x16x32_bf16 v[40:43], a[140:143], v[164:167], v[40:43]
v_exp_f32 v10, v10
v_mfma_f32_16x16x32_bf16 a[0:3], a[160:163], v[88:91], a[0:3]
v_cvt_pk_bf16_f32 v72, v8, v9
v_add_u32 v248, s49, v248
v_mfma_f32_16x16x32_bf16 a[32:35], a[160:163], v[92:95], a[32:35]
v_exp_f32 v11, v11
v_mfma_f32_16x16x32_bf16 a[64:67], a[160:163], v[96:99], a[64:67]
v_cvt_pk_bf16_f32 v73, v10, v11
v_and_b32 v244, 7, v1
v_mfma_f32_16x16x32_bf16 a[96:99], a[160:163], v[100:103], a[96:99]
s_add_u32 m0, s49, 1024
v_exp_f32 v12, v12
v_mfma_f32_16x16x32_bf16 v[48:51], a[128:131], v[168:171], v[140:143]
buffer_load_dwordx4 v6, s[20:23], s46 offen sc0 sc1 lds
v_mfma_f32_16x16x32_bf16 v[48:51], a[132:135], v[172:175], v[48:51]
v_exp_f32 v13, v13
v_mfma_f32_16x16x32_bf16 v[48:51], a[136:139], v[176:179], v[48:51]
ds_read_b64_tr_b16 a[160:161], v220 offset:16384
ds_read_b64_tr_b16 a[162:163], v220 offset:20480
v_mfma_f32_16x16x32_bf16 v[48:51], a[140:143], v[180:183], v[48:51]
v_exp_f32 v14, v14
v_mfma_f32_16x16x32_bf16 a[4:7], a[164:167], v[88:91], a[4:7]
v_cvt_pk_bf16_f32 v74, v12, v13
v_lshlrev_b32 v245, 1, v244
v_mfma_f32_16x16x32_bf16 a[36:39], a[164:167], v[92:95], a[36:39]
v_exp_f32 v15, v15
v_mfma_f32_16x16x32_bf16 a[68:71], a[164:167], v[96:99], a[68:71]
s_add_u32 m0, s49, 2048
v_cvt_pk_bf16_f32 v75, v14, v15
v_xor_b32 v245, v245, v4
v_mfma_f32_16x16x32_bf16 a[100:103], a[164:167], v[100:103], a[100:103]
v_exp_f32 v16, v16
v_smfmac_f32_16x16x64_bf16 a[248:251], a[208:211], v[88:95], v235
buffer_load_dwordx4 v7, s[20:23], s47 offen sc0 sc1 lds
v_mfma_f32_16x16x32_bf16 v[56:59], a[128:131], v[184:187], v[144:147]
v_exp_f32 v17, v17
v_mfma_f32_16x16x32_bf16 v[56:59], a[132:135], v[188:191], v[56:59]
ds_read_b64_tr_b16 a[164:165], v221 offset:16384
ds_read_b64_tr_b16 a[166:167], v221 offset:20480
v_mfma_f32_16x16x32_bf16 v[56:59], a[136:139], v[192:195], v[56:59]
v_exp_f32 v18, v18
v_mfma_f32_16x16x32_bf16 v[56:59], a[140:143], v[196:199], v[56:59]
v_cvt_pk_bf16_f32 v76, v16, v17
v_lshlrev_b32 v245, 4, v245
v_mfma_f32_16x16x32_bf16 a[8:11], a[168:171], v[88:91], a[8:11]
s_add_u32 m0, s49, 3072
v_exp_f32 v19, v19
v_mfma_f32_16x16x32_bf16 a[40:43], a[168:171], v[92:95], a[40:43]
s_add_u32 s48, s92, 1024
buffer_load_dwordx4 v249, s[64:67], s48 offen  lds
v_mfma_f32_16x16x32_bf16 a[72:75], a[168:171], v[96:99], a[72:75]
v_exp_f32 v20, v20
v_mfma_f32_16x16x32_bf16 a[104:107], a[168:171], v[100:103], a[104:107]
ds_read_b64_tr_b16 a[168:169], v222 offset:16384
ds_read_b64_tr_b16 a[170:171], v222 offset:20480
v_mfma_f32_16x16x32_bf16 v[64:67], a[128:131], v[200:203], v[148:151]
v_exp_f32 v21, v21
v_mfma_f32_16x16x32_bf16 v[64:67], a[132:135], v[204:207], v[64:67]
ds_read_b128 a[128:131], v216 offset:32768
ds_read_b128 a[132:135], v217 offset:32768
v_mfma_f32_16x16x32_bf16 v[64:67], a[136:139], v[208:211], v[64:67]
v_exp_f32 v22, v22
v_mfma_f32_16x16x32_bf16 v[64:67], a[140:143], v[212:215], v[64:67]
s_add_u32 m0, s37, 114688
ds_read_b128 a[136:139], v218 offset:32768
ds_read_b128 a[140:143], v219 offset:32768
v_mfma_f32_16x16x32_bf16 a[12:15], a[172:175], v[88:91], a[12:15]
v_exp_f32 v23, v23
v_mfma_f32_16x16x32_bf16 a[44:47], a[172:175], v[92:95], a[44:47]
buffer_load_dwordx4 v233, s[12:15], s39 offen offset:3072 lds
v_mfma_f32_16x16x32_bf16 a[76:79], a[172:175], v[96:99], a[76:79]
v_exp_f32 v24, v24
v_mfma_f32_16x16x32_bf16 a[108:111], a[172:175], v[100:103], a[108:111]
s_waitcnt lgkmcnt(6)
v_exp_f32 v25, v25
v_mfma_f32_16x16x32_bf16 v[44:47], a[144:147], v[152:155], v[136:139]
ds_read_b64_tr_b16 a[172:173], v223 offset:16384
ds_read_b64_tr_b16 a[174:175], v223 offset:20480
v_mfma_f32_16x16x32_bf16 v[44:47], a[148:151], v[156:159], v[44:47]
v_exp_f32 v26, v26
v_mfma_f32_16x16x32_bf16 v[44:47], a[152:155], v[160:163], v[44:47]
s_add_u32 s39, s39, 16384
v_cvt_pk_bf16_f32 v77, v18, v19
v_cvt_pk_bf16_f32 v78, v20, v21
v_mfma_f32_16x16x32_bf16 v[44:47], a[156:159], v[164:167], v[44:47]
s_add_u32 m0, s37, 0
v_exp_f32 v27, v27
v_mfma_f32_16x16x32_bf16 a[16:19], a[176:179], v[88:91], a[16:19]
buffer_load_dwordx4 v228, s[8:11], s38 offen offset:0 lds
v_mfma_f32_16x16x32_bf16 a[48:51], a[176:179], v[92:95], a[48:51]
v_exp_f32 v28, v28
v_mfma_f32_16x16x32_bf16 a[80:83], a[176:179], v[96:99], a[80:83]
v_cvt_pk_bf16_f32 v79, v22, v23
v_cvt_pk_bf16_f32 v80, v24, v25
v_mfma_f32_16x16x32_bf16 a[112:115], a[176:179], v[100:103], a[112:115]
v_exp_f32 v29, v29
v_mfma_f32_16x16x32_bf16 v[52:55], a[144:147], v[168:171], v[140:143]
ds_read_b64_tr_b16 a[176:177], v224 offset:16384
ds_read_b64_tr_b16 a[178:179], v224 offset:20480
v_mfma_f32_16x16x32_bf16 v[52:55], a[148:151], v[172:175], v[52:55]
v_exp_f32 v30, v30
v_mfma_f32_16x16x32_bf16 v[52:55], a[152:155], v[176:179], v[52:55]
buffer_load_dwordx4 v229, s[8:11], s38 offen offset:1024 lds
v_mfma_f32_16x16x32_bf16 v[52:55], a[156:159], v[180:183], v[52:55]
v_exp_f32 v31, v31
v_mfma_f32_16x16x32_bf16 a[20:23], a[180:183], v[88:91], a[20:23]
v_cvt_pk_bf16_f32 v81, v26, v27
v_cvt_pk_bf16_f32 v82, v28, v29
v_mfma_f32_16x16x32_bf16 a[52:55], a[180:183], v[92:95], a[52:55]
v_exp_f32 v32, v32
v_mfma_f32_16x16x32_bf16 a[84:87], a[180:183], v[96:99], a[84:87]
v_cvt_pk_bf16_f32 v83, v30, v31
v_lshl_add_u32 v245, v244, 8, v245
v_mfma_f32_16x16x32_bf16 a[116:119], a[180:183], v[100:103], a[116:119]
v_exp_f32 v33, v33
v_smfmac_f32_16x16x64_bf16 a[252:255], a[208:211], v[96:103], v235
buffer_load_dwordx4 v230, s[8:11], s38 offen offset:2048 lds
v_mfma_f32_16x16x32_bf16 v[60:63], a[144:147], v[184:187], v[144:147]
v_exp_f32 v34, v34
v_mfma_f32_16x16x32_bf16 v[60:63], a[148:151], v[188:191], v[60:63]
ds_read_b64_tr_b16 a[180:181], v225 offset:16384
ds_read_b64_tr_b16 a[182:183], v225 offset:20480
v_mfma_f32_16x16x32_bf16 v[60:63], a[152:155], v[192:195], v[60:63]
v_exp_f32 v35, v35
v_mfma_f32_16x16x32_bf16 v[60:63], a[156:159], v[196:199], v[60:63]
v_cvt_pk_bf16_f32 v84, v32, v33
v_cvt_pk_bf16_f32 v85, v34, v35
v_mfma_f32_16x16x32_bf16 a[24:27], a[184:187], v[88:91], a[24:27]
v_exp_f32 v36, v36
v_mfma_f32_16x16x32_bf16 a[56:59], a[184:187], v[92:95], a[56:59]
v_add_u32 v245, s49, v245
v_lshlrev_b32 v246, 4, v4
v_mfma_f32_16x16x32_bf16 a[88:91], a[184:187], v[96:99], a[88:91]
v_exp_f32 v37, v37
v_mfma_f32_16x16x32_bf16 a[120:123], a[184:187], v[100:103], a[120:123]
buffer_load_dwordx4 v231, s[8:11], s38 offen offset:3072 lds
v_mfma_f32_16x16x32_bf16 v[68:71], a[144:147], v[200:203], v[148:151]
v_exp_f32 v38, v38
v_mfma_f32_16x16x32_bf16 v[68:71], a[148:151], v[204:207], v[68:71]
ds_read_b64_tr_b16 a[184:185], v226 offset:16384
ds_read_b64_tr_b16 a[186:187], v226 offset:20480
v_mfma_f32_16x16x32_bf16 v[68:71], a[152:155], v[208:211], v[68:71]
v_exp_f32 v39, v39
v_mfma_f32_16x16x32_bf16 v[68:71], a[156:159], v[212:215], v[68:71]
ds_read_b128 a[144:147], v216 offset:36864
ds_read_b128 a[148:151], v217 offset:36864
v_mfma_f32_16x16x32_bf16 a[28:31], a[188:191], v[88:91], a[28:31]
ds_read_b128 a[152:155], v218 offset:36864
ds_read_b128 a[156:159], v219 offset:36864
v_mfma_f32_16x16x32_bf16 a[60:63], a[188:191], v[92:95], a[60:63]
s_add_u32 s38, s38, 16384
v_cvt_pk_bf16_f32 v86, v36, v37
v_cvt_pk_bf16_f32 v87, v38, v39
v_mfma_f32_16x16x32_bf16 a[92:95], a[188:191], v[96:99], a[92:95]
v_lshl_add_u32 v246, v244, 6, v246
v_mfma_f32_16x16x32_bf16 a[124:127], a[188:191], v[100:103], a[124:127]
s_waitcnt lgkmcnt(6)
s_cmp_lt_u32 s32, 2
s_cselect_b64 s[88:89], -1, 0
ds_read_b64_tr_b16 a[188:189], v227 offset:16384
ds_read_b64_tr_b16 a[190:191], v227 offset:20480
v_mfma_f32_16x16x32_bf16 v[8:11], a[128:131], v[152:155], v[136:139]
v_exp_f32 v40, v40
v_mfma_f32_16x16x32_bf16 v[8:11], a[132:135], v[156:159], v[8:11]
v_exp_f32 v41, v41
v_mfma_f32_16x16x32_bf16 v[8:11], a[136:139], v[160:163], v[8:11]
buffer_load_dwordx2 v[252:253], v251, s[76:79], s42 offen sc1
v_mfma_f32_16x16x32_bf16 v[8:11], a[140:143], v[164:167], v[8:11]
v_exp_f32 v42, v42
v_mfma_f32_16x16x32_bf16 a[0:3], a[160:163], v[72:75], a[0:3]
v_cvt_pk_bf16_f32 v88, v40, v41
v_add_u32 v246, s49, v246
v_mfma_f32_16x16x32_bf16 a[32:35], a[160:163], v[76:79], a[32:35]
v_exp_f32 v43, v43
v_mfma_f32_16x16x32_bf16 a[64:67], a[160:163], v[80:83], a[64:67]
v_cvt_pk_bf16_f32 v89, v42, v43
v_xor_b32 v5, 64, v245
v_mfma_f32_16x16x32_bf16 a[96:99], a[160:163], v[84:87], a[96:99]
v_exp_f32 v44, v44
v_mfma_f32_16x16x32_bf16 v[16:19], a[128:131], v[168:171], v[140:143]
ds_read_b64_tr_b16 a[160:161], v220 offset:24576
ds_read_b64_tr_b16 a[162:163], v220 offset:28672
v_mfma_f32_16x16x32_bf16 v[16:19], a[132:135], v[172:175], v[16:19]
v_exp_f32 v45, v45
v_mfma_f32_16x16x32_bf16 v[16:19], a[136:139], v[176:179], v[16:19]
v_cvt_pk_bf16_f32 v90, v44, v45
v_xor_b32 v6, 128, v245
v_mfma_f32_16x16x32_bf16 v[16:19], a[140:143], v[180:183], v[16:19]
v_exp_f32 v46, v46
v_mfma_f32_16x16x32_bf16 a[4:7], a[164:167], v[72:75], a[4:7]
v_xor_b32 v7, 192, v245
v_lshrrev_b32 v249, 2, v1
v_mfma_f32_16x16x32_bf16 a[36:39], a[164:167], v[76:79], a[36:39]
v_exp_f32 v47, v47
v_mfma_f32_16x16x32_bf16 a[68:71], a[164:167], v[80:83], a[68:71]
v_cvt_pk_bf16_f32 v91, v46, v47
v_lshlrev_b32 v249, 5, v249
v_mfma_f32_16x16x32_bf16 a[100:103], a[164:167], v[84:87], a[100:103]
v_exp_f32 v48, v48
v_smfmac_f32_16x16x64_bf16 a[248:251], a[208:211], v[72:79], v235
s_add_u32 s42, s42, s43
buffer_load_dword v255, v243, s[28:31], s45 offen
v_mfma_f32_16x16x32_bf16 v[24:27], a[128:131], v[184:187], v[144:147]
v_exp_f32 v49, v49
v_mfma_f32_16x16x32_bf16 v[24:27], a[132:135], v[188:191], v[24:27]
ds_read_b64_tr_b16 a[164:165], v221 offset:24576
ds_read_b64_tr_b16 a[166:167], v221 offset:28672
v_mfma_f32_16x16x32_bf16 v[24:27], a[136:139], v[192:195], v[24:27]
v_exp_f32 v50, v50
v_mfma_f32_16x16x32_bf16 v[24:27], a[140:143], v[196:199], v[24:27]
v_cvt_pk_bf16_f32 v92, v48, v49
v_lshl_add_u32 v249, v250, 3, v249
v_mfma_f32_16x16x32_bf16 a[8:11], a[168:171], v[72:75], a[8:11]
v_exp_f32 v51, v51
v_mfma_f32_16x16x32_bf16 a[40:43], a[168:171], v[76:79], a[40:43]
v_cvt_pk_bf16_f32 v93, v50, v51
v_add_u32 v249, s49, v249
v_mfma_f32_16x16x32_bf16 a[72:75], a[168:171], v[80:83], a[72:75]
v_exp_f32 v52, v52
v_mfma_f32_16x16x32_bf16 a[104:107], a[168:171], v[84:87], a[104:107]
ds_read_b64_tr_b16 a[168:169], v222 offset:24576
ds_read_b64_tr_b16 a[170:171], v222 offset:28672
v_mfma_f32_16x16x32_bf16 v[32:35], a[128:131], v[200:203], v[148:151]
v_exp_f32 v53, v53
v_mfma_f32_16x16x32_bf16 v[32:35], a[132:135], v[204:207], v[32:35]
ds_read_b128 a[128:131], v216 offset:40960
ds_read_b128 a[132:135], v217 offset:40960
v_mfma_f32_16x16x32_bf16 v[32:35], a[136:139], v[208:211], v[32:35]
v_exp_f32 v54, v54
v_mfma_f32_16x16x32_bf16 v[32:35], a[140:143], v[212:215], v[32:35]
ds_read_b128 a[136:139], v218 offset:40960
ds_read_b128 a[140:143], v219 offset:40960
v_mfma_f32_16x16x32_bf16 a[12:15], a[172:175], v[72:75], a[12:15]
v_exp_f32 v55, v55
v_mfma_f32_16x16x32_bf16 a[44:47], a[172:175], v[76:79], a[44:47]
v_cvt_pk_bf16_f32 v94, v52, v53
v_cvt_pk_bf16_f32 v95, v54, v55
v_mfma_f32_16x16x32_bf16 a[76:79], a[172:175], v[80:83], a[76:79]
s_waitcnt lgkmcnt(6)
v_exp_f32 v56, v56
v_mfma_f32_16x16x32_bf16 a[108:111], a[172:175], v[84:87], a[108:111]
s_add_u32 s45, s45, 589824
v_exp_f32 v57, v57
v_mfma_f32_16x16x32_bf16 v[12:15], a[144:147], v[152:155], v[136:139]
global_load_dword v255, v242, s[72:73]
v_mfma_f32_16x16x32_bf16 v[12:15], a[148:151], v[156:159], v[12:15]
v_exp_f32 v58, v58
v_mfma_f32_16x16x32_bf16 v[12:15], a[152:155], v[160:163], v[12:15]
ds_read_b64_tr_b16 a[172:173], v223 offset:24576
ds_read_b64_tr_b16 a[174:175], v223 offset:28672
v_mfma_f32_16x16x32_bf16 v[12:15], a[156:159], v[164:167], v[12:15]
v_exp_f32 v59, v59
v_mfma_f32_16x16x32_bf16 a[16:19], a[176:179], v[72:75], a[16:19]
v_cvt_pk_bf16_f32 v96, v56, v57
v_cvt_pk_bf16_f32 v97, v58, v59
v_mfma_f32_16x16x32_bf16 a[48:51], a[176:179], v[76:79], a[48:51]
v_exp_f32 v60, v60
v_mfma_f32_16x16x32_bf16 a[80:83], a[176:179], v[80:83], a[80:83]
v_mfma_f32_16x16x32_bf16 a[112:115], a[176:179], v[84:87], a[112:115]
v_exp_f32 v61, v61
v_mfma_f32_16x16x32_bf16 v[20:23], a[144:147], v[168:171], v[140:143]
ds_read_b64_tr_b16 a[176:177], v224 offset:24576
ds_read_b64_tr_b16 a[178:179], v224 offset:28672
v_mfma_f32_16x16x32_bf16 v[20:23], a[148:151], v[172:175], v[20:23]
v_exp_f32 v62, v62
v_mfma_f32_16x16x32_bf16 v[20:23], a[152:155], v[176:179], v[20:23]
v_cvt_pk_bf16_f32 v98, v60, v61
v_mfma_f32_16x16x32_bf16 v[20:23], a[156:159], v[180:183], v[20:23]
v_exp_f32 v63, v63
v_mfma_f32_16x16x32_bf16 a[20:23], a[180:183], v[72:75], a[20:23]
v_cvt_pk_bf16_f32 v99, v62, v63
v_mfma_f32_16x16x32_bf16 a[52:55], a[180:183], v[76:79], a[52:55]
v_exp_f32 v64, v64
v_mfma_f32_16x16x32_bf16 a[84:87], a[180:183], v[80:83], a[84:87]
buffer_load_dword v255, v0, s[24:27], s44 offen
v_mfma_f32_16x16x32_bf16 a[116:119], a[180:183], v[84:87], a[116:119]
v_exp_f32 v65, v65
v_smfmac_f32_16x16x64_bf16 a[252:255], a[208:211], v[80:87], v235
ds_read_b64_tr_b16 a[180:181], v225 offset:24576
ds_read_b64_tr_b16 a[182:183], v225 offset:28672
v_mfma_f32_16x16x32_bf16 v[28:31], a[144:147], v[184:187], v[144:147]
v_exp_f32 v66, v66
v_mfma_f32_16x16x32_bf16 v[28:31], a[148:151], v[188:191], v[28:31]
v_cvt_pk_bf16_f32 v100, v64, v65
v_mfma_f32_16x16x32_bf16 v[28:31], a[152:155], v[192:195], v[28:31]
v_exp_f32 v67, v67
v_mfma_f32_16x16x32_bf16 v[28:31], a[156:159], v[196:199], v[28:31]
v_cvt_pk_bf16_f32 v101, v66, v67
v_mfma_f32_16x16x32_bf16 a[24:27], a[184:187], v[72:75], a[24:27]
v_exp_f32 v68, v68
v_mfma_f32_16x16x32_bf16 a[56:59], a[184:187], v[76:79], a[56:59]
v_mfma_f32_16x16x32_bf16 a[88:91], a[184:187], v[80:83], a[88:91]
v_exp_f32 v69, v69
v_mfma_f32_16x16x32_bf16 a[120:123], a[184:187], v[84:87], a[120:123]
ds_read_b64_tr_b16 a[184:185], v226 offset:24576
ds_read_b64_tr_b16 a[186:187], v226 offset:28672
v_mfma_f32_16x16x32_bf16 v[36:39], a[144:147], v[200:203], v[148:151]
v_exp_f32 v70, v70
v_mfma_f32_16x16x32_bf16 v[36:39], a[148:151], v[204:207], v[36:39]
ds_read_b128 a[144:147], v216 offset:45056
ds_read_b128 a[148:151], v217 offset:45056
v_mfma_f32_16x16x32_bf16 v[36:39], a[152:155], v[208:211], v[36:39]
v_exp_f32 v71, v71
v_mfma_f32_16x16x32_bf16 v[36:39], a[156:159], v[212:215], v[36:39]
ds_read_b128 a[152:155], v218 offset:45056
ds_read_b128 a[156:159], v219 offset:45056
v_mfma_f32_16x16x32_bf16 a[28:31], a[188:191], v[72:75], a[28:31]
v_cvt_pk_bf16_f32 v102, v68, v69
v_cvt_pk_bf16_f32 v103, v70, v71
v_mfma_f32_16x16x32_bf16 a[60:63], a[188:191], v[76:79], a[60:63]
s_add_u32 s44, s44, 4096
v_mfma_f32_16x16x32_bf16 a[92:95], a[188:191], v[80:83], a[92:95]
v_mfma_f32_16x16x32_bf16 a[124:127], a[188:191], v[84:87], a[124:127]
s_waitcnt lgkmcnt(6)
ds_read_b64_tr_b16 a[188:189], v227 offset:24576
ds_read_b64_tr_b16 a[190:191], v227 offset:28672
v_mfma_f32_16x16x32_bf16 v[40:43], a[128:131], v[152:155], v[136:139]
v_exp_f32 v8, v8
v_mfma_f32_16x16x32_bf16 v[40:43], a[132:135], v[156:159], v[40:43]
v_exp_f32 v9, v9
v_mfma_f32_16x16x32_bf16 v[40:43], a[136:139], v[160:163], v[40:43]
v_cvt_pk_bf16_f32 v72, v8, v9
v_mfma_f32_16x16x32_bf16 v[40:43], a[140:143], v[164:167], v[40:43]
v_exp_f32 v10, v10
v_mfma_f32_16x16x32_bf16 a[0:3], a[160:163], v[88:91], a[0:3]
v_mfma_f32_16x16x32_bf16 a[32:35], a[160:163], v[92:95], a[32:35]
v_exp_f32 v11, v11
s_waitcnt vmcnt(4) lgkmcnt(0)
s_barrier
v_mfma_f32_16x16x32_bf16 a[64:67], a[160:163], v[96:99], a[64:67]
v_cvt_pk_bf16_f32 v73, v10, v11
v_mfma_f32_16x16x32_bf16 a[96:99], a[160:163], v[100:103], a[96:99]
s_add_u32 m0, s37, 65536
v_exp_f32 v12, v12
v_mfma_f32_16x16x32_bf16 v[48:51], a[128:131], v[168:171], v[140:143]
s_waitcnt vmcnt(9)
s_nop 0
buffer_load_dwordx4 v232, s[12:15], s39 offen offset:0 lds
v_mfma_f32_16x16x32_bf16 v[48:51], a[132:135], v[172:175], v[48:51]
v_exp_f32 v13, v13
v_mfma_f32_16x16x32_bf16 v[48:51], a[136:139], v[176:179], v[48:51]
ds_read_b64_tr_b16 a[160:161], v220 offset:32768
ds_read_b64_tr_b16 a[162:163], v220 offset:36864
v_mfma_f32_16x16x32_bf16 v[48:51], a[140:143], v[180:183], v[48:51]
v_exp_f32 v14, v14
v_mfma_f32_16x16x32_bf16 a[4:7], a[164:167], v[88:91], a[4:7]
ds_read_b64_tr_b16 a[192:193], v248 offset:4096
v_cvt_pk_bf16_f32 v74, v12, v13
v_mfma_f32_16x16x32_bf16 a[36:39], a[164:167], v[92:95], a[36:39]
v_exp_f32 v15, v15
v_mfma_f32_16x16x32_bf16 a[68:71], a[164:167], v[96:99], a[68:71]
ds_read_b64_tr_b16 a[194:195], v248 offset:4352
v_cvt_pk_bf16_f32 v75, v14, v15
v_mfma_f32_16x16x32_bf16 a[100:103], a[164:167], v[100:103], a[100:103]
v_exp_f32 v16, v16
v_smfmac_f32_16x16x64_bf16 a[248:251], a[208:211], v[88:95], v235
buffer_load_dwordx4 v233, s[12:15], s39 offen offset:1024 lds
v_mfma_f32_16x16x32_bf16 v[56:59], a[128:131], v[184:187], v[144:147]
v_exp_f32 v17, v17
v_mfma_f32_16x16x32_bf16 v[56:59], a[132:135], v[188:191], v[56:59]
ds_read_b64_tr_b16 a[164:165], v221 offset:32768
ds_read_b64_tr_b16 a[166:167], v221 offset:36864
v_mfma_f32_16x16x32_bf16 v[56:59], a[136:139], v[192:195], v[56:59]
v_exp_f32 v18, v18
v_mfma_f32_16x16x32_bf16 v[56:59], a[140:143], v[196:199], v[56:59]
ds_read_b64_tr_b16 a[196:197], v248 offset:4128
v_cvt_pk_bf16_f32 v76, v16, v17
v_mfma_f32_16x16x32_bf16 a[8:11], a[168:171], v[88:91], a[8:11]
v_exp_f32 v19, v19
v_mfma_f32_16x16x32_bf16 a[40:43], a[168:171], v[92:95], a[40:43]
ds_read_b64_tr_b16 a[198:199], v248 offset:4384
v_cvt_pk_bf16_f32 v77, v18, v19
v_mfma_f32_16x16x32_bf16 a[72:75], a[168:171], v[96:99], a[72:75]
v_exp_f32 v20, v20
v_mfma_f32_16x16x32_bf16 a[104:107], a[168:171], v[100:103], a[104:107]
ds_read_b64_tr_b16 a[168:169], v222 offset:32768
ds_read_b64_tr_b16 a[170:171], v222 offset:36864
v_mfma_f32_16x16x32_bf16 v[64:67], a[128:131], v[200:203], v[148:151]
v_exp_f32 v21, v21
v_mfma_f32_16x16x32_bf16 v[64:67], a[132:135], v[204:207], v[64:67]
buffer_load_dwordx4 v232, s[12:15], s39 offen offset:2048 lds
v_mfma_f32_16x16x32_bf16 v[64:67], a[136:139], v[208:211], v[64:67]
v_exp_f32 v22, v22
v_mfma_f32_16x16x32_bf16 v[64:67], a[140:143], v[212:215], v[64:67]
ds_read_b128 a[128:131], v216 offset:16384
ds_read_b128 a[132:135], v217 offset:16384
v_mfma_f32_16x16x32_bf16 a[12:15], a[172:175], v[88:91], a[12:15]
v_exp_f32 v23, v23
v_mfma_f32_16x16x32_bf16 a[44:47], a[172:175], v[92:95], a[44:47]
ds_read_b128 a[136:139], v218 offset:16384
ds_read_b128 a[140:143], v219 offset:16384
v_mfma_f32_16x16x32_bf16 a[76:79], a[172:175], v[96:99], a[76:79]
v_exp_f32 v24, v24
v_mfma_f32_16x16x32_bf16 a[108:111], a[172:175], v[100:103], a[108:111]
v_exp_f32 v25, v25
v_mfma_f32_16x16x32_bf16 v[44:47], a[144:147], v[152:155], v[136:139]
ds_read_b64_tr_b16 a[172:173], v223 offset:32768
ds_read_b64_tr_b16 a[174:175], v223 offset:36864
v_mfma_f32_16x16x32_bf16 v[44:47], a[148:151], v[156:159], v[44:47]
v_exp_f32 v26, v26
v_mfma_f32_16x16x32_bf16 v[44:47], a[152:155], v[160:163], v[44:47]
buffer_load_dwordx4 v233, s[12:15], s39 offen offset:3072 lds
v_mfma_f32_16x16x32_bf16 v[44:47], a[156:159], v[164:167], v[44:47]
v_exp_f32 v27, v27
v_mfma_f32_16x16x32_bf16 a[16:19], a[176:179], v[88:91], a[16:19]
v_cvt_pk_bf16_f32 v78, v20, v21
v_cvt_pk_bf16_f32 v79, v22, v23
v_mfma_f32_16x16x32_bf16 a[48:51], a[176:179], v[92:95], a[48:51]
v_exp_f32 v28, v28
v_mfma_f32_16x16x32_bf16 a[80:83], a[176:179], v[96:99], a[80:83]
v_cvt_pk_bf16_f32 v80, v24, v25
v_cvt_pk_bf16_f32 v81, v26, v27
v_mfma_f32_16x16x32_bf16 a[112:115], a[176:179], v[100:103], a[112:115]
v_exp_f32 v29, v29
v_mfma_f32_16x16x32_bf16 v[52:55], a[144:147], v[168:171], v[140:143]
ds_read_b64_tr_b16 a[176:177], v224 offset:32768
ds_read_b64_tr_b16 a[178:179], v224 offset:36864
v_mfma_f32_16x16x32_bf16 v[52:55], a[148:151], v[172:175], v[52:55]
v_exp_f32 v30, v30
v_mfma_f32_16x16x32_bf16 v[52:55], a[152:155], v[176:179], v[52:55]
ds_read_b64_tr_b16 a[200:201], v248 offset:6144
v_cvt_pk_bf16_f32 v82, v28, v29
v_mfma_f32_16x16x32_bf16 v[52:55], a[156:159], v[180:183], v[52:55]
s_add_u32 s39, s39, 16384
v_exp_f32 v31, v31
v_mfma_f32_16x16x32_bf16 a[20:23], a[180:183], v[88:91], a[20:23]
s_add_u32 m0, s37, 49152
ds_read_b64_tr_b16 a[202:203], v248 offset:6400
v_cvt_pk_bf16_f32 v83, v30, v31
v_mfma_f32_16x16x32_bf16 a[52:55], a[180:183], v[92:95], a[52:55]
v_exp_f32 v32, v32
v_mfma_f32_16x16x32_bf16 a[84:87], a[180:183], v[96:99], a[84:87]
buffer_load_dwordx4 v228, s[8:11], s38 offen offset:0 lds
v_mfma_f32_16x16x32_bf16 a[116:119], a[180:183], v[100:103], a[116:119]
v_exp_f32 v33, v33
v_smfmac_f32_16x16x64_bf16 a[252:255], a[208:211], v[96:103], v235
ds_read_b64_tr_b16 a[180:181], v225 offset:32768
ds_read_b64_tr_b16 a[182:183], v225 offset:36864
v_mfma_f32_16x16x32_bf16 v[60:63], a[144:147], v[184:187], v[144:147]
v_exp_f32 v34, v34
v_mfma_f32_16x16x32_bf16 v[60:63], a[148:151], v[188:191], v[60:63]
ds_read_b64_tr_b16 a[204:205], v248 offset:6176
v_cvt_pk_bf16_f32 v84, v32, v33
v_mfma_f32_16x16x32_bf16 v[60:63], a[152:155], v[192:195], v[60:63]
v_exp_f32 v35, v35
v_mfma_f32_16x16x32_bf16 v[60:63], a[156:159], v[196:199], v[60:63]
buffer_load_dwordx4 v229, s[8:11], s38 offen offset:1024 lds
v_mfma_f32_16x16x32_bf16 a[24:27], a[184:187], v[88:91], a[24:27]
v_exp_f32 v36, v36
v_mfma_f32_16x16x32_bf16 a[56:59], a[184:187], v[92:95], a[56:59]
ds_read_b64_tr_b16 a[206:207], v248 offset:6432
v_cvt_pk_bf16_f32 v85, v34, v35
v_mfma_f32_16x16x32_bf16 a[88:91], a[184:187], v[96:99], a[88:91]
v_exp_f32 v37, v37
v_mfma_f32_16x16x32_bf16 a[120:123], a[184:187], v[100:103], a[120:123]
ds_read_b64_tr_b16 a[184:185], v226 offset:32768
ds_read_b64_tr_b16 a[186:187], v226 offset:36864
v_mfma_f32_16x16x32_bf16 v[68:71], a[144:147], v[200:203], v[148:151]
v_exp_f32 v38, v38
v_mfma_f32_16x16x32_bf16 v[68:71], a[148:151], v[204:207], v[68:71]
ds_read_b128 a[144:147], v216 offset:20480
ds_read_b128 a[148:151], v217 offset:20480
v_mfma_f32_16x16x32_bf16 v[68:71], a[152:155], v[208:211], v[68:71]
v_exp_f32 v39, v39
v_mfma_f32_16x16x32_bf16 v[68:71], a[156:159], v[212:215], v[68:71]
ds_read_b128 a[152:155], v218 offset:20480
ds_read_b128 a[156:159], v219 offset:20480
v_mfma_f32_16x16x32_bf16 a[28:31], a[188:191], v[88:91], a[28:31]
v_cvt_pk_bf16_f32 v86, v36, v37
v_cvt_pk_bf16_f32 v87, v38, v39
v_mfma_f32_16x16x32_bf16 a[60:63], a[188:191], v[92:95], a[60:63]
ds_read_b128 a[228:231], v246 offset:2048
ds_read_b128 a[212:215], v245
v_mfma_f32_16x16x32_bf16 a[92:95], a[188:191], v[96:99], a[92:95]
ds_read_b128 a[216:219], v5
v_mfma_f32_16x16x32_bf16 a[124:127], a[188:191], v[100:103], a[124:127]
s_waitcnt lgkmcnt(9)
ds_read_b64_tr_b16 a[188:189], v227 offset:32768
ds_read_b64_tr_b16 a[190:191], v227 offset:36864
v_mfma_f32_16x16x32_bf16 v[8:11], a[128:131], v[152:155], v[136:139]
v_exp_f32 v40, v40
v_mfma_f32_16x16x32_bf16 v[8:11], a[132:135], v[156:159], v[8:11]
buffer_load_dwordx4 v230, s[8:11], s38 offen offset:2048 lds
v_mfma_f32_16x16x32_bf16 v[8:11], a[136:139], v[160:163], v[8:11]
v_exp_f32 v41, v41
v_mfma_f32_16x16x32_bf16 v[8:11], a[140:143], v[164:167], v[8:11]
ds_read_b128 a[220:223], v6
v_cvt_pk_bf16_f32 v88, v40, v41
v_mfma_f32_16x16x32_bf16 a[0:3], a[160:163], v[72:75], a[0:3]
v_exp_f32 v42, v42
v_mfma_f32_16x16x32_bf16 a[32:35], a[160:163], v[76:79], a[32:35]
ds_read_b128 a[224:227], v7
ds_read_b64_tr_b16 a[232:233], v249 offset:3072
v_mfma_f32_16x16x32_bf16 a[64:67], a[160:163], v[80:83], a[64:67]
v_exp_f32 v43, v43
v_mfma_f32_16x16x32_bf16 a[96:99], a[160:163], v[84:87], a[96:99]
ds_read_b64_tr_b16 a[160:161], v220 offset:40960
ds_read_b64_tr_b16 a[162:163], v220 offset:45056
v_mfma_f32_16x16x32_bf16 v[16:19], a[128:131], v[168:171], v[140:143]
v_exp_f32 v44, v44
v_mfma_f32_16x16x32_bf16 v[16:19], a[132:135], v[172:175], v[16:19]
s_add_u32 m0, s49, 4096
ds_read_b64_tr_b16 a[234:235], v249 offset:3584
v_cvt_pk_bf16_f32 v89, v42, v43
v_mfma_f32_16x16x32_bf16 v[16:19], a[136:139], v[176:179], v[16:19]
s_add_u32 s48, s50, 0
v_exp_f32 v45, v45
v_mfma_f32_16x16x32_bf16 v[16:19], a[140:143], v[180:183], v[16:19]
buffer_load_dwordx4 v238, s[60:63], s48 offen  lds
v_mfma_f32_16x16x32_bf16 a[4:7], a[164:167], v[72:75], a[4:7]
v_exp_f32 v46, v46
v_mfma_f32_16x16x32_bf16 a[36:39], a[164:167], v[76:79], a[36:39]
v_cvt_pk_bf16_f32 v90, v44, v45
v_mfma_f32_16x16x32_bf16 a[68:71], a[164:167], v[80:83], a[68:71]
v_exp_f32 v47, v47
v_mfma_f32_16x16x32_bf16 a[100:103], a[164:167], v[84:87], a[100:103]
ds_read_b64_tr_b16 a[164:165], v221 offset:40960
ds_read_b64_tr_b16 a[166:167], v221 offset:45056
v_smfmac_f32_16x16x64_bf16 a[248:251], a[208:211], v[72:79], v235
s_waitcnt lgkmcnt(5)
v_exp_f32 v48, v48
v_mfma_f32_16x16x32_bf16 v[104:107], a[192:195], a[228:231], 0
s_add_u32 m0, s37, 49152
v_cvt_pk_bf16_f32 v91, v46, v47
v_mfma_f32_16x16x32_bf16 v[24:27], a[128:131], v[184:187], v[144:147]
v_exp_f32 v49, v49
v_mfma_f32_16x16x32_bf16 v[24:27], a[132:135], v[188:191], v[24:27]
buffer_load_dwordx4 v231, s[8:11], s38 offen offset:3072 lds
v_mfma_f32_16x16x32_bf16 v[24:27], a[136:139], v[192:195], v[24:27]
v_exp_f32 v50, v50
v_mfma_f32_16x16x32_bf16 v[24:27], a[140:143], v[196:199], v[24:27]
v_cvt_pk_bf16_f32 v92, v48, v49
v_mfma_f32_16x16x32_bf16 a[8:11], a[168:171], v[72:75], a[8:11]
v_exp_f32 v51, v51
v_mfma_f32_16x16x32_bf16 a[40:43], a[168:171], v[76:79], a[40:43]
v_cvt_pk_bf16_f32 v93, v50, v51
v_mfma_f32_16x16x32_bf16 a[72:75], a[168:171], v[80:83], a[72:75]
v_exp_f32 v52, v52
v_mfma_f32_16x16x32_bf16 a[104:107], a[168:171], v[84:87], a[104:107]
s_add_u32 m0, s49, 5120
ds_read_b64_tr_b16 a[168:169], v222 offset:40960
ds_read_b64_tr_b16 a[170:171], v222 offset:45056
v_mfma_f32_16x16x32_bf16 v[32:35], a[128:131], v[200:203], v[148:151]
s_add_u32 s48, s50, 147456
v_exp_f32 v53, v53
v_mfma_f32_16x16x32_bf16 v[32:35], a[132:135], v[204:207], v[32:35]
buffer_load_dwordx4 v238, s[60:63], s48 offen  lds
v_mfma_f32_16x16x32_bf16 v[32:35], a[136:139], v[208:211], v[32:35]
v_exp_f32 v54, v54
v_mfma_f32_16x16x32_bf16 v[32:35], a[140:143], v[212:215], v[32:35]
ds_read_b128 a[128:131], v216 offset:24576
ds_read_b128 a[132:135], v217 offset:24576
v_mfma_f32_16x16x32_bf16 a[12:15], a[172:175], v[72:75], a[12:15]
v_exp_f32 v55, v55
v_mfma_f32_16x16x32_bf16 a[44:47], a[172:175], v[76:79], a[44:47]
ds_read_b128 a[136:139], v218 offset:24576
ds_read_b128 a[140:143], v219 offset:24576
v_mfma_f32_16x16x32_bf16 a[76:79], a[172:175], v[80:83], a[76:79]
v_cvt_pk_bf16_f32 v94, v52, v53
v_cvt_pk_bf16_f32 v95, v54, v55
v_mfma_f32_16x16x32_bf16 a[108:111], a[172:175], v[84:87], a[108:111]
v_exp_f32 v56, v56
v_mfma_f32_16x16x32_bf16 v[108:111], a[196:199], a[228:231], 0
s_add_u32 s38, s38, 16384
ds_read_b64_tr_b16 a[172:173], v223 offset:40960
ds_read_b64_tr_b16 a[174:175], v223 offset:45056
v_mfma_f32_16x16x32_bf16 v[12:15], a[144:147], v[152:155], v[136:139]
s_add_u32 m0, s37, 81920
v_exp_f32 v57, v57
v_mfma_f32_16x16x32_bf16 v[12:15], a[148:151], v[156:159], v[12:15]
buffer_load_dwordx4 v232, s[12:15], s39 offen offset:0 lds
v_mfma_f32_16x16x32_bf16 v[12:15], a[152:155], v[160:163], v[12:15]
v_exp_f32 v58, v58
v_mfma_f32_16x16x32_bf16 v[12:15], a[156:159], v[164:167], v[12:15]
v_cvt_pk_bf16_f32 v96, v56, v57
v_mfma_f32_16x16x32_bf16 a[16:19], a[176:179], v[72:75], a[16:19]
v_exp_f32 v59, v59
v_mfma_f32_16x16x32_bf16 a[48:51], a[176:179], v[76:79], a[48:51]
v_cvt_pk_bf16_f32 v97, v58, v59
v_mfma_f32_16x16x32_bf16 a[80:83], a[176:179], v[80:83], a[80:83]
v_exp_f32 v60, v60
v_mfma_f32_16x16x32_bf16 a[112:115], a[176:179], v[84:87], a[112:115]
s_add_u32 m0, s49, 6144
ds_read_b64_tr_b16 a[176:177], v224 offset:40960
ds_read_b64_tr_b16 a[178:179], v224 offset:45056
v_mfma_f32_16x16x32_bf16 v[20:23], a[144:147], v[168:171], v[140:143]
s_add_u32 s48, s50, 294912
v_exp_f32 v61, v61
v_mfma_f32_16x16x32_bf16 v[20:23], a[148:151], v[172:175], v[20:23]
buffer_load_dwordx4 v238, s[60:63], s48 offen  lds
v_mfma_f32_16x16x32_bf16 v[20:23], a[152:155], v[176:179], v[20:23]
v_exp_f32 v62, v62
v_mfma_f32_16x16x32_bf16 v[20:23], a[156:159], v[180:183], v[20:23]
v_cvt_pk_bf16_f32 v98, v60, v61
v_mfma_f32_16x16x32_bf16 a[20:23], a[180:183], v[72:75], a[20:23]
v_exp_f32 v63, v63
v_mfma_f32_16x16x32_bf16 a[52:55], a[180:183], v[76:79], a[52:55]
v_cvt_pk_bf16_f32 v99, v62, v63
v_mfma_f32_16x16x32_bf16 a[84:87], a[180:183], v[80:83], a[84:87]
v_exp_f32 v64, v64
v_mfma_f32_16x16x32_bf16 a[116:119], a[180:183], v[84:87], a[116:119]
s_add_u32 m0, s37, 81920
ds_read_b64_tr_b16 a[180:181], v225 offset:40960
ds_read_b64_tr_b16 a[182:183], v225 offset:45056
v_smfmac_f32_16x16x64_bf16 a[252:255], a[208:211], v[80:87], v235
v_exp_f32 v65, v65
v_mfma_f32_16x16x32_bf16 v[112:115], a[200:203], a[228:231], 0
buffer_load_dwordx4 v233, s[12:15], s39 offen offset:1024 lds
v_mfma_f32_16x16x32_bf16 v[28:31], a[144:147], v[184:187], v[144:147]
v_exp_f32 v66, v66
v_mfma_f32_16x16x32_bf16 v[28:31], a[148:151], v[188:191], v[28:31]
v_cvt_pk_bf16_f32 v100, v64, v65
v_mfma_f32_16x16x32_bf16 v[28:31], a[152:155], v[192:195], v[28:31]
v_exp_f32 v67, v67
v_mfma_f32_16x16x32_bf16 v[28:31], a[156:159], v[196:199], v[28:31]
v_cvt_pk_bf16_f32 v101, v66, v67
v_mfma_f32_16x16x32_bf16 a[24:27], a[184:187], v[72:75], a[24:27]
v_exp_f32 v68, v68
v_mfma_f32_16x16x32_bf16 a[56:59], a[184:187], v[76:79], a[56:59]
buffer_load_dwordx4 v232, s[12:15], s39 offen offset:2048 lds
v_mfma_f32_16x16x32_bf16 a[88:91], a[184:187], v[80:83], a[88:91]
v_exp_f32 v69, v69
v_mfma_f32_16x16x32_bf16 a[120:123], a[184:187], v[84:87], a[120:123]
ds_read_b64_tr_b16 a[184:185], v226 offset:40960
ds_read_b64_tr_b16 a[186:187], v226 offset:45056
v_mfma_f32_16x16x32_bf16 v[36:39], a[144:147], v[200:203], v[148:151]
v_exp_f32 v70, v70
v_mfma_f32_16x16x32_bf16 v[36:39], a[148:151], v[204:207], v[36:39]
ds_read_b128 a[144:147], v216 offset:28672
ds_read_b128 a[148:151], v217 offset:28672
v_mfma_f32_16x16x32_bf16 v[36:39], a[152:155], v[208:211], v[36:39]
v_exp_f32 v71, v71
v_mfma_f32_16x16x32_bf16 v[36:39], a[156:159], v[212:215], v[36:39]
ds_read_b128 a[152:155], v218 offset:28672
ds_read_b128 a[156:159], v219 offset:28672
v_mfma_f32_16x16x32_bf16 a[28:31], a[188:191], v[72:75], a[28:31]
v_cvt_pk_bf16_f32 v102, v68, v69
v_cvt_pk_bf16_f32 v103, v70, v71
v_mfma_f32_16x16x32_bf16 a[60:63], a[188:191], v[76:79], a[60:63]
v_mfma_f32_16x16x32_bf16 a[92:95], a[188:191], v[80:83], a[92:95]
v_mfma_f32_16x16x32_bf16 a[124:127], a[188:191], v[84:87], a[124:127]
ds_read_b64_tr_b16 a[188:189], v227 offset:40960
ds_read_b64_tr_b16 a[190:191], v227 offset:45056
v_mfma_f32_16x16x32_bf16 v[116:119], a[204:207], a[228:231], 0
s_waitcnt lgkmcnt(8)
v_mfma_f32_16x16x32_bf16 v[40:43], a[128:131], v[152:155], v[136:139]
v_exp_f32 v8, v8
v_mfma_f32_16x16x32_bf16 v[40:43], a[132:135], v[156:159], v[40:43]
v_exp_f32 v9, v9
v_mfma_f32_16x16x32_bf16 v[40:43], a[136:139], v[160:163], v[40:43]
buffer_load_dwordx4 v233, s[12:15], s39 offen offset:3072 lds
v_mfma_f32_16x16x32_bf16 v[40:43], a[140:143], v[164:167], v[40:43]
v_exp_f32 v10, v10
v_mfma_f32_16x16x32_bf16 a[0:3], a[160:163], v[88:91], a[0:3]
v_cvt_pk_bf16_f32 v72, v8, v9
v_mfma_f32_16x16x32_bf16 a[32:35], a[160:163], v[92:95], a[32:35]
v_exp_f32 v11, v11
v_mfma_f32_16x16x32_bf16 a[64:67], a[160:163], v[96:99], a[64:67]
v_cvt_pk_bf16_f32 v73, v10, v11
v_mfma_f32_16x16x32_bf16 a[96:99], a[160:163], v[100:103], a[96:99]
v_exp_f32 v12, v12
v_mfma_f32_16x16x32_bf16 v[48:51], a[128:131], v[168:171], v[140:143]
s_add_u32 m0, s49, 7168
ds_read_b64_tr_b16 a[160:161], v220 offset:49152
ds_read_b64_tr_b16 a[162:163], v220 offset:53248
v_mfma_f32_16x16x32_bf16 v[48:51], a[132:135], v[172:175], v[48:51]
s_add_u32 s48, s50, 442368
v_exp_f32 v13, v13
v_mfma_f32_16x16x32_bf16 v[48:51], a[136:139], v[176:179], v[48:51]
buffer_load_dwordx4 v238, s[60:63], s48 offen  lds
v_mfma_f32_16x16x32_bf16 v[48:51], a[140:143], v[180:183], v[48:51]
v_exp_f32 v14, v14
v_mfma_f32_16x16x32_bf16 a[4:7], a[164:167], v[88:91], a[4:7]
v_cvt_pk_bf16_f32 v74, v12, v13
v_mfma_f32_16x16x32_bf16 a[36:39], a[164:167], v[92:95], a[36:39]
v_exp_f32 v15, v15
v_mfma_f32_16x16x32_bf16 a[68:71], a[164:167], v[96:99], a[68:71]
v_cvt_pk_bf16_f32 v75, v14, v15
v_mfma_f32_16x16x32_bf16 a[100:103], a[164:167], v[100:103], a[100:103]
v_exp_f32 v16, v16
v_smfmac_f32_16x16x64_bf16 a[248:251], a[208:211], v[88:95], v235
s_add_u32 s39, s39, 16384
ds_read_b64_tr_b16 a[164:165], v221 offset:49152
ds_read_b64_tr_b16 a[166:167], v221 offset:53248
v_mfma_f32_16x16x32_bf16 v[56:59], a[128:131], v[184:187], v[144:147]
s_add_u32 m0, s37, 32768
v_exp_f32 v17, v17
v_mfma_f32_16x16x32_bf16 v[56:59], a[132:135], v[188:191], v[56:59]
buffer_load_dwordx4 v228, s[8:11], s38 offen offset:0 lds
v_mfma_f32_16x16x32_bf16 v[56:59], a[136:139], v[192:195], v[56:59]
v_exp_f32 v18, v18
v_mfma_f32_16x16x32_bf16 v[56:59], a[140:143], v[196:199], v[56:59]
v_cvt_pk_bf16_f32 v76, v16, v17
v_mfma_f32_16x16x32_bf16 a[8:11], a[168:171], v[88:91], a[8:11]
v_exp_f32 v19, v19
v_mfma_f32_16x16x32_bf16 a[40:43], a[168:171], v[92:95], a[40:43]
v_cvt_pk_bf16_f32 v77, v18, v19
v_mfma_f32_16x16x32_bf16 a[72:75], a[168:171], v[96:99], a[72:75]
v_exp_f32 v20, v20
v_mfma_f32_16x16x32_bf16 a[104:107], a[168:171], v[100:103], a[104:107]
s_add_u32 m0, s49, 0
ds_read_b64_tr_b16 a[168:169], v222 offset:49152
ds_read_b64_tr_b16 a[170:171], v222 offset:53248
v_mfma_f32_16x16x32_bf16 v[64:67], a[128:131], v[200:203], v[148:151]
s_add_u32 s48, s50, 0
v_exp_f32 v21, v21
v_mfma_f32_16x16x32_bf16 v[64:67], a[132:135], v[204:207], v[64:67]
buffer_load_dwordx4 v238, s[56:59], s48 offen  lds
v_mfma_f32_16x16x32_bf16 v[64:67], a[136:139], v[208:211], v[64:67]
v_exp_f32 v22, v22
v_mfma_f32_16x16x32_bf16 v[64:67], a[140:143], v[212:215], v[64:67]
ds_read_b128 a[128:131], v216 offset:0
ds_read_b128 a[132:135], v217 offset:0
v_mfma_f32_16x16x32_bf16 a[12:15], a[172:175], v[88:91], a[12:15]
v_exp_f32 v23, v23
v_mfma_f32_16x16x32_bf16 a[44:47], a[172:175], v[92:95], a[44:47]
ds_read_b128 a[136:139], v218 offset:0
ds_read_b128 a[140:143], v219 offset:0
v_mfma_f32_16x16x32_bf16 a[76:79], a[172:175], v[96:99], a[76:79]
s_waitcnt lgkmcnt(6)
v_exp_f32 v24, v24
v_mfma_f32_16x16x32_bf16 a[108:111], a[172:175], v[100:103], a[108:111]
s_add_u32 m0, s37, 32768
v_exp_f32 v25, v25
v_mfma_f32_16x16x32_bf16 v[44:47], a[144:147], v[152:155], v[136:139]
buffer_load_dwordx4 v229, s[8:11], s38 offen offset:1024 lds
v_mfma_f32_16x16x32_bf16 v[44:47], a[148:151], v[156:159], v[44:47]
v_exp_f32 v26, v26
v_mfma_f32_16x16x32_bf16 v[44:47], a[152:155], v[160:163], v[44:47]
ds_read_b64_tr_b16 a[172:173], v223 offset:49152
ds_read_b64_tr_b16 a[174:175], v223 offset:53248
v_mfma_f32_16x16x32_bf16 v[44:47], a[156:159], v[164:167], v[44:47]
v_exp_f32 v27, v27
v_mfma_f32_16x16x32_bf16 a[16:19], a[176:179], v[88:91], a[16:19]
v_cvt_pk_bf16_f32 v78, v20, v21
v_cvt_pk_bf16_f32 v79, v22, v23
v_mfma_f32_16x16x32_bf16 a[48:51], a[176:179], v[92:95], a[48:51]
v_exp_f32 v28, v28
v_mfma_f32_16x16x32_bf16 a[80:83], a[176:179], v[96:99], a[80:83]
s_add_u32 m0, s49, 1024
v_cvt_pk_bf16_f32 v80, v24, v25
v_cvt_pk_bf16_f32 v81, v26, v27
v_mfma_f32_16x16x32_bf16 a[112:115], a[176:179], v[100:103], a[112:115]
s_add_u32 s48, s50, 147456
v_exp_f32 v29, v29
v_mfma_f32_16x16x32_bf16 v[52:55], a[144:147], v[168:171], v[140:143]
buffer_load_dwordx4 v238, s[56:59], s48 offen  lds
v_mfma_f32_16x16x32_bf16 v[52:55], a[148:151], v[172:175], v[52:55]
v_exp_f32 v30, v30
v_mfma_f32_16x16x32_bf16 v[52:55], a[152:155], v[176:179], v[52:55]
ds_read_b64_tr_b16 a[176:177], v224 offset:49152
ds_read_b64_tr_b16 a[178:179], v224 offset:53248
v_mfma_f32_16x16x32_bf16 v[52:55], a[156:159], v[180:183], v[52:55]
v_exp_f32 v31, v31
v_mfma_f32_16x16x32_bf16 a[20:23], a[180:183], v[88:91], a[20:23]
v_cvt_pk_bf16_f32 v82, v28, v29
v_cvt_pk_bf16_f32 v83, v30, v31
v_mfma_f32_16x16x32_bf16 a[52:55], a[180:183], v[92:95], a[52:55]
v_exp_f32 v32, v32
v_mfma_f32_16x16x32_bf16 a[84:87], a[180:183], v[96:99], a[84:87]
s_add_u32 m0, s37, 32768
v_mfma_f32_16x16x32_bf16 a[116:119], a[180:183], v[100:103], a[116:119]
v_exp_f32 v33, v33
v_smfmac_f32_16x16x64_bf16 a[252:255], a[208:211], v[96:103], v235
buffer_load_dwordx4 v230, s[8:11], s38 offen offset:2048 lds
v_mfma_f32_16x16x32_bf16 v[60:63], a[144:147], v[184:187], v[144:147]
v_exp_f32 v34, v34
v_mfma_f32_16x16x32_bf16 v[60:63], a[148:151], v[188:191], v[60:63]
ds_read_b64_tr_b16 a[180:181], v225 offset:49152
ds_read_b64_tr_b16 a[182:183], v225 offset:53248
v_mfma_f32_16x16x32_bf16 v[60:63], a[152:155], v[192:195], v[60:63]
v_exp_f32 v35, v35
v_mfma_f32_16x16x32_bf16 v[60:63], a[156:159], v[196:199], v[60:63]
v_cvt_pk_bf16_f32 v84, v32, v33
v_cvt_pk_bf16_f32 v85, v34, v35
v_mfma_f32_16x16x32_bf16 a[24:27], a[184:187], v[88:91], a[24:27]
v_exp_f32 v36, v36
v_mfma_f32_16x16x32_bf16 a[56:59], a[184:187], v[92:95], a[56:59]
buffer_load_dwordx4 v231, s[8:11], s38 offen offset:3072 lds
v_mfma_f32_16x16x32_bf16 a[88:91], a[184:187], v[96:99], a[88:91]
v_exp_f32 v37, v37
v_mfma_f32_16x16x32_bf16 a[120:123], a[184:187], v[100:103], a[120:123]
ds_read_b64_tr_b16 a[184:185], v226 offset:49152
ds_read_b64_tr_b16 a[186:187], v226 offset:53248
v_mfma_f32_16x16x32_bf16 v[68:71], a[144:147], v[200:203], v[148:151]
v_exp_f32 v38, v38
v_mfma_f32_16x16x32_bf16 v[68:71], a[148:151], v[204:207], v[68:71]
ds_read_b128 a[144:147], v216 offset:4096
ds_read_b128 a[148:151], v217 offset:4096
v_mfma_f32_16x16x32_bf16 v[68:71], a[152:155], v[208:211], v[68:71]
v_exp_f32 v39, v39
v_mfma_f32_16x16x32_bf16 v[68:71], a[156:159], v[212:215], v[68:71]
ds_read_b128 a[152:155], v218 offset:4096
ds_read_b128 a[156:159], v219 offset:4096
v_mfma_f32_16x16x32_bf16 a[28:31], a[188:191], v[88:91], a[28:31]
v_cvt_pk_bf16_f32 v86, v36, v37
v_cvt_pk_bf16_f32 v87, v38, v39
v_mfma_f32_16x16x32_bf16 a[60:63], a[188:191], v[92:95], a[60:63]
s_add_u32 s38, s38, 16384
v_mfma_f32_16x16x32_bf16 a[92:95], a[188:191], v[96:99], a[92:95]
v_mfma_f32_16x16x32_bf16 a[124:127], a[188:191], v[100:103], a[124:127]
s_waitcnt lgkmcnt(6)
ds_read_b64_tr_b16 a[188:189], v227 offset:49152
ds_read_b64_tr_b16 a[190:191], v227 offset:53248
v_mfma_f32_16x16x32_bf16 v[8:11], a[128:131], v[152:155], v[136:139]
v_exp_f32 v40, v40
v_mfma_f32_16x16x32_bf16 v[8:11], a[132:135], v[156:159], v[8:11]
s_add_u32 m0, s49, 2048
v_exp_f32 v41, v41
v_mfma_f32_16x16x32_bf16 v[8:11], a[136:139], v[160:163], v[8:11]
s_add_u32 s48, s50, 294912
buffer_load_dwordx4 v238, s[56:59], s48 offen  lds
v_mfma_f32_16x16x32_bf16 v[8:11], a[140:143], v[164:167], v[8:11]
v_exp_f32 v42, v42
v_mfma_f32_16x16x32_bf16 a[0:3], a[160:163], v[72:75], a[0:3]
v_cvt_pk_bf16_f32 v88, v40, v41
v_mfma_f32_16x16x32_bf16 a[32:35], a[160:163], v[76:79], a[32:35]
v_exp_f32 v43, v43
v_mfma_f32_16x16x32_bf16 a[64:67], a[160:163], v[80:83], a[64:67]
v_cvt_pk_bf16_f32 v89, v42, v43
v_mfma_f32_16x16x32_bf16 a[96:99], a[160:163], v[84:87], a[96:99]
v_exp_f32 v44, v44
v_mfma_f32_16x16x32_bf16 v[16:19], a[128:131], v[168:171], v[140:143]
ds_read_b64_tr_b16 a[160:161], v220 offset:57344
ds_read_b64_tr_b16 a[162:163], v220 offset:61440
v_mfma_f32_16x16x32_bf16 v[16:19], a[132:135], v[172:175], v[16:19]
v_exp_f32 v45, v45
v_mfma_f32_16x16x32_bf16 v[16:19], a[136:139], v[176:179], v[16:19]
v_cvt_pk_bf16_f32 v90, v44, v45
v_mfma_f32_16x16x32_bf16 v[16:19], a[140:143], v[180:183], v[16:19]
s_add_u32 m0, s49, 3072
v_exp_f32 v46, v46
v_mfma_f32_16x16x32_bf16 a[4:7], a[164:167], v[72:75], a[4:7]
s_add_u32 s48, s50, 442368
buffer_load_dwordx4 v238, s[56:59], s48 offen  lds
v_mfma_f32_16x16x32_bf16 a[36:39], a[164:167], v[76:79], a[36:39]
v_exp_f32 v47, v47
v_mfma_f32_16x16x32_bf16 a[68:71], a[164:167], v[80:83], a[68:71]
v_cvt_pk_bf16_f32 v91, v46, v47
v_mfma_f32_16x16x32_bf16 a[100:103], a[164:167], v[84:87], a[100:103]
v_exp_f32 v48, v48
v_smfmac_f32_16x16x64_bf16 a[248:251], a[208:211], v[72:79], v235
ds_read_b64_tr_b16 a[164:165], v221 offset:57344
ds_read_b64_tr_b16 a[166:167], v221 offset:61440
v_mfma_f32_16x16x32_bf16 v[24:27], a[128:131], v[184:187], v[144:147]
v_exp_f32 v49, v49
v_mfma_f32_16x16x32_bf16 v[24:27], a[132:135], v[188:191], v[24:27]
v_cvt_pk_bf16_f32 v92, v48, v49
v_mfma_f32_16x16x32_bf16 v[24:27], a[136:139], v[192:195], v[24:27]
v_exp_f32 v50, v50
v_mfma_f32_16x16x32_bf16 v[24:27], a[140:143], v[196:199], v[24:27]
v_mfma_f32_16x16x32_bf16 a[8:11], a[168:171], v[72:75], a[8:11]
v_exp_f32 v51, v51
v_mfma_f32_16x16x32_bf16 a[40:43], a[168:171], v[76:79], a[40:43]
buffer_load_dwordx2 v[252:253], v251, s[76:79], s42 offen sc1
v_mfma_f32_16x16x32_bf16 a[72:75], a[168:171], v[80:83], a[72:75]
v_exp_f32 v52, v52
v_mfma_f32_16x16x32_bf16 a[104:107], a[168:171], v[84:87], a[104:107]
ds_read_b64_tr_b16 a[168:169], v222 offset:57344
ds_read_b64_tr_b16 a[170:171], v222 offset:61440
v_mfma_f32_16x16x32_bf16 v[32:35], a[128:131], v[200:203], v[148:151]
v_exp_f32 v53, v53
v_mfma_f32_16x16x32_bf16 v[32:35], a[132:135], v[204:207], v[32:35]
ds_read_b128 a[128:131], v216 offset:8192
ds_read_b128 a[132:135], v217 offset:8192
v_mfma_f32_16x16x32_bf16 v[32:35], a[136:139], v[208:211], v[32:35]
v_exp_f32 v54, v54
v_mfma_f32_16x16x32_bf16 v[32:35], a[140:143], v[212:215], v[32:35]
ds_read_b128 a[136:139], v218 offset:8192
ds_read_b128 a[140:143], v219 offset:8192
v_mfma_f32_16x16x32_bf16 a[12:15], a[172:175], v[72:75], a[12:15]
v_exp_f32 v55, v55
v_mfma_f32_16x16x32_bf16 a[44:47], a[172:175], v[76:79], a[44:47]
v_cvt_pk_bf16_f32 v93, v50, v51
v_cvt_pk_bf16_f32 v94, v52, v53
v_mfma_f32_16x16x32_bf16 a[76:79], a[172:175], v[80:83], a[76:79]
s_waitcnt lgkmcnt(6)
v_exp_f32 v56, v56
v_mfma_f32_16x16x32_bf16 a[108:111], a[172:175], v[84:87], a[108:111]
s_add_u32 s42, s42, s43
v_exp_f32 v57, v57
v_mfma_f32_16x16x32_bf16 v[12:15], a[144:147], v[152:155], v[136:139]
buffer_load_dword v255, v243, s[28:31], s45 offen
v_mfma_f32_16x16x32_bf16 v[12:15], a[148:151], v[156:159], v[12:15]
v_exp_f32 v58, v58
v_mfma_f32_16x16x32_bf16 v[12:15], a[152:155], v[160:163], v[12:15]
ds_read_b64_tr_b16 a[172:173], v223 offset:57344
ds_read_b64_tr_b16 a[174:175], v223 offset:61440
v_mfma_f32_16x16x32_bf16 v[12:15], a[156:159], v[164:167], v[12:15]
v_exp_f32 v59, v59
v_mfma_f32_16x16x32_bf16 a[16:19], a[176:179], v[72:75], a[16:19]
v_cvt_pk_bf16_f32 v95, v54, v55
v_cvt_pk_bf16_f32 v96, v56, v57
v_mfma_f32_16x16x32_bf16 a[48:51], a[176:179], v[76:79], a[48:51]
v_exp_f32 v60, v60
v_mfma_f32_16x16x32_bf16 a[80:83], a[176:179], v[80:83], a[80:83]
v_cvt_pk_bf16_f32 v97, v58, v59
v_mfma_f32_16x16x32_bf16 a[112:115], a[176:179], v[84:87], a[112:115]
v_exp_f32 v61, v61
v_mfma_f32_16x16x32_bf16 v[20:23], a[144:147], v[168:171], v[140:143]
ds_read_b64_tr_b16 a[176:177], v224 offset:57344
ds_read_b64_tr_b16 a[178:179], v224 offset:61440
v_mfma_f32_16x16x32_bf16 v[20:23], a[148:151], v[172:175], v[20:23]
s_add_u32 s45, s45, 589824
v_exp_f32 v62, v62
v_mfma_f32_16x16x32_bf16 v[20:23], a[152:155], v[176:179], v[20:23]
global_load_dword v255, v242, s[72:73]
v_mfma_f32_16x16x32_bf16 v[20:23], a[156:159], v[180:183], v[20:23]
v_exp_f32 v63, v63
v_mfma_f32_16x16x32_bf16 a[20:23], a[180:183], v[72:75], a[20:23]
v_cvt_pk_bf16_f32 v98, v60, v61
v_cvt_pk_bf16_f32 v99, v62, v63
v_mfma_f32_16x16x32_bf16 a[52:55], a[180:183], v[76:79], a[52:55]
v_exp_f32 v64, v64
v_mfma_f32_16x16x32_bf16 a[84:87], a[180:183], v[80:83], a[84:87]
v_mfma_f32_16x16x32_bf16 a[116:119], a[180:183], v[84:87], a[116:119]
v_exp_f32 v65, v65
v_smfmac_f32_16x16x64_bf16 a[252:255], a[208:211], v[80:87], v235
ds_read_b64_tr_b16 a[180:181], v225 offset:57344
ds_read_b64_tr_b16 a[182:183], v225 offset:61440
v_mfma_f32_16x16x32_bf16 v[28:31], a[144:147], v[184:187], v[144:147]
v_exp_f32 v66, v66
v_mfma_f32_16x16x32_bf16 v[28:31], a[148:151], v[188:191], v[28:31]
v_cvt_pk_bf16_f32 v100, v64, v65
v_mfma_f32_16x16x32_bf16 v[28:31], a[152:155], v[192:195], v[28:31]
v_exp_f32 v67, v67
v_mfma_f32_16x16x32_bf16 v[28:31], a[156:159], v[196:199], v[28:31]
buffer_load_dword v255, v0, s[24:27], s44 offen
v_mfma_f32_16x16x32_bf16 a[24:27], a[184:187], v[72:75], a[24:27]
v_exp_f32 v68, v68
v_mfma_f32_16x16x32_bf16 a[56:59], a[184:187], v[76:79], a[56:59]
v_cvt_pk_bf16_f32 v101, v66, v67
v_mfma_f32_16x16x32_bf16 a[88:91], a[184:187], v[80:83], a[88:91]
v_exp_f32 v69, v69
v_mfma_f32_16x16x32_bf16 a[120:123], a[184:187], v[84:87], a[120:123]
ds_read_b64_tr_b16 a[184:185], v226 offset:57344
ds_read_b64_tr_b16 a[186:187], v226 offset:61440
v_mfma_f32_16x16x32_bf16 v[36:39], a[144:147], v[200:203], v[148:151]
v_exp_f32 v70, v70
v_mfma_f32_16x16x32_bf16 v[36:39], a[148:151], v[204:207], v[36:39]
ds_read_b128 a[144:147], v216 offset:12288
ds_read_b128 a[148:151], v217 offset:12288
v_mfma_f32_16x16x32_bf16 v[36:39], a[152:155], v[208:211], v[36:39]
v_exp_f32 v71, v71
v_mfma_f32_16x16x32_bf16 v[36:39], a[156:159], v[212:215], v[36:39]
ds_read_b128 a[152:155], v218 offset:12288
ds_read_b128 a[156:159], v219 offset:12288
v_mfma_f32_16x16x32_bf16 a[28:31], a[188:191], v[72:75], a[28:31]
v_cvt_pk_bf16_f32 v102, v68, v69
v_cvt_pk_bf16_f32 v103, v70, v71
v_mfma_f32_16x16x32_bf16 a[60:63], a[188:191], v[76:79], a[60:63]
s_add_u32 s44, s44, 4096
v_mfma_f32_16x16x32_bf16 a[92:95], a[188:191], v[80:83], a[92:95]
v_mfma_f32_16x16x32_bf16 a[124:127], a[188:191], v[84:87], a[124:127]
s_waitcnt lgkmcnt(6)
ds_read_b64_tr_b16 a[188:189], v227 offset:57344
ds_read_b64_tr_b16 a[190:191], v227 offset:61440
v_mfma_f32_16x16x32_bf16 v[40:43], a[128:131], v[152:155], v[136:139]
v_exp_f32 v8, v8
v_mfma_f32_16x16x32_bf16 v[40:43], a[132:135], v[156:159], v[40:43]
v_exp_f32 v9, v9
v_mfma_f32_16x16x32_bf16 v[40:43], a[136:139], v[160:163], v[40:43]
v_cvt_pk_bf16_f32 v72, v8, v9
v_add_u32 v5, s49, v234
v_mfma_f32_16x16x32_bf16 v[40:43], a[140:143], v[164:167], v[40:43]
s_add_u32 s46, s3, 131072
v_exp_f32 v10, v10
v_mfma_f32_16x16x32_bf16 a[0:3], a[160:163], v[88:91], a[0:3]
v_add_u32 v6, s46, v234
v_lshlrev_b32 v7, 1, v4
v_mfma_f32_16x16x32_bf16 a[32:35], a[160:163], v[92:95], a[32:35]
v_exp_f32 v11, v11
s_waitcnt vmcnt(6) lgkmcnt(0)
s_barrier
v_mfma_f32_16x16x32_bf16 a[64:67], a[160:163], v[96:99], a[64:67]
v_cvt_pk_bf16_f32 v73, v10, v11
v_xor_b32 v7, v7, v3
v_mfma_f32_16x16x32_bf16 a[96:99], a[160:163], v[100:103], a[96:99]
s_add_u32 m0, s37, 98304
v_exp_f32 v12, v12
v_mfma_f32_16x16x32_bf16 v[48:51], a[128:131], v[168:171], v[140:143]
buffer_load_dwordx4 v232, s[12:15], s39 offen offset:0 lds
v_mfma_f32_16x16x32_bf16 v[48:51], a[132:135], v[172:175], v[48:51]
v_exp_f32 v13, v13
v_mfma_f32_16x16x32_bf16 v[48:51], a[136:139], v[176:179], v[48:51]
ds_read_b64_tr_b16 a[160:161], v220 offset:0
ds_read_b64_tr_b16 a[162:163], v220 offset:4096
v_mfma_f32_16x16x32_bf16 v[48:51], a[140:143], v[180:183], v[48:51]
v_exp_f32 v14, v14
v_mfma_f32_16x16x32_bf16 a[4:7], a[164:167], v[88:91], a[4:7]
v_cvt_pk_bf16_f32 v74, v12, v13
v_mul_u32_u24 v249, 0x480, v4
v_mfma_f32_16x16x32_bf16 a[36:39], a[164:167], v[92:95], a[36:39]
v_exp_f32 v15, v15
v_mfma_f32_16x16x32_bf16 a[68:71], a[164:167], v[96:99], a[68:71]
v_cvt_pk_bf16_f32 v75, v14, v15
v_lshl_add_u32 v249, v7, 4, v249
v_mfma_f32_16x16x32_bf16 a[100:103], a[164:167], v[100:103], a[100:103]
v_exp_f32 v16, v16
v_smfmac_f32_16x16x64_bf16 a[248:251], a[208:211], v[88:95], v235
buffer_load_dwordx4 v233, s[12:15], s39 offen offset:1024 lds
v_mfma_f32_16x16x32_bf16 v[56:59], a[128:131], v[184:187], v[144:147]
v_exp_f32 v17, v17
v_mfma_f32_16x16x32_bf16 v[56:59], a[132:135], v[188:191], v[56:59]
ds_read_b64_tr_b16 a[164:165], v221 offset:0
ds_read_b64_tr_b16 a[166:167], v221 offset:4096
v_mfma_f32_16x16x32_bf16 v[56:59], a[136:139], v[192:195], v[56:59]
v_exp_f32 v18, v18
v_mfma_f32_16x16x32_bf16 v[56:59], a[140:143], v[196:199], v[56:59]
v_cvt_pk_bf16_f32 v76, v16, v17
v_and_b32 v7, 8, v7
v_mfma_f32_16x16x32_bf16 a[8:11], a[168:171], v[88:91], a[8:11]
v_exp_f32 v19, v19
v_mfma_f32_16x16x32_bf16 a[40:43], a[168:171], v[92:95], a[40:43]
v_cvt_pk_bf16_f32 v77, v18, v19
v_lshlrev_b32 v7, 5, v7
v_mfma_f32_16x16x32_bf16 a[72:75], a[168:171], v[96:99], a[72:75]
v_exp_f32 v20, v20
v_mfma_f32_16x16x32_bf16 a[104:107], a[168:171], v[100:103], a[104:107]
ds_read_b64_tr_b16 a[168:169], v222 offset:0
ds_read_b64_tr_b16 a[170:171], v222 offset:4096
v_mfma_f32_16x16x32_bf16 v[64:67], a[128:131], v[200:203], v[148:151]
v_exp_f32 v21, v21
v_mfma_f32_16x16x32_bf16 v[64:67], a[132:135], v[204:207], v[64:67]
buffer_load_dwordx4 v232, s[12:15], s39 offen offset:2048 lds
v_mfma_f32_16x16x32_bf16 v[64:67], a[136:139], v[208:211], v[64:67]
v_exp_f32 v22, v22
v_mfma_f32_16x16x32_bf16 v[64:67], a[140:143], v[212:215], v[64:67]
ds_read_b128 a[128:131], v216 offset:49152
ds_read_b128 a[132:135], v217 offset:49152
v_mfma_f32_16x16x32_bf16 a[12:15], a[172:175], v[88:91], a[12:15]
v_exp_f32 v23, v23
v_mfma_f32_16x16x32_bf16 a[44:47], a[172:175], v[92:95], a[44:47]
ds_read_b128 a[136:139], v218 offset:49152
ds_read_b128 a[140:143], v219 offset:49152
v_mfma_f32_16x16x32_bf16 a[76:79], a[172:175], v[96:99], a[76:79]
v_exp_f32 v24, v24
v_mfma_f32_16x16x32_bf16 a[108:111], a[172:175], v[100:103], a[108:111]
v_exp_f32 v25, v25
v_mfma_f32_16x16x32_bf16 v[44:47], a[144:147], v[152:155], v[136:139]
ds_read_b64_tr_b16 a[172:173], v223 offset:0
ds_read_b64_tr_b16 a[174:175], v223 offset:4096
v_mfma_f32_16x16x32_bf16 v[44:47], a[148:151], v[156:159], v[44:47]
v_exp_f32 v26, v26
v_mfma_f32_16x16x32_bf16 v[44:47], a[152:155], v[160:163], v[44:47]
buffer_load_dwordx4 v233, s[12:15], s39 offen offset:3072 lds
v_mfma_f32_16x16x32_bf16 v[44:47], a[156:159], v[164:167], v[44:47]
v_exp_f32 v27, v27
v_mfma_f32_16x16x32_bf16 a[16:19], a[176:179], v[88:91], a[16:19]
v_cvt_pk_bf16_f32 v78, v20, v21
v_cvt_pk_bf16_f32 v79, v22, v23
v_mfma_f32_16x16x32_bf16 a[48:51], a[176:179], v[92:95], a[48:51]
v_exp_f32 v28, v28
v_mfma_f32_16x16x32_bf16 a[80:83], a[176:179], v[96:99], a[80:83]
v_cvt_pk_bf16_f32 v80, v24, v25
v_cvt_pk_bf16_f32 v81, v26, v27
v_mfma_f32_16x16x32_bf16 a[112:115], a[176:179], v[100:103], a[112:115]
v_exp_f32 v29, v29
v_mfma_f32_16x16x32_bf16 v[52:55], a[144:147], v[168:171], v[140:143]
ds_read_b64_tr_b16 a[176:177], v224 offset:0
ds_read_b64_tr_b16 a[178:179], v224 offset:4096
v_mfma_f32_16x16x32_bf16 v[52:55], a[148:151], v[172:175], v[52:55]
v_exp_f32 v30, v30
v_mfma_f32_16x16x32_bf16 v[52:55], a[152:155], v[176:179], v[52:55]
v_cvt_pk_bf16_f32 v82, v28, v29
v_sub_u32 v250, v249, v7
v_mfma_f32_16x16x32_bf16 v[52:55], a[156:159], v[180:183], v[52:55]
s_add_u32 s39, s39, 16384
v_exp_f32 v31, v31
v_mfma_f32_16x16x32_bf16 a[20:23], a[180:183], v[88:91], a[20:23]
s_add_u32 m0, s37, 16384
v_cvt_pk_bf16_f32 v83, v30, v31
v_add_u32 v250, 128, v250
v_mfma_f32_16x16x32_bf16 a[52:55], a[180:183], v[92:95], a[52:55]
v_exp_f32 v32, v32
v_mfma_f32_16x16x32_bf16 a[84:87], a[180:183], v[96:99], a[84:87]
buffer_load_dwordx4 v228, s[8:11], s38 offen offset:0 lds
v_mfma_f32_16x16x32_bf16 a[116:119], a[180:183], v[100:103], a[116:119]
v_exp_f32 v33, v33
v_smfmac_f32_16x16x64_bf16 a[252:255], a[208:211], v[96:103], v235
ds_read_b64_tr_b16 a[180:181], v225 offset:0
ds_read_b64_tr_b16 a[182:183], v225 offset:4096
v_mfma_f32_16x16x32_bf16 v[60:63], a[144:147], v[184:187], v[144:147]
v_exp_f32 v34, v34
v_mfma_f32_16x16x32_bf16 v[60:63], a[148:151], v[188:191], v[60:63]
v_cvt_pk_bf16_f32 v84, v32, v33
v_mfma_f32_16x16x32_bf16 v[60:63], a[152:155], v[192:195], v[60:63]
v_exp_f32 v35, v35
v_mfma_f32_16x16x32_bf16 v[60:63], a[156:159], v[196:199], v[60:63]
buffer_load_dwordx4 v229, s[8:11], s38 offen offset:1024 lds
v_mfma_f32_16x16x32_bf16 a[24:27], a[184:187], v[88:91], a[24:27]
v_exp_f32 v36, v36
v_mfma_f32_16x16x32_bf16 a[56:59], a[184:187], v[92:95], a[56:59]
v_cvt_pk_bf16_f32 v85, v34, v35
v_mfma_f32_16x16x32_bf16 a[88:91], a[184:187], v[96:99], a[88:91]
v_exp_f32 v37, v37
v_mfma_f32_16x16x32_bf16 a[120:123], a[184:187], v[100:103], a[120:123]
ds_read_b64_tr_b16 a[184:185], v226 offset:0
ds_read_b64_tr_b16 a[186:187], v226 offset:4096
v_mfma_f32_16x16x32_bf16 v[68:71], a[144:147], v[200:203], v[148:151]
v_exp_f32 v38, v38
v_mfma_f32_16x16x32_bf16 v[68:71], a[148:151], v[204:207], v[68:71]
ds_read_b128 a[144:147], v216 offset:53248
ds_read_b128 a[148:151], v217 offset:53248
v_mfma_f32_16x16x32_bf16 v[68:71], a[152:155], v[208:211], v[68:71]
v_exp_f32 v39, v39
v_mfma_f32_16x16x32_bf16 v[68:71], a[156:159], v[212:215], v[68:71]
ds_read_b128 a[152:155], v218 offset:53248
ds_read_b128 a[156:159], v219 offset:53248
v_mfma_f32_16x16x32_bf16 a[28:31], a[188:191], v[88:91], a[28:31]
v_cvt_pk_bf16_f32 v86, v36, v37
v_cvt_pk_bf16_f32 v87, v38, v39
v_mfma_f32_16x16x32_bf16 a[60:63], a[188:191], v[92:95], a[60:63]
v_mfma_f32_16x16x32_bf16 a[92:95], a[188:191], v[96:99], a[92:95]
v_mfma_f32_16x16x32_bf16 a[124:127], a[188:191], v[100:103], a[124:127]
s_waitcnt lgkmcnt(6)
ds_read_b64_tr_b16 a[188:189], v227 offset:0
ds_read_b64_tr_b16 a[190:191], v227 offset:4096
v_mfma_f32_16x16x32_bf16 v[8:11], a[128:131], v[152:155], v[136:139]
s_waitcnt vmcnt(10)
s_nop 0
v_exp_f32 v40, v40
v_mfma_f32_16x16x32_bf16 v[8:11], a[132:135], v[156:159], v[8:11]
v_exp_f32 v41, v41
v_mfma_f32_16x16x32_bf16 v[8:11], a[136:139], v[160:163], v[8:11]
buffer_load_dwordx4 v230, s[8:11], s38 offen offset:2048 lds
v_mfma_f32_16x16x32_bf16 v[8:11], a[140:143], v[164:167], v[8:11]
v_exp_f32 v42, v42
v_mfma_f32_16x16x32_bf16 a[0:3], a[160:163], v[72:75], a[0:3]
ds_read_b64_tr_b16 a[192:193], v248 offset:0
v_cvt_pk_bf16_f32 v88, v40, v41
v_mfma_f32_16x16x32_bf16 a[32:35], a[160:163], v[76:79], a[32:35]
v_exp_f32 v43, v43
v_mfma_f32_16x16x32_bf16 a[64:67], a[160:163], v[80:83], a[64:67]
ds_read_b64_tr_b16 a[194:195], v248 offset:256
v_cvt_pk_bf16_f32 v89, v42, v43
v_mfma_f32_16x16x32_bf16 a[96:99], a[160:163], v[84:87], a[96:99]
v_exp_f32 v44, v44
v_mfma_f32_16x16x32_bf16 v[16:19], a[128:131], v[168:171], v[140:143]
ds_read_b64_tr_b16 a[160:161], v220 offset:8192
ds_read_b64_tr_b16 a[162:163], v220 offset:12288
v_mfma_f32_16x16x32_bf16 v[16:19], a[132:135], v[172:175], v[16:19]
v_exp_f32 v45, v45
v_mfma_f32_16x16x32_bf16 v[16:19], a[136:139], v[176:179], v[16:19]
ds_read_b64_tr_b16 a[196:197], v248 offset:32
v_cvt_pk_bf16_f32 v90, v44, v45
v_mfma_f32_16x16x32_bf16 v[16:19], a[140:143], v[180:183], v[16:19]
v_exp_f32 v46, v46
v_mfma_f32_16x16x32_bf16 a[4:7], a[164:167], v[72:75], a[4:7]
ds_read_b64_tr_b16 a[198:199], v248 offset:288
ds_read_b64_tr_b16 a[200:201], v248 offset:4096
v_mfma_f32_16x16x32_bf16 a[36:39], a[164:167], v[76:79], a[36:39]
v_exp_f32 v47, v47
v_mfma_f32_16x16x32_bf16 a[68:71], a[164:167], v[80:83], a[68:71]
buffer_load_dwordx4 v231, s[8:11], s38 offen offset:3072 lds
v_mfma_f32_16x16x32_bf16 a[100:103], a[164:167], v[84:87], a[100:103]
v_exp_f32 v48, v48
v_smfmac_f32_16x16x64_bf16 a[248:251], a[208:211], v[72:79], v235
ds_read_b64_tr_b16 a[164:165], v221 offset:8192
ds_read_b64_tr_b16 a[166:167], v221 offset:12288
v_mfma_f32_16x16x32_bf16 v[24:27], a[128:131], v[184:187], v[144:147]
v_exp_f32 v49, v49
v_mfma_f32_16x16x32_bf16 v[24:27], a[132:135], v[188:191], v[24:27]
v_cvt_pk_bf16_f32 v91, v46, v47
v_cvt_pk_bf16_f32 v92, v48, v49
v_mfma_f32_16x16x32_bf16 v[24:27], a[136:139], v[192:195], v[24:27]
v_exp_f32 v50, v50
v_mfma_f32_16x16x32_bf16 v[24:27], a[140:143], v[196:199], v[24:27]
ds_read_b64_tr_b16 a[202:203], v248 offset:4352
ds_read_b64_tr_b16 a[204:205], v248 offset:4128
v_mfma_f32_16x16x32_bf16 a[8:11], a[168:171], v[72:75], a[8:11]
v_exp_f32 v51, v51
v_mfma_f32_16x16x32_bf16 a[40:43], a[168:171], v[76:79], a[40:43]
ds_read_b64_tr_b16 a[206:207], v248 offset:4384
v_cvt_pk_bf16_f32 v93, v50, v51
v_mfma_f32_16x16x32_bf16 a[72:75], a[168:171], v[80:83], a[72:75]
v_exp_f32 v52, v52
v_mfma_f32_16x16x32_bf16 a[104:107], a[168:171], v[84:87], a[104:107]
ds_read_b64_tr_b16 a[168:169], v222 offset:8192
ds_read_b64_tr_b16 a[170:171], v222 offset:12288
v_mfma_f32_16x16x32_bf16 v[32:35], a[128:131], v[200:203], v[148:151]
s_add_u32 s38, s38, 16384
v_exp_f32 v53, v53
v_mfma_f32_16x16x32_bf16 v[32:35], a[132:135], v[204:207], v[32:35]
s_add_u32 m0, s37, 114688
ds_read_b128 a[128:131], v216 offset:57344
ds_read_b128 a[132:135], v217 offset:57344
v_mfma_f32_16x16x32_bf16 v[32:35], a[136:139], v[208:211], v[32:35]
v_exp_f32 v54, v54
v_mfma_f32_16x16x32_bf16 v[32:35], a[140:143], v[212:215], v[32:35]
buffer_load_dwordx4 v232, s[12:15], s39 offen offset:0 lds
v_mfma_f32_16x16x32_bf16 a[12:15], a[172:175], v[72:75], a[12:15]
v_exp_f32 v55, v55
v_mfma_f32_16x16x32_bf16 a[44:47], a[172:175], v[76:79], a[44:47]
ds_read_b128 a[136:139], v218 offset:57344
ds_read_b128 a[140:143], v219 offset:57344
v_mfma_f32_16x16x32_bf16 a[76:79], a[172:175], v[80:83], a[76:79]
v_exp_f32 v56, v56
v_mfma_f32_16x16x32_bf16 a[108:111], a[172:175], v[84:87], a[108:111]
s_waitcnt lgkmcnt(6)
v_exp_f32 v57, v57
v_mfma_f32_16x16x32_bf16 v[12:15], a[144:147], v[152:155], v[136:139]
ds_read_b64_tr_b16 a[172:173], v223 offset:8192
ds_read_b64_tr_b16 a[174:175], v223 offset:12288
v_mfma_f32_16x16x32_bf16 v[12:15], a[148:151], v[156:159], v[12:15]
v_exp_f32 v58, v58
v_mfma_f32_16x16x32_bf16 v[12:15], a[152:155], v[160:163], v[12:15]
v_cvt_pk_bf16_f32 v94, v52, v53
v_cvt_pk_bf16_f32 v95, v54, v55
v_mfma_f32_16x16x32_bf16 v[12:15], a[156:159], v[164:167], v[12:15]
v_exp_f32 v59, v59
v_mfma_f32_16x16x32_bf16 a[16:19], a[176:179], v[72:75], a[16:19]
v_cvt_pk_bf16_f32 v96, v56, v57
v_cvt_pk_bf16_f32 v97, v58, v59
v_mfma_f32_16x16x32_bf16 a[48:51], a[176:179], v[76:79], a[48:51]
v_exp_f32 v60, v60
v_mfma_f32_16x16x32_bf16 a[80:83], a[176:179], v[80:83], a[80:83]
buffer_load_dwordx4 v233, s[12:15], s39 offen offset:1024 lds
v_mfma_f32_16x16x32_bf16 a[112:115], a[176:179], v[84:87], a[112:115]
v_exp_f32 v61, v61
v_mfma_f32_16x16x32_bf16 v[20:23], a[144:147], v[168:171], v[140:143]
ds_read_b64_tr_b16 a[176:177], v224 offset:8192
ds_read_b64_tr_b16 a[178:179], v224 offset:12288
v_mfma_f32_16x16x32_bf16 v[20:23], a[148:151], v[172:175], v[20:23]
v_exp_f32 v62, v62
v_mfma_f32_16x16x32_bf16 v[20:23], a[152:155], v[176:179], v[20:23]
ds_read_b64_tr_b16 v[120:121], v248 offset:2048
v_cvt_pk_bf16_f32 v98, v60, v61
v_mfma_f32_16x16x32_bf16 v[20:23], a[156:159], v[180:183], v[20:23]
v_exp_f32 v63, v63
v_mfma_f32_16x16x32_bf16 a[20:23], a[180:183], v[72:75], a[20:23]
ds_read_b64_tr_b16 v[122:123], v248 offset:2304
v_cvt_pk_bf16_f32 v99, v62, v63
v_mfma_f32_16x16x32_bf16 a[52:55], a[180:183], v[76:79], a[52:55]
v_exp_f32 v64, v64
v_mfma_f32_16x16x32_bf16 a[84:87], a[180:183], v[80:83], a[84:87]
ds_read_b64_tr_b16 v[124:125], v248 offset:2080
ds_read_b64_tr_b16 v[126:127], v248 offset:2336
v_mfma_f32_16x16x32_bf16 a[116:119], a[180:183], v[84:87], a[116:119]
v_exp_f32 v65, v65
v_smfmac_f32_16x16x64_bf16 a[252:255], a[208:211], v[80:87], v235
ds_read_b64_tr_b16 a[180:181], v225 offset:8192
ds_read_b64_tr_b16 a[182:183], v225 offset:12288
v_mfma_f32_16x16x32_bf16 v[28:31], a[144:147], v[184:187], v[144:147]
v_exp_f32 v66, v66
v_mfma_f32_16x16x32_bf16 v[28:31], a[148:151], v[188:191], v[28:31]
buffer_load_dwordx4 v232, s[12:15], s39 offen offset:2048 lds
v_mfma_f32_16x16x32_bf16 v[28:31], a[152:155], v[192:195], v[28:31]
v_exp_f32 v67, v67
v_mfma_f32_16x16x32_bf16 v[28:31], a[156:159], v[196:199], v[28:31]
v_cvt_pk_bf16_f32 v100, v64, v65
v_cvt_pk_bf16_f32 v101, v66, v67
v_mfma_f32_16x16x32_bf16 a[24:27], a[184:187], v[72:75], a[24:27]
v_exp_f32 v68, v68
v_mfma_f32_16x16x32_bf16 a[56:59], a[184:187], v[76:79], a[56:59]
ds_read_b64_tr_b16 v[128:129], v248 offset:6144
ds_read_b64_tr_b16 v[130:131], v248 offset:6400
v_mfma_f32_16x16x32_bf16 a[88:91], a[184:187], v[80:83], a[88:91]
v_exp_f32 v69, v69
v_mfma_f32_16x16x32_bf16 a[120:123], a[184:187], v[84:87], a[120:123]
ds_read_b64_tr_b16 a[184:185], v226 offset:8192
ds_read_b64_tr_b16 a[186:187], v226 offset:12288
v_mfma_f32_16x16x32_bf16 v[36:39], a[144:147], v[200:203], v[148:151]
v_exp_f32 v70, v70
v_mfma_f32_16x16x32_bf16 v[36:39], a[148:151], v[204:207], v[36:39]
ds_read_b128 a[144:147], v216 offset:61440
ds_read_b128 a[148:151], v217 offset:61440
v_mfma_f32_16x16x32_bf16 v[36:39], a[152:155], v[208:211], v[36:39]
v_exp_f32 v71, v71
v_mfma_f32_16x16x32_bf16 v[36:39], a[156:159], v[212:215], v[36:39]
ds_read_b128 a[152:155], v218 offset:61440
ds_read_b128 a[156:159], v219 offset:61440
v_mfma_f32_16x16x32_bf16 a[28:31], a[188:191], v[72:75], a[28:31]
v_cvt_pk_bf16_f32 v102, v68, v69
v_cvt_pk_bf16_f32 v103, v70, v71
v_mfma_f32_16x16x32_bf16 a[60:63], a[188:191], v[76:79], a[60:63]
ds_read_b64_tr_b16 v[132:133], v248 offset:6176
ds_read_b64_tr_b16 v[134:135], v248 offset:6432
v_mfma_f32_16x16x32_bf16 a[92:95], a[188:191], v[80:83], a[92:95]
v_mfma_f32_16x16x32_bf16 a[124:127], a[188:191], v[84:87], a[124:127]
s_waitcnt lgkmcnt(8)
ds_read_b64_tr_b16 a[188:189], v227 offset:8192
ds_read_b64_tr_b16 a[190:191], v227 offset:12288
v_mfma_f32_16x16x32_bf16 v[40:43], a[128:131], v[152:155], v[136:139]
v_exp_f32 v8, v8
v_mfma_f32_16x16x32_bf16 v[40:43], a[132:135], v[156:159], v[40:43]
buffer_load_dwordx4 v233, s[12:15], s39 offen offset:3072 lds
v_mfma_f32_16x16x32_bf16 v[40:43], a[136:139], v[160:163], v[40:43]
v_exp_f32 v9, v9
v_mfma_f32_16x16x32_bf16 v[40:43], a[140:143], v[164:167], v[40:43]
v_cvt_pk_bf16_f32 v72, v8, v9
v_mfma_f32_16x16x32_bf16 a[0:3], a[160:163], v[88:91], a[0:3]
v_exp_f32 v10, v10
v_mfma_f32_16x16x32_bf16 a[32:35], a[160:163], v[92:95], a[32:35]
v_mfma_f32_16x16x32_bf16 a[64:67], a[160:163], v[96:99], a[64:67]
v_exp_f32 v11, v11
v_mfma_f32_16x16x32_bf16 a[96:99], a[160:163], v[100:103], a[96:99]
ds_read_b64_tr_b16 a[160:161], v220 offset:16384
ds_read_b64_tr_b16 a[162:163], v220 offset:20480
v_mfma_f32_16x16x32_bf16 v[104:107], a[192:195], a[212:215], v[104:107]
s_add_u32 m0, s49, 0
v_exp_f32 v12, v12
v_mfma_f32_16x16x32_bf16 v[48:51], a[128:131], v[168:171], v[140:143]
s_add_u32 s48, s50, 589824
s_waitcnt lgkmcnt(4)
buffer_load_dwordx4 v238, s[56:59], s48 offen  lds
v_mfma_f32_16x16x32_bf16 v[48:51], a[132:135], v[172:175], v[48:51]
v_exp_f32 v13, v13
v_mfma_f32_16x16x32_bf16 v[48:51], a[136:139], v[176:179], v[48:51]
v_cvt_pk_bf16_f32 v73, v10, v11
v_cvt_pk_bf16_f32 v74, v12, v13
v_mfma_f32_16x16x32_bf16 v[48:51], a[140:143], v[180:183], v[48:51]
v_mfma_f32_16x16x32_bf16 a[4:7], a[164:167], v[88:91], a[4:7]
v_exp_f32 v14, v14
v_mfma_f32_16x16x32_bf16 a[36:39], a[164:167], v[92:95], a[36:39]
v_mfma_f32_16x16x32_bf16 a[68:71], a[164:167], v[96:99], a[68:71]
v_exp_f32 v15, v15
v_mfma_f32_16x16x32_bf16 a[100:103], a[164:167], v[100:103], a[100:103]
s_add_u32 s39, s39, 16384
ds_read_b64_tr_b16 a[164:165], v221 offset:16384
ds_read_b64_tr_b16 a[166:167], v221 offset:20480
v_smfmac_f32_16x16x64_bf16 a[248:251], a[208:211], v[88:95], v235
s_add_u32 m0, s37, 0
v_exp_f32 v16, v16
v_mfma_f32_16x16x32_bf16 v[108:111], a[196:199], a[212:215], v[108:111]
buffer_load_dwordx4 v228, s[8:11], s38 offen offset:0 lds
v_mfma_f32_16x16x32_bf16 v[56:59], a[128:131], v[184:187], v[144:147]
v_exp_f32 v17, v17
v_mfma_f32_16x16x32_bf16 v[56:59], a[132:135], v[188:191], v[56:59]
v_cvt_pk_bf16_f32 v75, v14, v15
v_cvt_pk_bf16_f32 v76, v16, v17
v_mfma_f32_16x16x32_bf16 v[56:59], a[136:139], v[192:195], v[56:59]
v_exp_f32 v18, v18
v_mfma_f32_16x16x32_bf16 v[56:59], a[140:143], v[196:199], v[56:59]
v_mfma_f32_16x16x32_bf16 a[8:11], a[168:171], v[88:91], a[8:11]
v_mfma_f32_16x16x32_bf16 a[40:43], a[168:171], v[92:95], a[40:43]
s_add_u32 m0, s49, 1024
v_exp_f32 v19, v19
v_mfma_f32_16x16x32_bf16 a[72:75], a[168:171], v[96:99], a[72:75]
s_add_u32 s48, s50, 737280
buffer_load_dwordx4 v238, s[56:59], s48 offen  lds
v_mfma_f32_16x16x32_bf16 a[104:107], a[168:171], v[100:103], a[104:107]
v_exp_f32 v20, v20
v_mfma_f32_16x16x32_bf16 v[112:115], a[200:203], a[212:215], v[112:115]
ds_read_b64_tr_b16 a[168:169], v222 offset:16384
ds_read_b64_tr_b16 a[170:171], v222 offset:20480
v_mfma_f32_16x16x32_bf16 v[64:67], a[128:131], v[200:203], v[148:151]
v_exp_f32 v21, v21
v_mfma_f32_16x16x32_bf16 v[64:67], a[132:135], v[204:207], v[64:67]
ds_read_b128 a[128:131], v216 offset:32768
ds_read_b128 a[132:135], v217 offset:32768
v_mfma_f32_16x16x32_bf16 v[64:67], a[136:139], v[208:211], v[64:67]
v_exp_f32 v22, v22
v_mfma_f32_16x16x32_bf16 v[64:67], a[140:143], v[212:215], v[64:67]
ds_read_b128 a[136:139], v218 offset:32768
ds_read_b128 a[140:143], v219 offset:32768
v_mfma_f32_16x16x32_bf16 a[12:15], a[172:175], v[88:91], a[12:15]
s_add_u32 m0, s37, 0
v_exp_f32 v23, v23
v_mfma_f32_16x16x32_bf16 a[44:47], a[172:175], v[92:95], a[44:47]
buffer_load_dwordx4 v229, s[8:11], s38 offen offset:1024 lds
v_mfma_f32_16x16x32_bf16 a[76:79], a[172:175], v[96:99], a[76:79]
v_cvt_pk_bf16_f32 v77, v18, v19
v_cvt_pk_bf16_f32 v78, v20, v21
v_mfma_f32_16x16x32_bf16 a[108:111], a[172:175], v[100:103], a[108:111]
v_exp_f32 v24, v24
v_mfma_f32_16x16x32_bf16 v[116:119], a[204:207], a[212:215], v[116:119]
ds_read_b64_tr_b16 a[172:173], v223 offset:16384
ds_read_b64_tr_b16 a[174:175], v223 offset:20480
v_mfma_f32_16x16x32_bf16 v[44:47], a[144:147], v[152:155], v[136:139]
v_exp_f32 v25, v25
v_mfma_f32_16x16x32_bf16 v[44:47], a[148:151], v[156:159], v[44:47]
v_cvt_pk_bf16_f32 v79, v22, v23
v_cvt_pk_bf16_f32 v80, v24, v25
v_mfma_f32_16x16x32_bf16 v[44:47], a[152:155], v[160:163], v[44:47]
s_add_u32 m0, s49, 2048
v_exp_f32 v26, v26
v_mfma_f32_16x16x32_bf16 v[44:47], a[156:159], v[164:167], v[44:47]
s_add_u32 s48, s50, 884736
buffer_load_dwordx4 v238, s[56:59], s48 offen  lds
v_mfma_f32_16x16x32_bf16 a[16:19], a[176:179], v[88:91], a[16:19]
v_exp_f32 v27, v27
v_mfma_f32_16x16x32_bf16 a[48:51], a[176:179], v[92:95], a[48:51]
v_cvt_pk_bf16_f32 v81, v26, v27
v_mfma_f32_16x16x32_bf16 a[80:83], a[176:179], v[96:99], a[80:83]
v_exp_f32 v28, v28
v_mfma_f32_16x16x32_bf16 a[112:115], a[176:179], v[100:103], a[112:115]
ds_read_b64_tr_b16 a[176:177], v224 offset:16384
ds_read_b64_tr_b16 a[178:179], v224 offset:20480
v_mfma_f32_16x16x32_bf16 v[104:107], v[120:123], a[216:219], v[104:107]
v_exp_f32 v29, v29
v_mfma_f32_16x16x32_bf16 v[52:55], a[144:147], v[168:171], v[140:143]
v_cvt_pk_bf16_f32 v82, v28, v29
v_mfma_f32_16x16x32_bf16 v[52:55], a[148:151], v[172:175], v[52:55]
s_add_u32 m0, s37, 0
v_mfma_f32_16x16x32_bf16 v[52:55], a[152:155], v[176:179], v[52:55]
v_exp_f32 v30, v30
v_mfma_f32_16x16x32_bf16 v[52:55], a[156:159], v[180:183], v[52:55]
buffer_load_dwordx4 v230, s[8:11], s38 offen offset:2048 lds
v_mfma_f32_16x16x32_bf16 a[20:23], a[180:183], v[88:91], a[20:23]
v_exp_f32 v31, v31
v_mfma_f32_16x16x32_bf16 a[52:55], a[180:183], v[92:95], a[52:55]
v_cvt_pk_bf16_f32 v83, v30, v31
v_mfma_f32_16x16x32_bf16 a[84:87], a[180:183], v[96:99], a[84:87]
v_exp_f32 v32, v32
v_mfma_f32_16x16x32_bf16 a[116:119], a[180:183], v[100:103], a[116:119]
ds_read_b64_tr_b16 a[180:181], v225 offset:16384
ds_read_b64_tr_b16 a[182:183], v225 offset:20480
v_smfmac_f32_16x16x64_bf16 a[252:255], a[208:211], v[96:103], v235
v_exp_f32 v33, v33
v_mfma_f32_16x16x32_bf16 v[108:111], v[124:127], a[216:219], v[108:111]
s_add_u32 m0, s49, 3072
v_cvt_pk_bf16_f32 v84, v32, v33
v_mfma_f32_16x16x32_bf16 v[60:63], a[144:147], v[184:187], v[144:147]
s_add_u32 s48, s50, 1032192
v_exp_f32 v34, v34
v_mfma_f32_16x16x32_bf16 v[60:63], a[148:151], v[188:191], v[60:63]
buffer_load_dwordx4 v238, s[56:59], s48 offen  lds
v_mfma_f32_16x16x32_bf16 v[60:63], a[152:155], v[192:195], v[60:63]
v_mfma_f32_16x16x32_bf16 v[60:63], a[156:159], v[196:199], v[60:63]
v_exp_f32 v35, v35
v_mfma_f32_16x16x32_bf16 a[24:27], a[184:187], v[88:91], a[24:27]
v_cvt_pk_bf16_f32 v85, v34, v35
v_mfma_f32_16x16x32_bf16 a[56:59], a[184:187], v[92:95], a[56:59]
v_exp_f32 v36, v36
v_mfma_f32_16x16x32_bf16 a[88:91], a[184:187], v[96:99], a[88:91]
v_mfma_f32_16x16x32_bf16 a[120:123], a[184:187], v[100:103], a[120:123]
s_add_u32 m0, s37, 0
v_exp_f32 v37, v37
v_mfma_f32_16x16x32_bf16 v[112:115], v[128:131], a[216:219], v[112:115]
buffer_load_dwordx4 v231, s[8:11], s38 offen offset:3072 lds
v_mfma_f32_16x16x32_bf16 v[68:71], a[144:147], v[200:203], v[148:151]
v_exp_f32 v38, v38
v_mfma_f32_16x16x32_bf16 v[68:71], a[148:151], v[204:207], v[68:71]
ds_read_b64_tr_b16 a[184:185], v226 offset:16384
ds_read_b64_tr_b16 a[186:187], v226 offset:20480
v_mfma_f32_16x16x32_bf16 v[68:71], a[152:155], v[208:211], v[68:71]
v_exp_f32 v39, v39
v_mfma_f32_16x16x32_bf16 v[68:71], a[156:159], v[212:215], v[68:71]
s_waitcnt lgkmcnt(2)
ds_read_b128 a[144:147], v216 offset:36864
ds_read_b128 a[148:151], v217 offset:36864
v_mfma_f32_16x16x32_bf16 a[28:31], a[188:191], v[88:91], a[28:31]
ds_read_b128 a[152:155], v218 offset:36864
ds_read_b128 a[156:159], v219 offset:36864
v_mfma_f32_16x16x32_bf16 a[60:63], a[188:191], v[92:95], a[60:63]
v_cvt_pk_bf16_f32 v86, v36, v37
v_cvt_pk_bf16_f32 v87, v38, v39
v_mfma_f32_16x16x32_bf16 a[92:95], a[188:191], v[96:99], a[92:95]
s_add_u32 s38, s38, 16384
v_mfma_f32_16x16x32_bf16 a[124:127], a[188:191], v[100:103], a[124:127]
ds_read_b64_tr_b16 a[188:189], v227 offset:16384
ds_read_b64_tr_b16 a[190:191], v227 offset:20480
v_mfma_f32_16x16x32_bf16 v[116:119], v[132:135], a[216:219], v[116:119]
v_mfma_f32_16x16x32_bf16 v[8:11], a[128:131], v[152:155], v[136:139]
v_exp_f32 v40, v40
v_mfma_f32_16x16x32_bf16 v[8:11], a[132:135], v[156:159], v[8:11]
s_add_u32 m0, s49, 4096
v_exp_f32 v41, v41
v_mfma_f32_16x16x32_bf16 v[8:11], a[136:139], v[160:163], v[8:11]
s_add_u32 s48, s50, 589824
buffer_load_dwordx4 v238, s[60:63], s48 offen  lds
v_mfma_f32_16x16x32_bf16 v[8:11], a[140:143], v[164:167], v[8:11]
v_exp_f32 v42, v42
v_mfma_f32_16x16x32_bf16 a[0:3], a[160:163], v[72:75], a[0:3]
v_cvt_pk_bf16_f32 v88, v40, v41
v_mfma_f32_16x16x32_bf16 a[32:35], a[160:163], v[76:79], a[32:35]
v_exp_f32 v43, v43
v_mfma_f32_16x16x32_bf16 a[64:67], a[160:163], v[80:83], a[64:67]
v_cvt_pk_bf16_f32 v89, v42, v43
v_mfma_f32_16x16x32_bf16 a[96:99], a[160:163], v[84:87], a[96:99]
v_exp_f32 v44, v44
v_mfma_f32_16x16x32_bf16 v[16:19], a[128:131], v[168:171], v[140:143]
s_add_u32 m0, s49, 5120
ds_read_b64_tr_b16 a[160:161], v220 offset:24576
ds_read_b64_tr_b16 a[162:163], v220 offset:28672
v_mfma_f32_16x16x32_bf16 v[16:19], a[132:135], v[172:175], v[16:19]
s_add_u32 s48, s50, 737280
v_exp_f32 v45, v45
v_mfma_f32_16x16x32_bf16 v[16:19], a[136:139], v[176:179], v[16:19]
buffer_load_dwordx4 v238, s[60:63], s48 offen  lds
v_mfma_f32_16x16x32_bf16 v[16:19], a[140:143], v[180:183], v[16:19]
v_exp_f32 v46, v46
v_mfma_f32_16x16x32_bf16 a[4:7], a[164:167], v[72:75], a[4:7]
v_cvt_pk_bf16_f32 v90, v44, v45
v_mfma_f32_16x16x32_bf16 a[36:39], a[164:167], v[76:79], a[36:39]
v_exp_f32 v47, v47
v_mfma_f32_16x16x32_bf16 a[68:71], a[164:167], v[80:83], a[68:71]
v_cvt_pk_bf16_f32 v91, v46, v47
v_mfma_f32_16x16x32_bf16 a[100:103], a[164:167], v[84:87], a[100:103]
v_exp_f32 v48, v48
v_smfmac_f32_16x16x64_bf16 a[248:251], a[208:211], v[72:79], v235
s_add_u32 m0, s49, 6144
ds_read_b64_tr_b16 a[164:165], v221 offset:24576
ds_read_b64_tr_b16 a[166:167], v221 offset:28672
v_mfma_f32_16x16x32_bf16 v[24:27], a[128:131], v[184:187], v[144:147]
s_add_u32 s48, s50, 884736
v_exp_f32 v49, v49
v_mfma_f32_16x16x32_bf16 v[24:27], a[132:135], v[188:191], v[24:27]
buffer_load_dwordx4 v238, s[60:63], s48 offen  lds
v_mfma_f32_16x16x32_bf16 v[24:27], a[136:139], v[192:195], v[24:27]
v_exp_f32 v50, v50
v_mfma_f32_16x16x32_bf16 v[24:27], a[140:143], v[196:199], v[24:27]
v_cvt_pk_bf16_f32 v92, v48, v49
v_mfma_f32_16x16x32_bf16 a[8:11], a[168:171], v[72:75], a[8:11]
v_exp_f32 v51, v51
v_mfma_f32_16x16x32_bf16 a[40:43], a[168:171], v[76:79], a[40:43]
v_cvt_pk_bf16_f32 v93, v50, v51
v_mfma_f32_16x16x32_bf16 a[72:75], a[168:171], v[80:83], a[72:75]
v_exp_f32 v52, v52
v_mfma_f32_16x16x32_bf16 a[104:107], a[168:171], v[84:87], a[104:107]
s_add_u32 m0, s49, 7168
ds_read_b64_tr_b16 a[168:169], v222 offset:24576
ds_read_b64_tr_b16 a[170:171], v222 offset:28672
v_mfma_f32_16x16x32_bf16 v[32:35], a[128:131], v[200:203], v[148:151]
s_add_u32 s48, s50, 1032192
v_exp_f32 v53, v53
v_mfma_f32_16x16x32_bf16 v[32:35], a[132:135], v[204:207], v[32:35]
buffer_load_dwordx4 v238, s[60:63], s48 offen  lds
v_mfma_f32_16x16x32_bf16 v[32:35], a[136:139], v[208:211], v[32:35]
v_exp_f32 v54, v54
v_mfma_f32_16x16x32_bf16 v[32:35], a[140:143], v[212:215], v[32:35]
ds_read_b128 a[128:131], v216 offset:40960
ds_read_b128 a[132:135], v217 offset:40960
v_mfma_f32_16x16x32_bf16 a[12:15], a[172:175], v[72:75], a[12:15]
v_exp_f32 v55, v55
v_mfma_f32_16x16x32_bf16 a[44:47], a[172:175], v[76:79], a[44:47]
ds_read_b128 a[136:139], v218 offset:40960
ds_read_b128 a[140:143], v219 offset:40960
v_mfma_f32_16x16x32_bf16 a[76:79], a[172:175], v[80:83], a[76:79]
v_exp_f32 v56, v56
v_mfma_f32_16x16x32_bf16 a[108:111], a[172:175], v[84:87], a[108:111]
s_waitcnt lgkmcnt(6)
v_exp_f32 v57, v57
v_mfma_f32_16x16x32_bf16 v[12:15], a[144:147], v[152:155], v[136:139]
buffer_load_dwordx2 v[252:253], v251, s[76:79], s42 offen sc1
v_mfma_f32_16x16x32_bf16 v[12:15], a[148:151], v[156:159], v[12:15]
v_exp_f32 v58, v58
v_mfma_f32_16x16x32_bf16 v[12:15], a[152:155], v[160:163], v[12:15]
ds_read_b64_tr_b16 a[172:173], v223 offset:24576
ds_read_b64_tr_b16 a[174:175], v223 offset:28672
v_mfma_f32_16x16x32_bf16 v[12:15], a[156:159], v[164:167], v[12:15]
v_exp_f32 v59, v59
v_mfma_f32_16x16x32_bf16 a[16:19], a[176:179], v[72:75], a[16:19]
v_cvt_pk_bf16_f32 v94, v52, v53
v_cvt_pk_bf16_f32 v95, v54, v55
v_mfma_f32_16x16x32_bf16 a[48:51], a[176:179], v[76:79], a[48:51]
v_exp_f32 v60, v60
v_mfma_f32_16x16x32_bf16 a[80:83], a[176:179], v[80:83], a[80:83]
s_add_u32 s42, s42, s43
buffer_load_dword v255, v243, s[28:31], s45 offen
v_mfma_f32_16x16x32_bf16 a[112:115], a[176:179], v[84:87], a[112:115]
v_exp_f32 v61, v61
v_mfma_f32_16x16x32_bf16 v[20:23], a[144:147], v[168:171], v[140:143]
ds_read_b64_tr_b16 a[176:177], v224 offset:24576
ds_read_b64_tr_b16 a[178:179], v224 offset:28672
v_mfma_f32_16x16x32_bf16 v[20:23], a[148:151], v[172:175], v[20:23]
v_exp_f32 v62, v62
v_mfma_f32_16x16x32_bf16 v[20:23], a[152:155], v[176:179], v[20:23]
v_cvt_pk_bf16_f32 v96, v56, v57
v_cvt_pk_bf16_f32 v97, v58, v59
v_mfma_f32_16x16x32_bf16 v[20:23], a[156:159], v[180:183], v[20:23]
v_exp_f32 v63, v63
v_mfma_f32_16x16x32_bf16 a[20:23], a[180:183], v[72:75], a[20:23]
v_cvt_pk_bf16_f32 v98, v60, v61
v_cvt_pk_bf16_f32 v99, v62, v63
v_mfma_f32_16x16x32_bf16 a[52:55], a[180:183], v[76:79], a[52:55]
v_exp_f32 v64, v64
v_mfma_f32_16x16x32_bf16 a[84:87], a[180:183], v[80:83], a[84:87]
s_add_u32 s45, s45, 589824
global_load_dword v255, v242, s[72:73]
v_mfma_f32_16x16x32_bf16 a[116:119], a[180:183], v[84:87], a[116:119]
v_exp_f32 v65, v65
v_smfmac_f32_16x16x64_bf16 a[252:255], a[208:211], v[80:87], v235
ds_read_b64_tr_b16 a[180:181], v225 offset:24576
ds_read_b64_tr_b16 a[182:183], v225 offset:28672
v_mfma_f32_16x16x32_bf16 v[28:31], a[144:147], v[184:187], v[144:147]
v_exp_f32 v66, v66
v_mfma_f32_16x16x32_bf16 v[28:31], a[148:151], v[188:191], v[28:31]
v_cvt_pk_bf16_f32 v100, v64, v65
v_mfma_f32_16x16x32_bf16 v[28:31], a[152:155], v[192:195], v[28:31]
v_exp_f32 v67, v67
v_mfma_f32_16x16x32_bf16 v[28:31], a[156:159], v[196:199], v[28:31]
v_cvt_pk_bf16_f32 v101, v66, v67
v_mfma_f32_16x16x32_bf16 a[24:27], a[184:187], v[72:75], a[24:27]
v_exp_f32 v68, v68
v_mfma_f32_16x16x32_bf16 a[56:59], a[184:187], v[76:79], a[56:59]
buffer_load_dword v255, v0, s[24:27], s44 offen
v_mfma_f32_16x16x32_bf16 a[88:91], a[184:187], v[80:83], a[88:91]
v_exp_f32 v69, v69
v_mfma_f32_16x16x32_bf16 a[120:123], a[184:187], v[84:87], a[120:123]
ds_read_b64_tr_b16 a[184:185], v226 offset:24576
ds_read_b64_tr_b16 a[186:187], v226 offset:28672
v_mfma_f32_16x16x32_bf16 v[36:39], a[144:147], v[200:203], v[148:151]
v_exp_f32 v70, v70
v_mfma_f32_16x16x32_bf16 v[36:39], a[148:151], v[204:207], v[36:39]
ds_read_b128 a[144:147], v216 offset:45056
ds_read_b128 a[148:151], v217 offset:45056
v_mfma_f32_16x16x32_bf16 v[36:39], a[152:155], v[208:211], v[36:39]
v_exp_f32 v71, v71
v_mfma_f32_16x16x32_bf16 v[36:39], a[156:159], v[212:215], v[36:39]
ds_read_b128 a[152:155], v218 offset:45056
ds_read_b128 a[156:159], v219 offset:45056
v_mfma_f32_16x16x32_bf16 a[28:31], a[188:191], v[72:75], a[28:31]
v_cvt_pk_bf16_f32 v102, v68, v69
v_cvt_pk_bf16_f32 v103, v70, v71
v_mfma_f32_16x16x32_bf16 a[60:63], a[188:191], v[76:79], a[60:63]
s_add_u32 s44, s44, 4096
v_mfma_f32_16x16x32_bf16 a[92:95], a[188:191], v[80:83], a[92:95]
v_mfma_f32_16x16x32_bf16 a[124:127], a[188:191], v[84:87], a[124:127]
s_waitcnt lgkmcnt(6)
ds_read_b64_tr_b16 a[188:189], v227 offset:24576
ds_read_b64_tr_b16 a[190:191], v227 offset:28672
v_mfma_f32_16x16x32_bf16 v[40:43], a[128:131], v[152:155], v[136:139]
v_exp_f32 v8, v8
v_mfma_f32_16x16x32_bf16 v[40:43], a[132:135], v[156:159], v[40:43]
v_exp_f32 v9, v9
v_mfma_f32_16x16x32_bf16 v[40:43], a[136:139], v[160:163], v[40:43]
v_cvt_pk_bf16_f32 v72, v8, v9
v_mfma_f32_16x16x32_bf16 v[40:43], a[140:143], v[164:167], v[40:43]
v_exp_f32 v10, v10
v_mfma_f32_16x16x32_bf16 a[0:3], a[160:163], v[88:91], a[0:3]
v_mfma_f32_16x16x32_bf16 a[32:35], a[160:163], v[92:95], a[32:35]
v_exp_f32 v11, v11
s_waitcnt vmcnt(8) lgkmcnt(0)
s_barrier
v_mfma_f32_16x16x32_bf16 a[64:67], a[160:163], v[96:99], a[64:67]
v_cvt_pk_bf16_f32 v73, v10, v11
v_mfma_f32_16x16x32_bf16 a[96:99], a[160:163], v[100:103], a[96:99]
s_add_u32 m0, s37, 65536
v_exp_f32 v12, v12
v_mfma_f32_16x16x32_bf16 v[48:51], a[128:131], v[168:171], v[140:143]
buffer_load_dwordx4 v232, s[12:15], s39 offen offset:0 lds
v_mfma_f32_16x16x32_bf16 v[48:51], a[132:135], v[172:175], v[48:51]
v_exp_f32 v13, v13
v_mfma_f32_16x16x32_bf16 v[48:51], a[136:139], v[176:179], v[48:51]
ds_read_b64_tr_b16 a[160:161], v220 offset:32768
ds_read_b64_tr_b16 a[162:163], v220 offset:36864
v_mfma_f32_16x16x32_bf16 v[48:51], a[140:143], v[180:183], v[48:51]
v_exp_f32 v14, v14
v_mfma_f32_16x16x32_bf16 a[4:7], a[164:167], v[88:91], a[4:7]
v_cvt_pk_bf16_f32 v74, v12, v13
v_mfma_f32_16x16x32_bf16 a[36:39], a[164:167], v[92:95], a[36:39]
v_exp_f32 v15, v15
v_mfma_f32_16x16x32_bf16 a[68:71], a[164:167], v[96:99], a[68:71]
v_cvt_pk_bf16_f32 v75, v14, v15
v_mfma_f32_16x16x32_bf16 a[100:103], a[164:167], v[100:103], a[100:103]
v_exp_f32 v16, v16
v_smfmac_f32_16x16x64_bf16 a[248:251], a[208:211], v[88:95], v235
buffer_load_dwordx4 v233, s[12:15], s39 offen offset:1024 lds
v_mfma_f32_16x16x32_bf16 v[56:59], a[128:131], v[184:187], v[144:147]
v_exp_f32 v17, v17
v_mfma_f32_16x16x32_bf16 v[56:59], a[132:135], v[188:191], v[56:59]
ds_read_b64_tr_b16 a[164:165], v221 offset:32768
ds_read_b64_tr_b16 a[166:167], v221 offset:36864
v_mfma_f32_16x16x32_bf16 v[56:59], a[136:139], v[192:195], v[56:59]
v_exp_f32 v18, v18
v_mfma_f32_16x16x32_bf16 v[56:59], a[140:143], v[196:199], v[56:59]
v_cvt_pk_bf16_f32 v76, v16, v17
v_mfma_f32_16x16x32_bf16 a[8:11], a[168:171], v[88:91], a[8:11]
v_exp_f32 v19, v19
v_mfma_f32_16x16x32_bf16 a[40:43], a[168:171], v[92:95], a[40:43]
v_cvt_pk_bf16_f32 v77, v18, v19
v_mfma_f32_16x16x32_bf16 a[72:75], a[168:171], v[96:99], a[72:75]
v_exp_f32 v20, v20
v_mfma_f32_16x16x32_bf16 a[104:107], a[168:171], v[100:103], a[104:107]
ds_read_b64_tr_b16 a[168:169], v222 offset:32768
ds_read_b64_tr_b16 a[170:171], v222 offset:36864
v_mfma_f32_16x16x32_bf16 v[64:67], a[128:131], v[200:203], v[148:151]
v_exp_f32 v21, v21
v_mfma_f32_16x16x32_bf16 v[64:67], a[132:135], v[204:207], v[64:67]
buffer_load_dwordx4 v232, s[12:15], s39 offen offset:2048 lds
v_mfma_f32_16x16x32_bf16 v[64:67], a[136:139], v[208:211], v[64:67]
v_exp_f32 v22, v22
v_mfma_f32_16x16x32_bf16 v[64:67], a[140:143], v[212:215], v[64:67]
ds_read_b128 a[128:131], v216 offset:16384
ds_read_b128 a[132:135], v217 offset:16384
v_mfma_f32_16x16x32_bf16 a[12:15], a[172:175], v[88:91], a[12:15]
v_exp_f32 v23, v23
v_mfma_f32_16x16x32_bf16 a[44:47], a[172:175], v[92:95], a[44:47]
ds_read_b128 a[136:139], v218 offset:16384
ds_read_b128 a[140:143], v219 offset:16384
v_mfma_f32_16x16x32_bf16 a[76:79], a[172:175], v[96:99], a[76:79]
v_exp_f32 v24, v24
v_mfma_f32_16x16x32_bf16 a[108:111], a[172:175], v[100:103], a[108:111]
v_exp_f32 v25, v25
v_mfma_f32_16x16x32_bf16 v[44:47], a[144:147], v[152:155], v[136:139]
ds_read_b64_tr_b16 a[172:173], v223 offset:32768
ds_read_b64_tr_b16 a[174:175], v223 offset:36864
v_mfma_f32_16x16x32_bf16 v[44:47], a[148:151], v[156:159], v[44:47]
v_exp_f32 v26, v26
v_mfma_f32_16x16x32_bf16 v[44:47], a[152:155], v[160:163], v[44:47]
buffer_load_dwordx4 v233, s[12:15], s39 offen offset:3072 lds
v_mfma_f32_16x16x32_bf16 v[44:47], a[156:159], v[164:167], v[44:47]
v_exp_f32 v27, v27
v_mfma_f32_16x16x32_bf16 a[16:19], a[176:179], v[88:91], a[16:19]
v_cvt_pk_bf16_f32 v78, v20, v21
v_cvt_pk_bf16_f32 v79, v22, v23
v_mfma_f32_16x16x32_bf16 a[48:51], a[176:179], v[92:95], a[48:51]
v_exp_f32 v28, v28
v_mfma_f32_16x16x32_bf16 a[80:83], a[176:179], v[96:99], a[80:83]
v_cvt_pk_bf16_f32 v80, v24, v25
v_cvt_pk_bf16_f32 v81, v26, v27
v_mfma_f32_16x16x32_bf16 a[112:115], a[176:179], v[100:103], a[112:115]
v_exp_f32 v29, v29
v_mfma_f32_16x16x32_bf16 v[52:55], a[144:147], v[168:171], v[140:143]
ds_read_b64_tr_b16 a[176:177], v224 offset:32768
ds_read_b64_tr_b16 a[178:179], v224 offset:36864
v_mfma_f32_16x16x32_bf16 v[52:55], a[148:151], v[172:175], v[52:55]
v_exp_f32 v30, v30
v_mfma_f32_16x16x32_bf16 v[52:55], a[152:155], v[176:179], v[52:55]
v_cvt_pk_bf16_f32 v82, v28, v29
v_mfma_f32_16x16x32_bf16 v[52:55], a[156:159], v[180:183], v[52:55]
s_add_u32 s39, s39, 16384
v_exp_f32 v31, v31
v_mfma_f32_16x16x32_bf16 a[20:23], a[180:183], v[88:91], a[20:23]
s_add_u32 m0, s37, 49152
v_cvt_pk_bf16_f32 v83, v30, v31
v_mfma_f32_16x16x32_bf16 a[52:55], a[180:183], v[92:95], a[52:55]
v_exp_f32 v32, v32
v_mfma_f32_16x16x32_bf16 a[84:87], a[180:183], v[96:99], a[84:87]
buffer_load_dwordx4 v228, s[8:11], s38 offen offset:0 lds
v_mfma_f32_16x16x32_bf16 a[116:119], a[180:183], v[100:103], a[116:119]
v_exp_f32 v33, v33
v_smfmac_f32_16x16x64_bf16 a[252:255], a[208:211], v[96:103], v235
ds_read_b64_tr_b16 a[180:181], v225 offset:32768
ds_read_b64_tr_b16 a[182:183], v225 offset:36864
v_mfma_f32_16x16x32_bf16 v[60:63], a[144:147], v[184:187], v[144:147]
v_exp_f32 v34, v34
v_mfma_f32_16x16x32_bf16 v[60:63], a[148:151], v[188:191], v[60:63]
v_cvt_pk_bf16_f32 v84, v32, v33
v_mfma_f32_16x16x32_bf16 v[60:63], a[152:155], v[192:195], v[60:63]
v_exp_f32 v35, v35
v_mfma_f32_16x16x32_bf16 v[60:63], a[156:159], v[196:199], v[60:63]
buffer_load_dwordx4 v229, s[8:11], s38 offen offset:1024 lds
v_mfma_f32_16x16x32_bf16 a[24:27], a[184:187], v[88:91], a[24:27]
v_exp_f32 v36, v36
v_mfma_f32_16x16x32_bf16 a[56:59], a[184:187], v[92:95], a[56:59]
v_cvt_pk_bf16_f32 v85, v34, v35
v_mfma_f32_16x16x32_bf16 a[88:91], a[184:187], v[96:99], a[88:91]
v_exp_f32 v37, v37
v_mfma_f32_16x16x32_bf16 a[120:123], a[184:187], v[100:103], a[120:123]
ds_read_b64_tr_b16 a[184:185], v226 offset:32768
ds_read_b64_tr_b16 a[186:187], v226 offset:36864
v_mfma_f32_16x16x32_bf16 v[68:71], a[144:147], v[200:203], v[148:151]
v_exp_f32 v38, v38
v_mfma_f32_16x16x32_bf16 v[68:71], a[148:151], v[204:207], v[68:71]
ds_read_b128 a[144:147], v216 offset:20480
ds_read_b128 a[148:151], v217 offset:20480
v_mfma_f32_16x16x32_bf16 v[68:71], a[152:155], v[208:211], v[68:71]
v_exp_f32 v39, v39
v_mfma_f32_16x16x32_bf16 v[68:71], a[156:159], v[212:215], v[68:71]
ds_read_b128 a[152:155], v218 offset:20480
ds_read_b128 a[156:159], v219 offset:20480
v_mfma_f32_16x16x32_bf16 a[28:31], a[188:191], v[88:91], a[28:31]
v_cvt_pk_bf16_f32 v86, v36, v37
v_cvt_pk_bf16_f32 v87, v38, v39
v_mfma_f32_16x16x32_bf16 a[60:63], a[188:191], v[92:95], a[60:63]
v_mfma_f32_16x16x32_bf16 a[92:95], a[188:191], v[96:99], a[92:95]
v_mfma_f32_16x16x32_bf16 a[124:127], a[188:191], v[100:103], a[124:127]
s_waitcnt lgkmcnt(6)
ds_read_b64_tr_b16 a[188:189], v227 offset:32768
ds_read_b64_tr_b16 a[190:191], v227 offset:36864
v_mfma_f32_16x16x32_bf16 v[8:11], a[128:131], v[152:155], v[136:139]
v_exp_f32 v40, v40
v_mfma_f32_16x16x32_bf16 v[8:11], a[132:135], v[156:159], v[8:11]
v_exp_f32 v41, v41
v_mfma_f32_16x16x32_bf16 v[8:11], a[136:139], v[160:163], v[8:11]
buffer_load_dwordx4 v230, s[8:11], s38 offen offset:2048 lds
v_mfma_f32_16x16x32_bf16 v[8:11], a[140:143], v[164:167], v[8:11]
v_exp_f32 v42, v42
v_mfma_f32_16x16x32_bf16 a[0:3], a[160:163], v[72:75], a[0:3]
v_cvt_pk_bf16_f32 v88, v40, v41
v_mfma_f32_16x16x32_bf16 a[32:35], a[160:163], v[76:79], a[32:35]
v_exp_f32 v43, v43
v_mfma_f32_16x16x32_bf16 a[64:67], a[160:163], v[80:83], a[64:67]
v_cvt_pk_bf16_f32 v89, v42, v43
v_mfma_f32_16x16x32_bf16 a[96:99], a[160:163], v[84:87], a[96:99]
v_exp_f32 v44, v44
v_mfma_f32_16x16x32_bf16 v[16:19], a[128:131], v[168:171], v[140:143]
ds_read_b64_tr_b16 a[160:161], v220 offset:40960
ds_read_b64_tr_b16 a[162:163], v220 offset:45056
v_mfma_f32_16x16x32_bf16 v[16:19], a[132:135], v[172:175], v[16:19]
v_exp_f32 v45, v45
v_mfma_f32_16x16x32_bf16 v[16:19], a[136:139], v[176:179], v[16:19]
v_cvt_pk_bf16_f32 v90, v44, v45
v_mfma_f32_16x16x32_bf16 v[16:19], a[140:143], v[180:183], v[16:19]
v_exp_f32 v46, v46
v_mfma_f32_16x16x32_bf16 a[4:7], a[164:167], v[72:75], a[4:7]
v_mfma_f32_16x16x32_bf16 a[36:39], a[164:167], v[76:79], a[36:39]
v_exp_f32 v47, v47
v_mfma_f32_16x16x32_bf16 a[68:71], a[164:167], v[80:83], a[68:71]
buffer_load_dwordx4 v231, s[8:11], s38 offen offset:3072 lds
v_mfma_f32_16x16x32_bf16 a[100:103], a[164:167], v[84:87], a[100:103]
v_exp_f32 v48, v48
v_smfmac_f32_16x16x64_bf16 a[248:251], a[208:211], v[72:79], v235
ds_read_b64_tr_b16 a[164:165], v221 offset:40960
ds_read_b64_tr_b16 a[166:167], v221 offset:45056
v_mfma_f32_16x16x32_bf16 v[24:27], a[128:131], v[184:187], v[144:147]
v_exp_f32 v49, v49
v_mfma_f32_16x16x32_bf16 v[24:27], a[132:135], v[188:191], v[24:27]
v_cvt_pk_bf16_f32 v91, v46, v47
v_cvt_pk_bf16_f32 v92, v48, v49
v_mfma_f32_16x16x32_bf16 v[24:27], a[136:139], v[192:195], v[24:27]
v_exp_f32 v50, v50
v_mfma_f32_16x16x32_bf16 v[24:27], a[140:143], v[196:199], v[24:27]
s_waitcnt vmcnt(12)
s_nop 0
ds_read_b64_tr_b16 a[192:193], v248 offset:0
ds_read_b64_tr_b16 a[194:195], v248 offset:256
v_mfma_f32_16x16x32_bf16 a[8:11], a[168:171], v[72:75], a[8:11]
v_exp_f32 v51, v51
v_mfma_f32_16x16x32_bf16 a[40:43], a[168:171], v[76:79], a[40:43]
ds_read_b64_tr_b16 a[196:197], v248 offset:32
v_cvt_pk_bf16_f32 v93, v50, v51
v_mfma_f32_16x16x32_bf16 a[72:75], a[168:171], v[80:83], a[72:75]
v_exp_f32 v52, v52
v_mfma_f32_16x16x32_bf16 a[104:107], a[168:171], v[84:87], a[104:107]
ds_read_b64_tr_b16 a[168:169], v222 offset:40960
ds_read_b64_tr_b16 a[170:171], v222 offset:45056
v_mfma_f32_16x16x32_bf16 v[32:35], a[128:131], v[200:203], v[148:151]
s_add_u32 s38, s38, 16384
v_exp_f32 v53, v53
v_mfma_f32_16x16x32_bf16 v[32:35], a[132:135], v[204:207], v[32:35]
s_add_u32 m0, s37, 81920
ds_read_b128 a[128:131], v216 offset:24576
ds_read_b128 a[132:135], v217 offset:24576
v_mfma_f32_16x16x32_bf16 v[32:35], a[136:139], v[208:211], v[32:35]
v_exp_f32 v54, v54
v_mfma_f32_16x16x32_bf16 v[32:35], a[140:143], v[212:215], v[32:35]
buffer_load_dwordx4 v232, s[12:15], s39 offen offset:0 lds
v_mfma_f32_16x16x32_bf16 a[12:15], a[172:175], v[72:75], a[12:15]
v_exp_f32 v55, v55
v_mfma_f32_16x16x32_bf16 a[44:47], a[172:175], v[76:79], a[44:47]
ds_read_b128 a[136:139], v218 offset:24576
ds_read_b128 a[140:143], v219 offset:24576
v_mfma_f32_16x16x32_bf16 a[76:79], a[172:175], v[80:83], a[76:79]
v_exp_f32 v56, v56
v_mfma_f32_16x16x32_bf16 a[108:111], a[172:175], v[84:87], a[108:111]
s_waitcnt lgkmcnt(6)
v_exp_f32 v57, v57
v_mfma_f32_16x16x32_bf16 v[12:15], a[144:147], v[152:155], v[136:139]
ds_read_b64_tr_b16 a[172:173], v223 offset:40960
ds_read_b64_tr_b16 a[174:175], v223 offset:45056
v_mfma_f32_16x16x32_bf16 v[12:15], a[148:151], v[156:159], v[12:15]
v_exp_f32 v58, v58
v_mfma_f32_16x16x32_bf16 v[12:15], a[152:155], v[160:163], v[12:15]
v_cvt_pk_bf16_f32 v94, v52, v53
v_cvt_pk_bf16_f32 v95, v54, v55
v_mfma_f32_16x16x32_bf16 v[12:15], a[156:159], v[164:167], v[12:15]
v_exp_f32 v59, v59
v_mfma_f32_16x16x32_bf16 a[16:19], a[176:179], v[72:75], a[16:19]
v_cvt_pk_bf16_f32 v96, v56, v57
v_cvt_pk_bf16_f32 v97, v58, v59
v_mfma_f32_16x16x32_bf16 a[48:51], a[176:179], v[76:79], a[48:51]
v_exp_f32 v60, v60
v_mfma_f32_16x16x32_bf16 a[80:83], a[176:179], v[80:83], a[80:83]
buffer_load_dwordx4 v233, s[12:15], s39 offen offset:1024 lds
v_mfma_f32_16x16x32_bf16 a[112:115], a[176:179], v[84:87], a[112:115]
v_exp_f32 v61, v61
v_mfma_f32_16x16x32_bf16 v[20:23], a[144:147], v[168:171], v[140:143]
ds_read_b64_tr_b16 a[176:177], v224 offset:40960
ds_read_b64_tr_b16 a[178:179], v224 offset:45056
v_mfma_f32_16x16x32_bf16 v[20:23], a[148:151], v[172:175], v[20:23]
v_exp_f32 v62, v62
v_mfma_f32_16x16x32_bf16 v[20:23], a[152:155], v[176:179], v[20:23]
ds_read_b64_tr_b16 a[198:199], v248 offset:288
v_cvt_pk_bf16_f32 v98, v60, v61
v_mfma_f32_16x16x32_bf16 v[20:23], a[156:159], v[180:183], v[20:23]
v_exp_f32 v63, v63
v_mfma_f32_16x16x32_bf16 a[20:23], a[180:183], v[72:75], a[20:23]
ds_read_b64_tr_b16 a[200:201], v248 offset:4096
v_cvt_pk_bf16_f32 v99, v62, v63
v_mfma_f32_16x16x32_bf16 a[52:55], a[180:183], v[76:79], a[52:55]
v_exp_f32 v64, v64
v_mfma_f32_16x16x32_bf16 a[84:87], a[180:183], v[80:83], a[84:87]
ds_read_b64_tr_b16 a[202:203], v248 offset:4352
ds_read_b64_tr_b16 a[204:205], v248 offset:4128
v_mfma_f32_16x16x32_bf16 a[116:119], a[180:183], v[84:87], a[116:119]
v_exp_f32 v65, v65
v_smfmac_f32_16x16x64_bf16 a[252:255], a[208:211], v[80:87], v235
ds_read_b64_tr_b16 a[180:181], v225 offset:40960
ds_read_b64_tr_b16 a[182:183], v225 offset:45056
v_mfma_f32_16x16x32_bf16 v[28:31], a[144:147], v[184:187], v[144:147]
v_exp_f32 v66, v66
v_mfma_f32_16x16x32_bf16 v[28:31], a[148:151], v[188:191], v[28:31]
buffer_load_dwordx4 v232, s[12:15], s39 offen offset:2048 lds
v_mfma_f32_16x16x32_bf16 v[28:31], a[152:155], v[192:195], v[28:31]
v_exp_f32 v67, v67
v_mfma_f32_16x16x32_bf16 v[28:31], a[156:159], v[196:199], v[28:31]
v_cvt_pk_bf16_f32 v100, v64, v65
v_cvt_pk_bf16_f32 v101, v66, v67
v_mfma_f32_16x16x32_bf16 a[24:27], a[184:187], v[72:75], a[24:27]
v_exp_f32 v68, v68
v_mfma_f32_16x16x32_bf16 a[56:59], a[184:187], v[76:79], a[56:59]
ds_read_b64_tr_b16 a[206:207], v248 offset:4384
ds_read_b64_tr_b16 v[120:121], v248 offset:2048
v_mfma_f32_16x16x32_bf16 a[88:91], a[184:187], v[80:83], a[88:91]
v_exp_f32 v69, v69
v_mfma_f32_16x16x32_bf16 a[120:123], a[184:187], v[84:87], a[120:123]
ds_read_b64_tr_b16 a[184:185], v226 offset:40960
ds_read_b64_tr_b16 a[186:187], v226 offset:45056
v_mfma_f32_16x16x32_bf16 v[36:39], a[144:147], v[200:203], v[148:151]
v_exp_f32 v70, v70
v_mfma_f32_16x16x32_bf16 v[36:39], a[148:151], v[204:207], v[36:39]
ds_read_b128 a[144:147], v216 offset:28672
ds_read_b128 a[148:151], v217 offset:28672
v_mfma_f32_16x16x32_bf16 v[36:39], a[152:155], v[208:211], v[36:39]
v_exp_f32 v71, v71
v_mfma_f32_16x16x32_bf16 v[36:39], a[156:159], v[212:215], v[36:39]
ds_read_b128 a[152:155], v218 offset:28672
ds_read_b128 a[156:159], v219 offset:28672
v_mfma_f32_16x16x32_bf16 a[28:31], a[188:191], v[72:75], a[28:31]
v_cvt_pk_bf16_f32 v102, v68, v69
v_cvt_pk_bf16_f32 v103, v70, v71
v_mfma_f32_16x16x32_bf16 a[60:63], a[188:191], v[76:79], a[60:63]
ds_read_b64_tr_b16 v[122:123], v248 offset:2304
v_mfma_f32_16x16x32_bf16 a[92:95], a[188:191], v[80:83], a[92:95]
v_mfma_f32_16x16x32_bf16 a[124:127], a[188:191], v[84:87], a[124:127]
s_waitcnt lgkmcnt(7)
ds_read_b64_tr_b16 a[188:189], v227 offset:40960
ds_read_b64_tr_b16 a[190:191], v227 offset:45056
v_mfma_f32_16x16x32_bf16 v[40:43], a[128:131], v[152:155], v[136:139]
s_sub_u32 s90, s49, 0xf000
v_exp_f32 v8, v8
v_mfma_f32_16x16x32_bf16 v[40:43], a[132:135], v[156:159], v[40:43]
buffer_load_dwordx4 v233, s[12:15], s39 offen offset:3072 lds
v_mfma_f32_16x16x32_bf16 v[40:43], a[136:139], v[160:163], v[40:43]
v_exp_f32 v9, v9
v_mfma_f32_16x16x32_bf16 v[40:43], a[140:143], v[164:167], v[40:43]
ds_read_b64_tr_b16 v[124:125], v248 offset:2080
v_cvt_pk_bf16_f32 v72, v8, v9
v_mfma_f32_16x16x32_bf16 a[0:3], a[160:163], v[88:91], a[0:3]
v_exp_f32 v10, v10
v_mfma_f32_16x16x32_bf16 a[32:35], a[160:163], v[92:95], a[32:35]
ds_read_b64_tr_b16 v[126:127], v248 offset:2336
ds_read_b64_tr_b16 v[128:129], v248 offset:6144
v_mfma_f32_16x16x32_bf16 a[64:67], a[160:163], v[96:99], a[64:67]
v_exp_f32 v11, v11
v_mfma_f32_16x16x32_bf16 a[96:99], a[160:163], v[100:103], a[96:99]
ds_read_b64_tr_b16 a[160:161], v220 offset:49152
ds_read_b64_tr_b16 a[162:163], v220 offset:53248
v_mfma_f32_16x16x32_bf16 v[104:107], a[192:195], a[220:223], v[104:107]
v_exp_f32 v12, v12
v_mfma_f32_16x16x32_bf16 v[48:51], a[128:131], v[168:171], v[140:143]
ds_read_b64_tr_b16 v[130:131], v248 offset:6400
v_cvt_pk_bf16_f32 v73, v10, v11
v_mfma_f32_16x16x32_bf16 v[48:51], a[132:135], v[172:175], v[48:51]
v_exp_f32 v13, v13
v_mfma_f32_16x16x32_bf16 v[48:51], a[136:139], v[176:179], v[48:51]
ds_read_b64_tr_b16 v[132:133], v248 offset:6176
v_cvt_pk_bf16_f32 v74, v12, v13
v_mfma_f32_16x16x32_bf16 v[48:51], a[140:143], v[180:183], v[48:51]
ds_read_b64_tr_b16 v[134:135], v248 offset:6432
v_mfma_f32_16x16x32_bf16 a[4:7], a[164:167], v[88:91], a[4:7]
v_exp_f32 v14, v14
v_mfma_f32_16x16x32_bf16 a[36:39], a[164:167], v[92:95], a[36:39]
v_mfma_f32_16x16x32_bf16 a[68:71], a[164:167], v[96:99], a[68:71]
s_add_u32 s39, s39, 16384
v_exp_f32 v15, v15
v_mfma_f32_16x16x32_bf16 a[100:103], a[164:167], v[100:103], a[100:103]
s_add_u32 m0, s37, 32768
ds_read_b64_tr_b16 a[164:165], v221 offset:49152
ds_read_b64_tr_b16 a[166:167], v221 offset:53248
v_smfmac_f32_16x16x64_bf16 a[248:251], a[208:211], v[88:95], v235
v_exp_f32 v16, v16
v_mfma_f32_16x16x32_bf16 v[108:111], a[196:199], a[220:223], v[108:111]
buffer_load_dwordx4 v228, s[8:11], s38 offen offset:0 lds
v_mfma_f32_16x16x32_bf16 v[56:59], a[128:131], v[184:187], v[144:147]
v_exp_f32 v17, v17
v_mfma_f32_16x16x32_bf16 v[56:59], a[132:135], v[188:191], v[56:59]
v_cvt_pk_bf16_f32 v75, v14, v15
v_cvt_pk_bf16_f32 v76, v16, v17
v_mfma_f32_16x16x32_bf16 v[56:59], a[136:139], v[192:195], v[56:59]
v_exp_f32 v18, v18
v_mfma_f32_16x16x32_bf16 v[56:59], a[140:143], v[196:199], v[56:59]
v_mfma_f32_16x16x32_bf16 a[8:11], a[168:171], v[88:91], a[8:11]
v_mfma_f32_16x16x32_bf16 a[40:43], a[168:171], v[92:95], a[40:43]
v_exp_f32 v19, v19
v_mfma_f32_16x16x32_bf16 a[72:75], a[168:171], v[96:99], a[72:75]
v_cvt_pk_bf16_f32 v77, v18, v19
v_mfma_f32_16x16x32_bf16 a[104:107], a[168:171], v[100:103], a[104:107]
v_exp_f32 v20, v20
v_mfma_f32_16x16x32_bf16 v[112:115], a[200:203], a[220:223], v[112:115]
ds_read_b64_tr_b16 a[168:169], v222 offset:49152
ds_read_b64_tr_b16 a[170:171], v222 offset:53248
v_mfma_f32_16x16x32_bf16 v[64:67], a[128:131], v[200:203], v[148:151]
v_exp_f32 v21, v21
v_mfma_f32_16x16x32_bf16 v[64:67], a[132:135], v[204:207], v[64:67]
buffer_load_dwordx4 v229, s[8:11], s38 offen offset:1024 lds
v_mfma_f32_16x16x32_bf16 v[64:67], a[136:139], v[208:211], v[64:67]
v_exp_f32 v22, v22
v_mfma_f32_16x16x32_bf16 v[64:67], a[140:143], v[212:215], v[64:67]
ds_read_b128 a[128:131], v216 offset:0
ds_read_b128 a[132:135], v217 offset:0
v_mfma_f32_16x16x32_bf16 a[12:15], a[172:175], v[88:91], a[12:15]
v_exp_f32 v23, v23
v_mfma_f32_16x16x32_bf16 a[44:47], a[172:175], v[92:95], a[44:47]
ds_read_b128 a[136:139], v218 offset:0
ds_read_b128 a[140:143], v219 offset:0
v_mfma_f32_16x16x32_bf16 a[76:79], a[172:175], v[96:99], a[76:79]
v_cvt_pk_bf16_f32 v78, v20, v21
v_cvt_pk_bf16_f32 v79, v22, v23
v_mfma_f32_16x16x32_bf16 a[108:111], a[172:175], v[100:103], a[108:111]
v_exp_f32 v24, v24
v_mfma_f32_16x16x32_bf16 v[116:119], a[204:207], a[220:223], v[116:119]
s_waitcnt lgkmcnt(6)
ds_read_b64_tr_b16 a[172:173], v223 offset:49152
ds_read_b64_tr_b16 a[174:175], v223 offset:53248
v_mfma_f32_16x16x32_bf16 v[44:47], a[144:147], v[152:155], v[136:139]
v_exp_f32 v25, v25
v_mfma_f32_16x16x32_bf16 v[44:47], a[148:151], v[156:159], v[44:47]
v_cvt_pk_bf16_f32 v80, v24, v25
v_mfma_f32_16x16x32_bf16 v[44:47], a[152:155], v[160:163], v[44:47]
v_exp_f32 v26, v26
v_mfma_f32_16x16x32_bf16 v[44:47], a[156:159], v[164:167], v[44:47]
v_mfma_f32_16x16x32_bf16 a[16:19], a[176:179], v[88:91], a[16:19]
v_exp_f32 v27, v27
v_mfma_f32_16x16x32_bf16 a[48:51], a[176:179], v[92:95], a[48:51]
v_cvt_pk_bf16_f32 v81, v26, v27
v_mfma_f32_16x16x32_bf16 a[80:83], a[176:179], v[96:99], a[80:83]
v_exp_f32 v28, v28
v_mfma_f32_16x16x32_bf16 a[112:115], a[176:179], v[100:103], a[112:115]
buffer_load_dwordx4 v230, s[8:11], s38 offen offset:2048 lds
v_mfma_f32_16x16x32_bf16 v[52:55], a[144:147], v[168:171], v[140:143]
v_exp_f32 v29, v29
v_mfma_f32_16x16x32_bf16 v[52:55], a[148:151], v[172:175], v[52:55]
ds_read_b64_tr_b16 a[176:177], v224 offset:49152
ds_read_b64_tr_b16 a[178:179], v224 offset:53248
v_mfma_f32_16x16x32_bf16 v[52:55], a[152:155], v[176:179], v[52:55]
v_cvt_pk_bf16_f32 v82, v28, v29
v_mfma_f32_16x16x32_bf16 v[52:55], a[156:159], v[180:183], v[52:55]
v_exp_f32 v30, v30
v_mfma_f32_16x16x32_bf16 a[20:23], a[180:183], v[88:91], a[20:23]
v_mfma_f32_16x16x32_bf16 a[52:55], a[180:183], v[92:95], a[52:55]
v_exp_f32 v31, v31
v_mfma_f32_16x16x32_bf16 a[84:87], a[180:183], v[96:99], a[84:87]
v_cvt_pk_bf16_f32 v83, v30, v31
v_mfma_f32_16x16x32_bf16 a[116:119], a[180:183], v[100:103], a[116:119]
v_exp_f32 v32, v32
v_smfmac_f32_16x16x64_bf16 a[252:255], a[208:211], v[96:103], v235
ds_read_b64_tr_b16 a[180:181], v225 offset:49152
ds_read_b64_tr_b16 a[182:183], v225 offset:53248
v_mfma_f32_16x16x32_bf16 v[104:107], v[120:123], a[224:227], v[104:107]
v_exp_f32 v33, v33
v_mfma_f32_16x16x32_bf16 v[60:63], a[144:147], v[184:187], v[144:147]
v_cvt_pk_bf16_f32 v84, v32, v33
v_mfma_f32_16x16x32_bf16 v[60:63], a[148:151], v[188:191], v[60:63]
v_exp_f32 v34, v34
v_mfma_f32_16x16x32_bf16 v[60:63], a[152:155], v[192:195], v[60:63]
buffer_load_dwordx4 v231, s[8:11], s38 offen offset:3072 lds
v_mfma_f32_16x16x32_bf16 v[60:63], a[156:159], v[196:199], v[60:63]
v_mfma_f32_16x16x32_bf16 a[24:27], a[184:187], v[88:91], a[24:27]
v_exp_f32 v35, v35
v_mfma_f32_16x16x32_bf16 a[56:59], a[184:187], v[92:95], a[56:59]
v_cvt_pk_bf16_f32 v85, v34, v35
v_mfma_f32_16x16x32_bf16 a[88:91], a[184:187], v[96:99], a[88:91]
v_exp_f32 v36, v36
v_mfma_f32_16x16x32_bf16 a[120:123], a[184:187], v[100:103], a[120:123]
ds_read_b64_tr_b16 a[184:185], v226 offset:49152
ds_read_b64_tr_b16 a[186:187], v226 offset:53248
v_mfma_f32_16x16x32_bf16 v[108:111], v[124:127], a[224:227], v[108:111]
v_exp_f32 v37, v37
v_mfma_f32_16x16x32_bf16 v[68:71], a[144:147], v[200:203], v[148:151]
ds_read_b128 a[144:147], v216 offset:4096
v_cvt_pk_bf16_f32 v86, v36, v37
v_mfma_f32_16x16x32_bf16 v[68:71], a[148:151], v[204:207], v[68:71]
v_exp_f32 v38, v38
v_mfma_f32_16x16x32_bf16 v[68:71], a[152:155], v[208:211], v[68:71]
ds_read_b128 a[148:151], v217 offset:4096
ds_read_b128 a[152:155], v218 offset:4096
v_mfma_f32_16x16x32_bf16 v[68:71], a[156:159], v[212:215], v[68:71]
v_exp_f32 v39, v39
v_mfma_f32_16x16x32_bf16 a[28:31], a[188:191], v[88:91], a[28:31]
ds_read_b128 a[156:159], v219 offset:4096
v_cvt_pk_bf16_f32 v87, v38, v39
v_mfma_f32_16x16x32_bf16 a[60:63], a[188:191], v[92:95], a[60:63]
v_mfma_f32_16x16x32_bf16 a[92:95], a[188:191], v[96:99], a[92:95]
v_mfma_f32_16x16x32_bf16 a[124:127], a[188:191], v[100:103], a[124:127]
s_add_u32 s38, s38, 16384
ds_read_b64_tr_b16 a[188:189], v227 offset:49152
ds_read_b64_tr_b16 a[190:191], v227 offset:53248
v_mfma_f32_16x16x32_bf16 v[112:115], v[128:131], a[224:227], v[112:115]
v_mfma_f32_16x16x32_bf16 v[116:119], v[132:135], a[224:227], v[116:119]
s_waitcnt lgkmcnt(6)
v_mfma_f32_16x16x32_bf16 v[8:11], a[128:131], v[152:155], v[136:139]
v_exp_f32 v40, v40
v_mfma_f32_16x16x32_bf16 v[8:11], a[132:135], v[156:159], v[8:11]
s_add_u32 m0, s49, 4096
v_exp_f32 v41, v41
v_mfma_f32_16x16x32_bf16 v[8:11], a[136:139], v[160:163], v[8:11]
s_add_u32 s48, s91, 0
buffer_load_dwordx4 v249, s[64:67], s48 offen  lds
v_mfma_f32_16x16x32_bf16 v[8:11], a[140:143], v[164:167], v[8:11]
v_exp_f32 v42, v42
v_mfma_f32_16x16x32_bf16 a[0:3], a[160:163], v[72:75], a[0:3]
v_cvt_pk_bf16_f32 v88, v40, v41
v_add_u32 v131, s90, v223
v_mfma_f32_16x16x32_bf16 a[32:35], a[160:163], v[76:79], a[32:35]
v_exp_f32 v43, v43
v_mfma_f32_16x16x32_bf16 a[64:67], a[160:163], v[80:83], a[64:67]
v_cvt_pk_bf16_f32 v89, v42, v43
v_add_u32 v132, s90, v224
v_mfma_f32_16x16x32_bf16 a[96:99], a[160:163], v[84:87], a[96:99]
v_exp_f32 v44, v44
v_mfma_f32_16x16x32_bf16 v[16:19], a[128:131], v[168:171], v[140:143]
s_add_u32 m0, s49, 5120
ds_read_b64_tr_b16 a[160:161], v220 offset:57344
ds_read_b64_tr_b16 a[162:163], v220 offset:61440
v_mfma_f32_16x16x32_bf16 v[16:19], a[132:135], v[172:175], v[16:19]
s_add_u32 s48, s91, 4608
v_exp_f32 v45, v45
v_mfma_f32_16x16x32_bf16 v[16:19], a[136:139], v[176:179], v[16:19]
buffer_load_dwordx4 v250, s[64:67], s48 offen  lds
v_mfma_f32_16x16x32_bf16 v[16:19], a[140:143], v[180:183], v[16:19]
v_exp_f32 v46, v46
v_mfma_f32_16x16x32_bf16 a[4:7], a[164:167], v[72:75], a[4:7]
v_cvt_pk_bf16_f32 v90, v44, v45
v_add_u32 v133, s90, v225
v_mfma_f32_16x16x32_bf16 a[36:39], a[164:167], v[76:79], a[36:39]
v_exp_f32 v47, v47
v_mfma_f32_16x16x32_bf16 a[68:71], a[164:167], v[80:83], a[68:71]
v_cvt_pk_bf16_f32 v91, v46, v47
v_add_u32 v134, s90, v226
v_mfma_f32_16x16x32_bf16 a[100:103], a[164:167], v[84:87], a[100:103]
v_exp_f32 v48, v48
v_smfmac_f32_16x16x64_bf16 a[248:251], a[208:211], v[72:79], v235
s_add_u32 m0, s49, 6144
ds_read_b64_tr_b16 a[164:165], v221 offset:57344
ds_read_b64_tr_b16 a[166:167], v221 offset:61440
v_mfma_f32_16x16x32_bf16 v[24:27], a[128:131], v[184:187], v[144:147]
s_add_u32 s48, s91, 9216
v_exp_f32 v49, v49
v_mfma_f32_16x16x32_bf16 v[24:27], a[132:135], v[188:191], v[24:27]
buffer_load_dwordx4 v249, s[64:67], s48 offen  lds
v_mfma_f32_16x16x32_bf16 v[24:27], a[136:139], v[192:195], v[24:27]
v_exp_f32 v50, v50
v_mfma_f32_16x16x32_bf16 v[24:27], a[140:143], v[196:199], v[24:27]
v_cvt_pk_bf16_f32 v92, v48, v49
v_add_u32 v135, s90, v227
v_mfma_f32_16x16x32_bf16 a[8:11], a[168:171], v[72:75], a[8:11]
v_exp_f32 v51, v51
v_mfma_f32_16x16x32_bf16 a[40:43], a[168:171], v[76:79], a[40:43]
v_cvt_pk_bf16_f32 v93, v50, v51
v_mfma_f32_16x16x32_bf16 a[72:75], a[168:171], v[80:83], a[72:75]
v_exp_f32 v52, v52
v_mfma_f32_16x16x32_bf16 a[104:107], a[168:171], v[84:87], a[104:107]
s_add_u32 m0, s49, 7168
ds_read_b64_tr_b16 a[168:169], v222 offset:57344
ds_read_b64_tr_b16 a[170:171], v222 offset:61440
v_mfma_f32_16x16x32_bf16 v[32:35], a[128:131], v[200:203], v[148:151]
s_add_u32 s48, s91, 13824
v_exp_f32 v53, v53
v_mfma_f32_16x16x32_bf16 v[32:35], a[132:135], v[204:207], v[32:35]
buffer_load_dwordx4 v250, s[64:67], s48 offen  lds
v_mfma_f32_16x16x32_bf16 v[32:35], a[136:139], v[208:211], v[32:35]
v_exp_f32 v54, v54
v_mfma_f32_16x16x32_bf16 v[32:35], a[140:143], v[212:215], v[32:35]
ds_read_b128 a[128:131], v216 offset:8192
ds_read_b128 a[132:135], v217 offset:8192
v_mfma_f32_16x16x32_bf16 a[12:15], a[172:175], v[72:75], a[12:15]
v_exp_f32 v55, v55
v_mfma_f32_16x16x32_bf16 a[44:47], a[172:175], v[76:79], a[44:47]
ds_read_b128 a[136:139], v218 offset:8192
ds_read_b128 a[140:143], v219 offset:8192
v_mfma_f32_16x16x32_bf16 a[76:79], a[172:175], v[80:83], a[76:79]
v_exp_f32 v56, v56
v_mfma_f32_16x16x32_bf16 a[108:111], a[172:175], v[84:87], a[108:111]
s_waitcnt lgkmcnt(6)
v_exp_f32 v57, v57
v_mfma_f32_16x16x32_bf16 v[12:15], a[144:147], v[152:155], v[136:139]
buffer_load_dwordx2 v[252:253], v251, s[76:79], s42 offen sc1
v_mfma_f32_16x16x32_bf16 v[12:15], a[148:151], v[156:159], v[12:15]
v_exp_f32 v58, v58
v_mfma_f32_16x16x32_bf16 v[12:15], a[152:155], v[160:163], v[12:15]
ds_read_b64_tr_b16 a[172:173], v223 offset:57344
ds_read_b64_tr_b16 a[174:175], v223 offset:61440
v_mfma_f32_16x16x32_bf16 v[12:15], a[156:159], v[164:167], v[12:15]
v_exp_f32 v59, v59
v_mfma_f32_16x16x32_bf16 a[16:19], a[176:179], v[72:75], a[16:19]
v_cvt_pk_bf16_f32 v94, v52, v53
v_cvt_pk_bf16_f32 v95, v54, v55
v_mfma_f32_16x16x32_bf16 a[48:51], a[176:179], v[76:79], a[48:51]
v_exp_f32 v60, v60
v_mfma_f32_16x16x32_bf16 a[80:83], a[176:179], v[80:83], a[80:83]
s_add_u32 s42, s42, s43
buffer_load_dword v255, v243, s[28:31], s45 offen
v_mfma_f32_16x16x32_bf16 a[112:115], a[176:179], v[84:87], a[112:115]
v_exp_f32 v61, v61
v_mfma_f32_16x16x32_bf16 v[20:23], a[144:147], v[168:171], v[140:143]
ds_read_b64_tr_b16 a[176:177], v224 offset:57344
ds_read_b64_tr_b16 a[178:179], v224 offset:61440
v_mfma_f32_16x16x32_bf16 v[20:23], a[148:151], v[172:175], v[20:23]
v_exp_f32 v62, v62
v_mfma_f32_16x16x32_bf16 v[20:23], a[152:155], v[176:179], v[20:23]
v_cvt_pk_bf16_f32 v96, v56, v57
v_cvt_pk_bf16_f32 v97, v58, v59
v_mfma_f32_16x16x32_bf16 v[20:23], a[156:159], v[180:183], v[20:23]
v_exp_f32 v63, v63
v_mfma_f32_16x16x32_bf16 a[20:23], a[180:183], v[72:75], a[20:23]
v_cvt_pk_bf16_f32 v98, v60, v61
v_cvt_pk_bf16_f32 v99, v62, v63
v_mfma_f32_16x16x32_bf16 a[52:55], a[180:183], v[76:79], a[52:55]
v_exp_f32 v64, v64
v_mfma_f32_16x16x32_bf16 a[84:87], a[180:183], v[80:83], a[84:87]
s_add_u32 s45, s45, 589824
global_load_dword v255, v242, s[72:73]
v_mfma_f32_16x16x32_bf16 a[116:119], a[180:183], v[84:87], a[116:119]
v_exp_f32 v65, v65
v_smfmac_f32_16x16x64_bf16 a[252:255], a[208:211], v[80:87], v235
ds_read_b64_tr_b16 a[180:181], v225 offset:57344
ds_read_b64_tr_b16 a[182:183], v225 offset:61440
v_mfma_f32_16x16x32_bf16 v[28:31], a[144:147], v[184:187], v[144:147]
v_exp_f32 v66, v66
v_mfma_f32_16x16x32_bf16 v[28:31], a[148:151], v[188:191], v[28:31]
v_cvt_pk_bf16_f32 v100, v64, v65
v_mfma_f32_16x16x32_bf16 v[28:31], a[152:155], v[192:195], v[28:31]
v_exp_f32 v67, v67
v_mfma_f32_16x16x32_bf16 v[28:31], a[156:159], v[196:199], v[28:31]
v_cvt_pk_bf16_f32 v101, v66, v67
v_mfma_f32_16x16x32_bf16 a[24:27], a[184:187], v[72:75], a[24:27]
v_exp_f32 v68, v68
v_mfma_f32_16x16x32_bf16 a[56:59], a[184:187], v[76:79], a[56:59]
buffer_load_dword v255, v0, s[24:27], s44 offen
v_mfma_f32_16x16x32_bf16 a[88:91], a[184:187], v[80:83], a[88:91]
v_exp_f32 v69, v69
v_mfma_f32_16x16x32_bf16 a[120:123], a[184:187], v[84:87], a[120:123]
ds_read_b64_tr_b16 a[184:185], v226 offset:57344
ds_read_b64_tr_b16 a[186:187], v226 offset:61440
v_mfma_f32_16x16x32_bf16 v[36:39], a[144:147], v[200:203], v[148:151]
v_exp_f32 v70, v70
v_mfma_f32_16x16x32_bf16 v[36:39], a[148:151], v[204:207], v[36:39]
ds_read_b128 a[144:147], v216 offset:12288
ds_read_b128 a[148:151], v217 offset:12288
v_mfma_f32_16x16x32_bf16 v[36:39], a[152:155], v[208:211], v[36:39]
v_exp_f32 v71, v71
v_mfma_f32_16x16x32_bf16 v[36:39], a[156:159], v[212:215], v[36:39]
ds_read_b128 a[152:155], v218 offset:12288
ds_read_b128 a[156:159], v219 offset:12288
v_mfma_f32_16x16x32_bf16 a[28:31], a[188:191], v[72:75], a[28:31]
v_cvt_pk_bf16_f32 v102, v68, v69
v_cvt_pk_bf16_f32 v103, v70, v71
v_mfma_f32_16x16x32_bf16 a[60:63], a[188:191], v[76:79], a[60:63]
s_add_u32 s44, s44, 4096
ds_write_b128 v5, v[104:107] offset:0
v_mfma_f32_16x16x32_bf16 a[92:95], a[188:191], v[80:83], a[92:95]
ds_write_b128 v5, v[108:111] offset:1024
v_mfma_f32_16x16x32_bf16 a[124:127], a[188:191], v[84:87], a[124:127]
s_waitcnt lgkmcnt(8)
ds_read_b64_tr_b16 a[188:189], v227 offset:57344
ds_read_b64_tr_b16 a[190:191], v227 offset:61440
ds_write_b128 v5, v[112:115] offset:2048
ds_write_b128 v5, v[116:119] offset:3072
s_sub_u32 s46, s49, 0xf000
v_mfma_f32_16x16x32_bf16 v[40:43], a[128:131], v[152:155], v[136:139]
v_exp_f32 v8, v8
v_mfma_f32_16x16x32_bf16 v[40:43], a[132:135], v[156:159], v[40:43]
v_exp_f32 v9, v9
v_mfma_f32_16x16x32_bf16 v[40:43], a[136:139], v[160:163], v[40:43]
v_cvt_pk_bf16_f32 v72, v8, v9
v_add_u32 v128, s46, v220
v_mfma_f32_16x16x32_bf16 v[40:43], a[140:143], v[164:167], v[40:43]
v_exp_f32 v10, v10
v_mfma_f32_16x16x32_bf16 a[0:3], a[160:163], v[88:91], a[0:3]
v_add_u32 v129, s46, v221
v_add_u32 v130, s46, v222
v_mfma_f32_16x16x32_bf16 a[32:35], a[160:163], v[92:95], a[32:35]
v_exp_f32 v11, v11
s_waitcnt vmcnt(8) lgkmcnt(0)
s_barrier
v_mfma_f32_16x16x32_bf16 a[64:67], a[160:163], v[96:99], a[64:67]
ds_read_b128 v[104:107], v6 offset:0
v_cvt_pk_bf16_f32 v73, v10, v11
v_mfma_f32_16x16x32_bf16 a[96:99], a[160:163], v[100:103], a[96:99]
s_add_u32 m0, s37, 98304
v_exp_f32 v12, v12
v_mfma_f32_16x16x32_bf16 v[48:51], a[128:131], v[168:171], v[140:143]
buffer_load_dwordx4 v232, s[12:15], s39 offen offset:0 lds
v_mfma_f32_16x16x32_bf16 v[48:51], a[132:135], v[172:175], v[48:51]
v_exp_f32 v13, v13
v_mfma_f32_16x16x32_bf16 v[48:51], a[136:139], v[176:179], v[48:51]
ds_read_b64_tr_b16 a[160:161], v220 offset:0
ds_read_b64_tr_b16 a[162:163], v220 offset:4096
v_mfma_f32_16x16x32_bf16 v[48:51], a[140:143], v[180:183], v[48:51]
v_exp_f32 v14, v14
v_mfma_f32_16x16x32_bf16 a[4:7], a[164:167], v[88:91], a[4:7]
ds_read_b128 v[108:111], v6 offset:8192
v_cvt_pk_bf16_f32 v74, v12, v13
v_mfma_f32_16x16x32_bf16 a[36:39], a[164:167], v[92:95], a[36:39]
v_exp_f32 v15, v15
v_mfma_f32_16x16x32_bf16 a[68:71], a[164:167], v[96:99], a[68:71]
ds_read_b128 v[112:115], v6 offset:16384
v_cvt_pk_bf16_f32 v75, v14, v15
v_mfma_f32_16x16x32_bf16 a[100:103], a[164:167], v[100:103], a[100:103]
v_exp_f32 v16, v16
v_smfmac_f32_16x16x64_bf16 a[248:251], a[208:211], v[88:95], v235
buffer_load_dwordx4 v233, s[12:15], s39 offen offset:1024 lds
v_mfma_f32_16x16x32_bf16 v[56:59], a[128:131], v[184:187], v[144:147]
v_exp_f32 v17, v17
v_mfma_f32_16x16x32_bf16 v[56:59], a[132:135], v[188:191], v[56:59]
ds_read_b64_tr_b16 a[164:165], v221 offset:0
ds_read_b64_tr_b16 a[166:167], v221 offset:4096
v_mfma_f32_16x16x32_bf16 v[56:59], a[136:139], v[192:195], v[56:59]
v_exp_f32 v18, v18
v_mfma_f32_16x16x32_bf16 v[56:59], a[140:143], v[196:199], v[56:59]
ds_read_b128 v[116:119], v6 offset:24576
v_cvt_pk_bf16_f32 v76, v16, v17
v_mfma_f32_16x16x32_bf16 a[8:11], a[168:171], v[88:91], a[8:11]
v_exp_f32 v19, v19
v_mfma_f32_16x16x32_bf16 a[40:43], a[168:171], v[92:95], a[40:43]
v_cvt_pk_bf16_f32 v77, v18, v19
v_mfma_f32_16x16x32_bf16 a[72:75], a[168:171], v[96:99], a[72:75]
v_exp_f32 v20, v20
v_mfma_f32_16x16x32_bf16 a[104:107], a[168:171], v[100:103], a[104:107]
ds_read_b64_tr_b16 a[168:169], v222 offset:0
ds_read_b64_tr_b16 a[170:171], v222 offset:4096
v_mfma_f32_16x16x32_bf16 v[64:67], a[128:131], v[200:203], v[148:151]
v_exp_f32 v21, v21
v_mfma_f32_16x16x32_bf16 v[64:67], a[132:135], v[204:207], v[64:67]
buffer_load_dwordx4 v232, s[12:15], s39 offen offset:2048 lds
v_mfma_f32_16x16x32_bf16 v[64:67], a[136:139], v[208:211], v[64:67]
v_exp_f32 v22, v22
v_mfma_f32_16x16x32_bf16 v[64:67], a[140:143], v[212:215], v[64:67]
ds_read_b128 a[128:131], v216 offset:49152
ds_read_b128 a[132:135], v217 offset:49152
v_mfma_f32_16x16x32_bf16 a[12:15], a[172:175], v[88:91], a[12:15]
v_exp_f32 v23, v23
v_mfma_f32_16x16x32_bf16 a[44:47], a[172:175], v[92:95], a[44:47]
ds_read_b128 a[136:139], v218 offset:49152
ds_read_b128 a[140:143], v219 offset:49152
v_mfma_f32_16x16x32_bf16 a[76:79], a[172:175], v[96:99], a[76:79]
v_exp_f32 v24, v24
v_mfma_f32_16x16x32_bf16 a[108:111], a[172:175], v[100:103], a[108:111]
v_exp_f32 v25, v25
v_mfma_f32_16x16x32_bf16 v[44:47], a[144:147], v[152:155], v[136:139]
ds_read_b64_tr_b16 a[172:173], v223 offset:0
ds_read_b64_tr_b16 a[174:175], v223 offset:4096
v_mfma_f32_16x16x32_bf16 v[44:47], a[148:151], v[156:159], v[44:47]
v_exp_f32 v26, v26
v_mfma_f32_16x16x32_bf16 v[44:47], a[152:155], v[160:163], v[44:47]
buffer_load_dwordx4 v233, s[12:15], s39 offen offset:3072 lds
v_mfma_f32_16x16x32_bf16 v[44:47], a[156:159], v[164:167], v[44:47]
v_exp_f32 v27, v27
v_mfma_f32_16x16x32_bf16 a[16:19], a[176:179], v[88:91], a[16:19]
v_cvt_pk_bf16_f32 v78, v20, v21
v_cvt_pk_bf16_f32 v79, v22, v23
v_mfma_f32_16x16x32_bf16 a[48:51], a[176:179], v[92:95], a[48:51]
v_exp_f32 v28, v28
v_mfma_f32_16x16x32_bf16 a[80:83], a[176:179], v[96:99], a[80:83]
v_cvt_pk_bf16_f32 v80, v24, v25
v_cvt_pk_bf16_f32 v81, v26, v27
v_mfma_f32_16x16x32_bf16 a[112:115], a[176:179], v[100:103], a[112:115]
v_exp_f32 v29, v29
v_mfma_f32_16x16x32_bf16 v[52:55], a[144:147], v[168:171], v[140:143]
ds_read_b64_tr_b16 a[176:177], v224 offset:0
ds_read_b64_tr_b16 a[178:179], v224 offset:4096
v_mfma_f32_16x16x32_bf16 v[52:55], a[148:151], v[172:175], v[52:55]
v_exp_f32 v30, v30
v_mfma_f32_16x16x32_bf16 v[52:55], a[152:155], v[176:179], v[52:55]
v_cvt_pk_bf16_f32 v82, v28, v29
s_waitcnt lgkmcnt(2)
v_add_f32 v104, v104, v108
v_mfma_f32_16x16x32_bf16 v[52:55], a[156:159], v[180:183], v[52:55]
s_add_u32 s39, s39, 16384
v_exp_f32 v31, v31
v_mfma_f32_16x16x32_bf16 a[20:23], a[180:183], v[88:91], a[20:23]
s_add_u32 m0, s37, 16384
v_cvt_pk_bf16_f32 v83, v30, v31
v_add_f32 v112, v112, v116
v_mfma_f32_16x16x32_bf16 a[52:55], a[180:183], v[92:95], a[52:55]
v_exp_f32 v32, v32
v_mfma_f32_16x16x32_bf16 a[84:87], a[180:183], v[96:99], a[84:87]
buffer_load_dwordx4 v228, s[8:11], s38 offen offset:0 lds
v_mfma_f32_16x16x32_bf16 a[116:119], a[180:183], v[100:103], a[116:119]
v_exp_f32 v33, v33
v_smfmac_f32_16x16x64_bf16 a[252:255], a[208:211], v[96:103], v235
ds_read_b64_tr_b16 a[180:181], v225 offset:0
ds_read_b64_tr_b16 a[182:183], v225 offset:4096
v_mfma_f32_16x16x32_bf16 v[60:63], a[144:147], v[184:187], v[144:147]
v_exp_f32 v34, v34
v_mfma_f32_16x16x32_bf16 v[60:63], a[148:151], v[188:191], v[60:63]
v_cvt_pk_bf16_f32 v84, v32, v33
v_add_f32 v105, v105, v109
v_mfma_f32_16x16x32_bf16 v[60:63], a[152:155], v[192:195], v[60:63]
v_exp_f32 v35, v35
v_mfma_f32_16x16x32_bf16 v[60:63], a[156:159], v[196:199], v[60:63]
buffer_load_dwordx4 v229, s[8:11], s38 offen offset:1024 lds
v_mfma_f32_16x16x32_bf16 a[24:27], a[184:187], v[88:91], a[24:27]
v_exp_f32 v36, v36
v_mfma_f32_16x16x32_bf16 a[56:59], a[184:187], v[92:95], a[56:59]
v_cvt_pk_bf16_f32 v85, v34, v35
v_add_f32 v113, v113, v117
v_mfma_f32_16x16x32_bf16 a[88:91], a[184:187], v[96:99], a[88:91]
v_exp_f32 v37, v37
v_mfma_f32_16x16x32_bf16 a[120:123], a[184:187], v[100:103], a[120:123]
ds_read_b64_tr_b16 a[184:185], v226 offset:0
ds_read_b64_tr_b16 a[186:187], v226 offset:4096
v_mfma_f32_16x16x32_bf16 v[68:71], a[144:147], v[200:203], v[148:151]
v_exp_f32 v38, v38
v_mfma_f32_16x16x32_bf16 v[68:71], a[148:151], v[204:207], v[68:71]
ds_read_b128 a[144:147], v216 offset:53248
ds_read_b128 a[148:151], v217 offset:53248
v_mfma_f32_16x16x32_bf16 v[68:71], a[152:155], v[208:211], v[68:71]
v_exp_f32 v39, v39
v_mfma_f32_16x16x32_bf16 v[68:71], a[156:159], v[212:215], v[68:71]
ds_read_b128 a[152:155], v218 offset:53248
ds_read_b128 a[156:159], v219 offset:53248
v_mfma_f32_16x16x32_bf16 a[28:31], a[188:191], v[88:91], a[28:31]
v_cvt_pk_bf16_f32 v86, v36, v37
v_cvt_pk_bf16_f32 v87, v38, v39
v_mfma_f32_16x16x32_bf16 a[60:63], a[188:191], v[92:95], a[60:63]
v_add_f32 v106, v106, v110
v_add_f32 v114, v114, v118
v_mfma_f32_16x16x32_bf16 a[92:95], a[188:191], v[96:99], a[92:95]
v_add_f32 v107, v107, v111
v_add_f32 v115, v115, v119
v_mfma_f32_16x16x32_bf16 a[124:127], a[188:191], v[100:103], a[124:127]
ds_read_b64_tr_b16 a[188:189], v227 offset:0
ds_read_b64_tr_b16 a[190:191], v227 offset:4096
v_mfma_f32_16x16x32_bf16 v[8:11], a[128:131], v[152:155], v[136:139]
v_exp_f32 v40, v40
v_mfma_f32_16x16x32_bf16 v[8:11], a[132:135], v[156:159], v[8:11]
v_exp_f32 v41, v41
v_mfma_f32_16x16x32_bf16 v[8:11], a[136:139], v[160:163], v[8:11]
buffer_load_dwordx4 v230, s[8:11], s38 offen offset:2048 lds
v_mfma_f32_16x16x32_bf16 v[8:11], a[140:143], v[164:167], v[8:11]
v_exp_f32 v42, v42
v_mfma_f32_16x16x32_bf16 a[0:3], a[160:163], v[72:75], a[0:3]
v_cvt_pk_bf16_f32 v88, v40, v41
v_add_f32 v104, v104, v112
v_mfma_f32_16x16x32_bf16 a[32:35], a[160:163], v[76:79], a[32:35]
v_exp_f32 v43, v43
v_mfma_f32_16x16x32_bf16 a[64:67], a[160:163], v[80:83], a[64:67]
v_cvt_pk_bf16_f32 v89, v42, v43
v_add_f32 v105, v105, v113
v_mfma_f32_16x16x32_bf16 a[96:99], a[160:163], v[84:87], a[96:99]
v_exp_f32 v44, v44
v_mfma_f32_16x16x32_bf16 v[16:19], a[128:131], v[168:171], v[140:143]
ds_read_b64_tr_b16 a[160:161], v220 offset:8192
ds_read_b64_tr_b16 a[162:163], v220 offset:12288
v_mfma_f32_16x16x32_bf16 v[16:19], a[132:135], v[172:175], v[16:19]
v_exp_f32 v45, v45
v_mfma_f32_16x16x32_bf16 v[16:19], a[136:139], v[176:179], v[16:19]
v_cvt_pk_bf16_f32 v90, v44, v45
v_add_f32 v106, v106, v114
v_mfma_f32_16x16x32_bf16 v[16:19], a[140:143], v[180:183], v[16:19]
v_exp_f32 v46, v46
v_mfma_f32_16x16x32_bf16 a[4:7], a[164:167], v[72:75], a[4:7]
v_add_f32 v107, v107, v115
v_cvt_pk_bf16_f32 v244, v104, v105
v_mfma_f32_16x16x32_bf16 a[36:39], a[164:167], v[76:79], a[36:39]
v_exp_f32 v47, v47
v_mfma_f32_16x16x32_bf16 a[68:71], a[164:167], v[80:83], a[68:71]
buffer_load_dwordx4 v231, s[8:11], s38 offen offset:3072 lds
v_mfma_f32_16x16x32_bf16 a[100:103], a[164:167], v[84:87], a[100:103]
v_exp_f32 v48, v48
v_smfmac_f32_16x16x64_bf16 a[248:251], a[208:211], v[72:79], v235
ds_read_b64_tr_b16 a[164:165], v221 offset:8192
ds_read_b64_tr_b16 a[166:167], v221 offset:12288
v_mfma_f32_16x16x32_bf16 v[24:27], a[128:131], v[184:187], v[144:147]
v_exp_f32 v49, v49
v_mfma_f32_16x16x32_bf16 v[24:27], a[132:135], v[188:191], v[24:27]
v_cvt_pk_bf16_f32 v91, v46, v47
v_cvt_pk_bf16_f32 v92, v48, v49
v_mfma_f32_16x16x32_bf16 v[24:27], a[136:139], v[192:195], v[24:27]
v_exp_f32 v50, v50
v_mfma_f32_16x16x32_bf16 v[24:27], a[140:143], v[196:199], v[24:27]
v_cvt_pk_bf16_f32 v245, v106, v107
v_lshlrev_b32 v104, 16, v244
v_mfma_f32_16x16x32_bf16 a[8:11], a[168:171], v[72:75], a[8:11]
v_exp_f32 v51, v51
v_mfma_f32_16x16x32_bf16 a[40:43], a[168:171], v[76:79], a[40:43]
v_cvt_pk_bf16_f32 v93, v50, v51
v_and_b32 v105, 0xffff0000, v244
v_mfma_f32_16x16x32_bf16 a[72:75], a[168:171], v[80:83], a[72:75]
v_exp_f32 v52, v52
v_mfma_f32_16x16x32_bf16 a[104:107], a[168:171], v[84:87], a[104:107]
ds_read_b64_tr_b16 a[168:169], v222 offset:8192
ds_read_b64_tr_b16 a[170:171], v222 offset:12288
v_mfma_f32_16x16x32_bf16 v[32:35], a[128:131], v[200:203], v[148:151]
s_add_u32 s38, s38, 16384
v_exp_f32 v53, v53
v_mfma_f32_16x16x32_bf16 v[32:35], a[132:135], v[204:207], v[32:35]
s_add_u32 m0, s37, 114688
ds_read_b128 a[128:131], v216 offset:57344
ds_read_b128 a[132:135], v217 offset:57344
v_mfma_f32_16x16x32_bf16 v[32:35], a[136:139], v[208:211], v[32:35]
v_exp_f32 v54, v54
v_mfma_f32_16x16x32_bf16 v[32:35], a[140:143], v[212:215], v[32:35]
buffer_load_dwordx4 v232, s[12:15], s39 offen offset:0 lds
v_mfma_f32_16x16x32_bf16 a[12:15], a[172:175], v[72:75], a[12:15]
v_exp_f32 v55, v55
v_mfma_f32_16x16x32_bf16 a[44:47], a[172:175], v[76:79], a[44:47]
ds_read_b128 a[136:139], v218 offset:57344
ds_read_b128 a[140:143], v219 offset:57344
v_mfma_f32_16x16x32_bf16 a[76:79], a[172:175], v[80:83], a[76:79]
v_exp_f32 v56, v56
v_mfma_f32_16x16x32_bf16 a[108:111], a[172:175], v[84:87], a[108:111]
s_waitcnt lgkmcnt(6)
v_exp_f32 v57, v57
v_mfma_f32_16x16x32_bf16 v[12:15], a[144:147], v[152:155], v[136:139]
ds_read_b64_tr_b16 a[172:173], v223 offset:8192
ds_read_b64_tr_b16 a[174:175], v223 offset:12288
v_mfma_f32_16x16x32_bf16 v[12:15], a[148:151], v[156:159], v[12:15]
v_exp_f32 v58, v58
v_mfma_f32_16x16x32_bf16 v[12:15], a[152:155], v[160:163], v[12:15]
v_cvt_pk_bf16_f32 v94, v52, v53
v_cvt_pk_bf16_f32 v95, v54, v55
v_mfma_f32_16x16x32_bf16 v[12:15], a[156:159], v[164:167], v[12:15]
v_exp_f32 v59, v59
v_mfma_f32_16x16x32_bf16 a[16:19], a[176:179], v[72:75], a[16:19]
v_cvt_pk_bf16_f32 v96, v56, v57
v_cvt_pk_bf16_f32 v97, v58, v59
v_mfma_f32_16x16x32_bf16 a[48:51], a[176:179], v[76:79], a[48:51]
v_exp_f32 v60, v60
v_mfma_f32_16x16x32_bf16 a[80:83], a[176:179], v[80:83], a[80:83]
buffer_load_dwordx4 v233, s[12:15], s39 offen offset:1024 lds
v_mfma_f32_16x16x32_bf16 a[112:115], a[176:179], v[84:87], a[112:115]
v_exp_f32 v61, v61
v_mfma_f32_16x16x32_bf16 v[20:23], a[144:147], v[168:171], v[140:143]
ds_read_b64_tr_b16 a[176:177], v224 offset:8192
ds_read_b64_tr_b16 a[178:179], v224 offset:12288
v_mfma_f32_16x16x32_bf16 v[20:23], a[148:151], v[172:175], v[20:23]
v_exp_f32 v62, v62
v_mfma_f32_16x16x32_bf16 v[20:23], a[152:155], v[176:179], v[20:23]
v_cvt_pk_bf16_f32 v98, v60, v61
v_lshlrev_b32 v106, 16, v245
v_mfma_f32_16x16x32_bf16 v[20:23], a[156:159], v[180:183], v[20:23]
v_exp_f32 v63, v63
v_mfma_f32_16x16x32_bf16 a[20:23], a[180:183], v[72:75], a[20:23]
v_cvt_pk_bf16_f32 v99, v62, v63
v_and_b32 v107, 0xffff0000, v245
v_mfma_f32_16x16x32_bf16 a[52:55], a[180:183], v[76:79], a[52:55]
v_exp_f32 v64, v64
v_mfma_f32_16x16x32_bf16 a[84:87], a[180:183], v[80:83], a[84:87]
v_mul_f32 v120, 0xbfb8aa3b, v104
v_mul_f32 v121, 0xbfb8aa3b, v105
v_mfma_f32_16x16x32_bf16 a[116:119], a[180:183], v[84:87], a[116:119]
v_exp_f32 v65, v65
v_smfmac_f32_16x16x64_bf16 a[252:255], a[208:211], v[80:87], v235
ds_read_b64_tr_b16 a[180:181], v225 offset:8192
ds_read_b64_tr_b16 a[182:183], v225 offset:12288
v_mfma_f32_16x16x32_bf16 v[28:31], a[144:147], v[184:187], v[144:147]
v_exp_f32 v66, v66
v_mfma_f32_16x16x32_bf16 v[28:31], a[148:151], v[188:191], v[28:31]
buffer_load_dwordx4 v232, s[12:15], s39 offen offset:2048 lds
v_mfma_f32_16x16x32_bf16 v[28:31], a[152:155], v[192:195], v[28:31]
v_exp_f32 v67, v67
v_mfma_f32_16x16x32_bf16 v[28:31], a[156:159], v[196:199], v[28:31]
v_cvt_pk_bf16_f32 v100, v64, v65
v_cvt_pk_bf16_f32 v101, v66, v67
v_mfma_f32_16x16x32_bf16 a[24:27], a[184:187], v[72:75], a[24:27]
v_exp_f32 v68, v68
v_mfma_f32_16x16x32_bf16 a[56:59], a[184:187], v[76:79], a[56:59]
v_mul_f32 v122, 0xbfb8aa3b, v106
v_mul_f32 v123, 0xbfb8aa3b, v107
v_mfma_f32_16x16x32_bf16 a[88:91], a[184:187], v[80:83], a[88:91]
v_exp_f32 v69, v69
v_mfma_f32_16x16x32_bf16 a[120:123], a[184:187], v[84:87], a[120:123]
ds_read_b64_tr_b16 a[184:185], v226 offset:8192
ds_read_b64_tr_b16 a[186:187], v226 offset:12288
v_mfma_f32_16x16x32_bf16 v[36:39], a[144:147], v[200:203], v[148:151]
v_exp_f32 v70, v70
v_mfma_f32_16x16x32_bf16 v[36:39], a[148:151], v[204:207], v[36:39]
ds_read_b128 a[144:147], v216 offset:61440
ds_read_b128 a[148:151], v217 offset:61440
v_mfma_f32_16x16x32_bf16 v[36:39], a[152:155], v[208:211], v[36:39]
v_exp_f32 v71, v71
v_mfma_f32_16x16x32_bf16 v[36:39], a[156:159], v[212:215], v[36:39]
ds_read_b128 a[152:155], v218 offset:61440
ds_read_b128 a[156:159], v219 offset:61440
v_mfma_f32_16x16x32_bf16 a[28:31], a[188:191], v[72:75], a[28:31]
v_cvt_pk_bf16_f32 v102, v68, v69
v_cvt_pk_bf16_f32 v103, v70, v71
v_mfma_f32_16x16x32_bf16 a[60:63], a[188:191], v[76:79], a[60:63]
v_exp_f32 v120, v120
v_mfma_f32_16x16x32_bf16 a[92:95], a[188:191], v[80:83], a[92:95]
v_exp_f32 v121, v121
v_mfma_f32_16x16x32_bf16 a[124:127], a[188:191], v[84:87], a[124:127]
s_waitcnt lgkmcnt(6)
ds_read_b64_tr_b16 a[188:189], v227 offset:8192
ds_read_b64_tr_b16 a[190:191], v227 offset:12288
v_mfma_f32_16x16x32_bf16 v[40:43], a[128:131], v[152:155], v[136:139]
v_exp_f32 v8, v8
v_mfma_f32_16x16x32_bf16 v[40:43], a[132:135], v[156:159], v[40:43]
v_exp_f32 v9, v9
v_mfma_f32_16x16x32_bf16 v[40:43], a[136:139], v[160:163], v[40:43]
buffer_load_dwordx4 v233, s[12:15], s39 offen offset:3072 lds
v_mfma_f32_16x16x32_bf16 v[40:43], a[140:143], v[164:167], v[40:43]
v_exp_f32 v10, v10
v_mfma_f32_16x16x32_bf16 a[0:3], a[160:163], v[88:91], a[0:3]
s_waitcnt vmcnt(16)
ds_read_b64_tr_b16 a[192:193], v128
v_cvt_pk_bf16_f32 v72, v8, v9
v_mfma_f32_16x16x32_bf16 a[32:35], a[160:163], v[92:95], a[32:35]
v_exp_f32 v11, v11
v_mfma_f32_16x16x32_bf16 a[64:67], a[160:163], v[96:99], a[64:67]
ds_read_b64_tr_b16 a[196:197], v129
v_cvt_pk_bf16_f32 v73, v10, v11
v_mfma_f32_16x16x32_bf16 a[96:99], a[160:163], v[100:103], a[96:99]
v_exp_f32 v12, v12
v_mfma_f32_16x16x32_bf16 v[48:51], a[128:131], v[168:171], v[140:143]
ds_read_b64_tr_b16 a[160:161], v220 offset:16384
ds_read_b64_tr_b16 a[162:163], v220 offset:20480
v_mfma_f32_16x16x32_bf16 v[48:51], a[132:135], v[172:175], v[48:51]
v_exp_f32 v13, v13
v_mfma_f32_16x16x32_bf16 v[48:51], a[136:139], v[176:179], v[48:51]
ds_read_b64_tr_b16 a[200:201], v130
v_cvt_pk_bf16_f32 v74, v12, v13
v_mfma_f32_16x16x32_bf16 v[48:51], a[140:143], v[180:183], v[48:51]
v_exp_f32 v14, v14
v_mfma_f32_16x16x32_bf16 a[4:7], a[164:167], v[88:91], a[4:7]
v_exp_f32 v122, v122
v_mfma_f32_16x16x32_bf16 a[36:39], a[164:167], v[92:95], a[36:39]
s_add_u32 s39, s39, 16384
v_exp_f32 v15, v15
v_mfma_f32_16x16x32_bf16 a[68:71], a[164:167], v[96:99], a[68:71]
s_add_u32 m0, s37, 0
ds_read_b64_tr_b16 a[204:205], v131
v_cvt_pk_bf16_f32 v75, v14, v15
v_mfma_f32_16x16x32_bf16 a[100:103], a[164:167], v[100:103], a[100:103]
v_exp_f32 v16, v16
v_smfmac_f32_16x16x64_bf16 a[248:251], a[208:211], v[88:95], v235
buffer_load_dwordx4 v228, s[8:11], s38 offen offset:0 lds
v_mfma_f32_16x16x32_bf16 v[56:59], a[128:131], v[184:187], v[144:147]
v_exp_f32 v17, v17
v_mfma_f32_16x16x32_bf16 v[56:59], a[132:135], v[188:191], v[56:59]
ds_read_b64_tr_b16 a[164:165], v221 offset:16384
ds_read_b64_tr_b16 a[166:167], v221 offset:20480
v_mfma_f32_16x16x32_bf16 v[56:59], a[136:139], v[192:195], v[56:59]
v_exp_f32 v18, v18
v_mfma_f32_16x16x32_bf16 v[56:59], a[140:143], v[196:199], v[56:59]
v_cvt_pk_bf16_f32 v76, v16, v17
v_mfma_f32_16x16x32_bf16 a[8:11], a[168:171], v[88:91], a[8:11]
v_exp_f32 v19, v19
v_mfma_f32_16x16x32_bf16 a[40:43], a[168:171], v[92:95], a[40:43]
v_cvt_pk_bf16_f32 v77, v18, v19
v_mfma_f32_16x16x32_bf16 a[72:75], a[168:171], v[96:99], a[72:75]
v_exp_f32 v20, v20
v_mfma_f32_16x16x32_bf16 a[104:107], a[168:171], v[100:103], a[104:107]
ds_read_b64_tr_b16 a[168:169], v222 offset:16384
ds_read_b64_tr_b16 a[170:171], v222 offset:20480
v_mfma_f32_16x16x32_bf16 v[64:67], a[128:131], v[200:203], v[148:151]
v_exp_f32 v21, v21
v_mfma_f32_16x16x32_bf16 v[64:67], a[132:135], v[204:207], v[64:67]
buffer_load_dwordx4 v229, s[8:11], s38 offen offset:1024 lds
v_mfma_f32_16x16x32_bf16 v[64:67], a[136:139], v[208:211], v[64:67]
v_exp_f32 v22, v22
v_mfma_f32_16x16x32_bf16 v[64:67], a[140:143], v[212:215], v[64:67]
ds_read_b128 a[128:131], v216 offset:32768
ds_read_b128 a[132:135], v217 offset:32768
v_mfma_f32_16x16x32_bf16 a[12:15], a[172:175], v[88:91], a[12:15]
v_exp_f32 v23, v23
v_mfma_f32_16x16x32_bf16 a[44:47], a[172:175], v[92:95], a[44:47]
ds_read_b128 a[136:139], v218 offset:32768
ds_read_b128 a[140:143], v219 offset:32768
v_mfma_f32_16x16x32_bf16 a[76:79], a[172:175], v[96:99], a[76:79]
v_exp_f32 v24, v24
v_mfma_f32_16x16x32_bf16 a[108:111], a[172:175], v[100:103], a[108:111]
s_waitcnt lgkmcnt(6)
v_exp_f32 v25, v25
v_mfma_f32_16x16x32_bf16 v[44:47], a[144:147], v[152:155], v[136:139]
ds_read_b64_tr_b16 a[172:173], v223 offset:16384
ds_read_b64_tr_b16 a[174:175], v223 offset:20480
v_mfma_f32_16x16x32_bf16 v[44:47], a[148:151], v[156:159], v[44:47]
v_exp_f32 v26, v26
v_mfma_f32_16x16x32_bf16 v[44:47], a[152:155], v[160:163], v[44:47]
v_cvt_pk_bf16_f32 v78, v20, v21
v_cvt_pk_bf16_f32 v79, v22, v23
v_mfma_f32_16x16x32_bf16 v[44:47], a[156:159], v[164:167], v[44:47]
v_exp_f32 v27, v27
v_mfma_f32_16x16x32_bf16 a[16:19], a[176:179], v[88:91], a[16:19]
v_cvt_pk_bf16_f32 v80, v24, v25
v_cvt_pk_bf16_f32 v81, v26, v27
v_mfma_f32_16x16x32_bf16 a[48:51], a[176:179], v[92:95], a[48:51]
v_exp_f32 v28, v28
v_mfma_f32_16x16x32_bf16 a[80:83], a[176:179], v[96:99], a[80:83]
buffer_load_dwordx4 v230, s[8:11], s38 offen offset:2048 lds
v_mfma_f32_16x16x32_bf16 a[112:115], a[176:179], v[100:103], a[112:115]
v_exp_f32 v29, v29
v_mfma_f32_16x16x32_bf16 v[52:55], a[144:147], v[168:171], v[140:143]
ds_read_b64_tr_b16 a[176:177], v224 offset:16384
ds_read_b64_tr_b16 a[178:179], v224 offset:20480
v_mfma_f32_16x16x32_bf16 v[52:55], a[148:151], v[172:175], v[52:55]
v_exp_f32 v30, v30
v_mfma_f32_16x16x32_bf16 v[52:55], a[152:155], v[176:179], v[52:55]
v_cvt_pk_bf16_f32 v82, v28, v29
v_mfma_f32_16x16x32_bf16 v[52:55], a[156:159], v[180:183], v[52:55]
v_exp_f32 v31, v31
v_mfma_f32_16x16x32_bf16 a[20:23], a[180:183], v[88:91], a[20:23]
v_cvt_pk_bf16_f32 v83, v30, v31
v_mfma_f32_16x16x32_bf16 a[52:55], a[180:183], v[92:95], a[52:55]
v_exp_f32 v32, v32
v_mfma_f32_16x16x32_bf16 a[84:87], a[180:183], v[96:99], a[84:87]
v_exp_f32 v123, v123
v_mfma_f32_16x16x32_bf16 a[116:119], a[180:183], v[100:103], a[116:119]
v_exp_f32 v33, v33
v_smfmac_f32_16x16x64_bf16 a[252:255], a[208:211], v[96:103], v235
ds_read_b64_tr_b16 a[180:181], v225 offset:16384
ds_read_b64_tr_b16 a[182:183], v225 offset:20480
v_mfma_f32_16x16x32_bf16 v[60:63], a[144:147], v[184:187], v[144:147]
v_exp_f32 v34, v34
v_mfma_f32_16x16x32_bf16 v[60:63], a[148:151], v[188:191], v[60:63]
buffer_load_dwordx4 v231, s[8:11], s38 offen offset:3072 lds
v_mfma_f32_16x16x32_bf16 v[60:63], a[152:155], v[192:195], v[60:63]
v_exp_f32 v35, v35
v_mfma_f32_16x16x32_bf16 v[60:63], a[156:159], v[196:199], v[60:63]
v_cvt_pk_bf16_f32 v84, v32, v33
v_cvt_pk_bf16_f32 v85, v34, v35
v_mfma_f32_16x16x32_bf16 a[24:27], a[184:187], v[88:91], a[24:27]
v_exp_f32 v36, v36
v_mfma_f32_16x16x32_bf16 a[56:59], a[184:187], v[92:95], a[56:59]
v_add_f32 v120, 1.0, v120
v_add_f32 v121, 1.0, v121
v_mfma_f32_16x16x32_bf16 a[88:91], a[184:187], v[96:99], a[88:91]
v_exp_f32 v37, v37
v_mfma_f32_16x16x32_bf16 a[120:123], a[184:187], v[100:103], a[120:123]
ds_read_b64_tr_b16 a[184:185], v226 offset:16384
ds_read_b64_tr_b16 a[186:187], v226 offset:20480
v_mfma_f32_16x16x32_bf16 v[68:71], a[144:147], v[200:203], v[148:151]
v_exp_f32 v38, v38
v_mfma_f32_16x16x32_bf16 v[68:71], a[148:151], v[204:207], v[68:71]
ds_read_b128 a[144:147], v216 offset:36864
ds_read_b128 a[148:151], v217 offset:36864
v_mfma_f32_16x16x32_bf16 v[68:71], a[152:155], v[208:211], v[68:71]
v_exp_f32 v39, v39
v_mfma_f32_16x16x32_bf16 v[68:71], a[156:159], v[212:215], v[68:71]
ds_read_b128 a[152:155], v218 offset:36864
ds_read_b128 a[156:159], v219 offset:36864
v_mfma_f32_16x16x32_bf16 a[28:31], a[188:191], v[88:91], a[28:31]
v_cvt_pk_bf16_f32 v86, v36, v37
v_cvt_pk_bf16_f32 v87, v38, v39
v_mfma_f32_16x16x32_bf16 a[60:63], a[188:191], v[92:95], a[60:63]
s_add_u32 s38, s38, 16384
v_add_f32 v122, 1.0, v122
v_add_f32 v123, 1.0, v123
v_mfma_f32_16x16x32_bf16 a[92:95], a[188:191], v[96:99], a[92:95]
v_rcp_f32 v120, v120
v_mfma_f32_16x16x32_bf16 a[124:127], a[188:191], v[100:103], a[124:127]
s_waitcnt lgkmcnt(6)
ds_read_b64_tr_b16 a[188:189], v227 offset:16384
ds_read_b64_tr_b16 a[190:191], v227 offset:20480
v_rcp_f32 v121, v121
v_rcp_f32 v122, v122
v_mfma_f32_16x16x32_bf16 v[8:11], a[128:131], v[152:155], v[136:139]
v_exp_f32 v40, v40
v_mfma_f32_16x16x32_bf16 v[8:11], a[132:135], v[156:159], v[8:11]
v_exp_f32 v41, v41
v_mfma_f32_16x16x32_bf16 v[8:11], a[136:139], v[160:163], v[8:11]
buffer_load_dwordx2 v[252:253], v251, s[76:79], s42 offen sc1
v_mfma_f32_16x16x32_bf16 v[8:11], a[140:143], v[164:167], v[8:11]
v_exp_f32 v42, v42
v_mfma_f32_16x16x32_bf16 a[0:3], a[160:163], v[72:75], a[0:3]
ds_read_b64_tr_b16 a[212:213], v132
v_cvt_pk_bf16_f32 v88, v40, v41
v_mfma_f32_16x16x32_bf16 a[32:35], a[160:163], v[76:79], a[32:35]
v_exp_f32 v43, v43
v_mfma_f32_16x16x32_bf16 a[64:67], a[160:163], v[80:83], a[64:67]
ds_read_b64_tr_b16 a[216:217], v133
v_cvt_pk_bf16_f32 v89, v42, v43
v_mfma_f32_16x16x32_bf16 a[96:99], a[160:163], v[84:87], a[96:99]
v_exp_f32 v44, v44
v_mfma_f32_16x16x32_bf16 v[16:19], a[128:131], v[168:171], v[140:143]
ds_read_b64_tr_b16 a[160:161], v220 offset:24576
ds_read_b64_tr_b16 a[162:163], v220 offset:28672
v_mfma_f32_16x16x32_bf16 v[16:19], a[132:135], v[172:175], v[16:19]
v_exp_f32 v45, v45
v_mfma_f32_16x16x32_bf16 v[16:19], a[136:139], v[176:179], v[16:19]
ds_read_b64_tr_b16 a[220:221], v134
v_cvt_pk_bf16_f32 v90, v44, v45
v_mfma_f32_16x16x32_bf16 v[16:19], a[140:143], v[180:183], v[16:19]
v_exp_f32 v46, v46
v_mfma_f32_16x16x32_bf16 a[4:7], a[164:167], v[72:75], a[4:7]
v_rcp_f32 v123, v123
v_mfma_f32_16x16x32_bf16 a[36:39], a[164:167], v[76:79], a[36:39]
v_exp_f32 v47, v47
v_mfma_f32_16x16x32_bf16 a[68:71], a[164:167], v[80:83], a[68:71]
v_cvt_pk_bf16_f32 v91, v46, v47
v_mul_f32 v104, v104, v120
v_mfma_f32_16x16x32_bf16 a[100:103], a[164:167], v[84:87], a[100:103]
v_exp_f32 v48, v48
v_smfmac_f32_16x16x64_bf16 a[248:251], a[208:211], v[72:79], v235
s_add_u32 s42, s42, s43
buffer_load_dword v255, v243, s[28:31], s45 offen
v_mfma_f32_16x16x32_bf16 v[24:27], a[128:131], v[184:187], v[144:147]
v_exp_f32 v49, v49
v_mfma_f32_16x16x32_bf16 v[24:27], a[132:135], v[188:191], v[24:27]
ds_read_b64_tr_b16 a[164:165], v221 offset:24576
ds_read_b64_tr_b16 a[166:167], v221 offset:28672
v_mfma_f32_16x16x32_bf16 v[24:27], a[136:139], v[192:195], v[24:27]
v_exp_f32 v50, v50
v_mfma_f32_16x16x32_bf16 v[24:27], a[140:143], v[196:199], v[24:27]
v_cvt_pk_bf16_f32 v92, v48, v49
v_mul_f32 v105, v105, v121
v_mfma_f32_16x16x32_bf16 a[8:11], a[168:171], v[72:75], a[8:11]
v_exp_f32 v51, v51
v_mfma_f32_16x16x32_bf16 a[40:43], a[168:171], v[76:79], a[40:43]
v_cvt_pk_bf16_f32 v93, v50, v51
v_mul_f32 v106, v106, v122
v_mfma_f32_16x16x32_bf16 a[72:75], a[168:171], v[80:83], a[72:75]
v_exp_f32 v52, v52
v_mfma_f32_16x16x32_bf16 a[104:107], a[168:171], v[84:87], a[104:107]
ds_read_b64_tr_b16 a[168:169], v222 offset:24576
ds_read_b64_tr_b16 a[170:171], v222 offset:28672
v_mfma_f32_16x16x32_bf16 v[32:35], a[128:131], v[200:203], v[148:151]
v_exp_f32 v53, v53
v_mfma_f32_16x16x32_bf16 v[32:35], a[132:135], v[204:207], v[32:35]
ds_read_b128 a[128:131], v216 offset:40960
ds_read_b128 a[132:135], v217 offset:40960
v_mfma_f32_16x16x32_bf16 v[32:35], a[136:139], v[208:211], v[32:35]
v_exp_f32 v54, v54
v_mfma_f32_16x16x32_bf16 v[32:35], a[140:143], v[212:215], v[32:35]
ds_read_b128 a[136:139], v218 offset:40960
ds_read_b128 a[140:143], v219 offset:40960
v_mfma_f32_16x16x32_bf16 a[12:15], a[172:175], v[72:75], a[12:15]
v_exp_f32 v55, v55
v_mfma_f32_16x16x32_bf16 a[44:47], a[172:175], v[76:79], a[44:47]
v_cvt_pk_bf16_f32 v94, v52, v53
v_cvt_pk_bf16_f32 v95, v54, v55
v_mfma_f32_16x16x32_bf16 a[76:79], a[172:175], v[80:83], a[76:79]
s_waitcnt lgkmcnt(6)
v_exp_f32 v56, v56
v_mfma_f32_16x16x32_bf16 a[108:111], a[172:175], v[84:87], a[108:111]
s_add_u32 s45, s45, 589824
v_exp_f32 v57, v57
v_mfma_f32_16x16x32_bf16 v[12:15], a[144:147], v[152:155], v[136:139]
global_load_dword v255, v242, s[72:73]
v_mfma_f32_16x16x32_bf16 v[12:15], a[148:151], v[156:159], v[12:15]
v_exp_f32 v58, v58
v_mfma_f32_16x16x32_bf16 v[12:15], a[152:155], v[160:163], v[12:15]
ds_read_b64_tr_b16 a[172:173], v223 offset:24576
ds_read_b64_tr_b16 a[174:175], v223 offset:28672
v_mfma_f32_16x16x32_bf16 v[12:15], a[156:159], v[164:167], v[12:15]
v_exp_f32 v59, v59
v_mfma_f32_16x16x32_bf16 a[16:19], a[176:179], v[72:75], a[16:19]
v_cvt_pk_bf16_f32 v96, v56, v57
v_cvt_pk_bf16_f32 v97, v58, v59
v_mfma_f32_16x16x32_bf16 a[48:51], a[176:179], v[76:79], a[48:51]
v_exp_f32 v60, v60
v_mfma_f32_16x16x32_bf16 a[80:83], a[176:179], v[80:83], a[80:83]
v_mul_f32 v107, v107, v123
v_cvt_pk_bf16_f32 v120, v104, v105
v_mfma_f32_16x16x32_bf16 a[112:115], a[176:179], v[84:87], a[112:115]
v_exp_f32 v61, v61
v_mfma_f32_16x16x32_bf16 v[20:23], a[144:147], v[168:171], v[140:143]
ds_read_b64_tr_b16 a[176:177], v224 offset:24576
ds_read_b64_tr_b16 a[178:179], v224 offset:28672
v_mfma_f32_16x16x32_bf16 v[20:23], a[148:151], v[172:175], v[20:23]
v_exp_f32 v62, v62
v_mfma_f32_16x16x32_bf16 v[20:23], a[152:155], v[176:179], v[20:23]
v_cvt_pk_bf16_f32 v98, v60, v61
v_cvt_pk_bf16_f32 v121, v106, v107
v_mfma_f32_16x16x32_bf16 v[20:23], a[156:159], v[180:183], v[20:23]
v_exp_f32 v63, v63
v_mfma_f32_16x16x32_bf16 a[20:23], a[180:183], v[72:75], a[20:23]
v_cvt_pk_bf16_f32 v99, v62, v63
v_cndmask_b32 v244, v244, v120, s[88:89]
v_mfma_f32_16x16x32_bf16 a[52:55], a[180:183], v[76:79], a[52:55]
v_exp_f32 v64, v64
v_mfma_f32_16x16x32_bf16 a[84:87], a[180:183], v[80:83], a[84:87]
buffer_load_dword v255, v0, s[24:27], s44 offen
v_mfma_f32_16x16x32_bf16 a[116:119], a[180:183], v[84:87], a[116:119]
v_exp_f32 v65, v65
v_smfmac_f32_16x16x64_bf16 a[252:255], a[208:211], v[80:87], v235
ds_read_b64_tr_b16 a[180:181], v225 offset:24576
ds_read_b64_tr_b16 a[182:183], v225 offset:28672
v_mfma_f32_16x16x32_bf16 v[28:31], a[144:147], v[184:187], v[144:147]
v_exp_f32 v66, v66
v_mfma_f32_16x16x32_bf16 v[28:31], a[148:151], v[188:191], v[28:31]
v_cvt_pk_bf16_f32 v100, v64, v65
v_cndmask_b32 v245, v245, v121, s[88:89]
v_mfma_f32_16x16x32_bf16 v[28:31], a[152:155], v[192:195], v[28:31]
v_exp_f32 v67, v67
v_mfma_f32_16x16x32_bf16 v[28:31], a[156:159], v[196:199], v[28:31]
ds_write_b64 v6, v[244:245] offset:0
v_cvt_pk_bf16_f32 v101, v66, v67
v_mfma_f32_16x16x32_bf16 a[24:27], a[184:187], v[72:75], a[24:27]
v_exp_f32 v68, v68
v_mfma_f32_16x16x32_bf16 a[56:59], a[184:187], v[76:79], a[56:59]
ds_write_b64 v6, v[244:245] offset:8192
ds_write_b64 v6, v[244:245] offset:16384
v_mfma_f32_16x16x32_bf16 a[88:91], a[184:187], v[80:83], a[88:91]
v_exp_f32 v69, v69
v_mfma_f32_16x16x32_bf16 a[120:123], a[184:187], v[84:87], a[120:123]
ds_read_b64_tr_b16 a[184:185], v226 offset:24576
ds_read_b64_tr_b16 a[186:187], v226 offset:28672
v_mfma_f32_16x16x32_bf16 v[36:39], a[144:147], v[200:203], v[148:151]
v_exp_f32 v70, v70
v_mfma_f32_16x16x32_bf16 v[36:39], a[148:151], v[204:207], v[36:39]
ds_read_b128 a[144:147], v216 offset:45056
ds_read_b128 a[148:151], v217 offset:45056
v_mfma_f32_16x16x32_bf16 v[36:39], a[152:155], v[208:211], v[36:39]
v_exp_f32 v71, v71
v_mfma_f32_16x16x32_bf16 v[36:39], a[156:159], v[212:215], v[36:39]
ds_read_b128 a[152:155], v218 offset:45056
ds_read_b128 a[156:159], v219 offset:45056
v_mfma_f32_16x16x32_bf16 a[28:31], a[188:191], v[72:75], a[28:31]
v_cvt_pk_bf16_f32 v102, v68, v69
v_cvt_pk_bf16_f32 v103, v70, v71
v_mfma_f32_16x16x32_bf16 a[60:63], a[188:191], v[76:79], a[60:63]
s_add_u32 s44, s44, 4096
ds_write_b64 v6, v[244:245] offset:24576
ds_read_b64_tr_b16 a[224:225], v135
v_mfma_f32_16x16x32_bf16 a[92:95], a[188:191], v[80:83], a[92:95]
v_mfma_f32_16x16x32_bf16 a[124:127], a[188:191], v[84:87], a[124:127]
s_waitcnt lgkmcnt(8)
ds_read_b64_tr_b16 a[188:189], v227 offset:24576
ds_read_b64_tr_b16 a[190:191], v227 offset:28672
v_mfma_f32_16x16x32_bf16 v[40:43], a[128:131], v[152:155], v[136:139]
s_lshl_b32 s90, s52, 7
v_exp_f32 v8, v8
v_mfma_f32_16x16x32_bf16 v[40:43], a[132:135], v[156:159], v[40:43]
s_add_u32 s90, s90, 0x2400000
v_exp_f32 v9, v9
v_mfma_f32_16x16x32_bf16 v[40:43], a[136:139], v[160:163], v[40:43]
s_add_u32 s47, s32, 32
v_cvt_pk_bf16_f32 v72, v8, v9
v_mfma_f32_16x16x32_bf16 v[40:43], a[140:143], v[164:167], v[40:43]
s_mul_i32 s92, s47, 74240
v_exp_f32 v10, v10
v_mfma_f32_16x16x32_bf16 a[0:3], a[160:163], v[88:91], a[0:3]
s_add_u32 s92, s92, s90
v_mfma_f32_16x16x32_bf16 a[32:35], a[160:163], v[92:95], a[32:35]
s_mul_i32 s47, s32, 593920
v_exp_f32 v11, v11
s_waitcnt vmcnt(4) lgkmcnt(0)
s_barrier
v_mfma_f32_16x16x32_bf16 a[64:67], a[160:163], v[96:99], a[64:67]
s_add_u32 s90, s90, s47
ds_read_b64 v[104:105], v5 offset:0
v_cvt_pk_bf16_f32 v73, v10, v11
v_mfma_f32_16x16x32_bf16 a[96:99], a[160:163], v[100:103], a[96:99]
s_add_u32 m0, s49, 4096
v_exp_f32 v12, v12
v_mfma_f32_16x16x32_bf16 v[48:51], a[128:131], v[168:171], v[140:143]
s_add_u32 s48, s91, 18432
buffer_load_dwordx4 v249, s[64:67], s48 offen  lds
v_mfma_f32_16x16x32_bf16 v[48:51], a[132:135], v[172:175], v[48:51]
v_exp_f32 v13, v13
v_mfma_f32_16x16x32_bf16 v[48:51], a[136:139], v[176:179], v[48:51]
ds_read_b64_tr_b16 a[160:161], v220 offset:32768
ds_read_b64_tr_b16 a[162:163], v220 offset:36864
v_mfma_f32_16x16x32_bf16 v[48:51], a[140:143], v[180:183], v[48:51]
v_exp_f32 v14, v14
v_mfma_f32_16x16x32_bf16 a[4:7], a[164:167], v[88:91], a[4:7]
s_add_u32 m0, s49, 5120
ds_read_b64 v[106:107], v5 offset:1024
v_cvt_pk_bf16_f32 v74, v12, v13
v_mfma_f32_16x16x32_bf16 a[36:39], a[164:167], v[92:95], a[36:39]
s_add_u32 s48, s91, 23040
v_exp_f32 v15, v15
v_mfma_f32_16x16x32_bf16 a[68:71], a[164:167], v[96:99], a[68:71]
buffer_load_dwordx4 v250, s[64:67], s48 offen  lds
v_mfma_f32_16x16x32_bf16 a[100:103], a[164:167], v[100:103], a[100:103]
v_exp_f32 v16, v16
v_smfmac_f32_16x16x64_bf16 a[248:251], a[208:211], v[88:95], v235
ds_read_b64_tr_b16 a[164:165], v221 offset:32768
ds_read_b64_tr_b16 a[166:167], v221 offset:36864
v_mfma_f32_16x16x32_bf16 v[56:59], a[128:131], v[184:187], v[144:147]
v_exp_f32 v17, v17
v_mfma_f32_16x16x32_bf16 v[56:59], a[132:135], v[188:191], v[56:59]
s_add_u32 m0, s49, 6144
v_cvt_pk_bf16_f32 v75, v14, v15
v_cvt_pk_bf16_f32 v76, v16, v17
v_mfma_f32_16x16x32_bf16 v[56:59], a[136:139], v[192:195], v[56:59]
s_add_u32 s48, s91, 27648
v_exp_f32 v18, v18
v_mfma_f32_16x16x32_bf16 v[56:59], a[140:143], v[196:199], v[56:59]
buffer_load_dwordx4 v249, s[64:67], s48 offen  lds
v_mfma_f32_16x16x32_bf16 a[8:11], a[168:171], v[88:91], a[8:11]
v_exp_f32 v19, v19
v_mfma_f32_16x16x32_bf16 a[40:43], a[168:171], v[92:95], a[40:43]
ds_read_b64 v[108:109], v5 offset:2048
v_cvt_pk_bf16_f32 v77, v18, v19
v_mfma_f32_16x16x32_bf16 a[72:75], a[168:171], v[96:99], a[72:75]
s_add_u32 m0, s49, 7168
v_exp_f32 v20, v20
v_mfma_f32_16x16x32_bf16 a[104:107], a[168:171], v[100:103], a[104:107]
s_add_u32 s48, s91, 32256
buffer_load_dwordx4 v250, s[64:67], s48 offen  lds
v_mfma_f32_16x16x32_bf16 v[64:67], a[128:131], v[200:203], v[148:151]
v_exp_f32 v21, v21
v_mfma_f32_16x16x32_bf16 v[64:67], a[132:135], v[204:207], v[64:67]
ds_read_b64_tr_b16 a[168:169], v222 offset:32768
ds_read_b64_tr_b16 a[170:171], v222 offset:36864
v_mfma_f32_16x16x32_bf16 v[64:67], a[136:139], v[208:211], v[64:67]
v_exp_f32 v22, v22
v_mfma_f32_16x16x32_bf16 v[64:67], a[140:143], v[212:215], v[64:67]
ds_read_b128 a[128:131], v216 offset:16384
ds_read_b128 a[132:135], v217 offset:16384
v_mfma_f32_16x16x32_bf16 a[12:15], a[172:175], v[88:91], a[12:15]
s_add_u32 m0, s37, 65536
v_exp_f32 v23, v23
v_mfma_f32_16x16x32_bf16 a[44:47], a[172:175], v[92:95], a[44:47]
buffer_load_dwordx4 v232, s[12:15], s39 offen offset:0 lds
v_mfma_f32_16x16x32_bf16 a[76:79], a[172:175], v[96:99], a[76:79]
v_exp_f32 v24, v24
v_mfma_f32_16x16x32_bf16 a[108:111], a[172:175], v[100:103], a[108:111]
v_exp_f32 v25, v25
v_mfma_f32_16x16x32_bf16 v[44:47], a[144:147], v[152:155], v[136:139]
ds_read_b128 a[136:139], v218 offset:16384
ds_read_b128 a[140:143], v219 offset:16384
v_mfma_f32_16x16x32_bf16 v[44:47], a[148:151], v[156:159], v[44:47]
v_exp_f32 v26, v26
v_mfma_f32_16x16x32_bf16 v[44:47], a[152:155], v[160:163], v[44:47]
buffer_load_dwordx4 v233, s[12:15], s39 offen offset:1024 lds
v_mfma_f32_16x16x32_bf16 v[44:47], a[156:159], v[164:167], v[44:47]
v_exp_f32 v27, v27
v_mfma_f32_16x16x32_bf16 a[16:19], a[176:179], v[88:91], a[16:19]
ds_read_b64_tr_b16 a[172:173], v223 offset:32768
ds_read_b64_tr_b16 a[174:175], v223 offset:36864
v_mfma_f32_16x16x32_bf16 a[48:51], a[176:179], v[92:95], a[48:51]
v_exp_f32 v28, v28
v_mfma_f32_16x16x32_bf16 a[80:83], a[176:179], v[96:99], a[80:83]
v_cvt_pk_bf16_f32 v78, v20, v21
v_cvt_pk_bf16_f32 v79, v22, v23
v_mfma_f32_16x16x32_bf16 a[112:115], a[176:179], v[100:103], a[112:115]
v_exp_f32 v29, v29
v_mfma_f32_16x16x32_bf16 v[52:55], a[144:147], v[168:171], v[140:143]
buffer_load_dwordx4 v232, s[12:15], s39 offen offset:2048 lds
v_mfma_f32_16x16x32_bf16 v[52:55], a[148:151], v[172:175], v[52:55]
v_exp_f32 v30, v30
v_mfma_f32_16x16x32_bf16 v[52:55], a[152:155], v[176:179], v[52:55]
ds_read_b64_tr_b16 a[176:177], v224 offset:32768
ds_read_b64_tr_b16 a[178:179], v224 offset:36864
v_mfma_f32_16x16x32_bf16 v[52:55], a[156:159], v[180:183], v[52:55]
v_exp_f32 v31, v31
v_mfma_f32_16x16x32_bf16 a[20:23], a[180:183], v[88:91], a[20:23]
v_cvt_pk_bf16_f32 v80, v24, v25
v_cvt_pk_bf16_f32 v81, v26, v27
v_mfma_f32_16x16x32_bf16 a[52:55], a[180:183], v[92:95], a[52:55]
v_exp_f32 v32, v32
v_mfma_f32_16x16x32_bf16 a[84:87], a[180:183], v[96:99], a[84:87]
buffer_load_dwordx4 v233, s[12:15], s39 offen offset:3072 lds
v_mfma_f32_16x16x32_bf16 a[116:119], a[180:183], v[100:103], a[116:119]
v_exp_f32 v33, v33
v_smfmac_f32_16x16x64_bf16 a[252:255], a[208:211], v[96:103], v235
ds_read_b64_tr_b16 a[180:181], v225 offset:32768
ds_read_b64_tr_b16 a[182:183], v225 offset:36864
v_mfma_f32_16x16x32_bf16 v[60:63], a[144:147], v[184:187], v[144:147]
v_exp_f32 v34, v34
v_mfma_f32_16x16x32_bf16 v[60:63], a[148:151], v[188:191], v[60:63]
s_add_u32 s39, s39, 16384
v_cvt_pk_bf16_f32 v82, v28, v29
v_cvt_pk_bf16_f32 v83, v30, v31
v_mfma_f32_16x16x32_bf16 v[60:63], a[152:155], v[192:195], v[60:63]
s_add_u32 m0, s37, 49152
v_exp_f32 v35, v35
v_mfma_f32_16x16x32_bf16 v[60:63], a[156:159], v[196:199], v[60:63]
buffer_load_dwordx4 v228, s[8:11], s38 offen offset:0 lds
v_mfma_f32_16x16x32_bf16 a[24:27], a[184:187], v[88:91], a[24:27]
v_exp_f32 v36, v36
v_mfma_f32_16x16x32_bf16 a[56:59], a[184:187], v[92:95], a[56:59]
v_cvt_pk_bf16_f32 v84, v32, v33
v_cvt_pk_bf16_f32 v85, v34, v35
v_mfma_f32_16x16x32_bf16 a[88:91], a[184:187], v[96:99], a[88:91]
v_exp_f32 v37, v37
v_mfma_f32_16x16x32_bf16 a[120:123], a[184:187], v[100:103], a[120:123]
buffer_load_dwordx4 v229, s[8:11], s38 offen offset:1024 lds
v_mfma_f32_16x16x32_bf16 v[68:71], a[144:147], v[200:203], v[148:151]
v_exp_f32 v38, v38
v_mfma_f32_16x16x32_bf16 v[68:71], a[148:151], v[204:207], v[68:71]
ds_read_b64_tr_b16 a[184:185], v226 offset:32768
ds_read_b64_tr_b16 a[186:187], v226 offset:36864
v_mfma_f32_16x16x32_bf16 v[68:71], a[152:155], v[208:211], v[68:71]
v_exp_f32 v39, v39
v_mfma_f32_16x16x32_bf16 v[68:71], a[156:159], v[212:215], v[68:71]
ds_read_b128 a[144:147], v216 offset:20480
ds_read_b128 a[148:151], v217 offset:20480
v_mfma_f32_16x16x32_bf16 a[28:31], a[188:191], v[88:91], a[28:31]
ds_read_b128 a[152:155], v218 offset:20480
ds_read_b128 a[156:159], v219 offset:20480
v_mfma_f32_16x16x32_bf16 a[60:63], a[188:191], v[92:95], a[60:63]
v_cvt_pk_bf16_f32 v86, v36, v37
v_cvt_pk_bf16_f32 v87, v38, v39
v_mfma_f32_16x16x32_bf16 a[92:95], a[188:191], v[96:99], a[92:95]
ds_read_b64 v[110:111], v5 offset:3072
v_and_b32 v7, 7, v1
v_mfma_f32_16x16x32_bf16 a[124:127], a[188:191], v[100:103], a[124:127]
s_waitcnt lgkmcnt(7)
ds_read_b64_tr_b16 a[188:189], v227 offset:32768
ds_read_b64_tr_b16 a[190:191], v227 offset:36864
v_mul_u32_u24 v248, 18560, v4
v_lshl_add_u32 v248, v7, 4, v248
v_mfma_f32_16x16x32_bf16 v[8:11], a[128:131], v[152:155], v[136:139]
v_exp_f32 v40, v40
v_mfma_f32_16x16x32_bf16 v[8:11], a[132:135], v[156:159], v[8:11]
v_exp_f32 v41, v41
v_mfma_f32_16x16x32_bf16 v[8:11], a[136:139], v[160:163], v[8:11]
buffer_load_dwordx4 v230, s[8:11], s38 offen offset:2048 lds
v_mfma_f32_16x16x32_bf16 v[8:11], a[140:143], v[164:167], v[8:11]
v_exp_f32 v42, v42
v_mfma_f32_16x16x32_bf16 a[0:3], a[160:163], v[72:75], a[0:3]
v_cvt_pk_bf16_f32 v88, v40, v41
s_waitcnt lgkmcnt(2)
v_lshlrev_b32 v112, 16, v104
v_mfma_f32_16x16x32_bf16 a[32:35], a[160:163], v[76:79], a[32:35]
v_exp_f32 v43, v43
v_mfma_f32_16x16x32_bf16 a[64:67], a[160:163], v[80:83], a[64:67]
v_cvt_pk_bf16_f32 v89, v42, v43
v_and_b32 v113, 0xffff0000, v104
v_mfma_f32_16x16x32_bf16 a[96:99], a[160:163], v[84:87], a[96:99]
v_exp_f32 v44, v44
v_mfma_f32_16x16x32_bf16 v[16:19], a[128:131], v[168:171], v[140:143]
ds_read_b64_tr_b16 a[160:161], v220 offset:40960
ds_read_b64_tr_b16 a[162:163], v220 offset:45056
v_mfma_f32_16x16x32_bf16 v[16:19], a[132:135], v[172:175], v[16:19]
v_exp_f32 v45, v45
v_mfma_f32_16x16x32_bf16 v[16:19], a[136:139], v[176:179], v[16:19]
v_cvt_pk_bf16_f32 v90, v44, v45
v_lshlrev_b32 v114, 16, v105
v_mfma_f32_16x16x32_bf16 v[16:19], a[140:143], v[180:183], v[16:19]
v_exp_f32 v46, v46
v_mfma_f32_16x16x32_bf16 a[4:7], a[164:167], v[72:75], a[4:7]
v_and_b32 v115, 0xffff0000, v105
v_lshlrev_b32 v116, 16, v106
v_mfma_f32_16x16x32_bf16 a[36:39], a[164:167], v[76:79], a[36:39]
v_exp_f32 v47, v47
v_mfma_f32_16x16x32_bf16 a[68:71], a[164:167], v[80:83], a[68:71]
buffer_load_dwordx4 v231, s[8:11], s38 offen offset:3072 lds
v_mfma_f32_16x16x32_bf16 a[100:103], a[164:167], v[84:87], a[100:103]
v_exp_f32 v48, v48
v_smfmac_f32_16x16x64_bf16 a[248:251], a[208:211], v[72:79], v235
ds_read_b64_tr_b16 a[164:165], v221 offset:40960
ds_read_b64_tr_b16 a[166:167], v221 offset:45056
v_mfma_f32_16x16x32_bf16 v[24:27], a[128:131], v[184:187], v[144:147]
v_exp_f32 v49, v49
v_mfma_f32_16x16x32_bf16 v[24:27], a[132:135], v[188:191], v[24:27]
v_cvt_pk_bf16_f32 v91, v46, v47
v_cvt_pk_bf16_f32 v92, v48, v49
v_mfma_f32_16x16x32_bf16 v[24:27], a[136:139], v[192:195], v[24:27]
v_exp_f32 v50, v50
v_mfma_f32_16x16x32_bf16 v[24:27], a[140:143], v[196:199], v[24:27]
v_and_b32 v117, 0xffff0000, v106
v_lshlrev_b32 v118, 16, v107
v_mfma_f32_16x16x32_bf16 a[8:11], a[168:171], v[72:75], a[8:11]
v_exp_f32 v51, v51
v_mfma_f32_16x16x32_bf16 a[40:43], a[168:171], v[76:79], a[40:43]
v_cvt_pk_bf16_f32 v93, v50, v51
v_and_b32 v119, 0xffff0000, v107
v_mfma_f32_16x16x32_bf16 a[72:75], a[168:171], v[80:83], a[72:75]
v_exp_f32 v52, v52
v_mfma_f32_16x16x32_bf16 a[104:107], a[168:171], v[84:87], a[104:107]
ds_read_b64_tr_b16 a[168:169], v222 offset:40960
ds_read_b64_tr_b16 a[170:171], v222 offset:45056
v_mfma_f32_16x16x32_bf16 v[32:35], a[128:131], v[200:203], v[148:151]
s_add_u32 s38, s38, 16384
v_exp_f32 v53, v53
v_mfma_f32_16x16x32_bf16 v[32:35], a[132:135], v[204:207], v[32:35]
s_add_u32 m0, s37, 81920
ds_read_b128 a[128:131], v216 offset:24576
ds_read_b128 a[132:135], v217 offset:24576
v_mfma_f32_16x16x32_bf16 v[32:35], a[136:139], v[208:211], v[32:35]
v_exp_f32 v54, v54
v_mfma_f32_16x16x32_bf16 v[32:35], a[140:143], v[212:215], v[32:35]
buffer_load_dwordx4 v232, s[12:15], s39 offen offset:0 lds
v_mfma_f32_16x16x32_bf16 a[12:15], a[172:175], v[72:75], a[12:15]
v_exp_f32 v55, v55
v_mfma_f32_16x16x32_bf16 a[44:47], a[172:175], v[76:79], a[44:47]
ds_read_b128 a[136:139], v218 offset:24576
ds_read_b128 a[140:143], v219 offset:24576
v_mfma_f32_16x16x32_bf16 a[76:79], a[172:175], v[80:83], a[76:79]
v_exp_f32 v56, v56
v_mfma_f32_16x16x32_bf16 a[108:111], a[172:175], v[84:87], a[108:111]
v_exp_f32 v57, v57
v_mfma_f32_16x16x32_bf16 v[12:15], a[144:147], v[152:155], v[136:139]
ds_read_b64_tr_b16 a[172:173], v223 offset:40960
ds_read_b64_tr_b16 a[174:175], v223 offset:45056
v_mfma_f32_16x16x32_bf16 v[12:15], a[148:151], v[156:159], v[12:15]
v_exp_f32 v58, v58
v_mfma_f32_16x16x32_bf16 v[12:15], a[152:155], v[160:163], v[12:15]
v_cvt_pk_bf16_f32 v94, v52, v53
v_cvt_pk_bf16_f32 v95, v54, v55
v_mfma_f32_16x16x32_bf16 v[12:15], a[156:159], v[164:167], v[12:15]
v_exp_f32 v59, v59
v_mfma_f32_16x16x32_bf16 a[16:19], a[176:179], v[72:75], a[16:19]
v_cvt_pk_bf16_f32 v96, v56, v57
v_cvt_pk_bf16_f32 v97, v58, v59
v_mfma_f32_16x16x32_bf16 a[48:51], a[176:179], v[76:79], a[48:51]
v_exp_f32 v60, v60
v_mfma_f32_16x16x32_bf16 a[80:83], a[176:179], v[80:83], a[80:83]
buffer_load_dwordx4 v233, s[12:15], s39 offen offset:1024 lds
v_mfma_f32_16x16x32_bf16 a[112:115], a[176:179], v[84:87], a[112:115]
v_exp_f32 v61, v61
v_mfma_f32_16x16x32_bf16 v[20:23], a[144:147], v[168:171], v[140:143]
ds_read_b64_tr_b16 a[176:177], v224 offset:40960
ds_read_b64_tr_b16 a[178:179], v224 offset:45056
v_mfma_f32_16x16x32_bf16 v[20:23], a[148:151], v[172:175], v[20:23]
v_exp_f32 v62, v62
v_mfma_f32_16x16x32_bf16 v[20:23], a[152:155], v[176:179], v[20:23]
v_cvt_pk_bf16_f32 v98, v60, v61
v_lshlrev_b32 v120, 16, v108
v_mfma_f32_16x16x32_bf16 v[20:23], a[156:159], v[180:183], v[20:23]
v_exp_f32 v63, v63
v_mfma_f32_16x16x32_bf16 a[20:23], a[180:183], v[72:75], a[20:23]
v_cvt_pk_bf16_f32 v99, v62, v63
v_and_b32 v121, 0xffff0000, v108
v_mfma_f32_16x16x32_bf16 a[52:55], a[180:183], v[76:79], a[52:55]
v_exp_f32 v64, v64
v_mfma_f32_16x16x32_bf16 a[84:87], a[180:183], v[80:83], a[84:87]
v_lshlrev_b32 v122, 16, v109
v_and_b32 v123, 0xffff0000, v109
v_mfma_f32_16x16x32_bf16 a[116:119], a[180:183], v[84:87], a[116:119]
v_exp_f32 v65, v65
v_smfmac_f32_16x16x64_bf16 a[252:255], a[208:211], v[80:87], v235
ds_read_b64_tr_b16 a[180:181], v225 offset:40960
ds_read_b64_tr_b16 a[182:183], v225 offset:45056
v_mfma_f32_16x16x32_bf16 v[28:31], a[144:147], v[184:187], v[144:147]
v_exp_f32 v66, v66
v_mfma_f32_16x16x32_bf16 v[28:31], a[148:151], v[188:191], v[28:31]
buffer_load_dwordx4 v232, s[12:15], s39 offen offset:2048 lds
v_mfma_f32_16x16x32_bf16 v[28:31], a[152:155], v[192:195], v[28:31]
v_exp_f32 v67, v67
v_mfma_f32_16x16x32_bf16 v[28:31], a[156:159], v[196:199], v[28:31]
v_cvt_pk_bf16_f32 v100, v64, v65
v_cvt_pk_bf16_f32 v101, v66, v67
v_mfma_f32_16x16x32_bf16 a[24:27], a[184:187], v[72:75], a[24:27]
v_exp_f32 v68, v68
v_mfma_f32_16x16x32_bf16 a[56:59], a[184:187], v[76:79], a[56:59]
v_lshlrev_b32 v124, 16, v110
v_and_b32 v125, 0xffff0000, v110
v_mfma_f32_16x16x32_bf16 a[88:91], a[184:187], v[80:83], a[88:91]
v_exp_f32 v69, v69
v_mfma_f32_16x16x32_bf16 a[120:123], a[184:187], v[84:87], a[120:123]
ds_read_b64_tr_b16 a[184:185], v226 offset:40960
ds_read_b64_tr_b16 a[186:187], v226 offset:45056
v_mfma_f32_16x16x32_bf16 v[36:39], a[144:147], v[200:203], v[148:151]
v_exp_f32 v70, v70
v_mfma_f32_16x16x32_bf16 v[36:39], a[148:151], v[204:207], v[36:39]
ds_read_b128 a[144:147], v216 offset:28672
ds_read_b128 a[148:151], v217 offset:28672
v_mfma_f32_16x16x32_bf16 v[36:39], a[152:155], v[208:211], v[36:39]
v_exp_f32 v71, v71
v_mfma_f32_16x16x32_bf16 v[36:39], a[156:159], v[212:215], v[36:39]
s_waitcnt lgkmcnt(4)
ds_read_b128 a[152:155], v218 offset:28672
ds_read_b128 a[156:159], v219 offset:28672
v_mfma_f32_16x16x32_bf16 a[28:31], a[188:191], v[72:75], a[28:31]
v_cvt_pk_bf16_f32 v102, v68, v69
v_cvt_pk_bf16_f32 v103, v70, v71
v_mfma_f32_16x16x32_bf16 a[60:63], a[188:191], v[76:79], a[60:63]
v_lshlrev_b32 v126, 16, v111
v_and_b32 v127, 0xffff0000, v111
v_mfma_f32_16x16x32_bf16 a[92:95], a[188:191], v[80:83], a[92:95]
v_mul_f32 v112, v112, v120
v_mul_f32 v113, v113, v121
v_mfma_f32_16x16x32_bf16 a[124:127], a[188:191], v[84:87], a[124:127]
ds_read_b64_tr_b16 a[188:189], v227 offset:40960
ds_read_b64_tr_b16 a[190:191], v227 offset:45056
v_mfma_f32_16x16x32_bf16 v[40:43], a[128:131], v[152:155], v[136:139]
v_exp_f32 v8, v8
v_mfma_f32_16x16x32_bf16 v[40:43], a[132:135], v[156:159], v[40:43]
v_exp_f32 v9, v9
v_mfma_f32_16x16x32_bf16 v[40:43], a[136:139], v[160:163], v[40:43]
buffer_load_dwordx4 v233, s[12:15], s39 offen offset:3072 lds
v_mfma_f32_16x16x32_bf16 v[40:43], a[140:143], v[164:167], v[40:43]
v_exp_f32 v10, v10
v_mfma_f32_16x16x32_bf16 a[0:3], a[160:163], v[88:91], a[0:3]
v_cvt_pk_bf16_f32 v72, v8, v9
v_mul_f32 v114, v114, v122
v_mfma_f32_16x16x32_bf16 a[32:35], a[160:163], v[92:95], a[32:35]
v_exp_f32 v11, v11
v_mfma_f32_16x16x32_bf16 a[64:67], a[160:163], v[96:99], a[64:67]
v_cvt_pk_bf16_f32 v73, v10, v11
v_mul_f32 v115, v115, v123
v_mfma_f32_16x16x32_bf16 a[96:99], a[160:163], v[100:103], a[96:99]
v_exp_f32 v12, v12
v_mfma_f32_16x16x32_bf16 v[48:51], a[128:131], v[168:171], v[140:143]
ds_read_b64_tr_b16 a[160:161], v220 offset:49152
ds_read_b64_tr_b16 a[162:163], v220 offset:53248
v_mfma_f32_16x16x32_bf16 v[48:51], a[132:135], v[172:175], v[48:51]
v_exp_f32 v13, v13
v_mfma_f32_16x16x32_bf16 v[48:51], a[136:139], v[176:179], v[48:51]
v_cvt_pk_bf16_f32 v74, v12, v13
v_mul_f32 v116, v116, v124
v_mfma_f32_16x16x32_bf16 v[48:51], a[140:143], v[180:183], v[48:51]
v_exp_f32 v14, v14
v_mfma_f32_16x16x32_bf16 a[4:7], a[164:167], v[88:91], a[4:7]
v_mul_f32 v117, v117, v125
v_mul_f32 v118, v118, v126
v_mfma_f32_16x16x32_bf16 a[36:39], a[164:167], v[92:95], a[36:39]
s_add_u32 s39, s39, 16384
v_exp_f32 v15, v15
v_mfma_f32_16x16x32_bf16 a[68:71], a[164:167], v[96:99], a[68:71]
s_add_u32 m0, s37, 32768
v_cvt_pk_bf16_f32 v75, v14, v15
v_mul_f32 v119, v119, v127
v_mfma_f32_16x16x32_bf16 a[100:103], a[164:167], v[100:103], a[100:103]
v_exp_f32 v16, v16
v_smfmac_f32_16x16x64_bf16 a[248:251], a[208:211], v[88:95], v235
buffer_load_dwordx4 v228, s[8:11], s38 offen offset:0 lds
v_mfma_f32_16x16x32_bf16 v[56:59], a[128:131], v[184:187], v[144:147]
v_exp_f32 v17, v17
v_mfma_f32_16x16x32_bf16 v[56:59], a[132:135], v[188:191], v[56:59]
ds_read_b64_tr_b16 a[164:165], v221 offset:49152
ds_read_b64_tr_b16 a[166:167], v221 offset:53248
v_mfma_f32_16x16x32_bf16 v[56:59], a[136:139], v[192:195], v[56:59]
v_exp_f32 v18, v18
v_mfma_f32_16x16x32_bf16 v[56:59], a[140:143], v[196:199], v[56:59]
v_cvt_pk_bf16_f32 v76, v16, v17
v_cvt_pk_bf16_f32 v244, v112, v113
v_mfma_f32_16x16x32_bf16 a[8:11], a[168:171], v[88:91], a[8:11]
v_exp_f32 v19, v19
v_mfma_f32_16x16x32_bf16 a[40:43], a[168:171], v[92:95], a[40:43]
v_cvt_pk_bf16_f32 v77, v18, v19
v_cvt_pk_bf16_f32 v245, v114, v115
v_mfma_f32_16x16x32_bf16 a[72:75], a[168:171], v[96:99], a[72:75]
v_exp_f32 v20, v20
v_mfma_f32_16x16x32_bf16 a[104:107], a[168:171], v[100:103], a[104:107]
ds_read_b64_tr_b16 a[168:169], v222 offset:49152
ds_read_b64_tr_b16 a[170:171], v222 offset:53248
v_mfma_f32_16x16x32_bf16 v[64:67], a[128:131], v[200:203], v[148:151]
v_exp_f32 v21, v21
v_mfma_f32_16x16x32_bf16 v[64:67], a[132:135], v[204:207], v[64:67]
buffer_load_dwordx4 v229, s[8:11], s38 offen offset:1024 lds
v_mfma_f32_16x16x32_bf16 v[64:67], a[136:139], v[208:211], v[64:67]
v_exp_f32 v22, v22
v_mfma_f32_16x16x32_bf16 v[64:67], a[140:143], v[212:215], v[64:67]
ds_read_b128 a[128:131], v216 offset:0
ds_read_b128 a[132:135], v217 offset:0
v_mfma_f32_16x16x32_bf16 a[12:15], a[172:175], v[88:91], a[12:15]
v_exp_f32 v23, v23
v_mfma_f32_16x16x32_bf16 a[44:47], a[172:175], v[92:95], a[44:47]
ds_read_b128 a[136:139], v218 offset:0
ds_read_b128 a[140:143], v219 offset:0
v_mfma_f32_16x16x32_bf16 a[76:79], a[172:175], v[96:99], a[76:79]
v_exp_f32 v24, v24
v_mfma_f32_16x16x32_bf16 a[108:111], a[172:175], v[100:103], a[108:111]
s_waitcnt lgkmcnt(6)
v_exp_f32 v25, v25
v_mfma_f32_16x16x32_bf16 v[44:47], a[144:147], v[152:155], v[136:139]
ds_read_b64_tr_b16 a[172:173], v223 offset:49152
ds_read_b64_tr_b16 a[174:175], v223 offset:53248
v_mfma_f32_16x16x32_bf16 v[44:47], a[148:151], v[156:159], v[44:47]
v_exp_f32 v26, v26
v_mfma_f32_16x16x32_bf16 v[44:47], a[152:155], v[160:163], v[44:47]
v_cvt_pk_bf16_f32 v78, v20, v21
v_cvt_pk_bf16_f32 v79, v22, v23
v_mfma_f32_16x16x32_bf16 v[44:47], a[156:159], v[164:167], v[44:47]
v_exp_f32 v27, v27
v_mfma_f32_16x16x32_bf16 a[16:19], a[176:179], v[88:91], a[16:19]
v_cvt_pk_bf16_f32 v80, v24, v25
v_cvt_pk_bf16_f32 v81, v26, v27
v_mfma_f32_16x16x32_bf16 a[48:51], a[176:179], v[92:95], a[48:51]
v_exp_f32 v28, v28
v_mfma_f32_16x16x32_bf16 a[80:83], a[176:179], v[96:99], a[80:83]
buffer_load_dwordx4 v230, s[8:11], s38 offen offset:2048 lds
v_mfma_f32_16x16x32_bf16 a[112:115], a[176:179], v[100:103], a[112:115]
v_exp_f32 v29, v29
v_mfma_f32_16x16x32_bf16 v[52:55], a[144:147], v[168:171], v[140:143]
ds_read_b64_tr_b16 a[176:177], v224 offset:49152
ds_read_b64_tr_b16 a[178:179], v224 offset:53248
v_mfma_f32_16x16x32_bf16 v[52:55], a[148:151], v[172:175], v[52:55]
v_exp_f32 v30, v30
v_mfma_f32_16x16x32_bf16 v[52:55], a[152:155], v[176:179], v[52:55]
v_cvt_pk_bf16_f32 v82, v28, v29
v_cvt_pk_bf16_f32 v246, v116, v117
v_mfma_f32_16x16x32_bf16 v[52:55], a[156:159], v[180:183], v[52:55]
v_exp_f32 v31, v31
v_mfma_f32_16x16x32_bf16 a[20:23], a[180:183], v[88:91], a[20:23]
v_cvt_pk_bf16_f32 v83, v30, v31
v_cvt_pk_bf16_f32 v247, v118, v119
v_mfma_f32_16x16x32_bf16 a[52:55], a[180:183], v[92:95], a[52:55]
v_exp_f32 v32, v32
v_mfma_f32_16x16x32_bf16 a[84:87], a[180:183], v[96:99], a[84:87]
s_waitcnt vmcnt(15)
ds_read_b64_tr_b16 a[194:195], v128
ds_read_b64_tr_b16 a[198:199], v129
v_mfma_f32_16x16x32_bf16 a[116:119], a[180:183], v[100:103], a[116:119]
v_exp_f32 v33, v33
v_smfmac_f32_16x16x64_bf16 a[252:255], a[208:211], v[96:103], v235
ds_read_b64_tr_b16 a[180:181], v225 offset:49152
ds_read_b64_tr_b16 a[182:183], v225 offset:53248
v_mfma_f32_16x16x32_bf16 v[60:63], a[144:147], v[184:187], v[144:147]
v_exp_f32 v34, v34
v_mfma_f32_16x16x32_bf16 v[60:63], a[148:151], v[188:191], v[60:63]
buffer_load_dwordx4 v231, s[8:11], s38 offen offset:3072 lds
v_mfma_f32_16x16x32_bf16 v[60:63], a[152:155], v[192:195], v[60:63]
v_exp_f32 v35, v35
v_mfma_f32_16x16x32_bf16 v[60:63], a[156:159], v[196:199], v[60:63]
v_cvt_pk_bf16_f32 v84, v32, v33
v_cvt_pk_bf16_f32 v85, v34, v35
v_mfma_f32_16x16x32_bf16 a[24:27], a[184:187], v[88:91], a[24:27]
v_exp_f32 v36, v36
v_mfma_f32_16x16x32_bf16 a[56:59], a[184:187], v[92:95], a[56:59]
ds_read_b64_tr_b16 a[202:203], v130
ds_read_b64_tr_b16 a[206:207], v131
v_mfma_f32_16x16x32_bf16 a[88:91], a[184:187], v[96:99], a[88:91]
v_exp_f32 v37, v37
v_mfma_f32_16x16x32_bf16 a[120:123], a[184:187], v[100:103], a[120:123]
ds_read_b64_tr_b16 a[184:185], v226 offset:49152
ds_read_b64_tr_b16 a[186:187], v226 offset:53248
v_mfma_f32_16x16x32_bf16 v[68:71], a[144:147], v[200:203], v[148:151]
v_exp_f32 v38, v38
v_mfma_f32_16x16x32_bf16 v[68:71], a[148:151], v[204:207], v[68:71]
ds_read_b128 a[144:147], v216 offset:4096
ds_read_b128 a[148:151], v217 offset:4096
v_mfma_f32_16x16x32_bf16 v[68:71], a[152:155], v[208:211], v[68:71]
v_exp_f32 v39, v39
v_mfma_f32_16x16x32_bf16 v[68:71], a[156:159], v[212:215], v[68:71]
ds_read_b128 a[152:155], v218 offset:4096
ds_read_b128 a[156:159], v219 offset:4096
v_mfma_f32_16x16x32_bf16 a[28:31], a[188:191], v[88:91], a[28:31]
v_cvt_pk_bf16_f32 v86, v36, v37
v_cvt_pk_bf16_f32 v87, v38, v39
v_mfma_f32_16x16x32_bf16 a[60:63], a[188:191], v[92:95], a[60:63]
s_add_u32 s38, s38, 16384
ds_read_b64_tr_b16 a[214:215], v132
ds_read_b64_tr_b16 a[218:219], v133
v_mfma_f32_16x16x32_bf16 a[92:95], a[188:191], v[96:99], a[92:95]
ds_read_b64_tr_b16 a[222:223], v134
ds_read_b64_tr_b16 a[226:227], v135
v_mfma_f32_16x16x32_bf16 a[124:127], a[188:191], v[100:103], a[124:127]
s_waitcnt lgkmcnt(10)
ds_read_b64_tr_b16 a[188:189], v227 offset:49152
ds_read_b64_tr_b16 a[190:191], v227 offset:53248
v_mfma_f32_16x16x32_bf16 v[8:11], a[128:131], v[152:155], v[136:139]
s_mov_b32 s40, 6
v_exp_f32 v40, v40
v_mfma_f32_16x16x32_bf16 v[8:11], a[132:135], v[156:159], v[8:11]
s_mov_b32 s74, 0x180
buffer_load_dwordx2 v[252:253], v251, s[76:79], s42 offen sc1
v_mfma_f32_16x16x32_bf16 v[8:11], a[136:139], v[160:163], v[8:11]
s_add_u32 s52, s52, 1
v_exp_f32 v41, v41
v_mfma_f32_16x16x32_bf16 v[8:11], a[140:143], v[164:167], v[8:11]
v_cvt_pk_bf16_f32 v88, v40, v41
v_mov_b32 v5, 0
v_mfma_f32_16x16x32_bf16 a[0:3], a[160:163], v[72:75], a[0:3]
s_lshl_b32 s46, s32, 2
v_exp_f32 v42, v42
v_mfma_f32_16x16x32_bf16 a[32:35], a[160:163], v[76:79], a[32:35]
s_add_u32 s46, s46, 163776
v_mov_b32 v6, s46
v_and_b32 v7, 12, v1
v_mfma_f32_16x16x32_bf16 a[64:67], a[160:163], v[80:83], a[64:67]
s_add_u32 s42, s42, s43
v_exp_f32 v43, v43
v_mfma_f32_16x16x32_bf16 a[96:99], a[160:163], v[84:87], a[96:99]
buffer_load_dword v255, v243, s[28:31], s45 offen
v_mfma_f32_16x16x32_bf16 a[228:231], a[232:235], v[244:247], 0
v_exp_f32 v44, v44
v_mfma_f32_16x16x32_bf16 v[104:107], a[192:195], v[244:247], 0
ds_read_b64_tr_b16 a[160:161], v220 offset:57344
ds_read_b64_tr_b16 a[162:163], v220 offset:61440
v_mfma_f32_16x16x32_bf16 v[108:111], a[196:199], v[244:247], 0
v_cvt_pk_bf16_f32 v89, v42, v43
v_add_u32 v7, 163776, v7
v_mfma_f32_16x16x32_bf16 v[112:115], a[200:203], v[244:247], 0
s_add_u32 s45, s45, 589824
v_exp_f32 v45, v45
v_mfma_f32_16x16x32_bf16 v[116:119], a[204:207], v[244:247], 0
global_load_dword v255, v242, s[72:73]
v_mfma_f32_16x16x32_bf16 v[16:19], a[128:131], v[168:171], v[140:143]
v_exp_f32 v46, v46
v_mfma_f32_16x16x32_bf16 v[16:19], a[132:135], v[172:175], v[16:19]
v_cvt_pk_bf16_f32 v90, v44, v45
v_mfma_f32_16x16x32_bf16 v[16:19], a[136:139], v[176:179], v[16:19]
v_exp_f32 v47, v47
v_mfma_f32_16x16x32_bf16 v[16:19], a[140:143], v[180:183], v[16:19]
v_cvt_pk_bf16_f32 v91, v46, v47
v_mfma_f32_16x16x32_bf16 a[4:7], a[164:167], v[72:75], a[4:7]
v_exp_f32 v48, v48
v_mfma_f32_16x16x32_bf16 a[36:39], a[164:167], v[76:79], a[36:39]
buffer_load_dword v255, v0, s[24:27], s44 offen
v_mfma_f32_16x16x32_bf16 a[68:71], a[164:167], v[80:83], a[68:71]
v_exp_f32 v49, v49
v_mfma_f32_16x16x32_bf16 a[100:103], a[164:167], v[84:87], a[100:103]
ds_read_b64_tr_b16 a[164:165], v221 offset:57344
ds_read_b64_tr_b16 a[166:167], v221 offset:61440
v_smfmac_f32_16x16x64_bf16 a[248:251], a[208:211], v[72:79], v235
s_waitcnt lgkmcnt(2)
v_cvt_pk_bf16_f32 v92, v48, v49
v_mfma_f32_16x16x32_bf16 v[120:123], a[212:215], v[244:247], 0
s_add_u32 s44, s44, 4096
v_exp_f32 v50, v50
v_mfma_f32_16x16x32_bf16 v[124:127], a[216:219], v[244:247], 0
buffer_store_dwordx4 a[228:231], v248, s[20:23], s92 offen sc0 sc1
v_mfma_f32_16x16x32_bf16 v[128:131], a[220:223], v[244:247], 0
v_exp_f32 v51, v51
v_mfma_f32_16x16x32_bf16 v[132:135], a[224:227], v[244:247], 0
v_cvt_pk_bf16_f32 v93, v50, v51
v_mfma_f32_16x16x32_bf16 v[24:27], a[128:131], v[184:187], v[144:147]
v_exp_f32 v52, v52
v_mfma_f32_16x16x32_bf16 v[24:27], a[132:135], v[188:191], v[24:27]
v_mfma_f32_16x16x32_bf16 v[24:27], a[136:139], v[192:195], v[24:27]
s_add_u32 s48, s90, 0
v_exp_f32 v53, v53
v_mfma_f32_16x16x32_bf16 v[24:27], a[140:143], v[196:199], v[24:27]
buffer_store_dwordx4 v[104:107], v248, s[20:23], s48 offen sc0 sc1
v_mfma_f32_16x16x32_bf16 a[8:11], a[168:171], v[72:75], a[8:11]
v_cvt_pk_bf16_f32 v94, v52, v53
v_mfma_f32_16x16x32_bf16 a[40:43], a[168:171], v[76:79], a[40:43]
v_exp_f32 v54, v54
v_mfma_f32_16x16x32_bf16 a[72:75], a[168:171], v[80:83], a[72:75]
v_mfma_f32_16x16x32_bf16 a[104:107], a[168:171], v[84:87], a[104:107]
s_add_u32 s48, s90, 74240
v_exp_f32 v55, v55
v_mfma_f32_16x16x32_bf16 v[32:35], a[128:131], v[200:203], v[148:151]
buffer_store_dwordx4 v[108:111], v248, s[20:23], s48 offen sc0 sc1
v_mfma_f32_16x16x32_bf16 v[32:35], a[132:135], v[204:207], v[32:35]
v_exp_f32 v56, v56
v_mfma_f32_16x16x32_bf16 v[32:35], a[136:139], v[208:211], v[32:35]
ds_read_b64_tr_b16 a[168:169], v222 offset:57344
ds_read_b64_tr_b16 a[170:171], v222 offset:61440
v_mfma_f32_16x16x32_bf16 v[32:35], a[140:143], v[212:215], v[32:35]
v_exp_f32 v57, v57
v_mfma_f32_16x16x32_bf16 a[12:15], a[172:175], v[72:75], a[12:15]
ds_read_b128 a[128:131], v216 offset:8192
ds_read_b128 a[132:135], v217 offset:8192
v_mfma_f32_16x16x32_bf16 a[44:47], a[172:175], v[76:79], a[44:47]
s_add_u32 s48, s90, 148480
v_exp_f32 v58, v58
v_mfma_f32_16x16x32_bf16 a[76:79], a[172:175], v[80:83], a[76:79]
buffer_store_dwordx4 v[112:115], v248, s[20:23], s48 offen sc0 sc1
v_mfma_f32_16x16x32_bf16 a[108:111], a[172:175], v[84:87], a[108:111]
ds_read_b128 a[136:139], v218 offset:8192
ds_read_b128 a[140:143], v219 offset:8192
v_mfma_f32_16x16x32_bf16 v[12:15], a[144:147], v[152:155], v[136:139]
v_exp_f32 v59, v59
v_mfma_f32_16x16x32_bf16 v[12:15], a[148:151], v[156:159], v[12:15]
ds_read_b64_tr_b16 a[172:173], v223 offset:57344
ds_read_b64_tr_b16 a[174:175], v223 offset:61440
v_mfma_f32_16x16x32_bf16 v[12:15], a[152:155], v[160:163], v[12:15]
s_add_u32 s48, s90, 222720
v_exp_f32 v60, v60
v_mfma_f32_16x16x32_bf16 v[12:15], a[156:159], v[164:167], v[12:15]
buffer_store_dwordx4 v[116:119], v248, s[20:23], s48 offen sc0 sc1
v_mfma_f32_16x16x32_bf16 a[16:19], a[176:179], v[72:75], a[16:19]
v_exp_f32 v61, v61
v_mfma_f32_16x16x32_bf16 a[48:51], a[176:179], v[76:79], a[48:51]
v_cvt_pk_bf16_f32 v95, v54, v55
v_cvt_pk_bf16_f32 v96, v56, v57
v_mfma_f32_16x16x32_bf16 a[80:83], a[176:179], v[80:83], a[80:83]
v_exp_f32 v62, v62
v_mfma_f32_16x16x32_bf16 a[112:115], a[176:179], v[84:87], a[112:115]
ds_read_b64_tr_b16 a[176:177], v224 offset:57344
ds_read_b64_tr_b16 a[178:179], v224 offset:61440
v_mfma_f32_16x16x32_bf16 v[20:23], a[144:147], v[168:171], v[140:143]
s_add_u32 s48, s90, 296960
buffer_store_dwordx4 v[120:123], v248, s[20:23], s48 offen sc0 sc1
v_mfma_f32_16x16x32_bf16 v[20:23], a[148:151], v[172:175], v[20:23]
v_exp_f32 v63, v63
v_mfma_f32_16x16x32_bf16 v[20:23], a[152:155], v[176:179], v[20:23]
v_cvt_pk_bf16_f32 v97, v58, v59
v_cvt_pk_bf16_f32 v98, v60, v61
v_mfma_f32_16x16x32_bf16 v[20:23], a[156:159], v[180:183], v[20:23]
v_exp_f32 v64, v64
v_mfma_f32_16x16x32_bf16 a[20:23], a[180:183], v[72:75], a[20:23]
ds_write_b32 v6, v5
v_cvt_pk_bf16_f32 v99, v62, v63
v_mfma_f32_16x16x32_bf16 a[52:55], a[180:183], v[76:79], a[52:55]
s_add_u32 s48, s90, 371200
v_exp_f32 v65, v65
v_mfma_f32_16x16x32_bf16 a[84:87], a[180:183], v[80:83], a[84:87]
buffer_store_dwordx4 v[124:127], v248, s[20:23], s48 offen sc0 sc1
v_mfma_f32_16x16x32_bf16 a[116:119], a[180:183], v[84:87], a[116:119]
v_exp_f32 v66, v66
v_smfmac_f32_16x16x64_bf16 a[252:255], a[208:211], v[80:87], v235
ds_read_b64_tr_b16 a[180:181], v225 offset:57344
ds_read_b64_tr_b16 a[182:183], v225 offset:61440
v_mfma_f32_16x16x32_bf16 v[28:31], a[144:147], v[184:187], v[144:147]
v_exp_f32 v67, v67
v_mfma_f32_16x16x32_bf16 v[28:31], a[148:151], v[188:191], v[28:31]
v_cvt_pk_bf16_f32 v100, v64, v65
v_cvt_pk_bf16_f32 v101, v66, v67
v_mfma_f32_16x16x32_bf16 v[28:31], a[152:155], v[192:195], v[28:31]
s_add_u32 s48, s90, 445440
buffer_store_dwordx4 v[128:131], v248, s[20:23], s48 offen sc0 sc1
v_mfma_f32_16x16x32_bf16 v[28:31], a[156:159], v[196:199], v[28:31]
v_exp_f32 v68, v68
v_mfma_f32_16x16x32_bf16 a[24:27], a[184:187], v[72:75], a[24:27]
v_mfma_f32_16x16x32_bf16 a[56:59], a[184:187], v[76:79], a[56:59]
v_exp_f32 v69, v69
v_mfma_f32_16x16x32_bf16 a[88:91], a[184:187], v[80:83], a[88:91]
v_cvt_pk_bf16_f32 v102, v68, v69
v_mfma_f32_16x16x32_bf16 a[120:123], a[184:187], v[84:87], a[120:123]
s_add_u32 s48, s90, 519680
v_exp_f32 v70, v70
v_mfma_f32_16x16x32_bf16 v[36:39], a[144:147], v[200:203], v[148:151]
buffer_store_dwordx4 v[132:135], v248, s[20:23], s48 offen sc0 sc1
v_mfma_f32_16x16x32_bf16 v[36:39], a[148:151], v[204:207], v[36:39]
v_exp_f32 v71, v71
v_mfma_f32_16x16x32_bf16 v[36:39], a[152:155], v[208:211], v[36:39]
ds_read_b64_tr_b16 a[184:185], v226 offset:57344
ds_read_b64_tr_b16 a[186:187], v226 offset:61440
v_mfma_f32_16x16x32_bf16 v[36:39], a[156:159], v[212:215], v[36:39]
ds_read_b128 a[144:147], v216 offset:12288
ds_read_b128 a[148:151], v217 offset:12288
v_mfma_f32_16x16x32_bf16 a[28:31], a[188:191], v[72:75], a[28:31]
ds_read_b128 a[152:155], v218 offset:12288
ds_read_b128 a[156:159], v219 offset:12288
v_mfma_f32_16x16x32_bf16 a[60:63], a[188:191], v[76:79], a[60:63]
v_cvt_pk_bf16_f32 v103, v70, v71
v_mfma_f32_16x16x32_bf16 a[92:95], a[188:191], v[80:83], a[92:95]
v_mfma_f32_16x16x32_bf16 a[124:127], a[188:191], v[84:87], a[124:127]
s_waitcnt lgkmcnt(6)
ds_read_b64_tr_b16 a[188:189], v227 offset:57344
ds_read_b64_tr_b16 a[190:191], v227 offset:61440
v_mfma_f32_16x16x32_bf16 v[40:43], a[128:131], v[152:155], v[136:139]
v_exp_f32 v8, v8
v_mfma_f32_16x16x32_bf16 v[40:43], a[132:135], v[156:159], v[40:43]
v_exp_f32 v9, v9
v_mfma_f32_16x16x32_bf16 v[40:43], a[136:139], v[160:163], v[40:43]
v_cvt_pk_bf16_f32 v72, v8, v9
v_mfma_f32_16x16x32_bf16 v[40:43], a[140:143], v[164:167], v[40:43]
v_exp_f32 v10, v10
v_mfma_f32_16x16x32_bf16 a[0:3], a[160:163], v[88:91], a[0:3]
v_mfma_f32_16x16x32_bf16 a[32:35], a[160:163], v[92:95], a[32:35]
v_exp_f32 v11, v11
s_waitcnt vmcnt(13) lgkmcnt(0)
s_barrier
v_mfma_f32_16x16x32_bf16 a[64:67], a[160:163], v[96:99], a[64:67]
v_cvt_pk_bf16_f32 v73, v10, v11
v_mfma_f32_16x16x32_bf16 a[96:99], a[160:163], v[100:103], a[96:99]
s_add_u32 m0, s37, 98304
v_exp_f32 v12, v12
v_mfma_f32_16x16x32_bf16 v[48:51], a[128:131], v[168:171], v[140:143]
buffer_load_dwordx4 v232, s[12:15], s39 offen offset:0 lds
v_mfma_f32_16x16x32_bf16 v[48:51], a[132:135], v[172:175], v[48:51]
v_exp_f32 v13, v13
v_mfma_f32_16x16x32_bf16 v[48:51], a[136:139], v[176:179], v[48:51]
ds_read_b64_tr_b16 a[160:161], v220 offset:0
ds_read_b64_tr_b16 a[162:163], v220 offset:4096
v_mfma_f32_16x16x32_bf16 v[48:51], a[140:143], v[180:183], v[48:51]
v_exp_f32 v14, v14
v_mfma_f32_16x16x32_bf16 a[4:7], a[164:167], v[88:91], a[4:7]
v_cvt_pk_bf16_f32 v74, v12, v13
v_mfma_f32_16x16x32_bf16 a[36:39], a[164:167], v[92:95], a[36:39]
v_exp_f32 v15, v15
v_mfma_f32_16x16x32_bf16 a[68:71], a[164:167], v[96:99], a[68:71]
v_cvt_pk_bf16_f32 v75, v14, v15
v_mfma_f32_16x16x32_bf16 a[100:103], a[164:167], v[100:103], a[100:103]
v_exp_f32 v16, v16
v_smfmac_f32_16x16x64_bf16 a[248:251], a[208:211], v[88:95], v235
buffer_load_dwordx4 v233, s[12:15], s39 offen offset:1024 lds
v_mfma_f32_16x16x32_bf16 v[56:59], a[128:131], v[184:187], v[144:147]
v_exp_f32 v17, v17
v_mfma_f32_16x16x32_bf16 v[56:59], a[132:135], v[188:191], v[56:59]
ds_read_b64_tr_b16 a[164:165], v221 offset:0
ds_read_b64_tr_b16 a[166:167], v221 offset:4096
v_mfma_f32_16x16x32_bf16 v[56:59], a[136:139], v[192:195], v[56:59]
v_exp_f32 v18, v18
v_mfma_f32_16x16x32_bf16 v[56:59], a[140:143], v[196:199], v[56:59]
v_cvt_pk_bf16_f32 v76, v16, v17
v_mfma_f32_16x16x32_bf16 a[8:11], a[168:171], v[88:91], a[8:11]
v_exp_f32 v19, v19
v_mfma_f32_16x16x32_bf16 a[40:43], a[168:171], v[92:95], a[40:43]
v_cvt_pk_bf16_f32 v77, v18, v19
v_mfma_f32_16x16x32_bf16 a[72:75], a[168:171], v[96:99], a[72:75]
v_exp_f32 v20, v20
v_mfma_f32_16x16x32_bf16 a[104:107], a[168:171], v[100:103], a[104:107]
ds_read_b64_tr_b16 a[168:169], v222 offset:0
ds_read_b64_tr_b16 a[170:171], v222 offset:4096
v_mfma_f32_16x16x32_bf16 v[64:67], a[128:131], v[200:203], v[148:151]
v_exp_f32 v21, v21
v_mfma_f32_16x16x32_bf16 v[64:67], a[132:135], v[204:207], v[64:67]
buffer_load_dwordx4 v232, s[12:15], s39 offen offset:2048 lds
v_mfma_f32_16x16x32_bf16 v[64:67], a[136:139], v[208:211], v[64:67]
v_exp_f32 v22, v22
v_mfma_f32_16x16x32_bf16 v[64:67], a[140:143], v[212:215], v[64:67]
ds_read_b128 a[128:131], v216 offset:49152
ds_read_b128 a[132:135], v217 offset:49152
v_mfma_f32_16x16x32_bf16 a[12:15], a[172:175], v[88:91], a[12:15]
v_exp_f32 v23, v23
v_mfma_f32_16x16x32_bf16 a[44:47], a[172:175], v[92:95], a[44:47]
ds_read_b128 a[136:139], v218 offset:49152
ds_read_b128 a[140:143], v219 offset:49152
v_mfma_f32_16x16x32_bf16 a[76:79], a[172:175], v[96:99], a[76:79]
v_exp_f32 v24, v24
v_mfma_f32_16x16x32_bf16 a[108:111], a[172:175], v[100:103], a[108:111]
v_exp_f32 v25, v25
v_mfma_f32_16x16x32_bf16 v[44:47], a[144:147], v[152:155], v[136:139]
ds_read_b64_tr_b16 a[172:173], v223 offset:0
ds_read_b64_tr_b16 a[174:175], v223 offset:4096
v_mfma_f32_16x16x32_bf16 v[44:47], a[148:151], v[156:159], v[44:47]
v_exp_f32 v26, v26
v_mfma_f32_16x16x32_bf16 v[44:47], a[152:155], v[160:163], v[44:47]
buffer_load_dwordx4 v233, s[12:15], s39 offen offset:3072 lds
v_mfma_f32_16x16x32_bf16 v[44:47], a[156:159], v[164:167], v[44:47]
v_exp_f32 v27, v27
v_mfma_f32_16x16x32_bf16 a[16:19], a[176:179], v[88:91], a[16:19]
v_cvt_pk_bf16_f32 v78, v20, v21
v_cvt_pk_bf16_f32 v79, v22, v23
v_mfma_f32_16x16x32_bf16 a[48:51], a[176:179], v[92:95], a[48:51]
v_exp_f32 v28, v28
v_mfma_f32_16x16x32_bf16 a[80:83], a[176:179], v[96:99], a[80:83]
v_cvt_pk_bf16_f32 v80, v24, v25
v_cvt_pk_bf16_f32 v81, v26, v27
v_mfma_f32_16x16x32_bf16 a[112:115], a[176:179], v[100:103], a[112:115]
v_exp_f32 v29, v29
v_mfma_f32_16x16x32_bf16 v[52:55], a[144:147], v[168:171], v[140:143]
ds_read_b64_tr_b16 a[176:177], v224 offset:0
ds_read_b64_tr_b16 a[178:179], v224 offset:4096
v_mfma_f32_16x16x32_bf16 v[52:55], a[148:151], v[172:175], v[52:55]
v_exp_f32 v30, v30
v_mfma_f32_16x16x32_bf16 v[52:55], a[152:155], v[176:179], v[52:55]
v_cvt_pk_bf16_f32 v82, v28, v29
v_mfma_f32_16x16x32_bf16 v[52:55], a[156:159], v[180:183], v[52:55]
s_add_u32 s39, s39, 16384
v_exp_f32 v31, v31
v_mfma_f32_16x16x32_bf16 a[20:23], a[180:183], v[88:91], a[20:23]
s_add_u32 m0, s37, 16384
v_cvt_pk_bf16_f32 v83, v30, v31
v_mfma_f32_16x16x32_bf16 a[52:55], a[180:183], v[92:95], a[52:55]
v_exp_f32 v32, v32
v_mfma_f32_16x16x32_bf16 a[84:87], a[180:183], v[96:99], a[84:87]
buffer_load_dwordx4 v228, s[8:11], s38 offen offset:0 lds
v_mfma_f32_16x16x32_bf16 a[116:119], a[180:183], v[100:103], a[116:119]
v_exp_f32 v33, v33
v_smfmac_f32_16x16x64_bf16 a[252:255], a[208:211], v[96:103], v235
ds_read_b64_tr_b16 a[180:181], v225 offset:0
ds_read_b64_tr_b16 a[182:183], v225 offset:4096
v_mfma_f32_16x16x32_bf16 v[60:63], a[144:147], v[184:187], v[144:147]
v_exp_f32 v34, v34
v_mfma_f32_16x16x32_bf16 v[60:63], a[148:151], v[188:191], v[60:63]
v_cvt_pk_bf16_f32 v84, v32, v33
v_mfma_f32_16x16x32_bf16 v[60:63], a[152:155], v[192:195], v[60:63]
v_exp_f32 v35, v35
v_mfma_f32_16x16x32_bf16 v[60:63], a[156:159], v[196:199], v[60:63]
buffer_load_dwordx4 v229, s[8:11], s38 offen offset:1024 lds
v_mfma_f32_16x16x32_bf16 a[24:27], a[184:187], v[88:91], a[24:27]
v_exp_f32 v36, v36
v_mfma_f32_16x16x32_bf16 a[56:59], a[184:187], v[92:95], a[56:59]
v_cvt_pk_bf16_f32 v85, v34, v35
v_mfma_f32_16x16x32_bf16 a[88:91], a[184:187], v[96:99], a[88:91]
v_exp_f32 v37, v37
v_mfma_f32_16x16x32_bf16 a[120:123], a[184:187], v[100:103], a[120:123]
ds_read_b64_tr_b16 a[184:185], v226 offset:0
ds_read_b64_tr_b16 a[186:187], v226 offset:4096
v_mfma_f32_16x16x32_bf16 v[68:71], a[144:147], v[200:203], v[148:151]
v_exp_f32 v38, v38
v_mfma_f32_16x16x32_bf16 v[68:71], a[148:151], v[204:207], v[68:71]
ds_read_b128 a[144:147], v216 offset:53248
ds_read_b128 a[148:151], v217 offset:53248
v_mfma_f32_16x16x32_bf16 v[68:71], a[152:155], v[208:211], v[68:71]
v_exp_f32 v39, v39
v_mfma_f32_16x16x32_bf16 v[68:71], a[156:159], v[212:215], v[68:71]
ds_read_b128 a[152:155], v218 offset:53248
ds_read_b128 a[156:159], v219 offset:53248
v_mfma_f32_16x16x32_bf16 a[28:31], a[188:191], v[88:91], a[28:31]
v_cvt_pk_bf16_f32 v86, v36, v37
v_cvt_pk_bf16_f32 v87, v38, v39
v_mfma_f32_16x16x32_bf16 a[60:63], a[188:191], v[92:95], a[60:63]
v_mfma_f32_16x16x32_bf16 a[92:95], a[188:191], v[96:99], a[92:95]
v_mfma_f32_16x16x32_bf16 a[124:127], a[188:191], v[100:103], a[124:127]
s_waitcnt lgkmcnt(6)
ds_read_b64_tr_b16 a[188:189], v227 offset:0
ds_read_b64_tr_b16 a[190:191], v227 offset:4096
s_waitcnt lgkmcnt(8)
s_branch K_B5
K_PUB:
s_mov_b32 s78, 0x4000
v_lshlrev_b32 v251, 7, v3
s_mov_b32 s42, 0x2000
s_mov_b32 s43, 0
s_cmp_lg_u32 s32, 0
s_cbranch_scc1 K_B4
v_mov_b32 v244, 1
s_and_b32 s46, s52, 15
s_lshl_b32 s46, s46, 7
s_add_u32 s46, s46, 0x272000
s_mov_b64 exec, 1
buffer_atomic_add v244, v234, s[20:23], s46 offen sc1
s_mov_b64 exec, -1
s_branch K_B4
K_RANK:
s_mov_b32 s46, 2
K_RANK1:
v_cmp_lt_u32 vcc, s92, v255
s_bcnt1_i32_b64 s48, vcc
s_cmp_lt_u32 s48, 8
s_cbranch_scc0 K_RANK2
v_mov_b32 v246, 0
v_cmp_lt_u32 vcc, s92, v104
v_addc_co_u32 v246, vcc, 0, v246, vcc
v_cmp_lt_u32 vcc, s92, v105
v_addc_co_u32 v246, vcc, 0, v246, vcc
v_cmp_lt_u32 vcc, s92, v106
v_addc_co_u32 v246, vcc, 0, v246, vcc
v_cmp_lt_u32 vcc, s92, v107
v_addc_co_u32 v246, vcc, 0, v246, vcc
v_cmp_lt_u32 vcc, s92, v108
v_addc_co_u32 v246, vcc, 0, v246, vcc
v_cmp_lt_u32 vcc, s92, v109
v_addc_co_u32 v246, vcc, 0, v246, vcc
v_cmp_lt_u32 vcc, s92, v110
v_addc_co_u32 v246, vcc, 0, v246, vcc
v_cmp_lt_u32 vcc, s92, v111
v_addc_co_u32 v246, vcc, 0, v246, vcc
v_cmp_lt_u32 vcc, s92, v112
v_addc_co_u32 v246, vcc, 0, v246, vcc
v_cmp_lt_u32 vcc, s92, v113
v_addc_co_u32 v246, vcc, 0, v246, vcc
v_cmp_lt_u32 vcc, s92, v114
v_addc_co_u32 v246, vcc, 0, v246, vcc
v_cmp_lt_u32 vcc, s92, v115
v_addc_co_u32 v246, vcc, 0, v246, vcc
v_cmp_lt_u32 vcc, s92, v116
v_addc_co_u32 v246, vcc, 0, v246, vcc
v_cmp_lt_u32 vcc, s92, v117
v_addc_co_u32 v246, vcc, 0, v246, vcc
v_cmp_lt_u32 vcc, s92, v118
v_addc_co_u32 v246, vcc, 0, v246, vcc
v_cmp_lt_u32 vcc, s92, v119
v_addc_co_u32 v246, vcc, 0, v246, vcc
v_cmp_lt_u32 vcc, s92, v120
v_addc_co_u32 v246, vcc, 0, v246, vcc
v_cmp_lt_u32 vcc, s92, v121
v_addc_co_u32 v246, vcc, 0, v246, vcc
v_cmp_lt_u32 vcc, s92, v122
v_addc_co_u32 v246, vcc, 0, v246, vcc
v_cmp_lt_u32 vcc, s92, v123
v_addc_co_u32 v246, vcc, 0, v246, vcc
v_cmp_lt_u32 vcc, s92, v124
v_addc_co_u32 v246, vcc, 0, v246, vcc
v_cmp_lt_u32 vcc, s92, v125
v_addc_co_u32 v246, vcc, 0, v246, vcc
v_cmp_lt_u32 vcc, s92, v126
v_addc_co_u32 v246, vcc, 0, v246, vcc
v_cmp_lt_u32 vcc, s92, v127
v_addc_co_u32 v246, vcc, 0, v246, vcc
v_cmp_lt_u32 vcc, s92, v128
v_addc_co_u32 v246, vcc, 0, v246, vcc
v_cmp_lt_u32 vcc, s92, v129
v_addc_co_u32 v246, vcc, 0, v246, vcc
v_cmp_lt_u32 vcc, s92, v130
v_addc_co_u32 v246, vcc, 0, v246, vcc
v_cmp_lt_u32 vcc, s92, v131
v_addc_co_u32 v246, vcc, 0, v246, vcc
v_cmp_lt_u32 vcc, s92, v132
v_addc_co_u32 v246, vcc, 0, v246, vcc
v_cmp_lt_u32 vcc, s92, v133
v_addc_co_u32 v246, vcc, 0, v246, vcc
v_cmp_lt_u32 vcc, s92, v134
v_addc_co_u32 v246, vcc, 0, v246, vcc
v_cmp_lt_u32 vcc, s92, v135
v_addc_co_u32 v246, vcc, 0, v246, vcc
s_mov_b32 s48, 0
v_cmp_lt_u32 vcc, 0, v246
s_bcnt1_i32_b64 s47, vcc
s_add_u32 s48, s48, s47
v_cmp_lt_u32 vcc, 1, v246
s_bcnt1_i32_b64 s47, vcc
s_add_u32 s48, s48, s47
v_cmp_lt_u32 vcc, 2, v246
s_bcnt1_i32_b64 s47, vcc
s_add_u32 s48, s48, s47
v_cmp_lt_u32 vcc, 3, v246
s_bcnt1_i32_b64 s47, vcc
s_add_u32 s48, s48, s47
v_cmp_lt_u32 vcc, 4, v246
s_bcnt1_i32_b64 s47, vcc
s_add_u32 s48, s48, s47
v_cmp_lt_u32 vcc, 5, v246
s_bcnt1_i32_b64 s47, vcc
s_add_u32 s48, s48, s47
v_cmp_lt_u32 vcc, 6, v246
s_bcnt1_i32_b64 s47, vcc
s_add_u32 s48, s48, s47
v_cmp_lt_u32 vcc, 7, v246
s_bcnt1_i32_b64 s47, vcc
s_add_u32 s48, s48, s47
s_cmp_lt_u32 s48, 8
s_cbranch_scc0 K_RANK2
s_and_b32 s47, s92, 0xffff
s_sub_u32 s47, 2048, s47
s_ashr_i32 s94, s92, 31
s_not_b32 s94, s94
s_or_b32 s94, s94, 0x80000000
s_xor_b32 s94, s94, s92
s_and_b32 s94, s94, 0xffff0000
v_mov_b32 v247, s94
v_mul_f32 v247, 0xbfb8aa3b, v247
v_exp_f32 v247, v247
s_nop 0
v_add_f32 v247, 1.0, v247
v_rcp_f32 v247, v247
s_nop 0
v_cvt_pk_bf16_f32 v247, v247, v247
v_lshlrev_b32 v247, 16, v247
v_or_b32 v247, 1, v247
v_mov_b32 v246, s47
s_lshl_b32 s48, s48, 3
s_add_u32 s48, s48, 0x270000
s_mov_b64 exec, 1
buffer_store_dword v246, v234, s[20:23], s48 offen offset:4 sc0 sc1
buffer_store_dword v247, v234, s[20:23], s48 offen offset:68 sc0 sc1
s_mov_b64 exec, -1
K_RANK2:
s_mov_b32 s92, s93
s_sub_u32 s46, s46, 1
s_cmp_lg_u32 s46, 0
s_cbranch_scc1 K_RANK1
s_branch K_RANKED
K_CODE_END:
K_FB:
s_mov_b32 s41, 1
s_waitcnt vmcnt(0) lgkmcnt(0)
s_barrier
v_mov_b32 v136, 0xff800000
v_mov_b32 v140, 0xff800000
v_mov_b32 v144, 0xff800000
v_mov_b32 v148, 0xff800000
s_mov_b32 s38, 0
s_mov_b32 s40, 32
K_FBLOOP:
s_add_u32 m0, s37, 0
s_nop 0
buffer_load_dwordx4 v228, s[8:11], s38 offen offset:0 lds
buffer_load_dwordx4 v229, s[8:11], s38 offen offset:1024 lds
buffer_load_dwordx4 v230, s[8:11], s38 offen offset:2048 lds
buffer_load_dwordx4 v231, s[8:11], s38 offen offset:3072 lds
s_add_u32 s38, s38, 16384
s_waitcnt vmcnt(0)
s_barrier
ds_read_b128 a[128:131], v216 offset:0
ds_read_b128 a[132:135], v217 offset:0
ds_read_b128 a[136:139], v218 offset:0
ds_read_b128 a[140:143], v219 offset:0
ds_read_b128 a[144:147], v216 offset:4096
ds_read_b128 a[148:151], v217 offset:4096
ds_read_b128 a[152:155], v218 offset:4096
ds_read_b128 a[156:159], v219 offset:4096
s_waitcnt lgkmcnt(0)
v_mfma_f32_16x16x32_bf16 v[8:11], a[128:131], v[152:155], 0
v_mfma_f32_16x16x32_bf16 v[8:11], a[132:135], v[156:159], v[8:11]
v_mfma_f32_16x16x32_bf16 v[8:11], a[136:139], v[160:163], v[8:11]
v_mfma_f32_16x16x32_bf16 v[8:11], a[140:143], v[164:167], v[8:11]
v_mfma_f32_16x16x32_bf16 v[12:15], a[144:147], v[152:155], 0
v_mfma_f32_16x16x32_bf16 v[12:15], a[148:151], v[156:159], v[12:15]
v_mfma_f32_16x16x32_bf16 v[12:15], a[152:155], v[160:163], v[12:15]
v_mfma_f32_16x16x32_bf16 v[12:15], a[156:159], v[164:167], v[12:15]
v_mfma_f32_16x16x32_bf16 v[16:19], a[128:131], v[168:171], 0
v_mfma_f32_16x16x32_bf16 v[16:19], a[132:135], v[172:175], v[16:19]
v_mfma_f32_16x16x32_bf16 v[16:19], a[136:139], v[176:179], v[16:19]
v_mfma_f32_16x16x32_bf16 v[16:19], a[140:143], v[180:183], v[16:19]
v_mfma_f32_16x16x32_bf16 v[20:23], a[144:147], v[168:171], 0
v_mfma_f32_16x16x32_bf16 v[20:23], a[148:151], v[172:175], v[20:23]
v_mfma_f32_16x16x32_bf16 v[20:23], a[152:155], v[176:179], v[20:23]
v_mfma_f32_16x16x32_bf16 v[20:23], a[156:159], v[180:183], v[20:23]
v_mfma_f32_16x16x32_bf16 v[24:27], a[128:131], v[184:187], 0
v_mfma_f32_16x16x32_bf16 v[24:27], a[132:135], v[188:191], v[24:27]
v_mfma_f32_16x16x32_bf16 v[24:27], a[136:139], v[192:195], v[24:27]
v_mfma_f32_16x16x32_bf16 v[24:27], a[140:143], v[196:199], v[24:27]
v_mfma_f32_16x16x32_bf16 v[28:31], a[144:147], v[184:187], 0
v_mfma_f32_16x16x32_bf16 v[28:31], a[148:151], v[188:191], v[28:31]
v_mfma_f32_16x16x32_bf16 v[28:31], a[152:155], v[192:195], v[28:31]
v_mfma_f32_16x16x32_bf16 v[28:31], a[156:159], v[196:199], v[28:31]
v_mfma_f32_16x16x32_bf16 v[32:35], a[128:131], v[200:203], 0
v_mfma_f32_16x16x32_bf16 v[32:35], a[132:135], v[204:207], v[32:35]
v_mfma_f32_16x16x32_bf16 v[32:35], a[136:139], v[208:211], v[32:35]
v_mfma_f32_16x16x32_bf16 v[32:35], a[140:143], v[212:215], v[32:35]
v_mfma_f32_16x16x32_bf16 v[36:39], a[144:147], v[200:203], 0
v_mfma_f32_16x16x32_bf16 v[36:39], a[148:151], v[204:207], v[36:39]
v_mfma_f32_16x16x32_bf16 v[36:39], a[152:155], v[208:211], v[36:39]
v_mfma_f32_16x16x32_bf16 v[36:39], a[156:159], v[212:215], v[36:39]
s_nop 7
v_max3_f32 v136, v136, v8, v9
v_max3_f32 v136, v136, v10, v11
v_max3_f32 v136, v136, v12, v13
v_max3_f32 v136, v136, v14, v15
v_max3_f32 v140, v140, v16, v17
v_max3_f32 v140, v140, v18, v19
v_max3_f32 v140, v140, v20, v21
v_max3_f32 v140, v140, v22, v23
v_max3_f32 v144, v144, v24, v25
v_max3_f32 v144, v144, v26, v27
v_max3_f32 v144, v144, v28, v29
v_max3_f32 v144, v144, v30, v31
v_max3_f32 v148, v148, v32, v33
v_max3_f32 v148, v148, v34, v35
v_max3_f32 v148, v148, v36, v37
v_max3_f32 v148, v148, v38, v39
ds_read_b128 a[128:131], v216 offset:8192
ds_read_b128 a[132:135], v217 offset:8192
ds_read_b128 a[136:139], v218 offset:8192
ds_read_b128 a[140:143], v219 offset:8192
ds_read_b128 a[144:147], v216 offset:12288
ds_read_b128 a[148:151], v217 offset:12288
ds_read_b128 a[152:155], v218 offset:12288
ds_read_b128 a[156:159], v219 offset:12288
s_waitcnt lgkmcnt(0)
v_mfma_f32_16x16x32_bf16 v[8:11], a[128:131], v[152:155], 0
v_mfma_f32_16x16x32_bf16 v[8:11], a[132:135], v[156:159], v[8:11]
v_mfma_f32_16x16x32_bf16 v[8:11], a[136:139], v[160:163], v[8:11]
v_mfma_f32_16x16x32_bf16 v[8:11], a[140:143], v[164:167], v[8:11]
v_mfma_f32_16x16x32_bf16 v[12:15], a[144:147], v[152:155], 0
v_mfma_f32_16x16x32_bf16 v[12:15], a[148:151], v[156:159], v[12:15]
v_mfma_f32_16x16x32_bf16 v[12:15], a[152:155], v[160:163], v[12:15]
v_mfma_f32_16x16x32_bf16 v[12:15], a[156:159], v[164:167], v[12:15]
v_mfma_f32_16x16x32_bf16 v[16:19], a[128:131], v[168:171], 0
v_mfma_f32_16x16x32_bf16 v[16:19], a[132:135], v[172:175], v[16:19]
v_mfma_f32_16x16x32_bf16 v[16:19], a[136:139], v[176:179], v[16:19]
v_mfma_f32_16x16x32_bf16 v[16:19], a[140:143], v[180:183], v[16:19]
v_mfma_f32_16x16x32_bf16 v[20:23], a[144:147], v[168:171], 0
v_mfma_f32_16x16x32_bf16 v[20:23], a[148:151], v[172:175], v[20:23]
v_mfma_f32_16x16x32_bf16 v[20:23], a[152:155], v[176:179], v[20:23]
v_mfma_f32_16x16x32_bf16 v[20:23], a[156:159], v[180:183], v[20:23]
v_mfma_f32_16x16x32_bf16 v[24:27], a[128:131], v[184:187], 0
v_mfma_f32_16x16x32_bf16 v[24:27], a[132:135], v[188:191], v[24:27]
v_mfma_f32_16x16x32_bf16 v[24:27], a[136:139], v[192:195], v[24:27]
v_mfma_f32_16x16x32_bf16 v[24:27], a[140:143], v[196:199], v[24:27]
v_mfma_f32_16x16x32_bf16 v[28:31], a[144:147], v[184:187], 0
v_mfma_f32_16x16x32_bf16 v[28:31], a[148:151], v[188:191], v[28:31]
v_mfma_f32_16x16x32_bf16 v[28:31], a[152:155], v[192:195], v[28:31]
v_mfma_f32_16x16x32_bf16 v[28:31], a[156:159], v[196:199], v[28:31]
v_mfma_f32_16x16x32_bf16 v[32:35], a[128:131], v[200:203], 0
v_mfma_f32_16x16x32_bf16 v[32:35], a[132:135], v[204:207], v[32:35]
v_mfma_f32_16x16x32_bf16 v[32:35], a[136:139], v[208:211], v[32:35]
v_mfma_f32_16x16x32_bf16 v[32:35], a[140:143], v[212:215], v[32:35]
v_mfma_f32_16x16x32_bf16 v[36:39], a[144:147], v[200:203], 0
v_mfma_f32_16x16x32_bf16 v[36:39], a[148:151], v[204:207], v[36:39]
v_mfma_f32_16x16x32_bf16 v[36:39], a[152:155], v[208:211], v[36:39]
v_mfma_f32_16x16x32_bf16 v[36:39], a[156:159], v[212:215], v[36:39]
s_nop 7
v_max3_f32 v136, v136, v8, v9
v_max3_f32 v136, v136, v10, v11
v_max3_f32 v136, v136, v12, v13
v_max3_f32 v136, v136, v14, v15
v_max3_f32 v140, v140, v16, v17
v_max3_f32 v140, v140, v18, v19
v_max3_f32 v140, v140, v20, v21
v_max3_f32 v140, v140, v22, v23
v_max3_f32 v144, v144, v24, v25
v_max3_f32 v144, v144, v26, v27
v_max3_f32 v144, v144, v28, v29
v_max3_f32 v144, v144, v30, v31
v_max3_f32 v148, v148, v32, v33
v_max3_f32 v148, v148, v34, v35
v_max3_f32 v148, v148, v36, v37
v_max3_f32 v148, v148, v38, v39
s_barrier
s_sub_u32 s40, s40, 1
s_cmp_lg_u32 s40, 0
s_cbranch_scc1 K_FBLOOP
v_mov_b32 v137, v136
s_nop 1
v_permlane16_swap_b32 v136, v137
v_max_f32 v136, v136, v137
v_mov_b32 v137, v136
s_nop 1
v_permlane32_swap_b32 v136, v137
v_max_f32 v136, v136, v137
v_sub_f32 v139, 0, v136
v_sub_f32 v138, 0, v136
v_sub_f32 v137, 0, v136
v_sub_f32 v136, 0, v136
v_mov_b32 v141, v140
s_nop 1
v_permlane16_swap_b32 v140, v141
v_max_f32 v140, v140, v141
v_mov_b32 v141, v140
s_nop 1
v_permlane32_swap_b32 v140, v141
v_max_f32 v140, v140, v141
v_sub_f32 v143, 0, v140
v_sub_f32 v142, 0, v140
v_sub_f32 v141, 0, v140
v_sub_f32 v140, 0, v140
v_mov_b32 v145, v144
s_nop 1
v_permlane16_swap_b32 v144, v145
v_max_f32 v144, v144, v145
v_mov_b32 v145, v144
s_nop 1
v_permlane32_swap_b32 v144, v145
v_max_f32 v144, v144, v145
v_sub_f32 v147, 0, v144
v_sub_f32 v146, 0, v144
v_sub_f32 v145, 0, v144
v_sub_f32 v144, 0, v144
v_mov_b32 v149, v148
s_nop 1
v_permlane16_swap_b32 v148, v149
v_max_f32 v148, v148, v149
v_mov_b32 v149, v148
s_nop 1
v_permlane32_swap_b32 v148, v149
v_max_f32 v148, v148, v149
v_sub_f32 v151, 0, v148
v_sub_f32 v150, 0, v148
v_sub_f32 v149, 0, v148
v_sub_f32 v148, 0, v148
s_mov_b32 s38, 0
s_add_u32 m0, s37, 32768
s_nop 0
buffer_load_dwordx4 v228, s[8:11], s38 offen offset:0 lds
buffer_load_dwordx4 v229, s[8:11], s38 offen offset:1024 lds
buffer_load_dwordx4 v230, s[8:11], s38 offen offset:2048 lds
buffer_load_dwordx4 v231, s[8:11], s38 offen offset:3072 lds
s_add_u32 s38, s38, 16384
s_add_u32 m0, s37, 16384
s_nop 0
buffer_load_dwordx4 v228, s[8:11], s38 offen offset:0 lds
buffer_load_dwordx4 v229, s[8:11], s38 offen offset:1024 lds
buffer_load_dwordx4 v230, s[8:11], s38 offen offset:2048 lds
buffer_load_dwordx4 v231, s[8:11], s38 offen offset:3072 lds
s_add_u32 s38, s38, 16384
s_add_u32 m0, s37, 0
s_nop 0
buffer_load_dwordx4 v228, s[8:11], s38 offen offset:0 lds
buffer_load_dwordx4 v229, s[8:11], s38 offen offset:1024 lds
buffer_load_dwordx4 v230, s[8:11], s38 offen offset:2048 lds
buffer_load_dwordx4 v231, s[8:11], s38 offen offset:3072 lds
s_add_u32 s38, s38, 16384
s_mov_b32 s39, 0
s_add_u32 m0, s37, 98304
s_nop 0
buffer_load_dwordx4 v232, s[12:15], s39 offen offset:0 lds
buffer_load_dwordx4 v233, s[12:15], s39 offen offset:1024 lds
buffer_load_dwordx4 v232, s[12:15], s39 offen offset:2048 lds
buffer_load_dwordx4 v233, s[12:15], s39 offen offset:3072 lds
s_add_u32 s39, s39, 16384
s_add_u32 m0, s37, 114688
s_nop 0
buffer_load_dwordx4 v232, s[12:15], s39 offen offset:0 lds
buffer_load_dwordx4 v233, s[12:15], s39 offen offset:1024 lds
buffer_load_dwordx4 v232, s[12:15], s39 offen offset:2048 lds
buffer_load_dwordx4 v233, s[12:15], s39 offen offset:3072 lds
s_add_u32 s39, s39, 16384
s_mov_b32 s78, 0
s_mov_b32 s42, 0
s_mov_b32 s43, 0
s_mov_b32 s44, 0x100000
s_mov_b32 s74, 0x100
s_mov_b32 s97, 0
s_mov_b32 s40, 0
v_accvgpr_write_b32 a0, 0
v_accvgpr_write_b32 a1, 0
v_accvgpr_write_b32 a2, 0
v_accvgpr_write_b32 a3, 0
v_accvgpr_write_b32 a4, 0
v_accvgpr_write_b32 a5, 0
v_accvgpr_write_b32 a6, 0
v_accvgpr_write_b32 a7, 0
v_accvgpr_write_b32 a8, 0
v_accvgpr_write_b32 a9, 0
v_accvgpr_write_b32 a10, 0
v_accvgpr_write_b32 a11, 0
v_accvgpr_write_b32 a12, 0
v_accvgpr_write_b32 a13, 0
v_accvgpr_write_b32 a14, 0
v_accvgpr_write_b32 a15, 0
v_accvgpr_write_b32 a16, 0
v_accvgpr_write_b32 a17, 0
v_accvgpr_write_b32 a18, 0
v_accvgpr_write_b32 a19, 0
v_accvgpr_write_b32 a20, 0
v_accvgpr_write_b32 a21, 0
v_accvgpr_write_b32 a22, 0
v_accvgpr_write_b32 a23, 0
v_accvgpr_write_b32 a24, 0
v_accvgpr_write_b32 a25, 0
v_accvgpr_write_b32 a26, 0
v_accvgpr_write_b32 a27, 0
v_accvgpr_write_b32 a28, 0
v_accvgpr_write_b32 a29, 0
v_accvgpr_write_b32 a30, 0
v_accvgpr_write_b32 a31, 0
v_accvgpr_write_b32 a32, 0
v_accvgpr_write_b32 a33, 0
v_accvgpr_write_b32 a34, 0
v_accvgpr_write_b32 a35, 0
v_accvgpr_write_b32 a36, 0
v_accvgpr_write_b32 a37, 0
v_accvgpr_write_b32 a38, 0
v_accvgpr_write_b32 a39, 0
v_accvgpr_write_b32 a40, 0
v_accvgpr_write_b32 a41, 0
v_accvgpr_write_b32 a42, 0
v_accvgpr_write_b32 a43, 0
v_accvgpr_write_b32 a44, 0
v_accvgpr_write_b32 a45, 0
v_accvgpr_write_b32 a46, 0
v_accvgpr_write_b32 a47, 0
v_accvgpr_write_b32 a48, 0
v_accvgpr_write_b32 a49, 0
v_accvgpr_write_b32 a50, 0
v_accvgpr_write_b32 a51, 0
v_accvgpr_write_b32 a52, 0
v_accvgpr_write_b32 a53, 0
v_accvgpr_write_b32 a54, 0
v_accvgpr_write_b32 a55, 0
v_accvgpr_write_b32 a56, 0
v_accvgpr_write_b32 a57, 0
v_accvgpr_write_b32 a58, 0
v_accvgpr_write_b32 a59, 0
v_accvgpr_write_b32 a60, 0
v_accvgpr_write_b32 a61, 0
v_accvgpr_write_b32 a62, 0
v_accvgpr_write_b32 a63, 0
v_accvgpr_write_b32 a64, 0
v_accvgpr_write_b32 a65, 0
v_accvgpr_write_b32 a66, 0
v_accvgpr_write_b32 a67, 0
v_accvgpr_write_b32 a68, 0
v_accvgpr_write_b32 a69, 0
v_accvgpr_write_b32 a70, 0
v_accvgpr_write_b32 a71, 0
v_accvgpr_write_b32 a72, 0
v_accvgpr_write_b32 a73, 0
v_accvgpr_write_b32 a74, 0
v_accvgpr_write_b32 a75, 0
v_accvgpr_write_b32 a76, 0
v_accvgpr_write_b32 a77, 0
v_accvgpr_write_b32 a78, 0
v_accvgpr_write_b32 a79, 0
v_accvgpr_write_b32 a80, 0
v_accvgpr_write_b32 a81, 0
v_accvgpr_write_b32 a82, 0
v_accvgpr_write_b32 a83, 0
v_accvgpr_write_b32 a84, 0
v_accvgpr_write_b32 a85, 0
v_accvgpr_write_b32 a86, 0
v_accvgpr_write_b32 a87, 0
v_accvgpr_write_b32 a88, 0
v_accvgpr_write_b32 a89, 0
v_accvgpr_write_b32 a90, 0
v_accvgpr_write_b32 a91, 0
v_accvgpr_write_b32 a92, 0
v_accvgpr_write_b32 a93, 0
v_accvgpr_write_b32 a94, 0
v_accvgpr_write_b32 a95, 0
v_accvgpr_write_b32 a96, 0
v_accvgpr_write_b32 a97, 0
v_accvgpr_write_b32 a98, 0
v_accvgpr_write_b32 a99, 0
v_accvgpr_write_b32 a100, 0
v_accvgpr_write_b32 a101, 0
v_accvgpr_write_b32 a102, 0
v_accvgpr_write_b32 a103, 0
v_accvgpr_write_b32 a104, 0
v_accvgpr_write_b32 a105, 0
v_accvgpr_write_b32 a106, 0
v_accvgpr_write_b32 a107, 0
v_accvgpr_write_b32 a108, 0
v_accvgpr_write_b32 a109, 0
v_accvgpr_write_b32 a110, 0
v_accvgpr_write_b32 a111, 0
v_accvgpr_write_b32 a112, 0
v_accvgpr_write_b32 a113, 0
v_accvgpr_write_b32 a114, 0
v_accvgpr_write_b32 a115, 0
v_accvgpr_write_b32 a116, 0
v_accvgpr_write_b32 a117, 0
v_accvgpr_write_b32 a118, 0
v_accvgpr_write_b32 a119, 0
v_accvgpr_write_b32 a120, 0
v_accvgpr_write_b32 a121, 0
v_accvgpr_write_b32 a122, 0
v_accvgpr_write_b32 a123, 0
v_accvgpr_write_b32 a124, 0
v_accvgpr_write_b32 a125, 0
v_accvgpr_write_b32 a126, 0
v_accvgpr_write_b32 a127, 0
v_accvgpr_write_b32 a248, 0
v_accvgpr_write_b32 a249, 0
v_accvgpr_write_b32 a250, 0
v_accvgpr_write_b32 a251, 0
v_accvgpr_write_b32 a252, 0
v_accvgpr_write_b32 a253, 0
v_accvgpr_write_b32 a254, 0
v_accvgpr_write_b32 a255, 0
s_waitcnt vmcnt(0)
s_barrier
ds_read_b128 a[128:131], v216 offset:32768
ds_read_b128 a[132:135], v217 offset:32768
ds_read_b128 a[136:139], v218 offset:32768
ds_read_b128 a[140:143], v219 offset:32768
ds_read_b128 a[144:147], v216 offset:36864
ds_read_b128 a[148:151], v217 offset:36864
ds_read_b128 a[152:155], v218 offset:36864
ds_read_b128 a[156:159], v219 offset:36864
s_waitcnt lgkmcnt(0)
v_mfma_f32_16x16x32_bf16 v[8:11], a[128:131], v[152:155], 0
v_mfma_f32_16x16x32_bf16 v[8:11], a[132:135], v[156:159], v[8:11]
v_mfma_f32_16x16x32_bf16 v[8:11], a[136:139], v[160:163], v[8:11]
v_mfma_f32_16x16x32_bf16 v[8:11], a[140:143], v[164:167], v[8:11]
v_mfma_f32_16x16x32_bf16 v[12:15], a[144:147], v[152:155], 0
v_mfma_f32_16x16x32_bf16 v[12:15], a[148:151], v[156:159], v[12:15]
v_mfma_f32_16x16x32_bf16 v[12:15], a[152:155], v[160:163], v[12:15]
v_mfma_f32_16x16x32_bf16 v[12:15], a[156:159], v[164:167], v[12:15]
v_mfma_f32_16x16x32_bf16 v[16:19], a[128:131], v[168:171], 0
v_mfma_f32_16x16x32_bf16 v[16:19], a[132:135], v[172:175], v[16:19]
v_mfma_f32_16x16x32_bf16 v[16:19], a[136:139], v[176:179], v[16:19]
v_mfma_f32_16x16x32_bf16 v[16:19], a[140:143], v[180:183], v[16:19]
v_mfma_f32_16x16x32_bf16 v[20:23], a[144:147], v[168:171], 0
v_mfma_f32_16x16x32_bf16 v[20:23], a[148:151], v[172:175], v[20:23]
v_mfma_f32_16x16x32_bf16 v[20:23], a[152:155], v[176:179], v[20:23]
v_mfma_f32_16x16x32_bf16 v[20:23], a[156:159], v[180:183], v[20:23]
v_mfma_f32_16x16x32_bf16 v[24:27], a[128:131], v[184:187], 0
v_mfma_f32_16x16x32_bf16 v[24:27], a[132:135], v[188:191], v[24:27]
v_mfma_f32_16x16x32_bf16 v[24:27], a[136:139], v[192:195], v[24:27]
v_mfma_f32_16x16x32_bf16 v[24:27], a[140:143], v[196:199], v[24:27]
v_mfma_f32_16x16x32_bf16 v[28:31], a[144:147], v[184:187], 0
v_mfma_f32_16x16x32_bf16 v[28:31], a[148:151], v[188:191], v[28:31]
v_mfma_f32_16x16x32_bf16 v[28:31], a[152:155], v[192:195], v[28:31]
v_mfma_f32_16x16x32_bf16 v[28:31], a[156:159], v[196:199], v[28:31]
v_mfma_f32_16x16x32_bf16 v[32:35], a[128:131], v[200:203], 0
v_mfma_f32_16x16x32_bf16 v[32:35], a[132:135], v[204:207], v[32:35]
v_mfma_f32_16x16x32_bf16 v[32:35], a[136:139], v[208:211], v[32:35]
v_mfma_f32_16x16x32_bf16 v[32:35], a[140:143], v[212:215], v[32:35]
v_mfma_f32_16x16x32_bf16 v[36:39], a[144:147], v[200:203], 0
v_mfma_f32_16x16x32_bf16 v[36:39], a[148:151], v[204:207], v[36:39]
v_mfma_f32_16x16x32_bf16 v[36:39], a[152:155], v[208:211], v[36:39]
v_mfma_f32_16x16x32_bf16 v[36:39], a[156:159], v[212:215], v[36:39]
ds_read_b128 a[128:131], v216 offset:40960
ds_read_b128 a[132:135], v217 offset:40960
ds_read_b128 a[136:139], v218 offset:40960
ds_read_b128 a[140:143], v219 offset:40960
ds_read_b128 a[144:147], v216 offset:45056
ds_read_b128 a[148:151], v217 offset:45056
ds_read_b128 a[152:155], v218 offset:45056
ds_read_b128 a[156:159], v219 offset:45056
s_waitcnt lgkmcnt(0)
s_branch K_HAVEMAX
.section .rodata,"a"
.p2align 6
.amdhsa_kernel recurrent_scan__gqa_block_cached__moe_arch_mod__prompt_kernel
  .amdhsa_next_free_vgpr 512
  .amdhsa_next_free_sgpr 102
  .amdhsa_accum_offset 256
  .amdhsa_group_segment_fixed_size 0
  .amdhsa_kernarg_size 104
  .amdhsa_user_sgpr_count 2
  .amdhsa_user_sgpr_kernarg_segment_ptr 1
  .amdhsa_system_sgpr_workgroup_id_x 1
  .amdhsa_float_denorm_mode_32 3
.end_amdhsa_kernel
```

```asm
; @launch grid=(256,1,1) block=(256,1,1) lds=163840
.amdgcn_target "amdgcn-amd-amdhsa--gfx950"
.text
.globl recurrent_scan__gqa_block_cached__moe_arch_mod__prompt_kernel
.p2align 8
.type recurrent_scan__gqa_block_cached__moe_arch_mod__prompt_kernel,@function
recurrent_scan__gqa_block_cached__moe_arch_mod__prompt_kernel:
s_cmp_ge_u32 s2, 256
s_cbranch_scc1 K_END
s_getpc_b64 s[96:97]
v_lshlrev_b32 v7, 5, v0
global_load_dword a4, v7, s[96:97]
s_load_dwordx8 s[88:95], s[0:1], 0
s_load_dwordx2 s[86:87], s[0:1], 48
s_load_dwordx4 s[4:7], s[0:1], 88
v_and_b32 v1, 63, v0
v_lshrrev_b32 v5, 6, v0
s_bfe_u32 s35, s2, 0x20001
s_bfe_u32 s36, s2, 0x20003
v_readfirstlane_b32 s32, v5
s_lshl_b32 s33, s35, 2
s_add_u32 s33, s33, s36
s_and_b32 s34, s2, 1
s_lshl_b32 s34, s34, 3
s_lshr_b32 s46, s2, 5
s_add_u32 s34, s34, s46
s_lshl_b32 s46, s34, 7
s_lshl_b32 s47, s33, 3
s_add_u32 s3, s46, s47
v_lshrrev_b32 v8, 5, v0
v_add_u32 v8, s3, v8
v_and_b32 v9, 31, v0
v_mul_u32_u24 v11, 12, v9
v_mul_u32_u24 v10, 0x480, v8
v_add_u32 v10, v10, v11
v_lshrrev_b32 v5, 3, v1
v_and_b32 v6, 7, v1
v_xor_b32 v6, v6, v5
v_mul_u32_u24 v5, 0x480, v5
v_lshl_add_u32 v144, v6, 4, v5
v_add_u32 v145, 8192, v144
v_add_u32 v146, 18432, v144
v_add_u32 v147, 26624, v144
s_lshl_b32 s47, s32, 5
s_add_u32 s55, s46, s47
s_mul_i32 s43, s55, 1152
s_and_b32 s74, s34, 7
s_mul_i32 s74, s74, 1
s_mul_i32 s47, s36, 2
s_add_u32 s74, s74, s47
s_mul_i32 s47, s74, 57
s_lshr_b32 s47, s47, 9
s_mul_i32 s47, s47, 9
s_sub_u32 s74, s74, s47
s_movk_i32 s73, -1024
s_lshl_b32 s47, s74, 7
s_add_u32 s43, s43, s47
s_lshl_b32 s37, s32, 12
s_lshr_b32 s46, s35, 1
s_lshl_b32 s47, s46, 11
s_or_b32 s45, s37, s47
s_xor_b32 s85, s45, 2048
s_lshl_b32 s46, s46, 4
s_add_u32 s55, s55, s46
s_mov_b32 s26, 0x240000
s_mov_b32 s27, 0x00020000
s_waitcnt lgkmcnt(0)
s_mov_b32 s24, s88
s_and_b32 s25, s89, 0xffff
buffer_load_dwordx3 v[12:14], v10, s[24:27], 0 offen offset:0
buffer_load_dwordx3 v[16:18], v10, s[24:27], 0 offen offset:384
buffer_load_dwordx3 v[20:22], v10, s[24:27], 0 offen offset:768
s_mov_b32 s28, s86
s_and_b32 s29, s87, 0xffff
s_mov_b32 s30, 0x480
s_mov_b32 s31, 0x00020000
s_add_u32 m0, s45, 32768
s_nop 0
buffer_load_dwordx4 v144, s[24:27], s43 offen offset:0 lds
buffer_load_dwordx4 v145, s[24:27], s43 offen offset:1024 lds
s_add_u32 m0, s85, 32768
s_nop 0
buffer_load_dwordx4 v146, s[24:27], s43 offen offset:0 lds
buffer_load_dwordx4 v147, s[24:27], s43 offen offset:1024 lds
s_cmp_eq_u32 s74, 8
s_cselect_b32 s72, s73, 128
s_add_u32 s43, s43, s72
s_mov_b32 s16, s94
s_and_b32 s17, s95, 0xffff
s_mov_b32 s18, 0x480000
s_mov_b32 s19, 0x00020000
v_lshrrev_b32 v5, 5, v1
v_and_b32 v6, 31, v1
v_lshlrev_b32 v7, 1, v5
v_xor_b32 v6, v6, v7
v_lshlrev_b32 v6, 4, v6
v_lshl_add_u32 v136, v5, 13, v6
s_lshl_b32 s42, s33, 9
s_lshl_b32 s46, s32, 17
s_add_u32 s42, s42, s46
s_lshl_b32 s44, s32, 13
s_lshl_b32 s46, s74, 19
s_add_u32 s42, s42, s46
v_xor_b32 v137, 64, v136
v_add_u32 v137, 15360, v137
v_add_u32 v138, 30720, v136
v_xor_b32 v139, 64, v136
v_add_u32 v139, 46080, v139
v_xor_b32 v140, 128, v136
v_add_u32 v140, 65536, v140
v_xor_b32 v141, 192, v136
v_add_u32 v141, 80896, v141
v_xor_b32 v142, 128, v136
v_add_u32 v142, 96256, v142
v_xor_b32 v143, 192, v136
v_add_u32 v143, 111616, v143
s_add_u32 m0, s44, 0
s_nop 0
buffer_load_dwordx4 v136, s[16:19], s42 offen offset:0 lds
buffer_load_dwordx4 v137, s[16:19], s42 offen offset:1024 lds
buffer_load_dwordx4 v138, s[16:19], s42 offen offset:2048 lds
buffer_load_dwordx4 v139, s[16:19], s42 offen offset:3072 lds
s_add_u32 m0, s44, 4096
s_nop 0
buffer_load_dwordx4 v140, s[16:19], s42 offen offset:0 lds
s_load_dwordx2 s[68:69], s[0:1], 32
s_load_dwordx4 s[56:59], s[0:1], 56
s_load_dwordx4 s[64:67], s[0:1], 72
s_mov_b32 s100, 0
v_and_b32 v3, 15, v1
v_lshrrev_b32 v4, 4, v1
v_lshlrev_b32 v234, 4, v1
v_mov_b32 v255, 1
s_lshl_b32 s46, s33, 19
s_add_u32 s8, s90, s46
s_addc_u32 s9, s91, 0
s_and_b32 s9, s9, 0xffff
s_mov_b32 s10, 0x80000
s_mov_b32 s11, 0x00020000
s_add_u32 s12, s92, s46
s_addc_u32 s13, s93, 0
s_and_b32 s13, s13, 0xffff
s_mov_b32 s14, 0x80000
s_mov_b32 s15, 0x00020000
s_mov_b32 s20, s6
s_and_b32 s21, s7, 0xffff
s_mov_b32 s22, 0x4000000
s_mov_b32 s23, 0x00020000
v_bfe_u32 v248, v1, 2, 2
v_and_b32 v249, 3, v1
v_and_b32 v5, 1, v4
v_lshl_add_u32 v5, v5, 2, v248
s_lshl_b32 s46, s32, 1
v_xor_b32 v5, s46, v5
v_lshlrev_b32 v5, 5, v5
v_lshl_add_u32 v6, v4, 3, v248
v_lshl_add_u32 v5, v6, 9, v5
v_lshl_add_u32 v184, v249, 3, v5
v_xor_b32 v185, 32, v184
v_xor_b32 v186, 64, v184
v_xor_b32 v187, 96, v184
v_xor_b32 v188, 128, v184
v_xor_b32 v189, 160, v184
v_xor_b32 v190, 192, v184
v_xor_b32 v191, 224, v184
v_and_b32 v5, 7, v3
v_xor_b32 v5, v5, v4
v_lshlrev_b32 v5, 4, v5
v_lshl_add_u32 v5, v3, 7, v5
v_add_u32 v5, s37, v5
v_add_u32 v192, 0x8000, v5
v_xor_b32 v193, 64, v192
v_add_u32 v194, 0x18000, v184
v_add_u32 v195, 0x18000, v185
v_add_u32 v196, 0x18000, v186
v_add_u32 v197, 0x18000, v187
v_add_u32 v198, 0x18000, v188
v_add_u32 v199, 0x18000, v189
v_add_u32 v200, 0x18000, v190
v_add_u32 v201, 0x18000, v191
v_add_u32 v202, 0x18000, v192
v_add_u32 v203, 0x18000, v193
v_add_u32 v204, 0xc000, v184
v_add_u32 v205, 0xc000, v185
v_add_u32 v206, 0xc000, v186
v_add_u32 v207, 0xc000, v187
v_add_u32 v208, 0xc000, v188
v_add_u32 v209, 0xc000, v189
v_add_u32 v210, 0xc000, v190
v_add_u32 v211, 0xc000, v191
v_add_u32 v212, 0xc000, v192
v_add_u32 v213, 0xc000, v193
v_lshrrev_b32 v5, 1, v4
v_and_b32 v6, 7, v3
v_xor_b32 v5, v5, v6
v_lshlrev_b32 v5, 4, v5
v_lshl_add_u32 v5, v3, 7, v5
v_and_b32 v6, 1, v4
v_lshl_add_u32 v241, v6, 3, v5
s_lshl_b32 s83, s32, 11
s_add_u32 s83, s83, 155648
v_add_u32 v152, s83, v241
v_xor_b32 v153, 32, v152
v_xor_b32 v154, 64, v152
v_xor_b32 v155, 96, v152
v_bfe_u32 v5, v1, 1, 1
v_bfe_u32 v6, v1, 5, 1
v_cmp_eq_u32 vcc, v5, v6
v_mov_b32 v7, 0x3f803f80
v_and_b32 v5, 1, v1
v_cndmask_b32 v7, 0, v7, vcc
v_accvgpr_write_b32 a208, v7
v_accvgpr_write_b32 a209, v7
v_accvgpr_write_b32 a210, v7
v_accvgpr_write_b32 a211, v7
v_mul_u32_u24 v5, 0xaaaa, v5
v_add_u32 v235, 0x4444, v5
v_accvgpr_write_b32 a248, 0
v_accvgpr_write_b32 a249, 0
v_accvgpr_write_b32 a250, 0
v_accvgpr_write_b32 a251, 0
v_accvgpr_write_b32 a252, 0
v_accvgpr_write_b32 a253, 0
v_accvgpr_write_b32 a254, 0
v_accvgpr_write_b32 a255, 0
s_lshl_b32 s46, s34, 2
s_add_u32 s47, s46, s35
s_lshl_b32 s47, s47, 2
s_add_u32 s47, s47, s32
s_lshl_b32 s54, s47, 7
s_add_u32 s54, s54, 0x250000
s_add_u32 s47, s46, s36
s_lshl_b32 s47, s47, 2
s_add_u32 s47, s47, s32
s_lshl_b32 s47, s47, 7
s_add_u32 s47, s47, s35
s_lshl_b32 s47, s47, 2
s_add_u32 s38, s47, 0x280000
s_add_u32 s46, s46, s32
s_lshl_b32 s46, s46, 5
s_add_u32 s46, s46, s33
s_lshl_b32 s46, s46, 2
s_add_u32 s39, s46, 0x260000
s_lshl_b32 s46, s36, 3
s_add_u32 s46, s46, s54
s_add_u32 s47, s46, 4
v_lshl_add_u32 v60, v1, 7, s38
v_mov_b32 v61, 0
v_writelane_b32 v60, s46, 4
buffer_load_dwordx4 v141, s[16:19], s42 offen offset:1024 lds
v_writelane_b32 v60, s47, 5
v_writelane_b32 v60, s39, 6
s_lshl_b32 s46, s34, 2
s_add_u32 s46, s46, s35
s_lshl_b32 s46, s46, 3
s_add_u32 s46, s46, 0x270000
s_or_b32 s47, s36, s32
s_cselect_b32 s46, 0x7f000000, s46
v_writelane_b32 v60, s46, 7
s_add_u32 s46, s46, 4
v_writelane_b32 v60, s46, 8
s_lshl_b32 s47, s32, 8
s_or_b32 s47, s47, s2
s_lshl_b32 s46, s2, 7
s_add_u32 s46, s46, 0x272000
s_cmp_lt_u32 s47, 32
s_cselect_b32 s46, s46, 0x7f000000
v_writelane_b32 v60, s46, 9
s_getpc_b64 s[96:97]
PC_a:
s_sub_u32 s96, s96, PC_a-recurrent_scan__gqa_block_cached__moe_arch_mod__prompt_kernel
s_subb_u32 s97, s97, 0
s_lshr_b32 s46, s2, 3
s_lshl_b32 s46, s46, 2
s_add_u32 s46, s46, s32
s_min_u32 s46, s46, (K_CODE_END-recurrent_scan__gqa_block_cached__moe_arch_mod__prompt_kernel)>>10
s_lshl_b32 s46, s46, 10
v_lshlrev_b32 v7, 4, v1
buffer_load_dwordx4 v142, s[16:19], s42 offen offset:2048 lds
v_add_u32 v7, s46, v7
global_load_dwordx4 a[0:3], v7, s[96:97]
s_waitcnt lgkmcnt(0)
s_lshl_b32 s46, s32, 2
v_bfrev_b32 v5, v4
v_lshrrev_b32 v5, 30, v5
v_xor_b32 v5, s46, v5
v_xor_b32 v5, v5, v3
v_lshlrev_b32 v5, 4, v5
v_lshl_add_u32 v216, v3, 8, v5
v_xor_b32 v217, 64, v216
v_xor_b32 v218, 128, v216
v_xor_b32 v219, 192, v216
v_lshl_add_u32 v6, v4, 2, v248
v_and_b32 v5, 7, v6
v_lshlrev_b32 v5, 5, v5
v_lshl_add_u32 v5, v6, 8, v5
v_lshl_add_u32 v5, v249, 3, v5
v_add_u32 v220, 0x10000, v5
v_xor_b32 v221, 32, v220
v_xor_b32 v222, 64, v220
v_xor_b32 v223, 96, v220
v_xor_b32 v224, 128, v220
v_xor_b32 v225, 160, v220
buffer_load_dwordx4 v143, s[16:19], s42 offen offset:3072 lds
v_xor_b32 v226, 192, v220
v_xor_b32 v227, 224, v220
v_xor_b32 v5, v4, v3
v_lshlrev_b32 v5, 4, v5
v_lshl_add_u32 v5, v4, 8, v5
v_add_u32 v228, s37, v5
v_xor_b32 v229, 64, v228
v_xor_b32 v230, 128, v228
v_xor_b32 v231, 192, v228
v_lshlrev_b32 v5, 1, v4
v_xor_b32 v5, v5, v3
v_lshlrev_b32 v5, 4, v5
v_lshl_add_u32 v5, v4, 8, v5
v_add_u32 v232, s37, v5
v_xor_b32 v233, 128, v232
s_mov_b32 s41, 0
s_lshl_b32 s49, s32, 13
s_add_u32 s49, s49, 131072
s_lshl_b32 s3, s32, 10
s_lshl_b32 s53, s34, 4
s_add_u32 s53, s53, s33
s_lshl_b32 s53, s53, 2
s_add_u32 s53, s53, s32
s_lshl_b32 s53, s53, 14
s_add_u32 s53, s53, 0x400000
v_add_u32 v5, s46, v4
s_lshl_b32 s72, s72, 12
s_add_u32 s42, s42, s72
s_nop 0
buffer_load_dwordx3 v[24:26], v11, s[28:31], 0 offen offset:0
v_and_b32 v6, 7, v5
v_lshlrev_b32 v6, 1, v6
v_xor_b32 v6, v6, v3
v_mul_u32_u24 v5, 0x480, v5
v_lshl_add_u32 v236, v6, 4, v5
v_lshrrev_b32 v5, 3, v0
v_and_b32 v6, 6, v5
v_and_b32 v7, 7, v1
v_xor_b32 v6, v6, v7
v_mul_u32_u24 v5, 0x480, v5
v_lshl_add_u32 v237, v6, 4, v5
v_lshrrev_b32 v5, 2, v1
v_mul_u32_u24 v5, 0x2400, v5
v_lshl_add_u32 v238, v249, 4, v5
s_lshl_b32 s47, s36, 8
s_mul_i32 s84, s35, 1179648
s_add_u32 s84, s84, s47
s_mul_i32 s75, s33, 294912
s_add_u32 s51, s75, s47
s_add_u32 s75, s75, 1024
s_mov_b64 s[86:87], s[68:69]
s_mov_b64 s[88:89], s[56:57]
s_mov_b64 s[90:91], s[58:59]
s_mov_b32 s68, s66
s_and_b32 s69, s67, 0xffff
s_mov_b32 s70, 0x240000
s_mov_b32 s71, 0x00020000
s_mov_b32 s64, s64
s_and_b32 s65, s65, 0xffff
s_mov_b32 s66, 0x510000
s_mov_b32 s67, 0x00020000
s_mov_b32 s56, s88
s_and_b32 s57, s89, 0xffff
s_mov_b32 s58, 0x510000
s_mov_b32 s59, 0x00020000
s_mov_b32 s60, s90
s_and_b32 s61, s91, 0xffff
s_mov_b32 s62, 0x510000
s_mov_b32 s63, 0x00020000
s_mov_b32 s52, 0
s_and_b32 s82, s35, 1
s_lshl_b32 s82, s82, 7
s_mul_i32 s80, s55, 1152
s_lshl_b32 s46, s36, 5
s_add_u32 s81, s80, s46
s_add_u32 s81, s81, 1024
s_add_u32 s80, s80, s47
s_add_u32 s80, s80, s82
s_bitcmp1_b32 s35, 0
s_cselect_b32 s81, 0x7f000000, s81
v_mov_b32 v239, v144
buffer_load_dwordx3 v[28:30], v11, s[28:31], 0 offen offset:384
v_mul_u32_u24 v5, 0x480, v3
v_lshl_add_u32 v240, v4, 3, v5
v_min_u32 v243, 35, v1
v_lshlrev_b32 v243, 7, v243
v_lshlrev_b32 v251, 3, v1
s_mov_b32 s92, 0x3ae38e39
s_mov_b32 s93, 0x3727c5ac
s_mov_b32 s94, 0xffff0000
v_and_b32 v5, 3, v1
v_lshlrev_b32 v5, 21, v5
buffer_load_dword a7, v61, s[8:11], 0 offen
buffer_load_dwordx4 v[160:163], v234, s[12:15], 0 offen
buffer_load_dword a9, v5, s[16:19], 0 offen
s_mov_b64 exec, 0x3ff
buffer_store_dword v61, v60, s[20:23], 0 offen sc0 sc1
s_mov_b64 exec, -1
s_waitcnt vmcnt(19)
v_lshlrev_b32 v40, 16, v12
v_and_b32 v41, s94, v12
v_lshlrev_b32 v42, 16, v13
v_and_b32 v43, s94, v13
v_lshlrev_b32 v44, 16, v14
v_and_b32 v45, s94, v14
v_lshlrev_b32 v46, 16, v16
buffer_load_dwordx3 v[32:34], v11, s[28:31], 0 offen offset:768
v_and_b32 v47, s94, v16
v_lshlrev_b32 v48, 16, v17
v_and_b32 v49, s94, v17
v_lshlrev_b32 v50, 16, v18
v_and_b32 v51, s94, v18
v_lshlrev_b32 v52, 16, v20
v_and_b32 v53, s94, v20
v_lshlrev_b32 v54, 16, v21
v_and_b32 v55, s94, v21
v_lshlrev_b32 v56, 16, v22
v_and_b32 v57, s94, v22
v_pk_add_f32 v[64:65], v[40:41], v[42:43]
v_pk_add_f32 v[66:67], v[44:45], v[46:47]
v_pk_add_f32 v[64:65], v[64:65], v[48:49]
v_pk_add_f32 v[66:67], v[66:67], v[50:51]
v_pk_add_f32 v[64:65], v[64:65], v[52:53]
v_pk_add_f32 v[66:67], v[66:67], v[54:55]
v_pk_add_f32 v[64:65], v[64:65], v[56:57]
v_pk_add_f32 v[64:65], v[64:65], v[66:67]
v_add_f32 v64, v64, v65
s_nop 1
v_add_f32_dpp v65, v64, v64 row_ror:8 row_mask:0xf bank_mask:0xf
s_nop 1
v_add_f32_dpp v64, v65, v65 row_ror:4 row_mask:0xf bank_mask:0xf
s_add_u32 m0, s45, 131072
s_nop 0
buffer_load_dwordx4 v144, s[24:27], s43 offen offset:0 lds
s_nop 1
v_add_f32_dpp v65, v64, v64 row_ror:2 row_mask:0xf bank_mask:0xf
s_nop 1
v_add_f32_dpp v64, v65, v65 row_ror:1 row_mask:0xf bank_mask:0xf
v_mov_b32 v65, v64
s_nop 1
v_permlane16_swap_b32 v64, v65
v_add_f32 v64, v64, v65
v_mul_f32 v64, s92, v64
v_pk_add_f32 v[72:73], v[40:41], v[64:65] op_sel_hi:[1,0] neg_lo:[0,1] neg_hi:[0,1]
v_pk_add_f32 v[74:75], v[42:43], v[64:65] op_sel_hi:[1,0] neg_lo:[0,1] neg_hi:[0,1]
v_pk_add_f32 v[76:77], v[44:45], v[64:65] op_sel_hi:[1,0] neg_lo:[0,1] neg_hi:[0,1]
v_pk_add_f32 v[78:79], v[46:47], v[64:65] op_sel_hi:[1,0] neg_lo:[0,1] neg_hi:[0,1]
v_pk_add_f32 v[80:81], v[48:49], v[64:65] op_sel_hi:[1,0] neg_lo:[0,1] neg_hi:[0,1]
v_pk_add_f32 v[82:83], v[50:51], v[64:65] op_sel_hi:[1,0] neg_lo:[0,1] neg_hi:[0,1]
v_pk_add_f32 v[84:85], v[52:53], v[64:65] op_sel_hi:[1,0] neg_lo:[0,1] neg_hi:[0,1]
v_pk_add_f32 v[86:87], v[54:55], v[64:65] op_sel_hi:[1,0] neg_lo:[0,1] neg_hi:[0,1]
v_pk_add_f32 v[88:89], v[56:57], v[64:65] op_sel_hi:[1,0] neg_lo:[0,1] neg_hi:[0,1]
v_pk_mul_f32 v[66:67], v[72:73], v[72:73]
v_pk_mul_f32 v[68:69], v[74:75], v[74:75]
v_pk_fma_f32 v[66:67], v[76:77], v[76:77], v[66:67]
v_pk_fma_f32 v[68:69], v[78:79], v[78:79], v[68:69]
v_pk_fma_f32 v[66:67], v[80:81], v[80:81], v[66:67]
v_pk_fma_f32 v[68:69], v[82:83], v[82:83], v[68:69]
buffer_load_dwordx4 v145, s[24:27], s43 offen offset:1024 lds
v_pk_fma_f32 v[66:67], v[84:85], v[84:85], v[66:67]
v_pk_fma_f32 v[68:69], v[86:87], v[86:87], v[68:69]
v_pk_fma_f32 v[66:67], v[88:89], v[88:89], v[66:67]
v_pk_add_f32 v[66:67], v[66:67], v[68:69]
v_add_f32 v69, v66, v67
v_cvt_pk_bf16_f32 v64, v64, v64
v_lshlrev_b32 v64, 16, v64
v_pk_add_f32 v[40:41], v[40:41], v[64:65] op_sel_hi:[1,0] neg_lo:[0,1] neg_hi:[0,1]
v_cvt_pk_bf16_f32 v12, v40, v41
v_add_f32_dpp v68, v69, v69 row_ror:8 row_mask:0xf bank_mask:0xf
v_pk_add_f32 v[42:43], v[42:43], v[64:65] op_sel_hi:[1,0] neg_lo:[0,1] neg_hi:[0,1]
v_cvt_pk_bf16_f32 v13, v42, v43
v_add_f32_dpp v69, v68, v68 row_ror:4 row_mask:0xf bank_mask:0xf
v_pk_add_f32 v[44:45], v[44:45], v[64:65] op_sel_hi:[1,0] neg_lo:[0,1] neg_hi:[0,1]
v_cvt_pk_bf16_f32 v14, v44, v45
v_add_f32_dpp v68, v69, v69 row_ror:2 row_mask:0xf bank_mask:0xf
v_pk_add_f32 v[46:47], v[46:47], v[64:65] op_sel_hi:[1,0] neg_lo:[0,1] neg_hi:[0,1]
v_cvt_pk_bf16_f32 v16, v46, v47
v_add_f32_dpp v69, v68, v68 row_ror:1 row_mask:0xf bank_mask:0xf
v_mov_b32 v68, v69
v_pk_add_f32 v[48:49], v[48:49], v[64:65] op_sel_hi:[1,0] neg_lo:[0,1] neg_hi:[0,1]
v_cvt_pk_bf16_f32 v17, v48, v49
v_permlane16_swap_b32 v69, v68
v_add_f32 v69, v69, v68
s_add_u32 m0, s85, 131072
s_nop 0
buffer_load_dwordx4 v146, s[24:27], s43 offen offset:0 lds
v_mul_f32 v69, s92, v69
v_cvt_pk_bf16_f32 v69, v69, v69
v_lshlrev_b32 v69, 16, v69
v_add_f32 v69, s93, v69
v_cvt_pk_bf16_f32 v69, v69, v69
v_lshlrev_b32 v69, 16, v69
v_sqrt_f32 v69, v69
v_pk_add_f32 v[50:51], v[50:51], v[64:65] op_sel_hi:[1,0] neg_lo:[0,1] neg_hi:[0,1]
v_cvt_pk_bf16_f32 v18, v50, v51
v_cvt_pk_bf16_f32 v65, v69, v69
v_lshlrev_b32 v65, 16, v65
v_rcp_f32 v66, v65
v_pk_add_f32 v[52:53], v[52:53], v[64:65] op_sel_hi:[1,0] neg_lo:[0,1] neg_hi:[0,1]
v_cvt_pk_bf16_f32 v20, v52, v53
v_pk_add_f32 v[54:55], v[54:55], v[64:65] op_sel_hi:[1,0] neg_lo:[0,1] neg_hi:[0,1]
v_cvt_pk_bf16_f32 v21, v54, v55
v_pk_add_f32 v[56:57], v[56:57], v[64:65] op_sel_hi:[1,0] neg_lo:[0,1] neg_hi:[0,1]
v_cvt_pk_bf16_f32 v22, v56, v57
v_lshlrev_b32 v40, 16, v12
v_and_b32 v41, s94, v12
v_lshlrev_b32 v42, 16, v13
v_and_b32 v43, s94, v13
v_lshlrev_b32 v44, 16, v14
v_and_b32 v45, s94, v14
buffer_load_dwordx4 v147, s[24:27], s43 offen offset:1024 lds
v_lshlrev_b32 v46, 16, v16
v_and_b32 v47, s94, v16
v_lshlrev_b32 v48, 16, v17
v_and_b32 v49, s94, v17
v_lshlrev_b32 v50, 16, v18
v_and_b32 v51, s94, v18
v_lshlrev_b32 v52, 16, v20
v_and_b32 v53, s94, v20
v_lshlrev_b32 v54, 16, v21
v_and_b32 v55, s94, v21
v_lshlrev_b32 v56, 16, v22
v_and_b32 v57, s94, v22
v_lshlrev_b32 v5, 3, v8
s_mov_b32 s46, 0x240000
s_mov_b32 exec_lo, 1
s_mov_b32 exec_hi, 1
buffer_store_dwordx2 v[64:65], v5, s[20:23], s46 offen sc0 sc1
s_mov_b64 exec, -1
v_mov_b32 v70, 0
s_waitcnt lgkmcnt(0)
v_pk_mul_f32 v[72:73], v[40:41], v[66:67] op_sel_hi:[1,0]
v_pk_fma_f32 v[40:41], v[72:73], v[64:65], v[40:41] op_sel:[0,1,0] op_sel_hi:[1,1,1] neg_lo:[1,0,0] neg_hi:[1,0,0]
v_pk_fma_f32 v[72:73], v[40:41], v[66:67], v[72:73] op_sel_hi:[1,0,1]
v_cvt_pk_bf16_f32 v12, v72, v73
s_cmp_eq_u32 s74, 7
s_cselect_b32 s72, s73, 128
s_add_u32 s43, s43, s72
s_add_u32 m0, s44, 98304
s_nop 0
buffer_load_dwordx4 v136, s[16:19], s42 offen offset:0 lds
v_pk_mul_f32 v[74:75], v[42:43], v[66:67] op_sel_hi:[1,0]
v_pk_fma_f32 v[42:43], v[74:75], v[64:65], v[42:43] op_sel:[0,1,0] op_sel_hi:[1,1,1] neg_lo:[1,0,0] neg_hi:[1,0,0]
v_pk_fma_f32 v[74:75], v[42:43], v[66:67], v[74:75] op_sel_hi:[1,0,1]
v_cvt_pk_bf16_f32 v13, v74, v75
v_pk_mul_f32 v[76:77], v[44:45], v[66:67] op_sel_hi:[1,0]
v_pk_fma_f32 v[44:45], v[76:77], v[64:65], v[44:45] op_sel:[0,1,0] op_sel_hi:[1,1,1] neg_lo:[1,0,0] neg_hi:[1,0,0]
v_pk_fma_f32 v[76:77], v[44:45], v[66:67], v[76:77] op_sel_hi:[1,0,1]
v_cvt_pk_bf16_f32 v14, v76, v77
buffer_store_dwordx3 v[12:14], v10, s[20:23], 0 offen offset:0 sc0 sc1
v_pk_mul_f32 v[78:79], v[46:47], v[66:67] op_sel_hi:[1,0]
v_pk_fma_f32 v[46:47], v[78:79], v[64:65], v[46:47] op_sel:[0,1,0] op_sel_hi:[1,1,1] neg_lo:[1,0,0] neg_hi:[1,0,0]
v_pk_fma_f32 v[78:79], v[46:47], v[66:67], v[78:79] op_sel_hi:[1,0,1]
v_cvt_pk_bf16_f32 v16, v78, v79
v_pk_mul_f32 v[80:81], v[48:49], v[66:67] op_sel_hi:[1,0]
v_pk_fma_f32 v[48:49], v[80:81], v[64:65], v[48:49] op_sel:[0,1,0] op_sel_hi:[1,1,1] neg_lo:[1,0,0] neg_hi:[1,0,0]
v_pk_fma_f32 v[80:81], v[48:49], v[66:67], v[80:81] op_sel_hi:[1,0,1]
v_cvt_pk_bf16_f32 v17, v80, v81
v_pk_mul_f32 v[82:83], v[50:51], v[66:67] op_sel_hi:[1,0]
v_pk_fma_f32 v[50:51], v[82:83], v[64:65], v[50:51] op_sel:[0,1,0] op_sel_hi:[1,1,1] neg_lo:[1,0,0] neg_hi:[1,0,0]
v_pk_fma_f32 v[82:83], v[50:51], v[66:67], v[82:83] op_sel_hi:[1,0,1]
v_cvt_pk_bf16_f32 v18, v82, v83
buffer_store_dwordx3 v[16:18], v10, s[20:23], 0 offen offset:384 sc0 sc1
v_pk_mul_f32 v[84:85], v[52:53], v[66:67] op_sel_hi:[1,0]
v_pk_fma_f32 v[52:53], v[84:85], v[64:65], v[52:53] op_sel:[0,1,0] op_sel_hi:[1,1,1] neg_lo:[1,0,0] neg_hi:[1,0,0]
buffer_load_dwordx4 v137, s[16:19], s42 offen offset:1024 lds
v_pk_fma_f32 v[84:85], v[52:53], v[66:67], v[84:85] op_sel_hi:[1,0,1]
v_cvt_pk_bf16_f32 v20, v84, v85
v_pk_mul_f32 v[86:87], v[54:55], v[66:67] op_sel_hi:[1,0]
v_pk_fma_f32 v[54:55], v[86:87], v[64:65], v[54:55] op_sel:[0,1,0] op_sel_hi:[1,1,1] neg_lo:[1,0,0] neg_hi:[1,0,0]
v_pk_fma_f32 v[86:87], v[54:55], v[66:67], v[86:87] op_sel_hi:[1,0,1]
v_cvt_pk_bf16_f32 v21, v86, v87
v_pk_mul_f32 v[88:89], v[56:57], v[66:67] op_sel_hi:[1,0]
v_pk_fma_f32 v[56:57], v[88:89], v[64:65], v[56:57] op_sel:[0,1,0] op_sel_hi:[1,1,1] neg_lo:[1,0,0] neg_hi:[1,0,0]
v_pk_fma_f32 v[88:89], v[56:57], v[66:67], v[88:89] op_sel_hi:[1,0,1]
v_cvt_pk_bf16_f32 v22, v88, v89
buffer_store_dwordx3 v[20:22], v10, s[20:23], 0 offen offset:768 sc0 sc1
s_waitcnt vmcnt(10)
v_dot2_f32_bf16 v70, v12, v24, v70
v_dot2_f32_bf16 v70, v13, v25, v70
v_dot2_f32_bf16 v70, v14, v26, v70
v_dot2_f32_bf16 v70, v16, v28, v70
v_dot2_f32_bf16 v70, v17, v29, v70
v_dot2_f32_bf16 v70, v18, v30, v70
v_dot2_f32_bf16 v70, v20, v32, v70
v_dot2_f32_bf16 v70, v21, v33, v70
v_dot2_f32_bf16 v70, v22, v34, v70
v_sub_u32 v68, 2047, v8
v_lshlrev_b32 v5, 2, v8
s_nop 1
v_add_f32_dpp v71, v70, v70 row_ror:8 row_mask:0xf bank_mask:0xf
buffer_load_dwordx4 v138, s[16:19], s42 offen offset:2048 lds
s_nop 1
v_add_f32_dpp v70, v71, v71 row_ror:4 row_mask:0xf bank_mask:0xf
s_nop 1
v_add_f32_dpp v71, v70, v70 row_ror:2 row_mask:0xf bank_mask:0xf
s_nop 1
v_add_f32_dpp v70, v71, v71 row_ror:1 row_mask:0xf bank_mask:0xf
v_mov_b32 v71, v70
s_nop 1
v_permlane16_swap_b32 v70, v71
v_add_f32 v70, v70, v71
v_cvt_pk_bf16_f32 v70, v70, v70
v_ashrrev_i32 v71, 31, v70
v_or_b32 v71, 0x80000000, v71
v_xor_b32 v70, v70, v71
v_and_or_b32 v214, v70, s94, v68
buffer_load_dwordx4 v139, s[16:19], s42 offen offset:3072 lds
s_add_u32 m0, s44, 102400
s_nop 0
buffer_load_dwordx4 v140, s[16:19], s42 offen offset:0 lds
buffer_load_dwordx4 v141, s[16:19], s42 offen offset:1024 lds
buffer_load_dwordx4 v142, s[16:19], s42 offen offset:2048 lds
buffer_load_dwordx4 v143, s[16:19], s42 offen offset:3072 lds
s_lshl_b32 s72, s72, 12
s_add_u32 s42, s42, s72
s_mov_b32 s46, 0x244000
s_mov_b32 exec_lo, 1
s_mov_b32 exec_hi, 1
buffer_store_dword v214, v5, s[20:23], s46 offen sc0 sc1
s_mov_b64 exec, -1
s_mov_b32 s28, s4
s_and_b32 s29, s5, 0xffff
s_mov_b32 s30, 0x100
s_mov_b32 s31, 0x00020000
s_waitcnt vmcnt(24)
s_barrier
ds_read_b128 a[192:195], v192 offset:0
ds_read_b128 a[196:199], v192 offset:2048
ds_read_b64_tr_b16 a[128:129], v184 offset:0
ds_read_b64_tr_b16 a[130:131], v184 offset:2048
ds_read_b64_tr_b16 a[132:133], v185 offset:0
ds_read_b64_tr_b16 a[134:135], v185 offset:2048
ds_read_b64_tr_b16 a[160:161], v184 offset:256
ds_read_b64_tr_b16 a[162:163], v184 offset:2304
ds_read_b64_tr_b16 a[164:165], v185 offset:256
ds_read_b64_tr_b16 a[166:167], v185 offset:2304
ds_read_b64_tr_b16 a[136:137], v186 offset:0
ds_read_b64_tr_b16 a[138:139], v186 offset:2048
ds_read_b64_tr_b16 a[140:141], v187 offset:0
ds_read_b64_tr_b16 a[142:143], v187 offset:2048
ds_read_b64_tr_b16 a[144:145], v188 offset:0
ds_read_b64_tr_b16 a[146:147], v188 offset:2048
ds_read_b64_tr_b16 a[148:149], v189 offset:0
ds_read_b64_tr_b16 a[150:151], v189 offset:2048
ds_read_b64_tr_b16 a[152:153], v190 offset:0
ds_read_b64_tr_b16 a[154:155], v190 offset:2048
ds_read_b64_tr_b16 a[156:157], v191 offset:0
ds_read_b64_tr_b16 a[158:159], v191 offset:2048
ds_read_b64_tr_b16 a[168:169], v186 offset:256
ds_read_b64_tr_b16 a[170:171], v186 offset:2304
ds_read_b64_tr_b16 a[172:173], v187 offset:256
ds_read_b64_tr_b16 a[174:175], v187 offset:2304
ds_read_b64_tr_b16 a[176:177], v188 offset:256
ds_read_b64_tr_b16 a[178:179], v188 offset:2304
ds_read_b64_tr_b16 a[180:181], v189 offset:256
ds_read_b64_tr_b16 a[182:183], v189 offset:2304
ds_read_b64_tr_b16 a[184:185], v190 offset:256
ds_read_b64_tr_b16 a[186:187], v190 offset:2304
ds_read_b64_tr_b16 a[188:189], v191 offset:256
ds_read_b64_tr_b16 a[190:191], v191 offset:2304
s_waitcnt lgkmcnt(15)
v_mfma_f32_16x16x32_bf16 v[8:11], a[128:131], a[192:195], 0
ds_read_b128 a[200:203], v193 offset:0
ds_read_b128 a[204:207], v193 offset:2048
v_mfma_f32_16x16x32_bf16 v[40:43], a[128:131], a[196:199], 0
s_add_u32 m0, s45, 81920
v_mfma_f32_16x16x32_bf16 v[12:15], a[132:135], a[192:195], 0
buffer_load_dwordx4 v144, s[24:27], s43 offen offset:0 lds
v_mfma_f32_16x16x32_bf16 v[44:47], a[132:135], a[196:199], 0
v_smfmac_f32_16x16x64_bf16 a[248:251], a[208:211], a[128:135], v235
ds_read_b64_tr_b16 a[128:129], v184 offset:16384
ds_read_b64_tr_b16 a[130:131], v184 offset:18432
v_mfma_f32_16x16x32_bf16 v[72:75], a[160:163], a[192:195], 0
ds_read_b64_tr_b16 a[132:133], v185 offset:16384
ds_read_b64_tr_b16 a[134:135], v185 offset:18432
v_mfma_f32_16x16x32_bf16 v[104:107], a[160:163], a[196:199], 0
buffer_load_dwordx4 v145, s[24:27], s43 offen offset:1024 lds
v_mfma_f32_16x16x32_bf16 v[76:79], a[164:167], a[192:195], 0
v_mfma_f32_16x16x32_bf16 v[108:111], a[164:167], a[196:199], 0
v_smfmac_f32_16x16x64_bf16 a[252:255], a[208:211], a[160:167], v235
s_add_u32 m0, s85, 81920
ds_read_b64_tr_b16 a[160:161], v184 offset:16640
ds_read_b64_tr_b16 a[162:163], v184 offset:18688
v_mfma_f32_16x16x32_bf16 v[16:19], a[136:139], a[192:195], 0
buffer_load_dwordx4 v146, s[24:27], s43 offen offset:0 lds
v_mfma_f32_16x16x32_bf16 v[48:51], a[136:139], a[196:199], 0
ds_read_b64_tr_b16 a[164:165], v185 offset:16640
ds_read_b64_tr_b16 a[166:167], v185 offset:18688
v_mfma_f32_16x16x32_bf16 v[20:23], a[140:143], a[192:195], 0
ds_read_b64_tr_b16 a[136:137], v186 offset:16384
ds_read_b64_tr_b16 a[138:139], v186 offset:18432
v_mfma_f32_16x16x32_bf16 v[52:55], a[140:143], a[196:199], 0
ds_read_b64_tr_b16 a[140:141], v187 offset:16384
ds_read_b64_tr_b16 a[142:143], v187 offset:18432
v_mfma_f32_16x16x32_bf16 v[24:27], a[144:147], a[192:195], 0
buffer_load_dwordx4 v147, s[24:27], s43 offen offset:1024 lds
v_mfma_f32_16x16x32_bf16 v[56:59], a[144:147], a[196:199], 0
s_cmp_eq_u32 s74, 6
s_cselect_b32 s72, s73, 128
ds_read_b64_tr_b16 a[144:145], v188 offset:16384
ds_read_b64_tr_b16 a[146:147], v188 offset:18432
v_mfma_f32_16x16x32_bf16 v[28:31], a[148:151], a[192:195], 0
s_add_u32 s43, s43, s72
v_mfma_f32_16x16x32_bf16 v[60:63], a[148:151], a[196:199], 0
s_waitcnt lgkmcnt(10)
s_add_u32 m0, s44, 49152
ds_read_b64_tr_b16 a[148:149], v189 offset:16384
ds_read_b64_tr_b16 a[150:151], v189 offset:18432
v_mfma_f32_16x16x32_bf16 v[32:35], a[152:155], a[192:195], 0
buffer_load_dwordx4 v136, s[16:19], s42 offen offset:0 lds
v_mfma_f32_16x16x32_bf16 v[64:67], a[152:155], a[196:199], 0
ds_read_b64_tr_b16 a[152:153], v190 offset:16384
ds_read_b64_tr_b16 a[154:155], v190 offset:18432
v_mfma_f32_16x16x32_bf16 v[36:39], a[156:159], a[192:195], 0
v_mfma_f32_16x16x32_bf16 v[68:71], a[156:159], a[196:199], 0
ds_read_b64_tr_b16 a[156:157], v191 offset:16384
ds_read_b64_tr_b16 a[158:159], v191 offset:18432
v_mfma_f32_16x16x32_bf16 v[80:83], a[168:171], a[192:195], 0
v_mfma_f32_16x16x32_bf16 v[112:115], a[168:171], a[196:199], 0
buffer_load_dwordx4 v137, s[16:19], s42 offen offset:1024 lds
v_mfma_f32_16x16x32_bf16 v[84:87], a[172:175], a[192:195], 0
ds_read_b64_tr_b16 a[168:169], v186 offset:16640
ds_read_b64_tr_b16 a[170:171], v186 offset:18688
v_mfma_f32_16x16x32_bf16 v[116:119], a[172:175], a[196:199], 0
ds_read_b64_tr_b16 a[172:173], v187 offset:16640
ds_read_b64_tr_b16 a[174:175], v187 offset:18688
v_mfma_f32_16x16x32_bf16 v[88:91], a[176:179], a[192:195], 0
v_mfma_f32_16x16x32_bf16 v[120:123], a[176:179], a[196:199], 0
buffer_load_dwordx4 v138, s[16:19], s42 offen offset:2048 lds
v_mfma_f32_16x16x32_bf16 v[92:95], a[180:183], a[192:195], 0
ds_read_b64_tr_b16 a[176:177], v188 offset:16640
ds_read_b64_tr_b16 a[178:179], v188 offset:18688
v_mfma_f32_16x16x32_bf16 v[124:127], a[180:183], a[196:199], 0
ds_read_b64_tr_b16 a[180:181], v189 offset:16640
ds_read_b64_tr_b16 a[182:183], v189 offset:18688
v_mfma_f32_16x16x32_bf16 v[96:99], a[184:187], a[192:195], 0
v_mfma_f32_16x16x32_bf16 v[128:131], a[184:187], a[196:199], 0
buffer_load_dwordx4 v139, s[16:19], s42 offen offset:3072 lds
v_mfma_f32_16x16x32_bf16 v[100:103], a[188:191], a[192:195], 0
ds_read_b64_tr_b16 a[184:185], v190 offset:16640
ds_read_b64_tr_b16 a[186:187], v190 offset:18688
v_mfma_f32_16x16x32_bf16 v[132:135], a[188:191], a[196:199], 0
ds_read_b64_tr_b16 a[188:189], v191 offset:16640
ds_read_b64_tr_b16 a[190:191], v191 offset:18688
v_mfma_f32_16x16x32_bf16 v[8:11], a[128:131], a[200:203], v[8:11]
s_add_u32 m0, s44, 53248
v_mfma_f32_16x16x32_bf16 v[40:43], a[128:131], a[204:207], v[40:43]
buffer_load_dwordx4 v140, s[16:19], s42 offen offset:0 lds
v_mfma_f32_16x16x32_bf16 v[12:15], a[132:135], a[200:203], v[12:15]
v_mfma_f32_16x16x32_bf16 v[44:47], a[132:135], a[204:207], v[44:47]
v_smfmac_f32_16x16x64_bf16 a[248:251], a[208:211], a[128:135], v235
s_waitcnt lgkmcnt(6)
v_mfma_f32_16x16x32_bf16 v[72:75], a[160:163], a[200:203], v[72:75]
v_mfma_f32_16x16x32_bf16 v[104:107], a[160:163], a[204:207], v[104:107]
s_waitcnt vmcnt(10) lgkmcnt(0)
s_barrier
v_mfma_f32_16x16x32_bf16 v[76:79], a[164:167], a[200:203], v[76:79]
ds_read_b128 a[192:195], v202 offset:0
ds_read_b128 a[196:199], v202 offset:2048
v_mfma_f32_16x16x32_bf16 v[108:111], a[164:167], a[204:207], v[108:111]
buffer_load_dwordx4 v141, s[16:19], s42 offen offset:1024 lds
v_smfmac_f32_16x16x64_bf16 a[252:255], a[208:211], a[160:167], v235
ds_read_b64_tr_b16 a[128:129], v194 offset:0
ds_read_b64_tr_b16 a[130:131], v194 offset:2048
v_mfma_f32_16x16x32_bf16 v[16:19], a[136:139], a[200:203], v[16:19]
ds_read_b64_tr_b16 a[132:133], v195 offset:0
ds_read_b64_tr_b16 a[134:135], v195 offset:2048
v_mfma_f32_16x16x32_bf16 v[48:51], a[136:139], a[204:207], v[48:51]
ds_read_b64_tr_b16 a[160:161], v194 offset:256
ds_read_b64_tr_b16 a[162:163], v194 offset:2304
v_mfma_f32_16x16x32_bf16 v[20:23], a[140:143], a[200:203], v[20:23]
ds_read_b64_tr_b16 a[164:165], v195 offset:256
ds_read_b64_tr_b16 a[166:167], v195 offset:2304
v_mfma_f32_16x16x32_bf16 v[52:55], a[140:143], a[204:207], v[52:55]
buffer_load_dwordx4 v142, s[16:19], s42 offen offset:2048 lds
v_mfma_f32_16x16x32_bf16 v[24:27], a[144:147], a[200:203], v[24:27]
ds_read_b64_tr_b16 a[136:137], v196 offset:0
ds_read_b64_tr_b16 a[138:139], v196 offset:2048
v_mfma_f32_16x16x32_bf16 v[56:59], a[144:147], a[204:207], v[56:59]
ds_read_b64_tr_b16 a[140:141], v197 offset:0
ds_read_b64_tr_b16 a[142:143], v197 offset:2048
v_mfma_f32_16x16x32_bf16 v[28:31], a[148:151], a[200:203], v[28:31]
ds_read_b64_tr_b16 a[144:145], v198 offset:0
ds_read_b64_tr_b16 a[146:147], v198 offset:2048
v_mfma_f32_16x16x32_bf16 v[60:63], a[148:151], a[204:207], v[60:63]
buffer_load_dwordx4 v143, s[16:19], s42 offen offset:3072 lds
v_mfma_f32_16x16x32_bf16 v[32:35], a[152:155], a[200:203], v[32:35]
s_lshl_b32 s72, s72, 12
ds_read_b64_tr_b16 a[148:149], v199 offset:0
ds_read_b64_tr_b16 a[150:151], v199 offset:2048
v_mfma_f32_16x16x32_bf16 v[64:67], a[152:155], a[204:207], v[64:67]
s_add_u32 s42, s42, s72
ds_read_b64_tr_b16 a[152:153], v200 offset:0
ds_read_b64_tr_b16 a[154:155], v200 offset:2048
v_mfma_f32_16x16x32_bf16 v[36:39], a[156:159], a[200:203], v[36:39]
s_add_u32 m0, s45, 32768
v_mfma_f32_16x16x32_bf16 v[68:71], a[156:159], a[204:207], v[68:71]
buffer_load_dwordx4 v144, s[24:27], s43 offen offset:0 lds
v_mfma_f32_16x16x32_bf16 v[80:83], a[168:171], a[200:203], v[80:83]
ds_read_b64_tr_b16 a[156:157], v201 offset:0
ds_read_b64_tr_b16 a[158:159], v201 offset:2048
v_mfma_f32_16x16x32_bf16 v[112:115], a[168:171], a[204:207], v[112:115]
ds_read_b64_tr_b16 a[168:169], v196 offset:256
ds_read_b64_tr_b16 a[170:171], v196 offset:2304
v_mfma_f32_16x16x32_bf16 v[84:87], a[172:175], a[200:203], v[84:87]
v_mfma_f32_16x16x32_bf16 v[116:119], a[172:175], a[204:207], v[116:119]
buffer_load_dwordx4 v145, s[24:27], s43 offen offset:1024 lds
v_mfma_f32_16x16x32_bf16 v[88:91], a[176:179], a[200:203], v[88:91]
ds_read_b64_tr_b16 a[172:173], v197 offset:256
ds_read_b64_tr_b16 a[174:175], v197 offset:2304
v_mfma_f32_16x16x32_bf16 v[120:123], a[176:179], a[204:207], v[120:123]
ds_read_b64_tr_b16 a[176:177], v198 offset:256
ds_read_b64_tr_b16 a[178:179], v198 offset:2304
v_mfma_f32_16x16x32_bf16 v[92:95], a[180:183], a[200:203], v[92:95]
s_add_u32 m0, s85, 32768
v_mfma_f32_16x16x32_bf16 v[124:127], a[180:183], a[204:207], v[124:127]
buffer_load_dwordx4 v146, s[24:27], s43 offen offset:0 lds
v_mfma_f32_16x16x32_bf16 v[96:99], a[184:187], a[200:203], v[96:99]
ds_read_b64_tr_b16 a[180:181], v199 offset:256
ds_read_b64_tr_b16 a[182:183], v199 offset:2304
v_mfma_f32_16x16x32_bf16 v[128:131], a[184:187], a[204:207], v[128:131]
ds_read_b64_tr_b16 a[184:185], v200 offset:256
ds_read_b64_tr_b16 a[186:187], v200 offset:2304
v_mfma_f32_16x16x32_bf16 v[100:103], a[188:191], a[200:203], v[100:103]
v_mfma_f32_16x16x32_bf16 v[132:135], a[188:191], a[204:207], v[132:135]
s_waitcnt lgkmcnt(8)
ds_read_b64_tr_b16 a[188:189], v201 offset:256
ds_read_b64_tr_b16 a[190:191], v201 offset:2304
v_mfma_f32_16x16x32_bf16 v[8:11], a[128:131], a[192:195], v[8:11]
buffer_load_dwordx4 v147, s[24:27], s43 offen offset:1024 lds
v_mfma_f32_16x16x32_bf16 v[40:43], a[128:131], a[196:199], v[40:43]
s_cmp_eq_u32 s74, 5
s_cselect_b32 s72, s73, 128
ds_read_b128 a[200:203], v203 offset:0
ds_read_b128 a[204:207], v203 offset:2048
v_mfma_f32_16x16x32_bf16 v[12:15], a[132:135], a[192:195], v[12:15]
s_add_u32 s43, s43, s72
v_mfma_f32_16x16x32_bf16 v[44:47], a[132:135], a[196:199], v[44:47]
s_add_u32 m0, s44, 0
v_smfmac_f32_16x16x64_bf16 a[248:251], a[208:211], a[128:135], v235
buffer_load_dwordx4 v136, s[16:19], s42 offen offset:0 lds
v_mfma_f32_16x16x32_bf16 v[72:75], a[160:163], a[192:195], v[72:75]
ds_read_b64_tr_b16 a[128:129], v194 offset:16384
ds_read_b64_tr_b16 a[130:131], v194 offset:18432
v_mfma_f32_16x16x32_bf16 v[104:107], a[160:163], a[196:199], v[104:107]
ds_read_b64_tr_b16 a[132:133], v195 offset:16384
ds_read_b64_tr_b16 a[134:135], v195 offset:18432
v_mfma_f32_16x16x32_bf16 v[76:79], a[164:167], a[192:195], v[76:79]
v_mfma_f32_16x16x32_bf16 v[108:111], a[164:167], a[196:199], v[108:111]
buffer_load_dwordx4 v137, s[16:19], s42 offen offset:1024 lds
v_smfmac_f32_16x16x64_bf16 a[252:255], a[208:211], a[160:167], v235
ds_read_b64_tr_b16 a[160:161], v194 offset:16640
ds_read_b64_tr_b16 a[162:163], v194 offset:18688
v_mfma_f32_16x16x32_bf16 v[16:19], a[136:139], a[192:195], v[16:19]
ds_read_b64_tr_b16 a[164:165], v195 offset:16640
ds_read_b64_tr_b16 a[166:167], v195 offset:18688
v_mfma_f32_16x16x32_bf16 v[48:51], a[136:139], a[196:199], v[48:51]
ds_read_b64_tr_b16 a[136:137], v196 offset:16384
ds_read_b64_tr_b16 a[138:139], v196 offset:18432
v_mfma_f32_16x16x32_bf16 v[20:23], a[140:143], a[192:195], v[20:23]
buffer_load_dwordx4 v138, s[16:19], s42 offen offset:2048 lds
v_mfma_f32_16x16x32_bf16 v[52:55], a[140:143], a[196:199], v[52:55]
ds_read_b64_tr_b16 a[140:141], v197 offset:16384
ds_read_b64_tr_b16 a[142:143], v197 offset:18432
v_mfma_f32_16x16x32_bf16 v[24:27], a[144:147], a[192:195], v[24:27]
v_mfma_f32_16x16x32_bf16 v[56:59], a[144:147], a[196:199], v[56:59]
ds_read_b64_tr_b16 a[144:145], v198 offset:16384
ds_read_b64_tr_b16 a[146:147], v198 offset:18432
v_mfma_f32_16x16x32_bf16 v[28:31], a[148:151], a[192:195], v[28:31]
buffer_load_dwordx4 v139, s[16:19], s42 offen offset:3072 lds
v_mfma_f32_16x16x32_bf16 v[60:63], a[148:151], a[196:199], v[60:63]
ds_read_b64_tr_b16 a[148:149], v199 offset:16384
ds_read_b64_tr_b16 a[150:151], v199 offset:18432
v_mfma_f32_16x16x32_bf16 v[32:35], a[152:155], a[192:195], v[32:35]
v_mfma_f32_16x16x32_bf16 v[64:67], a[152:155], a[196:199], v[64:67]
ds_read_b64_tr_b16 a[152:153], v200 offset:16384
ds_read_b64_tr_b16 a[154:155], v200 offset:18432
v_mfma_f32_16x16x32_bf16 v[36:39], a[156:159], a[192:195], v[36:39]
s_add_u32 m0, s44, 4096
v_mfma_f32_16x16x32_bf16 v[68:71], a[156:159], a[196:199], v[68:71]
buffer_load_dwordx4 v140, s[16:19], s42 offen offset:0 lds
v_mfma_f32_16x16x32_bf16 v[80:83], a[168:171], a[192:195], v[80:83]
ds_read_b64_tr_b16 a[156:157], v201 offset:16384
ds_read_b64_tr_b16 a[158:159], v201 offset:18432
v_mfma_f32_16x16x32_bf16 v[112:115], a[168:171], a[196:199], v[112:115]
s_waitcnt lgkmcnt(8)
ds_read_b64_tr_b16 a[168:169], v196 offset:16640
ds_read_b64_tr_b16 a[170:171], v196 offset:18688
v_mfma_f32_16x16x32_bf16 v[84:87], a[172:175], a[192:195], v[84:87]
v_mfma_f32_16x16x32_bf16 v[116:119], a[172:175], a[196:199], v[116:119]
buffer_load_dwordx4 v141, s[16:19], s42 offen offset:1024 lds
v_mfma_f32_16x16x32_bf16 v[88:91], a[176:179], a[192:195], v[88:91]
ds_read_b64_tr_b16 a[172:173], v197 offset:16640
ds_read_b64_tr_b16 a[174:175], v197 offset:18688
v_mfma_f32_16x16x32_bf16 v[120:123], a[176:179], a[196:199], v[120:123]
ds_read_b64_tr_b16 a[176:177], v198 offset:16640
ds_read_b64_tr_b16 a[178:179], v198 offset:18688
v_mfma_f32_16x16x32_bf16 v[92:95], a[180:183], a[192:195], v[92:95]
v_mfma_f32_16x16x32_bf16 v[124:127], a[180:183], a[196:199], v[124:127]
buffer_load_dwordx4 v142, s[16:19], s42 offen offset:2048 lds
v_mfma_f32_16x16x32_bf16 v[96:99], a[184:187], a[192:195], v[96:99]
ds_read_b64_tr_b16 a[180:181], v199 offset:16640
ds_read_b64_tr_b16 a[182:183], v199 offset:18688
v_mfma_f32_16x16x32_bf16 v[128:131], a[184:187], a[196:199], v[128:131]
ds_read_b64_tr_b16 a[184:185], v200 offset:16640
ds_read_b64_tr_b16 a[186:187], v200 offset:18688
v_mfma_f32_16x16x32_bf16 v[100:103], a[188:191], a[192:195], v[100:103]
v_mfma_f32_16x16x32_bf16 v[132:135], a[188:191], a[196:199], v[132:135]
ds_read_b64_tr_b16 a[188:189], v201 offset:16640
ds_read_b64_tr_b16 a[190:191], v201 offset:18688
v_mfma_f32_16x16x32_bf16 v[8:11], a[128:131], a[200:203], v[8:11]
buffer_load_dwordx4 v143, s[16:19], s42 offen offset:3072 lds
v_mfma_f32_16x16x32_bf16 v[40:43], a[128:131], a[204:207], v[40:43]
v_mfma_f32_16x16x32_bf16 v[12:15], a[132:135], a[200:203], v[12:15]
s_lshl_b32 s72, s72, 12
v_mfma_f32_16x16x32_bf16 v[44:47], a[132:135], a[204:207], v[44:47]
s_add_u32 s42, s42, s72
v_smfmac_f32_16x16x64_bf16 a[248:251], a[208:211], a[128:135], v235
v_mfma_f32_16x16x32_bf16 v[72:75], a[160:163], a[200:203], v[72:75]
v_mfma_f32_16x16x32_bf16 v[104:107], a[160:163], a[204:207], v[104:107]
s_waitcnt vmcnt(12) lgkmcnt(0)
s_barrier
s_cmp_lg_u32 s32, 0
s_cbranch_scc1 K_W0_3
s_lshl_b32 s48, s34, 4
s_mov_b64 exec, 1
buffer_atomic_add v255, v234, s[28:31], s48 offen sc1
s_mov_b64 exec, -1
K_W0_3:
v_mfma_f32_16x16x32_bf16 v[76:79], a[164:167], a[200:203], v[76:79]
s_add_u32 m0, s45, 131072
ds_read_b128 a[192:195], v212 offset:0
ds_read_b128 a[196:199], v212 offset:2048
v_mfma_f32_16x16x32_bf16 v[108:111], a[164:167], a[204:207], v[108:111]
buffer_load_dwordx4 v144, s[24:27], s43 offen offset:0 lds
v_smfmac_f32_16x16x64_bf16 a[252:255], a[208:211], a[160:167], v235
ds_read_b64_tr_b16 a[128:129], v204 offset:0
ds_read_b64_tr_b16 a[130:131], v204 offset:2048
v_mfma_f32_16x16x32_bf16 v[16:19], a[136:139], a[200:203], v[16:19]
ds_read_b64_tr_b16 a[132:133], v205 offset:0
ds_read_b64_tr_b16 a[134:135], v205 offset:2048
v_mfma_f32_16x16x32_bf16 v[48:51], a[136:139], a[204:207], v[48:51]
ds_read_b64_tr_b16 a[160:161], v204 offset:256
ds_read_b64_tr_b16 a[162:163], v204 offset:2304
v_mfma_f32_16x16x32_bf16 v[20:23], a[140:143], a[200:203], v[20:23]
ds_read_b64_tr_b16 a[164:165], v205 offset:256
ds_read_b64_tr_b16 a[166:167], v205 offset:2304
v_mfma_f32_16x16x32_bf16 v[52:55], a[140:143], a[204:207], v[52:55]
buffer_load_dwordx4 v145, s[24:27], s43 offen offset:1024 lds
v_mfma_f32_16x16x32_bf16 v[24:27], a[144:147], a[200:203], v[24:27]
ds_read_b64_tr_b16 a[136:137], v206 offset:0
ds_read_b64_tr_b16 a[138:139], v206 offset:2048
v_mfma_f32_16x16x32_bf16 v[56:59], a[144:147], a[204:207], v[56:59]
ds_read_b64_tr_b16 a[140:141], v207 offset:0
ds_read_b64_tr_b16 a[142:143], v207 offset:2048
v_mfma_f32_16x16x32_bf16 v[28:31], a[148:151], a[200:203], v[28:31]
s_add_u32 m0, s85, 131072
ds_read_b64_tr_b16 a[144:145], v208 offset:0
ds_read_b64_tr_b16 a[146:147], v208 offset:2048
v_mfma_f32_16x16x32_bf16 v[60:63], a[148:151], a[204:207], v[60:63]
buffer_load_dwordx4 v146, s[24:27], s43 offen offset:0 lds
v_mfma_f32_16x16x32_bf16 v[32:35], a[152:155], a[200:203], v[32:35]
ds_read_b64_tr_b16 a[148:149], v209 offset:0
ds_read_b64_tr_b16 a[150:151], v209 offset:2048
v_mfma_f32_16x16x32_bf16 v[64:67], a[152:155], a[204:207], v[64:67]
ds_read_b64_tr_b16 a[152:153], v210 offset:0
ds_read_b64_tr_b16 a[154:155], v210 offset:2048
v_mfma_f32_16x16x32_bf16 v[36:39], a[156:159], a[200:203], v[36:39]
v_mfma_f32_16x16x32_bf16 v[68:71], a[156:159], a[204:207], v[68:71]
buffer_load_dwordx4 v147, s[24:27], s43 offen offset:1024 lds
v_mfma_f32_16x16x32_bf16 v[80:83], a[168:171], a[200:203], v[80:83]
s_cmp_eq_u32 s74, 4
s_cselect_b32 s72, s73, 128
ds_read_b64_tr_b16 a[156:157], v211 offset:0
ds_read_b64_tr_b16 a[158:159], v211 offset:2048
v_mfma_f32_16x16x32_bf16 v[112:115], a[168:171], a[204:207], v[112:115]
s_add_u32 s43, s43, s72
ds_read_b64_tr_b16 a[168:169], v206 offset:256
ds_read_b64_tr_b16 a[170:171], v206 offset:2304
v_mfma_f32_16x16x32_bf16 v[84:87], a[172:175], a[200:203], v[84:87]
s_add_u32 m0, s44, 98304
v_mfma_f32_16x16x32_bf16 v[116:119], a[172:175], a[204:207], v[116:119]
buffer_load_dwordx4 v136, s[16:19], s42 offen offset:0 lds
v_mfma_f32_16x16x32_bf16 v[88:91], a[176:179], a[200:203], v[88:91]
ds_read_b64_tr_b16 a[172:173], v207 offset:256
ds_read_b64_tr_b16 a[174:175], v207 offset:2304
v_mfma_f32_16x16x32_bf16 v[120:123], a[176:179], a[204:207], v[120:123]
ds_read_b64_tr_b16 a[176:177], v208 offset:256
ds_read_b64_tr_b16 a[178:179], v208 offset:2304
v_mfma_f32_16x16x32_bf16 v[92:95], a[180:183], a[200:203], v[92:95]
v_mfma_f32_16x16x32_bf16 v[124:127], a[180:183], a[204:207], v[124:127]
buffer_load_dwordx4 v137, s[16:19], s42 offen offset:1024 lds
v_mfma_f32_16x16x32_bf16 v[96:99], a[184:187], a[200:203], v[96:99]
ds_read_b64_tr_b16 a[180:181], v209 offset:256
ds_read_b64_tr_b16 a[182:183], v209 offset:2304
v_mfma_f32_16x16x32_bf16 v[128:131], a[184:187], a[204:207], v[128:131]
ds_read_b64_tr_b16 a[184:185], v210 offset:256
ds_read_b64_tr_b16 a[186:187], v210 offset:2304
v_mfma_f32_16x16x32_bf16 v[100:103], a[188:191], a[200:203], v[100:103]
v_mfma_f32_16x16x32_bf16 v[132:135], a[188:191], a[204:207], v[132:135]
s_waitcnt lgkmcnt(8)
ds_read_b64_tr_b16 a[188:189], v211 offset:256
ds_read_b64_tr_b16 a[190:191], v211 offset:2304
v_mfma_f32_16x16x32_bf16 v[8:11], a[128:131], a[192:195], v[8:11]
buffer_load_dwordx4 v138, s[16:19], s42 offen offset:2048 lds
v_mfma_f32_16x16x32_bf16 v[40:43], a[128:131], a[196:199], v[40:43]
ds_read_b128 a[200:203], v213 offset:0
ds_read_b128 a[204:207], v213 offset:2048
v_mfma_f32_16x16x32_bf16 v[12:15], a[132:135], a[192:195], v[12:15]
s_waitcnt vmcnt(51)
v_and_b32 v160, 0x7f807f80, v160
v_and_b32 v161, 0x7f807f80, v161
v_mfma_f32_16x16x32_bf16 v[44:47], a[132:135], a[196:199], v[44:47]
v_and_b32 v162, 0x7f807f80, v162
v_and_b32 v163, 0x7f807f80, v163
v_smfmac_f32_16x16x64_bf16 a[248:251], a[208:211], a[128:135], v235
buffer_load_dwordx4 v139, s[16:19], s42 offen offset:3072 lds
v_mfma_f32_16x16x32_bf16 v[72:75], a[160:163], a[192:195], v[72:75]
ds_read_b64_tr_b16 a[128:129], v204 offset:16384
ds_read_b64_tr_b16 a[130:131], v204 offset:18432
v_mfma_f32_16x16x32_bf16 v[104:107], a[160:163], a[196:199], v[104:107]
ds_read_b64_tr_b16 a[132:133], v205 offset:16384
ds_read_b64_tr_b16 a[134:135], v205 offset:18432
v_mfma_f32_16x16x32_bf16 v[76:79], a[164:167], a[192:195], v[76:79]
s_add_u32 m0, s44, 102400
v_pk_max_u16 v160, v160, v161
v_pk_max_u16 v162, v162, v163
v_mfma_f32_16x16x32_bf16 v[108:111], a[164:167], a[196:199], v[108:111]
buffer_load_dwordx4 v140, s[16:19], s42 offen offset:0 lds
v_smfmac_f32_16x16x64_bf16 a[252:255], a[208:211], a[160:167], v235
ds_read_b64_tr_b16 a[160:161], v204 offset:16640
ds_read_b64_tr_b16 a[162:163], v204 offset:18688
v_mfma_f32_16x16x32_bf16 v[16:19], a[136:139], a[192:195], v[16:19]
ds_read_b64_tr_b16 a[164:165], v205 offset:16640
ds_read_b64_tr_b16 a[166:167], v205 offset:18688
v_mfma_f32_16x16x32_bf16 v[48:51], a[136:139], a[196:199], v[48:51]
ds_read_b64_tr_b16 a[136:137], v206 offset:16384
ds_read_b64_tr_b16 a[138:139], v206 offset:18432
v_mfma_f32_16x16x32_bf16 v[20:23], a[140:143], a[192:195], v[20:23]
buffer_load_dwordx4 v141, s[16:19], s42 offen offset:1024 lds
v_mfma_f32_16x16x32_bf16 v[52:55], a[140:143], a[196:199], v[52:55]
ds_read_b64_tr_b16 a[140:141], v207 offset:16384
ds_read_b64_tr_b16 a[142:143], v207 offset:18432
v_mfma_f32_16x16x32_bf16 v[24:27], a[144:147], a[192:195], v[24:27]
v_pk_max_u16 v160, v160, v162
v_lshlrev_b32 v161, 16, v160
v_mfma_f32_16x16x32_bf16 v[56:59], a[144:147], a[196:199], v[56:59]
ds_read_b64_tr_b16 a[144:145], v208 offset:16384
ds_read_b64_tr_b16 a[146:147], v208 offset:18432
v_mfma_f32_16x16x32_bf16 v[28:31], a[148:151], a[192:195], v[28:31]
buffer_load_dwordx4 v142, s[16:19], s42 offen offset:2048 lds
v_mfma_f32_16x16x32_bf16 v[60:63], a[148:151], a[196:199], v[60:63]
ds_read_b64_tr_b16 a[148:149], v209 offset:16384
ds_read_b64_tr_b16 a[150:151], v209 offset:18432
v_mfma_f32_16x16x32_bf16 v[32:35], a[152:155], a[192:195], v[32:35]
v_max_u32 v160, v160, v161
v_and_b32 v160, 0x7f800000, v160
v_mfma_f32_16x16x32_bf16 v[64:67], a[152:155], a[196:199], v[64:67]
ds_read_b64_tr_b16 a[152:153], v210 offset:16384
ds_read_b64_tr_b16 a[154:155], v210 offset:18432
v_mfma_f32_16x16x32_bf16 v[36:39], a[156:159], a[192:195], v[36:39]
v_nop
v_nop
v_mfma_f32_16x16x32_bf16 v[68:71], a[156:159], a[196:199], v[68:71]
buffer_load_dwordx4 v143, s[16:19], s42 offen offset:3072 lds
v_mfma_f32_16x16x32_bf16 v[80:83], a[168:171], a[192:195], v[80:83]
s_waitcnt lgkmcnt(8)
ds_read_b64_tr_b16 a[156:157], v211 offset:16384
ds_read_b64_tr_b16 a[158:159], v211 offset:18432
v_mfma_f32_16x16x32_bf16 v[112:115], a[168:171], a[196:199], v[112:115]
s_lshl_b32 s72, s72, 12
ds_read_b64_tr_b16 a[168:169], v206 offset:16640
ds_read_b64_tr_b16 a[170:171], v206 offset:18688
v_mfma_f32_16x16x32_bf16 v[84:87], a[172:175], a[192:195], v[84:87]
s_add_u32 s42, s42, s72
v_min_u32_dpp v160, v160, v160 row_ror:8 row_mask:0xf bank_mask:0xf
v_nop
v_mfma_f32_16x16x32_bf16 v[116:119], a[172:175], a[196:199], v[116:119]
ds_read_b64_tr_b16 a[172:173], v207 offset:16640
ds_read_b64_tr_b16 a[174:175], v207 offset:18688
v_mfma_f32_16x16x32_bf16 v[88:91], a[176:179], a[192:195], v[88:91]
v_nop
v_min_u32_dpp v160, v160, v160 row_ror:4 row_mask:0xf bank_mask:0xf
v_mfma_f32_16x16x32_bf16 v[120:123], a[176:179], a[196:199], v[120:123]
ds_read_b64_tr_b16 a[176:177], v208 offset:16640
ds_read_b64_tr_b16 a[178:179], v208 offset:18688
v_mfma_f32_16x16x32_bf16 v[92:95], a[180:183], a[192:195], v[92:95]
v_nop
v_nop
v_mfma_f32_16x16x32_bf16 v[124:127], a[180:183], a[196:199], v[124:127]
ds_read_b64_tr_b16 a[180:181], v209 offset:16640
ds_read_b64_tr_b16 a[182:183], v209 offset:18688
v_mfma_f32_16x16x32_bf16 v[96:99], a[184:187], a[192:195], v[96:99]
v_min_u32_dpp v160, v160, v160 row_ror:2 row_mask:0xf bank_mask:0xf
v_nop
v_mfma_f32_16x16x32_bf16 v[128:131], a[184:187], a[196:199], v[128:131]
ds_read_b64_tr_b16 a[184:185], v210 offset:16640
ds_read_b64_tr_b16 a[186:187], v210 offset:18688
v_mfma_f32_16x16x32_bf16 v[100:103], a[188:191], a[192:195], v[100:103]
v_mfma_f32_16x16x32_bf16 v[132:135], a[188:191], a[196:199], v[132:135]
ds_read_b64_tr_b16 a[188:189], v211 offset:16640
ds_read_b64_tr_b16 a[190:191], v211 offset:18688
v_mfma_f32_16x16x32_bf16 v[8:11], a[128:131], a[200:203], v[8:11]
v_nop
v_min_u32_dpp v160, v160, v160 row_ror:1 row_mask:0xf bank_mask:0xf
v_mfma_f32_16x16x32_bf16 v[40:43], a[128:131], a[204:207], v[40:43]
v_nop
v_readlane_b32 s97, v160, 0
v_mfma_f32_16x16x32_bf16 v[12:15], a[132:135], a[200:203], v[12:15]
v_readlane_b32 s46, v160, 16
v_readlane_b32 s47, v160, 32
v_mfma_f32_16x16x32_bf16 v[44:47], a[132:135], a[204:207], v[44:47]
s_min_u32 s97, s97, s46
v_readlane_b32 s46, v160, 48
v_smfmac_f32_16x16x64_bf16 a[248:251], a[208:211], a[128:135], v235
s_min_u32 s97, s97, s47
v_mfma_f32_16x16x32_bf16 v[72:75], a[160:163], a[200:203], v[72:75]
s_min_u32 s97, s97, s46
v_mfma_f32_16x16x32_bf16 v[104:107], a[160:163], a[204:207], v[104:107]
s_waitcnt vmcnt(12) lgkmcnt(0)
s_barrier
s_min_u32 s97, s97, 0x70000000
v_mfma_f32_16x16x32_bf16 v[76:79], a[164:167], a[200:203], v[76:79]
s_add_u32 m0, s45, 81920
ds_read_b128 a[192:195], v192 offset:0
ds_read_b128 a[196:199], v192 offset:2048
v_mfma_f32_16x16x32_bf16 v[108:111], a[164:167], a[204:207], v[108:111]
s_add_u32 s46, s97, 0x2400000
buffer_load_dwordx4 v144, s[24:27], s43 offen offset:0 lds
v_smfmac_f32_16x16x64_bf16 a[252:255], a[208:211], a[160:167], v235
s_cmp_lg_u32 s97, 0
s_cselect_b32 s97, s46, 0
ds_read_b64_tr_b16 a[128:129], v184 offset:0
ds_read_b64_tr_b16 a[130:131], v184 offset:2048
v_mfma_f32_16x16x32_bf16 v[16:19], a[136:139], a[200:203], v[16:19]
ds_read_b64_tr_b16 a[132:133], v185 offset:0
ds_read_b64_tr_b16 a[134:135], v185 offset:2048
v_mfma_f32_16x16x32_bf16 v[48:51], a[136:139], a[204:207], v[48:51]
ds_read_b64_tr_b16 a[160:161], v184 offset:256
ds_read_b64_tr_b16 a[162:163], v184 offset:2304
v_mfma_f32_16x16x32_bf16 v[20:23], a[140:143], a[200:203], v[20:23]
buffer_load_dwordx4 v145, s[24:27], s43 offen offset:1024 lds
v_mfma_f32_16x16x32_bf16 v[52:55], a[140:143], a[204:207], v[52:55]
ds_read_b64_tr_b16 a[164:165], v185 offset:256
ds_read_b64_tr_b16 a[166:167], v185 offset:2304
v_mfma_f32_16x16x32_bf16 v[24:27], a[144:147], a[200:203], v[24:27]
ds_read_b64_tr_b16 a[136:137], v186 offset:0
ds_read_b64_tr_b16 a[138:139], v186 offset:2048
v_mfma_f32_16x16x32_bf16 v[56:59], a[144:147], a[204:207], v[56:59]
s_add_u32 m0, s85, 81920
ds_read_b64_tr_b16 a[140:141], v187 offset:0
ds_read_b64_tr_b16 a[142:143], v187 offset:2048
v_mfma_f32_16x16x32_bf16 v[28:31], a[148:151], a[200:203], v[28:31]
buffer_load_dwordx4 v146, s[24:27], s43 offen offset:0 lds
v_mfma_f32_16x16x32_bf16 v[60:63], a[148:151], a[204:207], v[60:63]
ds_read_b64_tr_b16 a[144:145], v188 offset:0
ds_read_b64_tr_b16 a[146:147], v188 offset:2048
v_mfma_f32_16x16x32_bf16 v[32:35], a[152:155], a[200:203], v[32:35]
ds_read_b64_tr_b16 a[148:149], v189 offset:0
ds_read_b64_tr_b16 a[150:151], v189 offset:2048
v_mfma_f32_16x16x32_bf16 v[64:67], a[152:155], a[204:207], v[64:67]
ds_read_b64_tr_b16 a[152:153], v190 offset:0
ds_read_b64_tr_b16 a[154:155], v190 offset:2048
v_mfma_f32_16x16x32_bf16 v[36:39], a[156:159], a[200:203], v[36:39]
buffer_load_dwordx4 v147, s[24:27], s43 offen offset:1024 lds
v_mfma_f32_16x16x32_bf16 v[68:71], a[156:159], a[204:207], v[68:71]
ds_read_b64_tr_b16 a[156:157], v191 offset:0
ds_read_b64_tr_b16 a[158:159], v191 offset:2048
v_mfma_f32_16x16x32_bf16 v[80:83], a[168:171], a[200:203], v[80:83]
s_cmp_eq_u32 s74, 3
s_cselect_b32 s72, s73, 128
v_mov_b32 v160, s97
v_accvgpr_write_b32 a0, v160
v_mfma_f32_16x16x32_bf16 v[112:115], a[168:171], a[204:207], v[112:115]
s_add_u32 s43, s43, s72
ds_read_b64_tr_b16 a[168:169], v186 offset:256
ds_read_b64_tr_b16 a[170:171], v186 offset:2304
v_mfma_f32_16x16x32_bf16 v[84:87], a[172:175], a[200:203], v[84:87]
s_add_u32 m0, s44, 49152
v_accvgpr_write_b32 a1, v160
v_accvgpr_write_b32 a2, v160
v_mfma_f32_16x16x32_bf16 v[116:119], a[172:175], a[204:207], v[116:119]
buffer_load_dwordx4 v136, s[16:19], s42 offen offset:0 lds
v_mfma_f32_16x16x32_bf16 v[88:91], a[176:179], a[200:203], v[88:91]
ds_read_b64_tr_b16 a[172:173], v187 offset:256
ds_read_b64_tr_b16 a[174:175], v187 offset:2304
v_mfma_f32_16x16x32_bf16 v[120:123], a[176:179], a[204:207], v[120:123]
ds_read_b64_tr_b16 a[176:177], v188 offset:256
ds_read_b64_tr_b16 a[178:179], v188 offset:2304
v_mfma_f32_16x16x32_bf16 v[92:95], a[180:183], a[200:203], v[92:95]
v_accvgpr_write_b32 a3, v160
v_mfma_f32_16x16x32_bf16 v[124:127], a[180:183], a[204:207], v[124:127]
buffer_load_dwordx4 v137, s[16:19], s42 offen offset:1024 lds
v_mfma_f32_16x16x32_bf16 v[96:99], a[184:187], a[200:203], v[96:99]
ds_read_b64_tr_b16 a[180:181], v189 offset:256
ds_read_b64_tr_b16 a[182:183], v189 offset:2304
v_mfma_f32_16x16x32_bf16 v[128:131], a[184:187], a[204:207], v[128:131]
ds_read_b64_tr_b16 a[184:185], v190 offset:256
ds_read_b64_tr_b16 a[186:187], v190 offset:2304
v_mfma_f32_16x16x32_bf16 v[100:103], a[188:191], a[200:203], v[100:103]
v_mfma_f32_16x16x32_bf16 v[132:135], a[188:191], a[204:207], v[132:135]
s_waitcnt lgkmcnt(8)
ds_read_b64_tr_b16 a[188:189], v191 offset:256
ds_read_b64_tr_b16 a[190:191], v191 offset:2304
v_mfma_f32_16x16x32_bf16 v[8:11], a[128:131], a[192:195], v[8:11]
buffer_load_dwordx4 v138, s[16:19], s42 offen offset:2048 lds
v_mfma_f32_16x16x32_bf16 v[40:43], a[128:131], a[196:199], v[40:43]
ds_read_b128 a[200:203], v193 offset:0
ds_read_b128 a[204:207], v193 offset:2048
v_mfma_f32_16x16x32_bf16 v[12:15], a[132:135], a[192:195], v[12:15]
v_accvgpr_write_b32 a4, v160
v_accvgpr_write_b32 a5, v160
v_mfma_f32_16x16x32_bf16 v[44:47], a[132:135], a[196:199], v[44:47]
v_accvgpr_write_b32 a6, v160
v_accvgpr_write_b32 a7, v160
v_smfmac_f32_16x16x64_bf16 a[248:251], a[208:211], a[128:135], v235
buffer_load_dwordx4 v139, s[16:19], s42 offen offset:3072 lds
v_mfma_f32_16x16x32_bf16 v[72:75], a[160:163], a[192:195], v[72:75]
ds_read_b64_tr_b16 a[128:129], v184 offset:16384
ds_read_b64_tr_b16 a[130:131], v184 offset:18432
v_mfma_f32_16x16x32_bf16 v[104:107], a[160:163], a[196:199], v[104:107]
ds_read_b64_tr_b16 a[132:133], v185 offset:16384
ds_read_b64_tr_b16 a[134:135], v185 offset:18432
v_mfma_f32_16x16x32_bf16 v[76:79], a[164:167], a[192:195], v[76:79]
s_add_u32 m0, s44, 53248
v_accvgpr_write_b32 a8, v160
v_accvgpr_write_b32 a9, v160
v_mfma_f32_16x16x32_bf16 v[108:111], a[164:167], a[196:199], v[108:111]
buffer_load_dwordx4 v140, s[16:19], s42 offen offset:0 lds
v_smfmac_f32_16x16x64_bf16 a[252:255], a[208:211], a[160:167], v235
ds_read_b64_tr_b16 a[160:161], v184 offset:16640
ds_read_b64_tr_b16 a[162:163], v184 offset:18688
v_mfma_f32_16x16x32_bf16 v[16:19], a[136:139], a[192:195], v[16:19]
ds_read_b64_tr_b16 a[164:165], v185 offset:16640
ds_read_b64_tr_b16 a[166:167], v185 offset:18688
v_mfma_f32_16x16x32_bf16 v[48:51], a[136:139], a[196:199], v[48:51]
ds_read_b64_tr_b16 a[136:137], v186 offset:16384
ds_read_b64_tr_b16 a[138:139], v186 offset:18432
v_mfma_f32_16x16x32_bf16 v[20:23], a[140:143], a[192:195], v[20:23]
v_accvgpr_write_b32 a10, v160
v_accvgpr_write_b32 a11, v160
v_mfma_f32_16x16x32_bf16 v[52:55], a[140:143], a[196:199], v[52:55]
buffer_load_dwordx4 v141, s[16:19], s42 offen offset:1024 lds
v_mfma_f32_16x16x32_bf16 v[24:27], a[144:147], a[192:195], v[24:27]
ds_read_b64_tr_b16 a[140:141], v187 offset:16384
ds_read_b64_tr_b16 a[142:143], v187 offset:18432
v_mfma_f32_16x16x32_bf16 v[56:59], a[144:147], a[196:199], v[56:59]
ds_read_b64_tr_b16 a[144:145], v188 offset:16384
ds_read_b64_tr_b16 a[146:147], v188 offset:18432
v_mfma_f32_16x16x32_bf16 v[28:31], a[148:151], a[192:195], v[28:31]
v_accvgpr_write_b32 a12, v160
v_accvgpr_write_b32 a13, v160
v_mfma_f32_16x16x32_bf16 v[60:63], a[148:151], a[196:199], v[60:63]
buffer_load_dwordx4 v142, s[16:19], s42 offen offset:2048 lds
v_mfma_f32_16x16x32_bf16 v[32:35], a[152:155], a[192:195], v[32:35]
ds_read_b64_tr_b16 a[148:149], v189 offset:16384
ds_read_b64_tr_b16 a[150:151], v189 offset:18432
v_mfma_f32_16x16x32_bf16 v[64:67], a[152:155], a[196:199], v[64:67]
ds_read_b64_tr_b16 a[152:153], v190 offset:16384
ds_read_b64_tr_b16 a[154:155], v190 offset:18432
v_mfma_f32_16x16x32_bf16 v[36:39], a[156:159], a[192:195], v[36:39]
v_accvgpr_write_b32 a14, v160
v_accvgpr_write_b32 a15, v160
v_mfma_f32_16x16x32_bf16 v[68:71], a[156:159], a[196:199], v[68:71]
buffer_load_dwordx4 v143, s[16:19], s42 offen offset:3072 lds
v_mfma_f32_16x16x32_bf16 v[80:83], a[168:171], a[192:195], v[80:83]
s_waitcnt lgkmcnt(8)
ds_read_b64_tr_b16 a[156:157], v191 offset:16384
ds_read_b64_tr_b16 a[158:159], v191 offset:18432
v_mfma_f32_16x16x32_bf16 v[112:115], a[168:171], a[196:199], v[112:115]
s_lshl_b32 s72, s72, 12
ds_read_b64_tr_b16 a[168:169], v186 offset:16640
ds_read_b64_tr_b16 a[170:171], v186 offset:18688
v_mfma_f32_16x16x32_bf16 v[84:87], a[172:175], a[192:195], v[84:87]
s_add_u32 s42, s42, s72
v_accvgpr_write_b32 a16, v160
v_accvgpr_write_b32 a17, v160
v_mfma_f32_16x16x32_bf16 v[116:119], a[172:175], a[196:199], v[116:119]
ds_read_b64_tr_b16 a[172:173], v187 offset:16640
ds_read_b64_tr_b16 a[174:175], v187 offset:18688
v_mfma_f32_16x16x32_bf16 v[88:91], a[176:179], a[192:195], v[88:91]
v_accvgpr_write_b32 a18, v160
v_accvgpr_write_b32 a19, v160
v_mfma_f32_16x16x32_bf16 v[120:123], a[176:179], a[196:199], v[120:123]
ds_read_b64_tr_b16 a[176:177], v188 offset:16640
ds_read_b64_tr_b16 a[178:179], v188 offset:18688
v_mfma_f32_16x16x32_bf16 v[92:95], a[180:183], a[192:195], v[92:95]
v_accvgpr_write_b32 a20, v160
v_accvgpr_write_b32 a21, v160
v_mfma_f32_16x16x32_bf16 v[124:127], a[180:183], a[196:199], v[124:127]
ds_read_b64_tr_b16 a[180:181], v189 offset:16640
ds_read_b64_tr_b16 a[182:183], v189 offset:18688
v_mfma_f32_16x16x32_bf16 v[96:99], a[184:187], a[192:195], v[96:99]
v_accvgpr_write_b32 a22, v160
v_accvgpr_write_b32 a23, v160
v_mfma_f32_16x16x32_bf16 v[128:131], a[184:187], a[196:199], v[128:131]
ds_read_b64_tr_b16 a[184:185], v190 offset:16640
ds_read_b64_tr_b16 a[186:187], v190 offset:18688
v_mfma_f32_16x16x32_bf16 v[100:103], a[188:191], a[192:195], v[100:103]
v_mfma_f32_16x16x32_bf16 v[132:135], a[188:191], a[196:199], v[132:135]
ds_read_b64_tr_b16 a[188:189], v191 offset:16640
ds_read_b64_tr_b16 a[190:191], v191 offset:18688
v_mfma_f32_16x16x32_bf16 v[8:11], a[128:131], a[200:203], v[8:11]
v_accvgpr_write_b32 a24, v160
v_accvgpr_write_b32 a25, v160
v_mfma_f32_16x16x32_bf16 v[40:43], a[128:131], a[204:207], v[40:43]
v_accvgpr_write_b32 a26, v160
v_accvgpr_write_b32 a27, v160
v_mfma_f32_16x16x32_bf16 v[12:15], a[132:135], a[200:203], v[12:15]
v_accvgpr_write_b32 a28, v160
v_accvgpr_write_b32 a29, v160
v_mfma_f32_16x16x32_bf16 v[44:47], a[132:135], a[204:207], v[44:47]
v_accvgpr_write_b32 a30, v160
v_accvgpr_write_b32 a31, v160
v_smfmac_f32_16x16x64_bf16 a[248:251], a[208:211], a[128:135], v235
v_accvgpr_write_b32 a32, v160
v_accvgpr_write_b32 a33, v160
v_mfma_f32_16x16x32_bf16 v[72:75], a[160:163], a[200:203], v[72:75]
v_accvgpr_write_b32 a34, v160
v_accvgpr_write_b32 a35, v160
v_mfma_f32_16x16x32_bf16 v[104:107], a[160:163], a[204:207], v[104:107]
s_waitcnt vmcnt(12) lgkmcnt(0)
s_barrier
v_mfma_f32_16x16x32_bf16 v[76:79], a[164:167], a[200:203], v[76:79]
s_add_u32 m0, s45, 32768
ds_read_b128 a[192:195], v202 offset:0
ds_read_b128 a[196:199], v202 offset:2048
v_mfma_f32_16x16x32_bf16 v[108:111], a[164:167], a[204:207], v[108:111]
buffer_load_dwordx4 v144, s[24:27], s43 offen offset:0 lds
v_smfmac_f32_16x16x64_bf16 a[252:255], a[208:211], a[160:167], v235
ds_read_b64_tr_b16 a[128:129], v194 offset:0
ds_read_b64_tr_b16 a[130:131], v194 offset:2048
v_mfma_f32_16x16x32_bf16 v[16:19], a[136:139], a[200:203], v[16:19]
ds_read_b64_tr_b16 a[132:133], v195 offset:0
ds_read_b64_tr_b16 a[134:135], v195 offset:2048
v_mfma_f32_16x16x32_bf16 v[48:51], a[136:139], a[204:207], v[48:51]
ds_read_b64_tr_b16 a[160:161], v194 offset:256
ds_read_b64_tr_b16 a[162:163], v194 offset:2304
v_mfma_f32_16x16x32_bf16 v[20:23], a[140:143], a[200:203], v[20:23]
buffer_load_dwordx4 v145, s[24:27], s43 offen offset:1024 lds
v_mfma_f32_16x16x32_bf16 v[52:55], a[140:143], a[204:207], v[52:55]
ds_read_b64_tr_b16 a[164:165], v195 offset:256
ds_read_b64_tr_b16 a[166:167], v195 offset:2304
v_mfma_f32_16x16x32_bf16 v[24:27], a[144:147], a[200:203], v[24:27]
ds_read_b64_tr_b16 a[136:137], v196 offset:0
ds_read_b64_tr_b16 a[138:139], v196 offset:2048
v_mfma_f32_16x16x32_bf16 v[56:59], a[144:147], a[204:207], v[56:59]
ds_read_b64_tr_b16 a[140:141], v197 offset:0
ds_read_b64_tr_b16 a[142:143], v197 offset:2048
v_mfma_f32_16x16x32_bf16 v[28:31], a[148:151], a[200:203], v[28:31]
s_add_u32 m0, s85, 32768
ds_read_b64_tr_b16 a[144:145], v198 offset:0
ds_read_b64_tr_b16 a[146:147], v198 offset:2048
v_mfma_f32_16x16x32_bf16 v[60:63], a[148:151], a[204:207], v[60:63]
buffer_load_dwordx4 v146, s[24:27], s43 offen offset:0 lds
v_mfma_f32_16x16x32_bf16 v[32:35], a[152:155], a[200:203], v[32:35]
ds_read_b64_tr_b16 a[148:149], v199 offset:0
ds_read_b64_tr_b16 a[150:151], v199 offset:2048
v_mfma_f32_16x16x32_bf16 v[64:67], a[152:155], a[204:207], v[64:67]
ds_read_b64_tr_b16 a[152:153], v200 offset:0
ds_read_b64_tr_b16 a[154:155], v200 offset:2048
v_mfma_f32_16x16x32_bf16 v[36:39], a[156:159], a[200:203], v[36:39]
v_accvgpr_write_b32 a36, v160
v_accvgpr_write_b32 a37, v160
v_mfma_f32_16x16x32_bf16 v[68:71], a[156:159], a[204:207], v[68:71]
buffer_load_dwordx4 v147, s[24:27], s43 offen offset:1024 lds
v_mfma_f32_16x16x32_bf16 v[80:83], a[168:171], a[200:203], v[80:83]
s_cmp_eq_u32 s74, 2
s_cselect_b32 s72, s73, 128
ds_read_b64_tr_b16 a[156:157], v201 offset:0
ds_read_b64_tr_b16 a[158:159], v201 offset:2048
v_mfma_f32_16x16x32_bf16 v[112:115], a[168:171], a[204:207], v[112:115]
s_add_u32 s43, s43, s72
ds_read_b64_tr_b16 a[168:169], v196 offset:256
ds_read_b64_tr_b16 a[170:171], v196 offset:2304
v_mfma_f32_16x16x32_bf16 v[84:87], a[172:175], a[200:203], v[84:87]
s_add_u32 m0, s44, 0
v_accvgpr_write_b32 a38, v160
v_accvgpr_write_b32 a39, v160
v_mfma_f32_16x16x32_bf16 v[116:119], a[172:175], a[204:207], v[116:119]
buffer_load_dwordx4 v136, s[16:19], s42 offen offset:0 lds
v_mfma_f32_16x16x32_bf16 v[88:91], a[176:179], a[200:203], v[88:91]
ds_read_b64_tr_b16 a[172:173], v197 offset:256
ds_read_b64_tr_b16 a[174:175], v197 offset:2304
v_mfma_f32_16x16x32_bf16 v[120:123], a[176:179], a[204:207], v[120:123]
ds_read_b64_tr_b16 a[176:177], v198 offset:256
ds_read_b64_tr_b16 a[178:179], v198 offset:2304
v_mfma_f32_16x16x32_bf16 v[92:95], a[180:183], a[200:203], v[92:95]
v_accvgpr_write_b32 a40, v160
v_accvgpr_write_b32 a41, v160
v_mfma_f32_16x16x32_bf16 v[124:127], a[180:183], a[204:207], v[124:127]
buffer_load_dwordx4 v137, s[16:19], s42 offen offset:1024 lds
v_mfma_f32_16x16x32_bf16 v[96:99], a[184:187], a[200:203], v[96:99]
ds_read_b64_tr_b16 a[180:181], v199 offset:256
ds_read_b64_tr_b16 a[182:183], v199 offset:2304
v_mfma_f32_16x16x32_bf16 v[128:131], a[184:187], a[204:207], v[128:131]
ds_read_b64_tr_b16 a[184:185], v200 offset:256
ds_read_b64_tr_b16 a[186:187], v200 offset:2304
v_mfma_f32_16x16x32_bf16 v[100:103], a[188:191], a[200:203], v[100:103]
v_mfma_f32_16x16x32_bf16 v[132:135], a[188:191], a[204:207], v[132:135]
s_waitcnt lgkmcnt(8)
ds_read_b64_tr_b16 a[188:189], v201 offset:256
ds_read_b64_tr_b16 a[190:191], v201 offset:2304
v_mfma_f32_16x16x32_bf16 v[8:11], a[128:131], a[192:195], v[8:11]
buffer_load_dwordx4 v138, s[16:19], s42 offen offset:2048 lds
v_mfma_f32_16x16x32_bf16 v[40:43], a[128:131], a[196:199], v[40:43]
ds_read_b128 a[200:203], v203 offset:0
ds_read_b128 a[204:207], v203 offset:2048
v_mfma_f32_16x16x32_bf16 v[12:15], a[132:135], a[192:195], v[12:15]
v_accvgpr_write_b32 a42, v160
v_accvgpr_write_b32 a43, v160
v_mfma_f32_16x16x32_bf16 v[44:47], a[132:135], a[196:199], v[44:47]
v_accvgpr_write_b32 a44, v160
v_accvgpr_write_b32 a45, v160
v_smfmac_f32_16x16x64_bf16 a[248:251], a[208:211], a[128:135], v235
ds_read_b64_tr_b16 a[128:129], v194 offset:16384
ds_read_b64_tr_b16 a[130:131], v194 offset:18432
v_mfma_f32_16x16x32_bf16 v[72:75], a[160:163], a[192:195], v[72:75]
buffer_load_dwordx4 v139, s[16:19], s42 offen offset:3072 lds
v_mfma_f32_16x16x32_bf16 v[104:107], a[160:163], a[196:199], v[104:107]
ds_read_b64_tr_b16 a[132:133], v195 offset:16384
ds_read_b64_tr_b16 a[134:135], v195 offset:18432
v_mfma_f32_16x16x32_bf16 v[76:79], a[164:167], a[192:195], v[76:79]
v_accvgpr_write_b32 a46, v160
v_accvgpr_write_b32 a47, v160
v_mfma_f32_16x16x32_bf16 v[108:111], a[164:167], a[196:199], v[108:111]
s_add_u32 m0, s44, 4096
v_accvgpr_write_b32 a48, v160
v_accvgpr_write_b32 a49, v160
v_smfmac_f32_16x16x64_bf16 a[252:255], a[208:211], a[160:167], v235
buffer_load_dwordx4 v140, s[16:19], s42 offen offset:0 lds
v_mfma_f32_16x16x32_bf16 v[16:19], a[136:139], a[192:195], v[16:19]
ds_read_b64_tr_b16 a[160:161], v194 offset:16640
ds_read_b64_tr_b16 a[162:163], v194 offset:18688
v_mfma_f32_16x16x32_bf16 v[48:51], a[136:139], a[196:199], v[48:51]
ds_read_b64_tr_b16 a[164:165], v195 offset:16640
ds_read_b64_tr_b16 a[166:167], v195 offset:18688
v_mfma_f32_16x16x32_bf16 v[20:23], a[140:143], a[192:195], v[20:23]
ds_read_b64_tr_b16 a[136:137], v196 offset:16384
ds_read_b64_tr_b16 a[138:139], v196 offset:18432
v_mfma_f32_16x16x32_bf16 v[52:55], a[140:143], a[196:199], v[52:55]
buffer_load_dwordx4 v141, s[16:19], s42 offen offset:1024 lds
v_mfma_f32_16x16x32_bf16 v[24:27], a[144:147], a[192:195], v[24:27]
ds_read_b64_tr_b16 a[140:141], v197 offset:16384
ds_read_b64_tr_b16 a[142:143], v197 offset:18432
v_mfma_f32_16x16x32_bf16 v[56:59], a[144:147], a[196:199], v[56:59]
ds_read_b64_tr_b16 a[144:145], v198 offset:16384
ds_read_b64_tr_b16 a[146:147], v198 offset:18432
v_mfma_f32_16x16x32_bf16 v[28:31], a[148:151], a[192:195], v[28:31]
v_accvgpr_write_b32 a50, v160
v_accvgpr_write_b32 a51, v160
v_mfma_f32_16x16x32_bf16 v[60:63], a[148:151], a[196:199], v[60:63]
buffer_load_dwordx4 v142, s[16:19], s42 offen offset:2048 lds
v_mfma_f32_16x16x32_bf16 v[32:35], a[152:155], a[192:195], v[32:35]
ds_read_b64_tr_b16 a[148:149], v199 offset:16384
ds_read_b64_tr_b16 a[150:151], v199 offset:18432
v_mfma_f32_16x16x32_bf16 v[64:67], a[152:155], a[196:199], v[64:67]
ds_read_b64_tr_b16 a[152:153], v200 offset:16384
ds_read_b64_tr_b16 a[154:155], v200 offset:18432
v_mfma_f32_16x16x32_bf16 v[36:39], a[156:159], a[192:195], v[36:39]
v_accvgpr_write_b32 a52, v160
v_accvgpr_write_b32 a53, v160
v_mfma_f32_16x16x32_bf16 v[68:71], a[156:159], a[196:199], v[68:71]
buffer_load_dwordx4 v143, s[16:19], s42 offen offset:3072 lds
v_mfma_f32_16x16x32_bf16 v[80:83], a[168:171], a[192:195], v[80:83]
s_lshl_b32 s72, s72, 12
ds_read_b64_tr_b16 a[156:157], v201 offset:16384
ds_read_b64_tr_b16 a[158:159], v201 offset:18432
v_mfma_f32_16x16x32_bf16 v[112:115], a[168:171], a[196:199], v[112:115]
s_waitcnt lgkmcnt(10)
s_add_u32 s42, s42, s72
ds_read_b64_tr_b16 a[168:169], v196 offset:16640
ds_read_b64_tr_b16 a[170:171], v196 offset:18688
v_mfma_f32_16x16x32_bf16 v[84:87], a[172:175], a[192:195], v[84:87]
s_lshr_b32 s48, s2, 5
v_accvgpr_write_b32 a54, v160
v_accvgpr_write_b32 a55, v160
v_mfma_f32_16x16x32_bf16 v[116:119], a[172:175], a[196:199], v[116:119]
s_lshl_b32 s48, s48, 13
ds_read_b64_tr_b16 a[172:173], v197 offset:16640
v_lshlrev_b32 v254, 5, v0
v_mfma_f32_16x16x32_bf16 v[88:91], a[176:179], a[192:195], v[88:91]
buffer_load_dword v252, v254, s[8:11], s48 offen
v_mfma_f32_16x16x32_bf16 v[120:123], a[176:179], a[196:199], v[120:123]
ds_read_b64_tr_b16 a[174:175], v197 offset:18688
ds_read_b64_tr_b16 a[176:177], v198 offset:16640
v_mfma_f32_16x16x32_bf16 v[92:95], a[180:183], a[192:195], v[92:95]
ds_read_b64_tr_b16 a[178:179], v198 offset:18688
v_accvgpr_write_b32 a56, v160
v_mfma_f32_16x16x32_bf16 v[124:127], a[180:183], a[196:199], v[124:127]
ds_read_b64_tr_b16 a[180:181], v199 offset:16640
ds_read_b64_tr_b16 a[182:183], v199 offset:18688
v_mfma_f32_16x16x32_bf16 v[96:99], a[184:187], a[192:195], v[96:99]
buffer_load_dword v253, v254, s[12:15], s48 offen
v_mfma_f32_16x16x32_bf16 v[128:131], a[184:187], a[196:199], v[128:131]
ds_read_b64_tr_b16 a[184:185], v200 offset:16640
ds_read_b64_tr_b16 a[186:187], v200 offset:18688
v_mfma_f32_16x16x32_bf16 v[100:103], a[188:191], a[192:195], v[100:103]
v_accvgpr_write_b32 a57, v160
v_mfma_f32_16x16x32_bf16 v[132:135], a[188:191], a[196:199], v[132:135]
ds_read_b64_tr_b16 a[188:189], v201 offset:16640
ds_read_b64_tr_b16 a[190:191], v201 offset:18688
v_mfma_f32_16x16x32_bf16 v[8:11], a[128:131], a[200:203], v[8:11]
v_accvgpr_write_b32 a58, v160
v_accvgpr_write_b32 a59, v160
v_mfma_f32_16x16x32_bf16 v[40:43], a[128:131], a[204:207], v[40:43]
v_accvgpr_write_b32 a60, v160
v_accvgpr_write_b32 a61, v160
v_mfma_f32_16x16x32_bf16 v[12:15], a[132:135], a[200:203], v[12:15]
v_accvgpr_write_b32 a62, v160
v_accvgpr_write_b32 a63, v160
v_mfma_f32_16x16x32_bf16 v[44:47], a[132:135], a[204:207], v[44:47]
v_accvgpr_write_b32 a64, v160
v_accvgpr_write_b32 a65, v160
v_smfmac_f32_16x16x64_bf16 a[248:251], a[208:211], a[128:135], v235
v_accvgpr_write_b32 a66, v160
v_accvgpr_write_b32 a67, v160
v_mfma_f32_16x16x32_bf16 v[72:75], a[160:163], a[200:203], v[72:75]
v_accvgpr_write_b32 a68, v160
v_accvgpr_write_b32 a69, v160
v_mfma_f32_16x16x32_bf16 v[104:107], a[160:163], a[204:207], v[104:107]
s_waitcnt vmcnt(14) lgkmcnt(0)
s_barrier
v_mfma_f32_16x16x32_bf16 v[76:79], a[164:167], a[200:203], v[76:79]
s_add_u32 m0, s45, 131072
ds_read_b128 a[192:195], v212 offset:0
ds_read_b128 a[196:199], v212 offset:2048
v_mfma_f32_16x16x32_bf16 v[108:111], a[164:167], a[204:207], v[108:111]
buffer_load_dwordx4 v144, s[24:27], s43 offen offset:0 lds
v_smfmac_f32_16x16x64_bf16 a[252:255], a[208:211], a[160:167], v235
ds_read_b64_tr_b16 a[128:129], v204 offset:0
ds_read_b64_tr_b16 a[130:131], v204 offset:2048
v_mfma_f32_16x16x32_bf16 v[16:19], a[136:139], a[200:203], v[16:19]
ds_read_b64_tr_b16 a[132:133], v205 offset:0
ds_read_b64_tr_b16 a[134:135], v205 offset:2048
v_mfma_f32_16x16x32_bf16 v[48:51], a[136:139], a[204:207], v[48:51]
ds_read_b64_tr_b16 a[160:161], v204 offset:256
ds_read_b64_tr_b16 a[162:163], v204 offset:2304
v_mfma_f32_16x16x32_bf16 v[20:23], a[140:143], a[200:203], v[20:23]
buffer_load_dwordx4 v145, s[24:27], s43 offen offset:1024 lds
v_mfma_f32_16x16x32_bf16 v[52:55], a[140:143], a[204:207], v[52:55]
ds_read_b64_tr_b16 a[164:165], v205 offset:256
ds_read_b64_tr_b16 a[166:167], v205 offset:2304
v_mfma_f32_16x16x32_bf16 v[24:27], a[144:147], a[200:203], v[24:27]
ds_read_b64_tr_b16 a[136:137], v206 offset:0
ds_read_b64_tr_b16 a[138:139], v206 offset:2048
v_mfma_f32_16x16x32_bf16 v[56:59], a[144:147], a[204:207], v[56:59]
s_add_u32 m0, s85, 131072
ds_read_b64_tr_b16 a[140:141], v207 offset:0
ds_read_b64_tr_b16 a[142:143], v207 offset:2048
v_mfma_f32_16x16x32_bf16 v[28:31], a[148:151], a[200:203], v[28:31]
buffer_load_dwordx4 v146, s[24:27], s43 offen offset:0 lds
v_mfma_f32_16x16x32_bf16 v[60:63], a[148:151], a[204:207], v[60:63]
ds_read_b64_tr_b16 a[144:145], v208 offset:0
ds_read_b64_tr_b16 a[146:147], v208 offset:2048
v_mfma_f32_16x16x32_bf16 v[32:35], a[152:155], a[200:203], v[32:35]
ds_read_b64_tr_b16 a[148:149], v209 offset:0
ds_read_b64_tr_b16 a[150:151], v209 offset:2048
v_mfma_f32_16x16x32_bf16 v[64:67], a[152:155], a[204:207], v[64:67]
ds_read_b64_tr_b16 a[152:153], v210 offset:0
ds_read_b64_tr_b16 a[154:155], v210 offset:2048
v_mfma_f32_16x16x32_bf16 v[36:39], a[156:159], a[200:203], v[36:39]
v_accvgpr_write_b32 a70, v160
v_accvgpr_write_b32 a71, v160
v_mfma_f32_16x16x32_bf16 v[68:71], a[156:159], a[204:207], v[68:71]
buffer_load_dwordx4 v147, s[24:27], s43 offen offset:1024 lds
v_mfma_f32_16x16x32_bf16 v[80:83], a[168:171], a[200:203], v[80:83]
s_cmp_eq_u32 s74, 1
s_cselect_b32 s72, s73, 128
ds_read_b64_tr_b16 a[156:157], v211 offset:0
ds_read_b64_tr_b16 a[158:159], v211 offset:2048
v_mfma_f32_16x16x32_bf16 v[112:115], a[168:171], a[204:207], v[112:115]
s_add_u32 s43, s43, s72
ds_read_b64_tr_b16 a[168:169], v206 offset:256
ds_read_b64_tr_b16 a[170:171], v206 offset:2304
v_mfma_f32_16x16x32_bf16 v[84:87], a[172:175], a[200:203], v[84:87]
s_add_u32 m0, s44, 98304
v_accvgpr_write_b32 a72, v160
v_accvgpr_write_b32 a73, v160
v_mfma_f32_16x16x32_bf16 v[116:119], a[172:175], a[204:207], v[116:119]
buffer_load_dwordx4 v136, s[16:19], s42 offen offset:0 lds
v_mfma_f32_16x16x32_bf16 v[88:91], a[176:179], a[200:203], v[88:91]
ds_read_b64_tr_b16 a[172:173], v207 offset:256
ds_read_b64_tr_b16 a[174:175], v207 offset:2304
v_mfma_f32_16x16x32_bf16 v[120:123], a[176:179], a[204:207], v[120:123]
ds_read_b64_tr_b16 a[176:177], v208 offset:256
ds_read_b64_tr_b16 a[178:179], v208 offset:2304
v_mfma_f32_16x16x32_bf16 v[92:95], a[180:183], a[200:203], v[92:95]
v_accvgpr_write_b32 a74, v160
v_accvgpr_write_b32 a75, v160
v_mfma_f32_16x16x32_bf16 v[124:127], a[180:183], a[204:207], v[124:127]
buffer_load_dwordx4 v137, s[16:19], s42 offen offset:1024 lds
v_mfma_f32_16x16x32_bf16 v[96:99], a[184:187], a[200:203], v[96:99]
ds_read_b64_tr_b16 a[180:181], v209 offset:256
ds_read_b64_tr_b16 a[182:183], v209 offset:2304
v_mfma_f32_16x16x32_bf16 v[128:131], a[184:187], a[204:207], v[128:131]
ds_read_b64_tr_b16 a[184:185], v210 offset:256
ds_read_b64_tr_b16 a[186:187], v210 offset:2304
v_mfma_f32_16x16x32_bf16 v[100:103], a[188:191], a[200:203], v[100:103]
v_mfma_f32_16x16x32_bf16 v[132:135], a[188:191], a[204:207], v[132:135]
s_waitcnt lgkmcnt(8)
ds_read_b64_tr_b16 a[188:189], v211 offset:256
ds_read_b64_tr_b16 a[190:191], v211 offset:2304
v_mfma_f32_16x16x32_bf16 v[8:11], a[128:131], a[192:195], v[8:11]
buffer_load_dwordx4 v138, s[16:19], s42 offen offset:2048 lds
v_mfma_f32_16x16x32_bf16 v[40:43], a[128:131], a[196:199], v[40:43]
ds_read_b128 a[200:203], v213 offset:0
ds_read_b128 a[204:207], v213 offset:2048
v_mfma_f32_16x16x32_bf16 v[12:15], a[132:135], a[192:195], v[12:15]
v_accvgpr_write_b32 a76, v160
v_accvgpr_write_b32 a77, v160
v_mfma_f32_16x16x32_bf16 v[44:47], a[132:135], a[196:199], v[44:47]
v_accvgpr_write_b32 a78, v160
v_accvgpr_write_b32 a79, v160
v_smfmac_f32_16x16x64_bf16 a[248:251], a[208:211], a[128:135], v235
buffer_load_dwordx4 v139, s[16:19], s42 offen offset:3072 lds
v_mfma_f32_16x16x32_bf16 v[72:75], a[160:163], a[192:195], v[72:75]
ds_read_b64_tr_b16 a[128:129], v204 offset:16384
ds_read_b64_tr_b16 a[130:131], v204 offset:18432
v_mfma_f32_16x16x32_bf16 v[104:107], a[160:163], a[196:199], v[104:107]
ds_read_b64_tr_b16 a[132:133], v205 offset:16384
ds_read_b64_tr_b16 a[134:135], v205 offset:18432
v_mfma_f32_16x16x32_bf16 v[76:79], a[164:167], a[192:195], v[76:79]
v_accvgpr_write_b32 a80, v160
v_accvgpr_write_b32 a81, v160
v_mfma_f32_16x16x32_bf16 v[108:111], a[164:167], a[196:199], v[108:111]
s_add_u32 m0, s44, 102400
v_accvgpr_write_b32 a82, v160
v_accvgpr_write_b32 a83, v160
v_smfmac_f32_16x16x64_bf16 a[252:255], a[208:211], a[160:167], v235
buffer_load_dwordx4 v140, s[16:19], s42 offen offset:0 lds
v_mfma_f32_16x16x32_bf16 v[16:19], a[136:139], a[192:195], v[16:19]
ds_read_b64_tr_b16 a[160:161], v204 offset:16640
ds_read_b64_tr_b16 a[162:163], v204 offset:18688
v_mfma_f32_16x16x32_bf16 v[48:51], a[136:139], a[196:199], v[48:51]
ds_read_b64_tr_b16 a[164:165], v205 offset:16640
ds_read_b64_tr_b16 a[166:167], v205 offset:18688
v_mfma_f32_16x16x32_bf16 v[20:23], a[140:143], a[192:195], v[20:23]
ds_read_b64_tr_b16 a[136:137], v206 offset:16384
ds_read_b64_tr_b16 a[138:139], v206 offset:18432
v_mfma_f32_16x16x32_bf16 v[52:55], a[140:143], a[196:199], v[52:55]
buffer_load_dwordx4 v141, s[16:19], s42 offen offset:1024 lds
v_mfma_f32_16x16x32_bf16 v[24:27], a[144:147], a[192:195], v[24:27]
ds_read_b64_tr_b16 a[140:141], v207 offset:16384
ds_read_b64_tr_b16 a[142:143], v207 offset:18432
v_mfma_f32_16x16x32_bf16 v[56:59], a[144:147], a[196:199], v[56:59]
ds_read_b64_tr_b16 a[144:145], v208 offset:16384
ds_read_b64_tr_b16 a[146:147], v208 offset:18432
v_mfma_f32_16x16x32_bf16 v[28:31], a[148:151], a[192:195], v[28:31]
v_accvgpr_write_b32 a84, v160
v_accvgpr_write_b32 a85, v160
v_mfma_f32_16x16x32_bf16 v[60:63], a[148:151], a[196:199], v[60:63]
buffer_load_dwordx4 v142, s[16:19], s42 offen offset:2048 lds
v_mfma_f32_16x16x32_bf16 v[32:35], a[152:155], a[192:195], v[32:35]
ds_read_b64_tr_b16 a[148:149], v209 offset:16384
ds_read_b64_tr_b16 a[150:151], v209 offset:18432
v_mfma_f32_16x16x32_bf16 v[64:67], a[152:155], a[196:199], v[64:67]
ds_read_b64_tr_b16 a[152:153], v210 offset:16384
ds_read_b64_tr_b16 a[154:155], v210 offset:18432
v_mfma_f32_16x16x32_bf16 v[36:39], a[156:159], a[192:195], v[36:39]
v_accvgpr_write_b32 a86, v160
v_accvgpr_write_b32 a87, v160
v_mfma_f32_16x16x32_bf16 v[68:71], a[156:159], a[196:199], v[68:71]
buffer_load_dwordx4 v143, s[16:19], s42 offen offset:3072 lds
v_mfma_f32_16x16x32_bf16 v[80:83], a[168:171], a[192:195], v[80:83]
s_lshl_b32 s72, s72, 12
ds_read_b64_tr_b16 a[156:157], v211 offset:16384
ds_read_b64_tr_b16 a[158:159], v211 offset:18432
v_mfma_f32_16x16x32_bf16 v[112:115], a[168:171], a[196:199], v[112:115]
s_waitcnt lgkmcnt(10)
s_add_u32 s42, s42, s72
ds_read_b64_tr_b16 a[168:169], v206 offset:16640
ds_read_b64_tr_b16 a[170:171], v206 offset:18688
v_mfma_f32_16x16x32_bf16 v[84:87], a[172:175], a[192:195], v[84:87]
s_mov_b32 m0, s83
v_accvgpr_write_b32 a88, v160
v_accvgpr_write_b32 a89, v160
v_mfma_f32_16x16x32_bf16 v[116:119], a[172:175], a[196:199], v[116:119]
buffer_load_dwordx4 v144, s[24:27], s80 offen lds
v_mfma_f32_16x16x32_bf16 v[88:91], a[176:179], a[192:195], v[88:91]
ds_read_b64_tr_b16 a[172:173], v207 offset:16640
ds_read_b64_tr_b16 a[174:175], v207 offset:18688
v_mfma_f32_16x16x32_bf16 v[120:123], a[176:179], a[196:199], v[120:123]
ds_read_b64_tr_b16 a[176:177], v208 offset:16640
ds_read_b64_tr_b16 a[178:179], v208 offset:18688
v_mfma_f32_16x16x32_bf16 v[92:95], a[180:183], a[192:195], v[92:95]
v_accvgpr_write_b32 a90, v160
v_accvgpr_write_b32 a91, v160
v_mfma_f32_16x16x32_bf16 v[124:127], a[180:183], a[196:199], v[124:127]
ds_read_b64_tr_b16 a[180:181], v209 offset:16640
ds_read_b64_tr_b16 a[182:183], v209 offset:18688
v_mfma_f32_16x16x32_bf16 v[96:99], a[184:187], a[192:195], v[96:99]
buffer_load_dwordx4 v145, s[24:27], s80 offen offset:1024 lds
v_mfma_f32_16x16x32_bf16 v[128:131], a[184:187], a[196:199], v[128:131]
ds_read_b64_tr_b16 a[184:185], v210 offset:16640
ds_read_b64_tr_b16 a[186:187], v210 offset:18688
v_mfma_f32_16x16x32_bf16 v[100:103], a[188:191], a[192:195], v[100:103]
v_mfma_f32_16x16x32_bf16 v[132:135], a[188:191], a[196:199], v[132:135]
ds_read_b64_tr_b16 a[188:189], v211 offset:16640
ds_read_b64_tr_b16 a[190:191], v211 offset:18688
v_mfma_f32_16x16x32_bf16 v[8:11], a[128:131], a[200:203], v[8:11]
buffer_load_dwordx2 a[244:245], v240, s[24:27], s81 offen
v_mfma_f32_16x16x32_bf16 v[40:43], a[128:131], a[204:207], v[40:43]
v_accvgpr_write_b32 a92, v160
v_accvgpr_write_b32 a93, v160
v_mfma_f32_16x16x32_bf16 v[12:15], a[132:135], a[200:203], v[12:15]
v_accvgpr_write_b32 a94, v160
v_accvgpr_write_b32 a95, v160
v_mfma_f32_16x16x32_bf16 v[44:47], a[132:135], a[204:207], v[44:47]
v_accvgpr_write_b32 a96, v160
v_accvgpr_write_b32 a97, v160
v_smfmac_f32_16x16x64_bf16 a[248:251], a[208:211], a[128:135], v235
v_accvgpr_write_b32 a98, v160
v_accvgpr_write_b32 a99, v160
v_mfma_f32_16x16x32_bf16 v[72:75], a[160:163], a[200:203], v[72:75]
v_accvgpr_write_b32 a100, v160
v_accvgpr_write_b32 a101, v160
v_mfma_f32_16x16x32_bf16 v[104:107], a[160:163], a[204:207], v[104:107]
s_waitcnt vmcnt(17) lgkmcnt(0)
s_barrier
s_cmp_lg_u32 s32, 0
s_cbranch_scc1 K_W0_11
v_lshlrev_b32 v255, 4, v3
buffer_load_dword v254, v255, s[28:31], 0 offen sc0 sc1
K_W0_11:
v_mfma_f32_16x16x32_bf16 v[76:79], a[164:167], a[200:203], v[76:79]
s_add_u32 m0, s45, 81920
ds_read_b128 a[192:195], v192 offset:0
ds_read_b128 a[196:199], v192 offset:2048
v_mfma_f32_16x16x32_bf16 v[108:111], a[164:167], a[204:207], v[108:111]
buffer_load_dwordx4 v144, s[24:27], s43 offen offset:0 lds
v_smfmac_f32_16x16x64_bf16 a[252:255], a[208:211], a[160:167], v235
ds_read_b64_tr_b16 a[128:129], v184 offset:0
ds_read_b64_tr_b16 a[130:131], v184 offset:2048
v_mfma_f32_16x16x32_bf16 v[16:19], a[136:139], a[200:203], v[16:19]
ds_read_b64_tr_b16 a[132:133], v185 offset:0
ds_read_b64_tr_b16 a[134:135], v185 offset:2048
v_mfma_f32_16x16x32_bf16 v[48:51], a[136:139], a[204:207], v[48:51]
ds_read_b64_tr_b16 a[160:161], v184 offset:256
ds_read_b64_tr_b16 a[162:163], v184 offset:2304
v_mfma_f32_16x16x32_bf16 v[20:23], a[140:143], a[200:203], v[20:23]
buffer_load_dwordx4 v145, s[24:27], s43 offen offset:1024 lds
v_mfma_f32_16x16x32_bf16 v[52:55], a[140:143], a[204:207], v[52:55]
ds_read_b64_tr_b16 a[164:165], v185 offset:256
ds_read_b64_tr_b16 a[166:167], v185 offset:2304
v_mfma_f32_16x16x32_bf16 v[24:27], a[144:147], a[200:203], v[24:27]
ds_read_b64_tr_b16 a[136:137], v186 offset:0
ds_read_b64_tr_b16 a[138:139], v186 offset:2048
v_mfma_f32_16x16x32_bf16 v[56:59], a[144:147], a[204:207], v[56:59]
s_add_u32 m0, s85, 81920
ds_read_b64_tr_b16 a[140:141], v187 offset:0
ds_read_b64_tr_b16 a[142:143], v187 offset:2048
v_mfma_f32_16x16x32_bf16 v[28:31], a[148:151], a[200:203], v[28:31]
buffer_load_dwordx4 v146, s[24:27], s43 offen offset:0 lds
v_mfma_f32_16x16x32_bf16 v[60:63], a[148:151], a[204:207], v[60:63]
ds_read_b64_tr_b16 a[144:145], v188 offset:0
ds_read_b64_tr_b16 a[146:147], v188 offset:2048
v_mfma_f32_16x16x32_bf16 v[32:35], a[152:155], a[200:203], v[32:35]
ds_read_b64_tr_b16 a[148:149], v189 offset:0
ds_read_b64_tr_b16 a[150:151], v189 offset:2048
v_mfma_f32_16x16x32_bf16 v[64:67], a[152:155], a[204:207], v[64:67]
ds_read_b64_tr_b16 a[152:153], v190 offset:0
ds_read_b64_tr_b16 a[154:155], v190 offset:2048
v_mfma_f32_16x16x32_bf16 v[36:39], a[156:159], a[200:203], v[36:39]
v_accvgpr_write_b32 a102, v160
v_accvgpr_write_b32 a103, v160
v_mfma_f32_16x16x32_bf16 v[68:71], a[156:159], a[204:207], v[68:71]
buffer_load_dwordx4 v147, s[24:27], s43 offen offset:1024 lds
v_mfma_f32_16x16x32_bf16 v[80:83], a[168:171], a[200:203], v[80:83]
s_cmp_eq_u32 s74, 0
s_cselect_b32 s72, s73, 128
ds_read_b64_tr_b16 a[156:157], v191 offset:0
ds_read_b64_tr_b16 a[158:159], v191 offset:2048
v_mfma_f32_16x16x32_bf16 v[112:115], a[168:171], a[204:207], v[112:115]
s_add_u32 s43, s43, s72
ds_read_b64_tr_b16 a[168:169], v186 offset:256
ds_read_b64_tr_b16 a[170:171], v186 offset:2304
v_mfma_f32_16x16x32_bf16 v[84:87], a[172:175], a[200:203], v[84:87]
s_add_u32 m0, s44, 49152
v_accvgpr_write_b32 a104, v160
v_accvgpr_write_b32 a105, v160
v_mfma_f32_16x16x32_bf16 v[116:119], a[172:175], a[204:207], v[116:119]
buffer_load_dwordx4 v136, s[16:19], s42 offen offset:0 lds
v_mfma_f32_16x16x32_bf16 v[88:91], a[176:179], a[200:203], v[88:91]
ds_read_b64_tr_b16 a[172:173], v187 offset:256
ds_read_b64_tr_b16 a[174:175], v187 offset:2304
v_mfma_f32_16x16x32_bf16 v[120:123], a[176:179], a[204:207], v[120:123]
ds_read_b64_tr_b16 a[176:177], v188 offset:256
ds_read_b64_tr_b16 a[178:179], v188 offset:2304
v_mfma_f32_16x16x32_bf16 v[92:95], a[180:183], a[200:203], v[92:95]
v_accvgpr_write_b32 a106, v160
v_accvgpr_write_b32 a107, v160
v_mfma_f32_16x16x32_bf16 v[124:127], a[180:183], a[204:207], v[124:127]
buffer_load_dwordx4 v137, s[16:19], s42 offen offset:1024 lds
v_mfma_f32_16x16x32_bf16 v[96:99], a[184:187], a[200:203], v[96:99]
ds_read_b64_tr_b16 a[180:181], v189 offset:256
ds_read_b64_tr_b16 a[182:183], v189 offset:2304
v_mfma_f32_16x16x32_bf16 v[128:131], a[184:187], a[204:207], v[128:131]
ds_read_b64_tr_b16 a[184:185], v190 offset:256
ds_read_b64_tr_b16 a[186:187], v190 offset:2304
v_mfma_f32_16x16x32_bf16 v[100:103], a[188:191], a[200:203], v[100:103]
v_mfma_f32_16x16x32_bf16 v[132:135], a[188:191], a[204:207], v[132:135]
s_waitcnt lgkmcnt(8)
ds_read_b64_tr_b16 a[188:189], v191 offset:256
ds_read_b64_tr_b16 a[190:191], v191 offset:2304
v_mfma_f32_16x16x32_bf16 v[8:11], a[128:131], a[192:195], v[8:11]
buffer_load_dwordx4 v138, s[16:19], s42 offen offset:2048 lds
v_mfma_f32_16x16x32_bf16 v[40:43], a[128:131], a[196:199], v[40:43]
ds_read_b128 a[200:203], v193 offset:0
ds_read_b128 a[204:207], v193 offset:2048
v_mfma_f32_16x16x32_bf16 v[12:15], a[132:135], a[192:195], v[12:15]
v_accvgpr_write_b32 a108, v160
v_accvgpr_write_b32 a109, v160
v_mfma_f32_16x16x32_bf16 v[44:47], a[132:135], a[196:199], v[44:47]
v_accvgpr_write_b32 a110, v160
v_accvgpr_write_b32 a111, v160
v_smfmac_f32_16x16x64_bf16 a[248:251], a[208:211], a[128:135], v235
buffer_load_dwordx4 v139, s[16:19], s42 offen offset:3072 lds
v_mfma_f32_16x16x32_bf16 v[72:75], a[160:163], a[192:195], v[72:75]
ds_read_b64_tr_b16 a[128:129], v184 offset:16384
ds_read_b64_tr_b16 a[130:131], v184 offset:18432
v_mfma_f32_16x16x32_bf16 v[104:107], a[160:163], a[196:199], v[104:107]
ds_read_b64_tr_b16 a[132:133], v185 offset:16384
ds_read_b64_tr_b16 a[134:135], v185 offset:18432
v_mfma_f32_16x16x32_bf16 v[76:79], a[164:167], a[192:195], v[76:79]
v_accvgpr_write_b32 a112, v160
v_accvgpr_write_b32 a113, v160
v_mfma_f32_16x16x32_bf16 v[108:111], a[164:167], a[196:199], v[108:111]
s_add_u32 m0, s44, 53248
v_accvgpr_write_b32 a114, v160
v_accvgpr_write_b32 a115, v160
v_smfmac_f32_16x16x64_bf16 a[252:255], a[208:211], a[160:167], v235
buffer_load_dwordx4 v140, s[16:19], s42 offen offset:0 lds
v_mfma_f32_16x16x32_bf16 v[16:19], a[136:139], a[192:195], v[16:19]
ds_read_b64_tr_b16 a[160:161], v184 offset:16640
ds_read_b64_tr_b16 a[162:163], v184 offset:18688
v_mfma_f32_16x16x32_bf16 v[48:51], a[136:139], a[196:199], v[48:51]
ds_read_b64_tr_b16 a[164:165], v185 offset:16640
ds_read_b64_tr_b16 a[166:167], v185 offset:18688
v_mfma_f32_16x16x32_bf16 v[20:23], a[140:143], a[192:195], v[20:23]
ds_read_b64_tr_b16 a[136:137], v186 offset:16384
ds_read_b64_tr_b16 a[138:139], v186 offset:18432
v_mfma_f32_16x16x32_bf16 v[52:55], a[140:143], a[196:199], v[52:55]
buffer_load_dwordx4 v141, s[16:19], s42 offen offset:1024 lds
v_mfma_f32_16x16x32_bf16 v[24:27], a[144:147], a[192:195], v[24:27]
ds_read_b64_tr_b16 a[140:141], v187 offset:16384
ds_read_b64_tr_b16 a[142:143], v187 offset:18432
v_mfma_f32_16x16x32_bf16 v[56:59], a[144:147], a[196:199], v[56:59]
ds_read_b64_tr_b16 a[144:145], v188 offset:16384
ds_read_b64_tr_b16 a[146:147], v188 offset:18432
v_mfma_f32_16x16x32_bf16 v[28:31], a[148:151], a[192:195], v[28:31]
v_accvgpr_write_b32 a116, v160
v_accvgpr_write_b32 a117, v160
v_mfma_f32_16x16x32_bf16 v[60:63], a[148:151], a[196:199], v[60:63]
buffer_load_dwordx4 v142, s[16:19], s42 offen offset:2048 lds
v_mfma_f32_16x16x32_bf16 v[32:35], a[152:155], a[192:195], v[32:35]
ds_read_b64_tr_b16 a[148:149], v189 offset:16384
ds_read_b64_tr_b16 a[150:151], v189 offset:18432
v_mfma_f32_16x16x32_bf16 v[64:67], a[152:155], a[196:199], v[64:67]
ds_read_b64_tr_b16 a[152:153], v190 offset:16384
ds_read_b64_tr_b16 a[154:155], v190 offset:18432
v_mfma_f32_16x16x32_bf16 v[36:39], a[156:159], a[192:195], v[36:39]
v_accvgpr_write_b32 a118, v160
v_accvgpr_write_b32 a119, v160
v_mfma_f32_16x16x32_bf16 v[68:71], a[156:159], a[196:199], v[68:71]
buffer_load_dwordx4 v143, s[16:19], s42 offen offset:3072 lds
v_mfma_f32_16x16x32_bf16 v[80:83], a[168:171], a[192:195], v[80:83]
s_waitcnt lgkmcnt(8)
ds_read_b64_tr_b16 a[156:157], v191 offset:16384
ds_read_b64_tr_b16 a[158:159], v191 offset:18432
v_mfma_f32_16x16x32_bf16 v[112:115], a[168:171], a[196:199], v[112:115]
s_lshl_b32 s72, s72, 12
ds_read_b64_tr_b16 a[168:169], v186 offset:16640
ds_read_b64_tr_b16 a[170:171], v186 offset:18688
v_mfma_f32_16x16x32_bf16 v[84:87], a[172:175], a[192:195], v[84:87]
s_add_u32 s42, s42, s72
v_accvgpr_write_b32 a120, v160
v_accvgpr_write_b32 a121, v160
v_mfma_f32_16x16x32_bf16 v[116:119], a[172:175], a[196:199], v[116:119]
ds_read_b64_tr_b16 a[172:173], v187 offset:16640
ds_read_b64_tr_b16 a[174:175], v187 offset:18688
v_mfma_f32_16x16x32_bf16 v[88:91], a[176:179], a[192:195], v[88:91]
v_accvgpr_write_b32 a122, v160
v_accvgpr_write_b32 a123, v160
v_mfma_f32_16x16x32_bf16 v[120:123], a[176:179], a[196:199], v[120:123]
ds_read_b64_tr_b16 a[176:177], v188 offset:16640
ds_read_b64_tr_b16 a[178:179], v188 offset:18688
v_mfma_f32_16x16x32_bf16 v[92:95], a[180:183], a[192:195], v[92:95]
v_accvgpr_write_b32 a124, v160
v_accvgpr_write_b32 a125, v160
v_mfma_f32_16x16x32_bf16 v[124:127], a[180:183], a[196:199], v[124:127]
ds_read_b64_tr_b16 a[180:181], v189 offset:16640
ds_read_b64_tr_b16 a[182:183], v189 offset:18688
v_mfma_f32_16x16x32_bf16 v[96:99], a[184:187], a[192:195], v[96:99]
v_accvgpr_write_b32 a126, v160
v_accvgpr_write_b32 a127, v160
v_mfma_f32_16x16x32_bf16 v[128:131], a[184:187], a[196:199], v[128:131]
ds_read_b64_tr_b16 a[184:185], v190 offset:16640
ds_read_b64_tr_b16 a[186:187], v190 offset:18688
v_mfma_f32_16x16x32_bf16 v[100:103], a[188:191], a[192:195], v[100:103]
v_mfma_f32_16x16x32_bf16 v[132:135], a[188:191], a[196:199], v[132:135]
ds_read_b64_tr_b16 a[188:189], v191 offset:16640
ds_read_b64_tr_b16 a[190:191], v191 offset:18688
v_mfma_f32_16x16x32_bf16 v[8:11], a[128:131], a[200:203], v[8:11]
v_mfma_f32_16x16x32_bf16 v[40:43], a[128:131], a[204:207], v[40:43]
v_mfma_f32_16x16x32_bf16 v[12:15], a[132:135], a[200:203], v[12:15]
v_mfma_f32_16x16x32_bf16 v[44:47], a[132:135], a[204:207], v[44:47]
v_smfmac_f32_16x16x64_bf16 a[248:251], a[208:211], a[128:135], v235
v_mfma_f32_16x16x32_bf16 v[72:75], a[160:163], a[200:203], v[72:75]
v_mfma_f32_16x16x32_bf16 v[104:107], a[160:163], a[204:207], v[104:107]
s_cmp_lg_u32 s32, 0
s_cbranch_scc1 K_CNTOK
s_waitcnt vmcnt(12)
v_cmp_gt_u32 vcc, 16, v254
s_cbranch_vccz K_CNTOK
K_CNTSPIN:
s_sleep 2
s_add_u32 s100, s100, 1
s_bitcmp1_b32 s100, 19
s_cbranch_scc1 K_END
buffer_load_dword v254, v255, s[28:31], 0 offen sc0 sc1
s_waitcnt vmcnt(0)
v_cmp_gt_u32 vcc, 16, v254
s_cbranch_vccnz K_CNTSPIN
K_CNTOK:
s_waitcnt vmcnt(15) lgkmcnt(0)
s_barrier
v_mfma_f32_16x16x32_bf16 v[76:79], a[164:167], a[200:203], v[76:79]
s_mov_b32 s38, 0
ds_read_b128 a[192:195], v202 offset:0
ds_read_b128 a[196:199], v202 offset:2048
v_mfma_f32_16x16x32_bf16 v[108:111], a[164:167], a[204:207], v[108:111]
s_add_u32 m0, s37, 32768
ds_read_b64_tr_b16 a[128:129], v194 offset:0
ds_read_b64_tr_b16 a[130:131], v194 offset:2048
v_smfmac_f32_16x16x64_bf16 a[252:255], a[208:211], a[160:167], v235
buffer_load_dwordx4 v228, s[8:11], s38 offen offset:0 lds
v_mfma_f32_16x16x32_bf16 v[16:19], a[136:139], a[200:203], v[16:19]
ds_read_b64_tr_b16 a[132:133], v195 offset:0
ds_read_b64_tr_b16 a[134:135], v195 offset:2048
v_mfma_f32_16x16x32_bf16 v[48:51], a[136:139], a[204:207], v[48:51]
ds_read_b64_tr_b16 a[160:161], v194 offset:256
ds_read_b64_tr_b16 a[162:163], v194 offset:2304
v_mfma_f32_16x16x32_bf16 v[20:23], a[140:143], a[200:203], v[20:23]
ds_read_b64_tr_b16 a[164:165], v195 offset:256
ds_read_b64_tr_b16 a[166:167], v195 offset:2304
v_mfma_f32_16x16x32_bf16 v[52:55], a[140:143], a[204:207], v[52:55]
ds_read_b64_tr_b16 a[136:137], v196 offset:0
ds_read_b64_tr_b16 a[138:139], v196 offset:2048
v_mfma_f32_16x16x32_bf16 v[24:27], a[144:147], a[200:203], v[24:27]
buffer_load_dwordx4 v229, s[8:11], s38 offen offset:1024 lds
v_mfma_f32_16x16x32_bf16 v[56:59], a[144:147], a[204:207], v[56:59]
ds_read_b64_tr_b16 a[140:141], v197 offset:0
ds_read_b64_tr_b16 a[142:143], v197 offset:2048
v_mfma_f32_16x16x32_bf16 v[28:31], a[148:151], a[200:203], v[28:31]
ds_read_b64_tr_b16 a[144:145], v198 offset:0
ds_read_b64_tr_b16 a[146:147], v198 offset:2048
v_mfma_f32_16x16x32_bf16 v[60:63], a[148:151], a[204:207], v[60:63]
ds_read_b64_tr_b16 a[148:149], v199 offset:0
ds_read_b64_tr_b16 a[150:151], v199 offset:2048
v_mfma_f32_16x16x32_bf16 v[32:35], a[152:155], a[200:203], v[32:35]
buffer_load_dwordx4 v230, s[8:11], s38 offen offset:2048 lds
v_mfma_f32_16x16x32_bf16 v[64:67], a[152:155], a[204:207], v[64:67]
ds_read_b64_tr_b16 a[152:153], v200 offset:0
ds_read_b64_tr_b16 a[154:155], v200 offset:2048
v_mfma_f32_16x16x32_bf16 v[36:39], a[156:159], a[200:203], v[36:39]
v_mfma_f32_16x16x32_bf16 v[68:71], a[156:159], a[204:207], v[68:71]
ds_read_b64_tr_b16 a[156:157], v201 offset:0
ds_read_b64_tr_b16 a[158:159], v201 offset:2048
v_mfma_f32_16x16x32_bf16 v[80:83], a[168:171], a[200:203], v[80:83]
buffer_load_dwordx4 v231, s[8:11], s38 offen offset:3072 lds
v_mfma_f32_16x16x32_bf16 v[112:115], a[168:171], a[204:207], v[112:115]
ds_read_b64_tr_b16 a[168:169], v196 offset:256
ds_read_b64_tr_b16 a[170:171], v196 offset:2304
v_mfma_f32_16x16x32_bf16 v[84:87], a[172:175], a[200:203], v[84:87]
s_add_u32 s38, s38, 16384
v_mfma_f32_16x16x32_bf16 v[116:119], a[172:175], a[204:207], v[116:119]
s_add_u32 m0, s37, 16384
ds_read_b64_tr_b16 a[172:173], v197 offset:256
ds_read_b64_tr_b16 a[174:175], v197 offset:2304
v_mfma_f32_16x16x32_bf16 v[88:91], a[176:179], a[200:203], v[88:91]
buffer_load_dwordx4 v228, s[8:11], s38 offen offset:0 lds
v_mfma_f32_16x16x32_bf16 v[120:123], a[176:179], a[204:207], v[120:123]
ds_read_b64_tr_b16 a[176:177], v198 offset:256
ds_read_b64_tr_b16 a[178:179], v198 offset:2304
v_mfma_f32_16x16x32_bf16 v[92:95], a[180:183], a[200:203], v[92:95]
v_mfma_f32_16x16x32_bf16 v[124:127], a[180:183], a[204:207], v[124:127]
ds_read_b64_tr_b16 a[180:181], v199 offset:256
ds_read_b64_tr_b16 a[182:183], v199 offset:2304
v_mfma_f32_16x16x32_bf16 v[96:99], a[184:187], a[200:203], v[96:99]
buffer_load_dwordx4 v229, s[8:11], s38 offen offset:1024 lds
v_mfma_f32_16x16x32_bf16 v[128:131], a[184:187], a[204:207], v[128:131]
ds_read_b64_tr_b16 a[184:185], v200 offset:256
ds_read_b64_tr_b16 a[186:187], v200 offset:2304
v_mfma_f32_16x16x32_bf16 v[100:103], a[188:191], a[200:203], v[100:103]
v_mfma_f32_16x16x32_bf16 v[132:135], a[188:191], a[204:207], v[132:135]
s_waitcnt lgkmcnt(8)
ds_read_b64_tr_b16 a[188:189], v201 offset:256
ds_read_b64_tr_b16 a[190:191], v201 offset:2304
v_mfma_f32_16x16x32_bf16 v[8:11], a[128:131], a[192:195], v[8:11]
s_add_u32 s76, s6, 0x270000
s_addc_u32 s77, s7, 0
ds_read_b128 a[200:203], v203 offset:0
ds_read_b128 a[204:207], v203 offset:2048
v_mfma_f32_16x16x32_bf16 v[40:43], a[128:131], a[196:199], v[40:43]
s_and_b32 s77, s77, 0xffff
buffer_load_dwordx4 v230, s[8:11], s38 offen offset:2048 lds
v_mfma_f32_16x16x32_bf16 v[12:15], a[132:135], a[192:195], v[12:15]
s_mov_b32 s78, 512
v_mfma_f32_16x16x32_bf16 v[44:47], a[132:135], a[196:199], v[44:47]
s_mov_b32 s79, 0x00020000
v_smfmac_f32_16x16x64_bf16 a[248:251], a[208:211], a[128:135], v235
s_mov_b32 s16, s86
ds_read_b64_tr_b16 a[128:129], v194 offset:16384
ds_read_b64_tr_b16 a[130:131], v194 offset:18432
v_mfma_f32_16x16x32_bf16 v[72:75], a[160:163], a[192:195], v[72:75]
s_and_b32 s17, s87, 0xffff
buffer_load_dwordx4 v231, s[8:11], s38 offen offset:3072 lds
v_mfma_f32_16x16x32_bf16 v[104:107], a[160:163], a[196:199], v[104:107]
s_mov_b32 s18, 4718592
ds_read_b64_tr_b16 a[132:133], v195 offset:16384
ds_read_b64_tr_b16 a[134:135], v195 offset:18432
v_mfma_f32_16x16x32_bf16 v[76:79], a[164:167], a[192:195], v[76:79]
s_add_u32 s38, s38, 16384
v_mfma_f32_16x16x32_bf16 v[108:111], a[164:167], a[196:199], v[108:111]
s_add_u32 m0, s37, 0
v_smfmac_f32_16x16x64_bf16 a[252:255], a[208:211], a[160:167], v235
s_mul_i32 s47, s35, 1179648
buffer_load_dwordx4 v228, s[8:11], s38 offen offset:0 lds
v_mfma_f32_16x16x32_bf16 v[16:19], a[136:139], a[192:195], v[16:19]
s_add_u32 s28, s86, s47
s_addc_u32 s29, s87, 0
ds_read_b64_tr_b16 a[160:161], v194 offset:16640
ds_read_b64_tr_b16 a[162:163], v194 offset:18688
v_mfma_f32_16x16x32_bf16 v[48:51], a[136:139], a[196:199], v[48:51]
s_and_b32 s29, s29, 0xffff
ds_read_b64_tr_b16 a[164:165], v195 offset:16640
ds_read_b64_tr_b16 a[166:167], v195 offset:18688
v_mfma_f32_16x16x32_bf16 v[20:23], a[140:143], a[192:195], v[20:23]
s_mov_b32 s30, 1179648
ds_read_b64_tr_b16 a[136:137], v196 offset:16384
ds_read_b64_tr_b16 a[138:139], v196 offset:18432
v_mfma_f32_16x16x32_bf16 v[52:55], a[140:143], a[196:199], v[52:55]
s_mov_b32 s42, 0xffc00000
buffer_load_dwordx4 v229, s[8:11], s38 offen offset:1024 lds
v_mfma_f32_16x16x32_bf16 v[24:27], a[144:147], a[192:195], v[24:27]
s_mov_b32 s43, 0x100000
ds_read_b64_tr_b16 a[140:141], v197 offset:16384
ds_read_b64_tr_b16 a[142:143], v197 offset:18432
v_mfma_f32_16x16x32_bf16 v[56:59], a[144:147], a[196:199], v[56:59]
s_lshr_b32 s46, s2, 3
ds_read_b64_tr_b16 a[144:145], v198 offset:16384
ds_read_b64_tr_b16 a[146:147], v198 offset:18432
v_mfma_f32_16x16x32_bf16 v[28:31], a[148:151], a[192:195], v[28:31]
s_lshl_b32 s46, s46, 2
v_mfma_f32_16x16x32_bf16 v[60:63], a[148:151], a[196:199], v[60:63]
s_add_u32 s46, s46, s32
buffer_load_dwordx4 v230, s[8:11], s38 offen offset:2048 lds
v_mfma_f32_16x16x32_bf16 v[32:35], a[152:155], a[192:195], v[32:35]
s_mul_i32 s45, s46, 4608
ds_read_b64_tr_b16 a[148:149], v199 offset:16384
ds_read_b64_tr_b16 a[150:151], v199 offset:18432
v_mfma_f32_16x16x32_bf16 v[64:67], a[152:155], a[196:199], v[64:67]
s_sub_u32 s45, s45, 6488064
ds_read_b64_tr_b16 a[152:153], v200 offset:16384
ds_read_b64_tr_b16 a[154:155], v200 offset:18432
v_mfma_f32_16x16x32_bf16 v[36:39], a[156:159], a[192:195], v[36:39]
s_min_u32 s46, s46, (K_CODE_END-K_LAST)>>10
v_mfma_f32_16x16x32_bf16 v[68:71], a[156:159], a[196:199], v[68:71]
s_lshl_b32 s46, s46, 10
ds_read_b64_tr_b16 a[156:157], v201 offset:16384
ds_read_b64_tr_b16 a[158:159], v201 offset:18432
v_mfma_f32_16x16x32_bf16 v[80:83], a[168:171], a[192:195], v[80:83]
s_waitcnt lgkmcnt(10)
buffer_load_dwordx4 v231, s[8:11], s38 offen offset:3072 lds
v_mfma_f32_16x16x32_bf16 v[112:115], a[168:171], a[196:199], v[112:115]
s_add_u32 s38, s38, 16384
ds_read_b64_tr_b16 a[168:169], v196 offset:16640
v_lshlrev_b32 v255, 3, v3
v_mfma_f32_16x16x32_bf16 v[84:87], a[172:175], a[192:195], v[84:87]
s_lshl_b32 s48, s55, 3
ds_read_b64_tr_b16 a[170:171], v196 offset:18688
v_add_u32 v242, s46, v234
v_mfma_f32_16x16x32_bf16 v[116:119], a[172:175], a[196:199], v[116:119]
s_add_u32 s48, s48, 0x240000
ds_read_b64_tr_b16 a[172:173], v197 offset:16640
ds_read_b64_tr_b16 a[174:175], v197 offset:18688
v_mfma_f32_16x16x32_bf16 v[88:91], a[176:179], a[192:195], v[88:91]
s_lshl_b32 s47, s2, 2
buffer_load_dwordx2 v[148:149], v255, s[20:23], s48 offen sc0 sc1
v_mfma_f32_16x16x32_bf16 v[120:123], a[176:179], a[196:199], v[120:123]
s_add_u32 s47, s47, s32
ds_read_b64_tr_b16 a[176:177], v198 offset:16640
ds_read_b64_tr_b16 a[178:179], v198 offset:18688
v_mfma_f32_16x16x32_bf16 v[92:95], a[180:183], a[192:195], v[92:95]
s_cmp_ge_u32 s47, 324
s_cselect_b64 s[24:25], s[60:61], s[56:57]
s_cselect_b32 s46, 324, 0
v_mfma_f32_16x16x32_bf16 v[124:127], a[180:183], a[196:199], v[124:127]
s_xor_b32 s48, s48, 128
ds_read_b64_tr_b16 a[180:181], v199 offset:16640
ds_read_b64_tr_b16 a[182:183], v199 offset:18688
v_mfma_f32_16x16x32_bf16 v[96:99], a[184:187], a[192:195], v[96:99]
s_cmp_ge_u32 s47, 648
s_cselect_b64 s[24:25], s[64:65], s[24:25]
s_cselect_b32 s46, 648, s46
buffer_load_dwordx2 v[150:151], v255, s[20:23], s48 offen sc0 sc1
v_mfma_f32_16x16x32_bf16 v[128:131], a[184:187], a[196:199], v[128:131]
s_sub_u32 s47, s47, s46
ds_read_b64_tr_b16 a[184:185], v200 offset:16640
ds_read_b64_tr_b16 a[186:187], v200 offset:18688
v_mfma_f32_16x16x32_bf16 v[100:103], a[188:191], a[192:195], v[100:103]
s_min_u32 s47, s47, 323
v_mfma_f32_16x16x32_bf16 v[132:135], a[188:191], a[196:199], v[132:135]
s_lshl_b32 s47, s47, 14
ds_read_b64_tr_b16 a[188:189], v201 offset:16640
ds_read_b64_tr_b16 a[190:191], v201 offset:18688
s_add_u32 s24, s24, s47
s_addc_u32 s25, s25, 0
s_mov_b32 s26, 16384
v_mfma_f32_16x16x32_bf16 v[8:11], a[128:131], a[200:203], v[8:11]
s_mov_b32 s44, 0
v_lshlrev_b32 v0, 6, v1
v_mfma_f32_16x16x32_bf16 v[40:43], a[128:131], a[204:207], v[40:43]
s_or_b32 s46, s32, s36
s_cselect_b32 s74, 8, 12
v_mfma_f32_16x16x32_bf16 v[12:15], a[132:135], a[200:203], v[12:15]
s_bitset1_b32 s74, 8
v_mfma_f32_16x16x32_bf16 v[44:47], a[132:135], a[204:207], v[44:47]
s_getpc_b64 s[72:73]
PC_c:
s_add_u32 s72, s72, K_LAST-PC_c
s_addc_u32 s73, s73, 0
v_smfmac_f32_16x16x64_bf16 a[248:251], a[208:211], a[128:135], v235
v_mfma_f32_16x16x32_bf16 v[72:75], a[160:163], a[200:203], v[72:75]
v_mfma_f32_16x16x32_bf16 v[104:107], a[160:163], a[204:207], v[104:107]
s_waitcnt vmcnt(2) lgkmcnt(0)
s_barrier
v_mfma_f32_16x16x32_bf16 v[76:79], a[164:167], a[200:203], v[76:79]
s_mov_b32 s39, 0
ds_read_b128 a[192:195], v212 offset:0
ds_read_b128 a[196:199], v212 offset:2048
v_mfma_f32_16x16x32_bf16 v[108:111], a[164:167], a[204:207], v[108:111]
s_add_u32 m0, s37, 98304
ds_read_b64_tr_b16 a[128:129], v204 offset:0
ds_read_b64_tr_b16 a[130:131], v204 offset:2048
v_smfmac_f32_16x16x64_bf16 a[252:255], a[208:211], a[160:167], v235
buffer_load_dwordx4 v232, s[12:15], s39 offen offset:0 lds
v_mfma_f32_16x16x32_bf16 v[16:19], a[136:139], a[200:203], v[16:19]
ds_read_b64_tr_b16 a[132:133], v205 offset:0
ds_read_b64_tr_b16 a[134:135], v205 offset:2048
v_mfma_f32_16x16x32_bf16 v[48:51], a[136:139], a[204:207], v[48:51]
ds_read_b64_tr_b16 a[160:161], v204 offset:256
ds_read_b64_tr_b16 a[162:163], v204 offset:2304
v_mfma_f32_16x16x32_bf16 v[20:23], a[140:143], a[200:203], v[20:23]
ds_read_b64_tr_b16 a[164:165], v205 offset:256
ds_read_b64_tr_b16 a[166:167], v205 offset:2304
v_mfma_f32_16x16x32_bf16 v[52:55], a[140:143], a[204:207], v[52:55]
buffer_load_dwordx4 v233, s[12:15], s39 offen offset:1024 lds
v_mfma_f32_16x16x32_bf16 v[24:27], a[144:147], a[200:203], v[24:27]
ds_read_b64_tr_b16 a[136:137], v206 offset:0
ds_read_b64_tr_b16 a[138:139], v206 offset:2048
v_mfma_f32_16x16x32_bf16 v[56:59], a[144:147], a[204:207], v[56:59]
ds_read_b64_tr_b16 a[140:141], v207 offset:0
ds_read_b64_tr_b16 a[142:143], v207 offset:2048
v_mfma_f32_16x16x32_bf16 v[28:31], a[148:151], a[200:203], v[28:31]
ds_read_b64_tr_b16 a[144:145], v208 offset:0
ds_read_b64_tr_b16 a[146:147], v208 offset:2048
v_mfma_f32_16x16x32_bf16 v[60:63], a[148:151], a[204:207], v[60:63]
ds_read_b64_tr_b16 a[148:149], v209 offset:0
ds_read_b64_tr_b16 a[150:151], v209 offset:2048
v_mfma_f32_16x16x32_bf16 v[32:35], a[152:155], a[200:203], v[32:35]
buffer_load_dwordx4 v232, s[12:15], s39 offen offset:2048 lds
v_mfma_f32_16x16x32_bf16 v[64:67], a[152:155], a[204:207], v[64:67]
ds_read_b64_tr_b16 a[152:153], v210 offset:0
ds_read_b64_tr_b16 a[154:155], v210 offset:2048
v_mfma_f32_16x16x32_bf16 v[36:39], a[156:159], a[200:203], v[36:39]
v_mfma_f32_16x16x32_bf16 v[68:71], a[156:159], a[204:207], v[68:71]
ds_read_b64_tr_b16 a[156:157], v211 offset:0
ds_read_b64_tr_b16 a[158:159], v211 offset:2048
v_mfma_f32_16x16x32_bf16 v[80:83], a[168:171], a[200:203], v[80:83]
buffer_load_dwordx4 v233, s[12:15], s39 offen offset:3072 lds
v_mfma_f32_16x16x32_bf16 v[112:115], a[168:171], a[204:207], v[112:115]
ds_read_b64_tr_b16 a[168:169], v206 offset:256
ds_read_b64_tr_b16 a[170:171], v206 offset:2304
v_mfma_f32_16x16x32_bf16 v[84:87], a[172:175], a[200:203], v[84:87]
s_add_u32 s39, s39, 16384
v_mfma_f32_16x16x32_bf16 v[116:119], a[172:175], a[204:207], v[116:119]
s_add_u32 m0, s37, 114688
ds_read_b64_tr_b16 a[172:173], v207 offset:256
ds_read_b64_tr_b16 a[174:175], v207 offset:2304
v_mfma_f32_16x16x32_bf16 v[88:91], a[176:179], a[200:203], v[88:91]
buffer_load_dwordx4 v232, s[12:15], s39 offen offset:0 lds
v_mfma_f32_16x16x32_bf16 v[120:123], a[176:179], a[204:207], v[120:123]
ds_read_b64_tr_b16 a[176:177], v208 offset:256
ds_read_b64_tr_b16 a[178:179], v208 offset:2304
v_mfma_f32_16x16x32_bf16 v[92:95], a[180:183], a[200:203], v[92:95]
v_mfma_f32_16x16x32_bf16 v[124:127], a[180:183], a[204:207], v[124:127]
ds_read_b64_tr_b16 a[180:181], v209 offset:256
ds_read_b64_tr_b16 a[182:183], v209 offset:2304
v_mfma_f32_16x16x32_bf16 v[96:99], a[184:187], a[200:203], v[96:99]
buffer_load_dwordx4 v233, s[12:15], s39 offen offset:1024 lds
v_mfma_f32_16x16x32_bf16 v[128:131], a[184:187], a[204:207], v[128:131]
ds_read_b64_tr_b16 a[184:185], v210 offset:256
ds_read_b64_tr_b16 a[186:187], v210 offset:2304
v_mfma_f32_16x16x32_bf16 v[100:103], a[188:191], a[200:203], v[100:103]
v_mfma_f32_16x16x32_bf16 v[132:135], a[188:191], a[204:207], v[132:135]
s_waitcnt lgkmcnt(8)
ds_read_b64_tr_b16 a[188:189], v211 offset:256
ds_read_b64_tr_b16 a[190:191], v211 offset:2304
v_mfma_f32_16x16x32_bf16 v[8:11], a[128:131], a[192:195], v[8:11]
s_lshl_b32 s46, s32, 7
buffer_load_dwordx4 v232, s[12:15], s39 offen offset:2048 lds
v_mfma_f32_16x16x32_bf16 v[40:43], a[128:131], a[196:199], v[40:43]
s_add_u32 s46, s46, 147456
ds_read_b128 a[200:203], v213 offset:0
ds_read_b128 a[204:207], v213 offset:2048
v_mfma_f32_16x16x32_bf16 v[12:15], a[132:135], a[192:195], v[12:15]
v_lshl_add_u32 v144, v3, 2, s46
v_lshl_add_u32 v5, v4, 4, s46
v_mfma_f32_16x16x32_bf16 v[44:47], a[132:135], a[196:199], v[44:47]
v_xor_b32 v6, 128, v5
v_xor_b32 v7, 256, v5
v_smfmac_f32_16x16x64_bf16 a[248:251], a[208:211], a[128:135], v235
ds_read_b64_tr_b16 a[128:129], v204 offset:16384
ds_read_b64_tr_b16 a[130:131], v204 offset:18432
v_mfma_f32_16x16x32_bf16 v[72:75], a[160:163], a[192:195], v[72:75]
buffer_load_dwordx4 v233, s[12:15], s39 offen offset:3072 lds
v_mfma_f32_16x16x32_bf16 v[104:107], a[160:163], a[196:199], v[104:107]
ds_read_b64_tr_b16 a[132:133], v205 offset:16384
ds_read_b64_tr_b16 a[134:135], v205 offset:18432
v_mfma_f32_16x16x32_bf16 v[76:79], a[164:167], a[192:195], v[76:79]
v_xor_b32 v254, 384, v5
v_mfma_f32_16x16x32_bf16 v[108:111], a[164:167], a[196:199], v[108:111]
s_add_u32 s39, s39, 16384
ds_read_b64 a[236:237], v152
ds_read_b64 a[238:239], v153
v_smfmac_f32_16x16x64_bf16 a[252:255], a[208:211], a[160:167], v235
ds_read_b64_tr_b16 a[160:161], v204 offset:16640
ds_read_b64_tr_b16 a[162:163], v204 offset:18688
v_mfma_f32_16x16x32_bf16 v[16:19], a[136:139], a[192:195], v[16:19]
ds_read_b64_tr_b16 a[164:165], v205 offset:16640
ds_read_b64_tr_b16 a[166:167], v205 offset:18688
v_mfma_f32_16x16x32_bf16 v[48:51], a[136:139], a[196:199], v[48:51]
ds_read_b64_tr_b16 a[136:137], v206 offset:16384
ds_read_b64_tr_b16 a[138:139], v206 offset:18432
v_mfma_f32_16x16x32_bf16 v[20:23], a[140:143], a[192:195], v[20:23]
ds_read_b64 a[240:241], v154
ds_read_b64 a[242:243], v155
v_mfma_f32_16x16x32_bf16 v[52:55], a[140:143], a[196:199], v[52:55]
ds_read_b64_tr_b16 a[140:141], v207 offset:16384
ds_read_b64_tr_b16 a[142:143], v207 offset:18432
v_mfma_f32_16x16x32_bf16 v[24:27], a[144:147], a[192:195], v[24:27]
v_readlane_b32 s92, v214, 0
v_readlane_b32 s93, v214, 32
v_mfma_f32_16x16x32_bf16 v[56:59], a[144:147], a[196:199], v[56:59]
ds_read_b64_tr_b16 a[144:145], v208 offset:16384
ds_read_b64_tr_b16 a[146:147], v208 offset:18432
v_mfma_f32_16x16x32_bf16 v[28:31], a[148:151], a[192:195], v[28:31]
v_mfma_f32_16x16x32_bf16 v[60:63], a[148:151], a[196:199], v[60:63]
ds_read_b64_tr_b16 a[148:149], v209 offset:16384
ds_read_b64_tr_b16 a[150:151], v209 offset:18432
v_mfma_f32_16x16x32_bf16 v[32:35], a[152:155], a[192:195], v[32:35]
v_mfma_f32_16x16x32_bf16 v[64:67], a[152:155], a[196:199], v[64:67]
ds_read_b64_tr_b16 a[152:153], v210 offset:16384
ds_read_b64_tr_b16 a[154:155], v210 offset:18432
v_mfma_f32_16x16x32_bf16 v[36:39], a[156:159], a[192:195], v[36:39]
v_mfma_f32_16x16x32_bf16 v[68:71], a[156:159], a[196:199], v[68:71]
ds_read_b64_tr_b16 a[156:157], v211 offset:16384
ds_read_b64_tr_b16 a[158:159], v211 offset:18432
v_mfma_f32_16x16x32_bf16 v[80:83], a[168:171], a[192:195], v[80:83]
v_mfma_f32_16x16x32_bf16 v[112:115], a[168:171], a[196:199], v[112:115]
s_waitcnt lgkmcnt(8)
ds_read_b64_tr_b16 a[168:169], v206 offset:16640
ds_read_b64_tr_b16 a[170:171], v206 offset:18688
v_mfma_f32_16x16x32_bf16 v[84:87], a[172:175], a[192:195], v[84:87]
v_mfma_f32_16x16x32_bf16 v[116:119], a[172:175], a[196:199], v[116:119]
ds_read_b64_tr_b16 a[172:173], v207 offset:16640
ds_read_b64_tr_b16 a[174:175], v207 offset:18688
v_mfma_f32_16x16x32_bf16 v[88:91], a[176:179], a[192:195], v[88:91]
v_mfma_f32_16x16x32_bf16 v[120:123], a[176:179], a[196:199], v[120:123]
ds_read_b64_tr_b16 a[176:177], v208 offset:16640
ds_read_b64_tr_b16 a[178:179], v208 offset:18688
v_mfma_f32_16x16x32_bf16 v[92:95], a[180:183], a[192:195], v[92:95]
v_mfma_f32_16x16x32_bf16 v[124:127], a[180:183], a[196:199], v[124:127]
ds_read_b64_tr_b16 a[180:181], v209 offset:16640
ds_read_b64_tr_b16 a[182:183], v209 offset:18688
v_mfma_f32_16x16x32_bf16 v[96:99], a[184:187], a[192:195], v[96:99]
v_mfma_f32_16x16x32_bf16 v[128:131], a[184:187], a[196:199], v[128:131]
ds_read_b64_tr_b16 a[184:185], v210 offset:16640
ds_read_b64_tr_b16 a[186:187], v210 offset:18688
v_mfma_f32_16x16x32_bf16 v[100:103], a[188:191], a[192:195], v[100:103]
v_mfma_f32_16x16x32_bf16 v[132:135], a[188:191], a[196:199], v[132:135]
ds_read_b64_tr_b16 a[188:189], v211 offset:16640
ds_read_b64_tr_b16 a[190:191], v211 offset:18688
v_mfma_f32_16x16x32_bf16 v[8:11], a[128:131], a[200:203], v[8:11]
v_mfma_f32_16x16x32_bf16 v[40:43], a[128:131], a[204:207], v[40:43]
v_mfma_f32_16x16x32_bf16 v[12:15], a[132:135], a[200:203], v[12:15]
v_mfma_f32_16x16x32_bf16 v[44:47], a[132:135], a[204:207], v[44:47]
v_smfmac_f32_16x16x64_bf16 a[248:251], a[208:211], a[128:135], v235
ds_read_b128 a[128:131], v216 offset:32768
ds_read_b128 a[132:135], v217 offset:32768
v_mfma_f32_16x16x32_bf16 v[72:75], a[160:163], a[200:203], v[72:75]
v_mfma_f32_16x16x32_bf16 v[104:107], a[160:163], a[204:207], v[104:107]
v_mfma_f32_16x16x32_bf16 v[76:79], a[164:167], a[200:203], v[76:79]
v_mfma_f32_16x16x32_bf16 v[108:111], a[164:167], a[204:207], v[108:111]
v_smfmac_f32_16x16x64_bf16 a[252:255], a[208:211], a[160:167], v235
v_mfma_f32_16x16x32_bf16 v[16:19], a[136:139], a[200:203], v[16:19]
v_accvgpr_read_b32 v136, a248
v_accvgpr_read_b32 v137, a249
v_mfma_f32_16x16x32_bf16 v[48:51], a[136:139], a[204:207], v[48:51]
v_accvgpr_read_b32 v138, a250
v_accvgpr_read_b32 v139, a251
v_mfma_f32_16x16x32_bf16 v[20:23], a[140:143], a[200:203], v[20:23]
ds_read_b128 a[136:139], v218 offset:32768
v_mfma_f32_16x16x32_bf16 v[52:55], a[140:143], a[204:207], v[52:55]
s_waitcnt lgkmcnt(3)
ds_read_b128 a[140:143], v219 offset:32768
v_mfma_f32_16x16x32_bf16 v[24:27], a[144:147], a[200:203], v[24:27]
v_mfma_f32_16x16x32_bf16 v[56:59], a[144:147], a[204:207], v[56:59]
v_accvgpr_read_b32 v140, a252
v_accvgpr_read_b32 v141, a253
v_mfma_f32_16x16x32_bf16 v[28:31], a[148:151], a[200:203], v[28:31]
v_accvgpr_read_b32 v142, a254
v_accvgpr_read_b32 v143, a255
v_mfma_f32_16x16x32_bf16 v[60:63], a[148:151], a[204:207], v[60:63]
v_add_f32 v136, v136, v137
v_add_f32 v138, v138, v139
v_mfma_f32_16x16x32_bf16 v[32:35], a[152:155], a[200:203], v[32:35]
v_add_f32 v140, v140, v141
v_add_f32 v142, v142, v143
v_mfma_f32_16x16x32_bf16 v[64:67], a[152:155], a[204:207], v[64:67]
ds_write_b32 v144, v136 offset:0
ds_write_b32 v144, v138 offset:64
v_mfma_f32_16x16x32_bf16 v[36:39], a[156:159], a[200:203], v[36:39]
ds_write_b32 v144, v140 offset:512
ds_write_b32 v144, v142 offset:576
v_mfma_f32_16x16x32_bf16 v[68:71], a[156:159], a[204:207], v[68:71]
s_waitcnt vmcnt(8)
s_nop 0
ds_read_b128 a[144:147], v216 offset:36864
ds_read_b128 a[148:151], v217 offset:36864
v_mfma_f32_16x16x32_bf16 v[80:83], a[168:171], a[200:203], v[80:83]
ds_read_b128 a[152:155], v218 offset:36864
ds_read_b128 a[156:159], v219 offset:36864
v_mfma_f32_16x16x32_bf16 v[112:115], a[168:171], a[204:207], v[112:115]
v_accvgpr_write_b32 a246, v148
v_accvgpr_write_b32 a247, v149
v_mfma_f32_16x16x32_bf16 v[84:87], a[172:175], a[200:203], v[84:87]
v_rcp_f32 v149, v149
v_mfma_f32_16x16x32_bf16 v[116:119], a[172:175], a[204:207], v[116:119]
s_waitcnt lgkmcnt(0)
s_barrier
v_mfma_f32_16x16x32_bf16 v[88:91], a[176:179], a[200:203], v[88:91]
ds_read_b128 v[184:187], v5 offset:0
ds_read_b128 v[188:191], v5 offset:64
v_mfma_f32_16x16x32_bf16 v[120:123], a[176:179], a[204:207], v[120:123]
ds_read_b128 v[192:195], v6 offset:0
ds_read_b128 v[196:199], v6 offset:64
v_mfma_f32_16x16x32_bf16 v[92:95], a[180:183], a[200:203], v[92:95]
ds_read_b128 v[200:203], v7 offset:0
ds_read_b128 v[204:207], v7 offset:64
v_mfma_f32_16x16x32_bf16 v[124:127], a[180:183], a[204:207], v[124:127]
ds_read_b128 v[208:211], v254 offset:0
ds_read_b128 v[212:215], v254 offset:64
v_mfma_f32_16x16x32_bf16 v[96:99], a[184:187], a[200:203], v[96:99]
v_rcp_f32 v151, v151
v_mfma_f32_16x16x32_bf16 v[128:131], a[184:187], a[204:207], v[128:131]
v_sub_f32 v148, 0, v148
v_sub_f32 v150, 0, v150
v_mfma_f32_16x16x32_bf16 v[100:103], a[188:191], a[200:203], v[100:103]
v_mul_f32 v149, 0x3e0293ee, v149
v_mul_f32 v151, 0x3e0293ee, v151
v_mfma_f32_16x16x32_bf16 v[132:135], a[188:191], a[204:207], v[132:135]
v_accvgpr_write_b32 a248, 0
v_accvgpr_write_b32 a249, 0
v_accvgpr_write_b32 a250, 0
v_accvgpr_write_b32 a251, 0
v_accvgpr_write_b32 a252, 0
v_accvgpr_write_b32 a253, 0
v_accvgpr_write_b32 a254, 0
v_accvgpr_write_b32 a255, 0
s_waitcnt lgkmcnt(0)
v_pk_fma_f32 v[8:9], v[184:185], v[148:149], v[8:9] op_sel:[0,0,0] op_sel_hi:[1,0,1]
v_pk_fma_f32 v[10:11], v[186:187], v[148:149], v[10:11] op_sel:[0,0,0] op_sel_hi:[1,0,1]
v_pk_mul_f32 v[8:9], v[8:9], v[148:149] op_sel:[0,1] op_sel_hi:[1,1]
v_pk_mul_f32 v[10:11], v[10:11], v[148:149] op_sel:[0,1] op_sel_hi:[1,1]
v_pk_fma_f32 v[12:13], v[188:189], v[148:149], v[12:13] op_sel:[0,0,0] op_sel_hi:[1,0,1]
v_pk_fma_f32 v[14:15], v[190:191], v[148:149], v[14:15] op_sel:[0,0,0] op_sel_hi:[1,0,1]
v_pk_mul_f32 v[12:13], v[12:13], v[148:149] op_sel:[0,1] op_sel_hi:[1,1]
v_pk_mul_f32 v[14:15], v[14:15], v[148:149] op_sel:[0,1] op_sel_hi:[1,1]
v_pk_fma_f32 v[16:17], v[192:193], v[148:149], v[16:17] op_sel:[0,0,0] op_sel_hi:[1,0,1]
v_pk_fma_f32 v[18:19], v[194:195], v[148:149], v[18:19] op_sel:[0,0,0] op_sel_hi:[1,0,1]
v_pk_mul_f32 v[16:17], v[16:17], v[148:149] op_sel:[0,1] op_sel_hi:[1,1]
v_pk_mul_f32 v[18:19], v[18:19], v[148:149] op_sel:[0,1] op_sel_hi:[1,1]
v_pk_fma_f32 v[20:21], v[196:197], v[148:149], v[20:21] op_sel:[0,0,0] op_sel_hi:[1,0,1]
v_pk_fma_f32 v[22:23], v[198:199], v[148:149], v[22:23] op_sel:[0,0,0] op_sel_hi:[1,0,1]
v_pk_mul_f32 v[20:21], v[20:21], v[148:149] op_sel:[0,1] op_sel_hi:[1,1]
v_pk_mul_f32 v[22:23], v[22:23], v[148:149] op_sel:[0,1] op_sel_hi:[1,1]
v_pk_fma_f32 v[24:25], v[200:201], v[148:149], v[24:25] op_sel:[0,0,0] op_sel_hi:[1,0,1]
v_pk_fma_f32 v[26:27], v[202:203], v[148:149], v[26:27] op_sel:[0,0,0] op_sel_hi:[1,0,1]
v_pk_mul_f32 v[24:25], v[24:25], v[148:149] op_sel:[0,1] op_sel_hi:[1,1]
v_pk_mul_f32 v[26:27], v[26:27], v[148:149] op_sel:[0,1] op_sel_hi:[1,1]
v_pk_fma_f32 v[28:29], v[204:205], v[148:149], v[28:29] op_sel:[0,0,0] op_sel_hi:[1,0,1]
v_pk_fma_f32 v[30:31], v[206:207], v[148:149], v[30:31] op_sel:[0,0,0] op_sel_hi:[1,0,1]
v_pk_mul_f32 v[28:29], v[28:29], v[148:149] op_sel:[0,1] op_sel_hi:[1,1]
v_pk_mul_f32 v[30:31], v[30:31], v[148:149] op_sel:[0,1] op_sel_hi:[1,1]
v_pk_fma_f32 v[32:33], v[208:209], v[148:149], v[32:33] op_sel:[0,0,0] op_sel_hi:[1,0,1]
v_pk_fma_f32 v[34:35], v[210:211], v[148:149], v[34:35] op_sel:[0,0,0] op_sel_hi:[1,0,1]
v_pk_mul_f32 v[32:33], v[32:33], v[148:149] op_sel:[0,1] op_sel_hi:[1,1]
v_pk_mul_f32 v[34:35], v[34:35], v[148:149] op_sel:[0,1] op_sel_hi:[1,1]
v_pk_fma_f32 v[36:37], v[212:213], v[148:149], v[36:37] op_sel:[0,0,0] op_sel_hi:[1,0,1]
v_pk_fma_f32 v[38:39], v[214:215], v[148:149], v[38:39] op_sel:[0,0,0] op_sel_hi:[1,0,1]
v_pk_mul_f32 v[36:37], v[36:37], v[148:149] op_sel:[0,1] op_sel_hi:[1,1]
v_pk_mul_f32 v[38:39], v[38:39], v[148:149] op_sel:[0,1] op_sel_hi:[1,1]
v_cvt_pk_bf16_f32 v152, v8, v9
v_cvt_pk_bf16_f32 v153, v10, v11
v_cvt_pk_bf16_f32 v154, v12, v13
v_cvt_pk_bf16_f32 v155, v14, v15
v_cvt_pk_bf16_f32 v156, v16, v17
v_cvt_pk_bf16_f32 v157, v18, v19
v_cvt_pk_bf16_f32 v158, v20, v21
v_cvt_pk_bf16_f32 v159, v22, v23
v_cvt_pk_bf16_f32 v160, v24, v25
v_cvt_pk_bf16_f32 v161, v26, v27
v_cvt_pk_bf16_f32 v162, v28, v29
v_cvt_pk_bf16_f32 v163, v30, v31
v_cvt_pk_bf16_f32 v164, v32, v33
v_cvt_pk_bf16_f32 v165, v34, v35
v_cvt_pk_bf16_f32 v166, v36, v37
v_cvt_pk_bf16_f32 v167, v38, v39
v_permlane16_swap_b32 v152, v154
v_permlane16_swap_b32 v153, v155
v_permlane16_swap_b32 v156, v158
v_permlane16_swap_b32 v157, v159
v_permlane16_swap_b32 v160, v162
v_permlane16_swap_b32 v161, v163
v_permlane16_swap_b32 v164, v166
v_permlane16_swap_b32 v165, v167
v_pk_fma_f32 v[40:41], v[184:185], v[150:151], v[40:41] op_sel:[0,0,0] op_sel_hi:[1,0,1]
v_pk_fma_f32 v[42:43], v[186:187], v[150:151], v[42:43] op_sel:[0,0,0] op_sel_hi:[1,0,1]
v_pk_mul_f32 v[40:41], v[40:41], v[150:151] op_sel:[0,1] op_sel_hi:[1,1]
v_pk_mul_f32 v[42:43], v[42:43], v[150:151] op_sel:[0,1] op_sel_hi:[1,1]
v_pk_fma_f32 v[44:45], v[188:189], v[150:151], v[44:45] op_sel:[0,0,0] op_sel_hi:[1,0,1]
v_pk_fma_f32 v[46:47], v[190:191], v[150:151], v[46:47] op_sel:[0,0,0] op_sel_hi:[1,0,1]
v_pk_mul_f32 v[44:45], v[44:45], v[150:151] op_sel:[0,1] op_sel_hi:[1,1]
v_pk_mul_f32 v[46:47], v[46:47], v[150:151] op_sel:[0,1] op_sel_hi:[1,1]
v_pk_fma_f32 v[48:49], v[192:193], v[150:151], v[48:49] op_sel:[0,0,0] op_sel_hi:[1,0,1]
v_pk_fma_f32 v[50:51], v[194:195], v[150:151], v[50:51] op_sel:[0,0,0] op_sel_hi:[1,0,1]
v_pk_mul_f32 v[48:49], v[48:49], v[150:151] op_sel:[0,1] op_sel_hi:[1,1]
v_pk_mul_f32 v[50:51], v[50:51], v[150:151] op_sel:[0,1] op_sel_hi:[1,1]
v_pk_fma_f32 v[52:53], v[196:197], v[150:151], v[52:53] op_sel:[0,0,0] op_sel_hi:[1,0,1]
v_pk_fma_f32 v[54:55], v[198:199], v[150:151], v[54:55] op_sel:[0,0,0] op_sel_hi:[1,0,1]
v_pk_mul_f32 v[52:53], v[52:53], v[150:151] op_sel:[0,1] op_sel_hi:[1,1]
v_pk_mul_f32 v[54:55], v[54:55], v[150:151] op_sel:[0,1] op_sel_hi:[1,1]
v_pk_fma_f32 v[56:57], v[200:201], v[150:151], v[56:57] op_sel:[0,0,0] op_sel_hi:[1,0,1]
v_pk_fma_f32 v[58:59], v[202:203], v[150:151], v[58:59] op_sel:[0,0,0] op_sel_hi:[1,0,1]
v_pk_mul_f32 v[56:57], v[56:57], v[150:151] op_sel:[0,1] op_sel_hi:[1,1]
v_pk_mul_f32 v[58:59], v[58:59], v[150:151] op_sel:[0,1] op_sel_hi:[1,1]
v_pk_fma_f32 v[60:61], v[204:205], v[150:151], v[60:61] op_sel:[0,0,0] op_sel_hi:[1,0,1]
v_pk_fma_f32 v[62:63], v[206:207], v[150:151], v[62:63] op_sel:[0,0,0] op_sel_hi:[1,0,1]
v_pk_mul_f32 v[60:61], v[60:61], v[150:151] op_sel:[0,1] op_sel_hi:[1,1]
v_pk_mul_f32 v[62:63], v[62:63], v[150:151] op_sel:[0,1] op_sel_hi:[1,1]
v_pk_fma_f32 v[64:65], v[208:209], v[150:151], v[64:65] op_sel:[0,0,0] op_sel_hi:[1,0,1]
v_pk_fma_f32 v[66:67], v[210:211], v[150:151], v[66:67] op_sel:[0,0,0] op_sel_hi:[1,0,1]
v_pk_mul_f32 v[64:65], v[64:65], v[150:151] op_sel:[0,1] op_sel_hi:[1,1]
v_pk_mul_f32 v[66:67], v[66:67], v[150:151] op_sel:[0,1] op_sel_hi:[1,1]
v_pk_fma_f32 v[68:69], v[212:213], v[150:151], v[68:69] op_sel:[0,0,0] op_sel_hi:[1,0,1]
v_pk_fma_f32 v[70:71], v[214:215], v[150:151], v[70:71] op_sel:[0,0,0] op_sel_hi:[1,0,1]
v_pk_mul_f32 v[68:69], v[68:69], v[150:151] op_sel:[0,1] op_sel_hi:[1,1]
v_pk_mul_f32 v[70:71], v[70:71], v[150:151] op_sel:[0,1] op_sel_hi:[1,1]
v_mfma_f32_16x16x32_bf16 v[8:11], a[128:131], v[152:155], 0
ds_read_b128 v[24:27], v5 offset:512
v_cvt_pk_bf16_f32 v168, v40, v41
v_mfma_f32_16x16x32_bf16 v[8:11], a[132:135], v[156:159], v[8:11]
ds_read_b128 v[28:31], v5 offset:576
v_cvt_pk_bf16_f32 v169, v42, v43
v_mfma_f32_16x16x32_bf16 v[8:11], a[136:139], v[160:163], v[8:11]
ds_read_b128 v[32:35], v6 offset:512
v_cvt_pk_bf16_f32 v170, v44, v45
v_mfma_f32_16x16x32_bf16 v[8:11], a[140:143], v[164:167], v[8:11]
ds_read_b128 v[36:39], v6 offset:576
v_cvt_pk_bf16_f32 v171, v46, v47
v_mfma_f32_16x16x32_bf16 v[12:15], a[144:147], v[152:155], 0
ds_read_b128 v[136:139], v7 offset:512
v_cvt_pk_bf16_f32 v172, v48, v49
v_mfma_f32_16x16x32_bf16 v[12:15], a[148:151], v[156:159], v[12:15]
ds_read_b128 v[140:143], v7 offset:576
v_cvt_pk_bf16_f32 v173, v50, v51
v_mfma_f32_16x16x32_bf16 v[12:15], a[152:155], v[160:163], v[12:15]
ds_read_b128 v[144:147], v254 offset:512
v_cvt_pk_bf16_f32 v174, v52, v53
v_mfma_f32_16x16x32_bf16 v[12:15], a[156:159], v[164:167], v[12:15]
ds_read_b128 v[244:247], v254 offset:576
v_cvt_pk_bf16_f32 v175, v54, v55
v_cvt_pk_bf16_f32 v176, v56, v57
v_cvt_pk_bf16_f32 v177, v58, v59
v_cvt_pk_bf16_f32 v178, v60, v61
v_cvt_pk_bf16_f32 v179, v62, v63
v_cvt_pk_bf16_f32 v180, v64, v65
v_cvt_pk_bf16_f32 v181, v66, v67
v_cvt_pk_bf16_f32 v182, v68, v69
v_cvt_pk_bf16_f32 v183, v70, v71
v_permlane16_swap_b32 v168, v170
v_permlane16_swap_b32 v169, v171
v_permlane16_swap_b32 v172, v174
v_permlane16_swap_b32 v173, v175
v_permlane16_swap_b32 v176, v178
v_permlane16_swap_b32 v177, v179
v_permlane16_swap_b32 v180, v182
v_permlane16_swap_b32 v181, v183
s_waitcnt lgkmcnt(0)
v_pk_fma_f32 v[72:73], v[24:25], v[148:149], v[72:73] op_sel:[0,0,0] op_sel_hi:[1,0,1]
v_pk_fma_f32 v[74:75], v[26:27], v[148:149], v[74:75] op_sel:[0,0,0] op_sel_hi:[1,0,1]
v_pk_mul_f32 v[72:73], v[72:73], v[148:149] op_sel:[0,1] op_sel_hi:[1,1]
v_pk_mul_f32 v[74:75], v[74:75], v[148:149] op_sel:[0,1] op_sel_hi:[1,1]
v_pk_fma_f32 v[76:77], v[28:29], v[148:149], v[76:77] op_sel:[0,0,0] op_sel_hi:[1,0,1]
v_pk_fma_f32 v[78:79], v[30:31], v[148:149], v[78:79] op_sel:[0,0,0] op_sel_hi:[1,0,1]
v_pk_mul_f32 v[76:77], v[76:77], v[148:149] op_sel:[0,1] op_sel_hi:[1,1]
v_pk_mul_f32 v[78:79], v[78:79], v[148:149] op_sel:[0,1] op_sel_hi:[1,1]
v_pk_fma_f32 v[80:81], v[32:33], v[148:149], v[80:81] op_sel:[0,0,0] op_sel_hi:[1,0,1]
v_pk_fma_f32 v[82:83], v[34:35], v[148:149], v[82:83] op_sel:[0,0,0] op_sel_hi:[1,0,1]
v_pk_mul_f32 v[80:81], v[80:81], v[148:149] op_sel:[0,1] op_sel_hi:[1,1]
v_pk_mul_f32 v[82:83], v[82:83], v[148:149] op_sel:[0,1] op_sel_hi:[1,1]
v_pk_fma_f32 v[84:85], v[36:37], v[148:149], v[84:85] op_sel:[0,0,0] op_sel_hi:[1,0,1]
v_pk_fma_f32 v[86:87], v[38:39], v[148:149], v[86:87] op_sel:[0,0,0] op_sel_hi:[1,0,1]
v_pk_mul_f32 v[84:85], v[84:85], v[148:149] op_sel:[0,1] op_sel_hi:[1,1]
v_pk_mul_f32 v[86:87], v[86:87], v[148:149] op_sel:[0,1] op_sel_hi:[1,1]
v_pk_fma_f32 v[88:89], v[136:137], v[148:149], v[88:89] op_sel:[0,0,0] op_sel_hi:[1,0,1]
v_pk_fma_f32 v[90:91], v[138:139], v[148:149], v[90:91] op_sel:[0,0,0] op_sel_hi:[1,0,1]
v_pk_mul_f32 v[88:89], v[88:89], v[148:149] op_sel:[0,1] op_sel_hi:[1,1]
v_pk_mul_f32 v[90:91], v[90:91], v[148:149] op_sel:[0,1] op_sel_hi:[1,1]
v_pk_fma_f32 v[92:93], v[140:141], v[148:149], v[92:93] op_sel:[0,0,0] op_sel_hi:[1,0,1]
v_pk_fma_f32 v[94:95], v[142:143], v[148:149], v[94:95] op_sel:[0,0,0] op_sel_hi:[1,0,1]
v_pk_mul_f32 v[92:93], v[92:93], v[148:149] op_sel:[0,1] op_sel_hi:[1,1]
v_pk_mul_f32 v[94:95], v[94:95], v[148:149] op_sel:[0,1] op_sel_hi:[1,1]
v_pk_fma_f32 v[96:97], v[144:145], v[148:149], v[96:97] op_sel:[0,0,0] op_sel_hi:[1,0,1]
v_pk_fma_f32 v[98:99], v[146:147], v[148:149], v[98:99] op_sel:[0,0,0] op_sel_hi:[1,0,1]
v_pk_mul_f32 v[96:97], v[96:97], v[148:149] op_sel:[0,1] op_sel_hi:[1,1]
v_pk_mul_f32 v[98:99], v[98:99], v[148:149] op_sel:[0,1] op_sel_hi:[1,1]
v_pk_fma_f32 v[100:101], v[244:245], v[148:149], v[100:101] op_sel:[0,0,0] op_sel_hi:[1,0,1]
v_pk_fma_f32 v[102:103], v[246:247], v[148:149], v[102:103] op_sel:[0,0,0] op_sel_hi:[1,0,1]
v_pk_mul_f32 v[100:101], v[100:101], v[148:149] op_sel:[0,1] op_sel_hi:[1,1]
v_pk_mul_f32 v[102:103], v[102:103], v[148:149] op_sel:[0,1] op_sel_hi:[1,1]
v_mfma_f32_16x16x32_bf16 v[16:19], a[128:131], v[168:171], 0
v_cvt_pk_bf16_f32 v184, v72, v73
v_cvt_pk_bf16_f32 v185, v74, v75
v_mfma_f32_16x16x32_bf16 v[16:19], a[132:135], v[172:175], v[16:19]
v_cvt_pk_bf16_f32 v186, v76, v77
v_cvt_pk_bf16_f32 v187, v78, v79
v_mfma_f32_16x16x32_bf16 v[16:19], a[136:139], v[176:179], v[16:19]
v_cvt_pk_bf16_f32 v188, v80, v81
v_cvt_pk_bf16_f32 v189, v82, v83
v_mfma_f32_16x16x32_bf16 v[16:19], a[140:143], v[180:183], v[16:19]
v_cvt_pk_bf16_f32 v190, v84, v85
v_cvt_pk_bf16_f32 v191, v86, v87
v_mfma_f32_16x16x32_bf16 v[20:23], a[144:147], v[168:171], 0
v_cvt_pk_bf16_f32 v192, v88, v89
v_cvt_pk_bf16_f32 v193, v90, v91
v_mfma_f32_16x16x32_bf16 v[20:23], a[148:151], v[172:175], v[20:23]
v_cvt_pk_bf16_f32 v194, v92, v93
v_cvt_pk_bf16_f32 v195, v94, v95
v_mfma_f32_16x16x32_bf16 v[20:23], a[152:155], v[176:179], v[20:23]
v_cvt_pk_bf16_f32 v196, v96, v97
v_cvt_pk_bf16_f32 v197, v98, v99
v_mfma_f32_16x16x32_bf16 v[20:23], a[156:159], v[180:183], v[20:23]
v_cvt_pk_bf16_f32 v198, v100, v101
v_cvt_pk_bf16_f32 v199, v102, v103
v_permlane16_swap_b32 v184, v186
v_permlane16_swap_b32 v185, v187
v_permlane16_swap_b32 v188, v190
v_permlane16_swap_b32 v189, v191
v_permlane16_swap_b32 v192, v194
v_permlane16_swap_b32 v193, v195
v_permlane16_swap_b32 v196, v198
v_permlane16_swap_b32 v197, v199
v_pk_fma_f32 v[104:105], v[24:25], v[150:151], v[104:105] op_sel:[0,0,0] op_sel_hi:[1,0,1]
v_pk_fma_f32 v[106:107], v[26:27], v[150:151], v[106:107] op_sel:[0,0,0] op_sel_hi:[1,0,1]
v_pk_mul_f32 v[104:105], v[104:105], v[150:151] op_sel:[0,1] op_sel_hi:[1,1]
v_pk_mul_f32 v[106:107], v[106:107], v[150:151] op_sel:[0,1] op_sel_hi:[1,1]
v_pk_fma_f32 v[108:109], v[28:29], v[150:151], v[108:109] op_sel:[0,0,0] op_sel_hi:[1,0,1]
v_pk_fma_f32 v[110:111], v[30:31], v[150:151], v[110:111] op_sel:[0,0,0] op_sel_hi:[1,0,1]
v_pk_mul_f32 v[108:109], v[108:109], v[150:151] op_sel:[0,1] op_sel_hi:[1,1]
v_pk_mul_f32 v[110:111], v[110:111], v[150:151] op_sel:[0,1] op_sel_hi:[1,1]
v_pk_fma_f32 v[112:113], v[32:33], v[150:151], v[112:113] op_sel:[0,0,0] op_sel_hi:[1,0,1]
v_pk_fma_f32 v[114:115], v[34:35], v[150:151], v[114:115] op_sel:[0,0,0] op_sel_hi:[1,0,1]
v_pk_mul_f32 v[112:113], v[112:113], v[150:151] op_sel:[0,1] op_sel_hi:[1,1]
v_pk_mul_f32 v[114:115], v[114:115], v[150:151] op_sel:[0,1] op_sel_hi:[1,1]
v_pk_fma_f32 v[116:117], v[36:37], v[150:151], v[116:117] op_sel:[0,0,0] op_sel_hi:[1,0,1]
v_pk_fma_f32 v[118:119], v[38:39], v[150:151], v[118:119] op_sel:[0,0,0] op_sel_hi:[1,0,1]
v_pk_mul_f32 v[116:117], v[116:117], v[150:151] op_sel:[0,1] op_sel_hi:[1,1]
v_pk_mul_f32 v[118:119], v[118:119], v[150:151] op_sel:[0,1] op_sel_hi:[1,1]
v_pk_fma_f32 v[120:121], v[136:137], v[150:151], v[120:121] op_sel:[0,0,0] op_sel_hi:[1,0,1]
v_pk_fma_f32 v[122:123], v[138:139], v[150:151], v[122:123] op_sel:[0,0,0] op_sel_hi:[1,0,1]
v_pk_mul_f32 v[120:121], v[120:121], v[150:151] op_sel:[0,1] op_sel_hi:[1,1]
v_pk_mul_f32 v[122:123], v[122:123], v[150:151] op_sel:[0,1] op_sel_hi:[1,1]
v_pk_fma_f32 v[124:125], v[140:141], v[150:151], v[124:125] op_sel:[0,0,0] op_sel_hi:[1,0,1]
v_pk_fma_f32 v[126:127], v[142:143], v[150:151], v[126:127] op_sel:[0,0,0] op_sel_hi:[1,0,1]
v_pk_mul_f32 v[124:125], v[124:125], v[150:151] op_sel:[0,1] op_sel_hi:[1,1]
v_pk_mul_f32 v[126:127], v[126:127], v[150:151] op_sel:[0,1] op_sel_hi:[1,1]
v_pk_fma_f32 v[128:129], v[144:145], v[150:151], v[128:129] op_sel:[0,0,0] op_sel_hi:[1,0,1]
v_pk_fma_f32 v[130:131], v[146:147], v[150:151], v[130:131] op_sel:[0,0,0] op_sel_hi:[1,0,1]
v_pk_mul_f32 v[128:129], v[128:129], v[150:151] op_sel:[0,1] op_sel_hi:[1,1]
v_pk_mul_f32 v[130:131], v[130:131], v[150:151] op_sel:[0,1] op_sel_hi:[1,1]
v_pk_fma_f32 v[132:133], v[244:245], v[150:151], v[132:133] op_sel:[0,0,0] op_sel_hi:[1,0,1]
v_pk_fma_f32 v[134:135], v[246:247], v[150:151], v[134:135] op_sel:[0,0,0] op_sel_hi:[1,0,1]
v_pk_mul_f32 v[132:133], v[132:133], v[150:151] op_sel:[0,1] op_sel_hi:[1,1]
v_pk_mul_f32 v[134:135], v[134:135], v[150:151] op_sel:[0,1] op_sel_hi:[1,1]
v_mfma_f32_16x16x32_bf16 v[24:27], a[128:131], v[184:187], 0
v_cvt_pk_bf16_f32 v200, v104, v105
v_cvt_pk_bf16_f32 v201, v106, v107
v_mfma_f32_16x16x32_bf16 v[24:27], a[132:135], v[188:191], v[24:27]
v_cvt_pk_bf16_f32 v202, v108, v109
v_cvt_pk_bf16_f32 v203, v110, v111
v_mfma_f32_16x16x32_bf16 v[24:27], a[136:139], v[192:195], v[24:27]
v_cvt_pk_bf16_f32 v204, v112, v113
v_cvt_pk_bf16_f32 v205, v114, v115
v_mfma_f32_16x16x32_bf16 v[24:27], a[140:143], v[196:199], v[24:27]
v_cvt_pk_bf16_f32 v206, v116, v117
v_cvt_pk_bf16_f32 v207, v118, v119
v_mfma_f32_16x16x32_bf16 v[28:31], a[144:147], v[184:187], 0
v_cvt_pk_bf16_f32 v208, v120, v121
v_cvt_pk_bf16_f32 v209, v122, v123
v_mfma_f32_16x16x32_bf16 v[28:31], a[148:151], v[188:191], v[28:31]
v_cvt_pk_bf16_f32 v210, v124, v125
v_cvt_pk_bf16_f32 v211, v126, v127
v_mfma_f32_16x16x32_bf16 v[28:31], a[152:155], v[192:195], v[28:31]
v_cvt_pk_bf16_f32 v212, v128, v129
v_cvt_pk_bf16_f32 v213, v130, v131
v_mfma_f32_16x16x32_bf16 v[28:31], a[156:159], v[196:199], v[28:31]
v_cvt_pk_bf16_f32 v214, v132, v133
v_cvt_pk_bf16_f32 v215, v134, v135
v_permlane16_swap_b32 v200, v202
v_permlane16_swap_b32 v201, v203
v_permlane16_swap_b32 v204, v206
v_permlane16_swap_b32 v205, v207
v_permlane16_swap_b32 v208, v210
v_permlane16_swap_b32 v209, v211
v_permlane16_swap_b32 v212, v214
v_permlane16_swap_b32 v213, v215
v_max3_f32 v136, v8, v9, v10
v_max3_f32 v136, v136, v11, v12
v_mfma_f32_16x16x32_bf16 v[32:35], a[128:131], v[200:203], 0
ds_read_b128 a[128:131], v216 offset:40960
v_max3_f32 v136, v136, v13, v14
v_mfma_f32_16x16x32_bf16 v[32:35], a[132:135], v[204:207], v[32:35]
ds_read_b128 a[132:135], v217 offset:40960
v_max_f32 v136, v136, v15
v_mfma_f32_16x16x32_bf16 v[32:35], a[136:139], v[208:211], v[32:35]
ds_read_b128 a[136:139], v218 offset:40960
v_mov_b32 v137, v136
v_mfma_f32_16x16x32_bf16 v[32:35], a[140:143], v[212:215], v[32:35]
ds_read_b128 a[140:143], v219 offset:40960
v_max3_f32 v140, v16, v17, v18
v_mfma_f32_16x16x32_bf16 v[36:39], a[144:147], v[200:203], 0
ds_read_b128 a[144:147], v216 offset:45056
v_max3_f32 v140, v140, v19, v20
v_mfma_f32_16x16x32_bf16 v[36:39], a[148:151], v[204:207], v[36:39]
ds_read_b128 a[148:151], v217 offset:45056
v_max3_f32 v140, v140, v21, v22
v_mfma_f32_16x16x32_bf16 v[36:39], a[152:155], v[208:211], v[36:39]
ds_read_b128 a[152:155], v218 offset:45056
v_max_f32 v140, v140, v23
v_mfma_f32_16x16x32_bf16 v[36:39], a[156:159], v[212:215], v[36:39]
ds_read_b128 a[156:159], v219 offset:45056
v_mov_b32 v141, v140
s_mov_b32 s48, 0x244000
buffer_load_dwordx4 v[104:107], v234, s[20:23], s48 offen offset:0 sc0 sc1
buffer_load_dwordx4 v[108:111], v234, s[20:23], s48 offen offset:1024 sc0 sc1
buffer_load_dwordx4 v[112:115], v234, s[20:23], s48 offen offset:2048 sc0 sc1
buffer_load_dwordx4 v[116:119], v234, s[20:23], s48 offen offset:3072 sc0 sc1
v_max3_f32 v144, v24, v25, v26
v_max3_f32 v144, v144, v27, v28
v_max3_f32 v144, v144, v29, v30
v_max_f32 v144, v144, v31
v_mov_b32 v145, v144
s_mov_b32 s48, 0x245000
buffer_load_dwordx4 v[120:123], v234, s[20:23], s48 offen offset:0 sc0 sc1
buffer_load_dwordx4 v[124:127], v234, s[20:23], s48 offen offset:1024 sc0 sc1
buffer_load_dwordx4 v[128:131], v234, s[20:23], s48 offen offset:2048 sc0 sc1
buffer_load_dwordx4 v[132:135], v234, s[20:23], s48 offen offset:3072 sc0 sc1
v_max3_f32 v148, v32, v33, v34
v_max3_f32 v148, v148, v35, v36
v_max3_f32 v148, v148, v37, v38
v_max_f32 v148, v148, v39
v_mov_b32 v149, v148
v_permlane16_swap_b32 v136, v137
v_permlane16_swap_b32 v140, v141
v_permlane16_swap_b32 v144, v145
v_permlane16_swap_b32 v148, v149
v_max_f32 v136, v136, v137
v_mov_b32 v137, v136
v_max_f32 v140, v140, v141
v_mov_b32 v141, v140
v_max_f32 v144, v144, v145
v_mov_b32 v145, v144
v_max_f32 v148, v148, v149
v_mov_b32 v149, v148
v_permlane32_swap_b32 v136, v137
v_permlane32_swap_b32 v140, v141
v_permlane32_swap_b32 v144, v145
v_permlane32_swap_b32 v148, v149
v_max_f32 v136, v136, v137
v_max_f32 v140, v140, v141
v_max_f32 v144, v144, v145
v_max_f32 v148, v148, v149
v_sub_f32 v139, -4.0, v136
v_sub_f32 v138, -4.0, v136
v_sub_f32 v137, -4.0, v136
v_sub_f32 v136, -4.0, v136
v_sub_f32 v143, -4.0, v140
v_sub_f32 v142, -4.0, v140
v_sub_f32 v141, -4.0, v140
v_sub_f32 v140, -4.0, v140
v_sub_f32 v147, -4.0, v144
v_sub_f32 v146, -4.0, v144
v_sub_f32 v145, -4.0, v144
v_sub_f32 v144, -4.0, v144
v_sub_f32 v151, -4.0, v148
v_sub_f32 v150, -4.0, v148
v_sub_f32 v149, -4.0, v148
v_sub_f32 v148, -4.0, v148
K_HAVEMAX:
v_pk_add_f32 v[8:9], v[8:9], v[136:137]
v_pk_add_f32 v[10:11], v[10:11], v[136:137]
v_pk_add_f32 v[12:13], v[12:13], v[136:137]
v_pk_add_f32 v[14:15], v[14:15], v[136:137]
v_pk_add_f32 v[16:17], v[16:17], v[140:141]
v_pk_add_f32 v[18:19], v[18:19], v[140:141]
v_pk_add_f32 v[20:21], v[20:21], v[140:141]
v_pk_add_f32 v[22:23], v[22:23], v[140:141]
v_pk_add_f32 v[24:25], v[24:25], v[144:145]
v_pk_add_f32 v[26:27], v[26:27], v[144:145]
v_pk_add_f32 v[28:29], v[28:29], v[144:145]
v_pk_add_f32 v[30:31], v[30:31], v[144:145]
v_pk_add_f32 v[32:33], v[32:33], v[148:149]
v_pk_add_f32 v[34:35], v[34:35], v[148:149]
v_pk_add_f32 v[36:37], v[36:37], v[148:149]
v_pk_add_f32 v[38:39], v[38:39], v[148:149]
v_mov_b32 v5, 0
s_lshl_b32 s46, s32, 2
s_add_u32 s46, s46, 163776
v_mov_b32 v6, s46
v_and_b32 v7, 12, v1
v_add_u32 v7, 163776, v7
ds_write_b32 v6, v5
s_waitcnt lgkmcnt(8)
v_mfma_f32_16x16x32_bf16 v[40:43], a[128:131], v[152:155], v[136:139]
s_waitcnt lgkmcnt(7)
v_exp_f32 v8, v8
v_exp_f32 v9, v9
v_mfma_f32_16x16x32_bf16 v[40:43], a[132:135], v[156:159], v[40:43]
s_waitcnt lgkmcnt(6)
v_cvt_pk_bf16_f32 v72, v8, v9
v_exp_f32 v10, v10
v_mfma_f32_16x16x32_bf16 v[40:43], a[136:139], v[160:163], v[40:43]
s_waitcnt lgkmcnt(5)
v_exp_f32 v11, v11
v_mfma_f32_16x16x32_bf16 v[40:43], a[140:143], v[164:167], v[40:43]
v_cvt_pk_bf16_f32 v73, v10, v11
v_exp_f32 v12, v12
v_mfma_f32_16x16x32_bf16 v[48:51], a[140:143], v[180:183], v[140:143]
v_exp_f32 v13, v13
v_mfma_f32_16x16x32_bf16 v[48:51], a[136:139], v[176:179], v[48:51]
v_cvt_pk_bf16_f32 v74, v12, v13
v_exp_f32 v14, v14
s_waitcnt vmcnt(8) lgkmcnt(0)
s_barrier
v_mfma_f32_16x16x32_bf16 v[48:51], a[132:135], v[172:175], v[48:51]
ds_read_b64_tr_b16 a[160:161], v220 offset:32768
ds_read_b64_tr_b16 a[162:163], v220 offset:36864
v_exp_f32 v15, v15
v_mfma_f32_16x16x32_bf16 v[48:51], a[128:131], v[168:171], v[48:51]
s_add_u32 m0, s37, 65536
v_exp_f32 v16, v16
v_exp_f32 v17, v17
v_mfma_f32_16x16x32_bf16 v[56:59], a[128:131], v[184:187], v[144:147]
buffer_load_dwordx4 v232, s[12:15], s39 offen offset:0 lds
v_exp_f32 v18, v18
v_mfma_f32_16x16x32_bf16 v[56:59], a[132:135], v[188:191], v[56:59]
ds_read_b64_tr_b16 a[164:165], v221 offset:32768
ds_read_b64_tr_b16 a[166:167], v221 offset:36864
v_exp_f32 v19, v19
v_mfma_f32_16x16x32_bf16 v[56:59], a[136:139], v[192:195], v[56:59]
buffer_load_dwordx4 v233, s[12:15], s39 offen offset:1024 lds
v_exp_f32 v20, v20
v_mfma_f32_16x16x32_bf16 v[56:59], a[140:143], v[196:199], v[56:59]
ds_read_b64_tr_b16 a[168:169], v222 offset:32768
ds_read_b64_tr_b16 a[170:171], v222 offset:36864
v_exp_f32 v21, v21
v_mfma_f32_16x16x32_bf16 v[64:67], a[140:143], v[212:215], v[148:151]
ds_read_b64_tr_b16 a[172:173], v223 offset:32768
ds_read_b64_tr_b16 a[174:175], v223 offset:36864
v_exp_f32 v22, v22
v_mfma_f32_16x16x32_bf16 v[64:67], a[136:139], v[208:211], v[64:67]
ds_read_b128 a[140:143], v219 offset:16384
ds_read_b64_tr_b16 a[176:177], v224 offset:32768
v_exp_f32 v23, v23
v_mfma_f32_16x16x32_bf16 v[64:67], a[132:135], v[204:207], v[64:67]
v_exp_f32 v24, v24
v_exp_f32 v25, v25
v_mfma_f32_16x16x32_bf16 v[64:67], a[128:131], v[200:203], v[64:67]
buffer_load_dwordx4 v232, s[12:15], s39 offen offset:2048 lds
v_exp_f32 v26, v26
v_mfma_f32_16x16x32_bf16 v[44:47], a[144:147], v[152:155], v[136:139]
ds_read_b64_tr_b16 a[178:179], v224 offset:36864
ds_read_b128 a[136:139], v218 offset:16384
v_exp_f32 v27, v27
v_mfma_f32_16x16x32_bf16 v[44:47], a[148:151], v[156:159], v[44:47]
ds_read_b128 a[132:135], v217 offset:16384
ds_read_b128 a[128:131], v216 offset:16384
v_exp_f32 v28, v28
v_mfma_f32_16x16x32_bf16 v[44:47], a[152:155], v[160:163], v[44:47]
buffer_load_dwordx4 v233, s[12:15], s39 offen offset:3072 lds
v_exp_f32 v29, v29
v_mfma_f32_16x16x32_bf16 v[44:47], a[156:159], v[164:167], v[44:47]
ds_read_b64_tr_b16 a[180:181], v225 offset:32768
ds_read_b64_tr_b16 a[182:183], v225 offset:36864
v_exp_f32 v30, v30
v_mfma_f32_16x16x32_bf16 v[52:55], a[156:159], v[180:183], v[140:143]
ds_read_b64_tr_b16 a[184:185], v226 offset:32768
ds_read_b64_tr_b16 a[186:187], v226 offset:36864
v_exp_f32 v31, v31
v_mfma_f32_16x16x32_bf16 v[52:55], a[152:155], v[176:179], v[52:55]
s_add_u32 s39, s39, 16384
v_exp_f32 v32, v32
v_exp_f32 v33, v33
v_mfma_f32_16x16x32_bf16 v[52:55], a[148:151], v[172:175], v[52:55]
s_add_u32 m0, s37, 49152
ds_read_b64_tr_b16 a[188:189], v227 offset:32768
ds_read_b64_tr_b16 a[190:191], v227 offset:36864
v_exp_f32 v34, v34
v_mfma_f32_16x16x32_bf16 v[52:55], a[144:147], v[168:171], v[52:55]
buffer_load_dwordx4 v228, s[8:11], s38 offen offset:0 lds
v_exp_f32 v35, v35
v_mfma_f32_16x16x32_bf16 v[60:63], a[144:147], v[184:187], v[144:147]
v_cvt_pk_bf16_f32 v75, v14, v15
v_cvt_pk_bf16_f32 v76, v16, v17
v_exp_f32 v36, v36
v_mfma_f32_16x16x32_bf16 v[60:63], a[148:151], v[188:191], v[60:63]
buffer_load_dwordx4 v229, s[8:11], s38 offen offset:1024 lds
v_exp_f32 v37, v37
v_mfma_f32_16x16x32_bf16 v[60:63], a[152:155], v[192:195], v[60:63]
v_cvt_pk_bf16_f32 v77, v18, v19
v_cvt_pk_bf16_f32 v78, v20, v21
v_exp_f32 v38, v38
v_mfma_f32_16x16x32_bf16 v[60:63], a[156:159], v[196:199], v[60:63]
v_cvt_pk_bf16_f32 v79, v22, v23
v_cvt_pk_bf16_f32 v80, v24, v25
v_exp_f32 v39, v39
v_mfma_f32_16x16x32_bf16 v[68:71], a[156:159], v[212:215], v[148:151]
ds_read_b128 a[156:159], v219 offset:20480
v_cvt_pk_bf16_f32 v81, v26, v27
v_cvt_pk_bf16_f32 v82, v28, v29
v_cvt_pk_bf16_f32 v83, v30, v31
v_mfma_f32_16x16x32_bf16 v[68:71], a[152:155], v[208:211], v[68:71]
ds_read_b128 a[152:155], v218 offset:20480
v_cvt_pk_bf16_f32 v84, v32, v33
v_cvt_pk_bf16_f32 v85, v34, v35
v_cvt_pk_bf16_f32 v86, v36, v37
v_mfma_f32_16x16x32_bf16 v[68:71], a[148:151], v[204:207], v[68:71]
ds_read_b128 a[148:151], v217 offset:20480
v_cvt_pk_bf16_f32 v87, v38, v39
v_mfma_f32_16x16x32_bf16 v[68:71], a[144:147], v[200:203], v[68:71]
ds_read_b128 a[144:147], v216 offset:20480
s_cmp_lg_u32 s41, 0
s_cbranch_scc1 K_RANKED
s_waitcnt vmcnt(6)
v_max3_u32 v255, v104, v105, v106
s_max_u32 s48, s92, s93
v_max3_u32 v255, v255, v107, v108
v_max3_u32 v255, v255, v109, v110
v_max3_u32 v255, v255, v111, v112
v_max3_u32 v255, v255, v113, v114
v_max3_u32 v255, v255, v115, v116
v_max3_u32 v255, v255, v117, v118
v_max3_u32 v255, v255, v119, v120
v_max3_u32 v255, v255, v121, v122
v_max3_u32 v255, v255, v123, v124
v_max3_u32 v255, v255, v125, v126
v_max3_u32 v255, v255, v127, v128
v_max3_u32 v255, v255, v129, v130
v_max3_u32 v255, v255, v131, v132
v_max3_u32 v255, v255, v133, v134
v_max_u32 v255, v255, v135
v_cmp_lt_u32 vcc, s48, v255
s_bcnt1_i32_b64 s48, vcc
s_cmp_lt_u32 s48, 8
s_cbranch_scc1 K_RANK
K_RANKED:
s_memrealtime s[94:95]
s_waitcnt lgkmcnt(0)
s_mov_b32 s40, 0
.p2align 6
K_LOOP:
v_mfma_f32_16x16x32_bf16 a[0:3], a[160:163], v[72:75], a[0:3]
v_exp_f32 v40, v40
v_mfma_f32_16x16x32_bf16 a[32:35], a[160:163], v[76:79], a[32:35]
v_exp_f32 v41, v41
v_mfma_f32_16x16x32_bf16 a[64:67], a[160:163], v[80:83], a[64:67]
buffer_load_dwordx4 v230, s[8:11], s38 offen offset:2048 lds
v_mfma_f32_16x16x32_bf16 a[96:99], a[160:163], v[84:87], a[96:99]
v_exp_f32 v42, v42
v_mfma_f32_16x16x32_bf16 a[100:103], a[164:167], v[84:87], a[100:103]
ds_read_b64_tr_b16 a[160:161], v220 offset:40960
ds_read_b64_tr_b16 a[162:163], v220 offset:45056
v_mfma_f32_16x16x32_bf16 a[68:71], a[164:167], v[80:83], a[68:71]
v_exp_f32 v43, v43
v_mfma_f32_16x16x32_bf16 a[36:39], a[164:167], v[76:79], a[36:39]
v_cvt_pk_bf16_f32 v88, v40, v41
v_cvt_pk_bf16_f32 v89, v42, v43
v_mfma_f32_16x16x32_bf16 a[4:7], a[164:167], v[72:75], a[4:7]
v_exp_f32 v44, v44
v_mfma_f32_16x16x32_bf16 a[8:11], a[168:171], v[72:75], a[8:11]
ds_read_b64_tr_b16 a[164:165], v221 offset:40960
ds_read_b64_tr_b16 a[166:167], v221 offset:45056
v_mfma_f32_16x16x32_bf16 a[40:43], a[168:171], v[76:79], a[40:43]
v_exp_f32 v45, v45
v_mfma_f32_16x16x32_bf16 a[72:75], a[168:171], v[80:83], a[72:75]
v_cvt_pk_bf16_f32 v90, v44, v45
v_mfma_f32_16x16x32_bf16 a[104:107], a[168:171], v[84:87], a[104:107]
v_exp_f32 v46, v46
v_mfma_f32_16x16x32_bf16 a[108:111], a[172:175], v[84:87], a[108:111]
ds_read_b64_tr_b16 a[168:169], v222 offset:40960
ds_read_b64_tr_b16 a[170:171], v222 offset:45056
v_mfma_f32_16x16x32_bf16 a[76:79], a[172:175], v[80:83], a[76:79]
v_exp_f32 v47, v47
v_mfma_f32_16x16x32_bf16 a[44:47], a[172:175], v[76:79], a[44:47]
buffer_load_dwordx4 v231, s[8:11], s38 offen offset:3072 lds
v_mfma_f32_16x16x32_bf16 a[12:15], a[172:175], v[72:75], a[12:15]
v_exp_f32 v48, v48
v_smfmac_f32_16x16x64_bf16 a[248:251], a[208:211], v[72:79], v235
ds_read_b64_tr_b16 a[172:173], v223 offset:40960
ds_read_b64_tr_b16 a[174:175], v223 offset:45056
v_mfma_f32_16x16x32_bf16 v[8:11], a[128:131], v[152:155], v[136:139]
v_exp_f32 v49, v49
v_mfma_f32_16x16x32_bf16 v[8:11], a[132:135], v[156:159], v[8:11]
v_cvt_pk_bf16_f32 v91, v46, v47
v_cvt_pk_bf16_f32 v92, v48, v49
v_mfma_f32_16x16x32_bf16 v[8:11], a[136:139], v[160:163], v[8:11]
v_exp_f32 v50, v50
v_mfma_f32_16x16x32_bf16 v[8:11], a[140:143], v[164:167], v[8:11]
v_mfma_f32_16x16x32_bf16 v[16:19], a[140:143], v[180:183], v[140:143]
v_exp_f32 v51, v51
v_mfma_f32_16x16x32_bf16 v[16:19], a[136:139], v[176:179], v[16:19]
v_cvt_pk_bf16_f32 v93, v50, v51
v_mfma_f32_16x16x32_bf16 v[16:19], a[132:135], v[172:175], v[16:19]
v_exp_f32 v52, v52
v_mfma_f32_16x16x32_bf16 v[16:19], a[128:131], v[168:171], v[16:19]
v_mfma_f32_16x16x32_bf16 v[24:27], a[128:131], v[184:187], v[144:147]
s_add_u32 s38, s38, 16384
v_exp_f32 v53, v53
v_mfma_f32_16x16x32_bf16 v[24:27], a[132:135], v[188:191], v[24:27]
s_add_u32 m0, s37, 81920
v_cvt_pk_bf16_f32 v94, v52, v53
v_mfma_f32_16x16x32_bf16 v[24:27], a[136:139], v[192:195], v[24:27]
v_exp_f32 v54, v54
v_mfma_f32_16x16x32_bf16 v[24:27], a[140:143], v[196:199], v[24:27]
buffer_load_dwordx4 v232, s[12:15], s39 offen offset:0 lds
v_mfma_f32_16x16x32_bf16 v[32:35], a[140:143], v[212:215], v[148:151]
v_exp_f32 v55, v55
v_mfma_f32_16x16x32_bf16 v[32:35], a[136:139], v[208:211], v[32:35]
ds_read_b128 a[140:143], v219 offset:24576
ds_read_b128 a[136:139], v218 offset:24576
v_mfma_f32_16x16x32_bf16 v[32:35], a[132:135], v[204:207], v[32:35]
v_exp_f32 v56, v56
v_mfma_f32_16x16x32_bf16 v[32:35], a[128:131], v[200:203], v[32:35]
v_exp_f32 v57, v57
v_mfma_f32_16x16x32_bf16 a[16:19], a[176:179], v[72:75], a[16:19]
ds_read_b128 a[132:135], v217 offset:24576
ds_read_b128 a[128:131], v216 offset:24576
v_mfma_f32_16x16x32_bf16 a[48:51], a[176:179], v[76:79], a[48:51]
v_exp_f32 v58, v58
v_mfma_f32_16x16x32_bf16 a[80:83], a[176:179], v[80:83], a[80:83]
v_cvt_pk_bf16_f32 v95, v54, v55
v_cvt_pk_bf16_f32 v96, v56, v57
v_mfma_f32_16x16x32_bf16 a[112:115], a[176:179], v[84:87], a[112:115]
v_exp_f32 v59, v59
v_mfma_f32_16x16x32_bf16 a[116:119], a[180:183], v[84:87], a[116:119]
ds_read_b64_tr_b16 a[176:177], v224 offset:40960
ds_read_b64_tr_b16 a[178:179], v224 offset:45056
v_mfma_f32_16x16x32_bf16 a[84:87], a[180:183], v[80:83], a[84:87]
v_exp_f32 v60, v60
v_mfma_f32_16x16x32_bf16 a[52:55], a[180:183], v[76:79], a[52:55]
buffer_load_dwordx4 v233, s[12:15], s39 offen offset:1024 lds
v_mfma_f32_16x16x32_bf16 a[20:23], a[180:183], v[72:75], a[20:23]
v_exp_f32 v61, v61
v_mfma_f32_16x16x32_bf16 a[24:27], a[184:187], v[72:75], a[24:27]
ds_read_b64_tr_b16 a[180:181], v225 offset:40960
ds_read_b64_tr_b16 a[182:183], v225 offset:45056
v_mfma_f32_16x16x32_bf16 a[56:59], a[184:187], v[76:79], a[56:59]
v_exp_f32 v62, v62
v_mfma_f32_16x16x32_bf16 a[88:91], a[184:187], v[80:83], a[88:91]
v_cvt_pk_bf16_f32 v97, v58, v59
v_cvt_pk_bf16_f32 v98, v60, v61
v_mfma_f32_16x16x32_bf16 a[120:123], a[184:187], v[84:87], a[120:123]
v_exp_f32 v63, v63
v_mfma_f32_16x16x32_bf16 a[124:127], a[188:191], v[84:87], a[124:127]
ds_read_b64_tr_b16 a[184:185], v226 offset:40960
ds_read_b64_tr_b16 a[186:187], v226 offset:45056
v_mfma_f32_16x16x32_bf16 a[92:95], a[188:191], v[80:83], a[92:95]
v_exp_f32 v64, v64
v_mfma_f32_16x16x32_bf16 a[60:63], a[188:191], v[76:79], a[60:63]
v_cvt_pk_bf16_f32 v99, v62, v63
v_mfma_f32_16x16x32_bf16 a[28:31], a[188:191], v[72:75], a[28:31]
v_exp_f32 v65, v65
v_smfmac_f32_16x16x64_bf16 a[252:255], a[208:211], v[80:87], v235
s_waitcnt lgkmcnt(4)
ds_read_b64_tr_b16 a[188:189], v227 offset:40960
ds_read_b64_tr_b16 a[190:191], v227 offset:45056
v_mfma_f32_16x16x32_bf16 v[12:15], a[144:147], v[152:155], v[136:139]
v_exp_f32 v66, v66
v_mfma_f32_16x16x32_bf16 v[12:15], a[148:151], v[156:159], v[12:15]
buffer_load_dwordx4 v232, s[12:15], s39 offen offset:2048 lds
v_mfma_f32_16x16x32_bf16 v[12:15], a[152:155], v[160:163], v[12:15]
v_exp_f32 v67, v67
v_mfma_f32_16x16x32_bf16 v[12:15], a[156:159], v[164:167], v[12:15]
v_cvt_pk_bf16_f32 v100, v64, v65
v_cvt_pk_bf16_f32 v101, v66, v67
v_mfma_f32_16x16x32_bf16 v[20:23], a[156:159], v[180:183], v[140:143]
v_exp_f32 v68, v68
v_mfma_f32_16x16x32_bf16 v[20:23], a[152:155], v[176:179], v[20:23]
v_mfma_f32_16x16x32_bf16 v[20:23], a[148:151], v[172:175], v[20:23]
v_exp_f32 v69, v69
v_mfma_f32_16x16x32_bf16 v[20:23], a[144:147], v[168:171], v[20:23]
v_cvt_pk_bf16_f32 v102, v68, v69
v_mfma_f32_16x16x32_bf16 v[28:31], a[144:147], v[184:187], v[144:147]
v_exp_f32 v70, v70
v_mfma_f32_16x16x32_bf16 v[28:31], a[148:151], v[188:191], v[28:31]
v_mfma_f32_16x16x32_bf16 v[28:31], a[152:155], v[192:195], v[28:31]
v_exp_f32 v71, v71
v_mfma_f32_16x16x32_bf16 v[28:31], a[156:159], v[196:199], v[28:31]
v_cvt_pk_bf16_f32 v103, v70, v71
v_mfma_f32_16x16x32_bf16 v[36:39], a[156:159], v[212:215], v[148:151]
ds_read_b128 a[156:159], v219 offset:28672
v_mfma_f32_16x16x32_bf16 v[36:39], a[152:155], v[208:211], v[36:39]
ds_read_b128 a[152:155], v218 offset:28672
v_mfma_f32_16x16x32_bf16 v[36:39], a[148:151], v[204:207], v[36:39]
ds_read_b128 a[148:151], v217 offset:28672
v_mfma_f32_16x16x32_bf16 v[36:39], a[144:147], v[200:203], v[36:39]
ds_read_b128 a[144:147], v216 offset:28672
v_mfma_f32_16x16x32_bf16 a[0:3], a[160:163], v[88:91], a[0:3]
v_exp_f32 v8, v8
v_mfma_f32_16x16x32_bf16 a[32:35], a[160:163], v[92:95], a[32:35]
v_exp_f32 v9, v9
v_mfma_f32_16x16x32_bf16 a[64:67], a[160:163], v[96:99], a[64:67]
buffer_load_dwordx4 v233, s[12:15], s39 offen offset:3072 lds
v_mfma_f32_16x16x32_bf16 a[96:99], a[160:163], v[100:103], a[96:99]
v_exp_f32 v10, v10
v_mfma_f32_16x16x32_bf16 a[100:103], a[164:167], v[100:103], a[100:103]
ds_read_b64_tr_b16 a[160:161], v220 offset:49152
ds_read_b64_tr_b16 a[162:163], v220 offset:53248
v_mfma_f32_16x16x32_bf16 a[68:71], a[164:167], v[96:99], a[68:71]
v_exp_f32 v11, v11
v_mfma_f32_16x16x32_bf16 a[36:39], a[164:167], v[92:95], a[36:39]
v_cvt_pk_bf16_f32 v72, v8, v9
v_cvt_pk_bf16_f32 v73, v10, v11
v_mfma_f32_16x16x32_bf16 a[4:7], a[164:167], v[88:91], a[4:7]
v_exp_f32 v12, v12
v_mfma_f32_16x16x32_bf16 a[8:11], a[168:171], v[88:91], a[8:11]
ds_read_b64_tr_b16 a[164:165], v221 offset:49152
ds_read_b64_tr_b16 a[166:167], v221 offset:53248
v_mfma_f32_16x16x32_bf16 a[40:43], a[168:171], v[92:95], a[40:43]
v_exp_f32 v13, v13
v_mfma_f32_16x16x32_bf16 a[72:75], a[168:171], v[96:99], a[72:75]
v_cvt_pk_bf16_f32 v74, v12, v13
v_mfma_f32_16x16x32_bf16 a[104:107], a[168:171], v[100:103], a[104:107]
v_exp_f32 v14, v14
v_mfma_f32_16x16x32_bf16 a[108:111], a[172:175], v[100:103], a[108:111]
ds_read_b64_tr_b16 a[168:169], v222 offset:49152
ds_read_b64_tr_b16 a[170:171], v222 offset:53248
v_mfma_f32_16x16x32_bf16 a[76:79], a[172:175], v[96:99], a[76:79]
s_add_u32 s39, s39, 16384
v_exp_f32 v15, v15
v_mfma_f32_16x16x32_bf16 a[44:47], a[172:175], v[92:95], a[44:47]
s_add_u32 m0, s37, 32768
v_cvt_pk_bf16_f32 v75, v14, v15
v_mfma_f32_16x16x32_bf16 a[12:15], a[172:175], v[88:91], a[12:15]
v_exp_f32 v16, v16
v_smfmac_f32_16x16x64_bf16 a[248:251], a[208:211], v[88:95], v235
buffer_load_dwordx4 v228, s[8:11], s38 offen offset:0 lds
v_mfma_f32_16x16x32_bf16 v[40:43], a[128:131], v[152:155], v[136:139]
v_exp_f32 v17, v17
v_mfma_f32_16x16x32_bf16 v[40:43], a[132:135], v[156:159], v[40:43]
ds_read_b64_tr_b16 a[172:173], v223 offset:49152
ds_read_b64_tr_b16 a[174:175], v223 offset:53248
v_mfma_f32_16x16x32_bf16 v[40:43], a[136:139], v[160:163], v[40:43]
v_exp_f32 v18, v18
v_mfma_f32_16x16x32_bf16 v[40:43], a[140:143], v[164:167], v[40:43]
v_cvt_pk_bf16_f32 v76, v16, v17
v_mfma_f32_16x16x32_bf16 v[48:51], a[140:143], v[180:183], v[140:143]
v_exp_f32 v19, v19
v_mfma_f32_16x16x32_bf16 v[48:51], a[136:139], v[176:179], v[48:51]
v_cvt_pk_bf16_f32 v77, v18, v19
v_mfma_f32_16x16x32_bf16 v[48:51], a[132:135], v[172:175], v[48:51]
v_exp_f32 v20, v20
v_mfma_f32_16x16x32_bf16 v[48:51], a[128:131], v[168:171], v[48:51]
v_mfma_f32_16x16x32_bf16 v[56:59], a[128:131], v[184:187], v[144:147]
v_exp_f32 v21, v21
v_mfma_f32_16x16x32_bf16 v[56:59], a[132:135], v[188:191], v[56:59]
buffer_load_dwordx4 v229, s[8:11], s38 offen offset:1024 lds
v_mfma_f32_16x16x32_bf16 v[56:59], a[136:139], v[192:195], v[56:59]
v_exp_f32 v22, v22
v_mfma_f32_16x16x32_bf16 v[56:59], a[140:143], v[196:199], v[56:59]
v_cvt_pk_bf16_f32 v78, v20, v21
v_mfma_f32_16x16x32_bf16 v[64:67], a[140:143], v[212:215], v[148:151]
v_exp_f32 v23, v23
v_mfma_f32_16x16x32_bf16 v[64:67], a[136:139], v[208:211], v[64:67]
ds_read_b128 a[140:143], v219 offset:0
ds_read_b128 a[136:139], v218 offset:0
v_mfma_f32_16x16x32_bf16 v[64:67], a[132:135], v[204:207], v[64:67]
v_exp_f32 v24, v24
v_mfma_f32_16x16x32_bf16 v[64:67], a[128:131], v[200:203], v[64:67]
v_exp_f32 v25, v25
v_mfma_f32_16x16x32_bf16 a[16:19], a[176:179], v[88:91], a[16:19]
ds_read_b128 a[132:135], v217 offset:0
ds_read_b128 a[128:131], v216 offset:0
v_mfma_f32_16x16x32_bf16 a[48:51], a[176:179], v[92:95], a[48:51]
v_exp_f32 v26, v26
v_mfma_f32_16x16x32_bf16 a[80:83], a[176:179], v[96:99], a[80:83]
v_cvt_pk_bf16_f32 v79, v22, v23
v_cvt_pk_bf16_f32 v80, v24, v25
v_mfma_f32_16x16x32_bf16 a[112:115], a[176:179], v[100:103], a[112:115]
s_waitcnt lgkmcnt(4)
v_exp_f32 v27, v27
v_mfma_f32_16x16x32_bf16 a[116:119], a[180:183], v[100:103], a[116:119]
ds_read_b64_tr_b16 a[176:177], v224 offset:49152
ds_read_b64_tr_b16 a[178:179], v224 offset:53248
v_mfma_f32_16x16x32_bf16 a[84:87], a[180:183], v[96:99], a[84:87]
v_exp_f32 v28, v28
v_mfma_f32_16x16x32_bf16 a[52:55], a[180:183], v[92:95], a[52:55]
buffer_load_dwordx4 v230, s[8:11], s38 offen offset:2048 lds
v_mfma_f32_16x16x32_bf16 a[20:23], a[180:183], v[88:91], a[20:23]
v_exp_f32 v29, v29
v_mfma_f32_16x16x32_bf16 a[24:27], a[184:187], v[88:91], a[24:27]
ds_read_b64_tr_b16 a[180:181], v225 offset:49152
ds_read_b64_tr_b16 a[182:183], v225 offset:53248
v_mfma_f32_16x16x32_bf16 a[56:59], a[184:187], v[92:95], a[56:59]
v_exp_f32 v30, v30
v_mfma_f32_16x16x32_bf16 a[88:91], a[184:187], v[96:99], a[88:91]
v_cvt_pk_bf16_f32 v81, v26, v27
v_cvt_pk_bf16_f32 v82, v28, v29
v_mfma_f32_16x16x32_bf16 a[120:123], a[184:187], v[100:103], a[120:123]
v_exp_f32 v31, v31
v_mfma_f32_16x16x32_bf16 a[124:127], a[188:191], v[100:103], a[124:127]
ds_read_b64_tr_b16 a[184:185], v226 offset:49152
ds_read_b64_tr_b16 a[186:187], v226 offset:53248
v_mfma_f32_16x16x32_bf16 a[92:95], a[188:191], v[96:99], a[92:95]
v_exp_f32 v32, v32
v_mfma_f32_16x16x32_bf16 a[60:63], a[188:191], v[92:95], a[60:63]
v_cvt_pk_bf16_f32 v83, v30, v31
v_mfma_f32_16x16x32_bf16 a[28:31], a[188:191], v[88:91], a[28:31]
v_exp_f32 v33, v33
v_smfmac_f32_16x16x64_bf16 a[252:255], a[208:211], v[96:103], v235
ds_read_b64_tr_b16 a[188:189], v227 offset:49152
ds_read_b64_tr_b16 a[190:191], v227 offset:53248
v_mfma_f32_16x16x32_bf16 v[44:47], a[144:147], v[152:155], v[136:139]
v_exp_f32 v34, v34
v_mfma_f32_16x16x32_bf16 v[44:47], a[148:151], v[156:159], v[44:47]
buffer_load_dwordx4 v231, s[8:11], s38 offen offset:3072 lds
v_mfma_f32_16x16x32_bf16 v[44:47], a[152:155], v[160:163], v[44:47]
v_exp_f32 v35, v35
v_mfma_f32_16x16x32_bf16 v[44:47], a[156:159], v[164:167], v[44:47]
v_cvt_pk_bf16_f32 v84, v32, v33
v_cvt_pk_bf16_f32 v85, v34, v35
v_mfma_f32_16x16x32_bf16 v[52:55], a[156:159], v[180:183], v[140:143]
v_exp_f32 v36, v36
v_mfma_f32_16x16x32_bf16 v[52:55], a[152:155], v[176:179], v[52:55]
v_mfma_f32_16x16x32_bf16 v[52:55], a[148:151], v[172:175], v[52:55]
v_exp_f32 v37, v37
v_mfma_f32_16x16x32_bf16 v[52:55], a[144:147], v[168:171], v[52:55]
v_cvt_pk_bf16_f32 v86, v36, v37
v_mfma_f32_16x16x32_bf16 v[60:63], a[144:147], v[184:187], v[144:147]
v_exp_f32 v38, v38
v_mfma_f32_16x16x32_bf16 v[60:63], a[148:151], v[188:191], v[60:63]
v_mfma_f32_16x16x32_bf16 v[60:63], a[152:155], v[192:195], v[60:63]
v_exp_f32 v39, v39
v_mfma_f32_16x16x32_bf16 v[60:63], a[156:159], v[196:199], v[60:63]
v_cvt_pk_bf16_f32 v87, v38, v39
v_mfma_f32_16x16x32_bf16 v[68:71], a[156:159], v[212:215], v[148:151]
ds_read_b128 a[156:159], v219 offset:4096
v_mfma_f32_16x16x32_bf16 v[68:71], a[152:155], v[208:211], v[68:71]
s_add_u32 s38, s38, 16384
ds_read_b128 a[152:155], v218 offset:4096
v_mfma_f32_16x16x32_bf16 v[68:71], a[148:151], v[204:207], v[68:71]
ds_read_b128 a[148:151], v217 offset:4096
v_mfma_f32_16x16x32_bf16 v[68:71], a[144:147], v[200:203], v[68:71]
ds_read_b128 a[144:147], v216 offset:4096
v_mfma_f32_16x16x32_bf16 a[0:3], a[160:163], v[72:75], a[0:3]
v_exp_f32 v40, v40
v_mfma_f32_16x16x32_bf16 a[32:35], a[160:163], v[76:79], a[32:35]
v_exp_f32 v41, v41
v_mfma_f32_16x16x32_bf16 a[64:67], a[160:163], v[80:83], a[64:67]
buffer_load_dwordx2 v[252:253], v251, s[76:79], s42 offen sc1
v_mfma_f32_16x16x32_bf16 a[96:99], a[160:163], v[84:87], a[96:99]
v_exp_f32 v42, v42
v_mfma_f32_16x16x32_bf16 a[100:103], a[164:167], v[84:87], a[100:103]
ds_read_b64_tr_b16 a[160:161], v220 offset:57344
ds_read_b64_tr_b16 a[162:163], v220 offset:61440
v_mfma_f32_16x16x32_bf16 a[68:71], a[164:167], v[80:83], a[68:71]
v_exp_f32 v43, v43
v_mfma_f32_16x16x32_bf16 a[36:39], a[164:167], v[76:79], a[36:39]
v_cvt_pk_bf16_f32 v88, v40, v41
v_cvt_pk_bf16_f32 v89, v42, v43
v_mfma_f32_16x16x32_bf16 a[4:7], a[164:167], v[72:75], a[4:7]
v_exp_f32 v44, v44
v_mfma_f32_16x16x32_bf16 a[8:11], a[168:171], v[72:75], a[8:11]
ds_read_b64_tr_b16 a[164:165], v221 offset:57344
ds_read_b64_tr_b16 a[166:167], v221 offset:61440
v_mfma_f32_16x16x32_bf16 a[40:43], a[168:171], v[76:79], a[40:43]
v_exp_f32 v45, v45
v_mfma_f32_16x16x32_bf16 a[72:75], a[168:171], v[80:83], a[72:75]
s_add_u32 s42, s42, s43
buffer_load_dword v255, v243, s[28:31], s45 offen
v_mfma_f32_16x16x32_bf16 a[104:107], a[168:171], v[84:87], a[104:107]
v_exp_f32 v46, v46
v_mfma_f32_16x16x32_bf16 a[108:111], a[172:175], v[84:87], a[108:111]
ds_read_b64_tr_b16 a[168:169], v222 offset:57344
ds_read_b64_tr_b16 a[170:171], v222 offset:61440
v_mfma_f32_16x16x32_bf16 a[76:79], a[172:175], v[80:83], a[76:79]
v_exp_f32 v47, v47
v_mfma_f32_16x16x32_bf16 a[44:47], a[172:175], v[76:79], a[44:47]
v_cvt_pk_bf16_f32 v90, v44, v45
v_cvt_pk_bf16_f32 v91, v46, v47
v_mfma_f32_16x16x32_bf16 a[12:15], a[172:175], v[72:75], a[12:15]
v_exp_f32 v48, v48
v_smfmac_f32_16x16x64_bf16 a[248:251], a[208:211], v[72:79], v235
s_waitcnt lgkmcnt(4)
ds_read_b64_tr_b16 a[172:173], v223 offset:57344
ds_read_b64_tr_b16 a[174:175], v223 offset:61440
v_mfma_f32_16x16x32_bf16 v[8:11], a[128:131], v[152:155], v[136:139]
v_exp_f32 v49, v49
v_mfma_f32_16x16x32_bf16 v[8:11], a[132:135], v[156:159], v[8:11]
v_cvt_pk_bf16_f32 v92, v48, v49
v_mfma_f32_16x16x32_bf16 v[8:11], a[136:139], v[160:163], v[8:11]
s_add_u32 s45, s45, 589824
v_exp_f32 v50, v50
v_mfma_f32_16x16x32_bf16 v[8:11], a[140:143], v[164:167], v[8:11]
global_load_dword v255, v242, s[72:73]
v_mfma_f32_16x16x32_bf16 v[16:19], a[140:143], v[180:183], v[140:143]
v_exp_f32 v51, v51
v_mfma_f32_16x16x32_bf16 v[16:19], a[136:139], v[176:179], v[16:19]
v_cvt_pk_bf16_f32 v93, v50, v51
v_mfma_f32_16x16x32_bf16 v[16:19], a[132:135], v[172:175], v[16:19]
v_exp_f32 v52, v52
v_mfma_f32_16x16x32_bf16 v[16:19], a[128:131], v[168:171], v[16:19]
v_mfma_f32_16x16x32_bf16 v[24:27], a[128:131], v[184:187], v[144:147]
v_exp_f32 v53, v53
v_mfma_f32_16x16x32_bf16 v[24:27], a[132:135], v[188:191], v[24:27]
v_cvt_pk_bf16_f32 v94, v52, v53
v_mfma_f32_16x16x32_bf16 v[24:27], a[136:139], v[192:195], v[24:27]
v_exp_f32 v54, v54
v_mfma_f32_16x16x32_bf16 v[24:27], a[140:143], v[196:199], v[24:27]
buffer_load_dword v255, v0, s[24:27], s44 offen
v_mfma_f32_16x16x32_bf16 v[32:35], a[140:143], v[212:215], v[148:151]
v_exp_f32 v55, v55
v_mfma_f32_16x16x32_bf16 v[32:35], a[136:139], v[208:211], v[32:35]
ds_read_b128 a[140:143], v219 offset:8192
ds_read_b128 a[136:139], v218 offset:8192
v_mfma_f32_16x16x32_bf16 v[32:35], a[132:135], v[204:207], v[32:35]
v_exp_f32 v56, v56
v_mfma_f32_16x16x32_bf16 v[32:35], a[128:131], v[200:203], v[32:35]
v_exp_f32 v57, v57
v_mfma_f32_16x16x32_bf16 a[16:19], a[176:179], v[72:75], a[16:19]
ds_read_b128 a[132:135], v217 offset:8192
ds_read_b128 a[128:131], v216 offset:8192
v_mfma_f32_16x16x32_bf16 a[48:51], a[176:179], v[76:79], a[48:51]
v_exp_f32 v58, v58
v_mfma_f32_16x16x32_bf16 a[80:83], a[176:179], v[80:83], a[80:83]
v_cvt_pk_bf16_f32 v95, v54, v55
v_cvt_pk_bf16_f32 v96, v56, v57
v_mfma_f32_16x16x32_bf16 a[112:115], a[176:179], v[84:87], a[112:115]
v_exp_f32 v59, v59
v_mfma_f32_16x16x32_bf16 a[116:119], a[180:183], v[84:87], a[116:119]
s_add_u32 s44, s44, 4096
ds_read_b64_tr_b16 a[176:177], v224 offset:57344
ds_read_b64_tr_b16 a[178:179], v224 offset:61440
v_mfma_f32_16x16x32_bf16 a[84:87], a[180:183], v[80:83], a[84:87]
v_exp_f32 v60, v60
v_mfma_f32_16x16x32_bf16 a[52:55], a[180:183], v[76:79], a[52:55]
v_cvt_pk_bf16_f32 v97, v58, v59
v_mfma_f32_16x16x32_bf16 a[20:23], a[180:183], v[72:75], a[20:23]
v_exp_f32 v61, v61
v_mfma_f32_16x16x32_bf16 a[24:27], a[184:187], v[72:75], a[24:27]
ds_read_b64_tr_b16 a[180:181], v225 offset:57344
ds_read_b64_tr_b16 a[182:183], v225 offset:61440
v_mfma_f32_16x16x32_bf16 a[56:59], a[184:187], v[76:79], a[56:59]
v_exp_f32 v62, v62
v_mfma_f32_16x16x32_bf16 a[88:91], a[184:187], v[80:83], a[88:91]
v_cvt_pk_bf16_f32 v98, v60, v61
v_mfma_f32_16x16x32_bf16 a[120:123], a[184:187], v[84:87], a[120:123]
v_exp_f32 v63, v63
v_mfma_f32_16x16x32_bf16 a[124:127], a[188:191], v[84:87], a[124:127]
ds_read_b64_tr_b16 a[184:185], v226 offset:57344
ds_read_b64_tr_b16 a[186:187], v226 offset:61440
v_mfma_f32_16x16x32_bf16 a[92:95], a[188:191], v[80:83], a[92:95]
v_exp_f32 v64, v64
v_mfma_f32_16x16x32_bf16 a[60:63], a[188:191], v[76:79], a[60:63]
v_cvt_pk_bf16_f32 v99, v62, v63
v_mfma_f32_16x16x32_bf16 a[28:31], a[188:191], v[72:75], a[28:31]
v_exp_f32 v65, v65
v_smfmac_f32_16x16x64_bf16 a[252:255], a[208:211], v[80:87], v235
ds_read_b64_tr_b16 a[188:189], v227 offset:57344
ds_read_b64_tr_b16 a[190:191], v227 offset:61440
v_mfma_f32_16x16x32_bf16 v[12:15], a[144:147], v[152:155], v[136:139]
v_exp_f32 v66, v66
v_mfma_f32_16x16x32_bf16 v[12:15], a[148:151], v[156:159], v[12:15]
v_cvt_pk_bf16_f32 v100, v64, v65
v_mfma_f32_16x16x32_bf16 v[12:15], a[152:155], v[160:163], v[12:15]
v_exp_f32 v67, v67
v_mfma_f32_16x16x32_bf16 v[12:15], a[156:159], v[164:167], v[12:15]
v_cvt_pk_bf16_f32 v101, v66, v67
v_mfma_f32_16x16x32_bf16 v[20:23], a[156:159], v[180:183], v[140:143]
v_exp_f32 v68, v68
v_mfma_f32_16x16x32_bf16 v[20:23], a[152:155], v[176:179], v[20:23]
v_mfma_f32_16x16x32_bf16 v[20:23], a[148:151], v[172:175], v[20:23]
v_exp_f32 v69, v69
v_mfma_f32_16x16x32_bf16 v[20:23], a[144:147], v[168:171], v[20:23]
v_cvt_pk_bf16_f32 v102, v68, v69
v_mfma_f32_16x16x32_bf16 v[28:31], a[144:147], v[184:187], v[144:147]
v_exp_f32 v70, v70
v_mfma_f32_16x16x32_bf16 v[28:31], a[148:151], v[188:191], v[28:31]
v_mfma_f32_16x16x32_bf16 v[28:31], a[152:155], v[192:195], v[28:31]
v_exp_f32 v71, v71
v_mfma_f32_16x16x32_bf16 v[28:31], a[156:159], v[196:199], v[28:31]
v_cvt_pk_bf16_f32 v103, v70, v71
v_mfma_f32_16x16x32_bf16 v[36:39], a[156:159], v[212:215], v[148:151]
s_add_u32 s40, s40, 1
ds_read_b128 a[156:159], v219 offset:12288
v_mfma_f32_16x16x32_bf16 v[36:39], a[152:155], v[208:211], v[36:39]
s_bitcmp1_b32 s74, s40
ds_read_b128 a[152:155], v218 offset:12288
v_mfma_f32_16x16x32_bf16 v[36:39], a[148:151], v[204:207], v[36:39]
ds_read_b128 a[148:151], v217 offset:12288
v_mfma_f32_16x16x32_bf16 v[36:39], a[144:147], v[200:203], v[36:39]
ds_read_b128 a[144:147], v216 offset:12288
s_cbranch_scc1 K_EXIT
K_B4:
v_mfma_f32_16x16x32_bf16 a[0:3], a[160:163], v[88:91], a[0:3]
v_exp_f32 v8, v8
v_mfma_f32_16x16x32_bf16 a[32:35], a[160:163], v[92:95], a[32:35]
v_exp_f32 v9, v9
v_mfma_f32_16x16x32_bf16 a[64:67], a[160:163], v[96:99], a[64:67]
v_cvt_pk_bf16_f32 v72, v8, v9
v_mfma_f32_16x16x32_bf16 a[96:99], a[160:163], v[100:103], a[96:99]
s_waitcnt lgkmcnt(4)
v_exp_f32 v10, v10
v_mfma_f32_16x16x32_bf16 a[100:103], a[164:167], v[100:103], a[100:103]
v_mfma_f32_16x16x32_bf16 a[68:71], a[164:167], v[96:99], a[68:71]
v_exp_f32 v11, v11
s_waitcnt vmcnt(4) lgkmcnt(0)
s_barrier
v_mfma_f32_16x16x32_bf16 a[36:39], a[164:167], v[92:95], a[36:39]
ds_read_b64_tr_b16 a[160:161], v220 offset:0
ds_read_b64_tr_b16 a[162:163], v220 offset:4096
v_mfma_f32_16x16x32_bf16 a[4:7], a[164:167], v[88:91], a[4:7]
s_add_u32 m0, s37, 98304
v_exp_f32 v12, v12
v_mfma_f32_16x16x32_bf16 a[8:11], a[168:171], v[88:91], a[8:11]
buffer_load_dwordx4 v232, s[12:15], s39 offen offset:0 lds
v_mfma_f32_16x16x32_bf16 a[40:43], a[168:171], v[92:95], a[40:43]
v_exp_f32 v13, v13
v_mfma_f32_16x16x32_bf16 a[72:75], a[168:171], v[96:99], a[72:75]
ds_read_b64_tr_b16 a[164:165], v221 offset:0
ds_read_b64_tr_b16 a[166:167], v221 offset:4096
v_mfma_f32_16x16x32_bf16 a[104:107], a[168:171], v[100:103], a[104:107]
v_exp_f32 v14, v14
v_mfma_f32_16x16x32_bf16 a[108:111], a[172:175], v[100:103], a[108:111]
ds_read_b64_tr_b16 a[168:169], v222 offset:0
ds_read_b64_tr_b16 a[170:171], v222 offset:4096
v_mfma_f32_16x16x32_bf16 a[76:79], a[172:175], v[96:99], a[76:79]
v_exp_f32 v15, v15
v_mfma_f32_16x16x32_bf16 a[44:47], a[172:175], v[92:95], a[44:47]
v_cvt_pk_bf16_f32 v73, v10, v11
v_cvt_pk_bf16_f32 v74, v12, v13
v_mfma_f32_16x16x32_bf16 a[12:15], a[172:175], v[88:91], a[12:15]
v_exp_f32 v16, v16
v_smfmac_f32_16x16x64_bf16 a[248:251], a[208:211], v[88:95], v235
buffer_load_dwordx4 v233, s[12:15], s39 offen offset:1024 lds
v_mfma_f32_16x16x32_bf16 v[40:43], a[128:131], v[152:155], v[136:139]
v_exp_f32 v17, v17
v_mfma_f32_16x16x32_bf16 v[40:43], a[132:135], v[156:159], v[40:43]
ds_read_b64_tr_b16 a[172:173], v223 offset:0
ds_read_b64_tr_b16 a[174:175], v223 offset:4096
v_mfma_f32_16x16x32_bf16 v[40:43], a[136:139], v[160:163], v[40:43]
v_exp_f32 v18, v18
v_mfma_f32_16x16x32_bf16 v[40:43], a[140:143], v[164:167], v[40:43]
v_cvt_pk_bf16_f32 v75, v14, v15
v_cvt_pk_bf16_f32 v76, v16, v17
v_mfma_f32_16x16x32_bf16 v[48:51], a[140:143], v[180:183], v[140:143]
v_exp_f32 v19, v19
v_mfma_f32_16x16x32_bf16 v[48:51], a[136:139], v[176:179], v[48:51]
v_cvt_pk_bf16_f32 v77, v18, v19
v_mfma_f32_16x16x32_bf16 v[48:51], a[132:135], v[172:175], v[48:51]
v_exp_f32 v20, v20
v_mfma_f32_16x16x32_bf16 v[48:51], a[128:131], v[168:171], v[48:51]
v_mfma_f32_16x16x32_bf16 v[56:59], a[128:131], v[184:187], v[144:147]
v_exp_f32 v21, v21
v_mfma_f32_16x16x32_bf16 v[56:59], a[132:135], v[188:191], v[56:59]
buffer_load_dwordx4 v232, s[12:15], s39 offen offset:2048 lds
v_mfma_f32_16x16x32_bf16 v[56:59], a[136:139], v[192:195], v[56:59]
v_exp_f32 v22, v22
v_mfma_f32_16x16x32_bf16 v[56:59], a[140:143], v[196:199], v[56:59]
v_cvt_pk_bf16_f32 v78, v20, v21
v_mfma_f32_16x16x32_bf16 v[64:67], a[140:143], v[212:215], v[148:151]
v_exp_f32 v23, v23
v_mfma_f32_16x16x32_bf16 v[64:67], a[136:139], v[208:211], v[64:67]
ds_read_b128 a[140:143], v219 offset:49152
ds_read_b128 a[136:139], v218 offset:49152
v_mfma_f32_16x16x32_bf16 v[64:67], a[132:135], v[204:207], v[64:67]
v_exp_f32 v24, v24
v_mfma_f32_16x16x32_bf16 v[64:67], a[128:131], v[200:203], v[64:67]
v_exp_f32 v25, v25
v_mfma_f32_16x16x32_bf16 a[16:19], a[176:179], v[88:91], a[16:19]
ds_read_b128 a[132:135], v217 offset:49152
ds_read_b128 a[128:131], v216 offset:49152
v_mfma_f32_16x16x32_bf16 a[48:51], a[176:179], v[92:95], a[48:51]
v_exp_f32 v26, v26
v_mfma_f32_16x16x32_bf16 a[80:83], a[176:179], v[96:99], a[80:83]
buffer_load_dwordx4 v233, s[12:15], s39 offen offset:3072 lds
v_mfma_f32_16x16x32_bf16 a[112:115], a[176:179], v[100:103], a[112:115]
v_exp_f32 v27, v27
v_mfma_f32_16x16x32_bf16 a[116:119], a[180:183], v[100:103], a[116:119]
ds_read_b64_tr_b16 a[176:177], v224 offset:0
ds_read_b64_tr_b16 a[178:179], v224 offset:4096
v_mfma_f32_16x16x32_bf16 a[84:87], a[180:183], v[96:99], a[84:87]
v_exp_f32 v28, v28
v_mfma_f32_16x16x32_bf16 a[52:55], a[180:183], v[92:95], a[52:55]
v_cvt_pk_bf16_f32 v79, v22, v23
v_cvt_pk_bf16_f32 v80, v24, v25
v_mfma_f32_16x16x32_bf16 a[20:23], a[180:183], v[88:91], a[20:23]
v_exp_f32 v29, v29
v_mfma_f32_16x16x32_bf16 a[24:27], a[184:187], v[88:91], a[24:27]
ds_read_b64_tr_b16 a[180:181], v225 offset:0
ds_read_b64_tr_b16 a[182:183], v225 offset:4096
v_mfma_f32_16x16x32_bf16 a[56:59], a[184:187], v[92:95], a[56:59]
v_exp_f32 v30, v30
v_mfma_f32_16x16x32_bf16 a[88:91], a[184:187], v[96:99], a[88:91]
v_cvt_pk_bf16_f32 v81, v26, v27
v_cvt_pk_bf16_f32 v82, v28, v29
v_mfma_f32_16x16x32_bf16 a[120:123], a[184:187], v[100:103], a[120:123]
s_add_u32 s39, s39, 16384
v_exp_f32 v31, v31
v_mfma_f32_16x16x32_bf16 a[124:127], a[188:191], v[100:103], a[124:127]
s_add_u32 m0, s37, 16384
ds_read_b64_tr_b16 a[184:185], v226 offset:0
ds_read_b64_tr_b16 a[186:187], v226 offset:4096
v_mfma_f32_16x16x32_bf16 a[92:95], a[188:191], v[96:99], a[92:95]
v_exp_f32 v32, v32
v_mfma_f32_16x16x32_bf16 a[60:63], a[188:191], v[92:95], a[60:63]
buffer_load_dwordx4 v228, s[8:11], s38 offen offset:0 lds
v_mfma_f32_16x16x32_bf16 a[28:31], a[188:191], v[88:91], a[28:31]
v_exp_f32 v33, v33
v_smfmac_f32_16x16x64_bf16 a[252:255], a[208:211], v[96:103], v235
ds_read_b64_tr_b16 a[188:189], v227 offset:0
ds_read_b64_tr_b16 a[190:191], v227 offset:4096
v_mfma_f32_16x16x32_bf16 v[44:47], a[144:147], v[152:155], v[136:139]
v_exp_f32 v34, v34
v_mfma_f32_16x16x32_bf16 v[44:47], a[148:151], v[156:159], v[44:47]
v_cvt_pk_bf16_f32 v83, v30, v31
v_cvt_pk_bf16_f32 v84, v32, v33
v_mfma_f32_16x16x32_bf16 v[44:47], a[152:155], v[160:163], v[44:47]
v_exp_f32 v35, v35
v_mfma_f32_16x16x32_bf16 v[44:47], a[156:159], v[164:167], v[44:47]
buffer_load_dwordx4 v229, s[8:11], s38 offen offset:1024 lds
v_mfma_f32_16x16x32_bf16 v[52:55], a[156:159], v[180:183], v[140:143]
v_exp_f32 v36, v36
v_mfma_f32_16x16x32_bf16 v[52:55], a[152:155], v[176:179], v[52:55]
v_cvt_pk_bf16_f32 v85, v34, v35
v_mfma_f32_16x16x32_bf16 v[52:55], a[148:151], v[172:175], v[52:55]
v_exp_f32 v37, v37
v_mfma_f32_16x16x32_bf16 v[52:55], a[144:147], v[168:171], v[52:55]
v_cvt_pk_bf16_f32 v86, v36, v37
v_mfma_f32_16x16x32_bf16 v[60:63], a[144:147], v[184:187], v[144:147]
v_exp_f32 v38, v38
v_mfma_f32_16x16x32_bf16 v[60:63], a[148:151], v[188:191], v[60:63]
v_mfma_f32_16x16x32_bf16 v[60:63], a[152:155], v[192:195], v[60:63]
v_exp_f32 v39, v39
v_mfma_f32_16x16x32_bf16 v[60:63], a[156:159], v[196:199], v[60:63]
v_cvt_pk_bf16_f32 v87, v38, v39
v_mfma_f32_16x16x32_bf16 v[68:71], a[156:159], v[212:215], v[148:151]
ds_read_b128 a[156:159], v219 offset:53248
v_mfma_f32_16x16x32_bf16 v[68:71], a[152:155], v[208:211], v[68:71]
ds_read_b128 a[152:155], v218 offset:53248
v_mfma_f32_16x16x32_bf16 v[68:71], a[148:151], v[204:207], v[68:71]
ds_read_b128 a[148:151], v217 offset:53248
v_mfma_f32_16x16x32_bf16 v[68:71], a[144:147], v[200:203], v[68:71]
s_waitcnt lgkmcnt(3)
ds_read_b128 a[144:147], v216 offset:53248
K_B5:
v_mfma_f32_16x16x32_bf16 a[0:3], a[160:163], v[72:75], a[0:3]
v_exp_f32 v40, v40
v_mfma_f32_16x16x32_bf16 a[32:35], a[160:163], v[76:79], a[32:35]
v_exp_f32 v41, v41
v_mfma_f32_16x16x32_bf16 a[64:67], a[160:163], v[80:83], a[64:67]
buffer_load_dwordx4 v230, s[8:11], s38 offen offset:2048 lds
v_mfma_f32_16x16x32_bf16 a[96:99], a[160:163], v[84:87], a[96:99]
v_exp_f32 v42, v42
v_mfma_f32_16x16x32_bf16 a[100:103], a[164:167], v[84:87], a[100:103]
ds_read_b64_tr_b16 a[160:161], v220 offset:8192
ds_read_b64_tr_b16 a[162:163], v220 offset:12288
v_mfma_f32_16x16x32_bf16 a[68:71], a[164:167], v[80:83], a[68:71]
v_exp_f32 v43, v43
v_mfma_f32_16x16x32_bf16 a[36:39], a[164:167], v[76:79], a[36:39]
v_cvt_pk_bf16_f32 v88, v40, v41
v_cvt_pk_bf16_f32 v89, v42, v43
v_mfma_f32_16x16x32_bf16 a[4:7], a[164:167], v[72:75], a[4:7]
v_exp_f32 v44, v44
v_mfma_f32_16x16x32_bf16 a[8:11], a[168:171], v[72:75], a[8:11]
ds_read_b64_tr_b16 a[164:165], v221 offset:8192
ds_read_b64_tr_b16 a[166:167], v221 offset:12288
v_mfma_f32_16x16x32_bf16 a[40:43], a[168:171], v[76:79], a[40:43]
v_exp_f32 v45, v45
v_mfma_f32_16x16x32_bf16 a[72:75], a[168:171], v[80:83], a[72:75]
v_cvt_pk_bf16_f32 v90, v44, v45
v_mfma_f32_16x16x32_bf16 a[104:107], a[168:171], v[84:87], a[104:107]
v_exp_f32 v46, v46
v_mfma_f32_16x16x32_bf16 a[108:111], a[172:175], v[84:87], a[108:111]
ds_read_b64_tr_b16 a[168:169], v222 offset:8192
ds_read_b64_tr_b16 a[170:171], v222 offset:12288
v_mfma_f32_16x16x32_bf16 a[76:79], a[172:175], v[80:83], a[76:79]
v_exp_f32 v47, v47
v_mfma_f32_16x16x32_bf16 a[44:47], a[172:175], v[76:79], a[44:47]
buffer_load_dwordx4 v231, s[8:11], s38 offen offset:3072 lds
v_mfma_f32_16x16x32_bf16 a[12:15], a[172:175], v[72:75], a[12:15]
v_exp_f32 v48, v48
v_smfmac_f32_16x16x64_bf16 a[248:251], a[208:211], v[72:79], v235
ds_read_b64_tr_b16 a[172:173], v223 offset:8192
ds_read_b64_tr_b16 a[174:175], v223 offset:12288
v_mfma_f32_16x16x32_bf16 v[8:11], a[128:131], v[152:155], v[136:139]
v_exp_f32 v49, v49
v_mfma_f32_16x16x32_bf16 v[8:11], a[132:135], v[156:159], v[8:11]
v_cvt_pk_bf16_f32 v91, v46, v47
v_cvt_pk_bf16_f32 v92, v48, v49
v_mfma_f32_16x16x32_bf16 v[8:11], a[136:139], v[160:163], v[8:11]
v_exp_f32 v50, v50
v_mfma_f32_16x16x32_bf16 v[8:11], a[140:143], v[164:167], v[8:11]
v_mfma_f32_16x16x32_bf16 v[16:19], a[140:143], v[180:183], v[140:143]
v_exp_f32 v51, v51
v_mfma_f32_16x16x32_bf16 v[16:19], a[136:139], v[176:179], v[16:19]
v_cvt_pk_bf16_f32 v93, v50, v51
v_mfma_f32_16x16x32_bf16 v[16:19], a[132:135], v[172:175], v[16:19]
v_exp_f32 v52, v52
v_mfma_f32_16x16x32_bf16 v[16:19], a[128:131], v[168:171], v[16:19]
v_mfma_f32_16x16x32_bf16 v[24:27], a[128:131], v[184:187], v[144:147]
s_add_u32 s38, s38, 16384
v_exp_f32 v53, v53
v_mfma_f32_16x16x32_bf16 v[24:27], a[132:135], v[188:191], v[24:27]
s_add_u32 m0, s37, 114688
v_cvt_pk_bf16_f32 v94, v52, v53
v_mfma_f32_16x16x32_bf16 v[24:27], a[136:139], v[192:195], v[24:27]
v_exp_f32 v54, v54
v_mfma_f32_16x16x32_bf16 v[24:27], a[140:143], v[196:199], v[24:27]
buffer_load_dwordx4 v232, s[12:15], s39 offen offset:0 lds
v_mfma_f32_16x16x32_bf16 v[32:35], a[140:143], v[212:215], v[148:151]
v_exp_f32 v55, v55
v_mfma_f32_16x16x32_bf16 v[32:35], a[136:139], v[208:211], v[32:35]
ds_read_b128 a[140:143], v219 offset:57344
ds_read_b128 a[136:139], v218 offset:57344
v_mfma_f32_16x16x32_bf16 v[32:35], a[132:135], v[204:207], v[32:35]
v_exp_f32 v56, v56
v_mfma_f32_16x16x32_bf16 v[32:35], a[128:131], v[200:203], v[32:35]
v_exp_f32 v57, v57
v_mfma_f32_16x16x32_bf16 a[16:19], a[176:179], v[72:75], a[16:19]
ds_read_b128 a[132:135], v217 offset:57344
ds_read_b128 a[128:131], v216 offset:57344
v_mfma_f32_16x16x32_bf16 a[48:51], a[176:179], v[76:79], a[48:51]
v_exp_f32 v58, v58
v_mfma_f32_16x16x32_bf16 a[80:83], a[176:179], v[80:83], a[80:83]
v_cvt_pk_bf16_f32 v95, v54, v55
v_cvt_pk_bf16_f32 v96, v56, v57
v_mfma_f32_16x16x32_bf16 a[112:115], a[176:179], v[84:87], a[112:115]
v_exp_f32 v59, v59
v_mfma_f32_16x16x32_bf16 a[116:119], a[180:183], v[84:87], a[116:119]
ds_read_b64_tr_b16 a[176:177], v224 offset:8192
ds_read_b64_tr_b16 a[178:179], v224 offset:12288
v_mfma_f32_16x16x32_bf16 a[84:87], a[180:183], v[80:83], a[84:87]
v_exp_f32 v60, v60
v_mfma_f32_16x16x32_bf16 a[52:55], a[180:183], v[76:79], a[52:55]
buffer_load_dwordx4 v233, s[12:15], s39 offen offset:1024 lds
v_mfma_f32_16x16x32_bf16 a[20:23], a[180:183], v[72:75], a[20:23]
v_exp_f32 v61, v61
v_mfma_f32_16x16x32_bf16 a[24:27], a[184:187], v[72:75], a[24:27]
ds_read_b64_tr_b16 a[180:181], v225 offset:8192
ds_read_b64_tr_b16 a[182:183], v225 offset:12288
v_mfma_f32_16x16x32_bf16 a[56:59], a[184:187], v[76:79], a[56:59]
v_exp_f32 v62, v62
v_mfma_f32_16x16x32_bf16 a[88:91], a[184:187], v[80:83], a[88:91]
v_cvt_pk_bf16_f32 v97, v58, v59
v_cvt_pk_bf16_f32 v98, v60, v61
v_mfma_f32_16x16x32_bf16 a[120:123], a[184:187], v[84:87], a[120:123]
v_exp_f32 v63, v63
v_mfma_f32_16x16x32_bf16 a[124:127], a[188:191], v[84:87], a[124:127]
ds_read_b64_tr_b16 a[184:185], v226 offset:8192
ds_read_b64_tr_b16 a[186:187], v226 offset:12288
v_mfma_f32_16x16x32_bf16 a[92:95], a[188:191], v[80:83], a[92:95]
v_exp_f32 v64, v64
v_mfma_f32_16x16x32_bf16 a[60:63], a[188:191], v[76:79], a[60:63]
v_cvt_pk_bf16_f32 v99, v62, v63
v_mfma_f32_16x16x32_bf16 a[28:31], a[188:191], v[72:75], a[28:31]
v_exp_f32 v65, v65
v_smfmac_f32_16x16x64_bf16 a[252:255], a[208:211], v[80:87], v235
s_waitcnt lgkmcnt(4)
ds_read_b64_tr_b16 a[188:189], v227 offset:8192
ds_read_b64_tr_b16 a[190:191], v227 offset:12288
v_mfma_f32_16x16x32_bf16 v[12:15], a[144:147], v[152:155], v[136:139]
v_exp_f32 v66, v66
v_mfma_f32_16x16x32_bf16 v[12:15], a[148:151], v[156:159], v[12:15]
buffer_load_dwordx4 v232, s[12:15], s39 offen offset:2048 lds
v_mfma_f32_16x16x32_bf16 v[12:15], a[152:155], v[160:163], v[12:15]
v_exp_f32 v67, v67
v_mfma_f32_16x16x32_bf16 v[12:15], a[156:159], v[164:167], v[12:15]
v_cvt_pk_bf16_f32 v100, v64, v65
v_cvt_pk_bf16_f32 v101, v66, v67
v_mfma_f32_16x16x32_bf16 v[20:23], a[156:159], v[180:183], v[140:143]
v_exp_f32 v68, v68
v_mfma_f32_16x16x32_bf16 v[20:23], a[152:155], v[176:179], v[20:23]
v_mfma_f32_16x16x32_bf16 v[20:23], a[148:151], v[172:175], v[20:23]
v_exp_f32 v69, v69
v_mfma_f32_16x16x32_bf16 v[20:23], a[144:147], v[168:171], v[20:23]
v_cvt_pk_bf16_f32 v102, v68, v69
v_mfma_f32_16x16x32_bf16 v[28:31], a[144:147], v[184:187], v[144:147]
v_exp_f32 v70, v70
v_mfma_f32_16x16x32_bf16 v[28:31], a[148:151], v[188:191], v[28:31]
v_mfma_f32_16x16x32_bf16 v[28:31], a[152:155], v[192:195], v[28:31]
v_exp_f32 v71, v71
v_mfma_f32_16x16x32_bf16 v[28:31], a[156:159], v[196:199], v[28:31]
v_cvt_pk_bf16_f32 v103, v70, v71
v_mfma_f32_16x16x32_bf16 v[36:39], a[156:159], v[212:215], v[148:151]
ds_read_b128 a[156:159], v219 offset:61440
v_mfma_f32_16x16x32_bf16 v[36:39], a[152:155], v[208:211], v[36:39]
ds_read_b128 a[152:155], v218 offset:61440
v_mfma_f32_16x16x32_bf16 v[36:39], a[148:151], v[204:207], v[36:39]
ds_read_b128 a[148:151], v217 offset:61440
v_mfma_f32_16x16x32_bf16 v[36:39], a[144:147], v[200:203], v[36:39]
ds_read_b128 a[144:147], v216 offset:61440
v_mfma_f32_16x16x32_bf16 a[0:3], a[160:163], v[88:91], a[0:3]
v_exp_f32 v8, v8
v_mfma_f32_16x16x32_bf16 a[32:35], a[160:163], v[92:95], a[32:35]
v_exp_f32 v9, v9
v_mfma_f32_16x16x32_bf16 a[64:67], a[160:163], v[96:99], a[64:67]
buffer_load_dwordx4 v233, s[12:15], s39 offen offset:3072 lds
v_mfma_f32_16x16x32_bf16 a[96:99], a[160:163], v[100:103], a[96:99]
v_exp_f32 v10, v10
v_mfma_f32_16x16x32_bf16 a[100:103], a[164:167], v[100:103], a[100:103]
ds_read_b64_tr_b16 a[160:161], v220 offset:16384
ds_read_b64_tr_b16 a[162:163], v220 offset:20480
v_mfma_f32_16x16x32_bf16 a[68:71], a[164:167], v[96:99], a[68:71]
v_exp_f32 v11, v11
v_mfma_f32_16x16x32_bf16 a[36:39], a[164:167], v[92:95], a[36:39]
v_cvt_pk_bf16_f32 v72, v8, v9
v_cvt_pk_bf16_f32 v73, v10, v11
v_mfma_f32_16x16x32_bf16 a[4:7], a[164:167], v[88:91], a[4:7]
v_exp_f32 v12, v12
v_mfma_f32_16x16x32_bf16 a[8:11], a[168:171], v[88:91], a[8:11]
ds_read_b64_tr_b16 a[164:165], v221 offset:16384
ds_read_b64_tr_b16 a[166:167], v221 offset:20480
v_mfma_f32_16x16x32_bf16 a[40:43], a[168:171], v[92:95], a[40:43]
v_exp_f32 v13, v13
v_mfma_f32_16x16x32_bf16 a[72:75], a[168:171], v[96:99], a[72:75]
v_cvt_pk_bf16_f32 v74, v12, v13
v_mfma_f32_16x16x32_bf16 a[104:107], a[168:171], v[100:103], a[104:107]
v_exp_f32 v14, v14
v_mfma_f32_16x16x32_bf16 a[108:111], a[172:175], v[100:103], a[108:111]
ds_read_b64_tr_b16 a[168:169], v222 offset:16384
ds_read_b64_tr_b16 a[170:171], v222 offset:20480
v_mfma_f32_16x16x32_bf16 a[76:79], a[172:175], v[96:99], a[76:79]
s_add_u32 s39, s39, 16384
v_exp_f32 v15, v15
v_mfma_f32_16x16x32_bf16 a[44:47], a[172:175], v[92:95], a[44:47]
s_add_u32 m0, s37, 0
v_cvt_pk_bf16_f32 v75, v14, v15
v_mfma_f32_16x16x32_bf16 a[12:15], a[172:175], v[88:91], a[12:15]
v_exp_f32 v16, v16
v_smfmac_f32_16x16x64_bf16 a[248:251], a[208:211], v[88:95], v235
buffer_load_dwordx4 v228, s[8:11], s38 offen offset:0 lds
v_mfma_f32_16x16x32_bf16 v[40:43], a[128:131], v[152:155], v[136:139]
v_exp_f32 v17, v17
v_mfma_f32_16x16x32_bf16 v[40:43], a[132:135], v[156:159], v[40:43]
ds_read_b64_tr_b16 a[172:173], v223 offset:16384
ds_read_b64_tr_b16 a[174:175], v223 offset:20480
v_mfma_f32_16x16x32_bf16 v[40:43], a[136:139], v[160:163], v[40:43]
v_exp_f32 v18, v18
v_mfma_f32_16x16x32_bf16 v[40:43], a[140:143], v[164:167], v[40:43]
v_cvt_pk_bf16_f32 v76, v16, v17
v_mfma_f32_16x16x32_bf16 v[48:51], a[140:143], v[180:183], v[140:143]
v_exp_f32 v19, v19
v_mfma_f32_16x16x32_bf16 v[48:51], a[136:139], v[176:179], v[48:51]
v_cvt_pk_bf16_f32 v77, v18, v19
v_mfma_f32_16x16x32_bf16 v[48:51], a[132:135], v[172:175], v[48:51]
v_exp_f32 v20, v20
v_mfma_f32_16x16x32_bf16 v[48:51], a[128:131], v[168:171], v[48:51]
v_mfma_f32_16x16x32_bf16 v[56:59], a[128:131], v[184:187], v[144:147]
v_exp_f32 v21, v21
v_mfma_f32_16x16x32_bf16 v[56:59], a[132:135], v[188:191], v[56:59]
buffer_load_dwordx4 v229, s[8:11], s38 offen offset:1024 lds
v_mfma_f32_16x16x32_bf16 v[56:59], a[136:139], v[192:195], v[56:59]
v_exp_f32 v22, v22
v_mfma_f32_16x16x32_bf16 v[56:59], a[140:143], v[196:199], v[56:59]
v_cvt_pk_bf16_f32 v78, v20, v21
v_mfma_f32_16x16x32_bf16 v[64:67], a[140:143], v[212:215], v[148:151]
v_exp_f32 v23, v23
v_mfma_f32_16x16x32_bf16 v[64:67], a[136:139], v[208:211], v[64:67]
ds_read_b128 a[140:143], v219 offset:32768
ds_read_b128 a[136:139], v218 offset:32768
v_mfma_f32_16x16x32_bf16 v[64:67], a[132:135], v[204:207], v[64:67]
v_exp_f32 v24, v24
v_mfma_f32_16x16x32_bf16 v[64:67], a[128:131], v[200:203], v[64:67]
v_exp_f32 v25, v25
v_mfma_f32_16x16x32_bf16 a[16:19], a[176:179], v[88:91], a[16:19]
ds_read_b128 a[132:135], v217 offset:32768
ds_read_b128 a[128:131], v216 offset:32768
v_mfma_f32_16x16x32_bf16 a[48:51], a[176:179], v[92:95], a[48:51]
v_exp_f32 v26, v26
v_mfma_f32_16x16x32_bf16 a[80:83], a[176:179], v[96:99], a[80:83]
v_cvt_pk_bf16_f32 v79, v22, v23
v_cvt_pk_bf16_f32 v80, v24, v25
v_mfma_f32_16x16x32_bf16 a[112:115], a[176:179], v[100:103], a[112:115]
s_waitcnt lgkmcnt(4)
v_exp_f32 v27, v27
v_mfma_f32_16x16x32_bf16 a[116:119], a[180:183], v[100:103], a[116:119]
ds_read_b64_tr_b16 a[176:177], v224 offset:16384
ds_read_b64_tr_b16 a[178:179], v224 offset:20480
v_mfma_f32_16x16x32_bf16 a[84:87], a[180:183], v[96:99], a[84:87]
v_exp_f32 v28, v28
v_mfma_f32_16x16x32_bf16 a[52:55], a[180:183], v[92:95], a[52:55]
buffer_load_dwordx4 v230, s[8:11], s38 offen offset:2048 lds
v_mfma_f32_16x16x32_bf16 a[20:23], a[180:183], v[88:91], a[20:23]
v_exp_f32 v29, v29
v_mfma_f32_16x16x32_bf16 a[24:27], a[184:187], v[88:91], a[24:27]
ds_read_b64_tr_b16 a[180:181], v225 offset:16384
ds_read_b64_tr_b16 a[182:183], v225 offset:20480
v_mfma_f32_16x16x32_bf16 a[56:59], a[184:187], v[92:95], a[56:59]
v_exp_f32 v30, v30
v_mfma_f32_16x16x32_bf16 a[88:91], a[184:187], v[96:99], a[88:91]
v_cvt_pk_bf16_f32 v81, v26, v27
v_cvt_pk_bf16_f32 v82, v28, v29
v_mfma_f32_16x16x32_bf16 a[120:123], a[184:187], v[100:103], a[120:123]
v_exp_f32 v31, v31
v_mfma_f32_16x16x32_bf16 a[124:127], a[188:191], v[100:103], a[124:127]
ds_read_b64_tr_b16 a[184:185], v226 offset:16384
ds_read_b64_tr_b16 a[186:187], v226 offset:20480
v_mfma_f32_16x16x32_bf16 a[92:95], a[188:191], v[96:99], a[92:95]
v_exp_f32 v32, v32
v_mfma_f32_16x16x32_bf16 a[60:63], a[188:191], v[92:95], a[60:63]
v_cvt_pk_bf16_f32 v83, v30, v31
v_mfma_f32_16x16x32_bf16 a[28:31], a[188:191], v[88:91], a[28:31]
v_exp_f32 v33, v33
v_smfmac_f32_16x16x64_bf16 a[252:255], a[208:211], v[96:103], v235
ds_read_b64_tr_b16 a[188:189], v227 offset:16384
ds_read_b64_tr_b16 a[190:191], v227 offset:20480
v_mfma_f32_16x16x32_bf16 v[44:47], a[144:147], v[152:155], v[136:139]
v_exp_f32 v34, v34
v_mfma_f32_16x16x32_bf16 v[44:47], a[148:151], v[156:159], v[44:47]
buffer_load_dwordx4 v231, s[8:11], s38 offen offset:3072 lds
v_mfma_f32_16x16x32_bf16 v[44:47], a[152:155], v[160:163], v[44:47]
v_exp_f32 v35, v35
v_mfma_f32_16x16x32_bf16 v[44:47], a[156:159], v[164:167], v[44:47]
v_cvt_pk_bf16_f32 v84, v32, v33
v_cvt_pk_bf16_f32 v85, v34, v35
v_mfma_f32_16x16x32_bf16 v[52:55], a[156:159], v[180:183], v[140:143]
v_exp_f32 v36, v36
v_mfma_f32_16x16x32_bf16 v[52:55], a[152:155], v[176:179], v[52:55]
v_mfma_f32_16x16x32_bf16 v[52:55], a[148:151], v[172:175], v[52:55]
v_exp_f32 v37, v37
v_mfma_f32_16x16x32_bf16 v[52:55], a[144:147], v[168:171], v[52:55]
v_cvt_pk_bf16_f32 v86, v36, v37
v_mfma_f32_16x16x32_bf16 v[60:63], a[144:147], v[184:187], v[144:147]
v_exp_f32 v38, v38
v_mfma_f32_16x16x32_bf16 v[60:63], a[148:151], v[188:191], v[60:63]
v_mfma_f32_16x16x32_bf16 v[60:63], a[152:155], v[192:195], v[60:63]
v_exp_f32 v39, v39
v_mfma_f32_16x16x32_bf16 v[60:63], a[156:159], v[196:199], v[60:63]
v_cvt_pk_bf16_f32 v87, v38, v39
v_mfma_f32_16x16x32_bf16 v[68:71], a[156:159], v[212:215], v[148:151]
ds_read_b128 a[156:159], v219 offset:36864
v_mfma_f32_16x16x32_bf16 v[68:71], a[152:155], v[208:211], v[68:71]
s_add_u32 s38, s38, 16384
ds_read_b128 a[152:155], v218 offset:36864
v_mfma_f32_16x16x32_bf16 v[68:71], a[148:151], v[204:207], v[68:71]
ds_read_b128 a[148:151], v217 offset:36864
v_mfma_f32_16x16x32_bf16 v[68:71], a[144:147], v[200:203], v[68:71]
ds_read_b128 a[144:147], v216 offset:36864
v_mfma_f32_16x16x32_bf16 a[0:3], a[160:163], v[72:75], a[0:3]
v_exp_f32 v40, v40
v_mfma_f32_16x16x32_bf16 a[32:35], a[160:163], v[76:79], a[32:35]
v_exp_f32 v41, v41
v_mfma_f32_16x16x32_bf16 a[64:67], a[160:163], v[80:83], a[64:67]
buffer_load_dwordx2 v[252:253], v251, s[76:79], s42 offen sc1
v_mfma_f32_16x16x32_bf16 a[96:99], a[160:163], v[84:87], a[96:99]
v_exp_f32 v42, v42
v_mfma_f32_16x16x32_bf16 a[100:103], a[164:167], v[84:87], a[100:103]
ds_read_b64_tr_b16 a[160:161], v220 offset:24576
ds_read_b64_tr_b16 a[162:163], v220 offset:28672
v_mfma_f32_16x16x32_bf16 a[68:71], a[164:167], v[80:83], a[68:71]
v_exp_f32 v43, v43
v_mfma_f32_16x16x32_bf16 a[36:39], a[164:167], v[76:79], a[36:39]
v_cvt_pk_bf16_f32 v88, v40, v41
v_cvt_pk_bf16_f32 v89, v42, v43
v_mfma_f32_16x16x32_bf16 a[4:7], a[164:167], v[72:75], a[4:7]
v_exp_f32 v44, v44
v_mfma_f32_16x16x32_bf16 a[8:11], a[168:171], v[72:75], a[8:11]
ds_read_b64_tr_b16 a[164:165], v221 offset:24576
ds_read_b64_tr_b16 a[166:167], v221 offset:28672
v_mfma_f32_16x16x32_bf16 a[40:43], a[168:171], v[76:79], a[40:43]
v_exp_f32 v45, v45
v_mfma_f32_16x16x32_bf16 a[72:75], a[168:171], v[80:83], a[72:75]
s_add_u32 s42, s42, s43
buffer_load_dword v255, v243, s[28:31], s45 offen
v_mfma_f32_16x16x32_bf16 a[104:107], a[168:171], v[84:87], a[104:107]
v_exp_f32 v46, v46
v_mfma_f32_16x16x32_bf16 a[108:111], a[172:175], v[84:87], a[108:111]
ds_read_b64_tr_b16 a[168:169], v222 offset:24576
ds_read_b64_tr_b16 a[170:171], v222 offset:28672
v_mfma_f32_16x16x32_bf16 a[76:79], a[172:175], v[80:83], a[76:79]
v_exp_f32 v47, v47
v_mfma_f32_16x16x32_bf16 a[44:47], a[172:175], v[76:79], a[44:47]
v_cvt_pk_bf16_f32 v90, v44, v45
v_cvt_pk_bf16_f32 v91, v46, v47
v_mfma_f32_16x16x32_bf16 a[12:15], a[172:175], v[72:75], a[12:15]
v_exp_f32 v48, v48
v_smfmac_f32_16x16x64_bf16 a[248:251], a[208:211], v[72:79], v235
s_waitcnt lgkmcnt(4)
ds_read_b64_tr_b16 a[172:173], v223 offset:24576
ds_read_b64_tr_b16 a[174:175], v223 offset:28672
v_mfma_f32_16x16x32_bf16 v[8:11], a[128:131], v[152:155], v[136:139]
v_exp_f32 v49, v49
v_mfma_f32_16x16x32_bf16 v[8:11], a[132:135], v[156:159], v[8:11]
v_cvt_pk_bf16_f32 v92, v48, v49
v_mfma_f32_16x16x32_bf16 v[8:11], a[136:139], v[160:163], v[8:11]
s_add_u32 s45, s45, 589824
v_exp_f32 v50, v50
v_mfma_f32_16x16x32_bf16 v[8:11], a[140:143], v[164:167], v[8:11]
global_load_dword v255, v242, s[72:73]
v_mfma_f32_16x16x32_bf16 v[16:19], a[140:143], v[180:183], v[140:143]
v_exp_f32 v51, v51
v_mfma_f32_16x16x32_bf16 v[16:19], a[136:139], v[176:179], v[16:19]
v_cvt_pk_bf16_f32 v93, v50, v51
v_mfma_f32_16x16x32_bf16 v[16:19], a[132:135], v[172:175], v[16:19]
v_exp_f32 v52, v52
v_mfma_f32_16x16x32_bf16 v[16:19], a[128:131], v[168:171], v[16:19]
v_mfma_f32_16x16x32_bf16 v[24:27], a[128:131], v[184:187], v[144:147]
v_exp_f32 v53, v53
v_mfma_f32_16x16x32_bf16 v[24:27], a[132:135], v[188:191], v[24:27]
v_cvt_pk_bf16_f32 v94, v52, v53
v_mfma_f32_16x16x32_bf16 v[24:27], a[136:139], v[192:195], v[24:27]
v_exp_f32 v54, v54
v_mfma_f32_16x16x32_bf16 v[24:27], a[140:143], v[196:199], v[24:27]
buffer_load_dword v255, v0, s[24:27], s44 offen
v_mfma_f32_16x16x32_bf16 v[32:35], a[140:143], v[212:215], v[148:151]
v_exp_f32 v55, v55
v_mfma_f32_16x16x32_bf16 v[32:35], a[136:139], v[208:211], v[32:35]
ds_read_b128 a[140:143], v219 offset:40960
ds_read_b128 a[136:139], v218 offset:40960
v_mfma_f32_16x16x32_bf16 v[32:35], a[132:135], v[204:207], v[32:35]
v_exp_f32 v56, v56
v_mfma_f32_16x16x32_bf16 v[32:35], a[128:131], v[200:203], v[32:35]
v_exp_f32 v57, v57
v_mfma_f32_16x16x32_bf16 a[16:19], a[176:179], v[72:75], a[16:19]
ds_read_b128 a[132:135], v217 offset:40960
ds_read_b128 a[128:131], v216 offset:40960
v_mfma_f32_16x16x32_bf16 a[48:51], a[176:179], v[76:79], a[48:51]
v_exp_f32 v58, v58
v_mfma_f32_16x16x32_bf16 a[80:83], a[176:179], v[80:83], a[80:83]
v_cvt_pk_bf16_f32 v95, v54, v55
v_cvt_pk_bf16_f32 v96, v56, v57
v_mfma_f32_16x16x32_bf16 a[112:115], a[176:179], v[84:87], a[112:115]
v_exp_f32 v59, v59
v_mfma_f32_16x16x32_bf16 a[116:119], a[180:183], v[84:87], a[116:119]
s_add_u32 s44, s44, 4096
ds_read_b64_tr_b16 a[176:177], v224 offset:24576
ds_read_b64_tr_b16 a[178:179], v224 offset:28672
v_mfma_f32_16x16x32_bf16 a[84:87], a[180:183], v[80:83], a[84:87]
v_exp_f32 v60, v60
v_mfma_f32_16x16x32_bf16 a[52:55], a[180:183], v[76:79], a[52:55]
v_cvt_pk_bf16_f32 v97, v58, v59
v_mfma_f32_16x16x32_bf16 a[20:23], a[180:183], v[72:75], a[20:23]
v_exp_f32 v61, v61
v_mfma_f32_16x16x32_bf16 a[24:27], a[184:187], v[72:75], a[24:27]
ds_read_b64_tr_b16 a[180:181], v225 offset:24576
ds_read_b64_tr_b16 a[182:183], v225 offset:28672
v_mfma_f32_16x16x32_bf16 a[56:59], a[184:187], v[76:79], a[56:59]
v_exp_f32 v62, v62
v_mfma_f32_16x16x32_bf16 a[88:91], a[184:187], v[80:83], a[88:91]
v_cvt_pk_bf16_f32 v98, v60, v61
v_mfma_f32_16x16x32_bf16 a[120:123], a[184:187], v[84:87], a[120:123]
v_exp_f32 v63, v63
v_mfma_f32_16x16x32_bf16 a[124:127], a[188:191], v[84:87], a[124:127]
ds_read_b64_tr_b16 a[184:185], v226 offset:24576
ds_read_b64_tr_b16 a[186:187], v226 offset:28672
v_mfma_f32_16x16x32_bf16 a[92:95], a[188:191], v[80:83], a[92:95]
v_exp_f32 v64, v64
v_mfma_f32_16x16x32_bf16 a[60:63], a[188:191], v[76:79], a[60:63]
v_cvt_pk_bf16_f32 v99, v62, v63
v_mfma_f32_16x16x32_bf16 a[28:31], a[188:191], v[72:75], a[28:31]
v_exp_f32 v65, v65
v_smfmac_f32_16x16x64_bf16 a[252:255], a[208:211], v[80:87], v235
ds_read_b64_tr_b16 a[188:189], v227 offset:24576
ds_read_b64_tr_b16 a[190:191], v227 offset:28672
v_mfma_f32_16x16x32_bf16 v[12:15], a[144:147], v[152:155], v[136:139]
v_exp_f32 v66, v66
v_mfma_f32_16x16x32_bf16 v[12:15], a[148:151], v[156:159], v[12:15]
v_cvt_pk_bf16_f32 v100, v64, v65
v_mfma_f32_16x16x32_bf16 v[12:15], a[152:155], v[160:163], v[12:15]
v_exp_f32 v67, v67
v_mfma_f32_16x16x32_bf16 v[12:15], a[156:159], v[164:167], v[12:15]
v_cvt_pk_bf16_f32 v101, v66, v67
v_mfma_f32_16x16x32_bf16 v[20:23], a[156:159], v[180:183], v[140:143]
v_exp_f32 v68, v68
v_mfma_f32_16x16x32_bf16 v[20:23], a[152:155], v[176:179], v[20:23]
v_mfma_f32_16x16x32_bf16 v[20:23], a[148:151], v[172:175], v[20:23]
v_exp_f32 v69, v69
v_mfma_f32_16x16x32_bf16 v[20:23], a[144:147], v[168:171], v[20:23]
v_cvt_pk_bf16_f32 v102, v68, v69
v_mfma_f32_16x16x32_bf16 v[28:31], a[144:147], v[184:187], v[144:147]
v_exp_f32 v70, v70
v_mfma_f32_16x16x32_bf16 v[28:31], a[148:151], v[188:191], v[28:31]
v_mfma_f32_16x16x32_bf16 v[28:31], a[152:155], v[192:195], v[28:31]
v_exp_f32 v71, v71
v_mfma_f32_16x16x32_bf16 v[28:31], a[156:159], v[196:199], v[28:31]
v_cvt_pk_bf16_f32 v103, v70, v71
v_mfma_f32_16x16x32_bf16 v[36:39], a[156:159], v[212:215], v[148:151]
ds_read_b128 a[156:159], v219 offset:45056
v_mfma_f32_16x16x32_bf16 v[36:39], a[152:155], v[208:211], v[36:39]
ds_read_b128 a[152:155], v218 offset:45056
v_mfma_f32_16x16x32_bf16 v[36:39], a[148:151], v[204:207], v[36:39]
ds_read_b128 a[148:151], v217 offset:45056
v_mfma_f32_16x16x32_bf16 v[36:39], a[144:147], v[200:203], v[36:39]
ds_read_b128 a[144:147], v216 offset:45056
v_mfma_f32_16x16x32_bf16 a[0:3], a[160:163], v[88:91], a[0:3]
v_exp_f32 v8, v8
v_mfma_f32_16x16x32_bf16 a[32:35], a[160:163], v[92:95], a[32:35]
v_exp_f32 v9, v9
v_mfma_f32_16x16x32_bf16 a[64:67], a[160:163], v[96:99], a[64:67]
v_cvt_pk_bf16_f32 v72, v8, v9
v_mfma_f32_16x16x32_bf16 a[96:99], a[160:163], v[100:103], a[96:99]
s_waitcnt lgkmcnt(4)
v_exp_f32 v10, v10
v_mfma_f32_16x16x32_bf16 a[100:103], a[164:167], v[100:103], a[100:103]
v_mfma_f32_16x16x32_bf16 a[68:71], a[164:167], v[96:99], a[68:71]
v_exp_f32 v11, v11
s_waitcnt vmcnt(4) lgkmcnt(0)
s_barrier
v_mfma_f32_16x16x32_bf16 a[36:39], a[164:167], v[92:95], a[36:39]
ds_read_b64_tr_b16 a[160:161], v220 offset:32768
ds_read_b64_tr_b16 a[162:163], v220 offset:36864
v_mfma_f32_16x16x32_bf16 a[4:7], a[164:167], v[88:91], a[4:7]
s_add_u32 m0, s37, 65536
v_exp_f32 v12, v12
v_mfma_f32_16x16x32_bf16 a[8:11], a[168:171], v[88:91], a[8:11]
buffer_load_dwordx4 v232, s[12:15], s39 offen offset:0 lds
v_mfma_f32_16x16x32_bf16 a[40:43], a[168:171], v[92:95], a[40:43]
v_exp_f32 v13, v13
v_mfma_f32_16x16x32_bf16 a[72:75], a[168:171], v[96:99], a[72:75]
ds_read_b64_tr_b16 a[164:165], v221 offset:32768
ds_read_b64_tr_b16 a[166:167], v221 offset:36864
v_mfma_f32_16x16x32_bf16 a[104:107], a[168:171], v[100:103], a[104:107]
v_exp_f32 v14, v14
v_mfma_f32_16x16x32_bf16 a[108:111], a[172:175], v[100:103], a[108:111]
ds_read_b64_tr_b16 a[168:169], v222 offset:32768
ds_read_b64_tr_b16 a[170:171], v222 offset:36864
v_mfma_f32_16x16x32_bf16 a[76:79], a[172:175], v[96:99], a[76:79]
v_exp_f32 v15, v15
v_mfma_f32_16x16x32_bf16 a[44:47], a[172:175], v[92:95], a[44:47]
v_cvt_pk_bf16_f32 v73, v10, v11
v_cvt_pk_bf16_f32 v74, v12, v13
v_mfma_f32_16x16x32_bf16 a[12:15], a[172:175], v[88:91], a[12:15]
v_exp_f32 v16, v16
v_smfmac_f32_16x16x64_bf16 a[248:251], a[208:211], v[88:95], v235
buffer_load_dwordx4 v233, s[12:15], s39 offen offset:1024 lds
v_mfma_f32_16x16x32_bf16 v[40:43], a[128:131], v[152:155], v[136:139]
v_exp_f32 v17, v17
v_mfma_f32_16x16x32_bf16 v[40:43], a[132:135], v[156:159], v[40:43]
ds_read_b64_tr_b16 a[172:173], v223 offset:32768
ds_read_b64_tr_b16 a[174:175], v223 offset:36864
v_mfma_f32_16x16x32_bf16 v[40:43], a[136:139], v[160:163], v[40:43]
v_exp_f32 v18, v18
v_mfma_f32_16x16x32_bf16 v[40:43], a[140:143], v[164:167], v[40:43]
v_cvt_pk_bf16_f32 v75, v14, v15
v_cvt_pk_bf16_f32 v76, v16, v17
v_mfma_f32_16x16x32_bf16 v[48:51], a[140:143], v[180:183], v[140:143]
v_exp_f32 v19, v19
v_mfma_f32_16x16x32_bf16 v[48:51], a[136:139], v[176:179], v[48:51]
v_cvt_pk_bf16_f32 v77, v18, v19
v_mfma_f32_16x16x32_bf16 v[48:51], a[132:135], v[172:175], v[48:51]
v_exp_f32 v20, v20
v_mfma_f32_16x16x32_bf16 v[48:51], a[128:131], v[168:171], v[48:51]
v_mfma_f32_16x16x32_bf16 v[56:59], a[128:131], v[184:187], v[144:147]
v_exp_f32 v21, v21
v_mfma_f32_16x16x32_bf16 v[56:59], a[132:135], v[188:191], v[56:59]
buffer_load_dwordx4 v232, s[12:15], s39 offen offset:2048 lds
v_mfma_f32_16x16x32_bf16 v[56:59], a[136:139], v[192:195], v[56:59]
v_exp_f32 v22, v22
v_mfma_f32_16x16x32_bf16 v[56:59], a[140:143], v[196:199], v[56:59]
v_cvt_pk_bf16_f32 v78, v20, v21
v_mfma_f32_16x16x32_bf16 v[64:67], a[140:143], v[212:215], v[148:151]
v_exp_f32 v23, v23
v_mfma_f32_16x16x32_bf16 v[64:67], a[136:139], v[208:211], v[64:67]
ds_read_b128 a[140:143], v219 offset:16384
ds_read_b128 a[136:139], v218 offset:16384
v_mfma_f32_16x16x32_bf16 v[64:67], a[132:135], v[204:207], v[64:67]
v_exp_f32 v24, v24
v_mfma_f32_16x16x32_bf16 v[64:67], a[128:131], v[200:203], v[64:67]
v_exp_f32 v25, v25
v_mfma_f32_16x16x32_bf16 a[16:19], a[176:179], v[88:91], a[16:19]
ds_read_b128 a[132:135], v217 offset:16384
ds_read_b128 a[128:131], v216 offset:16384
v_mfma_f32_16x16x32_bf16 a[48:51], a[176:179], v[92:95], a[48:51]
v_exp_f32 v26, v26
v_mfma_f32_16x16x32_bf16 a[80:83], a[176:179], v[96:99], a[80:83]
buffer_load_dwordx4 v233, s[12:15], s39 offen offset:3072 lds
v_mfma_f32_16x16x32_bf16 a[112:115], a[176:179], v[100:103], a[112:115]
v_exp_f32 v27, v27
v_mfma_f32_16x16x32_bf16 a[116:119], a[180:183], v[100:103], a[116:119]
ds_read_b64_tr_b16 a[176:177], v224 offset:32768
ds_read_b64_tr_b16 a[178:179], v224 offset:36864
v_mfma_f32_16x16x32_bf16 a[84:87], a[180:183], v[96:99], a[84:87]
v_exp_f32 v28, v28
v_mfma_f32_16x16x32_bf16 a[52:55], a[180:183], v[92:95], a[52:55]
v_cvt_pk_bf16_f32 v79, v22, v23
v_cvt_pk_bf16_f32 v80, v24, v25
v_mfma_f32_16x16x32_bf16 a[20:23], a[180:183], v[88:91], a[20:23]
v_exp_f32 v29, v29
v_mfma_f32_16x16x32_bf16 a[24:27], a[184:187], v[88:91], a[24:27]
ds_read_b64_tr_b16 a[180:181], v225 offset:32768
ds_read_b64_tr_b16 a[182:183], v225 offset:36864
v_mfma_f32_16x16x32_bf16 a[56:59], a[184:187], v[92:95], a[56:59]
v_exp_f32 v30, v30
v_mfma_f32_16x16x32_bf16 a[88:91], a[184:187], v[96:99], a[88:91]
v_cvt_pk_bf16_f32 v81, v26, v27
v_cvt_pk_bf16_f32 v82, v28, v29
v_mfma_f32_16x16x32_bf16 a[120:123], a[184:187], v[100:103], a[120:123]
s_add_u32 s39, s39, 16384
v_exp_f32 v31, v31
v_mfma_f32_16x16x32_bf16 a[124:127], a[188:191], v[100:103], a[124:127]
s_add_u32 m0, s37, 49152
ds_read_b64_tr_b16 a[184:185], v226 offset:32768
ds_read_b64_tr_b16 a[186:187], v226 offset:36864
v_mfma_f32_16x16x32_bf16 a[92:95], a[188:191], v[96:99], a[92:95]
v_exp_f32 v32, v32
v_mfma_f32_16x16x32_bf16 a[60:63], a[188:191], v[92:95], a[60:63]
buffer_load_dwordx4 v228, s[8:11], s38 offen offset:0 lds
v_mfma_f32_16x16x32_bf16 a[28:31], a[188:191], v[88:91], a[28:31]
v_exp_f32 v33, v33
v_smfmac_f32_16x16x64_bf16 a[252:255], a[208:211], v[96:103], v235
ds_read_b64_tr_b16 a[188:189], v227 offset:32768
ds_read_b64_tr_b16 a[190:191], v227 offset:36864
v_mfma_f32_16x16x32_bf16 v[44:47], a[144:147], v[152:155], v[136:139]
v_exp_f32 v34, v34
v_mfma_f32_16x16x32_bf16 v[44:47], a[148:151], v[156:159], v[44:47]
v_cvt_pk_bf16_f32 v83, v30, v31
v_cvt_pk_bf16_f32 v84, v32, v33
v_mfma_f32_16x16x32_bf16 v[44:47], a[152:155], v[160:163], v[44:47]
v_exp_f32 v35, v35
v_mfma_f32_16x16x32_bf16 v[44:47], a[156:159], v[164:167], v[44:47]
buffer_load_dwordx4 v229, s[8:11], s38 offen offset:1024 lds
v_mfma_f32_16x16x32_bf16 v[52:55], a[156:159], v[180:183], v[140:143]
v_exp_f32 v36, v36
v_mfma_f32_16x16x32_bf16 v[52:55], a[152:155], v[176:179], v[52:55]
v_cvt_pk_bf16_f32 v85, v34, v35
v_mfma_f32_16x16x32_bf16 v[52:55], a[148:151], v[172:175], v[52:55]
v_exp_f32 v37, v37
v_mfma_f32_16x16x32_bf16 v[52:55], a[144:147], v[168:171], v[52:55]
v_cvt_pk_bf16_f32 v86, v36, v37
v_mfma_f32_16x16x32_bf16 v[60:63], a[144:147], v[184:187], v[144:147]
v_exp_f32 v38, v38
v_mfma_f32_16x16x32_bf16 v[60:63], a[148:151], v[188:191], v[60:63]
v_mfma_f32_16x16x32_bf16 v[60:63], a[152:155], v[192:195], v[60:63]
v_exp_f32 v39, v39
v_mfma_f32_16x16x32_bf16 v[60:63], a[156:159], v[196:199], v[60:63]
v_cvt_pk_bf16_f32 v87, v38, v39
v_mfma_f32_16x16x32_bf16 v[68:71], a[156:159], v[212:215], v[148:151]
ds_read_b128 a[156:159], v219 offset:20480
v_mfma_f32_16x16x32_bf16 v[68:71], a[152:155], v[208:211], v[68:71]
ds_read_b128 a[152:155], v218 offset:20480
v_mfma_f32_16x16x32_bf16 v[68:71], a[148:151], v[204:207], v[68:71]
ds_read_b128 a[148:151], v217 offset:20480
v_mfma_f32_16x16x32_bf16 v[68:71], a[144:147], v[200:203], v[68:71]
s_waitcnt lgkmcnt(3)
ds_read_b128 a[144:147], v216 offset:20480
s_branch K_LOOP
K_EXIT:
s_cmp_lg_u32 s40, 8
s_cbranch_scc1 K_HOOK
s_cmp_lg_u32 s52, 0
s_cbranch_scc1 K_YR0
K_LAST:
v_mfma_f32_16x16x32_bf16 a[0:3], a[160:163], v[88:91], a[0:3]
s_add_u32 s46, s36, 1
v_exp_f32 v8, v8
v_mfma_f32_16x16x32_bf16 a[32:35], a[160:163], v[92:95], a[32:35]
s_and_b32 s46, s46, 3
v_exp_f32 v9, v9
v_mfma_f32_16x16x32_bf16 a[64:67], a[160:163], v[96:99], a[64:67]
s_mul_i32 s42, s46, 294912
v_cvt_pk_bf16_f32 v72, v8, v9
v_mfma_f32_16x16x32_bf16 a[96:99], a[160:163], v[100:103], a[96:99]
s_waitcnt lgkmcnt(4)
s_add_u32 s42, s42, s84
v_exp_f32 v10, v10
v_mfma_f32_16x16x32_bf16 a[100:103], a[164:167], v[100:103], a[100:103]
s_add_u32 s46, s36, 2
v_mfma_f32_16x16x32_bf16 a[68:71], a[164:167], v[96:99], a[68:71]
s_and_b32 s46, s46, 3
v_exp_f32 v11, v11
s_waitcnt vmcnt(4) lgkmcnt(0)
s_barrier
v_mfma_f32_16x16x32_bf16 a[36:39], a[164:167], v[92:95], a[36:39]
s_mul_i32 s43, s46, 294912
ds_read_b64_tr_b16 a[160:161], v220 offset:0
ds_read_b64_tr_b16 a[162:163], v220 offset:4096
v_mfma_f32_16x16x32_bf16 a[4:7], a[164:167], v[88:91], a[4:7]
s_add_u32 m0, s3, 98304
v_exp_f32 v12, v12
v_mfma_f32_16x16x32_bf16 a[8:11], a[168:171], v[88:91], a[8:11]
s_add_u32 s48, s51, 0
buffer_load_dwordx4 v236, s[16:19], s48 offen lds
v_mfma_f32_16x16x32_bf16 a[40:43], a[168:171], v[92:95], a[40:43]
s_add_u32 s43, s43, s84
v_exp_f32 v13, v13
v_mfma_f32_16x16x32_bf16 a[72:75], a[168:171], v[96:99], a[72:75]
s_add_u32 s46, s36, 3
ds_read_b64_tr_b16 a[164:165], v221 offset:0
ds_read_b64_tr_b16 a[166:167], v221 offset:4096
v_mfma_f32_16x16x32_bf16 a[104:107], a[168:171], v[100:103], a[104:107]
s_and_b32 s46, s46, 3
v_exp_f32 v14, v14
v_mfma_f32_16x16x32_bf16 a[108:111], a[172:175], v[100:103], a[108:111]
s_add_u32 m0, s3, 102400
ds_read_b64_tr_b16 a[168:169], v222 offset:0
ds_read_b64_tr_b16 a[170:171], v222 offset:4096
v_mfma_f32_16x16x32_bf16 a[76:79], a[172:175], v[96:99], a[76:79]
s_add_u32 s48, s51, 18432
v_exp_f32 v15, v15
v_mfma_f32_16x16x32_bf16 a[44:47], a[172:175], v[92:95], a[44:47]
s_mul_i32 s44, s46, 294912
buffer_load_dwordx4 v236, s[16:19], s48 offen lds
v_mfma_f32_16x16x32_bf16 a[12:15], a[172:175], v[88:91], a[12:15]
s_add_u32 s44, s44, s84
v_exp_f32 v16, v16
v_smfmac_f32_16x16x64_bf16 a[248:251], a[208:211], v[88:95], v235
s_cmp_eq_u32 s32, s36
s_cselect_b32 s83, s52, 0
ds_read_b64_tr_b16 a[172:173], v223 offset:0
ds_read_b64_tr_b16 a[174:175], v223 offset:4096
v_mfma_f32_16x16x32_bf16 v[40:43], a[128:131], v[152:155], v[136:139]
v_exp_f32 v17, v17
v_mfma_f32_16x16x32_bf16 v[40:43], a[132:135], v[156:159], v[40:43]
s_add_u32 m0, s3, 106496
v_cvt_pk_bf16_f32 v73, v10, v11
v_cvt_pk_bf16_f32 v74, v12, v13
v_mfma_f32_16x16x32_bf16 v[40:43], a[136:139], v[160:163], v[40:43]
s_add_u32 s48, s51, 36864
v_exp_f32 v18, v18
v_mfma_f32_16x16x32_bf16 v[40:43], a[140:143], v[164:167], v[40:43]
buffer_load_dwordx4 v236, s[16:19], s48 offen lds
v_mfma_f32_16x16x32_bf16 v[48:51], a[140:143], v[180:183], v[140:143]
v_exp_f32 v19, v19
v_mfma_f32_16x16x32_bf16 v[48:51], a[136:139], v[176:179], v[48:51]
v_cvt_pk_bf16_f32 v75, v14, v15
v_cvt_pk_bf16_f32 v76, v16, v17
v_mfma_f32_16x16x32_bf16 v[48:51], a[132:135], v[172:175], v[48:51]
s_add_u32 m0, s3, 110592
v_exp_f32 v20, v20
v_mfma_f32_16x16x32_bf16 v[48:51], a[128:131], v[168:171], v[48:51]
s_add_u32 s48, s51, 55296
buffer_load_dwordx4 v236, s[16:19], s48 offen lds
v_mfma_f32_16x16x32_bf16 v[56:59], a[128:131], v[184:187], v[144:147]
v_exp_f32 v21, v21
v_mfma_f32_16x16x32_bf16 v[56:59], a[132:135], v[188:191], v[56:59]
v_cvt_pk_bf16_f32 v77, v18, v19
v_cvt_pk_bf16_f32 v78, v20, v21
v_mfma_f32_16x16x32_bf16 v[56:59], a[136:139], v[192:195], v[56:59]
v_exp_f32 v22, v22
v_mfma_f32_16x16x32_bf16 v[56:59], a[140:143], v[196:199], v[56:59]
v_mfma_f32_16x16x32_bf16 v[64:67], a[140:143], v[212:215], v[148:151]
s_add_u32 m0, s3, 114688
v_exp_f32 v23, v23
v_mfma_f32_16x16x32_bf16 v[64:67], a[136:139], v[208:211], v[64:67]
s_add_u32 s48, s51, 73728
buffer_load_dwordx4 v236, s[16:19], s48 offen lds
v_mfma_f32_16x16x32_bf16 v[64:67], a[132:135], v[204:207], v[64:67]
v_exp_f32 v24, v24
v_mfma_f32_16x16x32_bf16 v[64:67], a[128:131], v[200:203], v[64:67]
v_exp_f32 v25, v25
v_mfma_f32_16x16x32_bf16 a[16:19], a[176:179], v[88:91], a[16:19]
ds_read_b128 a[140:143], v219 offset:49152
ds_read_b128 a[136:139], v218 offset:49152
v_mfma_f32_16x16x32_bf16 a[48:51], a[176:179], v[92:95], a[48:51]
v_exp_f32 v26, v26
v_mfma_f32_16x16x32_bf16 a[80:83], a[176:179], v[96:99], a[80:83]
s_add_u32 m0, s3, 118784
ds_read_b128 a[132:135], v217 offset:49152
ds_read_b128 a[128:131], v216 offset:49152
v_mfma_f32_16x16x32_bf16 a[112:115], a[176:179], v[100:103], a[112:115]
s_add_u32 s48, s51, 92160
v_exp_f32 v27, v27
v_mfma_f32_16x16x32_bf16 a[116:119], a[180:183], v[100:103], a[116:119]
buffer_load_dwordx4 v236, s[16:19], s48 offen lds
v_mfma_f32_16x16x32_bf16 a[84:87], a[180:183], v[96:99], a[84:87]
v_exp_f32 v28, v28
v_mfma_f32_16x16x32_bf16 a[52:55], a[180:183], v[92:95], a[52:55]
ds_read_b64_tr_b16 a[176:177], v224 offset:0
ds_read_b64_tr_b16 a[178:179], v224 offset:4096
v_mfma_f32_16x16x32_bf16 a[20:23], a[180:183], v[88:91], a[20:23]
s_add_u32 m0, s3, 122880
v_exp_f32 v29, v29
v_mfma_f32_16x16x32_bf16 a[24:27], a[184:187], v[88:91], a[24:27]
s_add_u32 s48, s51, 110592
buffer_load_dwordx4 v236, s[16:19], s48 offen lds
v_mfma_f32_16x16x32_bf16 a[56:59], a[184:187], v[92:95], a[56:59]
v_exp_f32 v30, v30
v_mfma_f32_16x16x32_bf16 a[88:91], a[184:187], v[96:99], a[88:91]
ds_read_b64_tr_b16 a[180:181], v225 offset:0
ds_read_b64_tr_b16 a[182:183], v225 offset:4096
v_mfma_f32_16x16x32_bf16 a[120:123], a[184:187], v[100:103], a[120:123]
v_exp_f32 v31, v31
v_mfma_f32_16x16x32_bf16 a[124:127], a[188:191], v[100:103], a[124:127]
ds_read_b64_tr_b16 a[184:185], v226 offset:0
ds_read_b64_tr_b16 a[186:187], v226 offset:4096
v_mfma_f32_16x16x32_bf16 a[92:95], a[188:191], v[96:99], a[92:95]
s_add_u32 m0, s3, 126976
v_exp_f32 v32, v32
v_mfma_f32_16x16x32_bf16 a[60:63], a[188:191], v[92:95], a[60:63]
s_add_u32 s48, s51, 129024
buffer_load_dwordx4 v236, s[16:19], s48 offen lds
v_mfma_f32_16x16x32_bf16 a[28:31], a[188:191], v[88:91], a[28:31]
v_exp_f32 v33, v33
v_smfmac_f32_16x16x64_bf16 a[252:255], a[208:211], v[96:103], v235
ds_read_b64_tr_b16 a[188:189], v227 offset:0
ds_read_b64_tr_b16 a[190:191], v227 offset:4096
v_mfma_f32_16x16x32_bf16 v[44:47], a[144:147], v[152:155], v[136:139]
v_exp_f32 v34, v34
v_mfma_f32_16x16x32_bf16 v[44:47], a[148:151], v[156:159], v[44:47]
s_add_u32 m0, s3, 0
v_cvt_pk_bf16_f32 v79, v22, v23
v_cvt_pk_bf16_f32 v80, v24, v25
v_mfma_f32_16x16x32_bf16 v[44:47], a[152:155], v[160:163], v[44:47]
s_add_u32 s48, s75, 0
v_exp_f32 v35, v35
v_mfma_f32_16x16x32_bf16 v[44:47], a[156:159], v[164:167], v[44:47]
buffer_load_dwordx4 v237, s[16:19], s48 offen lds
v_mfma_f32_16x16x32_bf16 v[52:55], a[156:159], v[180:183], v[140:143]
v_exp_f32 v36, v36
v_mfma_f32_16x16x32_bf16 v[52:55], a[152:155], v[176:179], v[52:55]
v_cvt_pk_bf16_f32 v81, v26, v27
v_cvt_pk_bf16_f32 v82, v28, v29
v_mfma_f32_16x16x32_bf16 v[52:55], a[148:151], v[172:175], v[52:55]
v_exp_f32 v37, v37
v_mfma_f32_16x16x32_bf16 v[52:55], a[144:147], v[168:171], v[52:55]
s_add_u32 m0, s3, 4096
v_cvt_pk_bf16_f32 v83, v30, v31
v_cvt_pk_bf16_f32 v84, v32, v33
v_mfma_f32_16x16x32_bf16 v[60:63], a[144:147], v[184:187], v[144:147]
s_add_u32 s48, s75, 36864
v_exp_f32 v38, v38
v_mfma_f32_16x16x32_bf16 v[60:63], a[148:151], v[188:191], v[60:63]
buffer_load_dwordx4 v237, s[16:19], s48 offen lds
v_mfma_f32_16x16x32_bf16 v[60:63], a[152:155], v[192:195], v[60:63]
v_exp_f32 v39, v39
v_mfma_f32_16x16x32_bf16 v[60:63], a[156:159], v[196:199], v[60:63]
v_cvt_pk_bf16_f32 v85, v34, v35
v_cvt_pk_bf16_f32 v86, v36, v37
v_mfma_f32_16x16x32_bf16 v[68:71], a[156:159], v[212:215], v[148:151]
ds_read_b128 a[156:159], v219 offset:53248
v_cvt_pk_bf16_f32 v87, v38, v39
v_mfma_f32_16x16x32_bf16 v[68:71], a[152:155], v[208:211], v[68:71]
ds_read_b128 a[152:155], v218 offset:53248
v_mfma_f32_16x16x32_bf16 v[68:71], a[148:151], v[204:207], v[68:71]
ds_read_b128 a[148:151], v217 offset:53248
v_mfma_f32_16x16x32_bf16 v[68:71], a[144:147], v[200:203], v[68:71]
s_waitcnt lgkmcnt(3)
ds_read_b128 a[144:147], v216 offset:53248
v_mfma_f32_16x16x32_bf16 a[0:3], a[160:163], v[72:75], a[0:3]
v_exp_f32 v40, v40
v_mfma_f32_16x16x32_bf16 a[32:35], a[160:163], v[76:79], a[32:35]
s_add_u32 m0, s3, 8192
v_exp_f32 v41, v41
v_mfma_f32_16x16x32_bf16 a[64:67], a[160:163], v[80:83], a[64:67]
s_add_u32 s48, s75, 73728
buffer_load_dwordx4 v237, s[16:19], s48 offen lds
v_mfma_f32_16x16x32_bf16 a[96:99], a[160:163], v[84:87], a[96:99]
v_exp_f32 v42, v42
v_mfma_f32_16x16x32_bf16 a[100:103], a[164:167], v[84:87], a[100:103]
ds_read_b64_tr_b16 a[160:161], v220 offset:8192
ds_read_b64_tr_b16 a[162:163], v220 offset:12288
v_mfma_f32_16x16x32_bf16 a[68:71], a[164:167], v[80:83], a[68:71]
v_exp_f32 v43, v43
v_mfma_f32_16x16x32_bf16 a[36:39], a[164:167], v[76:79], a[36:39]
s_add_u32 m0, s3, 12288
v_cvt_pk_bf16_f32 v88, v40, v41
v_cvt_pk_bf16_f32 v89, v42, v43
v_mfma_f32_16x16x32_bf16 a[4:7], a[164:167], v[72:75], a[4:7]
s_add_u32 s48, s75, 110592
v_exp_f32 v44, v44
v_mfma_f32_16x16x32_bf16 a[8:11], a[168:171], v[72:75], a[8:11]
buffer_load_dwordx4 v237, s[16:19], s48 offen lds
v_mfma_f32_16x16x32_bf16 a[40:43], a[168:171], v[76:79], a[40:43]
v_exp_f32 v45, v45
v_mfma_f32_16x16x32_bf16 a[72:75], a[168:171], v[80:83], a[72:75]
ds_read_b64_tr_b16 a[164:165], v221 offset:8192
ds_read_b64_tr_b16 a[166:167], v221 offset:12288
v_mfma_f32_16x16x32_bf16 a[104:107], a[168:171], v[84:87], a[104:107]
s_add_u32 m0, s3, 16384
v_exp_f32 v46, v46
v_mfma_f32_16x16x32_bf16 a[108:111], a[172:175], v[84:87], a[108:111]
s_add_u32 s48, s75, 147456
buffer_load_dwordx4 v237, s[16:19], s48 offen lds
v_mfma_f32_16x16x32_bf16 a[76:79], a[172:175], v[80:83], a[76:79]
v_exp_f32 v47, v47
v_mfma_f32_16x16x32_bf16 a[44:47], a[172:175], v[76:79], a[44:47]
ds_read_b64_tr_b16 a[168:169], v222 offset:8192
ds_read_b64_tr_b16 a[170:171], v222 offset:12288
v_mfma_f32_16x16x32_bf16 a[12:15], a[172:175], v[72:75], a[12:15]
v_exp_f32 v48, v48
v_smfmac_f32_16x16x64_bf16 a[248:251], a[208:211], v[72:79], v235
s_add_u32 m0, s3, 20480
ds_read_b64_tr_b16 a[172:173], v223 offset:8192
ds_read_b64_tr_b16 a[174:175], v223 offset:12288
v_mfma_f32_16x16x32_bf16 v[8:11], a[128:131], v[152:155], v[136:139]
s_add_u32 s48, s75, 184320
v_exp_f32 v49, v49
v_mfma_f32_16x16x32_bf16 v[8:11], a[132:135], v[156:159], v[8:11]
buffer_load_dwordx4 v237, s[16:19], s48 offen lds
v_mfma_f32_16x16x32_bf16 v[8:11], a[136:139], v[160:163], v[8:11]
v_exp_f32 v50, v50
v_mfma_f32_16x16x32_bf16 v[8:11], a[140:143], v[164:167], v[8:11]
v_cvt_pk_bf16_f32 v90, v44, v45
v_cvt_pk_bf16_f32 v91, v46, v47
v_mfma_f32_16x16x32_bf16 v[16:19], a[140:143], v[180:183], v[140:143]
s_add_u32 m0, s3, 24576
v_exp_f32 v51, v51
v_mfma_f32_16x16x32_bf16 v[16:19], a[136:139], v[176:179], v[16:19]
s_add_u32 s48, s75, 221184
buffer_load_dwordx4 v237, s[16:19], s48 offen lds
v_mfma_f32_16x16x32_bf16 v[16:19], a[132:135], v[172:175], v[16:19]
v_exp_f32 v52, v52
v_mfma_f32_16x16x32_bf16 v[16:19], a[128:131], v[168:171], v[16:19]
v_cvt_pk_bf16_f32 v92, v48, v49
v_cvt_pk_bf16_f32 v93, v50, v51
v_mfma_f32_16x16x32_bf16 v[24:27], a[128:131], v[184:187], v[144:147]
v_exp_f32 v53, v53
v_mfma_f32_16x16x32_bf16 v[24:27], a[132:135], v[188:191], v[24:27]
s_add_u32 m0, s3, 28672
v_cvt_pk_bf16_f32 v94, v52, v53
v_mfma_f32_16x16x32_bf16 v[24:27], a[136:139], v[192:195], v[24:27]
s_add_u32 s48, s75, 258048
v_exp_f32 v54, v54
v_mfma_f32_16x16x32_bf16 v[24:27], a[140:143], v[196:199], v[24:27]
buffer_load_dwordx4 v237, s[16:19], s48 offen lds
v_mfma_f32_16x16x32_bf16 v[32:35], a[140:143], v[212:215], v[148:151]
v_exp_f32 v55, v55
v_mfma_f32_16x16x32_bf16 v[32:35], a[136:139], v[208:211], v[32:35]
ds_read_b128 a[140:143], v219 offset:57344
ds_read_b128 a[136:139], v218 offset:57344
v_mfma_f32_16x16x32_bf16 v[32:35], a[132:135], v[204:207], v[32:35]
v_exp_f32 v56, v56
v_mfma_f32_16x16x32_bf16 v[32:35], a[128:131], v[200:203], v[32:35]
s_add_u32 m0, s3, 131072
v_exp_f32 v57, v57
v_mfma_f32_16x16x32_bf16 a[16:19], a[176:179], v[72:75], a[16:19]
s_add_u32 s48, s51, 147456
buffer_load_dwordx4 v236, s[16:19], s48 offen lds
v_mfma_f32_16x16x32_bf16 a[48:51], a[176:179], v[76:79], a[48:51]
v_exp_f32 v58, v58
v_mfma_f32_16x16x32_bf16 a[80:83], a[176:179], v[80:83], a[80:83]
ds_read_b128 a[132:135], v217 offset:57344
ds_read_b128 a[128:131], v216 offset:57344
v_mfma_f32_16x16x32_bf16 a[112:115], a[176:179], v[84:87], a[112:115]
v_exp_f32 v59, v59
v_mfma_f32_16x16x32_bf16 a[116:119], a[180:183], v[84:87], a[116:119]
s_add_u32 m0, s3, 135168
ds_read_b64_tr_b16 a[176:177], v224 offset:8192
ds_read_b64_tr_b16 a[178:179], v224 offset:12288
v_mfma_f32_16x16x32_bf16 a[84:87], a[180:183], v[80:83], a[84:87]
s_add_u32 s48, s51, 165888
v_exp_f32 v60, v60
v_mfma_f32_16x16x32_bf16 a[52:55], a[180:183], v[76:79], a[52:55]
buffer_load_dwordx4 v236, s[16:19], s48 offen lds
v_mfma_f32_16x16x32_bf16 a[20:23], a[180:183], v[72:75], a[20:23]
v_exp_f32 v61, v61
v_mfma_f32_16x16x32_bf16 a[24:27], a[184:187], v[72:75], a[24:27]
ds_read_b64_tr_b16 a[180:181], v225 offset:8192
ds_read_b64_tr_b16 a[182:183], v225 offset:12288
v_mfma_f32_16x16x32_bf16 a[56:59], a[184:187], v[76:79], a[56:59]
s_add_u32 m0, s3, 139264
v_exp_f32 v62, v62
v_mfma_f32_16x16x32_bf16 a[88:91], a[184:187], v[80:83], a[88:91]
s_add_u32 s48, s51, 184320
buffer_load_dwordx4 v236, s[16:19], s48 offen lds
v_mfma_f32_16x16x32_bf16 a[120:123], a[184:187], v[84:87], a[120:123]
v_exp_f32 v63, v63
v_mfma_f32_16x16x32_bf16 a[124:127], a[188:191], v[84:87], a[124:127]
ds_read_b64_tr_b16 a[184:185], v226 offset:8192
ds_read_b64_tr_b16 a[186:187], v226 offset:12288
v_mfma_f32_16x16x32_bf16 a[92:95], a[188:191], v[80:83], a[92:95]
v_exp_f32 v64, v64
v_mfma_f32_16x16x32_bf16 a[60:63], a[188:191], v[76:79], a[60:63]
s_add_u32 m0, s3, 143360
v_cvt_pk_bf16_f32 v95, v54, v55
v_cvt_pk_bf16_f32 v96, v56, v57
v_mfma_f32_16x16x32_bf16 a[28:31], a[188:191], v[72:75], a[28:31]
s_add_u32 s48, s51, 202752
v_exp_f32 v65, v65
v_smfmac_f32_16x16x64_bf16 a[252:255], a[208:211], v[80:87], v235
s_waitcnt lgkmcnt(4)
buffer_load_dwordx4 v236, s[16:19], s48 offen lds
v_mfma_f32_16x16x32_bf16 v[12:15], a[144:147], v[152:155], v[136:139]
v_exp_f32 v66, v66
v_mfma_f32_16x16x32_bf16 v[12:15], a[148:151], v[156:159], v[12:15]
ds_read_b64_tr_b16 a[188:189], v227 offset:8192
ds_read_b64_tr_b16 a[190:191], v227 offset:12288
v_mfma_f32_16x16x32_bf16 v[12:15], a[152:155], v[160:163], v[12:15]
s_add_u32 m0, s3, 147456
v_exp_f32 v67, v67
v_mfma_f32_16x16x32_bf16 v[12:15], a[156:159], v[164:167], v[12:15]
s_add_u32 s48, s51, 221184
buffer_load_dwordx4 v236, s[16:19], s48 offen lds
v_mfma_f32_16x16x32_bf16 v[20:23], a[156:159], v[180:183], v[140:143]
v_exp_f32 v68, v68
v_mfma_f32_16x16x32_bf16 v[20:23], a[152:155], v[176:179], v[20:23]
v_cvt_pk_bf16_f32 v97, v58, v59
v_cvt_pk_bf16_f32 v98, v60, v61
v_mfma_f32_16x16x32_bf16 v[20:23], a[148:151], v[172:175], v[20:23]
v_exp_f32 v69, v69
v_mfma_f32_16x16x32_bf16 v[20:23], a[144:147], v[168:171], v[20:23]
s_add_u32 m0, s3, 151552
v_cvt_pk_bf16_f32 v99, v62, v63
v_cvt_pk_bf16_f32 v100, v64, v65
v_mfma_f32_16x16x32_bf16 v[28:31], a[144:147], v[184:187], v[144:147]
s_add_u32 s48, s51, 239616
v_exp_f32 v70, v70
v_mfma_f32_16x16x32_bf16 v[28:31], a[148:151], v[188:191], v[28:31]
buffer_load_dwordx4 v236, s[16:19], s48 offen lds
v_mfma_f32_16x16x32_bf16 v[28:31], a[152:155], v[192:195], v[28:31]
v_exp_f32 v71, v71
v_mfma_f32_16x16x32_bf16 v[28:31], a[156:159], v[196:199], v[28:31]
v_cvt_pk_bf16_f32 v101, v66, v67
v_cvt_pk_bf16_f32 v102, v68, v69
v_mfma_f32_16x16x32_bf16 v[36:39], a[156:159], v[212:215], v[148:151]
ds_read_b128 a[156:159], v219 offset:61440
v_cvt_pk_bf16_f32 v103, v70, v71
v_mfma_f32_16x16x32_bf16 v[36:39], a[152:155], v[208:211], v[36:39]
ds_read_b128 a[152:155], v218 offset:61440
v_mfma_f32_16x16x32_bf16 v[36:39], a[148:151], v[204:207], v[36:39]
ds_read_b128 a[148:151], v217 offset:61440
v_mfma_f32_16x16x32_bf16 v[36:39], a[144:147], v[200:203], v[36:39]
ds_read_b128 a[144:147], v216 offset:61440
v_mfma_f32_16x16x32_bf16 a[0:3], a[160:163], v[88:91], a[0:3]
v_exp_f32 v8, v8
v_mfma_f32_16x16x32_bf16 a[32:35], a[160:163], v[92:95], a[32:35]
v_exp_f32 v9, v9
v_mfma_f32_16x16x32_bf16 a[64:67], a[160:163], v[96:99], a[64:67]
v_cvt_pk_bf16_f32 v72, v8, v9
v_mfma_f32_16x16x32_bf16 a[96:99], a[160:163], v[100:103], a[96:99]
v_exp_f32 v10, v10
v_mfma_f32_16x16x32_bf16 a[100:103], a[164:167], v[100:103], a[100:103]
v_mfma_f32_16x16x32_bf16 a[68:71], a[164:167], v[96:99], a[68:71]
v_exp_f32 v11, v11
s_waitcnt lgkmcnt(0)
s_barrier
v_mfma_f32_16x16x32_bf16 a[36:39], a[164:167], v[92:95], a[36:39]
ds_read_b64_tr_b16 a[160:161], v220 offset:16384
ds_read_b64_tr_b16 a[162:163], v220 offset:20480
v_mfma_f32_16x16x32_bf16 a[4:7], a[164:167], v[88:91], a[4:7]
s_add_u32 m0, s3, 155648
v_exp_f32 v12, v12
v_mfma_f32_16x16x32_bf16 a[8:11], a[168:171], v[88:91], a[8:11]
s_add_u32 s48, s51, 258048
buffer_load_dwordx4 v236, s[16:19], s48 offen lds
v_mfma_f32_16x16x32_bf16 a[40:43], a[168:171], v[92:95], a[40:43]
v_exp_f32 v13, v13
v_mfma_f32_16x16x32_bf16 a[72:75], a[168:171], v[96:99], a[72:75]
ds_read_b64_tr_b16 a[164:165], v221 offset:16384
ds_read_b64_tr_b16 a[166:167], v221 offset:20480
v_mfma_f32_16x16x32_bf16 a[104:107], a[168:171], v[100:103], a[104:107]
s_add_u32 m0, s3, 159744
v_exp_f32 v14, v14
v_mfma_f32_16x16x32_bf16 a[108:111], a[172:175], v[100:103], a[108:111]
s_add_u32 s48, s51, 276480
buffer_load_dwordx4 v236, s[16:19], s48 offen lds
v_mfma_f32_16x16x32_bf16 a[76:79], a[172:175], v[96:99], a[76:79]
v_exp_f32 v15, v15
v_mfma_f32_16x16x32_bf16 a[44:47], a[172:175], v[92:95], a[44:47]
ds_read_b64_tr_b16 a[168:169], v222 offset:16384
ds_read_b64_tr_b16 a[170:171], v222 offset:20480
v_mfma_f32_16x16x32_bf16 a[12:15], a[172:175], v[88:91], a[12:15]
s_add_u32 m0, s3, 32768
v_exp_f32 v16, v16
v_smfmac_f32_16x16x64_bf16 a[248:251], a[208:211], v[88:95], v235
s_add_u32 s48, s42, 0
buffer_load_dwordx4 v236, s[16:19], s48 offen lds
v_mfma_f32_16x16x32_bf16 v[40:43], a[128:131], v[152:155], v[136:139]
v_exp_f32 v17, v17
v_mfma_f32_16x16x32_bf16 v[40:43], a[132:135], v[156:159], v[40:43]
ds_read_b64_tr_b16 a[172:173], v223 offset:16384
ds_read_b64_tr_b16 a[174:175], v223 offset:20480
v_mfma_f32_16x16x32_bf16 v[40:43], a[136:139], v[160:163], v[40:43]
s_add_u32 m0, s3, 36864
v_exp_f32 v18, v18
v_mfma_f32_16x16x32_bf16 v[40:43], a[140:143], v[164:167], v[40:43]
s_add_u32 s48, s42, 18432
buffer_load_dwordx4 v236, s[16:19], s48 offen lds
v_mfma_f32_16x16x32_bf16 v[48:51], a[140:143], v[180:183], v[140:143]
v_exp_f32 v19, v19
v_mfma_f32_16x16x32_bf16 v[48:51], a[136:139], v[176:179], v[48:51]
v_cvt_pk_bf16_f32 v73, v10, v11
v_cvt_pk_bf16_f32 v74, v12, v13
v_mfma_f32_16x16x32_bf16 v[48:51], a[132:135], v[172:175], v[48:51]
v_exp_f32 v20, v20
v_mfma_f32_16x16x32_bf16 v[48:51], a[128:131], v[168:171], v[48:51]
s_add_u32 m0, s3, 40960
v_cvt_pk_bf16_f32 v75, v14, v15
v_cvt_pk_bf16_f32 v76, v16, v17
v_mfma_f32_16x16x32_bf16 v[56:59], a[128:131], v[184:187], v[144:147]
s_add_u32 s48, s42, 36864
v_exp_f32 v21, v21
v_mfma_f32_16x16x32_bf16 v[56:59], a[132:135], v[188:191], v[56:59]
buffer_load_dwordx4 v236, s[16:19], s48 offen lds
v_mfma_f32_16x16x32_bf16 v[56:59], a[136:139], v[192:195], v[56:59]
v_exp_f32 v22, v22
v_mfma_f32_16x16x32_bf16 v[56:59], a[140:143], v[196:199], v[56:59]
s_add_u32 m0, s3, 45056
v_cvt_pk_bf16_f32 v77, v18, v19
v_cvt_pk_bf16_f32 v78, v20, v21
v_mfma_f32_16x16x32_bf16 v[64:67], a[140:143], v[212:215], v[148:151]
s_add_u32 s48, s42, 55296
v_exp_f32 v23, v23
v_mfma_f32_16x16x32_bf16 v[64:67], a[136:139], v[208:211], v[64:67]
buffer_load_dwordx4 v236, s[16:19], s48 offen lds
v_mfma_f32_16x16x32_bf16 v[64:67], a[132:135], v[204:207], v[64:67]
v_exp_f32 v24, v24
v_mfma_f32_16x16x32_bf16 v[64:67], a[128:131], v[200:203], v[64:67]
s_add_u32 m0, s3, 49152
v_exp_f32 v25, v25
v_mfma_f32_16x16x32_bf16 a[16:19], a[176:179], v[88:91], a[16:19]
s_add_u32 s48, s42, 73728
buffer_load_dwordx4 v236, s[16:19], s48 offen lds
v_mfma_f32_16x16x32_bf16 a[48:51], a[176:179], v[92:95], a[48:51]
v_exp_f32 v26, v26
v_mfma_f32_16x16x32_bf16 a[80:83], a[176:179], v[96:99], a[80:83]
v_cvt_pk_bf16_f32 v79, v22, v23
v_cvt_pk_bf16_f32 v80, v24, v25
v_mfma_f32_16x16x32_bf16 a[112:115], a[176:179], v[100:103], a[112:115]
v_exp_f32 v27, v27
v_mfma_f32_16x16x32_bf16 a[116:119], a[180:183], v[100:103], a[116:119]
s_add_u32 m0, s3, 53248
ds_read_b64_tr_b16 a[176:177], v224 offset:16384
ds_read_b64_tr_b16 a[178:179], v224 offset:20480
v_mfma_f32_16x16x32_bf16 a[84:87], a[180:183], v[96:99], a[84:87]
s_add_u32 s48, s42, 92160
v_exp_f32 v28, v28
v_mfma_f32_16x16x32_bf16 a[52:55], a[180:183], v[92:95], a[52:55]
buffer_load_dwordx4 v236, s[16:19], s48 offen lds
v_mfma_f32_16x16x32_bf16 a[20:23], a[180:183], v[88:91], a[20:23]
v_exp_f32 v29, v29
v_mfma_f32_16x16x32_bf16 a[24:27], a[184:187], v[88:91], a[24:27]
s_add_u32 m0, s3, 57344
ds_read_b64_tr_b16 a[180:181], v225 offset:16384
ds_read_b64_tr_b16 a[182:183], v225 offset:20480
v_mfma_f32_16x16x32_bf16 a[56:59], a[184:187], v[92:95], a[56:59]
s_add_u32 s48, s42, 110592
v_exp_f32 v30, v30
v_mfma_f32_16x16x32_bf16 a[88:91], a[184:187], v[96:99], a[88:91]
buffer_load_dwordx4 v236, s[16:19], s48 offen lds
v_mfma_f32_16x16x32_bf16 a[120:123], a[184:187], v[100:103], a[120:123]
v_exp_f32 v31, v31
v_mfma_f32_16x16x32_bf16 a[124:127], a[188:191], v[100:103], a[124:127]
s_add_u32 m0, s3, 61440
ds_read_b64_tr_b16 a[184:185], v226 offset:16384
ds_read_b64_tr_b16 a[186:187], v226 offset:20480
v_mfma_f32_16x16x32_bf16 a[92:95], a[188:191], v[96:99], a[92:95]
s_add_u32 s48, s42, 129024
v_exp_f32 v32, v32
v_mfma_f32_16x16x32_bf16 a[60:63], a[188:191], v[92:95], a[60:63]
buffer_load_dwordx4 v236, s[16:19], s48 offen lds
v_mfma_f32_16x16x32_bf16 a[28:31], a[188:191], v[88:91], a[28:31]
v_exp_f32 v33, v33
v_smfmac_f32_16x16x64_bf16 a[252:255], a[208:211], v[96:103], v235
ds_read_b64_tr_b16 a[188:189], v227 offset:16384
ds_read_b64_tr_b16 a[190:191], v227 offset:20480
v_mfma_f32_16x16x32_bf16 v[44:47], a[144:147], v[152:155], v[136:139]
s_add_u32 m0, s3, 65536
v_exp_f32 v34, v34
v_mfma_f32_16x16x32_bf16 v[44:47], a[148:151], v[156:159], v[44:47]
s_add_u32 s48, s43, 0
buffer_load_dwordx4 v236, s[16:19], s48 offen lds
v_mfma_f32_16x16x32_bf16 v[44:47], a[152:155], v[160:163], v[44:47]
v_exp_f32 v35, v35
v_mfma_f32_16x16x32_bf16 v[44:47], a[156:159], v[164:167], v[44:47]
v_cvt_pk_bf16_f32 v81, v26, v27
v_cvt_pk_bf16_f32 v82, v28, v29
v_mfma_f32_16x16x32_bf16 v[52:55], a[156:159], v[180:183], v[140:143]
s_add_u32 m0, s3, 69632
v_exp_f32 v36, v36
v_mfma_f32_16x16x32_bf16 v[52:55], a[152:155], v[176:179], v[52:55]
s_add_u32 s48, s43, 18432
buffer_load_dwordx4 v236, s[16:19], s48 offen lds
v_mfma_f32_16x16x32_bf16 v[52:55], a[148:151], v[172:175], v[52:55]
v_exp_f32 v37, v37
v_mfma_f32_16x16x32_bf16 v[52:55], a[144:147], v[168:171], v[52:55]
v_cvt_pk_bf16_f32 v83, v30, v31
v_cvt_pk_bf16_f32 v84, v32, v33
v_mfma_f32_16x16x32_bf16 v[60:63], a[144:147], v[184:187], v[144:147]
s_add_u32 m0, s3, 73728
v_exp_f32 v38, v38
v_mfma_f32_16x16x32_bf16 v[60:63], a[148:151], v[188:191], v[60:63]
s_add_u32 s48, s43, 36864
buffer_load_dwordx4 v236, s[16:19], s48 offen lds
v_mfma_f32_16x16x32_bf16 v[60:63], a[152:155], v[192:195], v[60:63]
v_exp_f32 v39, v39
v_mfma_f32_16x16x32_bf16 v[60:63], a[156:159], v[196:199], v[60:63]
v_cvt_pk_bf16_f32 v85, v34, v35
v_cvt_pk_bf16_f32 v86, v36, v37
v_mfma_f32_16x16x32_bf16 v[68:71], a[156:159], v[212:215], v[148:151]
v_cvt_pk_bf16_f32 v87, v38, v39
v_mfma_f32_16x16x32_bf16 v[68:71], a[152:155], v[208:211], v[68:71]
v_mfma_f32_16x16x32_bf16 v[68:71], a[148:151], v[204:207], v[68:71]
v_mfma_f32_16x16x32_bf16 v[68:71], a[144:147], v[200:203], v[68:71]
s_waitcnt lgkmcnt(0)
v_mfma_f32_16x16x32_bf16 a[0:3], a[160:163], v[72:75], a[0:3]
v_exp_f32 v40, v40
v_exp_f32 v41, v41
v_mfma_f32_16x16x32_bf16 a[32:35], a[160:163], v[76:79], a[32:35]
v_cvt_pk_bf16_f32 v88, v40, v41
v_exp_f32 v42, v42
v_mfma_f32_16x16x32_bf16 a[64:67], a[160:163], v[80:83], a[64:67]
v_exp_f32 v43, v43
v_mfma_f32_16x16x32_bf16 a[96:99], a[160:163], v[84:87], a[96:99]
ds_read_b64_tr_b16 a[160:161], v220 offset:24576
ds_read_b64_tr_b16 a[162:163], v220 offset:28672
v_exp_f32 v44, v44
v_mfma_f32_16x16x32_bf16 a[100:103], a[164:167], v[84:87], a[100:103]
v_cvt_pk_bf16_f32 v89, v42, v43
v_exp_f32 v45, v45
v_mfma_f32_16x16x32_bf16 a[68:71], a[164:167], v[80:83], a[68:71]
v_cvt_pk_bf16_f32 v90, v44, v45
v_exp_f32 v46, v46
v_mfma_f32_16x16x32_bf16 a[36:39], a[164:167], v[76:79], a[36:39]
v_exp_f32 v47, v47
v_mfma_f32_16x16x32_bf16 a[4:7], a[164:167], v[72:75], a[4:7]
ds_read_b64_tr_b16 a[164:165], v221 offset:24576
ds_read_b64_tr_b16 a[166:167], v221 offset:28672
v_exp_f32 v48, v48
v_smfmac_f32_16x16x64_bf16 a[248:251], a[208:211], v[72:79], v235
v_cvt_pk_bf16_f32 v91, v46, v47
v_exp_f32 v49, v49
v_mfma_f32_16x16x32_bf16 a[8:11], a[168:171], v[72:75], a[8:11]
v_cvt_pk_bf16_f32 v92, v48, v49
v_exp_f32 v50, v50
v_mfma_f32_16x16x32_bf16 a[40:43], a[168:171], v[76:79], a[40:43]
v_exp_f32 v51, v51
v_mfma_f32_16x16x32_bf16 a[72:75], a[168:171], v[80:83], a[72:75]
v_cvt_pk_bf16_f32 v93, v50, v51
v_exp_f32 v52, v52
v_mfma_f32_16x16x32_bf16 a[104:107], a[168:171], v[84:87], a[104:107]
ds_read_b64_tr_b16 a[168:169], v222 offset:24576
ds_read_b64_tr_b16 a[170:171], v222 offset:28672
v_exp_f32 v53, v53
v_mfma_f32_16x16x32_bf16 a[108:111], a[172:175], v[84:87], a[108:111]
v_cvt_pk_bf16_f32 v94, v52, v53
v_exp_f32 v54, v54
v_mfma_f32_16x16x32_bf16 a[76:79], a[172:175], v[80:83], a[76:79]
v_exp_f32 v55, v55
v_mfma_f32_16x16x32_bf16 a[44:47], a[172:175], v[76:79], a[44:47]
v_exp_f32 v56, v56
v_exp_f32 v57, v57
v_mfma_f32_16x16x32_bf16 a[12:15], a[172:175], v[72:75], a[12:15]
ds_read_b64_tr_b16 a[172:173], v223 offset:24576
ds_read_b64_tr_b16 a[174:175], v223 offset:28672
v_exp_f32 v58, v58
v_mfma_f32_16x16x32_bf16 a[16:19], a[176:179], v[72:75], a[16:19]
v_cvt_pk_bf16_f32 v95, v54, v55
v_cvt_pk_bf16_f32 v96, v56, v57
v_exp_f32 v59, v59
v_mfma_f32_16x16x32_bf16 a[48:51], a[176:179], v[76:79], a[48:51]
v_cvt_pk_bf16_f32 v97, v58, v59
v_exp_f32 v60, v60
v_mfma_f32_16x16x32_bf16 a[80:83], a[176:179], v[80:83], a[80:83]
v_exp_f32 v61, v61
v_mfma_f32_16x16x32_bf16 a[112:115], a[176:179], v[84:87], a[112:115]
ds_read_b64_tr_b16 a[176:177], v224 offset:24576
ds_read_b64_tr_b16 a[178:179], v224 offset:28672
v_exp_f32 v62, v62
v_mfma_f32_16x16x32_bf16 a[116:119], a[180:183], v[84:87], a[116:119]
v_cvt_pk_bf16_f32 v98, v60, v61
v_exp_f32 v63, v63
v_mfma_f32_16x16x32_bf16 a[84:87], a[180:183], v[80:83], a[84:87]
v_cvt_pk_bf16_f32 v99, v62, v63
v_exp_f32 v64, v64
v_mfma_f32_16x16x32_bf16 a[52:55], a[180:183], v[76:79], a[52:55]
v_exp_f32 v65, v65
v_mfma_f32_16x16x32_bf16 a[20:23], a[180:183], v[72:75], a[20:23]
ds_read_b64_tr_b16 a[180:181], v225 offset:24576
ds_read_b64_tr_b16 a[182:183], v225 offset:28672
v_exp_f32 v66, v66
v_smfmac_f32_16x16x64_bf16 a[252:255], a[208:211], v[80:87], v235
v_cvt_pk_bf16_f32 v100, v64, v65
v_exp_f32 v67, v67
v_mfma_f32_16x16x32_bf16 a[24:27], a[184:187], v[72:75], a[24:27]
v_cvt_pk_bf16_f32 v101, v66, v67
v_exp_f32 v68, v68
v_mfma_f32_16x16x32_bf16 a[56:59], a[184:187], v[76:79], a[56:59]
v_exp_f32 v69, v69
v_mfma_f32_16x16x32_bf16 a[88:91], a[184:187], v[80:83], a[88:91]
v_cvt_pk_bf16_f32 v102, v68, v69
v_exp_f32 v70, v70
v_mfma_f32_16x16x32_bf16 a[120:123], a[184:187], v[84:87], a[120:123]
ds_read_b64_tr_b16 a[184:185], v226 offset:24576
ds_read_b64_tr_b16 a[186:187], v226 offset:28672
v_exp_f32 v71, v71
v_mfma_f32_16x16x32_bf16 a[124:127], a[188:191], v[84:87], a[124:127]
v_cvt_pk_bf16_f32 v103, v70, v71
v_mfma_f32_16x16x32_bf16 a[92:95], a[188:191], v[80:83], a[92:95]
v_mfma_f32_16x16x32_bf16 a[60:63], a[188:191], v[76:79], a[60:63]
v_mfma_f32_16x16x32_bf16 a[28:31], a[188:191], v[72:75], a[28:31]
ds_read_b64_tr_b16 a[188:189], v227 offset:24576
ds_read_b64_tr_b16 a[190:191], v227 offset:28672
v_smfmac_f32_16x16x64_bf16 a[248:251], a[208:211], v[88:95], v235
s_lshl_b32 s46, s32, 2
v_and_b32 v138, 3, v1
v_smfmac_f32_16x16x64_bf16 a[252:255], a[208:211], v[96:103], v235
s_add_u32 s46, s46, 77824
v_lshlrev_b32 v138, 10, v138
s_waitcnt lgkmcnt(4)
v_mfma_f32_16x16x32_bf16 a[0:3], a[160:163], v[88:91], a[0:3]
s_add_u32 s47, s3, 77824
v_add_u32 v138, s46, v138
v_mfma_f32_16x16x32_bf16 a[4:7], a[164:167], v[88:91], a[4:7]
v_mov_b32 v139, s47
v_mfma_f32_16x16x32_bf16 a[8:11], a[168:171], v[88:91], a[8:11]
s_nop 0
s_nop 0
v_mfma_f32_16x16x32_bf16 a[12:15], a[172:175], v[88:91], a[12:15]
v_accvgpr_read_b32 v104, a248
v_accvgpr_read_b32 v105, a249
v_mfma_f32_16x16x32_bf16 a[16:19], a[176:179], v[88:91], a[16:19]
v_accvgpr_read_b32 v106, a250
v_accvgpr_read_b32 v107, a251
v_mfma_f32_16x16x32_bf16 a[20:23], a[180:183], v[88:91], a[20:23]
v_accvgpr_read_b32 v108, a252
v_accvgpr_read_b32 v109, a253
s_waitcnt lgkmcnt(2)
v_mfma_f32_16x16x32_bf16 a[24:27], a[184:187], v[88:91], a[24:27]
v_accvgpr_read_b32 v110, a254
v_accvgpr_read_b32 v111, a255
s_waitcnt lgkmcnt(0)
v_mfma_f32_16x16x32_bf16 a[28:31], a[188:191], v[88:91], a[28:31]
v_add_f32 v104, v104, v105
v_add_f32 v106, v106, v107
v_mfma_f32_16x16x32_bf16 a[32:35], a[160:163], v[92:95], a[32:35]
v_add_f32 v108, v108, v109
v_add_f32 v110, v110, v111
v_mfma_f32_16x16x32_bf16 a[36:39], a[164:167], v[92:95], a[36:39]
v_max3_f32 v136, v104, v106, v108
v_add_f32 v137, v104, v106
v_mfma_f32_16x16x32_bf16 a[40:43], a[168:171], v[92:95], a[40:43]
v_max_f32 v136, v136, v110
v_add_f32 v137, v137, v108
v_mfma_f32_16x16x32_bf16 a[44:47], a[172:175], v[92:95], a[44:47]
v_cmp_nge_f32 vcc, 0x5f800000, v136
v_add_f32 v137, v137, v110
v_mfma_f32_16x16x32_bf16 a[48:51], a[176:179], v[92:95], a[48:51]
v_cmp_u_f32 s[94:95], v137, v137
v_mfma_f32_16x16x32_bf16 a[52:55], a[180:183], v[92:95], a[52:55]
v_mfma_f32_16x16x32_bf16 a[56:59], a[184:187], v[92:95], a[56:59]
v_mfma_f32_16x16x32_bf16 a[60:63], a[188:191], v[92:95], a[60:63]
s_or_b64 vcc, vcc, s[94:95]
s_cmp_lg_u64 vcc, 0
s_cselect_b32 s48, 1, 0
v_mov_b32 v136, s48
ds_write_b32 v138, v136
s_cmp_lg_u32 s52, 0
s_cbranch_scc1 K_YRA
K_YRAD:
v_rcp_f32 v104, v104
v_rcp_f32 v106, v106
v_rcp_f32 v108, v108
v_rcp_f32 v110, v110
v_mul_f32 v105, -s97, v104
v_mul_f32 v107, -s97, v106
v_mul_f32 v109, -s97, v108
v_mul_f32 v111, -s97, v110
s_waitcnt vmcnt(0) lgkmcnt(0)
s_barrier
ds_read_b128 v[140:143], v139
v_mfma_f32_16x16x32_bf16 a[64:67], a[160:163], v[96:99], a[64:67]
v_accvgpr_read_b32 v40, a0
v_accvgpr_read_b32 v41, a1
v_mfma_f32_16x16x32_bf16 a[68:71], a[164:167], v[96:99], a[68:71]
v_accvgpr_read_b32 v42, a2
v_accvgpr_read_b32 v43, a3
v_mfma_f32_16x16x32_bf16 a[72:75], a[168:171], v[96:99], a[72:75]
v_accvgpr_read_b32 v44, a4
v_accvgpr_read_b32 v45, a5
v_mfma_f32_16x16x32_bf16 a[76:79], a[172:175], v[96:99], a[76:79]
v_accvgpr_read_b32 v46, a6
v_accvgpr_read_b32 v47, a7
v_mfma_f32_16x16x32_bf16 a[80:83], a[176:179], v[96:99], a[80:83]
v_accvgpr_read_b32 v48, a8
v_accvgpr_read_b32 v49, a9
v_mfma_f32_16x16x32_bf16 a[84:87], a[180:183], v[96:99], a[84:87]
v_accvgpr_read_b32 v50, a10
v_accvgpr_read_b32 v51, a11
v_mfma_f32_16x16x32_bf16 a[88:91], a[184:187], v[96:99], a[88:91]
v_accvgpr_read_b32 v52, a12
v_accvgpr_read_b32 v53, a13
v_mfma_f32_16x16x32_bf16 a[92:95], a[188:191], v[96:99], a[92:95]
v_accvgpr_read_b32 v54, a14
v_accvgpr_read_b32 v55, a15
v_mfma_f32_16x16x32_bf16 a[96:99], a[160:163], v[100:103], a[96:99]
v_accvgpr_read_b32 v56, a16
v_accvgpr_read_b32 v57, a17
v_mfma_f32_16x16x32_bf16 a[100:103], a[164:167], v[100:103], a[100:103]
v_accvgpr_read_b32 v58, a18
v_accvgpr_read_b32 v59, a19
v_mfma_f32_16x16x32_bf16 a[104:107], a[168:171], v[100:103], a[104:107]
v_accvgpr_read_b32 v60, a20
v_accvgpr_read_b32 v61, a21
v_mfma_f32_16x16x32_bf16 a[108:111], a[172:175], v[100:103], a[108:111]
v_accvgpr_read_b32 v62, a22
v_accvgpr_read_b32 v63, a23
v_mfma_f32_16x16x32_bf16 a[112:115], a[176:179], v[100:103], a[112:115]
v_accvgpr_read_b32 v64, a24
v_accvgpr_read_b32 v65, a25
v_mfma_f32_16x16x32_bf16 a[116:119], a[180:183], v[100:103], a[116:119]
v_accvgpr_read_b32 v66, a26
v_accvgpr_read_b32 v67, a27
v_mfma_f32_16x16x32_bf16 a[120:123], a[184:187], v[100:103], a[120:123]
v_accvgpr_read_b32 v68, a28
v_accvgpr_read_b32 v69, a29
v_mfma_f32_16x16x32_bf16 a[124:127], a[188:191], v[100:103], a[124:127]
v_accvgpr_read_b32 v70, a30
v_accvgpr_read_b32 v71, a31
v_pk_fma_f32 v[40:41], v[40:41], v[104:105], v[104:105] op_sel:[0,0,1] op_sel_hi:[1,0,1]
v_pk_fma_f32 v[42:43], v[42:43], v[104:105], v[104:105] op_sel:[0,0,1] op_sel_hi:[1,0,1]
v_pk_fma_f32 v[44:45], v[44:45], v[104:105], v[104:105] op_sel:[0,0,1] op_sel_hi:[1,0,1]
v_pk_fma_f32 v[46:47], v[46:47], v[104:105], v[104:105] op_sel:[0,0,1] op_sel_hi:[1,0,1]
v_cvt_pk_bf16_f32 v8, v40, v41
v_cvt_pk_bf16_f32 v9, v42, v43
v_cvt_pk_bf16_f32 v10, v44, v45
v_cvt_pk_bf16_f32 v11, v46, v47
s_add_u32 s94, s53, 0
buffer_store_dwordx4 v[8:11], v234, s[20:23], s94 offen offset:0 sc0 sc1
v_pk_fma_f32 v[48:49], v[48:49], v[104:105], v[104:105] op_sel:[0,0,1] op_sel_hi:[1,0,1]
v_pk_fma_f32 v[50:51], v[50:51], v[104:105], v[104:105] op_sel:[0,0,1] op_sel_hi:[1,0,1]
v_pk_fma_f32 v[52:53], v[52:53], v[104:105], v[104:105] op_sel:[0,0,1] op_sel_hi:[1,0,1]
v_pk_fma_f32 v[54:55], v[54:55], v[104:105], v[104:105] op_sel:[0,0,1] op_sel_hi:[1,0,1]
v_cvt_pk_bf16_f32 v16, v48, v49
v_cvt_pk_bf16_f32 v17, v50, v51
v_cvt_pk_bf16_f32 v18, v52, v53
v_cvt_pk_bf16_f32 v19, v54, v55
s_add_u32 s94, s53, 0
buffer_store_dwordx4 v[16:19], v234, s[20:23], s94 offen offset:2048 sc0 sc1
v_pk_fma_f32 v[56:57], v[56:57], v[104:105], v[104:105] op_sel:[0,0,1] op_sel_hi:[1,0,1]
v_pk_fma_f32 v[58:59], v[58:59], v[104:105], v[104:105] op_sel:[0,0,1] op_sel_hi:[1,0,1]
v_pk_fma_f32 v[60:61], v[60:61], v[104:105], v[104:105] op_sel:[0,0,1] op_sel_hi:[1,0,1]
v_pk_fma_f32 v[62:63], v[62:63], v[104:105], v[104:105] op_sel:[0,0,1] op_sel_hi:[1,0,1]
v_cvt_pk_bf16_f32 v24, v56, v57
v_cvt_pk_bf16_f32 v25, v58, v59
v_cvt_pk_bf16_f32 v26, v60, v61
v_cvt_pk_bf16_f32 v27, v62, v63
s_add_u32 s94, s53, 4096
buffer_store_dwordx4 v[24:27], v234, s[20:23], s94 offen offset:0 sc0 sc1
v_pk_fma_f32 v[64:65], v[64:65], v[104:105], v[104:105] op_sel:[0,0,1] op_sel_hi:[1,0,1]
v_pk_fma_f32 v[66:67], v[66:67], v[104:105], v[104:105] op_sel:[0,0,1] op_sel_hi:[1,0,1]
v_pk_fma_f32 v[68:69], v[68:69], v[104:105], v[104:105] op_sel:[0,0,1] op_sel_hi:[1,0,1]
v_pk_fma_f32 v[70:71], v[70:71], v[104:105], v[104:105] op_sel:[0,0,1] op_sel_hi:[1,0,1]
v_cvt_pk_bf16_f32 v32, v64, v65
v_cvt_pk_bf16_f32 v33, v66, v67
v_cvt_pk_bf16_f32 v34, v68, v69
v_cvt_pk_bf16_f32 v35, v70, v71
s_add_u32 s94, s53, 4096
buffer_store_dwordx4 v[32:35], v234, s[20:23], s94 offen offset:2048 sc0 sc1
v_accvgpr_read_b32 v72, a32
v_accvgpr_read_b32 v73, a33
v_accvgpr_read_b32 v74, a34
v_accvgpr_read_b32 v75, a35
v_accvgpr_read_b32 v76, a36
v_accvgpr_read_b32 v77, a37
v_accvgpr_read_b32 v78, a38
v_accvgpr_read_b32 v79, a39
v_accvgpr_read_b32 v80, a40
v_accvgpr_read_b32 v81, a41
v_accvgpr_read_b32 v82, a42
v_accvgpr_read_b32 v83, a43
v_accvgpr_read_b32 v84, a44
v_accvgpr_read_b32 v85, a45
v_accvgpr_read_b32 v86, a46
v_accvgpr_read_b32 v87, a47
v_accvgpr_read_b32 v88, a48
v_accvgpr_read_b32 v89, a49
v_accvgpr_read_b32 v90, a50
v_accvgpr_read_b32 v91, a51
v_accvgpr_read_b32 v92, a52
v_accvgpr_read_b32 v93, a53
v_accvgpr_read_b32 v94, a54
v_accvgpr_read_b32 v95, a55
v_accvgpr_read_b32 v96, a56
v_accvgpr_read_b32 v97, a57
v_accvgpr_read_b32 v98, a58
v_accvgpr_read_b32 v99, a59
v_accvgpr_read_b32 v100, a60
v_accvgpr_read_b32 v101, a61
v_accvgpr_read_b32 v102, a62
v_accvgpr_read_b32 v103, a63
v_pk_fma_f32 v[72:73], v[72:73], v[106:107], v[106:107] op_sel:[0,0,1] op_sel_hi:[1,0,1]
v_pk_fma_f32 v[74:75], v[74:75], v[106:107], v[106:107] op_sel:[0,0,1] op_sel_hi:[1,0,1]
v_pk_fma_f32 v[76:77], v[76:77], v[106:107], v[106:107] op_sel:[0,0,1] op_sel_hi:[1,0,1]
v_pk_fma_f32 v[78:79], v[78:79], v[106:107], v[106:107] op_sel:[0,0,1] op_sel_hi:[1,0,1]
v_cvt_pk_bf16_f32 v12, v72, v73
v_cvt_pk_bf16_f32 v13, v74, v75
v_cvt_pk_bf16_f32 v14, v76, v77
v_cvt_pk_bf16_f32 v15, v78, v79
s_add_u32 s94, s53, 0
buffer_store_dwordx4 v[12:15], v234, s[20:23], s94 offen offset:1024 sc0 sc1
v_pk_fma_f32 v[80:81], v[80:81], v[106:107], v[106:107] op_sel:[0,0,1] op_sel_hi:[1,0,1]
v_pk_fma_f32 v[82:83], v[82:83], v[106:107], v[106:107] op_sel:[0,0,1] op_sel_hi:[1,0,1]
v_pk_fma_f32 v[84:85], v[84:85], v[106:107], v[106:107] op_sel:[0,0,1] op_sel_hi:[1,0,1]
v_pk_fma_f32 v[86:87], v[86:87], v[106:107], v[106:107] op_sel:[0,0,1] op_sel_hi:[1,0,1]
v_cvt_pk_bf16_f32 v20, v80, v81
v_cvt_pk_bf16_f32 v21, v82, v83
v_cvt_pk_bf16_f32 v22, v84, v85
v_cvt_pk_bf16_f32 v23, v86, v87
s_add_u32 s94, s53, 0
buffer_store_dwordx4 v[20:23], v234, s[20:23], s94 offen offset:3072 sc0 sc1
v_pk_fma_f32 v[88:89], v[88:89], v[106:107], v[106:107] op_sel:[0,0,1] op_sel_hi:[1,0,1]
v_pk_fma_f32 v[90:91], v[90:91], v[106:107], v[106:107] op_sel:[0,0,1] op_sel_hi:[1,0,1]
v_pk_fma_f32 v[92:93], v[92:93], v[106:107], v[106:107] op_sel:[0,0,1] op_sel_hi:[1,0,1]
v_pk_fma_f32 v[94:95], v[94:95], v[106:107], v[106:107] op_sel:[0,0,1] op_sel_hi:[1,0,1]
v_cvt_pk_bf16_f32 v28, v88, v89
v_cvt_pk_bf16_f32 v29, v90, v91
v_cvt_pk_bf16_f32 v30, v92, v93
v_cvt_pk_bf16_f32 v31, v94, v95
s_add_u32 s94, s53, 4096
buffer_store_dwordx4 v[28:31], v234, s[20:23], s94 offen offset:1024 sc0 sc1
v_pk_fma_f32 v[96:97], v[96:97], v[106:107], v[106:107] op_sel:[0,0,1] op_sel_hi:[1,0,1]
v_pk_fma_f32 v[98:99], v[98:99], v[106:107], v[106:107] op_sel:[0,0,1] op_sel_hi:[1,0,1]
v_pk_fma_f32 v[100:101], v[100:101], v[106:107], v[106:107] op_sel:[0,0,1] op_sel_hi:[1,0,1]
v_pk_fma_f32 v[102:103], v[102:103], v[106:107], v[106:107] op_sel:[0,0,1] op_sel_hi:[1,0,1]
v_cvt_pk_bf16_f32 v36, v96, v97
v_cvt_pk_bf16_f32 v37, v98, v99
v_cvt_pk_bf16_f32 v38, v100, v101
v_cvt_pk_bf16_f32 v39, v102, v103
s_add_u32 s94, s53, 4096
buffer_store_dwordx4 v[36:39], v234, s[20:23], s94 offen offset:3072 sc0 sc1
s_waitcnt lgkmcnt(0)
v_or3_b32 v140, v140, v141, v142
v_or_b32 v140, v140, v143
s_nop 0
v_readfirstlane_b32 s46, v140
s_andn2_b32 s46, s46, s41
s_cbranch_scc1 K_FB
s_cmp_lg_u32 s83, 0
s_cbranch_scc1 K_YR1
K_YR1D:
v_accvgpr_read_b32 v120, a236
v_accvgpr_read_b32 v121, a237
v_accvgpr_read_b32 v122, a238
v_accvgpr_read_b32 v123, a239
v_accvgpr_read_b32 v124, a240
v_accvgpr_read_b32 v125, a241
v_accvgpr_read_b32 v126, a242
v_accvgpr_read_b32 v127, a243
v_accvgpr_read_b32 v128, a244
v_accvgpr_read_b32 v129, a245
v_accvgpr_read_b32 v130, a246
v_accvgpr_read_b32 v131, a247
v_xor_b32 v220, s82, v220
v_xor_b32 v221, s82, v221
v_xor_b32 v222, s82, v222
v_xor_b32 v223, s82, v223
v_xor_b32 v224, s82, v224
v_xor_b32 v225, s82, v225
v_xor_b32 v226, s82, v226
v_xor_b32 v227, s82, v227
v_bfe_u32 v5, v1, 2, 2
v_lshl_add_u32 v5, v4, 2, v5
v_bfe_u32 v6, v5, 1, 2
v_lshlrev_b32 v6, 5, v6
v_lshl_add_u32 v6, v5, 7, v6
v_and_b32 v5, 3, v1
v_lshl_add_u32 v216, v5, 3, v6
v_xor_b32 v217, 32, v216
v_xor_b32 v218, 64, v216
v_xor_b32 v219, 96, v216
ds_read_b64_tr_b16 a[192:193], v220 offset:32768
ds_read_b64_tr_b16 a[194:195], v220 offset:36864
ds_read_b64_tr_b16 a[196:197], v221 offset:32768
ds_read_b64_tr_b16 a[198:199], v221 offset:36864
ds_read_b64_tr_b16 a[200:201], v222 offset:32768
ds_read_b64_tr_b16 a[202:203], v222 offset:36864
ds_read_b64_tr_b16 a[204:205], v223 offset:32768
ds_read_b64_tr_b16 a[206:207], v223 offset:36864
ds_read_b64_tr_b16 a[208:209], v224 offset:32768
ds_read_b64_tr_b16 a[210:211], v224 offset:36864
ds_read_b64_tr_b16 a[212:213], v225 offset:32768
ds_read_b64_tr_b16 a[214:215], v225 offset:36864
ds_read_b64_tr_b16 a[216:217], v226 offset:32768
ds_read_b64_tr_b16 a[218:219], v226 offset:36864
ds_read_b64_tr_b16 a[220:221], v227 offset:32768
ds_read_b64_tr_b16 a[222:223], v227 offset:36864
ds_read_b64_tr_b16 a[224:225], v216 offset:0
ds_read_b64_tr_b16 a[226:227], v216 offset:2048
ds_read_b64_tr_b16 a[228:229], v217 offset:0
ds_read_b64_tr_b16 a[230:231], v217 offset:2048
ds_read_b64_tr_b16 a[232:233], v218 offset:0
ds_read_b64_tr_b16 a[234:235], v218 offset:2048
ds_read_b64_tr_b16 a[236:237], v219 offset:0
ds_read_b64_tr_b16 a[238:239], v219 offset:2048
v_accvgpr_read_b32 v112, a64
v_accvgpr_read_b32 v113, a65
v_accvgpr_read_b32 v114, a66
v_accvgpr_read_b32 v115, a67
v_accvgpr_read_b32 v116, a68
v_accvgpr_read_b32 v117, a69
v_accvgpr_read_b32 v118, a70
v_accvgpr_read_b32 v119, a71
v_pk_fma_f32 v[112:113], v[112:113], v[108:109], v[108:109] op_sel:[0,0,1] op_sel_hi:[1,0,1]
v_pk_fma_f32 v[114:115], v[114:115], v[108:109], v[108:109] op_sel:[0,0,1] op_sel_hi:[1,0,1]
v_pk_fma_f32 v[116:117], v[116:117], v[108:109], v[108:109] op_sel:[0,0,1] op_sel_hi:[1,0,1]
v_pk_fma_f32 v[118:119], v[118:119], v[108:109], v[108:109] op_sel:[0,0,1] op_sel_hi:[1,0,1]
v_cvt_pk_bf16_f32 v40, v112, v113
v_cvt_pk_bf16_f32 v41, v114, v115
v_cvt_pk_bf16_f32 v42, v116, v117
v_cvt_pk_bf16_f32 v43, v118, v119
v_accvgpr_read_b32 v112, a96
v_accvgpr_read_b32 v113, a97
v_accvgpr_read_b32 v114, a98
v_accvgpr_read_b32 v115, a99
v_accvgpr_read_b32 v116, a100
v_accvgpr_read_b32 v117, a101
v_accvgpr_read_b32 v118, a102
v_accvgpr_read_b32 v119, a103
v_pk_fma_f32 v[112:113], v[112:113], v[110:111], v[110:111] op_sel:[0,0,1] op_sel_hi:[1,0,1]
v_pk_fma_f32 v[114:115], v[114:115], v[110:111], v[110:111] op_sel:[0,0,1] op_sel_hi:[1,0,1]
v_pk_fma_f32 v[116:117], v[116:117], v[110:111], v[110:111] op_sel:[0,0,1] op_sel_hi:[1,0,1]
v_pk_fma_f32 v[118:119], v[118:119], v[110:111], v[110:111] op_sel:[0,0,1] op_sel_hi:[1,0,1]
v_cvt_pk_bf16_f32 v44, v112, v113
v_cvt_pk_bf16_f32 v45, v114, v115
v_cvt_pk_bf16_f32 v46, v116, v117
v_cvt_pk_bf16_f32 v47, v118, v119
v_accvgpr_read_b32 v112, a72
v_accvgpr_read_b32 v113, a73
v_accvgpr_read_b32 v114, a74
v_accvgpr_read_b32 v115, a75
v_accvgpr_read_b32 v116, a76
v_accvgpr_read_b32 v117, a77
v_accvgpr_read_b32 v118, a78
v_accvgpr_read_b32 v119, a79
v_pk_fma_f32 v[112:113], v[112:113], v[108:109], v[108:109] op_sel:[0,0,1] op_sel_hi:[1,0,1]
v_pk_fma_f32 v[114:115], v[114:115], v[108:109], v[108:109] op_sel:[0,0,1] op_sel_hi:[1,0,1]
v_pk_fma_f32 v[116:117], v[116:117], v[108:109], v[108:109] op_sel:[0,0,1] op_sel_hi:[1,0,1]
v_pk_fma_f32 v[118:119], v[118:119], v[108:109], v[108:109] op_sel:[0,0,1] op_sel_hi:[1,0,1]
v_cvt_pk_bf16_f32 v48, v112, v113
v_cvt_pk_bf16_f32 v49, v114, v115
v_cvt_pk_bf16_f32 v50, v116, v117
v_cvt_pk_bf16_f32 v51, v118, v119
v_accvgpr_read_b32 v112, a104
v_accvgpr_read_b32 v113, a105
v_accvgpr_read_b32 v114, a106
v_accvgpr_read_b32 v115, a107
v_accvgpr_read_b32 v116, a108
v_accvgpr_read_b32 v117, a109
v_accvgpr_read_b32 v118, a110
v_accvgpr_read_b32 v119, a111
v_pk_fma_f32 v[112:113], v[112:113], v[110:111], v[110:111] op_sel:[0,0,1] op_sel_hi:[1,0,1]
v_pk_fma_f32 v[114:115], v[114:115], v[110:111], v[110:111] op_sel:[0,0,1] op_sel_hi:[1,0,1]
v_pk_fma_f32 v[116:117], v[116:117], v[110:111], v[110:111] op_sel:[0,0,1] op_sel_hi:[1,0,1]
v_pk_fma_f32 v[118:119], v[118:119], v[110:111], v[110:111] op_sel:[0,0,1] op_sel_hi:[1,0,1]
v_cvt_pk_bf16_f32 v52, v112, v113
v_cvt_pk_bf16_f32 v53, v114, v115
v_cvt_pk_bf16_f32 v54, v116, v117
v_cvt_pk_bf16_f32 v55, v118, v119
v_accvgpr_read_b32 v112, a80
v_accvgpr_read_b32 v113, a81
v_accvgpr_read_b32 v114, a82
v_accvgpr_read_b32 v115, a83
v_accvgpr_read_b32 v116, a84
v_accvgpr_read_b32 v117, a85
v_accvgpr_read_b32 v118, a86
v_accvgpr_read_b32 v119, a87
v_pk_fma_f32 v[112:113], v[112:113], v[108:109], v[108:109] op_sel:[0,0,1] op_sel_hi:[1,0,1]
v_pk_fma_f32 v[114:115], v[114:115], v[108:109], v[108:109] op_sel:[0,0,1] op_sel_hi:[1,0,1]
v_pk_fma_f32 v[116:117], v[116:117], v[108:109], v[108:109] op_sel:[0,0,1] op_sel_hi:[1,0,1]
v_pk_fma_f32 v[118:119], v[118:119], v[108:109], v[108:109] op_sel:[0,0,1] op_sel_hi:[1,0,1]
v_cvt_pk_bf16_f32 v56, v112, v113
v_cvt_pk_bf16_f32 v57, v114, v115
v_cvt_pk_bf16_f32 v58, v116, v117
v_cvt_pk_bf16_f32 v59, v118, v119
v_accvgpr_read_b32 v112, a112
v_accvgpr_read_b32 v113, a113
v_accvgpr_read_b32 v114, a114
v_accvgpr_read_b32 v115, a115
v_accvgpr_read_b32 v116, a116
v_accvgpr_read_b32 v117, a117
v_accvgpr_read_b32 v118, a118
v_accvgpr_read_b32 v119, a119
v_pk_fma_f32 v[112:113], v[112:113], v[110:111], v[110:111] op_sel:[0,0,1] op_sel_hi:[1,0,1]
v_pk_fma_f32 v[114:115], v[114:115], v[110:111], v[110:111] op_sel:[0,0,1] op_sel_hi:[1,0,1]
v_pk_fma_f32 v[116:117], v[116:117], v[110:111], v[110:111] op_sel:[0,0,1] op_sel_hi:[1,0,1]
v_pk_fma_f32 v[118:119], v[118:119], v[110:111], v[110:111] op_sel:[0,0,1] op_sel_hi:[1,0,1]
v_cvt_pk_bf16_f32 v60, v112, v113
v_cvt_pk_bf16_f32 v61, v114, v115
v_cvt_pk_bf16_f32 v62, v116, v117
v_cvt_pk_bf16_f32 v63, v118, v119
v_accvgpr_read_b32 v112, a88
v_accvgpr_read_b32 v113, a89
v_accvgpr_read_b32 v114, a90
v_accvgpr_read_b32 v115, a91
v_accvgpr_read_b32 v116, a92
v_accvgpr_read_b32 v117, a93
v_accvgpr_read_b32 v118, a94
v_accvgpr_read_b32 v119, a95
v_pk_fma_f32 v[112:113], v[112:113], v[108:109], v[108:109] op_sel:[0,0,1] op_sel_hi:[1,0,1]
v_pk_fma_f32 v[114:115], v[114:115], v[108:109], v[108:109] op_sel:[0,0,1] op_sel_hi:[1,0,1]
v_pk_fma_f32 v[116:117], v[116:117], v[108:109], v[108:109] op_sel:[0,0,1] op_sel_hi:[1,0,1]
v_pk_fma_f32 v[118:119], v[118:119], v[108:109], v[108:109] op_sel:[0,0,1] op_sel_hi:[1,0,1]
v_cvt_pk_bf16_f32 v64, v112, v113
v_cvt_pk_bf16_f32 v65, v114, v115
v_cvt_pk_bf16_f32 v66, v116, v117
v_cvt_pk_bf16_f32 v67, v118, v119
v_accvgpr_read_b32 v112, a120
v_accvgpr_read_b32 v113, a121
v_accvgpr_read_b32 v114, a122
v_accvgpr_read_b32 v115, a123
v_accvgpr_read_b32 v116, a124
v_accvgpr_read_b32 v117, a125
v_accvgpr_read_b32 v118, a126
v_accvgpr_read_b32 v119, a127
v_pk_fma_f32 v[112:113], v[112:113], v[110:111], v[110:111] op_sel:[0,0,1] op_sel_hi:[1,0,1]
v_pk_fma_f32 v[114:115], v[114:115], v[110:111], v[110:111] op_sel:[0,0,1] op_sel_hi:[1,0,1]
v_pk_fma_f32 v[116:117], v[116:117], v[110:111], v[110:111] op_sel:[0,0,1] op_sel_hi:[1,0,1]
v_pk_fma_f32 v[118:119], v[118:119], v[110:111], v[110:111] op_sel:[0,0,1] op_sel_hi:[1,0,1]
v_cvt_pk_bf16_f32 v68, v112, v113
v_cvt_pk_bf16_f32 v69, v114, v115
v_cvt_pk_bf16_f32 v70, v116, v117
v_cvt_pk_bf16_f32 v71, v118, v119
s_lshl_b32 s95, s36, 3
v_mov_b32 v5, 1
v_and_b32 v6, 7, v1
s_add_u32 s95, s95, s54
v_lshlrev_b32 v6, 2, v6
v_lshlrev_b32 v250, 3, v1
s_waitcnt lgkmcnt(15)
v_mfma_f32_16x16x32_bf16 v[136:139], a[192:195], v[8:11], 0
s_add_u32 s67, s36, 1
v_add_u32 v208, 0x10000, v220
v_add_u32 v209, 0x10000, v221
v_mfma_f32_16x16x32_bf16 v[168:171], a[192:195], v[12:15], 0
s_and_b32 s67, s67, 3
ds_read_b64_tr_b16 a[192:193], v220 offset:40960
ds_read_b64_tr_b16 a[194:195], v220 offset:45056
v_mfma_f32_16x16x32_bf16 v[140:143], a[196:199], v[8:11], 0
s_sub_u32 s67, s67, s36
v_add_u32 v210, 0x10000, v222
v_add_u32 v211, 0x10000, v223
v_mfma_f32_16x16x32_bf16 v[172:175], a[196:199], v[12:15], 0
s_lshl_b32 s67, s67, 16
ds_read_b64_tr_b16 a[196:197], v221 offset:40960
ds_read_b64_tr_b16 a[198:199], v221 offset:45056
v_mfma_f32_16x16x32_bf16 v[144:147], a[200:203], v[8:11], 0
s_add_u32 s90, s53, s67
v_add_u32 v212, 0x10000, v224
v_add_u32 v213, 0x10000, v225
v_mfma_f32_16x16x32_bf16 v[176:179], a[200:203], v[12:15], 0
s_add_u32 s67, s36, 2
ds_read_b64_tr_b16 a[200:201], v222 offset:40960
ds_read_b64_tr_b16 a[202:203], v222 offset:45056
v_mfma_f32_16x16x32_bf16 v[148:151], a[204:207], v[8:11], 0
s_add_u32 m0, s3, 77824
v_add_u32 v214, 0x10000, v226
v_add_u32 v215, 0x10000, v227
v_mfma_f32_16x16x32_bf16 v[180:183], a[204:207], v[12:15], 0
s_waitcnt lgkmcnt(15)
s_add_u32 s48, s43, 55296
ds_read_b64_tr_b16 a[204:205], v223 offset:40960
ds_read_b64_tr_b16 a[206:207], v223 offset:45056
v_mfma_f32_16x16x32_bf16 v[152:155], a[208:211], v[8:11], 0
s_and_b32 s67, s67, 3
buffer_load_dwordx4 v236, s[16:19], s48 offen lds
v_mfma_f32_16x16x32_bf16 v[184:187], a[208:211], v[12:15], 0
s_sub_u32 s67, s67, s36
ds_read_b64_tr_b16 a[208:209], v224 offset:40960
ds_read_b64_tr_b16 a[210:211], v224 offset:45056
v_mfma_f32_16x16x32_bf16 v[156:159], a[212:215], v[8:11], 0
s_add_u32 m0, s3, 81920
v_subrev_u32 v200, 0x10000, v220
v_subrev_u32 v201, 0x10000, v221
v_mfma_f32_16x16x32_bf16 v[188:191], a[212:215], v[12:15], 0
s_add_u32 s48, s43, 73728
ds_read_b64_tr_b16 a[212:213], v225 offset:40960
ds_read_b64_tr_b16 a[214:215], v225 offset:45056
v_mfma_f32_16x16x32_bf16 v[160:163], a[216:219], v[8:11], 0
s_lshl_b32 s67, s67, 16
buffer_load_dwordx4 v236, s[16:19], s48 offen lds
v_mfma_f32_16x16x32_bf16 v[192:195], a[216:219], v[12:15], 0
s_waitcnt lgkmcnt(8)
s_add_u32 s91, s53, s67
ds_read_b64_tr_b16 a[216:217], v226 offset:40960
ds_read_b64_tr_b16 a[218:219], v226 offset:45056
v_mfma_f32_16x16x32_bf16 v[164:167], a[220:223], v[8:11], 0
s_add_u32 m0, s3, 86016
v_subrev_u32 v202, 0x10000, v222
v_subrev_u32 v203, 0x10000, v223
v_mfma_f32_16x16x32_bf16 v[196:199], a[220:223], v[12:15], 0
s_add_u32 s48, s43, 92160
ds_read_b64_tr_b16 a[220:221], v227 offset:40960
ds_read_b64_tr_b16 a[222:223], v227 offset:45056
v_mfma_f32_16x16x32_bf16 v[72:75], a[224:227], v[8:11], 0
s_add_u32 s67, s36, 3
buffer_load_dwordx4 v236, s[16:19], s48 offen lds
v_mfma_f32_16x16x32_bf16 v[88:91], a[224:227], v[12:15], 0
s_and_b32 s67, s67, 3
ds_read_b64_tr_b16 a[224:225], v216 offset:4096
ds_read_b64_tr_b16 a[226:227], v216 offset:6144
v_mfma_f32_16x16x32_bf16 v[76:79], a[228:231], v[8:11], 0
s_add_u32 m0, s3, 90112
v_subrev_u32 v204, 0x10000, v224
v_subrev_u32 v205, 0x10000, v225
v_mfma_f32_16x16x32_bf16 v[92:95], a[228:231], v[12:15], 0
s_add_u32 s48, s43, 110592
ds_read_b64_tr_b16 a[228:229], v217 offset:4096
ds_read_b64_tr_b16 a[230:231], v217 offset:6144
v_mfma_f32_16x16x32_bf16 v[80:83], a[232:235], v[8:11], 0
s_sub_u32 s67, s67, s36
buffer_load_dwordx4 v236, s[16:19], s48 offen lds
v_mfma_f32_16x16x32_bf16 v[96:99], a[232:235], v[12:15], 0
ds_read_b64_tr_b16 a[232:233], v218 offset:4096
ds_read_b64_tr_b16 a[234:235], v218 offset:6144
v_mfma_f32_16x16x32_bf16 v[84:87], a[236:239], v[8:11], 0
v_subrev_u32 v206, 0x10000, v226
v_mfma_f32_16x16x32_bf16 v[100:103], a[236:239], v[12:15], 0
ds_read_b64_tr_b16 a[236:237], v219 offset:4096
ds_read_b64_tr_b16 a[238:239], v219 offset:6144
s_waitcnt vmcnt(4)
s_mov_b64 exec, 1
buffer_store_dword v5, v234, s[20:23], s95 offen offset:0 sc0 sc1
s_mov_b64 exec, -1
v_mfma_f32_16x16x32_bf16 v[136:139], a[192:195], v[16:19], v[136:139]
s_add_u32 m0, s3, 94208
v_subrev_u32 v207, 0x10000, v227
v_mfma_f32_16x16x32_bf16 v[168:171], a[192:195], v[20:23], v[168:171]
s_add_u32 s48, s43, 129024
ds_read_b64_tr_b16 a[192:193], v220 offset:49152
ds_read_b64_tr_b16 a[194:195], v220 offset:53248
v_mfma_f32_16x16x32_bf16 v[140:143], a[196:199], v[16:19], v[140:143]
s_lshl_b32 s67, s67, 16
buffer_load_dwordx4 v236, s[16:19], s48 offen lds
v_mfma_f32_16x16x32_bf16 v[172:175], a[196:199], v[20:23], v[172:175]
s_waitcnt lgkmcnt(8)
s_add_u32 s92, s53, s67
ds_read_b64_tr_b16 a[196:197], v221 offset:49152
ds_read_b64_tr_b16 a[198:199], v221 offset:53248
v_mfma_f32_16x16x32_bf16 v[144:147], a[200:203], v[16:19], v[144:147]
s_lshl_b32 s67, s34, 2
v_mfma_f32_16x16x32_bf16 v[176:179], a[200:203], v[20:23], v[176:179]
s_add_u32 s94, s53, 8192
ds_read_b64_tr_b16 a[200:201], v222 offset:49152
ds_read_b64_tr_b16 a[202:203], v222 offset:53248
v_mfma_f32_16x16x32_bf16 v[148:151], a[204:207], v[16:19], v[148:151]
s_add_u32 s67, s67, s32
buffer_store_dwordx4 v[40:43], v234, s[20:23], s94 offen offset:0 sc0 sc1
v_mfma_f32_16x16x32_bf16 v[180:183], a[204:207], v[20:23], v[180:183]
s_lshl_b32 s86, s67, 7
ds_read_b64_tr_b16 a[204:205], v223 offset:49152
ds_read_b64_tr_b16 a[206:207], v223 offset:53248
v_mfma_f32_16x16x32_bf16 v[152:155], a[208:211], v[16:19], v[152:155]
s_add_u32 s86, s86, 0x260000
v_mfma_f32_16x16x32_bf16 v[184:187], a[208:211], v[20:23], v[184:187]
s_lshl_b32 s67, s67, 1
ds_read_b64_tr_b16 a[208:209], v224 offset:49152
ds_read_b64_tr_b16 a[210:211], v224 offset:53248
v_mfma_f32_16x16x32_bf16 v[156:159], a[212:215], v[16:19], v[156:159]
s_lshr_b32 s47, s35, 1
v_mfma_f32_16x16x32_bf16 v[188:191], a[212:215], v[20:23], v[188:191]
s_add_u32 s67, s67, s47
ds_read_b64_tr_b16 a[212:213], v225 offset:49152
ds_read_b64_tr_b16 a[214:215], v225 offset:53248
v_mfma_f32_16x16x32_bf16 v[160:163], a[216:219], v[16:19], v[160:163]
s_lshl_b32 s87, s67, 15
v_mfma_f32_16x16x32_bf16 v[192:195], a[216:219], v[20:23], v[192:195]
s_add_u32 s87, s87, 0x2000000
ds_read_b64_tr_b16 a[216:217], v226 offset:49152
ds_read_b64_tr_b16 a[218:219], v226 offset:53248
v_mfma_f32_16x16x32_bf16 v[164:167], a[220:223], v[16:19], v[164:167]
s_lshl_b32 s67, s33, 9
v_mfma_f32_16x16x32_bf16 v[196:199], a[220:223], v[20:23], v[196:199]
s_add_u32 s88, s87, s67
ds_read_b64_tr_b16 a[220:221], v227 offset:49152
ds_read_b64_tr_b16 a[222:223], v227 offset:53248
v_mfma_f32_16x16x32_bf16 v[72:75], a[224:227], v[16:19], v[72:75]
s_xor_b32 s89, s88, 0x8000
v_mfma_f32_16x16x32_bf16 v[88:91], a[224:227], v[20:23], v[88:91]
s_waitcnt lgkmcnt(8)
s_add_u32 s94, s53, 8192
ds_read_b64_tr_b16 a[224:225], v216 offset:8192
ds_read_b64_tr_b16 a[226:227], v216 offset:10240
v_mfma_f32_16x16x32_bf16 v[76:79], a[228:231], v[16:19], v[76:79]
s_lshl_b32 s47, s34, 2
buffer_store_dwordx4 v[44:47], v234, s[20:23], s94 offen offset:1024 sc0 sc1
v_mfma_f32_16x16x32_bf16 v[92:95], a[228:231], v[20:23], v[92:95]
s_add_u32 s47, s47, s36
ds_read_b64_tr_b16 a[228:229], v217 offset:8192
ds_read_b64_tr_b16 a[230:231], v217 offset:10240
v_mfma_f32_16x16x32_bf16 v[80:83], a[232:235], v[16:19], v[80:83]
s_lshl_b32 s63, s47, 2
v_mfma_f32_16x16x32_bf16 v[96:99], a[232:235], v[20:23], v[96:99]
ds_read_b64_tr_b16 a[232:233], v218 offset:8192
ds_read_b64_tr_b16 a[234:235], v218 offset:10240
v_mfma_f32_16x16x32_bf16 v[84:87], a[236:239], v[16:19], v[84:87]
v_mfma_f32_16x16x32_bf16 v[100:103], a[236:239], v[20:23], v[100:103]
ds_read_b64_tr_b16 a[236:237], v219 offset:8192
ds_read_b64_tr_b16 a[238:239], v219 offset:10240
v_mfma_f32_16x16x32_bf16 v[136:139], a[192:195], v[24:27], v[136:139]
s_add_u32 s63, s63, s32
v_mfma_f32_16x16x32_bf16 v[168:171], a[192:195], v[28:31], v[168:171]
s_lshl_b32 s63, s63, 9
ds_read_b64_tr_b16 a[192:193], v220 offset:57344
ds_read_b64_tr_b16 a[194:195], v220 offset:61440
v_mfma_f32_16x16x32_bf16 v[140:143], a[196:199], v[24:27], v[140:143]
s_add_u32 s63, s63, 0x280000
v_mfma_f32_16x16x32_bf16 v[172:175], a[196:199], v[28:31], v[172:175]
s_lshl_b32 s47, s47, 6
ds_read_b64_tr_b16 a[196:197], v221 offset:57344
ds_read_b64_tr_b16 a[198:199], v221 offset:61440
v_mfma_f32_16x16x32_bf16 v[144:147], a[200:203], v[24:27], v[144:147]
s_add_u32 s47, s47, s32
v_mfma_f32_16x16x32_bf16 v[176:179], a[200:203], v[28:31], v[176:179]
s_add_u32 s94, s53, 8192
ds_read_b64_tr_b16 a[200:201], v222 offset:57344
ds_read_b64_tr_b16 a[202:203], v222 offset:61440
v_mfma_f32_16x16x32_bf16 v[148:151], a[204:207], v[24:27], v[148:151]
s_lshl_b32 s47, s47, 11
buffer_store_dwordx4 v[48:51], v234, s[20:23], s94 offen offset:2048 sc0 sc1
v_mfma_f32_16x16x32_bf16 v[180:183], a[204:207], v[28:31], v[180:183]
s_waitcnt lgkmcnt(8)
s_mul_i32 s67, s35, 40960
ds_read_b64_tr_b16 a[204:205], v223 offset:57344
ds_read_b64_tr_b16 a[206:207], v223 offset:61440
v_mfma_f32_16x16x32_bf16 v[152:155], a[208:211], v[24:27], v[152:155]
s_add_u32 s67, s67, s47
v_mfma_f32_16x16x32_bf16 v[184:187], a[208:211], v[28:31], v[184:187]
s_add_u32 s67, s67, 0x1400000
ds_read_b64_tr_b16 a[208:209], v224 offset:57344
ds_read_b64_tr_b16 a[210:211], v224 offset:61440
v_mfma_f32_16x16x32_bf16 v[156:159], a[212:215], v[24:27], v[156:159]
s_mov_b32 s57, 0xbfb8aa3b
v_mfma_f32_16x16x32_bf16 v[188:191], a[212:215], v[28:31], v[188:191]
s_mov_b32 s56, 0xffff0000
ds_read_b64_tr_b16 a[212:213], v225 offset:57344
ds_read_b64_tr_b16 a[214:215], v225 offset:61440
v_mfma_f32_16x16x32_bf16 v[160:163], a[216:219], v[24:27], v[160:163]
s_mov_b32 s58, 0x00003f80
v_mfma_f32_16x16x32_bf16 v[192:195], a[216:219], v[28:31], v[192:195]
s_mov_b32 s59, 0x3f800000
ds_read_b64_tr_b16 a[216:217], v226 offset:57344
ds_read_b64_tr_b16 a[218:219], v226 offset:61440
v_mfma_f32_16x16x32_bf16 v[164:167], a[220:223], v[24:27], v[164:167]
s_lshl_b32 s47, s36, 13
v_mfma_f32_16x16x32_bf16 v[196:199], a[220:223], v[28:31], v[196:199]
s_add_u32 s87, s87, s47
ds_read_b64_tr_b16 a[220:221], v227 offset:57344
ds_read_b64_tr_b16 a[222:223], v227 offset:61440
v_mfma_f32_16x16x32_bf16 v[72:75], a[224:227], v[24:27], v[72:75]
s_mov_b32 s38, 15
v_mfma_f32_16x16x32_bf16 v[88:91], a[224:227], v[28:31], v[88:91]
s_add_u32 s94, s53, 8192
ds_read_b64_tr_b16 a[224:225], v216 offset:12288
ds_read_b64_tr_b16 a[226:227], v216 offset:14336
v_mfma_f32_16x16x32_bf16 v[76:79], a[228:231], v[24:27], v[76:79]
s_bitset0_b32 s38, s35
buffer_store_dwordx4 v[52:55], v234, s[20:23], s94 offen offset:3072 sc0 sc1
v_mfma_f32_16x16x32_bf16 v[92:95], a[228:231], v[28:31], v[92:95]
s_xor_b32 s60, s67, 8192
ds_read_b64_tr_b16 a[228:229], v217 offset:12288
ds_read_b64_tr_b16 a[230:231], v217 offset:14336
v_mfma_f32_16x16x32_bf16 v[80:83], a[232:235], v[24:27], v[80:83]
s_xor_b32 s64, s67, 32768
v_mfma_f32_16x16x32_bf16 v[96:99], a[232:235], v[28:31], v[96:99]
s_waitcnt lgkmcnt(8)
ds_read_b64_tr_b16 a[232:233], v218 offset:12288
ds_read_b64_tr_b16 a[234:235], v218 offset:14336
v_mfma_f32_16x16x32_bf16 v[84:87], a[236:239], v[24:27], v[84:87]
v_mfma_f32_16x16x32_bf16 v[100:103], a[236:239], v[28:31], v[100:103]
ds_read_b64_tr_b16 a[236:237], v219 offset:12288
ds_read_b64_tr_b16 a[238:239], v219 offset:14336
v_mfma_f32_16x16x32_bf16 v[136:139], a[192:195], v[32:35], v[136:139]
v_mfma_f32_16x16x32_bf16 v[168:171], a[192:195], v[36:39], v[168:171]
v_mfma_f32_16x16x32_bf16 v[140:143], a[196:199], v[32:35], v[140:143]
v_mfma_f32_16x16x32_bf16 v[172:175], a[196:199], v[36:39], v[172:175]
v_mfma_f32_16x16x32_bf16 v[144:147], a[200:203], v[32:35], v[144:147]
s_waitcnt lgkmcnt(0)
s_barrier
v_mfma_f32_16x16x32_bf16 v[176:179], a[200:203], v[36:39], v[176:179]
s_xor_b32 s61, s67, 16384
ds_read_b64_tr_b16 a[192:193], v208 offset:0
ds_read_b64_tr_b16 a[194:195], v208 offset:4096
v_mfma_f32_16x16x32_bf16 v[148:151], a[204:207], v[32:35], v[148:151]
s_add_u32 s94, s53, 12288
ds_read_b64_tr_b16 a[196:197], v209 offset:0
ds_read_b64_tr_b16 a[198:199], v209 offset:4096
v_mfma_f32_16x16x32_bf16 v[180:183], a[204:207], v[36:39], v[180:183]
s_xor_b32 s65, s67, 65536
buffer_store_dwordx4 v[56:59], v234, s[20:23], s94 offen offset:0 sc0 sc1
v_mfma_f32_16x16x32_bf16 v[152:155], a[208:211], v[32:35], v[152:155]
s_xor_b32 s62, s67, 24576
ds_read_b64_tr_b16 a[200:201], v210 offset:0
ds_read_b64_tr_b16 a[202:203], v210 offset:4096
v_mfma_f32_16x16x32_bf16 v[184:187], a[208:211], v[36:39], v[184:187]
s_xor_b32 s66, s67, 98304
ds_read_b64_tr_b16 a[204:205], v211 offset:0
ds_read_b64_tr_b16 a[206:207], v211 offset:4096
v_mfma_f32_16x16x32_bf16 v[156:159], a[212:215], v[32:35], v[156:159]
ds_read_b64_tr_b16 a[208:209], v212 offset:0
ds_read_b64_tr_b16 a[210:211], v212 offset:4096
v_mfma_f32_16x16x32_bf16 v[188:191], a[212:215], v[36:39], v[188:191]
ds_read_b64_tr_b16 a[212:213], v213 offset:0
ds_read_b64_tr_b16 a[214:215], v213 offset:4096
v_mfma_f32_16x16x32_bf16 v[160:163], a[216:219], v[32:35], v[160:163]
v_mfma_f32_16x16x32_bf16 v[192:195], a[216:219], v[36:39], v[192:195]
ds_read_b64_tr_b16 a[216:217], v214 offset:0
ds_read_b64_tr_b16 a[218:219], v214 offset:4096
v_mfma_f32_16x16x32_bf16 v[164:167], a[220:223], v[32:35], v[164:167]
v_mfma_f32_16x16x32_bf16 v[196:199], a[220:223], v[36:39], v[196:199]
ds_read_b64_tr_b16 a[220:221], v215 offset:0
ds_read_b64_tr_b16 a[222:223], v215 offset:4096
v_mfma_f32_16x16x32_bf16 v[72:75], a[224:227], v[32:35], v[72:75]
v_mfma_f32_16x16x32_bf16 v[88:91], a[224:227], v[36:39], v[88:91]
ds_read_b64_tr_b16 a[224:225], v216 offset:16384
ds_read_b64_tr_b16 a[226:227], v216 offset:18432
v_mfma_f32_16x16x32_bf16 v[76:79], a[228:231], v[32:35], v[76:79]
s_add_u32 s94, s53, 12288
v_mfma_f32_16x16x32_bf16 v[92:95], a[228:231], v[36:39], v[92:95]
buffer_store_dwordx4 v[60:63], v234, s[20:23], s94 offen offset:1024 sc0 sc1
v_mfma_f32_16x16x32_bf16 v[80:83], a[232:235], v[32:35], v[80:83]
ds_read_b64_tr_b16 a[228:229], v217 offset:16384
ds_read_b64_tr_b16 a[230:231], v217 offset:18432
v_mfma_f32_16x16x32_bf16 v[96:99], a[232:235], v[36:39], v[96:99]
ds_read_b64_tr_b16 a[232:233], v218 offset:16384
ds_read_b64_tr_b16 a[234:235], v218 offset:18432
v_mfma_f32_16x16x32_bf16 v[84:87], a[236:239], v[32:35], v[84:87]
v_mfma_f32_16x16x32_bf16 v[100:103], a[236:239], v[36:39], v[100:103]
s_waitcnt lgkmcnt(8)
ds_read_b64_tr_b16 a[236:237], v219 offset:16384
ds_read_b64_tr_b16 a[238:239], v219 offset:18432
buffer_load_dword v246, v6, s[20:23], s54 offen sc0 sc1
v_mfma_f32_16x16x32_bf16 v[136:139], a[192:195], v[40:43], v[136:139]
v_mfma_f32_16x16x32_bf16 v[168:171], a[192:195], v[44:47], v[168:171]
ds_read_b64_tr_b16 a[192:193], v208 offset:8192
ds_read_b64_tr_b16 a[194:195], v208 offset:12288
v_mfma_f32_16x16x32_bf16 v[140:143], a[196:199], v[40:43], v[140:143]
v_mfma_f32_16x16x32_bf16 v[172:175], a[196:199], v[44:47], v[172:175]
ds_read_b64_tr_b16 a[196:197], v209 offset:8192
ds_read_b64_tr_b16 a[198:199], v209 offset:12288
v_mfma_f32_16x16x32_bf16 v[144:147], a[200:203], v[40:43], v[144:147]
v_mfma_f32_16x16x32_bf16 v[176:179], a[200:203], v[44:47], v[176:179]
ds_read_b64_tr_b16 a[200:201], v210 offset:8192
ds_read_b64_tr_b16 a[202:203], v210 offset:12288
v_mfma_f32_16x16x32_bf16 v[148:151], a[204:207], v[40:43], v[148:151]
s_add_u32 s94, s53, 12288
v_mfma_f32_16x16x32_bf16 v[180:183], a[204:207], v[44:47], v[180:183]
buffer_store_dwordx4 v[64:67], v234, s[20:23], s94 offen offset:2048 sc0 sc1
v_mfma_f32_16x16x32_bf16 v[152:155], a[208:211], v[40:43], v[152:155]
ds_read_b64_tr_b16 a[204:205], v211 offset:8192
ds_read_b64_tr_b16 a[206:207], v211 offset:12288
v_mfma_f32_16x16x32_bf16 v[184:187], a[208:211], v[44:47], v[184:187]
ds_read_b64_tr_b16 a[208:209], v212 offset:8192
ds_read_b64_tr_b16 a[210:211], v212 offset:12288
v_mfma_f32_16x16x32_bf16 v[156:159], a[212:215], v[40:43], v[156:159]
v_mfma_f32_16x16x32_bf16 v[188:191], a[212:215], v[44:47], v[188:191]
ds_read_b64_tr_b16 a[212:213], v213 offset:8192
ds_read_b64_tr_b16 a[214:215], v213 offset:12288
v_mfma_f32_16x16x32_bf16 v[160:163], a[216:219], v[40:43], v[160:163]
v_mfma_f32_16x16x32_bf16 v[192:195], a[216:219], v[44:47], v[192:195]
s_waitcnt lgkmcnt(8)
ds_read_b64_tr_b16 a[216:217], v214 offset:8192
ds_read_b64_tr_b16 a[218:219], v214 offset:12288
v_mfma_f32_16x16x32_bf16 v[164:167], a[220:223], v[40:43], v[164:167]
v_mfma_f32_16x16x32_bf16 v[196:199], a[220:223], v[44:47], v[196:199]
ds_read_b64_tr_b16 a[220:221], v215 offset:8192
ds_read_b64_tr_b16 a[222:223], v215 offset:12288
v_mfma_f32_16x16x32_bf16 v[72:75], a[224:227], v[40:43], v[72:75]
v_mfma_f32_16x16x32_bf16 v[88:91], a[224:227], v[44:47], v[88:91]
ds_read_b64_tr_b16 a[224:225], v216 offset:20480
ds_read_b64_tr_b16 a[226:227], v216 offset:22528
v_mfma_f32_16x16x32_bf16 v[76:79], a[228:231], v[40:43], v[76:79]
s_add_u32 s94, s53, 12288
v_mfma_f32_16x16x32_bf16 v[92:95], a[228:231], v[44:47], v[92:95]
buffer_store_dwordx4 v[68:71], v234, s[20:23], s94 offen offset:3072 sc0 sc1
v_mfma_f32_16x16x32_bf16 v[80:83], a[232:235], v[40:43], v[80:83]
ds_read_b64_tr_b16 a[228:229], v217 offset:20480
ds_read_b64_tr_b16 a[230:231], v217 offset:22528
v_mfma_f32_16x16x32_bf16 v[96:99], a[232:235], v[44:47], v[96:99]
ds_read_b64_tr_b16 a[232:233], v218 offset:20480
ds_read_b64_tr_b16 a[234:235], v218 offset:22528
v_mfma_f32_16x16x32_bf16 v[84:87], a[236:239], v[40:43], v[84:87]
v_mfma_f32_16x16x32_bf16 v[100:103], a[236:239], v[44:47], v[100:103]
ds_read_b64_tr_b16 a[236:237], v219 offset:20480
ds_read_b64_tr_b16 a[238:239], v219 offset:22528
v_mfma_f32_16x16x32_bf16 v[136:139], a[192:195], v[48:51], v[136:139]
v_mfma_f32_16x16x32_bf16 v[168:171], a[192:195], v[52:55], v[168:171]
ds_read_b64_tr_b16 a[192:193], v208 offset:16384
ds_read_b64_tr_b16 a[194:195], v208 offset:20480
v_mfma_f32_16x16x32_bf16 v[140:143], a[196:199], v[48:51], v[140:143]
v_mfma_f32_16x16x32_bf16 v[172:175], a[196:199], v[52:55], v[172:175]
s_waitcnt lgkmcnt(8)
ds_read_b64_tr_b16 a[196:197], v209 offset:16384
ds_read_b64_tr_b16 a[198:199], v209 offset:20480
v_mfma_f32_16x16x32_bf16 v[144:147], a[200:203], v[48:51], v[144:147]
v_mfma_f32_16x16x32_bf16 v[176:179], a[200:203], v[52:55], v[176:179]
s_add_u32 m0, s3, 98304
ds_read_b64_tr_b16 a[200:201], v210 offset:16384
ds_read_b64_tr_b16 a[202:203], v210 offset:20480
v_mfma_f32_16x16x32_bf16 v[148:151], a[204:207], v[48:51], v[148:151]
s_add_u32 s48, s44, 0
v_mfma_f32_16x16x32_bf16 v[180:183], a[204:207], v[52:55], v[180:183]
buffer_load_dwordx4 v236, s[16:19], s48 offen lds
v_mfma_f32_16x16x32_bf16 v[152:155], a[208:211], v[48:51], v[152:155]
ds_read_b64_tr_b16 a[204:205], v211 offset:16384
ds_read_b64_tr_b16 a[206:207], v211 offset:20480
v_mfma_f32_16x16x32_bf16 v[184:187], a[208:211], v[52:55], v[184:187]
s_add_u32 m0, s3, 102400
ds_read_b64_tr_b16 a[208:209], v212 offset:16384
ds_read_b64_tr_b16 a[210:211], v212 offset:20480
v_mfma_f32_16x16x32_bf16 v[156:159], a[212:215], v[48:51], v[156:159]
s_add_u32 s48, s44, 18432
v_mfma_f32_16x16x32_bf16 v[188:191], a[212:215], v[52:55], v[188:191]
buffer_load_dwordx4 v236, s[16:19], s48 offen lds
v_mfma_f32_16x16x32_bf16 v[160:163], a[216:219], v[48:51], v[160:163]
ds_read_b64_tr_b16 a[212:213], v213 offset:16384
ds_read_b64_tr_b16 a[214:215], v213 offset:20480
v_mfma_f32_16x16x32_bf16 v[192:195], a[216:219], v[52:55], v[192:195]
s_add_u32 m0, s3, 106496
ds_read_b64_tr_b16 a[216:217], v214 offset:16384
ds_read_b64_tr_b16 a[218:219], v214 offset:20480
v_mfma_f32_16x16x32_bf16 v[164:167], a[220:223], v[48:51], v[164:167]
s_add_u32 s48, s44, 36864
v_mfma_f32_16x16x32_bf16 v[196:199], a[220:223], v[52:55], v[196:199]
buffer_load_dwordx4 v236, s[16:19], s48 offen lds
v_mfma_f32_16x16x32_bf16 v[72:75], a[224:227], v[48:51], v[72:75]
s_waitcnt lgkmcnt(8)
ds_read_b64_tr_b16 a[220:221], v215 offset:16384
ds_read_b64_tr_b16 a[222:223], v215 offset:20480
v_mfma_f32_16x16x32_bf16 v[88:91], a[224:227], v[52:55], v[88:91]
s_add_u32 m0, s3, 110592
ds_read_b64_tr_b16 a[224:225], v216 offset:24576
ds_read_b64_tr_b16 a[226:227], v216 offset:26624
v_mfma_f32_16x16x32_bf16 v[76:79], a[228:231], v[48:51], v[76:79]
s_add_u32 s48, s44, 55296
v_mfma_f32_16x16x32_bf16 v[92:95], a[228:231], v[52:55], v[92:95]
buffer_load_dwordx4 v236, s[16:19], s48 offen lds
v_mfma_f32_16x16x32_bf16 v[80:83], a[232:235], v[48:51], v[80:83]
ds_read_b64_tr_b16 a[228:229], v217 offset:24576
ds_read_b64_tr_b16 a[230:231], v217 offset:26624
v_mfma_f32_16x16x32_bf16 v[96:99], a[232:235], v[52:55], v[96:99]
ds_read_b64_tr_b16 a[232:233], v218 offset:24576
ds_read_b64_tr_b16 a[234:235], v218 offset:26624
v_mfma_f32_16x16x32_bf16 v[84:87], a[236:239], v[48:51], v[84:87]
v_mfma_f32_16x16x32_bf16 v[100:103], a[236:239], v[52:55], v[100:103]
ds_read_b64_tr_b16 a[236:237], v219 offset:24576
ds_read_b64_tr_b16 a[238:239], v219 offset:26624
v_rcp_f32 v132, v131
s_waitcnt vmcnt(6)
v_cmp_ne_u32 vcc, 1, v246
s_and_b32 s46, vcc_lo, 85
s_cbranch_scc0 K_F0_OK
K_F0:
s_sleep 1
s_add_u32 s100, s100, 1
s_bitcmp1_b32 s100, 19
s_cbranch_scc1 K_END
buffer_load_dword v246, v6, s[20:23], s54 offen sc0 sc1
s_waitcnt vmcnt(0)
v_cmp_ne_u32 vcc, 1, v246
s_and_b32 s46, vcc_lo, 85
s_cbranch_scc1 K_F0
K_F0_OK:
v_mfma_f32_16x16x32_bf16 v[136:139], a[192:195], v[56:59], v[136:139]
s_add_u32 s94, s90, 0
v_mfma_f32_16x16x32_bf16 v[168:171], a[192:195], v[60:63], v[168:171]
buffer_load_dwordx4 a[0:3], v234, s[20:23], s94 offen offset:0 sc0 sc1
v_mfma_f32_16x16x32_bf16 v[140:143], a[196:199], v[56:59], v[140:143]
ds_read_b64_tr_b16 a[192:193], v208 offset:24576
ds_read_b64_tr_b16 a[194:195], v208 offset:28672
v_mfma_f32_16x16x32_bf16 v[172:175], a[196:199], v[60:63], v[172:175]
s_add_u32 s94, s90, 0
ds_read_b64_tr_b16 a[196:197], v209 offset:24576
ds_read_b64_tr_b16 a[198:199], v209 offset:28672
v_mfma_f32_16x16x32_bf16 v[144:147], a[200:203], v[56:59], v[144:147]
buffer_load_dwordx4 a[4:7], v234, s[20:23], s94 offen offset:1024 sc0 sc1
v_mfma_f32_16x16x32_bf16 v[176:179], a[200:203], v[60:63], v[176:179]
s_waitcnt lgkmcnt(10)
ds_read_b64_tr_b16 a[200:201], v210 offset:24576
ds_read_b64_tr_b16 a[202:203], v210 offset:28672
v_mfma_f32_16x16x32_bf16 v[148:151], a[204:207], v[56:59], v[148:151]
s_add_u32 s94, s90, 0
v_mfma_f32_16x16x32_bf16 v[180:183], a[204:207], v[60:63], v[180:183]
buffer_load_dwordx4 a[8:11], v234, s[20:23], s94 offen offset:2048 sc0 sc1
v_mfma_f32_16x16x32_bf16 v[152:155], a[208:211], v[56:59], v[152:155]
ds_read_b64_tr_b16 a[204:205], v211 offset:24576
ds_read_b64_tr_b16 a[206:207], v211 offset:28672
v_mfma_f32_16x16x32_bf16 v[184:187], a[208:211], v[60:63], v[184:187]
s_add_u32 s94, s90, 0
ds_read_b64_tr_b16 a[208:209], v212 offset:24576
ds_read_b64_tr_b16 a[210:211], v212 offset:28672
v_mfma_f32_16x16x32_bf16 v[156:159], a[212:215], v[56:59], v[156:159]
buffer_load_dwordx4 a[12:15], v234, s[20:23], s94 offen offset:3072 sc0 sc1
v_mfma_f32_16x16x32_bf16 v[188:191], a[212:215], v[60:63], v[188:191]
ds_read_b64_tr_b16 a[212:213], v213 offset:24576
ds_read_b64_tr_b16 a[214:215], v213 offset:28672
v_mfma_f32_16x16x32_bf16 v[160:163], a[216:219], v[56:59], v[160:163]
s_add_u32 s94, s90, 4096
v_mfma_f32_16x16x32_bf16 v[192:195], a[216:219], v[60:63], v[192:195]
buffer_load_dwordx4 a[16:19], v234, s[20:23], s94 offen offset:0 sc0 sc1
v_mfma_f32_16x16x32_bf16 v[164:167], a[220:223], v[56:59], v[164:167]
ds_read_b64_tr_b16 a[216:217], v214 offset:24576
ds_read_b64_tr_b16 a[218:219], v214 offset:28672
v_mfma_f32_16x16x32_bf16 v[196:199], a[220:223], v[60:63], v[196:199]
s_add_u32 s94, s90, 4096
ds_read_b64_tr_b16 a[220:221], v215 offset:24576
ds_read_b64_tr_b16 a[222:223], v215 offset:28672
v_mfma_f32_16x16x32_bf16 v[72:75], a[224:227], v[56:59], v[72:75]
buffer_load_dwordx4 a[20:23], v234, s[20:23], s94 offen offset:1024 sc0 sc1
v_mfma_f32_16x16x32_bf16 v[88:91], a[224:227], v[60:63], v[88:91]
s_waitcnt lgkmcnt(10)
ds_read_b64_tr_b16 a[224:225], v216 offset:28672
ds_read_b64_tr_b16 a[226:227], v216 offset:30720
v_mfma_f32_16x16x32_bf16 v[76:79], a[228:231], v[56:59], v[76:79]
s_add_u32 s94, s90, 4096
v_mfma_f32_16x16x32_bf16 v[92:95], a[228:231], v[60:63], v[92:95]
buffer_load_dwordx4 a[24:27], v234, s[20:23], s94 offen offset:2048 sc0 sc1
v_mfma_f32_16x16x32_bf16 v[80:83], a[232:235], v[56:59], v[80:83]
ds_read_b64_tr_b16 a[228:229], v217 offset:28672
ds_read_b64_tr_b16 a[230:231], v217 offset:30720
v_mfma_f32_16x16x32_bf16 v[96:99], a[232:235], v[60:63], v[96:99]
s_add_u32 s94, s90, 4096
ds_read_b64_tr_b16 a[232:233], v218 offset:28672
ds_read_b64_tr_b16 a[234:235], v218 offset:30720
v_mfma_f32_16x16x32_bf16 v[84:87], a[236:239], v[56:59], v[84:87]
buffer_load_dwordx4 a[28:31], v234, s[20:23], s94 offen offset:3072 sc0 sc1
v_mfma_f32_16x16x32_bf16 v[100:103], a[236:239], v[60:63], v[100:103]
ds_read_b64_tr_b16 a[236:237], v219 offset:28672
ds_read_b64_tr_b16 a[238:239], v219 offset:30720
s_waitcnt vmcnt(12)
s_mov_b64 exec, 1
buffer_store_dword v5, v234, s[20:23], s95 offen offset:4 sc0 sc1
s_mov_b64 exec, -1
v_mfma_f32_16x16x32_bf16 v[136:139], a[192:195], v[64:67], v[136:139]
v_mfma_f32_16x16x32_bf16 v[168:171], a[192:195], v[68:71], v[168:171]
v_mfma_f32_16x16x32_bf16 v[140:143], a[196:199], v[64:67], v[140:143]
v_mfma_f32_16x16x32_bf16 v[172:175], a[196:199], v[68:71], v[172:175]
v_mfma_f32_16x16x32_bf16 v[144:147], a[200:203], v[64:67], v[144:147]
s_waitcnt vmcnt(22) lgkmcnt(0)
s_barrier
v_mfma_f32_16x16x32_bf16 v[176:179], a[200:203], v[68:71], v[176:179]
ds_read_b64_tr_b16 a[192:193], v200 offset:32768
ds_read_b64_tr_b16 a[194:195], v200 offset:36864
v_mfma_f32_16x16x32_bf16 v[148:151], a[204:207], v[64:67], v[148:151]
s_add_u32 s94, s91, 0
ds_read_b64_tr_b16 a[196:197], v201 offset:32768
ds_read_b64_tr_b16 a[198:199], v201 offset:36864
v_mfma_f32_16x16x32_bf16 v[180:183], a[204:207], v[68:71], v[180:183]
buffer_load_dwordx4 a[32:35], v234, s[20:23], s94 offen offset:0 sc0 sc1
v_mfma_f32_16x16x32_bf16 v[152:155], a[208:211], v[64:67], v[152:155]
ds_read_b64_tr_b16 a[200:201], v202 offset:32768
ds_read_b64_tr_b16 a[202:203], v202 offset:36864
v_mfma_f32_16x16x32_bf16 v[184:187], a[208:211], v[68:71], v[184:187]
ds_read_b64_tr_b16 a[204:205], v203 offset:32768
ds_read_b64_tr_b16 a[206:207], v203 offset:36864
v_mfma_f32_16x16x32_bf16 v[156:159], a[212:215], v[64:67], v[156:159]
s_add_u32 s94, s91, 0
ds_read_b64_tr_b16 a[208:209], v204 offset:32768
ds_read_b64_tr_b16 a[210:211], v204 offset:36864
v_mfma_f32_16x16x32_bf16 v[188:191], a[212:215], v[68:71], v[188:191]
buffer_load_dwordx4 a[36:39], v234, s[20:23], s94 offen offset:1024 sc0 sc1
v_mfma_f32_16x16x32_bf16 v[160:163], a[216:219], v[64:67], v[160:163]
ds_read_b64_tr_b16 a[212:213], v205 offset:32768
ds_read_b64_tr_b16 a[214:215], v205 offset:36864
v_mfma_f32_16x16x32_bf16 v[192:195], a[216:219], v[68:71], v[192:195]
ds_read_b64_tr_b16 a[216:217], v206 offset:32768
ds_read_b64_tr_b16 a[218:219], v206 offset:36864
v_mfma_f32_16x16x32_bf16 v[164:167], a[220:223], v[64:67], v[164:167]
s_add_u32 s94, s91, 0
v_mfma_f32_16x16x32_bf16 v[196:199], a[220:223], v[68:71], v[196:199]
buffer_load_dwordx4 a[40:43], v234, s[20:23], s94 offen offset:2048 sc0 sc1
v_mfma_f32_16x16x32_bf16 v[72:75], a[224:227], v[64:67], v[72:75]
ds_read_b64_tr_b16 a[220:221], v207 offset:32768
ds_read_b64_tr_b16 a[222:223], v207 offset:36864
v_mfma_f32_16x16x32_bf16 v[88:91], a[224:227], v[68:71], v[88:91]
v_mfma_f32_16x16x32_bf16 v[76:79], a[228:231], v[64:67], v[76:79]
s_add_u32 s94, s91, 0
v_mfma_f32_16x16x32_bf16 v[92:95], a[228:231], v[68:71], v[92:95]
buffer_load_dwordx4 a[44:47], v234, s[20:23], s94 offen offset:3072 sc0 sc1
v_mfma_f32_16x16x32_bf16 v[80:83], a[232:235], v[64:67], v[80:83]
v_mfma_f32_16x16x32_bf16 v[96:99], a[232:235], v[68:71], v[96:99]
v_mfma_f32_16x16x32_bf16 v[84:87], a[236:239], v[64:67], v[84:87]
v_mfma_f32_16x16x32_bf16 v[100:103], a[236:239], v[68:71], v[100:103]
s_waitcnt lgkmcnt(2)
s_cmp_lg_u32 s83, 0
s_cbranch_scc1 K_YR2
K_YR2D:
s_waitcnt vmcnt(5)
v_mfma_f32_16x16x32_bf16 v[136:139], a[192:195], a[0:3], v[136:139]
s_add_u32 s94, s91, 4096
v_mfma_f32_16x16x32_bf16 v[168:171], a[192:195], a[4:7], v[168:171]
buffer_load_dwordx4 a[48:51], v234, s[20:23], s94 offen offset:0 sc0 sc1
v_mfma_f32_16x16x32_bf16 v[140:143], a[196:199], a[0:3], v[140:143]
ds_read_b64_tr_b16 a[192:193], v200 offset:40960
ds_read_b64_tr_b16 a[194:195], v200 offset:45056
v_mfma_f32_16x16x32_bf16 v[172:175], a[196:199], a[4:7], v[172:175]
ds_read_b64_tr_b16 a[196:197], v201 offset:40960
ds_read_b64_tr_b16 a[198:199], v201 offset:45056
v_mfma_f32_16x16x32_bf16 v[144:147], a[200:203], a[0:3], v[144:147]
s_add_u32 s94, s91, 4096
v_cvt_pk_bf16_f32 v72, v72, v73
v_cvt_pk_bf16_f32 v73, v74, v75
v_mfma_f32_16x16x32_bf16 v[176:179], a[200:203], a[4:7], v[176:179]
buffer_load_dwordx4 a[52:55], v234, s[20:23], s94 offen offset:1024 sc0 sc1
v_mfma_f32_16x16x32_bf16 v[148:151], a[204:207], a[0:3], v[148:151]
ds_read_b64_tr_b16 a[200:201], v202 offset:40960
ds_read_b64_tr_b16 a[202:203], v202 offset:45056
v_mfma_f32_16x16x32_bf16 v[180:183], a[204:207], a[4:7], v[180:183]
ds_read_b64_tr_b16 a[204:205], v203 offset:40960
ds_read_b64_tr_b16 a[206:207], v203 offset:45056
v_mfma_f32_16x16x32_bf16 v[152:155], a[208:211], a[0:3], v[152:155]
s_add_u32 s94, s91, 4096
v_cvt_pk_bf16_f32 v76, v76, v77
v_cvt_pk_bf16_f32 v77, v78, v79
v_mfma_f32_16x16x32_bf16 v[184:187], a[208:211], a[4:7], v[184:187]
buffer_load_dwordx4 a[56:59], v234, s[20:23], s94 offen offset:2048 sc0 sc1
v_mfma_f32_16x16x32_bf16 v[156:159], a[212:215], a[0:3], v[156:159]
ds_read_b64_tr_b16 a[208:209], v204 offset:40960
ds_read_b64_tr_b16 a[210:211], v204 offset:45056
v_mfma_f32_16x16x32_bf16 v[188:191], a[212:215], a[4:7], v[188:191]
ds_read_b64_tr_b16 a[212:213], v205 offset:40960
ds_read_b64_tr_b16 a[214:215], v205 offset:45056
v_mfma_f32_16x16x32_bf16 v[160:163], a[216:219], a[0:3], v[160:163]
s_add_u32 s94, s91, 4096
v_cvt_pk_bf16_f32 v80, v80, v81
v_cvt_pk_bf16_f32 v81, v82, v83
v_mfma_f32_16x16x32_bf16 v[192:195], a[216:219], a[4:7], v[192:195]
s_waitcnt lgkmcnt(8)
buffer_load_dwordx4 a[60:63], v234, s[20:23], s94 offen offset:3072 sc0 sc1
v_mfma_f32_16x16x32_bf16 v[164:167], a[220:223], a[0:3], v[164:167]
ds_read_b64_tr_b16 a[216:217], v206 offset:40960
ds_read_b64_tr_b16 a[218:219], v206 offset:45056
v_mfma_f32_16x16x32_bf16 v[196:199], a[220:223], a[4:7], v[196:199]
ds_read_b64_tr_b16 a[220:221], v207 offset:40960
ds_read_b64_tr_b16 a[222:223], v207 offset:45056
v_mfma_f32_16x16x32_bf16 v[136:139], a[192:195], a[8:11], v[136:139]
s_add_u32 m0, s3, 114688
v_cvt_pk_bf16_f32 v84, v84, v85
v_cvt_pk_bf16_f32 v85, v86, v87
v_mfma_f32_16x16x32_bf16 v[168:171], a[192:195], a[12:15], v[168:171]
s_add_u32 s48, s44, 73728
ds_read_b64_tr_b16 a[192:193], v200 offset:49152
ds_read_b64_tr_b16 a[194:195], v200 offset:53248
v_mfma_f32_16x16x32_bf16 v[140:143], a[196:199], a[8:11], v[140:143]
buffer_load_dwordx4 v236, s[16:19], s48 offen lds
v_mfma_f32_16x16x32_bf16 v[172:175], a[196:199], a[12:15], v[172:175]
s_waitcnt lgkmcnt(10)
ds_read_b64_tr_b16 a[196:197], v201 offset:49152
ds_read_b64_tr_b16 a[198:199], v201 offset:53248
v_mfma_f32_16x16x32_bf16 v[144:147], a[200:203], a[8:11], v[144:147]
s_add_u32 m0, s3, 118784
v_cvt_pk_bf16_f32 v88, v88, v89
v_cvt_pk_bf16_f32 v89, v90, v91
v_mfma_f32_16x16x32_bf16 v[176:179], a[200:203], a[12:15], v[176:179]
s_add_u32 s48, s44, 92160
ds_read_b64_tr_b16 a[200:201], v202 offset:49152
ds_read_b64_tr_b16 a[202:203], v202 offset:53248
v_mfma_f32_16x16x32_bf16 v[148:151], a[204:207], a[8:11], v[148:151]
buffer_load_dwordx4 v236, s[16:19], s48 offen lds
v_mfma_f32_16x16x32_bf16 v[180:183], a[204:207], a[12:15], v[180:183]
s_waitcnt lgkmcnt(10)
ds_read_b64_tr_b16 a[204:205], v203 offset:49152
ds_read_b64_tr_b16 a[206:207], v203 offset:53248
v_mfma_f32_16x16x32_bf16 v[152:155], a[208:211], a[8:11], v[152:155]
s_add_u32 m0, s3, 122880
v_cvt_pk_bf16_f32 v92, v92, v93
v_cvt_pk_bf16_f32 v93, v94, v95
v_mfma_f32_16x16x32_bf16 v[184:187], a[208:211], a[12:15], v[184:187]
s_add_u32 s48, s44, 110592
ds_read_b64_tr_b16 a[208:209], v204 offset:49152
ds_read_b64_tr_b16 a[210:211], v204 offset:53248
v_mfma_f32_16x16x32_bf16 v[156:159], a[212:215], a[8:11], v[156:159]
buffer_load_dwordx4 v236, s[16:19], s48 offen lds
v_mfma_f32_16x16x32_bf16 v[188:191], a[212:215], a[12:15], v[188:191]
s_waitcnt lgkmcnt(8)
ds_read_b64_tr_b16 a[212:213], v205 offset:49152
ds_read_b64_tr_b16 a[214:215], v205 offset:53248
v_mfma_f32_16x16x32_bf16 v[160:163], a[216:219], a[8:11], v[160:163]
s_add_u32 m0, s3, 126976
v_cvt_pk_bf16_f32 v96, v96, v97
v_mfma_f32_16x16x32_bf16 v[192:195], a[216:219], a[12:15], v[192:195]
s_add_u32 s48, s44, 129024
ds_read_b64_tr_b16 a[216:217], v206 offset:49152
ds_read_b64_tr_b16 a[218:219], v206 offset:53248
v_mfma_f32_16x16x32_bf16 v[164:167], a[220:223], a[8:11], v[164:167]
buffer_load_dwordx4 v236, s[16:19], s48 offen lds
v_mfma_f32_16x16x32_bf16 v[196:199], a[220:223], a[12:15], v[196:199]
ds_read_b64_tr_b16 a[220:221], v207 offset:49152
ds_read_b64_tr_b16 a[222:223], v207 offset:53248
v_mfma_f32_16x16x32_bf16 v[136:139], a[192:195], a[16:19], v[136:139]
s_waitcnt lgkmcnt(10)
v_cvt_pk_bf16_f32 v97, v98, v99
v_cvt_pk_bf16_f32 v100, v100, v101
v_mfma_f32_16x16x32_bf16 v[168:171], a[192:195], a[20:23], v[168:171]
s_add_u32 s94, s92, 0
ds_read_b64_tr_b16 a[192:193], v200 offset:57344
ds_read_b64_tr_b16 a[194:195], v200 offset:61440
v_mfma_f32_16x16x32_bf16 v[140:143], a[196:199], a[16:19], v[140:143]
buffer_load_dwordx4 a[64:67], v234, s[20:23], s94 offen offset:0 sc0 sc1
v_mfma_f32_16x16x32_bf16 v[172:175], a[196:199], a[20:23], v[172:175]
ds_read_b64_tr_b16 a[196:197], v201 offset:57344
ds_read_b64_tr_b16 a[198:199], v201 offset:61440
v_mfma_f32_16x16x32_bf16 v[144:147], a[200:203], a[16:19], v[144:147]
s_waitcnt lgkmcnt(10)
v_cvt_pk_bf16_f32 v101, v102, v103
v_lshlrev_b32 v249, 7, v1
v_mfma_f32_16x16x32_bf16 v[176:179], a[200:203], a[20:23], v[176:179]
s_add_u32 s94, s92, 0
ds_read_b64_tr_b16 a[200:201], v202 offset:57344
ds_read_b64_tr_b16 a[202:203], v202 offset:61440
v_mfma_f32_16x16x32_bf16 v[148:151], a[204:207], a[16:19], v[148:151]
buffer_load_dwordx4 a[68:71], v234, s[20:23], s94 offen offset:1024 sc0 sc1
v_mfma_f32_16x16x32_bf16 v[180:183], a[204:207], a[20:23], v[180:183]
ds_read_b64_tr_b16 a[204:205], v203 offset:57344
ds_read_b64_tr_b16 a[206:207], v203 offset:61440
v_mfma_f32_16x16x32_bf16 v[152:155], a[208:211], a[16:19], v[152:155]
s_waitcnt lgkmcnt(10)
v_lshlrev_b32 v7, 2, v3
v_subrev_u32 v248, s55, v254
v_mfma_f32_16x16x32_bf16 v[184:187], a[208:211], a[20:23], v[184:187]
s_add_u32 s94, s92, 0
ds_read_b64_tr_b16 a[208:209], v204 offset:57344
ds_read_b64_tr_b16 a[210:211], v204 offset:61440
v_mfma_f32_16x16x32_bf16 v[156:159], a[212:215], a[16:19], v[156:159]
buffer_load_dwordx4 a[72:75], v234, s[20:23], s94 offen offset:2048 sc0 sc1
v_mfma_f32_16x16x32_bf16 v[188:191], a[212:215], a[20:23], v[188:191]
ds_read_b64_tr_b16 a[212:213], v205 offset:57344
ds_read_b64_tr_b16 a[214:215], v205 offset:61440
v_mfma_f32_16x16x32_bf16 v[160:163], a[216:219], a[16:19], v[160:163]
s_waitcnt lgkmcnt(10)
v_subrev_u32 v248, 1, v248
v_mfma_f32_16x16x32_bf16 v[192:195], a[216:219], a[20:23], v[192:195]
s_add_u32 s94, s92, 0
ds_read_b64_tr_b16 a[216:217], v206 offset:57344
ds_read_b64_tr_b16 a[218:219], v206 offset:61440
v_mfma_f32_16x16x32_bf16 v[164:167], a[220:223], a[16:19], v[164:167]
buffer_load_dwordx4 a[76:79], v234, s[20:23], s94 offen offset:3072 sc0 sc1
v_mfma_f32_16x16x32_bf16 v[196:199], a[220:223], a[20:23], v[196:199]
ds_read_b64_tr_b16 a[220:221], v207 offset:57344
ds_read_b64_tr_b16 a[222:223], v207 offset:61440
buffer_load_dword v246, v6, s[20:23], s54 offen sc0 sc1
v_mfma_f32_16x16x32_bf16 v[136:139], a[192:195], a[24:27], v[136:139]
s_waitcnt lgkmcnt(10)
v_add_u32 v241, s37, v241
v_add_u32 v241, 65536, v241
v_mfma_f32_16x16x32_bf16 v[168:171], a[192:195], a[28:31], v[168:171]
s_add_u32 s94, s92, 4096
ds_read_b64_tr_b16 a[192:193], v220 offset:0
ds_read_b64_tr_b16 a[194:195], v220 offset:4096
v_mfma_f32_16x16x32_bf16 v[140:143], a[196:199], a[24:27], v[140:143]
buffer_load_dwordx4 a[80:83], v234, s[20:23], s94 offen offset:0 sc0 sc1
v_mfma_f32_16x16x32_bf16 v[172:175], a[196:199], a[28:31], v[172:175]
ds_read_b64_tr_b16 a[196:197], v221 offset:0
ds_read_b64_tr_b16 a[198:199], v221 offset:4096
v_mfma_f32_16x16x32_bf16 v[144:147], a[200:203], a[24:27], v[144:147]
s_waitcnt lgkmcnt(10)
v_xor_b32 v242, 32, v241
v_xor_b32 v243, 64, v241
v_mfma_f32_16x16x32_bf16 v[176:179], a[200:203], a[28:31], v[176:179]
s_add_u32 s94, s92, 4096
ds_read_b64_tr_b16 a[200:201], v222 offset:0
ds_read_b64_tr_b16 a[202:203], v222 offset:4096
v_mfma_f32_16x16x32_bf16 v[148:151], a[204:207], a[24:27], v[148:151]
buffer_load_dwordx4 a[84:87], v234, s[20:23], s94 offen offset:1024 sc0 sc1
v_mfma_f32_16x16x32_bf16 v[180:183], a[204:207], a[28:31], v[180:183]
ds_read_b64_tr_b16 a[204:205], v223 offset:0
ds_read_b64_tr_b16 a[206:207], v223 offset:4096
v_mfma_f32_16x16x32_bf16 v[152:155], a[208:211], a[24:27], v[152:155]
s_waitcnt lgkmcnt(10)
v_xor_b32 v244, 96, v241
v_mfma_f32_16x16x32_bf16 v[184:187], a[208:211], a[28:31], v[184:187]
s_add_u32 s94, s92, 4096
ds_read_b64_tr_b16 a[208:209], v224 offset:0
ds_read_b64_tr_b16 a[210:211], v224 offset:4096
v_mfma_f32_16x16x32_bf16 v[156:159], a[212:215], a[24:27], v[156:159]
buffer_load_dwordx4 a[88:91], v234, s[20:23], s94 offen offset:2048 sc0 sc1
v_mfma_f32_16x16x32_bf16 v[188:191], a[212:215], a[28:31], v[188:191]
ds_read_b64_tr_b16 a[212:213], v225 offset:0
ds_read_b64_tr_b16 a[214:215], v225 offset:4096
v_mfma_f32_16x16x32_bf16 v[160:163], a[216:219], a[24:27], v[160:163]
s_waitcnt lgkmcnt(10)
v_mfma_f32_16x16x32_bf16 v[192:195], a[216:219], a[28:31], v[192:195]
s_add_u32 s94, s92, 4096
ds_read_b64_tr_b16 a[216:217], v226 offset:0
ds_read_b64_tr_b16 a[218:219], v226 offset:4096
v_mfma_f32_16x16x32_bf16 v[164:167], a[220:223], a[24:27], v[164:167]
buffer_load_dwordx4 a[92:95], v234, s[20:23], s94 offen offset:3072 sc0 sc1
v_mfma_f32_16x16x32_bf16 v[196:199], a[220:223], a[28:31], v[196:199]
ds_read_b64_tr_b16 a[220:221], v227 offset:0
ds_read_b64_tr_b16 a[222:223], v227 offset:4096
s_waitcnt vmcnt(13)
v_mfma_f32_16x16x32_bf16 v[136:139], a[192:195], a[32:35], v[136:139]
s_add_u32 m0, s3, 131072
v_mfma_f32_16x16x32_bf16 v[168:171], a[192:195], a[36:39], v[168:171]
s_waitcnt lgkmcnt(8)
s_add_u32 s48, s42, 147456
ds_read_b64_tr_b16 a[192:193], v220 offset:8192
ds_read_b64_tr_b16 a[194:195], v220 offset:12288
v_mfma_f32_16x16x32_bf16 v[140:143], a[196:199], a[32:35], v[140:143]
buffer_load_dwordx4 v236, s[16:19], s48 offen lds
v_mfma_f32_16x16x32_bf16 v[172:175], a[196:199], a[36:39], v[172:175]
ds_read_b64_tr_b16 a[196:197], v221 offset:8192
ds_read_b64_tr_b16 a[198:199], v221 offset:12288
v_mfma_f32_16x16x32_bf16 v[144:147], a[200:203], a[32:35], v[144:147]
s_add_u32 m0, s3, 135168
v_mfma_f32_16x16x32_bf16 v[176:179], a[200:203], a[36:39], v[176:179]
s_add_u32 s48, s42, 165888
ds_read_b64_tr_b16 a[200:201], v222 offset:8192
ds_read_b64_tr_b16 a[202:203], v222 offset:12288
v_mfma_f32_16x16x32_bf16 v[148:151], a[204:207], a[32:35], v[148:151]
buffer_load_dwordx4 v236, s[16:19], s48 offen lds
v_mfma_f32_16x16x32_bf16 v[180:183], a[204:207], a[36:39], v[180:183]
s_waitcnt lgkmcnt(8)
ds_read_b64_tr_b16 a[204:205], v223 offset:8192
ds_read_b64_tr_b16 a[206:207], v223 offset:12288
v_mfma_f32_16x16x32_bf16 v[152:155], a[208:211], a[32:35], v[152:155]
s_add_u32 m0, s3, 139264
v_mfma_f32_16x16x32_bf16 v[184:187], a[208:211], a[36:39], v[184:187]
s_add_u32 s48, s42, 184320
ds_read_b64_tr_b16 a[208:209], v224 offset:8192
ds_read_b64_tr_b16 a[210:211], v224 offset:12288
v_mfma_f32_16x16x32_bf16 v[156:159], a[212:215], a[32:35], v[156:159]
buffer_load_dwordx4 v236, s[16:19], s48 offen lds
v_mfma_f32_16x16x32_bf16 v[188:191], a[212:215], a[36:39], v[188:191]
ds_read_b64_tr_b16 a[212:213], v225 offset:8192
ds_read_b64_tr_b16 a[214:215], v225 offset:12288
v_mfma_f32_16x16x32_bf16 v[160:163], a[216:219], a[32:35], v[160:163]
s_add_u32 m0, s3, 143360
v_mfma_f32_16x16x32_bf16 v[192:195], a[216:219], a[36:39], v[192:195]
s_waitcnt lgkmcnt(8)
s_add_u32 s48, s42, 202752
ds_read_b64_tr_b16 a[216:217], v226 offset:8192
ds_read_b64_tr_b16 a[218:219], v226 offset:12288
v_mfma_f32_16x16x32_bf16 v[164:167], a[220:223], a[32:35], v[164:167]
buffer_load_dwordx4 v236, s[16:19], s48 offen lds
v_mfma_f32_16x16x32_bf16 v[196:199], a[220:223], a[36:39], v[196:199]
ds_read_b64_tr_b16 a[220:221], v227 offset:8192
ds_read_b64_tr_b16 a[222:223], v227 offset:12288
v_mfma_f32_16x16x32_bf16 v[136:139], a[192:195], a[40:43], v[136:139]
s_add_u32 m0, s3, 147456
v_mfma_f32_16x16x32_bf16 v[168:171], a[192:195], a[44:47], v[168:171]
s_add_u32 s48, s42, 221184
ds_read_b64_tr_b16 a[192:193], v220 offset:16384
ds_read_b64_tr_b16 a[194:195], v220 offset:20480
v_mfma_f32_16x16x32_bf16 v[140:143], a[196:199], a[40:43], v[140:143]
buffer_load_dwordx4 v236, s[16:19], s48 offen lds
v_mfma_f32_16x16x32_bf16 v[172:175], a[196:199], a[44:47], v[172:175]
s_waitcnt lgkmcnt(8)
ds_read_b64_tr_b16 a[196:197], v221 offset:16384
ds_read_b64_tr_b16 a[198:199], v221 offset:20480
v_mfma_f32_16x16x32_bf16 v[144:147], a[200:203], a[40:43], v[144:147]
s_add_u32 m0, s3, 151552
v_mfma_f32_16x16x32_bf16 v[176:179], a[200:203], a[44:47], v[176:179]
s_add_u32 s48, s42, 239616
ds_read_b64_tr_b16 a[200:201], v222 offset:16384
ds_read_b64_tr_b16 a[202:203], v222 offset:20480
v_mfma_f32_16x16x32_bf16 v[148:151], a[204:207], a[40:43], v[148:151]
buffer_load_dwordx4 v236, s[16:19], s48 offen lds
v_mfma_f32_16x16x32_bf16 v[180:183], a[204:207], a[44:47], v[180:183]
ds_read_b64_tr_b16 a[204:205], v223 offset:16384
ds_read_b64_tr_b16 a[206:207], v223 offset:20480
v_mfma_f32_16x16x32_bf16 v[152:155], a[208:211], a[40:43], v[152:155]
s_add_u32 m0, s3, 155648
v_mfma_f32_16x16x32_bf16 v[184:187], a[208:211], a[44:47], v[184:187]
s_waitcnt lgkmcnt(8)
s_add_u32 s48, s42, 258048
ds_read_b64_tr_b16 a[208:209], v224 offset:16384
ds_read_b64_tr_b16 a[210:211], v224 offset:20480
v_mfma_f32_16x16x32_bf16 v[156:159], a[212:215], a[40:43], v[156:159]
buffer_load_dwordx4 v236, s[16:19], s48 offen lds
v_mfma_f32_16x16x32_bf16 v[188:191], a[212:215], a[44:47], v[188:191]
ds_read_b64_tr_b16 a[212:213], v225 offset:16384
ds_read_b64_tr_b16 a[214:215], v225 offset:20480
v_mfma_f32_16x16x32_bf16 v[160:163], a[216:219], a[40:43], v[160:163]
s_add_u32 m0, s3, 159744
v_mfma_f32_16x16x32_bf16 v[192:195], a[216:219], a[44:47], v[192:195]
s_add_u32 s48, s42, 276480
ds_read_b64_tr_b16 a[216:217], v226 offset:16384
ds_read_b64_tr_b16 a[218:219], v226 offset:20480
v_mfma_f32_16x16x32_bf16 v[164:167], a[220:223], a[40:43], v[164:167]
buffer_load_dwordx4 v236, s[16:19], s48 offen lds
v_mfma_f32_16x16x32_bf16 v[196:199], a[220:223], a[44:47], v[196:199]
s_waitcnt lgkmcnt(8)
ds_read_b64_tr_b16 a[220:221], v227 offset:16384
ds_read_b64_tr_b16 a[222:223], v227 offset:20480
s_waitcnt vmcnt(12)
v_cmp_ne_u32 vcc, 1, v246
s_and_b32 s46, vcc_lo, 170
s_cbranch_scc0 K_F1_OK
K_F1:
s_sleep 1
s_add_u32 s100, s100, 1
s_bitcmp1_b32 s100, 19
s_cbranch_scc1 K_END
buffer_load_dword v246, v6, s[20:23], s54 offen sc0 sc1
s_waitcnt vmcnt(0)
v_cmp_ne_u32 vcc, 1, v246
s_and_b32 s46, vcc_lo, 170
s_cbranch_scc1 K_F1
K_F1_OK:
v_mfma_f32_16x16x32_bf16 v[136:139], a[192:195], a[48:51], v[136:139]
v_mfma_f32_16x16x32_bf16 v[168:171], a[192:195], a[52:55], v[168:171]
s_add_u32 s94, s90, 8192
ds_read_b64_tr_b16 a[192:193], v220 offset:24576
ds_read_b64_tr_b16 a[194:195], v220 offset:28672
v_mfma_f32_16x16x32_bf16 v[140:143], a[196:199], a[48:51], v[140:143]
buffer_load_dwordx4 a[96:99], v234, s[20:23], s94 offen offset:0 sc0 sc1
v_mfma_f32_16x16x32_bf16 v[172:175], a[196:199], a[52:55], v[172:175]
ds_read_b64_tr_b16 a[196:197], v221 offset:24576
ds_read_b64_tr_b16 a[198:199], v221 offset:28672
v_mfma_f32_16x16x32_bf16 v[144:147], a[200:203], a[48:51], v[144:147]
s_add_u32 s94, s90, 8192
v_mfma_f32_16x16x32_bf16 v[176:179], a[200:203], a[52:55], v[176:179]
s_waitcnt lgkmcnt(8)
buffer_load_dwordx4 a[100:103], v234, s[20:23], s94 offen offset:1024 sc0 sc1
v_mfma_f32_16x16x32_bf16 v[148:151], a[204:207], a[48:51], v[148:151]
ds_read_b64_tr_b16 a[200:201], v222 offset:24576
ds_read_b64_tr_b16 a[202:203], v222 offset:28672
v_mfma_f32_16x16x32_bf16 v[180:183], a[204:207], a[52:55], v[180:183]
ds_read_b64_tr_b16 a[204:205], v223 offset:24576
ds_read_b64_tr_b16 a[206:207], v223 offset:28672
v_mfma_f32_16x16x32_bf16 v[152:155], a[208:211], a[48:51], v[152:155]
s_add_u32 s94, s90, 8192
v_mfma_f32_16x16x32_bf16 v[184:187], a[208:211], a[52:55], v[184:187]
buffer_load_dwordx4 a[104:107], v234, s[20:23], s94 offen offset:2048 sc0 sc1
v_mfma_f32_16x16x32_bf16 v[156:159], a[212:215], a[48:51], v[156:159]
s_waitcnt lgkmcnt(8)
ds_read_b64_tr_b16 a[208:209], v224 offset:24576
ds_read_b64_tr_b16 a[210:211], v224 offset:28672
v_mfma_f32_16x16x32_bf16 v[188:191], a[212:215], a[52:55], v[188:191]
s_add_u32 s94, s90, 8192
ds_read_b64_tr_b16 a[212:213], v225 offset:24576
ds_read_b64_tr_b16 a[214:215], v225 offset:28672
v_mfma_f32_16x16x32_bf16 v[160:163], a[216:219], a[48:51], v[160:163]
buffer_load_dwordx4 a[108:111], v234, s[20:23], s94 offen offset:3072 sc0 sc1
v_mfma_f32_16x16x32_bf16 v[192:195], a[216:219], a[52:55], v[192:195]
ds_read_b64_tr_b16 a[216:217], v226 offset:24576
ds_read_b64_tr_b16 a[218:219], v226 offset:28672
v_mfma_f32_16x16x32_bf16 v[164:167], a[220:223], a[48:51], v[164:167]
v_mfma_f32_16x16x32_bf16 v[196:199], a[220:223], a[52:55], v[196:199]
s_waitcnt lgkmcnt(10)
ds_read_b64_tr_b16 a[220:221], v227 offset:24576
ds_read_b64_tr_b16 a[222:223], v227 offset:28672
v_mfma_f32_16x16x32_bf16 v[136:139], a[192:195], a[56:59], v[136:139]
v_mfma_f32_16x16x32_bf16 v[168:171], a[192:195], a[60:63], v[168:171]
v_mfma_f32_16x16x32_bf16 v[140:143], a[196:199], a[56:59], v[140:143]
v_mfma_f32_16x16x32_bf16 v[172:175], a[196:199], a[60:63], v[172:175]
s_waitcnt lgkmcnt(8)
v_mfma_f32_16x16x32_bf16 v[144:147], a[200:203], a[56:59], v[144:147]
s_waitcnt vmcnt(21) lgkmcnt(0)
s_barrier
v_mfma_f32_16x16x32_bf16 v[176:179], a[200:203], a[60:63], v[176:179]
ds_read_b64_tr_b16 a[192:193], v220 offset:32768
ds_read_b64_tr_b16 a[194:195], v220 offset:36864
v_mfma_f32_16x16x32_bf16 v[148:151], a[204:207], a[56:59], v[148:151]
s_add_u32 s94, s90, 12288
ds_read_b64_tr_b16 a[196:197], v221 offset:32768
ds_read_b64_tr_b16 a[198:199], v221 offset:36864
v_mfma_f32_16x16x32_bf16 v[180:183], a[204:207], a[60:63], v[180:183]
buffer_load_dwordx4 a[112:115], v234, s[20:23], s94 offen offset:0 sc0 sc1
v_mfma_f32_16x16x32_bf16 v[152:155], a[208:211], a[56:59], v[152:155]
ds_read_b64_tr_b16 a[200:201], v222 offset:32768
ds_read_b64_tr_b16 a[202:203], v222 offset:36864
v_mfma_f32_16x16x32_bf16 v[184:187], a[208:211], a[60:63], v[184:187]
s_add_u32 s94, s90, 12288
ds_read_b64_tr_b16 a[204:205], v223 offset:32768
ds_read_b64_tr_b16 a[206:207], v223 offset:36864
v_mfma_f32_16x16x32_bf16 v[156:159], a[212:215], a[56:59], v[156:159]
buffer_load_dwordx4 a[116:119], v234, s[20:23], s94 offen offset:1024 sc0 sc1
v_mfma_f32_16x16x32_bf16 v[188:191], a[212:215], a[60:63], v[188:191]
ds_read_b64_tr_b16 a[208:209], v224 offset:32768
ds_read_b64_tr_b16 a[210:211], v224 offset:36864
v_mfma_f32_16x16x32_bf16 v[160:163], a[216:219], a[56:59], v[160:163]
ds_read_b64_tr_b16 a[212:213], v225 offset:32768
ds_read_b64_tr_b16 a[214:215], v225 offset:36864
v_mfma_f32_16x16x32_bf16 v[192:195], a[216:219], a[60:63], v[192:195]
s_add_u32 s94, s90, 12288
ds_read_b64_tr_b16 a[216:217], v226 offset:32768
ds_read_b64_tr_b16 a[218:219], v226 offset:36864
v_mfma_f32_16x16x32_bf16 v[164:167], a[220:223], a[56:59], v[164:167]
buffer_load_dwordx4 a[120:123], v234, s[20:23], s94 offen offset:2048 sc0 sc1
v_mfma_f32_16x16x32_bf16 v[196:199], a[220:223], a[60:63], v[196:199]
s_waitcnt lgkmcnt(12)
ds_read_b64_tr_b16 a[220:221], v227 offset:32768
ds_read_b64_tr_b16 a[222:223], v227 offset:36864
s_waitcnt vmcnt(15)
v_mfma_f32_16x16x32_bf16 v[136:139], a[192:195], a[64:67], v[136:139]
s_add_u32 s94, s90, 12288
v_mfma_f32_16x16x32_bf16 v[168:171], a[192:195], a[68:71], v[168:171]
s_waitcnt lgkmcnt(12)
buffer_load_dwordx4 a[124:127], v234, s[20:23], s94 offen offset:3072 sc0 sc1
v_mfma_f32_16x16x32_bf16 v[140:143], a[196:199], a[64:67], v[140:143]
s_waitcnt lgkmcnt(10)
ds_read_b64_tr_b16 a[192:193], v220 offset:40960
ds_read_b64_tr_b16 a[194:195], v220 offset:45056
v_mfma_f32_16x16x32_bf16 v[172:175], a[196:199], a[68:71], v[172:175]
s_add_u32 m0, s3, 0
ds_read_b64_tr_b16 a[196:197], v221 offset:40960
ds_read_b64_tr_b16 a[198:199], v221 offset:45056
v_mfma_f32_16x16x32_bf16 v[144:147], a[200:203], a[64:67], v[144:147]
s_add_u32 s48, s43, 147456
v_mfma_f32_16x16x32_bf16 v[176:179], a[200:203], a[68:71], v[176:179]
s_waitcnt lgkmcnt(10)
buffer_load_dwordx4 v236, s[16:19], s48 offen lds
v_mfma_f32_16x16x32_bf16 v[148:151], a[204:207], a[64:67], v[148:151]
s_add_u32 m0, s3, 4096
ds_read_b64_tr_b16 a[200:201], v222 offset:40960
ds_read_b64_tr_b16 a[202:203], v222 offset:45056
v_mfma_f32_16x16x32_bf16 v[180:183], a[204:207], a[68:71], v[180:183]
s_add_u32 s48, s43, 165888
ds_read_b64_tr_b16 a[204:205], v223 offset:40960
ds_read_b64_tr_b16 a[206:207], v223 offset:45056
v_mfma_f32_16x16x32_bf16 v[152:155], a[208:211], a[64:67], v[152:155]
s_waitcnt lgkmcnt(10)
buffer_load_dwordx4 v236, s[16:19], s48 offen lds
v_mfma_f32_16x16x32_bf16 v[184:187], a[208:211], a[68:71], v[184:187]
s_add_u32 m0, s3, 8192
ds_read_b64_tr_b16 a[208:209], v224 offset:40960
ds_read_b64_tr_b16 a[210:211], v224 offset:45056
v_mfma_f32_16x16x32_bf16 v[156:159], a[212:215], a[64:67], v[156:159]
s_add_u32 s48, s43, 184320
v_mfma_f32_16x16x32_bf16 v[188:191], a[212:215], a[68:71], v[188:191]
buffer_load_dwordx4 v236, s[16:19], s48 offen lds
v_mfma_f32_16x16x32_bf16 v[160:163], a[216:219], a[64:67], v[160:163]
ds_read_b64_tr_b16 a[212:213], v225 offset:40960
ds_read_b64_tr_b16 a[214:215], v225 offset:45056
v_mfma_f32_16x16x32_bf16 v[192:195], a[216:219], a[68:71], v[192:195]
s_waitcnt lgkmcnt(8)
ds_read_b64_tr_b16 a[216:217], v226 offset:40960
ds_read_b64_tr_b16 a[218:219], v226 offset:45056
v_mfma_f32_16x16x32_bf16 v[164:167], a[220:223], a[64:67], v[164:167]
v_mfma_f32_16x16x32_bf16 v[196:199], a[220:223], a[68:71], v[196:199]
ds_read_b64_tr_b16 a[220:221], v227 offset:40960
ds_read_b64_tr_b16 a[222:223], v227 offset:45056
v_mfma_f32_16x16x32_bf16 v[136:139], a[192:195], a[72:75], v[136:139]
s_add_u32 m0, s3, 12288
v_mfma_f32_16x16x32_bf16 v[168:171], a[192:195], a[76:79], v[168:171]
s_add_u32 s48, s43, 202752
ds_read_b64_tr_b16 a[192:193], v220 offset:49152
ds_read_b64_tr_b16 a[194:195], v220 offset:53248
v_mfma_f32_16x16x32_bf16 v[140:143], a[196:199], a[72:75], v[140:143]
s_waitcnt lgkmcnt(10)
buffer_load_dwordx4 v236, s[16:19], s48 offen lds
v_mfma_f32_16x16x32_bf16 v[172:175], a[196:199], a[76:79], v[172:175]
s_add_u32 m0, s3, 16384
ds_read_b64_tr_b16 a[196:197], v221 offset:49152
ds_read_b64_tr_b16 a[198:199], v221 offset:53248
v_mfma_f32_16x16x32_bf16 v[144:147], a[200:203], a[72:75], v[144:147]
s_add_u32 s48, s43, 221184
v_mfma_f32_16x16x32_bf16 v[176:179], a[200:203], a[76:79], v[176:179]
buffer_load_dwordx4 v236, s[16:19], s48 offen lds
v_mfma_f32_16x16x32_bf16 v[148:151], a[204:207], a[72:75], v[148:151]
s_add_u32 m0, s3, 20480
ds_read_b64_tr_b16 a[200:201], v222 offset:49152
ds_read_b64_tr_b16 a[202:203], v222 offset:53248
v_mfma_f32_16x16x32_bf16 v[180:183], a[204:207], a[76:79], v[180:183]
s_waitcnt lgkmcnt(8)
s_add_u32 s48, s43, 239616
ds_read_b64_tr_b16 a[204:205], v223 offset:49152
ds_read_b64_tr_b16 a[206:207], v223 offset:53248
v_mfma_f32_16x16x32_bf16 v[152:155], a[208:211], a[72:75], v[152:155]
buffer_load_dwordx4 v236, s[16:19], s48 offen lds
v_mfma_f32_16x16x32_bf16 v[184:187], a[208:211], a[76:79], v[184:187]
ds_read_b64_tr_b16 a[208:209], v224 offset:49152
ds_read_b64_tr_b16 a[210:211], v224 offset:53248
v_mfma_f32_16x16x32_bf16 v[156:159], a[212:215], a[72:75], v[156:159]
s_add_u32 m0, s3, 24576
v_mfma_f32_16x16x32_bf16 v[188:191], a[212:215], a[76:79], v[188:191]
s_add_u32 s48, s43, 258048
ds_read_b64_tr_b16 a[212:213], v225 offset:49152
ds_read_b64_tr_b16 a[214:215], v225 offset:53248
v_mfma_f32_16x16x32_bf16 v[160:163], a[216:219], a[72:75], v[160:163]
buffer_load_dwordx4 v236, s[16:19], s48 offen lds
v_mfma_f32_16x16x32_bf16 v[192:195], a[216:219], a[76:79], v[192:195]
s_waitcnt lgkmcnt(8)
ds_read_b64_tr_b16 a[216:217], v226 offset:49152
ds_read_b64_tr_b16 a[218:219], v226 offset:53248
v_mfma_f32_16x16x32_bf16 v[164:167], a[220:223], a[72:75], v[164:167]
v_mfma_f32_16x16x32_bf16 v[196:199], a[220:223], a[76:79], v[196:199]
ds_read_b64_tr_b16 a[220:221], v227 offset:49152
ds_read_b64_tr_b16 a[222:223], v227 offset:53248
v_mfma_f32_16x16x32_bf16 v[136:139], a[192:195], a[80:83], v[136:139]
s_add_u32 m0, s3, 28672
v_mfma_f32_16x16x32_bf16 v[168:171], a[192:195], a[84:87], v[168:171]
s_add_u32 s48, s43, 276480
ds_read_b64_tr_b16 a[192:193], v220 offset:57344
ds_read_b64_tr_b16 a[194:195], v220 offset:61440
v_mfma_f32_16x16x32_bf16 v[140:143], a[196:199], a[80:83], v[140:143]
buffer_load_dwordx4 v236, s[16:19], s48 offen lds
v_mfma_f32_16x16x32_bf16 v[172:175], a[196:199], a[84:87], v[172:175]
s_waitcnt lgkmcnt(8)
ds_read_b64_tr_b16 a[196:197], v221 offset:57344
ds_read_b64_tr_b16 a[198:199], v221 offset:61440
v_mfma_f32_16x16x32_bf16 v[144:147], a[200:203], a[80:83], v[144:147]
s_add_u32 s94, s88, 0
v_mfma_f32_16x16x32_bf16 v[176:179], a[200:203], a[84:87], v[176:179]
buffer_store_dwordx2 v[72:73], v250, s[20:23], s94 offen sc0 sc1
v_mfma_f32_16x16x32_bf16 v[148:151], a[204:207], a[80:83], v[148:151]
ds_read_b64_tr_b16 a[200:201], v222 offset:57344
ds_read_b64_tr_b16 a[202:203], v222 offset:61440
v_mfma_f32_16x16x32_bf16 v[180:183], a[204:207], a[84:87], v[180:183]
ds_read_b64_tr_b16 a[204:205], v223 offset:57344
ds_read_b64_tr_b16 a[206:207], v223 offset:61440
v_mfma_f32_16x16x32_bf16 v[152:155], a[208:211], a[80:83], v[152:155]
s_waitcnt lgkmcnt(10)
v_mfma_f32_16x16x32_bf16 v[184:187], a[208:211], a[84:87], v[184:187]
s_add_u32 s94, s88, 8192
ds_read_b64_tr_b16 a[208:209], v224 offset:57344
ds_read_b64_tr_b16 a[210:211], v224 offset:61440
v_mfma_f32_16x16x32_bf16 v[156:159], a[212:215], a[80:83], v[156:159]
buffer_store_dwordx2 v[76:77], v250, s[20:23], s94 offen sc0 sc1
v_mfma_f32_16x16x32_bf16 v[188:191], a[212:215], a[84:87], v[188:191]
ds_read_b64_tr_b16 a[212:213], v225 offset:57344
ds_read_b64_tr_b16 a[214:215], v225 offset:61440
v_mfma_f32_16x16x32_bf16 v[160:163], a[216:219], a[80:83], v[160:163]
s_waitcnt lgkmcnt(10)
v_mfma_f32_16x16x32_bf16 v[192:195], a[216:219], a[84:87], v[192:195]
s_add_u32 s94, s88, 16384
ds_read_b64_tr_b16 a[216:217], v226 offset:57344
ds_read_b64_tr_b16 a[218:219], v226 offset:61440
v_mfma_f32_16x16x32_bf16 v[164:167], a[220:223], a[80:83], v[164:167]
buffer_store_dwordx2 v[80:81], v250, s[20:23], s94 offen sc0 sc1
v_mfma_f32_16x16x32_bf16 v[196:199], a[220:223], a[84:87], v[196:199]
ds_read_b64_tr_b16 a[220:221], v227 offset:57344
ds_read_b64_tr_b16 a[222:223], v227 offset:61440
v_mfma_f32_16x16x32_bf16 v[136:139], a[192:195], a[88:91], v[136:139]
v_mfma_f32_16x16x32_bf16 v[168:171], a[192:195], a[92:95], v[168:171]
s_waitcnt lgkmcnt(8)
v_mfma_f32_16x16x32_bf16 v[140:143], a[196:199], a[88:91], v[140:143]
v_mfma_f32_16x16x32_bf16 v[172:175], a[196:199], a[92:95], v[172:175]
v_mfma_f32_16x16x32_bf16 v[144:147], a[200:203], a[88:91], v[144:147]
s_waitcnt vmcnt(19) lgkmcnt(0)
s_barrier
v_mfma_f32_16x16x32_bf16 v[176:179], a[200:203], a[92:95], v[176:179]
ds_read_b64_tr_b16 a[192:193], v208 offset:0
ds_read_b64_tr_b16 a[194:195], v208 offset:4096
v_mfma_f32_16x16x32_bf16 v[148:151], a[204:207], a[88:91], v[148:151]
s_add_u32 s94, s88, 24576
ds_read_b64_tr_b16 a[196:197], v209 offset:0
ds_read_b64_tr_b16 a[198:199], v209 offset:4096
v_mfma_f32_16x16x32_bf16 v[180:183], a[204:207], a[92:95], v[180:183]
buffer_store_dwordx2 v[84:85], v250, s[20:23], s94 offen sc0 sc1
v_mfma_f32_16x16x32_bf16 v[152:155], a[208:211], a[88:91], v[152:155]
ds_read_b64_tr_b16 a[200:201], v210 offset:0
ds_read_b64_tr_b16 a[202:203], v210 offset:4096
v_mfma_f32_16x16x32_bf16 v[184:187], a[208:211], a[92:95], v[184:187]
ds_read_b64_tr_b16 a[204:205], v211 offset:0
ds_read_b64_tr_b16 a[206:207], v211 offset:4096
v_mfma_f32_16x16x32_bf16 v[156:159], a[212:215], a[88:91], v[156:159]
s_add_u32 s94, s89, 0
ds_read_b64_tr_b16 a[208:209], v212 offset:0
ds_read_b64_tr_b16 a[210:211], v212 offset:4096
v_mfma_f32_16x16x32_bf16 v[188:191], a[212:215], a[92:95], v[188:191]
buffer_store_dwordx2 v[88:89], v250, s[20:23], s94 offen sc0 sc1
v_mfma_f32_16x16x32_bf16 v[160:163], a[216:219], a[88:91], v[160:163]
ds_read_b64_tr_b16 a[212:213], v213 offset:0
ds_read_b64_tr_b16 a[214:215], v213 offset:4096
v_mfma_f32_16x16x32_bf16 v[192:195], a[216:219], a[92:95], v[192:195]
ds_read_b64_tr_b16 a[216:217], v214 offset:0
ds_read_b64_tr_b16 a[218:219], v214 offset:4096
v_mfma_f32_16x16x32_bf16 v[164:167], a[220:223], a[88:91], v[164:167]
v_mfma_f32_16x16x32_bf16 v[196:199], a[220:223], a[92:95], v[196:199]
s_waitcnt lgkmcnt(12)
ds_read_b64_tr_b16 a[220:221], v215 offset:0
ds_read_b64_tr_b16 a[222:223], v215 offset:4096
s_waitcnt vmcnt(13)
v_mfma_f32_16x16x32_bf16 v[136:139], a[192:195], a[96:99], v[136:139]
s_add_u32 s94, s89, 8192
v_mfma_f32_16x16x32_bf16 v[168:171], a[192:195], a[100:103], v[168:171]
s_waitcnt lgkmcnt(12)
buffer_store_dwordx2 v[92:93], v250, s[20:23], s94 offen sc0 sc1
v_mfma_f32_16x16x32_bf16 v[140:143], a[196:199], a[96:99], v[140:143]
ds_read_b64_tr_b16 a[192:193], v208 offset:8192
ds_read_b64_tr_b16 a[194:195], v208 offset:12288
v_mfma_f32_16x16x32_bf16 v[172:175], a[196:199], a[100:103], v[172:175]
s_waitcnt lgkmcnt(10)
ds_read_b64_tr_b16 a[196:197], v209 offset:8192
ds_read_b64_tr_b16 a[198:199], v209 offset:12288
v_mfma_f32_16x16x32_bf16 v[144:147], a[200:203], a[96:99], v[144:147]
s_add_u32 s94, s89, 16384
v_mfma_f32_16x16x32_bf16 v[176:179], a[200:203], a[100:103], v[176:179]
buffer_store_dwordx2 v[96:97], v250, s[20:23], s94 offen sc0 sc1
v_mfma_f32_16x16x32_bf16 v[148:151], a[204:207], a[96:99], v[148:151]
ds_read_b64_tr_b16 a[200:201], v210 offset:8192
ds_read_b64_tr_b16 a[202:203], v210 offset:12288
v_mfma_f32_16x16x32_bf16 v[180:183], a[204:207], a[100:103], v[180:183]
s_waitcnt lgkmcnt(8)
ds_read_b64_tr_b16 a[204:205], v211 offset:8192
ds_read_b64_tr_b16 a[206:207], v211 offset:12288
v_mfma_f32_16x16x32_bf16 v[152:155], a[208:211], a[96:99], v[152:155]
s_add_u32 s94, s89, 24576
v_mfma_f32_16x16x32_bf16 v[184:187], a[208:211], a[100:103], v[184:187]
buffer_store_dwordx2 v[100:101], v250, s[20:23], s94 offen sc0 sc1
v_mfma_f32_16x16x32_bf16 v[156:159], a[212:215], a[96:99], v[156:159]
ds_read_b64_tr_b16 a[208:209], v212 offset:8192
ds_read_b64_tr_b16 a[210:211], v212 offset:12288
v_mfma_f32_16x16x32_bf16 v[188:191], a[212:215], a[100:103], v[188:191]
ds_read_b64_tr_b16 a[212:213], v213 offset:8192
ds_read_b64_tr_b16 a[214:215], v213 offset:12288
v_mfma_f32_16x16x32_bf16 v[160:163], a[216:219], a[96:99], v[160:163]
s_add_u32 s94, s91, 8192
v_mfma_f32_16x16x32_bf16 v[192:195], a[216:219], a[100:103], v[192:195]
s_waitcnt lgkmcnt(8)
buffer_load_dwordx4 a[128:131], v234, s[20:23], s94 offen offset:0 sc0 sc1
v_mfma_f32_16x16x32_bf16 v[164:167], a[220:223], a[96:99], v[164:167]
ds_read_b64_tr_b16 a[216:217], v214 offset:8192
ds_read_b64_tr_b16 a[218:219], v214 offset:12288
v_mfma_f32_16x16x32_bf16 v[196:199], a[220:223], a[100:103], v[196:199]
ds_read_b64_tr_b16 a[220:221], v215 offset:8192
ds_read_b64_tr_b16 a[222:223], v215 offset:12288
v_mfma_f32_16x16x32_bf16 v[136:139], a[192:195], a[104:107], v[136:139]
s_add_u32 s94, s91, 8192
v_mfma_f32_16x16x32_bf16 v[168:171], a[192:195], a[108:111], v[168:171]
buffer_load_dwordx4 a[132:135], v234, s[20:23], s94 offen offset:1024 sc0 sc1
v_mfma_f32_16x16x32_bf16 v[140:143], a[196:199], a[104:107], v[140:143]
s_waitcnt lgkmcnt(8)
ds_read_b64_tr_b16 a[192:193], v208 offset:16384
ds_read_b64_tr_b16 a[194:195], v208 offset:20480
v_mfma_f32_16x16x32_bf16 v[172:175], a[196:199], a[108:111], v[172:175]
s_add_u32 s94, s91, 8192
ds_read_b64_tr_b16 a[196:197], v209 offset:16384
ds_read_b64_tr_b16 a[198:199], v209 offset:20480
v_mfma_f32_16x16x32_bf16 v[144:147], a[200:203], a[104:107], v[144:147]
buffer_load_dwordx4 a[136:139], v234, s[20:23], s94 offen offset:2048 sc0 sc1
v_mfma_f32_16x16x32_bf16 v[176:179], a[200:203], a[108:111], v[176:179]
s_add_u32 s94, s91, 8192
ds_read_b64_tr_b16 a[200:201], v210 offset:16384
ds_read_b64_tr_b16 a[202:203], v210 offset:20480
v_mfma_f32_16x16x32_bf16 v[148:151], a[204:207], a[104:107], v[148:151]
s_waitcnt lgkmcnt(10)
buffer_load_dwordx4 a[140:143], v234, s[20:23], s94 offen offset:3072 sc0 sc1
v_mfma_f32_16x16x32_bf16 v[180:183], a[204:207], a[108:111], v[180:183]
s_add_u32 s94, s91, 12288
ds_read_b64_tr_b16 a[204:205], v211 offset:16384
ds_read_b64_tr_b16 a[206:207], v211 offset:20480
v_mfma_f32_16x16x32_bf16 v[152:155], a[208:211], a[104:107], v[152:155]
buffer_load_dwordx4 a[144:147], v234, s[20:23], s94 offen offset:0 sc0 sc1
v_mfma_f32_16x16x32_bf16 v[184:187], a[208:211], a[108:111], v[184:187]
ds_read_b64_tr_b16 a[208:209], v212 offset:16384
ds_read_b64_tr_b16 a[210:211], v212 offset:20480
v_mfma_f32_16x16x32_bf16 v[156:159], a[212:215], a[104:107], v[156:159]
s_add_u32 s94, s91, 12288
v_mfma_f32_16x16x32_bf16 v[188:191], a[212:215], a[108:111], v[188:191]
s_waitcnt lgkmcnt(10)
buffer_load_dwordx4 a[148:151], v234, s[20:23], s94 offen offset:1024 sc0 sc1
v_mfma_f32_16x16x32_bf16 v[160:163], a[216:219], a[104:107], v[160:163]
s_add_u32 s94, s91, 12288
ds_read_b64_tr_b16 a[212:213], v213 offset:16384
ds_read_b64_tr_b16 a[214:215], v213 offset:20480
v_mfma_f32_16x16x32_bf16 v[192:195], a[216:219], a[108:111], v[192:195]
buffer_load_dwordx4 a[152:155], v234, s[20:23], s94 offen offset:2048 sc0 sc1
v_mfma_f32_16x16x32_bf16 v[164:167], a[220:223], a[104:107], v[164:167]
ds_read_b64_tr_b16 a[216:217], v214 offset:16384
ds_read_b64_tr_b16 a[218:219], v214 offset:20480
v_mfma_f32_16x16x32_bf16 v[196:199], a[220:223], a[108:111], v[196:199]
s_waitcnt lgkmcnt(8)
ds_read_b64_tr_b16 a[220:221], v215 offset:16384
ds_read_b64_tr_b16 a[222:223], v215 offset:20480
v_mfma_f32_16x16x32_bf16 v[136:139], a[192:195], a[112:115], v[136:139]
s_add_u32 s94, s91, 12288
v_mfma_f32_16x16x32_bf16 v[168:171], a[192:195], a[116:119], v[168:171]
buffer_load_dwordx4 a[156:159], v234, s[20:23], s94 offen offset:3072 sc0 sc1
v_mfma_f32_16x16x32_bf16 v[140:143], a[196:199], a[112:115], v[140:143]
ds_read_b64_tr_b16 a[192:193], v208 offset:24576
ds_read_b64_tr_b16 a[194:195], v208 offset:28672
v_mfma_f32_16x16x32_bf16 v[172:175], a[196:199], a[116:119], v[172:175]
s_add_u32 m0, s3, 32768
ds_read_b64_tr_b16 a[196:197], v209 offset:24576
ds_read_b64_tr_b16 a[198:199], v209 offset:28672
v_mfma_f32_16x16x32_bf16 v[144:147], a[200:203], a[112:115], v[144:147]
s_add_u32 s48, s44, 147456
v_mfma_f32_16x16x32_bf16 v[176:179], a[200:203], a[116:119], v[176:179]
s_waitcnt lgkmcnt(10)
buffer_load_dwordx4 v236, s[16:19], s48 offen lds
v_mfma_f32_16x16x32_bf16 v[148:151], a[204:207], a[112:115], v[148:151]
ds_read_b64_tr_b16 a[200:201], v210 offset:24576
ds_read_b64_tr_b16 a[202:203], v210 offset:28672
v_mfma_f32_16x16x32_bf16 v[180:183], a[204:207], a[116:119], v[180:183]
s_add_u32 m0, s3, 36864
ds_read_b64_tr_b16 a[204:205], v211 offset:24576
ds_read_b64_tr_b16 a[206:207], v211 offset:28672
v_mfma_f32_16x16x32_bf16 v[152:155], a[208:211], a[112:115], v[152:155]
s_add_u32 s48, s44, 165888
v_mfma_f32_16x16x32_bf16 v[184:187], a[208:211], a[116:119], v[184:187]
s_waitcnt lgkmcnt(8)
buffer_load_dwordx4 v236, s[16:19], s48 offen lds
v_mfma_f32_16x16x32_bf16 v[156:159], a[212:215], a[112:115], v[156:159]
ds_read_b64_tr_b16 a[208:209], v212 offset:24576
ds_read_b64_tr_b16 a[210:211], v212 offset:28672
v_mfma_f32_16x16x32_bf16 v[188:191], a[212:215], a[116:119], v[188:191]
s_add_u32 m0, s3, 40960
ds_read_b64_tr_b16 a[212:213], v213 offset:24576
ds_read_b64_tr_b16 a[214:215], v213 offset:28672
v_mfma_f32_16x16x32_bf16 v[160:163], a[216:219], a[112:115], v[160:163]
s_add_u32 s48, s44, 184320
v_mfma_f32_16x16x32_bf16 v[192:195], a[216:219], a[116:119], v[192:195]
buffer_load_dwordx4 v236, s[16:19], s48 offen lds
v_mfma_f32_16x16x32_bf16 v[164:167], a[220:223], a[112:115], v[164:167]
ds_read_b64_tr_b16 a[216:217], v214 offset:24576
ds_read_b64_tr_b16 a[218:219], v214 offset:28672
v_mfma_f32_16x16x32_bf16 v[196:199], a[220:223], a[116:119], v[196:199]
s_waitcnt lgkmcnt(10)
ds_read_b64_tr_b16 a[220:221], v215 offset:24576
ds_read_b64_tr_b16 a[222:223], v215 offset:28672
v_mfma_f32_16x16x32_bf16 v[136:139], a[192:195], a[120:123], v[136:139]
v_mfma_f32_16x16x32_bf16 v[168:171], a[192:195], a[124:127], v[168:171]
v_mfma_f32_16x16x32_bf16 v[140:143], a[196:199], a[120:123], v[140:143]
v_mfma_f32_16x16x32_bf16 v[172:175], a[196:199], a[124:127], v[172:175]
s_waitcnt lgkmcnt(8)
v_mfma_f32_16x16x32_bf16 v[144:147], a[200:203], a[120:123], v[144:147]
s_waitcnt vmcnt(19) lgkmcnt(0)
s_barrier
v_mfma_f32_16x16x32_bf16 v[176:179], a[200:203], a[124:127], v[176:179]
s_add_u32 m0, s3, 45056
ds_read_b64_tr_b16 a[192:193], v200 offset:0
ds_read_b64_tr_b16 a[194:195], v200 offset:4096
v_mfma_f32_16x16x32_bf16 v[148:151], a[204:207], a[120:123], v[148:151]
s_add_u32 s48, s44, 202752
ds_read_b64_tr_b16 a[196:197], v201 offset:0
ds_read_b64_tr_b16 a[198:199], v201 offset:4096
v_mfma_f32_16x16x32_bf16 v[180:183], a[204:207], a[124:127], v[180:183]
buffer_load_dwordx4 v236, s[16:19], s48 offen lds
v_mfma_f32_16x16x32_bf16 v[152:155], a[208:211], a[120:123], v[152:155]
s_add_u32 m0, s3, 49152
ds_read_b64_tr_b16 a[200:201], v202 offset:0
ds_read_b64_tr_b16 a[202:203], v202 offset:4096
v_mfma_f32_16x16x32_bf16 v[184:187], a[208:211], a[124:127], v[184:187]
s_add_u32 s48, s44, 221184
ds_read_b64_tr_b16 a[204:205], v203 offset:0
ds_read_b64_tr_b16 a[206:207], v203 offset:4096
v_mfma_f32_16x16x32_bf16 v[156:159], a[212:215], a[120:123], v[156:159]
buffer_load_dwordx4 v236, s[16:19], s48 offen lds
v_mfma_f32_16x16x32_bf16 v[188:191], a[212:215], a[124:127], v[188:191]
ds_read_b64_tr_b16 a[208:209], v204 offset:0
ds_read_b64_tr_b16 a[210:211], v204 offset:4096
v_mfma_f32_16x16x32_bf16 v[160:163], a[216:219], a[120:123], v[160:163]
s_add_u32 m0, s3, 53248
ds_read_b64_tr_b16 a[212:213], v205 offset:0
ds_read_b64_tr_b16 a[214:215], v205 offset:4096
v_mfma_f32_16x16x32_bf16 v[192:195], a[216:219], a[124:127], v[192:195]
s_add_u32 s48, s44, 239616
ds_read_b64_tr_b16 a[216:217], v206 offset:0
ds_read_b64_tr_b16 a[218:219], v206 offset:4096
v_mfma_f32_16x16x32_bf16 v[164:167], a[220:223], a[120:123], v[164:167]
buffer_load_dwordx4 v236, s[16:19], s48 offen lds
v_mfma_f32_16x16x32_bf16 v[196:199], a[220:223], a[124:127], v[196:199]
s_waitcnt lgkmcnt(12)
ds_read_b64_tr_b16 a[220:221], v207 offset:0
ds_read_b64_tr_b16 a[222:223], v207 offset:4096
s_waitcnt vmcnt(6)
s_waitcnt vmcnt(14)
s_lshl_b32 s46, s33, 2
s_add_u32 s46, s46, s86
s_mov_b64 exec, 1
buffer_store_dword v5, v234, s[20:23], s46 offen sc0 sc1
s_mov_b64 exec, -1
v_mfma_f32_16x16x32_bf16 v[136:139], a[192:195], a[128:131], v[136:139]
s_add_u32 m0, s3, 57344
v_mfma_f32_16x16x32_bf16 v[168:171], a[192:195], a[132:135], v[168:171]
s_waitcnt lgkmcnt(12)
s_add_u32 s48, s44, 258048
ds_read_b64_tr_b16 a[192:193], v200 offset:8192
ds_read_b64_tr_b16 a[194:195], v200 offset:12288
v_mfma_f32_16x16x32_bf16 v[140:143], a[196:199], a[128:131], v[140:143]
s_waitcnt lgkmcnt(12)
buffer_load_dwordx4 v236, s[16:19], s48 offen lds
v_mfma_f32_16x16x32_bf16 v[172:175], a[196:199], a[132:135], v[172:175]
s_add_u32 m0, s3, 61440
ds_read_b64_tr_b16 a[196:197], v201 offset:8192
ds_read_b64_tr_b16 a[198:199], v201 offset:12288
v_mfma_f32_16x16x32_bf16 v[144:147], a[200:203], a[128:131], v[144:147]
s_add_u32 s48, s44, 276480
v_mfma_f32_16x16x32_bf16 v[176:179], a[200:203], a[132:135], v[176:179]
s_waitcnt lgkmcnt(10)
buffer_load_dwordx4 v236, s[16:19], s48 offen lds
v_mfma_f32_16x16x32_bf16 v[148:151], a[204:207], a[128:131], v[148:151]
ds_read_b64_tr_b16 a[200:201], v202 offset:8192
ds_read_b64_tr_b16 a[202:203], v202 offset:12288
v_mfma_f32_16x16x32_bf16 v[180:183], a[204:207], a[132:135], v[180:183]
s_add_u32 s94, s92, 8192
ds_read_b64_tr_b16 a[204:205], v203 offset:8192
ds_read_b64_tr_b16 a[206:207], v203 offset:12288
v_mfma_f32_16x16x32_bf16 v[152:155], a[208:211], a[128:131], v[152:155]
buffer_load_dwordx4 a[160:163], v234, s[20:23], s94 offen offset:0 sc0 sc1
v_mfma_f32_16x16x32_bf16 v[184:187], a[208:211], a[132:135], v[184:187]
s_waitcnt lgkmcnt(8)
ds_read_b64_tr_b16 a[208:209], v204 offset:8192
ds_read_b64_tr_b16 a[210:211], v204 offset:12288
v_mfma_f32_16x16x32_bf16 v[156:159], a[212:215], a[128:131], v[156:159]
s_add_u32 s94, s92, 8192
v_mfma_f32_16x16x32_bf16 v[188:191], a[212:215], a[132:135], v[188:191]
buffer_load_dwordx4 a[164:167], v234, s[20:23], s94 offen offset:1024 sc0 sc1
v_mfma_f32_16x16x32_bf16 v[160:163], a[216:219], a[128:131], v[160:163]
ds_read_b64_tr_b16 a[212:213], v205 offset:8192
ds_read_b64_tr_b16 a[214:215], v205 offset:12288
v_mfma_f32_16x16x32_bf16 v[192:195], a[216:219], a[132:135], v[192:195]
ds_read_b64_tr_b16 a[216:217], v206 offset:8192
ds_read_b64_tr_b16 a[218:219], v206 offset:12288
v_mfma_f32_16x16x32_bf16 v[164:167], a[220:223], a[128:131], v[164:167]
v_mfma_f32_16x16x32_bf16 v[196:199], a[220:223], a[132:135], v[196:199]
s_waitcnt lgkmcnt(10)
ds_read_b64_tr_b16 a[220:221], v207 offset:8192
ds_read_b64_tr_b16 a[222:223], v207 offset:12288
v_mfma_f32_16x16x32_bf16 v[136:139], a[192:195], a[136:139], v[136:139]
s_add_u32 s94, s92, 8192
v_mfma_f32_16x16x32_bf16 v[168:171], a[192:195], a[140:143], v[168:171]
buffer_load_dwordx4 a[168:171], v234, s[20:23], s94 offen offset:2048 sc0 sc1
v_mfma_f32_16x16x32_bf16 v[140:143], a[196:199], a[136:139], v[140:143]
s_add_u32 s94, s92, 8192
ds_read_b64_tr_b16 a[192:193], v200 offset:16384
ds_read_b64_tr_b16 a[194:195], v200 offset:20480
v_mfma_f32_16x16x32_bf16 v[172:175], a[196:199], a[140:143], v[172:175]
s_waitcnt lgkmcnt(8)
buffer_load_dwordx4 a[172:175], v234, s[20:23], s94 offen offset:3072 sc0 sc1
v_mfma_f32_16x16x32_bf16 v[144:147], a[200:203], a[136:139], v[144:147]
ds_read_b64_tr_b16 a[196:197], v201 offset:16384
ds_read_b64_tr_b16 a[198:199], v201 offset:20480
v_mfma_f32_16x16x32_bf16 v[176:179], a[200:203], a[140:143], v[176:179]
s_add_u32 s94, s92, 12288
ds_read_b64_tr_b16 a[200:201], v202 offset:16384
ds_read_b64_tr_b16 a[202:203], v202 offset:20480
v_mfma_f32_16x16x32_bf16 v[148:151], a[204:207], a[136:139], v[148:151]
buffer_load_dwordx4 a[176:179], v234, s[20:23], s94 offen offset:0 sc0 sc1
v_mfma_f32_16x16x32_bf16 v[180:183], a[204:207], a[140:143], v[180:183]
ds_read_b64_tr_b16 a[204:205], v203 offset:16384
ds_read_b64_tr_b16 a[206:207], v203 offset:20480
v_mfma_f32_16x16x32_bf16 v[152:155], a[208:211], a[136:139], v[152:155]
s_add_u32 s94, s92, 12288
v_mfma_f32_16x16x32_bf16 v[184:187], a[208:211], a[140:143], v[184:187]
s_waitcnt lgkmcnt(8)
buffer_load_dwordx4 a[180:183], v234, s[20:23], s94 offen offset:1024 sc0 sc1
v_mfma_f32_16x16x32_bf16 v[156:159], a[212:215], a[136:139], v[156:159]
ds_read_b64_tr_b16 a[208:209], v204 offset:16384
ds_read_b64_tr_b16 a[210:211], v204 offset:20480
v_mfma_f32_16x16x32_bf16 v[188:191], a[212:215], a[140:143], v[188:191]
s_add_u32 s94, s92, 12288
ds_read_b64_tr_b16 a[212:213], v205 offset:16384
ds_read_b64_tr_b16 a[214:215], v205 offset:20480
v_mfma_f32_16x16x32_bf16 v[160:163], a[216:219], a[136:139], v[160:163]
buffer_load_dwordx4 a[184:187], v234, s[20:23], s94 offen offset:2048 sc0 sc1
v_mfma_f32_16x16x32_bf16 v[192:195], a[216:219], a[140:143], v[192:195]
ds_read_b64_tr_b16 a[216:217], v206 offset:16384
ds_read_b64_tr_b16 a[218:219], v206 offset:20480
v_mfma_f32_16x16x32_bf16 v[164:167], a[220:223], a[136:139], v[164:167]
v_mfma_f32_16x16x32_bf16 v[196:199], a[220:223], a[140:143], v[196:199]
s_waitcnt lgkmcnt(8)
ds_read_b64_tr_b16 a[220:221], v207 offset:16384
ds_read_b64_tr_b16 a[222:223], v207 offset:20480
v_mfma_f32_16x16x32_bf16 v[136:139], a[192:195], a[144:147], v[136:139]
s_add_u32 s94, s92, 12288
v_mfma_f32_16x16x32_bf16 v[168:171], a[192:195], a[148:151], v[168:171]
buffer_load_dwordx4 a[188:191], v234, s[20:23], s94 offen offset:3072 sc0 sc1
v_mfma_f32_16x16x32_bf16 v[140:143], a[196:199], a[144:147], v[140:143]
ds_read_b64_tr_b16 a[192:193], v200 offset:24576
ds_read_b64_tr_b16 a[194:195], v200 offset:28672
v_mfma_f32_16x16x32_bf16 v[172:175], a[196:199], a[148:151], v[172:175]
ds_read_b64_tr_b16 a[196:197], v201 offset:24576
ds_read_b64_tr_b16 a[198:199], v201 offset:28672
v_mfma_f32_16x16x32_bf16 v[144:147], a[200:203], a[144:147], v[144:147]
v_mfma_f32_16x16x32_bf16 v[176:179], a[200:203], a[148:151], v[176:179]
s_waitcnt lgkmcnt(8)
ds_read_b64_tr_b16 a[200:201], v202 offset:24576
ds_read_b64_tr_b16 a[202:203], v202 offset:28672
v_mfma_f32_16x16x32_bf16 v[148:151], a[204:207], a[144:147], v[148:151]
v_mfma_f32_16x16x32_bf16 v[180:183], a[204:207], a[148:151], v[180:183]
ds_read_b64_tr_b16 a[204:205], v203 offset:24576
ds_read_b64_tr_b16 a[206:207], v203 offset:28672
v_mfma_f32_16x16x32_bf16 v[152:155], a[208:211], a[144:147], v[152:155]
v_mfma_f32_16x16x32_bf16 v[184:187], a[208:211], a[148:151], v[184:187]
ds_read_b64_tr_b16 a[208:209], v204 offset:24576
ds_read_b64_tr_b16 a[210:211], v204 offset:28672
v_mfma_f32_16x16x32_bf16 v[156:159], a[212:215], a[144:147], v[156:159]
v_mfma_f32_16x16x32_bf16 v[188:191], a[212:215], a[148:151], v[188:191]
s_waitcnt lgkmcnt(10)
ds_read_b64_tr_b16 a[212:213], v205 offset:24576
ds_read_b64_tr_b16 a[214:215], v205 offset:28672
v_mfma_f32_16x16x32_bf16 v[160:163], a[216:219], a[144:147], v[160:163]
v_mfma_f32_16x16x32_bf16 v[192:195], a[216:219], a[148:151], v[192:195]
ds_read_b64_tr_b16 a[216:217], v206 offset:24576
ds_read_b64_tr_b16 a[218:219], v206 offset:28672
v_mfma_f32_16x16x32_bf16 v[164:167], a[220:223], a[144:147], v[164:167]
v_mfma_f32_16x16x32_bf16 v[196:199], a[220:223], a[148:151], v[196:199]
s_waitcnt lgkmcnt(8)
ds_read_b64_tr_b16 a[220:221], v207 offset:24576
ds_read_b64_tr_b16 a[222:223], v207 offset:28672
v_mfma_f32_16x16x32_bf16 v[136:139], a[192:195], a[152:155], v[136:139]
v_mfma_f32_16x16x32_bf16 v[168:171], a[192:195], a[156:159], v[168:171]
v_mfma_f32_16x16x32_bf16 v[140:143], a[196:199], a[152:155], v[140:143]
v_mfma_f32_16x16x32_bf16 v[172:175], a[196:199], a[156:159], v[172:175]
v_mfma_f32_16x16x32_bf16 v[144:147], a[200:203], a[152:155], v[144:147]
s_waitcnt vmcnt(8) lgkmcnt(0)
s_barrier
v_mfma_f32_16x16x32_bf16 v[176:179], a[200:203], a[156:159], v[176:179]
ds_read_b64_tr_b16 a[192:193], v200 offset:32768
ds_read_b64_tr_b16 a[194:195], v200 offset:36864
v_mfma_f32_16x16x32_bf16 v[148:151], a[204:207], a[152:155], v[148:151]
ds_read_b64_tr_b16 a[196:197], v201 offset:32768
ds_read_b64_tr_b16 a[198:199], v201 offset:36864
v_mfma_f32_16x16x32_bf16 v[180:183], a[204:207], a[156:159], v[180:183]
ds_read_b64_tr_b16 a[200:201], v202 offset:32768
ds_read_b64_tr_b16 a[202:203], v202 offset:36864
v_mfma_f32_16x16x32_bf16 v[152:155], a[208:211], a[152:155], v[152:155]
ds_read_b64_tr_b16 a[204:205], v203 offset:32768
ds_read_b64_tr_b16 a[206:207], v203 offset:36864
v_mfma_f32_16x16x32_bf16 v[184:187], a[208:211], a[156:159], v[184:187]
ds_read_b64_tr_b16 a[208:209], v204 offset:32768
ds_read_b64_tr_b16 a[210:211], v204 offset:36864
v_mfma_f32_16x16x32_bf16 v[156:159], a[212:215], a[152:155], v[156:159]
v_mfma_f32_16x16x32_bf16 v[188:191], a[212:215], a[156:159], v[188:191]
ds_read_b64_tr_b16 a[212:213], v205 offset:32768
ds_read_b64_tr_b16 a[214:215], v205 offset:36864
v_mfma_f32_16x16x32_bf16 v[160:163], a[216:219], a[152:155], v[160:163]
v_mfma_f32_16x16x32_bf16 v[192:195], a[216:219], a[156:159], v[192:195]
ds_read_b64_tr_b16 a[216:217], v206 offset:32768
ds_read_b64_tr_b16 a[218:219], v206 offset:36864
v_mfma_f32_16x16x32_bf16 v[164:167], a[220:223], a[152:155], v[164:167]
v_mfma_f32_16x16x32_bf16 v[196:199], a[220:223], a[156:159], v[196:199]
s_waitcnt lgkmcnt(12)
ds_read_b64_tr_b16 a[220:221], v207 offset:32768
ds_read_b64_tr_b16 a[222:223], v207 offset:36864
s_waitcnt vmcnt(0)
v_mfma_f32_16x16x32_bf16 v[136:139], a[192:195], a[160:163], v[136:139]
v_mfma_f32_16x16x32_bf16 v[168:171], a[192:195], a[164:167], v[168:171]
s_waitcnt lgkmcnt(10)
ds_read_b64_tr_b16 a[192:193], v200 offset:40960
ds_read_b64_tr_b16 a[194:195], v200 offset:45056
v_mfma_f32_16x16x32_bf16 v[140:143], a[196:199], a[160:163], v[140:143]
v_mfma_f32_16x16x32_bf16 v[172:175], a[196:199], a[164:167], v[172:175]
ds_read_b64_tr_b16 a[196:197], v201 offset:40960
ds_read_b64_tr_b16 a[198:199], v201 offset:45056
v_mfma_f32_16x16x32_bf16 v[144:147], a[200:203], a[160:163], v[144:147]
v_mfma_f32_16x16x32_bf16 v[176:179], a[200:203], a[164:167], v[176:179]
s_waitcnt lgkmcnt(8)
ds_read_b64_tr_b16 a[200:201], v202 offset:40960
ds_read_b64_tr_b16 a[202:203], v202 offset:45056
v_mfma_f32_16x16x32_bf16 v[148:151], a[204:207], a[160:163], v[148:151]
v_mfma_f32_16x16x32_bf16 v[180:183], a[204:207], a[164:167], v[180:183]
ds_read_b64_tr_b16 a[204:205], v203 offset:40960
ds_read_b64_tr_b16 a[206:207], v203 offset:45056
v_mfma_f32_16x16x32_bf16 v[152:155], a[208:211], a[160:163], v[152:155]
v_mfma_f32_16x16x32_bf16 v[184:187], a[208:211], a[164:167], v[184:187]
ds_read_b64_tr_b16 a[208:209], v204 offset:40960
ds_read_b64_tr_b16 a[210:211], v204 offset:45056
v_mfma_f32_16x16x32_bf16 v[156:159], a[212:215], a[160:163], v[156:159]
v_mfma_f32_16x16x32_bf16 v[188:191], a[212:215], a[164:167], v[188:191]
s_waitcnt lgkmcnt(8)
ds_read_b64_tr_b16 a[212:213], v205 offset:40960
ds_read_b64_tr_b16 a[214:215], v205 offset:45056
v_mfma_f32_16x16x32_bf16 v[160:163], a[216:219], a[160:163], v[160:163]
v_mfma_f32_16x16x32_bf16 v[192:195], a[216:219], a[164:167], v[192:195]
ds_read_b64_tr_b16 a[216:217], v206 offset:40960
ds_read_b64_tr_b16 a[218:219], v206 offset:45056
v_mfma_f32_16x16x32_bf16 v[164:167], a[220:223], a[160:163], v[164:167]
v_mfma_f32_16x16x32_bf16 v[196:199], a[220:223], a[164:167], v[196:199]
ds_read_b64_tr_b16 a[220:221], v207 offset:40960
ds_read_b64_tr_b16 a[222:223], v207 offset:45056
v_cmp_gt_u32 vcc, 16, v248
v_lshlrev_b32 v6, 7, v3
v_add_u32 v6, 0x272800, v6
s_and_b32 s93, vcc_lo, 0xff
s_cselect_b32 s47, 0, 0x7f000000
v_mfma_f32_16x16x32_bf16 v[136:139], a[192:195], a[168:171], v[136:139]
buffer_load_dword v246, v7, s[20:23], s86 offen sc0 sc1
v_mfma_f32_16x16x32_bf16 v[168:171], a[192:195], a[172:175], v[168:171]
s_waitcnt lgkmcnt(8)
ds_read_b64_tr_b16 a[192:193], v200 offset:49152
ds_read_b64_tr_b16 a[194:195], v200 offset:53248
v_mfma_f32_16x16x32_bf16 v[140:143], a[196:199], a[168:171], v[140:143]
v_mfma_f32_16x16x32_bf16 v[172:175], a[196:199], a[172:175], v[172:175]
ds_read_b64_tr_b16 a[196:197], v201 offset:49152
ds_read_b64_tr_b16 a[198:199], v201 offset:53248
v_mfma_f32_16x16x32_bf16 v[144:147], a[200:203], a[168:171], v[144:147]
buffer_load_dword v247, v6, s[20:23], s47 offen sc0 sc1
v_mfma_f32_16x16x32_bf16 v[176:179], a[200:203], a[172:175], v[176:179]
ds_read_b64_tr_b16 a[200:201], v202 offset:49152
ds_read_b64_tr_b16 a[202:203], v202 offset:53248
v_mfma_f32_16x16x32_bf16 v[148:151], a[204:207], a[168:171], v[148:151]
v_mfma_f32_16x16x32_bf16 v[180:183], a[204:207], a[172:175], v[180:183]
s_waitcnt lgkmcnt(8)
ds_read_b64_tr_b16 a[204:205], v203 offset:49152
ds_read_b64_tr_b16 a[206:207], v203 offset:53248
v_mfma_f32_16x16x32_bf16 v[152:155], a[208:211], a[168:171], v[152:155]
v_mfma_f32_16x16x32_bf16 v[184:187], a[208:211], a[172:175], v[184:187]
ds_read_b64_tr_b16 a[208:209], v204 offset:49152
ds_read_b64_tr_b16 a[210:211], v204 offset:53248
v_mfma_f32_16x16x32_bf16 v[156:159], a[212:215], a[168:171], v[156:159]
v_mfma_f32_16x16x32_bf16 v[188:191], a[212:215], a[172:175], v[188:191]
ds_read_b64_tr_b16 a[212:213], v205 offset:49152
ds_read_b64_tr_b16 a[214:215], v205 offset:53248
v_mfma_f32_16x16x32_bf16 v[160:163], a[216:219], a[168:171], v[160:163]
v_mfma_f32_16x16x32_bf16 v[192:195], a[216:219], a[172:175], v[192:195]
s_waitcnt lgkmcnt(8)
ds_read_b64_tr_b16 a[216:217], v206 offset:49152
ds_read_b64_tr_b16 a[218:219], v206 offset:53248
v_mfma_f32_16x16x32_bf16 v[164:167], a[220:223], a[168:171], v[164:167]
v_mfma_f32_16x16x32_bf16 v[196:199], a[220:223], a[172:175], v[196:199]
ds_read_b64_tr_b16 a[220:221], v207 offset:49152
ds_read_b64_tr_b16 a[222:223], v207 offset:53248
v_mfma_f32_16x16x32_bf16 v[136:139], a[192:195], a[176:179], v[136:139]
v_mfma_f32_16x16x32_bf16 v[168:171], a[192:195], a[180:183], v[168:171]
ds_read_b64_tr_b16 a[192:193], v200 offset:57344
ds_read_b64_tr_b16 a[194:195], v200 offset:61440
v_mfma_f32_16x16x32_bf16 v[140:143], a[196:199], a[176:179], v[140:143]
v_mfma_f32_16x16x32_bf16 v[172:175], a[196:199], a[180:183], v[172:175]
s_waitcnt lgkmcnt(8)
ds_read_b64_tr_b16 a[196:197], v201 offset:57344
ds_read_b64_tr_b16 a[198:199], v201 offset:61440
v_mfma_f32_16x16x32_bf16 v[144:147], a[200:203], a[176:179], v[144:147]
v_mfma_f32_16x16x32_bf16 v[176:179], a[200:203], a[180:183], v[176:179]
ds_read_b64_tr_b16 a[200:201], v202 offset:57344
ds_read_b64_tr_b16 a[202:203], v202 offset:61440
v_mfma_f32_16x16x32_bf16 v[148:151], a[204:207], a[176:179], v[148:151]
v_mfma_f32_16x16x32_bf16 v[180:183], a[204:207], a[180:183], v[180:183]
ds_read_b64_tr_b16 a[204:205], v203 offset:57344
ds_read_b64_tr_b16 a[206:207], v203 offset:61440
v_mfma_f32_16x16x32_bf16 v[152:155], a[208:211], a[176:179], v[152:155]
v_mfma_f32_16x16x32_bf16 v[184:187], a[208:211], a[180:183], v[184:187]
s_waitcnt lgkmcnt(8)
ds_read_b64_tr_b16 a[208:209], v204 offset:57344
ds_read_b64_tr_b16 a[210:211], v204 offset:61440
v_mfma_f32_16x16x32_bf16 v[156:159], a[212:215], a[176:179], v[156:159]
v_mfma_f32_16x16x32_bf16 v[188:191], a[212:215], a[180:183], v[188:191]
ds_read_b64_tr_b16 a[212:213], v205 offset:57344
ds_read_b64_tr_b16 a[214:215], v205 offset:61440
v_mfma_f32_16x16x32_bf16 v[160:163], a[216:219], a[176:179], v[160:163]
v_mfma_f32_16x16x32_bf16 v[192:195], a[216:219], a[180:183], v[192:195]
ds_read_b64_tr_b16 a[216:217], v206 offset:57344
ds_read_b64_tr_b16 a[218:219], v206 offset:61440
v_mfma_f32_16x16x32_bf16 v[164:167], a[220:223], a[176:179], v[164:167]
v_mfma_f32_16x16x32_bf16 v[196:199], a[220:223], a[180:183], v[196:199]
s_waitcnt lgkmcnt(8)
ds_read_b64_tr_b16 a[220:221], v207 offset:57344
ds_read_b64_tr_b16 a[222:223], v207 offset:61440
v_mfma_f32_16x16x32_bf16 v[136:139], a[192:195], a[184:187], v[136:139]
v_mfma_f32_16x16x32_bf16 v[168:171], a[192:195], a[188:191], v[168:171]
v_mfma_f32_16x16x32_bf16 v[140:143], a[196:199], a[184:187], v[140:143]
v_mfma_f32_16x16x32_bf16 v[172:175], a[196:199], a[188:191], v[172:175]
v_mfma_f32_16x16x32_bf16 v[144:147], a[200:203], a[184:187], v[144:147]
v_mfma_f32_16x16x32_bf16 v[176:179], a[200:203], a[188:191], v[176:179]
s_waitcnt lgkmcnt(4)
v_mfma_f32_16x16x32_bf16 v[148:151], a[204:207], a[184:187], v[148:151]
v_mfma_f32_16x16x32_bf16 v[180:183], a[204:207], a[188:191], v[180:183]
v_mfma_f32_16x16x32_bf16 v[152:155], a[208:211], a[184:187], v[152:155]
v_mfma_f32_16x16x32_bf16 v[184:187], a[208:211], a[188:191], v[184:187]
v_mfma_f32_16x16x32_bf16 v[156:159], a[212:215], a[184:187], v[156:159]
v_mfma_f32_16x16x32_bf16 v[188:191], a[212:215], a[188:191], v[188:191]
s_waitcnt lgkmcnt(0)
v_mfma_f32_16x16x32_bf16 v[160:163], a[216:219], a[184:187], v[160:163]
v_mfma_f32_16x16x32_bf16 v[192:195], a[216:219], a[188:191], v[192:195]
v_mfma_f32_16x16x32_bf16 v[164:167], a[220:223], a[184:187], v[164:167]
v_mfma_f32_16x16x32_bf16 v[196:199], a[220:223], a[188:191], v[196:199]
s_lshl_b32 s95, s35, 2
s_add_u32 s95, s95, s63
s_lshl_b32 s46, s35, 7
s_add_u32 s63, s63, s46
v_cvt_pk_bf16_f32 v200, v168, v169
v_cvt_pk_bf16_f32 v201, v170, v171
v_cvt_pk_bf16_f32 v202, v172, v173
v_cvt_pk_bf16_f32 v203, v174, v175
buffer_store_dwordx4 v[200:203], v234, s[20:23], s65 offen offset:0 sc0 sc1
v_cvt_pk_bf16_f32 v204, v176, v177
v_cvt_pk_bf16_f32 v205, v178, v179
v_cvt_pk_bf16_f32 v206, v180, v181
v_cvt_pk_bf16_f32 v207, v182, v183
buffer_store_dwordx4 v[204:207], v234, s[20:23], s65 offen offset:1024 sc0 sc1
v_cvt_pk_bf16_f32 v208, v152, v153
v_cvt_pk_bf16_f32 v209, v154, v155
v_cvt_pk_bf16_f32 v210, v156, v157
v_cvt_pk_bf16_f32 v211, v158, v159
buffer_store_dwordx4 v[208:211], v234, s[20:23], s64 offen offset:0 sc0 sc1
v_cvt_pk_bf16_f32 v212, v160, v161
v_cvt_pk_bf16_f32 v213, v162, v163
v_cvt_pk_bf16_f32 v214, v164, v165
v_cvt_pk_bf16_f32 v215, v166, v167
buffer_store_dwordx4 v[212:215], v234, s[20:23], s64 offen offset:1024 sc0 sc1
v_cvt_pk_bf16_f32 v216, v184, v185
v_cvt_pk_bf16_f32 v217, v186, v187
v_cvt_pk_bf16_f32 v218, v188, v189
v_cvt_pk_bf16_f32 v219, v190, v191
buffer_store_dwordx4 v[216:219], v234, s[20:23], s66 offen offset:0 sc0 sc1
v_cvt_pk_bf16_f32 v220, v192, v193
v_cvt_pk_bf16_f32 v221, v194, v195
v_cvt_pk_bf16_f32 v222, v196, v197
v_cvt_pk_bf16_f32 v223, v198, v199
buffer_store_dwordx4 v[220:223], v234, s[20:23], s66 offen offset:1024 sc0 sc1
s_waitcnt vmcnt(6)
v_cmp_ne_u32 vcc, 1, v246
s_and_b32 s46, s35, 1
s_or_b32 s46, s46, vcc_lo
s_cselect_b32 s67, 0, 1
s_cbranch_scc1 K_NOER
s_add_u32 s48, s87, 4096
buffer_load_dwordx2 v[40:41], v250, s[20:23], s87 offen offset:0 sc0 sc1
buffer_load_dwordx2 v[42:43], v250, s[20:23], s87 offen offset:512 sc0 sc1
buffer_load_dwordx2 v[44:45], v250, s[20:23], s87 offen offset:1024 sc0 sc1
buffer_load_dwordx2 v[46:47], v250, s[20:23], s87 offen offset:1536 sc0 sc1
buffer_load_dwordx2 v[48:49], v250, s[20:23], s87 offen offset:2048 sc0 sc1
buffer_load_dwordx2 v[50:51], v250, s[20:23], s87 offen offset:2560 sc0 sc1
buffer_load_dwordx2 v[52:53], v250, s[20:23], s87 offen offset:3072 sc0 sc1
buffer_load_dwordx2 v[54:55], v250, s[20:23], s87 offen offset:3584 sc0 sc1
buffer_load_dwordx2 v[56:57], v250, s[20:23], s48 offen offset:0 sc0 sc1
buffer_load_dwordx2 v[58:59], v250, s[20:23], s48 offen offset:512 sc0 sc1
buffer_load_dwordx2 v[60:61], v250, s[20:23], s48 offen offset:1024 sc0 sc1
buffer_load_dwordx2 v[62:63], v250, s[20:23], s48 offen offset:1536 sc0 sc1
buffer_load_dwordx2 v[64:65], v250, s[20:23], s48 offen offset:2048 sc0 sc1
buffer_load_dwordx2 v[66:67], v250, s[20:23], s48 offen offset:2560 sc0 sc1
buffer_load_dwordx2 v[68:69], v250, s[20:23], s48 offen offset:3072 sc0 sc1
buffer_load_dwordx2 v[70:71], v250, s[20:23], s48 offen offset:3584 sc0 sc1
K_NOER:
v_lshlrev_b32 v30, 16, v120
v_and_b32 v31, s56, v120
v_lshlrev_b32 v32, 16, v121
v_and_b32 v33, s56, v121
v_pk_add_f32 v[30:31], v[30:31], v[130:131] op_sel_hi:[1,0] neg_lo:[0,1] neg_hi:[0,1]
v_pk_add_f32 v[32:33], v[32:33], v[130:131] op_sel_hi:[1,0] neg_lo:[0,1] neg_hi:[0,1]
v_cvt_pk_bf16_f32 v28, v30, v31
v_cvt_pk_bf16_f32 v29, v32, v33
v_lshlrev_b32 v30, 16, v28
v_and_b32 v31, s56, v28
v_lshlrev_b32 v32, 16, v29
v_and_b32 v33, s56, v29
v_pk_mul_f32 v[8:9], v[30:31], v[132:133] op_sel_hi:[1,0]
v_pk_mul_f32 v[10:11], v[32:33], v[132:133] op_sel_hi:[1,0]
v_pk_fma_f32 v[30:31], v[8:9], v[130:131], v[30:31] op_sel:[0,1,0] op_sel_hi:[1,1,1] neg_lo:[1,0,0] neg_hi:[1,0,0]
v_pk_fma_f32 v[32:33], v[10:11], v[130:131], v[32:33] op_sel:[0,1,0] op_sel_hi:[1,1,1] neg_lo:[1,0,0] neg_hi:[1,0,0]
v_pk_fma_f32 v[8:9], v[30:31], v[132:133], v[8:9] op_sel_hi:[1,0,1]
v_pk_fma_f32 v[10:11], v[32:33], v[132:133], v[10:11] op_sel_hi:[1,0,1]
v_cvt_pk_bf16_f32 v28, v8, v9
v_cvt_pk_bf16_f32 v29, v10, v11
v_lshlrev_b32 v8, 16, v28
v_and_b32 v9, s56, v28
v_lshlrev_b32 v10, 16, v29
v_and_b32 v11, s56, v29
v_mul_f32 v30, s57, v8
v_mul_f32 v31, s57, v9
v_mul_f32 v32, s57, v10
v_mul_f32 v33, s57, v11
v_exp_f32 v30, v30
v_exp_f32 v31, v31
v_exp_f32 v32, v32
v_exp_f32 v33, v33
s_nop 0
v_add_f32 v30, 1.0, v30
v_add_f32 v31, 1.0, v31
v_add_f32 v32, 1.0, v32
v_add_f32 v33, 1.0, v33
v_rcp_f32 v30, v30
v_rcp_f32 v31, v31
v_rcp_f32 v32, v32
v_rcp_f32 v33, v33
s_nop 0
v_pk_mul_f32 v[8:9], v[8:9], v[30:31]
v_pk_mul_f32 v[10:11], v[10:11], v[32:33]
v_cvt_pk_bf16_f32 v28, v8, v9
v_cvt_pk_bf16_f32 v29, v10, v11
v_lshlrev_b32 v8, 16, v28
v_and_b32 v9, s56, v28
v_lshlrev_b32 v10, 16, v29
v_and_b32 v11, s56, v29
v_lshlrev_b32 v30, 16, v122
v_and_b32 v31, s56, v122
v_lshlrev_b32 v32, 16, v123
v_and_b32 v33, s56, v123
v_pk_add_f32 v[30:31], v[30:31], v[130:131] op_sel_hi:[1,0] neg_lo:[0,1] neg_hi:[0,1]
v_pk_add_f32 v[32:33], v[32:33], v[130:131] op_sel_hi:[1,0] neg_lo:[0,1] neg_hi:[0,1]
v_cvt_pk_bf16_f32 v28, v30, v31
v_cvt_pk_bf16_f32 v29, v32, v33
v_lshlrev_b32 v30, 16, v28
v_and_b32 v31, s56, v28
v_lshlrev_b32 v32, 16, v29
v_and_b32 v33, s56, v29
v_pk_mul_f32 v[12:13], v[30:31], v[132:133] op_sel_hi:[1,0]
v_pk_mul_f32 v[14:15], v[32:33], v[132:133] op_sel_hi:[1,0]
v_pk_fma_f32 v[30:31], v[12:13], v[130:131], v[30:31] op_sel:[0,1,0] op_sel_hi:[1,1,1] neg_lo:[1,0,0] neg_hi:[1,0,0]
v_pk_fma_f32 v[32:33], v[14:15], v[130:131], v[32:33] op_sel:[0,1,0] op_sel_hi:[1,1,1] neg_lo:[1,0,0] neg_hi:[1,0,0]
v_pk_fma_f32 v[12:13], v[30:31], v[132:133], v[12:13] op_sel_hi:[1,0,1]
v_pk_fma_f32 v[14:15], v[32:33], v[132:133], v[14:15] op_sel_hi:[1,0,1]
v_cvt_pk_bf16_f32 v28, v12, v13
v_cvt_pk_bf16_f32 v29, v14, v15
v_lshlrev_b32 v12, 16, v28
v_and_b32 v13, s56, v28
v_lshlrev_b32 v14, 16, v29
v_and_b32 v15, s56, v29
v_mul_f32 v30, s57, v12
v_mul_f32 v31, s57, v13
v_mul_f32 v32, s57, v14
v_mul_f32 v33, s57, v15
v_exp_f32 v30, v30
v_exp_f32 v31, v31
v_exp_f32 v32, v32
v_exp_f32 v33, v33
s_nop 0
v_add_f32 v30, 1.0, v30
v_add_f32 v31, 1.0, v31
v_add_f32 v32, 1.0, v32
v_add_f32 v33, 1.0, v33
v_rcp_f32 v30, v30
v_rcp_f32 v31, v31
v_rcp_f32 v32, v32
v_rcp_f32 v33, v33
s_nop 0
v_pk_mul_f32 v[12:13], v[12:13], v[30:31]
v_pk_mul_f32 v[14:15], v[14:15], v[32:33]
v_cvt_pk_bf16_f32 v28, v12, v13
v_cvt_pk_bf16_f32 v29, v14, v15
v_lshlrev_b32 v12, 16, v28
v_and_b32 v13, s56, v28
v_lshlrev_b32 v14, 16, v29
v_and_b32 v15, s56, v29
s_mov_b32 s47, s67
s_and_b32 s46, s35, 1
s_or_b32 s67, s67, s46
s_cselect_b32 s46, 0, 16
v_and_b32 v153, 3, v1
v_lshl_add_u32 v153, v153, 2, s63
v_add_u32 v7, s86, v7
v_cmp_gt_u32 vcc, s46, v1
s_add_u32 s48, s35, 16
s_nop 0
v_cndmask_b32 v152, v153, v7, vcc
s_waitcnt vmcnt(16)
s_cmp_lg_u32 s47, 0
s_cbranch_scc1 K_FLAGGED
s_waitcnt vmcnt(0)
K_FLAGGED:
buffer_load_dword v246, v152, s[20:23], 0 offen sc0 sc1
s_mov_b32 exec_lo, s38
s_mov_b32 exec_hi, 0
buffer_store_dword v5, v249, s[20:23], s95 offen sc0 sc1
s_mov_b64 exec, -1
v_lshlrev_b32 v30, 16, v124
v_and_b32 v31, s56, v124
v_lshlrev_b32 v32, 16, v125
v_and_b32 v33, s56, v125
v_pk_add_f32 v[30:31], v[30:31], v[130:131] op_sel_hi:[1,0] neg_lo:[0,1] neg_hi:[0,1]
v_pk_add_f32 v[32:33], v[32:33], v[130:131] op_sel_hi:[1,0] neg_lo:[0,1] neg_hi:[0,1]
v_cvt_pk_bf16_f32 v28, v30, v31
v_cvt_pk_bf16_f32 v29, v32, v33
v_lshlrev_b32 v30, 16, v28
v_and_b32 v31, s56, v28
v_lshlrev_b32 v32, 16, v29
v_and_b32 v33, s56, v29
v_pk_mul_f32 v[16:17], v[30:31], v[132:133] op_sel_hi:[1,0]
v_pk_mul_f32 v[18:19], v[32:33], v[132:133] op_sel_hi:[1,0]
v_pk_fma_f32 v[30:31], v[16:17], v[130:131], v[30:31] op_sel:[0,1,0] op_sel_hi:[1,1,1] neg_lo:[1,0,0] neg_hi:[1,0,0]
v_pk_fma_f32 v[32:33], v[18:19], v[130:131], v[32:33] op_sel:[0,1,0] op_sel_hi:[1,1,1] neg_lo:[1,0,0] neg_hi:[1,0,0]
v_pk_fma_f32 v[16:17], v[30:31], v[132:133], v[16:17] op_sel_hi:[1,0,1]
v_pk_fma_f32 v[18:19], v[32:33], v[132:133], v[18:19] op_sel_hi:[1,0,1]
v_cvt_pk_bf16_f32 v28, v16, v17
v_cvt_pk_bf16_f32 v29, v18, v19
v_lshlrev_b32 v16, 16, v28
v_and_b32 v17, s56, v28
v_lshlrev_b32 v18, 16, v29
v_and_b32 v19, s56, v29
v_mul_f32 v30, s57, v16
v_mul_f32 v31, s57, v17
v_mul_f32 v32, s57, v18
v_mul_f32 v33, s57, v19
v_exp_f32 v30, v30
v_exp_f32 v31, v31
v_exp_f32 v32, v32
v_exp_f32 v33, v33
s_nop 0
v_add_f32 v30, 1.0, v30
v_add_f32 v31, 1.0, v31
v_add_f32 v32, 1.0, v32
v_add_f32 v33, 1.0, v33
v_rcp_f32 v30, v30
v_rcp_f32 v31, v31
v_rcp_f32 v32, v32
v_rcp_f32 v33, v33
s_nop 0
v_pk_mul_f32 v[16:17], v[16:17], v[30:31]
v_pk_mul_f32 v[18:19], v[18:19], v[32:33]
v_cvt_pk_bf16_f32 v28, v16, v17
v_cvt_pk_bf16_f32 v29, v18, v19
v_lshlrev_b32 v16, 16, v28
v_and_b32 v17, s56, v28
v_lshlrev_b32 v18, 16, v29
v_and_b32 v19, s56, v29
v_lshlrev_b32 v30, 16, v126
v_and_b32 v31, s56, v126
v_lshlrev_b32 v32, 16, v127
v_and_b32 v33, s56, v127
v_pk_add_f32 v[30:31], v[30:31], v[130:131] op_sel_hi:[1,0] neg_lo:[0,1] neg_hi:[0,1]
v_pk_add_f32 v[32:33], v[32:33], v[130:131] op_sel_hi:[1,0] neg_lo:[0,1] neg_hi:[0,1]
v_cvt_pk_bf16_f32 v28, v30, v31
v_cvt_pk_bf16_f32 v29, v32, v33
v_lshlrev_b32 v30, 16, v28
v_and_b32 v31, s56, v28
v_lshlrev_b32 v32, 16, v29
v_and_b32 v33, s56, v29
v_pk_mul_f32 v[20:21], v[30:31], v[132:133] op_sel_hi:[1,0]
v_pk_mul_f32 v[22:23], v[32:33], v[132:133] op_sel_hi:[1,0]
v_pk_fma_f32 v[30:31], v[20:21], v[130:131], v[30:31] op_sel:[0,1,0] op_sel_hi:[1,1,1] neg_lo:[1,0,0] neg_hi:[1,0,0]
v_pk_fma_f32 v[32:33], v[22:23], v[130:131], v[32:33] op_sel:[0,1,0] op_sel_hi:[1,1,1] neg_lo:[1,0,0] neg_hi:[1,0,0]
v_pk_fma_f32 v[20:21], v[30:31], v[132:133], v[20:21] op_sel_hi:[1,0,1]
v_pk_fma_f32 v[22:23], v[32:33], v[132:133], v[22:23] op_sel_hi:[1,0,1]
v_cvt_pk_bf16_f32 v28, v20, v21
v_cvt_pk_bf16_f32 v29, v22, v23
v_lshlrev_b32 v20, 16, v28
v_and_b32 v21, s56, v28
v_lshlrev_b32 v22, 16, v29
v_and_b32 v23, s56, v29
v_mul_f32 v30, s57, v20
v_mul_f32 v31, s57, v21
v_mul_f32 v32, s57, v22
v_mul_f32 v33, s57, v23
v_exp_f32 v30, v30
v_exp_f32 v31, v31
v_exp_f32 v32, v32
v_exp_f32 v33, v33
s_nop 0
v_add_f32 v30, 1.0, v30
v_add_f32 v31, 1.0, v31
v_add_f32 v32, 1.0, v32
v_add_f32 v33, 1.0, v33
v_rcp_f32 v30, v30
v_rcp_f32 v31, v31
v_rcp_f32 v32, v32
v_rcp_f32 v33, v33
s_nop 0
v_pk_mul_f32 v[20:21], v[20:21], v[30:31]
v_pk_mul_f32 v[22:23], v[22:23], v[32:33]
v_cvt_pk_bf16_f32 v28, v20, v21
v_cvt_pk_bf16_f32 v29, v22, v23
v_lshlrev_b32 v20, 16, v28
v_and_b32 v21, s56, v28
v_lshlrev_b32 v22, 16, v29
v_and_b32 v23, s56, v29
v_lshlrev_b32 v30, 16, v128
v_and_b32 v31, s56, v128
v_lshlrev_b32 v32, 16, v129
v_and_b32 v33, s56, v129
v_pk_add_f32 v[30:31], v[30:31], v[130:131] op_sel_hi:[1,0] neg_lo:[0,1] neg_hi:[0,1]
v_pk_add_f32 v[32:33], v[32:33], v[130:131] op_sel_hi:[1,0] neg_lo:[0,1] neg_hi:[0,1]
v_cvt_pk_bf16_f32 v28, v30, v31
v_cvt_pk_bf16_f32 v29, v32, v33
v_lshlrev_b32 v30, 16, v28
v_and_b32 v31, s56, v28
v_lshlrev_b32 v32, 16, v29
v_and_b32 v33, s56, v29
v_pk_mul_f32 v[24:25], v[30:31], v[132:133] op_sel_hi:[1,0]
v_pk_mul_f32 v[26:27], v[32:33], v[132:133] op_sel_hi:[1,0]
v_pk_fma_f32 v[30:31], v[24:25], v[130:131], v[30:31] op_sel:[0,1,0] op_sel_hi:[1,1,1] neg_lo:[1,0,0] neg_hi:[1,0,0]
v_pk_fma_f32 v[32:33], v[26:27], v[130:131], v[32:33] op_sel:[0,1,0] op_sel_hi:[1,1,1] neg_lo:[1,0,0] neg_hi:[1,0,0]
v_pk_fma_f32 v[24:25], v[30:31], v[132:133], v[24:25] op_sel_hi:[1,0,1]
v_pk_fma_f32 v[26:27], v[32:33], v[132:133], v[26:27] op_sel_hi:[1,0,1]
v_cvt_pk_bf16_f32 v28, v24, v25
v_cvt_pk_bf16_f32 v29, v26, v27
v_lshlrev_b32 v24, 16, v28
v_and_b32 v25, s56, v28
v_lshlrev_b32 v26, 16, v29
v_and_b32 v27, s56, v29
v_mul_f32 v30, s57, v24
v_mul_f32 v31, s57, v25
v_mul_f32 v32, s57, v26
v_mul_f32 v33, s57, v27
v_exp_f32 v30, v30
v_exp_f32 v31, v31
v_exp_f32 v32, v32
v_exp_f32 v33, v33
s_nop 0
v_add_f32 v30, 1.0, v30
v_add_f32 v31, 1.0, v31
v_add_f32 v32, 1.0, v32
v_add_f32 v33, 1.0, v33
v_rcp_f32 v30, v30
v_rcp_f32 v31, v31
v_rcp_f32 v32, v32
v_rcp_f32 v33, v33
s_nop 0
v_pk_mul_f32 v[24:25], v[24:25], v[30:31]
v_pk_mul_f32 v[26:27], v[26:27], v[32:33]
v_cvt_pk_bf16_f32 v28, v24, v25
v_cvt_pk_bf16_f32 v29, v26, v27
v_lshlrev_b32 v24, 16, v28
v_and_b32 v25, s56, v28
v_lshlrev_b32 v26, 16, v29
v_and_b32 v27, s56, v29
s_waitcnt vmcnt(2)
v_lshlrev_b32 v36, 16, v40
v_and_b32 v37, s56, v40
v_lshlrev_b32 v38, 16, v41
v_and_b32 v39, s56, v41
v_dot2_f32_bf16 v36, v42, s58, v36
v_dot2_f32_bf16 v37, v42, s59, v37
v_dot2_f32_bf16 v38, v43, s58, v38
v_dot2_f32_bf16 v39, v43, s59, v39
v_dot2_f32_bf16 v36, v44, s58, v36
v_dot2_f32_bf16 v37, v44, s59, v37
v_dot2_f32_bf16 v38, v45, s58, v38
v_dot2_f32_bf16 v39, v45, s59, v39
v_dot2_f32_bf16 v36, v46, s58, v36
v_dot2_f32_bf16 v37, v46, s59, v37
v_dot2_f32_bf16 v38, v47, s58, v38
v_dot2_f32_bf16 v39, v47, s59, v39
v_dot2_f32_bf16 v36, v48, s58, v36
v_dot2_f32_bf16 v37, v48, s59, v37
v_dot2_f32_bf16 v38, v49, s58, v38
v_dot2_f32_bf16 v39, v49, s59, v39
v_dot2_f32_bf16 v36, v50, s58, v36
v_dot2_f32_bf16 v37, v50, s59, v37
v_dot2_f32_bf16 v38, v51, s58, v38
v_dot2_f32_bf16 v39, v51, s59, v39
v_dot2_f32_bf16 v36, v52, s58, v36
v_dot2_f32_bf16 v37, v52, s59, v37
v_dot2_f32_bf16 v38, v53, s58, v38
v_dot2_f32_bf16 v39, v53, s59, v39
v_dot2_f32_bf16 v36, v54, s58, v36
v_dot2_f32_bf16 v37, v54, s59, v37
v_dot2_f32_bf16 v38, v55, s58, v38
v_dot2_f32_bf16 v39, v55, s59, v39
v_dot2_f32_bf16 v36, v56, s58, v36
v_dot2_f32_bf16 v37, v56, s59, v37
v_dot2_f32_bf16 v38, v57, s58, v38
v_dot2_f32_bf16 v39, v57, s59, v39
v_dot2_f32_bf16 v36, v58, s58, v36
v_dot2_f32_bf16 v37, v58, s59, v37
v_dot2_f32_bf16 v38, v59, s58, v38
v_dot2_f32_bf16 v39, v59, s59, v39
v_dot2_f32_bf16 v36, v60, s58, v36
v_dot2_f32_bf16 v37, v60, s59, v37
v_dot2_f32_bf16 v38, v61, s58, v38
v_dot2_f32_bf16 v39, v61, s59, v39
v_dot2_f32_bf16 v36, v62, s58, v36
v_dot2_f32_bf16 v37, v62, s59, v37
v_dot2_f32_bf16 v38, v63, s58, v38
v_dot2_f32_bf16 v39, v63, s59, v39
v_dot2_f32_bf16 v36, v64, s58, v36
v_dot2_f32_bf16 v37, v64, s59, v37
v_dot2_f32_bf16 v38, v65, s58, v38
v_dot2_f32_bf16 v39, v65, s59, v39
v_dot2_f32_bf16 v36, v66, s58, v36
v_dot2_f32_bf16 v37, v66, s59, v37
v_dot2_f32_bf16 v38, v67, s58, v38
v_dot2_f32_bf16 v39, v67, s59, v39
v_dot2_f32_bf16 v36, v68, s58, v36
v_dot2_f32_bf16 v37, v68, s59, v37
v_dot2_f32_bf16 v38, v69, s58, v38
v_dot2_f32_bf16 v39, v69, s59, v39
v_dot2_f32_bf16 v36, v70, s58, v36
v_dot2_f32_bf16 v37, v70, s59, v37
v_dot2_f32_bf16 v38, v71, s58, v38
v_dot2_f32_bf16 v39, v71, s59, v39
s_cmp_lg_u32 s93, 0
s_cbranch_scc1 K_YG
K_YGD:
s_waitcnt vmcnt(1)
s_branch K_XW
K_XPOLL:
s_sleep 2
s_add_u32 s100, s100, 1
s_bitcmp1_b32 s100, 19
s_cbranch_scc1 K_END
buffer_load_dword v246, v152, s[20:23], 0 offen sc0 sc1
s_waitcnt vmcnt(0)
K_XW:
v_writelane_b32 v246, 1, s48
v_cmp_ne_u32 vcc, 1, v246
s_cmp_lg_u32 s67, 0
s_cbranch_scc1 K_XW2
s_and_b32 s46, vcc_lo, 0xffff
s_cbranch_scc1 K_XPOLL
s_add_u32 s46, s87, 4096
s_mov_b32 s67, 2
v_mov_b32 v152, v153
buffer_load_dwordx2 v[40:41], v250, s[20:23], s87 offen offset:0 sc0 sc1
buffer_load_dwordx2 v[42:43], v250, s[20:23], s87 offen offset:512 sc0 sc1
buffer_load_dwordx2 v[44:45], v250, s[20:23], s87 offen offset:1024 sc0 sc1
buffer_load_dwordx2 v[46:47], v250, s[20:23], s87 offen offset:1536 sc0 sc1
buffer_load_dwordx2 v[48:49], v250, s[20:23], s87 offen offset:2048 sc0 sc1
buffer_load_dwordx2 v[50:51], v250, s[20:23], s87 offen offset:2560 sc0 sc1
buffer_load_dwordx2 v[52:53], v250, s[20:23], s87 offen offset:3072 sc0 sc1
buffer_load_dwordx2 v[54:55], v250, s[20:23], s87 offen offset:3584 sc0 sc1
buffer_load_dwordx2 v[56:57], v250, s[20:23], s46 offen offset:0 sc0 sc1
buffer_load_dwordx2 v[58:59], v250, s[20:23], s46 offen offset:512 sc0 sc1
buffer_load_dwordx2 v[60:61], v250, s[20:23], s46 offen offset:1024 sc0 sc1
buffer_load_dwordx2 v[62:63], v250, s[20:23], s46 offen offset:1536 sc0 sc1
buffer_load_dwordx2 v[64:65], v250, s[20:23], s46 offen offset:2048 sc0 sc1
buffer_load_dwordx2 v[66:67], v250, s[20:23], s46 offen offset:2560 sc0 sc1
buffer_load_dwordx2 v[68:69], v250, s[20:23], s46 offen offset:3072 sc0 sc1
buffer_load_dwordx2 v[70:71], v250, s[20:23], s46 offen offset:3584 sc0 sc1
K_XW2:
s_and_b32 s46, vcc_lo, 0xf0000
s_cbranch_scc1 K_XPOLL
buffer_load_dwordx4 v[96:99], v234, s[20:23], s60 offen offset:0 sc0 sc1
buffer_load_dwordx4 v[104:107], v234, s[20:23], s61 offen offset:0 sc0 sc1
buffer_load_dwordx4 v[112:115], v234, s[20:23], s62 offen offset:0 sc0 sc1
buffer_load_dwordx4 v[100:103], v234, s[20:23], s60 offen offset:1024 sc0 sc1
buffer_load_dwordx4 v[108:111], v234, s[20:23], s61 offen offset:1024 sc0 sc1
buffer_load_dwordx4 v[116:119], v234, s[20:23], s62 offen offset:1024 sc0 sc1
v_lshlrev_b32 v72, 16, v120
v_and_b32 v73, s56, v120
v_lshlrev_b32 v74, 16, v121
v_and_b32 v75, s56, v121
v_lshlrev_b32 v76, 16, v122
v_and_b32 v77, s56, v122
v_lshlrev_b32 v78, 16, v123
v_and_b32 v79, s56, v123
v_lshlrev_b32 v80, 16, v124
v_and_b32 v81, s56, v124
v_lshlrev_b32 v82, 16, v125
v_and_b32 v83, s56, v125
v_lshlrev_b32 v84, 16, v126
v_and_b32 v85, s56, v126
v_lshlrev_b32 v86, 16, v127
v_and_b32 v87, s56, v127
v_lshlrev_b32 v88, 16, v128
v_and_b32 v89, s56, v128
v_lshlrev_b32 v90, 16, v129
v_and_b32 v91, s56, v129
s_cmp_lg_u32 s67, 2
s_cbranch_scc1 K_EFIN
s_waitcnt vmcnt(6)
v_lshlrev_b32 v36, 16, v40
v_and_b32 v37, s56, v40
v_lshlrev_b32 v38, 16, v41
v_and_b32 v39, s56, v41
v_dot2_f32_bf16 v36, v42, s58, v36
v_dot2_f32_bf16 v37, v42, s59, v37
v_dot2_f32_bf16 v38, v43, s58, v38
v_dot2_f32_bf16 v39, v43, s59, v39
v_dot2_f32_bf16 v36, v44, s58, v36
v_dot2_f32_bf16 v37, v44, s59, v37
v_dot2_f32_bf16 v38, v45, s58, v38
v_dot2_f32_bf16 v39, v45, s59, v39
v_dot2_f32_bf16 v36, v46, s58, v36
v_dot2_f32_bf16 v37, v46, s59, v37
v_dot2_f32_bf16 v38, v47, s58, v38
v_dot2_f32_bf16 v39, v47, s59, v39
v_dot2_f32_bf16 v36, v48, s58, v36
v_dot2_f32_bf16 v37, v48, s59, v37
v_dot2_f32_bf16 v38, v49, s58, v38
v_dot2_f32_bf16 v39, v49, s59, v39
v_dot2_f32_bf16 v36, v50, s58, v36
v_dot2_f32_bf16 v37, v50, s59, v37
v_dot2_f32_bf16 v38, v51, s58, v38
v_dot2_f32_bf16 v39, v51, s59, v39
v_dot2_f32_bf16 v36, v52, s58, v36
v_dot2_f32_bf16 v37, v52, s59, v37
v_dot2_f32_bf16 v38, v53, s58, v38
v_dot2_f32_bf16 v39, v53, s59, v39
v_dot2_f32_bf16 v36, v54, s58, v36
v_dot2_f32_bf16 v37, v54, s59, v37
v_dot2_f32_bf16 v38, v55, s58, v38
v_dot2_f32_bf16 v39, v55, s59, v39
v_dot2_f32_bf16 v36, v56, s58, v36
v_dot2_f32_bf16 v37, v56, s59, v37
v_dot2_f32_bf16 v38, v57, s58, v38
v_dot2_f32_bf16 v39, v57, s59, v39
v_dot2_f32_bf16 v36, v58, s58, v36
v_dot2_f32_bf16 v37, v58, s59, v37
v_dot2_f32_bf16 v38, v59, s58, v38
v_dot2_f32_bf16 v39, v59, s59, v39
v_dot2_f32_bf16 v36, v60, s58, v36
v_dot2_f32_bf16 v37, v60, s59, v37
v_dot2_f32_bf16 v38, v61, s58, v38
v_dot2_f32_bf16 v39, v61, s59, v39
v_dot2_f32_bf16 v36, v62, s58, v36
v_dot2_f32_bf16 v37, v62, s59, v37
v_dot2_f32_bf16 v38, v63, s58, v38
v_dot2_f32_bf16 v39, v63, s59, v39
v_dot2_f32_bf16 v36, v64, s58, v36
v_dot2_f32_bf16 v37, v64, s59, v37
v_dot2_f32_bf16 v38, v65, s58, v38
v_dot2_f32_bf16 v39, v65, s59, v39
v_dot2_f32_bf16 v36, v66, s58, v36
v_dot2_f32_bf16 v37, v66, s59, v37
v_dot2_f32_bf16 v38, v67, s58, v38
v_dot2_f32_bf16 v39, v67, s59, v39
v_dot2_f32_bf16 v36, v68, s58, v36
v_dot2_f32_bf16 v37, v68, s59, v37
v_dot2_f32_bf16 v38, v69, s58, v38
v_dot2_f32_bf16 v39, v69, s59, v39
v_dot2_f32_bf16 v36, v70, s58, v36
v_dot2_f32_bf16 v37, v70, s59, v37
v_dot2_f32_bf16 v38, v71, s58, v38
v_dot2_f32_bf16 v39, v71, s59, v39
s_nop 1
K_EFIN:
v_cvt_pk_bf16_f32 v28, v36, v37
v_cvt_pk_bf16_f32 v29, v38, v39
v_lshlrev_b32 v36, 16, v28
v_and_b32 v37, s56, v28
v_lshlrev_b32 v38, 16, v29
v_and_b32 v39, s56, v29
v_pk_mul_f32 v[36:37], v[36:37], v[24:25]
v_pk_mul_f32 v[38:39], v[38:39], v[26:27]
v_cvt_pk_bf16_f32 v28, v36, v37
v_cvt_pk_bf16_f32 v29, v38, v39
v_lshlrev_b32 v36, 16, v28
v_and_b32 v37, s56, v28
v_lshlrev_b32 v38, 16, v29
v_and_b32 v39, s56, v29
v_pk_add_f32 v[36:37], v[36:37], v[88:89]
v_pk_add_f32 v[38:39], v[38:39], v[90:91]
v_cvt_pk_bf16_f32 v36, v36, v37
v_cvt_pk_bf16_f32 v37, v38, v39
buffer_store_dwordx2 v[36:37], v240, s[68:71], s81 offen sc0 sc1 nt
s_add_u32 s46, s37, 65536
v_add_u32 v5, s46, v234
s_add_u32 s46, s80, 9216
s_waitcnt vmcnt(4)
v_dot2_f32_bf16 v136, v96, s58, v136
v_dot2_f32_bf16 v137, v96, s59, v137
v_dot2_f32_bf16 v138, v97, s58, v138
v_dot2_f32_bf16 v139, v97, s59, v139
v_dot2_f32_bf16 v140, v98, s58, v140
v_dot2_f32_bf16 v141, v98, s59, v141
v_dot2_f32_bf16 v142, v99, s58, v142
v_dot2_f32_bf16 v143, v99, s59, v143
v_dot2_f32_bf16 v136, v104, s58, v136
v_dot2_f32_bf16 v137, v104, s59, v137
v_dot2_f32_bf16 v138, v105, s58, v138
v_dot2_f32_bf16 v139, v105, s59, v139
v_dot2_f32_bf16 v140, v106, s58, v140
v_dot2_f32_bf16 v141, v106, s59, v141
v_dot2_f32_bf16 v142, v107, s58, v142
v_dot2_f32_bf16 v143, v107, s59, v143
v_dot2_f32_bf16 v136, v112, s58, v136
v_dot2_f32_bf16 v137, v112, s59, v137
v_dot2_f32_bf16 v138, v113, s58, v138
v_dot2_f32_bf16 v139, v113, s59, v139
v_dot2_f32_bf16 v140, v114, s58, v140
v_dot2_f32_bf16 v141, v114, s59, v141
v_dot2_f32_bf16 v142, v115, s58, v142
v_dot2_f32_bf16 v143, v115, s59, v143
v_cvt_pk_bf16_f32 v28, v136, v137
v_cvt_pk_bf16_f32 v29, v138, v139
v_lshlrev_b32 v136, 16, v28
v_and_b32 v137, s56, v28
v_lshlrev_b32 v138, 16, v29
v_and_b32 v139, s56, v29
v_pk_mul_f32 v[136:137], v[136:137], v[8:9]
v_pk_mul_f32 v[138:139], v[138:139], v[10:11]
v_cvt_pk_bf16_f32 v28, v136, v137
v_cvt_pk_bf16_f32 v29, v138, v139
v_lshlrev_b32 v136, 16, v28
v_and_b32 v137, s56, v28
v_lshlrev_b32 v138, 16, v29
v_and_b32 v139, s56, v29
v_pk_add_f32 v[136:137], v[136:137], v[72:73]
v_pk_add_f32 v[138:139], v[138:139], v[74:75]
v_cvt_pk_bf16_f32 v136, v136, v137
v_cvt_pk_bf16_f32 v137, v138, v139
ds_write_b64 v241, v[136:137]
v_cvt_pk_bf16_f32 v28, v140, v141
v_cvt_pk_bf16_f32 v29, v142, v143
v_lshlrev_b32 v140, 16, v28
v_and_b32 v141, s56, v28
v_lshlrev_b32 v142, 16, v29
v_and_b32 v143, s56, v29
v_pk_mul_f32 v[140:141], v[140:141], v[12:13]
v_pk_mul_f32 v[142:143], v[142:143], v[14:15]
v_cvt_pk_bf16_f32 v28, v140, v141
v_cvt_pk_bf16_f32 v29, v142, v143
v_lshlrev_b32 v140, 16, v28
v_and_b32 v141, s56, v28
v_lshlrev_b32 v142, 16, v29
v_and_b32 v143, s56, v29
v_pk_add_f32 v[140:141], v[140:141], v[76:77]
v_pk_add_f32 v[142:143], v[142:143], v[78:79]
v_cvt_pk_bf16_f32 v140, v140, v141
v_cvt_pk_bf16_f32 v141, v142, v143
ds_write_b64 v242, v[140:141]
s_waitcnt vmcnt(1)
v_dot2_f32_bf16 v144, v100, s58, v144
v_dot2_f32_bf16 v145, v100, s59, v145
v_dot2_f32_bf16 v146, v101, s58, v146
v_dot2_f32_bf16 v147, v101, s59, v147
v_dot2_f32_bf16 v148, v102, s58, v148
v_dot2_f32_bf16 v149, v102, s59, v149
v_dot2_f32_bf16 v150, v103, s58, v150
v_dot2_f32_bf16 v151, v103, s59, v151
v_dot2_f32_bf16 v144, v108, s58, v144
v_dot2_f32_bf16 v145, v108, s59, v145
v_dot2_f32_bf16 v146, v109, s58, v146
v_dot2_f32_bf16 v147, v109, s59, v147
v_dot2_f32_bf16 v148, v110, s58, v148
v_dot2_f32_bf16 v149, v110, s59, v149
v_dot2_f32_bf16 v150, v111, s58, v150
v_dot2_f32_bf16 v151, v111, s59, v151
v_dot2_f32_bf16 v144, v116, s58, v144
v_dot2_f32_bf16 v145, v116, s59, v145
v_dot2_f32_bf16 v146, v117, s58, v146
v_dot2_f32_bf16 v147, v117, s59, v147
v_dot2_f32_bf16 v148, v118, s58, v148
v_dot2_f32_bf16 v149, v118, s59, v149
v_dot2_f32_bf16 v150, v119, s58, v150
v_dot2_f32_bf16 v151, v119, s59, v151
v_cvt_pk_bf16_f32 v28, v144, v145
v_cvt_pk_bf16_f32 v29, v146, v147
v_lshlrev_b32 v144, 16, v28
v_and_b32 v145, s56, v28
v_lshlrev_b32 v146, 16, v29
v_and_b32 v147, s56, v29
v_pk_mul_f32 v[144:145], v[144:145], v[16:17]
v_pk_mul_f32 v[146:147], v[146:147], v[18:19]
v_cvt_pk_bf16_f32 v28, v144, v145
v_cvt_pk_bf16_f32 v29, v146, v147
v_lshlrev_b32 v144, 16, v28
v_and_b32 v145, s56, v28
v_lshlrev_b32 v146, 16, v29
v_and_b32 v147, s56, v29
v_pk_add_f32 v[144:145], v[144:145], v[80:81]
v_pk_add_f32 v[146:147], v[146:147], v[82:83]
v_cvt_pk_bf16_f32 v144, v144, v145
v_cvt_pk_bf16_f32 v145, v146, v147
ds_write_b64 v243, v[144:145]
v_cvt_pk_bf16_f32 v28, v148, v149
v_cvt_pk_bf16_f32 v29, v150, v151
v_lshlrev_b32 v148, 16, v28
v_and_b32 v149, s56, v28
v_lshlrev_b32 v150, 16, v29
v_and_b32 v151, s56, v29
v_pk_mul_f32 v[148:149], v[148:149], v[20:21]
v_pk_mul_f32 v[150:151], v[150:151], v[22:23]
v_cvt_pk_bf16_f32 v28, v148, v149
v_cvt_pk_bf16_f32 v29, v150, v151
v_lshlrev_b32 v148, 16, v28
v_and_b32 v149, s56, v28
v_lshlrev_b32 v150, 16, v29
v_and_b32 v151, s56, v29
v_pk_add_f32 v[148:149], v[148:149], v[84:85]
v_pk_add_f32 v[150:151], v[150:151], v[86:87]
v_cvt_pk_bf16_f32 v148, v148, v149
v_cvt_pk_bf16_f32 v149, v150, v151
ds_write_b64 v244, v[148:149]
ds_read_b128 v[40:43], v5
ds_read_b128 v[44:47], v5 offset:1024
s_waitcnt lgkmcnt(1)
buffer_store_dwordx4 v[40:43], v239, s[68:71], s80 offen sc0 sc1 nt
s_waitcnt lgkmcnt(0)
buffer_store_dwordx4 v[44:47], v239, s[68:71], s46 offen sc0 sc1 nt
K_END:
s_endpgm
K_YSPIN:
s_sleep 4
s_add_u32 s100, s100, 1
s_bitcmp1_b32 s100, 19
s_cbranch_scc1 K_END
buffer_load_dwordx2 v[252:253], v251, s[76:79], s42 offen sc0 sc1
s_waitcnt vmcnt(0)
K_YR0:
s_cmp_lg_u32 s41, 0
s_cbranch_scc1 K_YR0B
s_waitcnt vmcnt(3)
v_cmp_gt_u32 vcc, 9, v252
s_cbranch_vccnz K_YSPIN
K_YR0B:
s_mul_i32 s48, s52, 18560
s_mul_i32 s46, s32, 4608
s_add_u32 s48, s48, s46
s_add_u32 s48, s48, 0x23fb780
s_add_u32 s46, s48, 4096
buffer_load_dwordx4 v[112:115], v234, s[20:23], s48 offen offset:0 sc0 sc1
buffer_load_dwordx4 v[116:119], v234, s[20:23], s48 offen offset:1024 sc0 sc1
buffer_load_dwordx4 v[120:123], v234, s[20:23], s48 offen offset:2048 sc0 sc1
buffer_load_dwordx4 v[124:127], v234, s[20:23], s48 offen offset:3072 sc0 sc1
v_subrev_u32 v245, 1, v254
v_and_b32 v245, 0x7ff, v245
v_mul_u32_u24 v245, 0x480, v245
v_mov_b64 v[128:129], 0
v_mov_b64 v[130:131], 0
s_lshl_b32 s50, s52, 3
s_sub_u32 s50, s50, 8
s_mov_b32 exec_hi, 0
buffer_load_dwordx4 v[128:131], v234, s[20:23], s46 offen sc0 sc1
s_mov_b32 exec_lo, 0xff
buffer_load_dwordx2 v[134:135], v245, s[20:23], s50 offen sc0 sc1
s_mov_b64 exec, -1
s_branch K_LAST
K_YRA:
s_waitcnt vmcnt(35)
v_pk_add_f32 v[112:113], v[112:113], v[116:117]
v_pk_add_f32 v[114:115], v[114:115], v[118:119]
v_pk_add_f32 v[112:113], v[112:113], v[120:121]
v_pk_add_f32 v[114:115], v[114:115], v[122:123]
v_pk_add_f32 v[112:113], v[112:113], v[124:125]
v_pk_add_f32 v[114:115], v[114:115], v[126:127]
v_pk_add_f32 v[112:113], v[112:113], v[128:129]
v_pk_add_f32 v[114:115], v[114:115], v[130:131]
s_lshl_b32 s46, s36, 10
s_lshl_b32 s47, s32, 7
s_add_u32 s46, s46, s47
v_add_f32_dpp v112, v112, v112 row_ror:8 row_mask:0xf bank_mask:0xf
v_add_f32_dpp v113, v113, v113 row_ror:8 row_mask:0xf bank_mask:0xf
v_add_f32_dpp v114, v114, v114 row_ror:8 row_mask:0xf bank_mask:0xf
v_add_f32_dpp v115, v115, v115 row_ror:8 row_mask:0xf bank_mask:0xf
s_add_u32 s46, s46, 77952
v_and_b32 v120, 0x70, v234
v_add_u32 v120, s46, v120
v_mov_b32 v116, v112
v_mov_b32 v117, v113
v_mov_b32 v118, v114
v_mov_b32 v119, v115
v_permlane16_swap_b32 v112, v116
v_permlane16_swap_b32 v113, v117
v_permlane16_swap_b32 v114, v118
v_permlane16_swap_b32 v115, v119
v_pk_add_f32 v[112:113], v[112:113], v[116:117]
v_pk_add_f32 v[114:115], v[114:115], v[118:119]
v_mov_b32 v116, v112
v_mov_b32 v117, v113
v_mov_b32 v118, v114
v_mov_b32 v119, v115
v_permlane32_swap_b32 v112, v116
v_permlane32_swap_b32 v113, v117
v_permlane32_swap_b32 v114, v118
v_permlane32_swap_b32 v115, v119
v_pk_add_f32 v[112:113], v[112:113], v[116:117]
v_pk_add_f32 v[114:115], v[114:115], v[118:119]
ds_write_b128 v120, v[112:115]
v_subrev_u32 v120, s47, v120
s_branch K_YRAD
K_YR1:
ds_read_b128 v[144:147], v120 offset:0
ds_read_b128 v[148:151], v120 offset:128
ds_read_b128 v[152:155], v120 offset:256
ds_read_b128 v[156:159], v120 offset:384
v_mov_b32_dpp v160, v254 row_ror:8 row_mask:0xf bank_mask:0xf
v_mul_u32_u24 v245, 0x480, v1
s_mov_b32 s57, 0xbfb8aa3b
s_mov_b32 s56, 0xffff0000
v_and_b32 v160, s56, v160
s_waitcnt lgkmcnt(0)
v_pk_add_f32 v[112:113], v[144:145], v[148:149]
v_pk_add_f32 v[116:117], v[152:153], v[156:157]
v_pk_add_f32 v[112:113], v[112:113], v[116:117]
v_pk_add_f32 v[114:115], v[146:147], v[150:151]
v_pk_add_f32 v[118:119], v[154:155], v[158:159]
v_pk_add_f32 v[114:115], v[114:115], v[118:119]
v_cvt_pk_bf16_f32 v162, v112, v113
v_cvt_pk_bf16_f32 v163, v114, v115
v_lshlrev_b32 v112, 16, v162
v_and_b32 v113, s56, v162
v_lshlrev_b32 v114, 16, v163
v_and_b32 v115, s56, v163
v_mul_f32 v112, v160, v112
v_mul_f32 v113, v160, v113
v_mul_f32 v114, v160, v114
v_mul_f32 v115, v160, v115
v_cvt_pk_bf16_f32 v162, v112, v113
v_cvt_pk_bf16_f32 v163, v114, v115
v_lshlrev_b32 v112, 16, v162
v_and_b32 v113, s56, v162
v_lshlrev_b32 v114, 16, v163
v_and_b32 v115, s56, v163
v_lshlrev_b32 v116, 16, v134
v_and_b32 v117, 0xffff0000, v134
v_lshlrev_b32 v118, 16, v135
v_and_b32 v119, 0xffff0000, v135
v_pk_add_f32 v[112:113], v[112:113], v[116:117]
v_pk_add_f32 v[114:115], v[114:115], v[118:119]
v_cvt_pk_bf16_f32 v162, v112, v113
v_cvt_pk_bf16_f32 v163, v114, v115
v_lshlrev_b32 v112, 16, v162
v_and_b32 v113, s56, v162
v_lshlrev_b32 v114, 16, v163
v_and_b32 v115, s56, v163
v_mul_f32 v116, s57, v112
v_mul_f32 v117, s57, v113
v_mul_f32 v118, s57, v114
v_mul_f32 v119, s57, v115
v_exp_f32 v116, v116
v_exp_f32 v117, v117
v_exp_f32 v118, v118
v_exp_f32 v119, v119
s_nop 0
v_add_f32 v116, 1.0, v116
v_add_f32 v117, 1.0, v117
v_add_f32 v118, 1.0, v118
v_add_f32 v119, 1.0, v119
v_rcp_f32 v116, v116
v_rcp_f32 v117, v117
v_rcp_f32 v118, v118
v_rcp_f32 v119, v119
s_add_u32 s46, s50, 0x274000
v_pk_mul_f32 v[112:113], v[112:113], v[116:117]
v_pk_mul_f32 v[114:115], v[114:115], v[118:119]
v_cvt_pk_bf16_f32 v134, v112, v113
v_cvt_pk_bf16_f32 v135, v114, v115
s_mov_b64 exec, 0xff
buffer_store_dwordx2 v[134:135], v245, s[20:23], s46 offen sc0 sc1
s_mov_b64 exec, -1
s_branch K_YR1D
K_YR2:
s_waitcnt vmcnt(32)
s_and_b32 s46, s83, 15
s_lshl_b32 s46, s46, 7
s_add_u32 s46, s46, 0x272800
s_mov_b64 exec, 1
buffer_atomic_add v5, v234, s[20:23], s46 offen sc1
s_mov_b64 exec, -1
s_branch K_YR2D
K_YG:
v_mov_b32 v157, -1
K_YG1:
s_ff1_i32_b32 s46, s93
s_bitset0_b32 s93, s46
v_readlane_b32 s47, v248, s46
v_mov_b32 v158, s46
s_nop 0
v_cmp_eq_u32 vcc, s47, v3
s_cmp_lg_u32 s93, 0
s_nop 0
v_cndmask_b32 v157, v157, v158, vcc
s_cbranch_scc1 K_YG1
v_mul_u32_u24 v158, 0x480, v157
v_lshl_add_u32 v158, v4, 3, v158
s_lshl_b32 s46, s36, 8
s_add_u32 s46, s46, s82
s_add_u32 s46, s46, 0x274000
s_lshl_b32 s47, s36, 5
s_add_u32 s47, s47, 0x274400
s_branch K_YG3
K_YG2:
s_sleep 2
s_add_u32 s100, s100, 1
s_bitcmp1_b32 s100, 19
s_cbranch_scc1 K_END
buffer_load_dword v247, v6, s[20:23], 0 offen sc0 sc1
s_waitcnt vmcnt(0)
K_YG3:
v_cmp_gt_u32 vcc, 9, v247
s_cbranch_vccnz K_YG2
v_cmp_gt_u32 vcc, 8, v157
s_nop 1
s_mov_b64 exec, vcc
buffer_load_dwordx2 v[160:161], v158, s[20:23], s46 offen offset:0 sc0 sc1
buffer_load_dwordx2 v[162:163], v158, s[20:23], s46 offen offset:32 sc0 sc1
buffer_load_dwordx2 v[164:165], v158, s[20:23], s46 offen offset:64 sc0 sc1
buffer_load_dwordx2 v[166:167], v158, s[20:23], s46 offen offset:96 sc0 sc1
buffer_load_dwordx2 v[168:169], v158, s[20:23], s47 offen offset:0 sc0 sc1
s_waitcnt vmcnt(0)
v_lshlrev_b32 v8, 16, v160
v_and_b32 v9, s56, v160
v_lshlrev_b32 v10, 16, v161
v_and_b32 v11, s56, v161
v_lshlrev_b32 v12, 16, v162
v_and_b32 v13, s56, v162
v_lshlrev_b32 v14, 16, v163
v_and_b32 v15, s56, v163
v_lshlrev_b32 v16, 16, v164
v_and_b32 v17, s56, v164
v_lshlrev_b32 v18, 16, v165
v_and_b32 v19, s56, v165
v_lshlrev_b32 v20, 16, v166
v_and_b32 v21, s56, v166
v_lshlrev_b32 v22, 16, v167
v_and_b32 v23, s56, v167
v_lshlrev_b32 v24, 16, v168
v_and_b32 v25, s56, v168
v_lshlrev_b32 v26, 16, v169
v_and_b32 v27, s56, v169
s_mov_b64 exec, -1
s_branch K_YGD
K_TAIL_END:
K_HOOK:
s_lshl_b32 s48, s34, 2
s_add_u32 s48, s48, s35
s_cmp_eq_u32 s40, 3
s_cbranch_scc1 K_QTW
s_cmp_eq_u32 s40, 7
s_cbranch_scc1 K_PUB
s_memrealtime s[46:47]
s_waitcnt lgkmcnt(0)
s_sub_u32 s47, s46, s94
s_mul_i32 s47, s47, 12
s_lshr_b32 s47, s47, 2
s_add_u32 s46, s46, s47
s_lshl_b32 s46, s46, 6
s_or_b32 s46, s46, s48
s_bitset1_b32 s46, 31
v_mov_b32 v244, s46
s_lshl_b32 s48, s48, 3
s_mov_b64 exec, 1
buffer_store_dword v244, v234, s[76:79], s48 offen sc0 sc1
s_mov_b64 exec, -1
s_branch K_B4
K_QTSPIN:
s_sleep 4
s_add_u32 s100, s100, 1
s_bitcmp1_b32 s100, 19
s_cbranch_scc1 K_END
buffer_load_dwordx2 v[252:253], v251, s[76:79], 0 offen sc0 sc1
s_waitcnt vmcnt(0)
K_QTW:
s_waitcnt vmcnt(3)
v_cmp_eq_u32 vcc, 0, v252
v_cmp_eq_u32 s[88:89], 0, v253
v_readlane_b32 s46, v252, s48
v_mov_b32 v254, v253
s_and_b32 s88, s88, 0xffff
s_or_b32 s88, s88, vcc_lo
s_or_b32 s88, s88, vcc_hi
v_cmp_gt_u32 vcc, s46, v252
s_cbranch_scc1 K_QTSPIN
s_bcnt1_i32_b64 s46, vcc
s_cmp_ge_u32 s46, 36
s_cbranch_scc1 K_B4
s_lshl_b32 s52, s46, 2
s_add_u32 s52, s52, s36
s_lshl_b32 s50, s52, 6
s_mul_i32 s90, s32, 294912
s_add_u32 s90, s90, s50
v_mfma_f32_16x16x32_bf16 a[0:3], a[160:163], v[88:91], a[0:3]
v_exp_f32 v8, v8
v_mfma_f32_16x16x32_bf16 a[32:35], a[160:163], v[92:95], a[32:35]
v_exp_f32 v9, v9
v_mfma_f32_16x16x32_bf16 a[64:67], a[160:163], v[96:99], a[64:67]
v_cvt_pk_bf16_f32 v72, v8, v9
v_lshlrev_b32 v5, 2, v4
v_mfma_f32_16x16x32_bf16 a[96:99], a[160:163], v[100:103], a[96:99]
s_waitcnt lgkmcnt(4)
v_exp_f32 v10, v10
v_mfma_f32_16x16x32_bf16 a[100:103], a[164:167], v[100:103], a[100:103]
v_add_u32 v6, 16, v5
v_and_b32 v7, 28, v1
v_mfma_f32_16x16x32_bf16 a[68:71], a[164:167], v[96:99], a[68:71]
v_exp_f32 v11, v11
s_waitcnt vmcnt(4) lgkmcnt(0)
s_barrier
v_mfma_f32_16x16x32_bf16 a[36:39], a[164:167], v[92:95], a[36:39]
ds_read_b64_tr_b16 a[160:161], v220 offset:0
ds_read_b64_tr_b16 a[162:163], v220 offset:4096
v_mfma_f32_16x16x32_bf16 a[4:7], a[164:167], v[88:91], a[4:7]
s_add_u32 m0, s37, 98304
v_exp_f32 v12, v12
v_mfma_f32_16x16x32_bf16 a[8:11], a[168:171], v[88:91], a[8:11]
buffer_load_dwordx4 v232, s[12:15], s39 offen offset:0 lds
v_mfma_f32_16x16x32_bf16 a[40:43], a[168:171], v[92:95], a[40:43]
v_exp_f32 v13, v13
v_mfma_f32_16x16x32_bf16 a[72:75], a[168:171], v[96:99], a[72:75]
ds_read_b64_tr_b16 a[164:165], v221 offset:0
ds_read_b64_tr_b16 a[166:167], v221 offset:4096
v_mfma_f32_16x16x32_bf16 a[104:107], a[168:171], v[100:103], a[104:107]
v_exp_f32 v14, v14
v_mfma_f32_16x16x32_bf16 a[108:111], a[172:175], v[100:103], a[108:111]
s_add_u32 m0, s49, 4096
ds_read_b64_tr_b16 a[168:169], v222 offset:0
ds_read_b64_tr_b16 a[170:171], v222 offset:4096
v_mfma_f32_16x16x32_bf16 a[76:79], a[172:175], v[96:99], a[76:79]
s_add_u32 s48, s90, 4718592
v_exp_f32 v15, v15
v_mfma_f32_16x16x32_bf16 a[44:47], a[172:175], v[92:95], a[44:47]
buffer_load_dwordx4 v238, s[56:59], s48 offen  lds
v_mfma_f32_16x16x32_bf16 a[12:15], a[172:175], v[88:91], a[12:15]
v_exp_f32 v16, v16
v_smfmac_f32_16x16x64_bf16 a[248:251], a[208:211], v[88:95], v235
ds_read_b64_tr_b16 a[172:173], v223 offset:0
ds_read_b64_tr_b16 a[174:175], v223 offset:4096
v_mfma_f32_16x16x32_bf16 v[40:43], a[128:131], v[152:155], v[136:139]
v_exp_f32 v17, v17
v_mfma_f32_16x16x32_bf16 v[40:43], a[132:135], v[156:159], v[40:43]
s_add_u32 m0, s37, 98304
v_cvt_pk_bf16_f32 v73, v10, v11
v_cvt_pk_bf16_f32 v74, v12, v13
v_mfma_f32_16x16x32_bf16 v[40:43], a[136:139], v[160:163], v[40:43]
v_exp_f32 v18, v18
v_mfma_f32_16x16x32_bf16 v[40:43], a[140:143], v[164:167], v[40:43]
buffer_load_dwordx4 v233, s[12:15], s39 offen offset:1024 lds
v_mfma_f32_16x16x32_bf16 v[48:51], a[140:143], v[180:183], v[140:143]
v_exp_f32 v19, v19
v_mfma_f32_16x16x32_bf16 v[48:51], a[136:139], v[176:179], v[48:51]
v_cvt_pk_bf16_f32 v75, v14, v15
v_cvt_pk_bf16_f32 v76, v16, v17
v_mfma_f32_16x16x32_bf16 v[48:51], a[132:135], v[172:175], v[48:51]
s_add_u32 m0, s49, 5120
v_exp_f32 v20, v20
v_mfma_f32_16x16x32_bf16 v[48:51], a[128:131], v[168:171], v[48:51]
s_add_u32 s48, s90, 4866048
buffer_load_dwordx4 v238, s[56:59], s48 offen  lds
v_mfma_f32_16x16x32_bf16 v[56:59], a[128:131], v[184:187], v[144:147]
v_exp_f32 v21, v21
v_mfma_f32_16x16x32_bf16 v[56:59], a[132:135], v[188:191], v[56:59]
v_cvt_pk_bf16_f32 v77, v18, v19
v_cvt_pk_bf16_f32 v78, v20, v21
v_mfma_f32_16x16x32_bf16 v[56:59], a[136:139], v[192:195], v[56:59]
v_exp_f32 v22, v22
v_mfma_f32_16x16x32_bf16 v[56:59], a[140:143], v[196:199], v[56:59]
ds_bpermute_b32 v5, v5, v254
ds_bpermute_b32 v6, v6, v254
v_mfma_f32_16x16x32_bf16 v[64:67], a[140:143], v[212:215], v[148:151]
s_add_u32 m0, s37, 98304
v_exp_f32 v23, v23
v_mfma_f32_16x16x32_bf16 v[64:67], a[136:139], v[208:211], v[64:67]
buffer_load_dwordx4 v232, s[12:15], s39 offen offset:2048 lds
v_mfma_f32_16x16x32_bf16 v[64:67], a[132:135], v[204:207], v[64:67]
v_exp_f32 v24, v24
v_mfma_f32_16x16x32_bf16 v[64:67], a[128:131], v[200:203], v[64:67]
v_exp_f32 v25, v25
v_mfma_f32_16x16x32_bf16 a[16:19], a[176:179], v[88:91], a[16:19]
ds_read_b128 a[140:143], v219 offset:49152
ds_read_b128 a[136:139], v218 offset:49152
v_mfma_f32_16x16x32_bf16 a[48:51], a[176:179], v[92:95], a[48:51]
v_exp_f32 v26, v26
v_mfma_f32_16x16x32_bf16 a[80:83], a[176:179], v[96:99], a[80:83]
s_add_u32 m0, s49, 6144
ds_read_b128 a[132:135], v217 offset:49152
ds_read_b128 a[128:131], v216 offset:49152
v_mfma_f32_16x16x32_bf16 a[112:115], a[176:179], v[100:103], a[112:115]
s_add_u32 s48, s90, 4718592
v_exp_f32 v27, v27
v_mfma_f32_16x16x32_bf16 a[116:119], a[180:183], v[100:103], a[116:119]
buffer_load_dwordx4 v238, s[60:63], s48 offen  lds
v_mfma_f32_16x16x32_bf16 a[84:87], a[180:183], v[96:99], a[84:87]
v_exp_f32 v28, v28
v_mfma_f32_16x16x32_bf16 a[52:55], a[180:183], v[92:95], a[52:55]
ds_read_b64_tr_b16 a[176:177], v224 offset:0
ds_read_b64_tr_b16 a[178:179], v224 offset:4096
v_mfma_f32_16x16x32_bf16 a[20:23], a[180:183], v[88:91], a[20:23]
s_add_u32 m0, s37, 98304
v_exp_f32 v29, v29
v_mfma_f32_16x16x32_bf16 a[24:27], a[184:187], v[88:91], a[24:27]
buffer_load_dwordx4 v233, s[12:15], s39 offen offset:3072 lds
v_mfma_f32_16x16x32_bf16 a[56:59], a[184:187], v[92:95], a[56:59]
v_exp_f32 v30, v30
v_mfma_f32_16x16x32_bf16 a[88:91], a[184:187], v[96:99], a[88:91]
ds_read_b64_tr_b16 a[180:181], v225 offset:0
ds_read_b64_tr_b16 a[182:183], v225 offset:4096
v_mfma_f32_16x16x32_bf16 a[120:123], a[184:187], v[100:103], a[120:123]
v_exp_f32 v31, v31
v_mfma_f32_16x16x32_bf16 a[124:127], a[188:191], v[100:103], a[124:127]
ds_read_b64_tr_b16 a[184:185], v226 offset:0
ds_read_b64_tr_b16 a[186:187], v226 offset:4096
v_mfma_f32_16x16x32_bf16 a[92:95], a[188:191], v[96:99], a[92:95]
s_add_u32 m0, s49, 7168
v_exp_f32 v32, v32
v_mfma_f32_16x16x32_bf16 a[60:63], a[188:191], v[92:95], a[60:63]
s_add_u32 s48, s90, 4866048
buffer_load_dwordx4 v238, s[60:63], s48 offen  lds
v_mfma_f32_16x16x32_bf16 a[28:31], a[188:191], v[88:91], a[28:31]
v_exp_f32 v33, v33
v_smfmac_f32_16x16x64_bf16 a[252:255], a[208:211], v[96:103], v235
ds_read_b64_tr_b16 a[188:189], v227 offset:0
ds_read_b64_tr_b16 a[190:191], v227 offset:4096
v_mfma_f32_16x16x32_bf16 v[44:47], a[144:147], v[152:155], v[136:139]
v_exp_f32 v34, v34
v_mfma_f32_16x16x32_bf16 v[44:47], a[148:151], v[156:159], v[44:47]
s_add_u32 s39, s39, 16384
v_cvt_pk_bf16_f32 v79, v22, v23
v_cvt_pk_bf16_f32 v80, v24, v25
v_mfma_f32_16x16x32_bf16 v[44:47], a[152:155], v[160:163], v[44:47]
s_add_u32 m0, s37, 16384
v_exp_f32 v35, v35
v_mfma_f32_16x16x32_bf16 v[44:47], a[156:159], v[164:167], v[44:47]
buffer_load_dwordx4 v228, s[8:11], s38 offen offset:0 lds
v_mfma_f32_16x16x32_bf16 v[52:55], a[156:159], v[180:183], v[140:143]
v_exp_f32 v36, v36
v_mfma_f32_16x16x32_bf16 v[52:55], a[152:155], v[176:179], v[52:55]
v_cvt_pk_bf16_f32 v81, v26, v27
v_cvt_pk_bf16_f32 v82, v28, v29
v_mfma_f32_16x16x32_bf16 v[52:55], a[148:151], v[172:175], v[52:55]
v_exp_f32 v37, v37
v_mfma_f32_16x16x32_bf16 v[52:55], a[144:147], v[168:171], v[52:55]
buffer_load_dwordx4 v229, s[8:11], s38 offen offset:1024 lds
v_mfma_f32_16x16x32_bf16 v[60:63], a[144:147], v[184:187], v[144:147]
v_exp_f32 v38, v38
v_mfma_f32_16x16x32_bf16 v[60:63], a[148:151], v[188:191], v[60:63]
v_cvt_pk_bf16_f32 v83, v30, v31
v_cvt_pk_bf16_f32 v84, v32, v33
v_mfma_f32_16x16x32_bf16 v[60:63], a[152:155], v[192:195], v[60:63]
v_exp_f32 v39, v39
v_mfma_f32_16x16x32_bf16 v[60:63], a[156:159], v[196:199], v[60:63]
v_cvt_pk_bf16_f32 v85, v34, v35
v_cvt_pk_bf16_f32 v86, v36, v37
v_mfma_f32_16x16x32_bf16 v[68:71], a[156:159], v[212:215], v[148:151]
ds_read_b128 a[156:159], v219 offset:53248
v_cvt_pk_bf16_f32 v87, v38, v39
v_mfma_f32_16x16x32_bf16 v[68:71], a[152:155], v[208:211], v[68:71]
ds_read_b128 a[152:155], v218 offset:53248
ds_bpermute_b32 v7, v7, v254
v_mfma_f32_16x16x32_bf16 v[68:71], a[148:151], v[204:207], v[68:71]
s_mul_i32 s91, s52, 36864
ds_read_b128 a[148:151], v217 offset:53248
v_mfma_f32_16x16x32_bf16 v[68:71], a[144:147], v[200:203], v[68:71]
s_waitcnt lgkmcnt(4)
s_lshl_b32 s46, s32, 5
ds_read_b128 a[144:147], v216 offset:53248
s_add_u32 s92, s91, s46
s_mul_i32 s46, s32, 1179648
s_add_u32 s50, s50, s46
s_lshl_b32 s46, s32, 8
s_add_u32 s91, s91, s46
s_and_b32 s47, s32, 1
s_lshl_b32 s47, s47, 6
s_add_u32 s47, s47, 1024
s_mov_b32 s88, 0x480
v_and_b32 v250, 3, v1
v_mfma_f32_16x16x32_bf16 a[0:3], a[160:163], v[72:75], a[0:3]
v_exp_f32 v40, v40
v_mfma_f32_16x16x32_bf16 a[32:35], a[160:163], v[76:79], a[32:35]
v_exp_f32 v41, v41
v_mfma_f32_16x16x32_bf16 a[64:67], a[160:163], v[80:83], a[64:67]
buffer_load_dwordx4 v230, s[8:11], s38 offen offset:2048 lds
v_mfma_f32_16x16x32_bf16 a[96:99], a[160:163], v[84:87], a[96:99]
v_exp_f32 v42, v42
v_mfma_f32_16x16x32_bf16 a[100:103], a[164:167], v[84:87], a[100:103]
ds_read_b64_tr_b16 a[160:161], v220 offset:8192
ds_read_b64_tr_b16 a[162:163], v220 offset:12288
v_mfma_f32_16x16x32_bf16 a[68:71], a[164:167], v[80:83], a[68:71]
v_exp_f32 v43, v43
v_mfma_f32_16x16x32_bf16 a[36:39], a[164:167], v[76:79], a[36:39]
v_cvt_pk_bf16_f32 v88, v40, v41
v_cvt_pk_bf16_f32 v89, v42, v43
v_mfma_f32_16x16x32_bf16 a[4:7], a[164:167], v[72:75], a[4:7]
v_exp_f32 v44, v44
v_mfma_f32_16x16x32_bf16 a[8:11], a[168:171], v[72:75], a[8:11]
ds_read_b64_tr_b16 a[164:165], v221 offset:8192
ds_read_b64_tr_b16 a[166:167], v221 offset:12288
v_mfma_f32_16x16x32_bf16 a[40:43], a[168:171], v[76:79], a[40:43]
v_exp_f32 v45, v45
v_mfma_f32_16x16x32_bf16 a[72:75], a[168:171], v[80:83], a[72:75]
v_cvt_pk_bf16_f32 v90, v44, v45
v_lshlrev_b32 v244, 1, v4
v_mfma_f32_16x16x32_bf16 a[104:107], a[168:171], v[84:87], a[104:107]
v_exp_f32 v46, v46
v_mfma_f32_16x16x32_bf16 a[108:111], a[172:175], v[84:87], a[108:111]
ds_read_b64_tr_b16 a[168:169], v222 offset:8192
ds_read_b64_tr_b16 a[170:171], v222 offset:12288
v_mfma_f32_16x16x32_bf16 a[76:79], a[172:175], v[80:83], a[76:79]
v_exp_f32 v47, v47
v_mfma_f32_16x16x32_bf16 a[44:47], a[172:175], v[76:79], a[44:47]
buffer_load_dwordx4 v231, s[8:11], s38 offen offset:3072 lds
v_mfma_f32_16x16x32_bf16 a[12:15], a[172:175], v[72:75], a[12:15]
v_exp_f32 v48, v48
v_smfmac_f32_16x16x64_bf16 a[248:251], a[208:211], v[72:79], v235
ds_read_b64_tr_b16 a[172:173], v223 offset:8192
ds_read_b64_tr_b16 a[174:175], v223 offset:12288
v_mfma_f32_16x16x32_bf16 v[8:11], a[128:131], v[152:155], v[136:139]
v_exp_f32 v49, v49
v_mfma_f32_16x16x32_bf16 v[8:11], a[132:135], v[156:159], v[8:11]
v_cvt_pk_bf16_f32 v91, v46, v47
v_cvt_pk_bf16_f32 v92, v48, v49
v_mfma_f32_16x16x32_bf16 v[8:11], a[136:139], v[160:163], v[8:11]
v_exp_f32 v50, v50
v_mfma_f32_16x16x32_bf16 v[8:11], a[140:143], v[164:167], v[8:11]
v_xor_b32 v244, v244, v3
v_lshlrev_b32 v244, 4, v244
v_mfma_f32_16x16x32_bf16 v[16:19], a[140:143], v[180:183], v[140:143]
v_exp_f32 v51, v51
v_mfma_f32_16x16x32_bf16 v[16:19], a[136:139], v[176:179], v[16:19]
v_cvt_pk_bf16_f32 v93, v50, v51
v_xor_b32 v245, 128, v244
v_mfma_f32_16x16x32_bf16 v[16:19], a[132:135], v[172:175], v[16:19]
v_exp_f32 v52, v52
v_mfma_f32_16x16x32_bf16 v[16:19], a[128:131], v[168:171], v[16:19]
v_subrev_u32 v244, 0x480, v244
v_subrev_u32 v245, 0x480, v245
v_mfma_f32_16x16x32_bf16 v[24:27], a[128:131], v[184:187], v[144:147]
s_add_u32 s38, s38, 16384
v_exp_f32 v53, v53
v_mfma_f32_16x16x32_bf16 v[24:27], a[132:135], v[188:191], v[24:27]
s_add_u32 m0, s37, 114688
v_cvt_pk_bf16_f32 v94, v52, v53
v_lshlrev_b32 v246, 4, v250
v_mfma_f32_16x16x32_bf16 v[24:27], a[136:139], v[192:195], v[24:27]
v_exp_f32 v54, v54
v_mfma_f32_16x16x32_bf16 v[24:27], a[140:143], v[196:199], v[24:27]
buffer_load_dwordx4 v232, s[12:15], s39 offen offset:0 lds
v_mfma_f32_16x16x32_bf16 v[32:35], a[140:143], v[212:215], v[148:151]
v_exp_f32 v55, v55
v_mfma_f32_16x16x32_bf16 v[32:35], a[136:139], v[208:211], v[32:35]
ds_read_b128 a[140:143], v219 offset:57344
ds_read_b128 a[136:139], v218 offset:57344
v_mfma_f32_16x16x32_bf16 v[32:35], a[132:135], v[204:207], v[32:35]
v_exp_f32 v56, v56
v_mfma_f32_16x16x32_bf16 v[32:35], a[128:131], v[200:203], v[32:35]
v_exp_f32 v57, v57
v_mfma_f32_16x16x32_bf16 a[16:19], a[176:179], v[72:75], a[16:19]
ds_read_b128 a[132:135], v217 offset:57344
ds_read_b128 a[128:131], v216 offset:57344
v_mfma_f32_16x16x32_bf16 a[48:51], a[176:179], v[76:79], a[48:51]
v_exp_f32 v58, v58
v_mfma_f32_16x16x32_bf16 a[80:83], a[176:179], v[80:83], a[80:83]
v_cvt_pk_bf16_f32 v95, v54, v55
v_cvt_pk_bf16_f32 v96, v56, v57
v_mfma_f32_16x16x32_bf16 a[112:115], a[176:179], v[84:87], a[112:115]
v_exp_f32 v59, v59
v_mfma_f32_16x16x32_bf16 a[116:119], a[180:183], v[84:87], a[116:119]
ds_read_b64_tr_b16 a[176:177], v224 offset:8192
ds_read_b64_tr_b16 a[178:179], v224 offset:12288
v_mfma_f32_16x16x32_bf16 a[84:87], a[180:183], v[80:83], a[84:87]
v_exp_f32 v60, v60
v_mfma_f32_16x16x32_bf16 a[52:55], a[180:183], v[76:79], a[52:55]
buffer_load_dwordx4 v233, s[12:15], s39 offen offset:1024 lds
v_mfma_f32_16x16x32_bf16 a[20:23], a[180:183], v[72:75], a[20:23]
v_exp_f32 v61, v61
v_mfma_f32_16x16x32_bf16 a[24:27], a[184:187], v[72:75], a[24:27]
ds_read_b64_tr_b16 a[180:181], v225 offset:8192
ds_read_b64_tr_b16 a[182:183], v225 offset:12288
v_mfma_f32_16x16x32_bf16 a[56:59], a[184:187], v[76:79], a[56:59]
v_exp_f32 v62, v62
v_mfma_f32_16x16x32_bf16 a[88:91], a[184:187], v[80:83], a[88:91]
v_cvt_pk_bf16_f32 v97, v58, v59
v_cvt_pk_bf16_f32 v98, v60, v61
v_mfma_f32_16x16x32_bf16 a[120:123], a[184:187], v[84:87], a[120:123]
v_exp_f32 v63, v63
v_mfma_f32_16x16x32_bf16 a[124:127], a[188:191], v[84:87], a[124:127]
ds_read_b64_tr_b16 a[184:185], v226 offset:8192
ds_read_b64_tr_b16 a[186:187], v226 offset:12288
v_mfma_f32_16x16x32_bf16 a[92:95], a[188:191], v[80:83], a[92:95]
v_exp_f32 v64, v64
v_mfma_f32_16x16x32_bf16 a[60:63], a[188:191], v[76:79], a[60:63]
v_cvt_pk_bf16_f32 v99, v62, v63
v_subrev_u32 v246, 0x480, v246
v_mfma_f32_16x16x32_bf16 a[28:31], a[188:191], v[72:75], a[28:31]
v_exp_f32 v65, v65
v_smfmac_f32_16x16x64_bf16 a[252:255], a[208:211], v[80:87], v235
s_waitcnt lgkmcnt(4)
ds_read_b64_tr_b16 a[188:189], v227 offset:8192
ds_read_b64_tr_b16 a[190:191], v227 offset:12288
v_mfma_f32_16x16x32_bf16 v[12:15], a[144:147], v[152:155], v[136:139]
v_exp_f32 v66, v66
v_mfma_f32_16x16x32_bf16 v[12:15], a[148:151], v[156:159], v[12:15]
buffer_load_dwordx4 v232, s[12:15], s39 offen offset:2048 lds
v_mfma_f32_16x16x32_bf16 v[12:15], a[152:155], v[160:163], v[12:15]
v_exp_f32 v67, v67
v_mfma_f32_16x16x32_bf16 v[12:15], a[156:159], v[164:167], v[12:15]
v_cvt_pk_bf16_f32 v100, v64, v65
v_cvt_pk_bf16_f32 v101, v66, v67
v_mfma_f32_16x16x32_bf16 v[20:23], a[156:159], v[180:183], v[140:143]
v_exp_f32 v68, v68
v_mfma_f32_16x16x32_bf16 v[20:23], a[152:155], v[176:179], v[20:23]
v_mad_u32_u24 v5, v5, s88, v244
v_mad_u32_u24 v6, v6, s88, v245
v_mfma_f32_16x16x32_bf16 v[20:23], a[148:151], v[172:175], v[20:23]
v_exp_f32 v69, v69
v_mfma_f32_16x16x32_bf16 v[20:23], a[144:147], v[168:171], v[20:23]
v_cvt_pk_bf16_f32 v102, v68, v69
v_mad_u32_u24 v7, v7, s88, v246
v_mfma_f32_16x16x32_bf16 v[28:31], a[144:147], v[184:187], v[144:147]
v_exp_f32 v70, v70
v_mfma_f32_16x16x32_bf16 v[28:31], a[148:151], v[188:191], v[28:31]
v_lshrrev_b32 v249, 1, v1
v_mul_u32_u24 v249, 0x480, v249
v_mfma_f32_16x16x32_bf16 v[28:31], a[152:155], v[192:195], v[28:31]
v_exp_f32 v71, v71
v_mfma_f32_16x16x32_bf16 v[28:31], a[156:159], v[196:199], v[28:31]
v_cvt_pk_bf16_f32 v103, v70, v71
v_and_b32 v248, 1, v1
v_mfma_f32_16x16x32_bf16 v[36:39], a[156:159], v[212:215], v[148:151]
ds_read_b128 a[156:159], v219 offset:61440
v_lshl_add_u32 v249, v248, 4, v249
v_mfma_f32_16x16x32_bf16 v[36:39], a[152:155], v[208:211], v[36:39]
ds_read_b128 a[152:155], v218 offset:61440
v_bfe_u32 v248, v1, 2, 2
v_mfma_f32_16x16x32_bf16 v[36:39], a[148:151], v[204:207], v[36:39]
ds_read_b128 a[148:151], v217 offset:61440
v_lshl_add_u32 v248, v4, 3, v248
v_mfma_f32_16x16x32_bf16 v[36:39], a[144:147], v[200:203], v[36:39]
ds_read_b128 a[144:147], v216 offset:61440
v_lshlrev_b32 v248, 6, v248
v_lshl_add_u32 v248, v250, 3, v248
v_mfma_f32_16x16x32_bf16 a[0:3], a[160:163], v[88:91], a[0:3]
v_exp_f32 v8, v8
v_mfma_f32_16x16x32_bf16 a[32:35], a[160:163], v[92:95], a[32:35]
s_add_u32 m0, s49, 0
v_exp_f32 v9, v9
v_mfma_f32_16x16x32_bf16 a[64:67], a[160:163], v[96:99], a[64:67]
buffer_load_dwordx4 v5, s[20:23], s46 offen sc0 sc1 lds
v_mfma_f32_16x16x32_bf16 a[96:99], a[160:163], v[100:103], a[96:99]
v_exp_f32 v10, v10
v_mfma_f32_16x16x32_bf16 a[100:103], a[164:167], v[100:103], a[100:103]
ds_read_b64_tr_b16 a[160:161], v220 offset:16384
ds_read_b64_tr_b16 a[162:163], v220 offset:20480
v_mfma_f32_16x16x32_bf16 a[68:71], a[164:167], v[96:99], a[68:71]
v_exp_f32 v11, v11
v_mfma_f32_16x16x32_bf16 a[36:39], a[164:167], v[92:95], a[36:39]
v_cvt_pk_bf16_f32 v72, v8, v9
v_cvt_pk_bf16_f32 v73, v10, v11
v_mfma_f32_16x16x32_bf16 a[4:7], a[164:167], v[88:91], a[4:7]
s_add_u32 m0, s49, 1024
v_exp_f32 v12, v12
v_mfma_f32_16x16x32_bf16 a[8:11], a[168:171], v[88:91], a[8:11]
buffer_load_dwordx4 v6, s[20:23], s46 offen sc0 sc1 lds
v_mfma_f32_16x16x32_bf16 a[40:43], a[168:171], v[92:95], a[40:43]
v_exp_f32 v13, v13
v_mfma_f32_16x16x32_bf16 a[72:75], a[168:171], v[96:99], a[72:75]
ds_read_b64_tr_b16 a[164:165], v221 offset:16384
ds_read_b64_tr_b16 a[166:167], v221 offset:20480
v_mfma_f32_16x16x32_bf16 a[104:107], a[168:171], v[100:103], a[104:107]
v_exp_f32 v14, v14
v_mfma_f32_16x16x32_bf16 a[108:111], a[172:175], v[100:103], a[108:111]
ds_read_b64_tr_b16 a[168:169], v222 offset:16384
ds_read_b64_tr_b16 a[170:171], v222 offset:20480
v_mfma_f32_16x16x32_bf16 a[76:79], a[172:175], v[96:99], a[76:79]
v_exp_f32 v15, v15
v_mfma_f32_16x16x32_bf16 a[44:47], a[172:175], v[92:95], a[44:47]
s_add_u32 m0, s49, 2048
v_cvt_pk_bf16_f32 v74, v12, v13
v_cvt_pk_bf16_f32 v75, v14, v15
v_mfma_f32_16x16x32_bf16 a[12:15], a[172:175], v[88:91], a[12:15]
v_exp_f32 v16, v16
v_smfmac_f32_16x16x64_bf16 a[248:251], a[208:211], v[88:95], v235
buffer_load_dwordx4 v7, s[20:23], s47 offen sc0 sc1 lds
v_mfma_f32_16x16x32_bf16 v[40:43], a[128:131], v[152:155], v[136:139]
v_exp_f32 v17, v17
v_mfma_f32_16x16x32_bf16 v[40:43], a[132:135], v[156:159], v[40:43]
ds_read_b64_tr_b16 a[172:173], v223 offset:16384
ds_read_b64_tr_b16 a[174:175], v223 offset:20480
v_mfma_f32_16x16x32_bf16 v[40:43], a[136:139], v[160:163], v[40:43]
v_exp_f32 v18, v18
v_mfma_f32_16x16x32_bf16 v[40:43], a[140:143], v[164:167], v[40:43]
v_cvt_pk_bf16_f32 v76, v16, v17
v_add_u32 v248, s49, v248
v_mfma_f32_16x16x32_bf16 v[48:51], a[140:143], v[180:183], v[140:143]
s_add_u32 m0, s49, 3072
v_exp_f32 v19, v19
v_mfma_f32_16x16x32_bf16 v[48:51], a[136:139], v[176:179], v[48:51]
s_add_u32 s48, s92, 1024
buffer_load_dwordx4 v249, s[64:67], s48 offen  lds
v_mfma_f32_16x16x32_bf16 v[48:51], a[132:135], v[172:175], v[48:51]
v_exp_f32 v20, v20
v_mfma_f32_16x16x32_bf16 v[48:51], a[128:131], v[168:171], v[48:51]
v_cvt_pk_bf16_f32 v77, v18, v19
v_and_b32 v244, 7, v1
v_mfma_f32_16x16x32_bf16 v[56:59], a[128:131], v[184:187], v[144:147]
v_exp_f32 v21, v21
v_mfma_f32_16x16x32_bf16 v[56:59], a[132:135], v[188:191], v[56:59]
v_cvt_pk_bf16_f32 v78, v20, v21
v_lshlrev_b32 v245, 1, v244
v_mfma_f32_16x16x32_bf16 v[56:59], a[136:139], v[192:195], v[56:59]
v_exp_f32 v22, v22
v_mfma_f32_16x16x32_bf16 v[56:59], a[140:143], v[196:199], v[56:59]
s_add_u32 m0, s37, 114688
v_xor_b32 v245, v245, v4
v_lshlrev_b32 v245, 4, v245
v_mfma_f32_16x16x32_bf16 v[64:67], a[140:143], v[212:215], v[148:151]
v_exp_f32 v23, v23
v_mfma_f32_16x16x32_bf16 v[64:67], a[136:139], v[208:211], v[64:67]
buffer_load_dwordx4 v233, s[12:15], s39 offen offset:3072 lds
v_mfma_f32_16x16x32_bf16 v[64:67], a[132:135], v[204:207], v[64:67]
v_exp_f32 v24, v24
v_mfma_f32_16x16x32_bf16 v[64:67], a[128:131], v[200:203], v[64:67]
v_exp_f32 v25, v25
v_mfma_f32_16x16x32_bf16 a[16:19], a[176:179], v[88:91], a[16:19]
ds_read_b128 a[140:143], v219 offset:32768
ds_read_b128 a[136:139], v218 offset:32768
v_mfma_f32_16x16x32_bf16 a[48:51], a[176:179], v[92:95], a[48:51]
v_exp_f32 v26, v26
v_mfma_f32_16x16x32_bf16 a[80:83], a[176:179], v[96:99], a[80:83]
s_add_u32 s39, s39, 16384
ds_read_b128 a[132:135], v217 offset:32768
ds_read_b128 a[128:131], v216 offset:32768
v_mfma_f32_16x16x32_bf16 a[112:115], a[176:179], v[100:103], a[112:115]
s_waitcnt lgkmcnt(4)
s_add_u32 m0, s37, 0
v_exp_f32 v27, v27
v_mfma_f32_16x16x32_bf16 a[116:119], a[180:183], v[100:103], a[116:119]
buffer_load_dwordx4 v228, s[8:11], s38 offen offset:0 lds
v_mfma_f32_16x16x32_bf16 a[84:87], a[180:183], v[96:99], a[84:87]
v_exp_f32 v28, v28
v_mfma_f32_16x16x32_bf16 a[52:55], a[180:183], v[92:95], a[52:55]
ds_read_b64_tr_b16 a[176:177], v224 offset:16384
ds_read_b64_tr_b16 a[178:179], v224 offset:20480
v_mfma_f32_16x16x32_bf16 a[20:23], a[180:183], v[88:91], a[20:23]
v_exp_f32 v29, v29
v_mfma_f32_16x16x32_bf16 a[24:27], a[184:187], v[88:91], a[24:27]
ds_read_b64_tr_b16 a[180:181], v225 offset:16384
ds_read_b64_tr_b16 a[182:183], v225 offset:20480
v_mfma_f32_16x16x32_bf16 a[56:59], a[184:187], v[92:95], a[56:59]
v_exp_f32 v30, v30
v_mfma_f32_16x16x32_bf16 a[88:91], a[184:187], v[96:99], a[88:91]
buffer_load_dwordx4 v229, s[8:11], s38 offen offset:1024 lds
v_mfma_f32_16x16x32_bf16 a[120:123], a[184:187], v[100:103], a[120:123]
v_exp_f32 v31, v31
v_mfma_f32_16x16x32_bf16 a[124:127], a[188:191], v[100:103], a[124:127]
ds_read_b64_tr_b16 a[184:185], v226 offset:16384
ds_read_b64_tr_b16 a[186:187], v226 offset:20480
v_mfma_f32_16x16x32_bf16 a[92:95], a[188:191], v[96:99], a[92:95]
v_exp_f32 v32, v32
v_mfma_f32_16x16x32_bf16 a[60:63], a[188:191], v[92:95], a[60:63]
v_cvt_pk_bf16_f32 v79, v22, v23
v_cvt_pk_bf16_f32 v80, v24, v25
v_mfma_f32_16x16x32_bf16 a[28:31], a[188:191], v[88:91], a[28:31]
v_exp_f32 v33, v33
v_smfmac_f32_16x16x64_bf16 a[252:255], a[208:211], v[96:103], v235
buffer_load_dwordx4 v230, s[8:11], s38 offen offset:2048 lds
v_mfma_f32_16x16x32_bf16 v[44:47], a[144:147], v[152:155], v[136:139]
v_exp_f32 v34, v34
v_mfma_f32_16x16x32_bf16 v[44:47], a[148:151], v[156:159], v[44:47]
ds_read_b64_tr_b16 a[188:189], v227 offset:16384
ds_read_b64_tr_b16 a[190:191], v227 offset:20480
v_mfma_f32_16x16x32_bf16 v[44:47], a[152:155], v[160:163], v[44:47]
v_exp_f32 v35, v35
v_mfma_f32_16x16x32_bf16 v[44:47], a[156:159], v[164:167], v[44:47]
v_cvt_pk_bf16_f32 v81, v26, v27
v_cvt_pk_bf16_f32 v82, v28, v29
v_mfma_f32_16x16x32_bf16 v[52:55], a[156:159], v[180:183], v[140:143]
v_exp_f32 v36, v36
v_mfma_f32_16x16x32_bf16 v[52:55], a[152:155], v[176:179], v[52:55]
v_cvt_pk_bf16_f32 v83, v30, v31
v_cvt_pk_bf16_f32 v84, v32, v33
v_mfma_f32_16x16x32_bf16 v[52:55], a[148:151], v[172:175], v[52:55]
v_exp_f32 v37, v37
v_mfma_f32_16x16x32_bf16 v[52:55], a[144:147], v[168:171], v[52:55]
buffer_load_dwordx4 v231, s[8:11], s38 offen offset:3072 lds
v_mfma_f32_16x16x32_bf16 v[60:63], a[144:147], v[184:187], v[144:147]
v_exp_f32 v38, v38
v_mfma_f32_16x16x32_bf16 v[60:63], a[148:151], v[188:191], v[60:63]
v_cvt_pk_bf16_f32 v85, v34, v35
v_cvt_pk_bf16_f32 v86, v36, v37
v_mfma_f32_16x16x32_bf16 v[60:63], a[152:155], v[192:195], v[60:63]
v_exp_f32 v39, v39
v_mfma_f32_16x16x32_bf16 v[60:63], a[156:159], v[196:199], v[60:63]
v_cvt_pk_bf16_f32 v87, v38, v39
v_lshl_add_u32 v245, v244, 8, v245
v_mfma_f32_16x16x32_bf16 v[68:71], a[156:159], v[212:215], v[148:151]
ds_read_b128 a[156:159], v219 offset:36864
v_add_u32 v245, s49, v245
v_mfma_f32_16x16x32_bf16 v[68:71], a[152:155], v[208:211], v[68:71]
s_add_u32 s38, s38, 16384
ds_read_b128 a[152:155], v218 offset:36864
v_lshlrev_b32 v246, 4, v4
v_mfma_f32_16x16x32_bf16 v[68:71], a[148:151], v[204:207], v[68:71]
ds_read_b128 a[148:151], v217 offset:36864
v_lshl_add_u32 v246, v244, 6, v246
v_mfma_f32_16x16x32_bf16 v[68:71], a[144:147], v[200:203], v[68:71]
s_cmp_lt_u32 s32, 2
s_cselect_b64 s[88:89], -1, 0
ds_read_b128 a[144:147], v216 offset:36864
v_mfma_f32_16x16x32_bf16 a[0:3], a[160:163], v[72:75], a[0:3]
v_exp_f32 v40, v40
v_mfma_f32_16x16x32_bf16 a[32:35], a[160:163], v[76:79], a[32:35]
v_exp_f32 v41, v41
v_mfma_f32_16x16x32_bf16 a[64:67], a[160:163], v[80:83], a[64:67]
buffer_load_dwordx2 v[252:253], v251, s[76:79], s42 offen sc1
v_mfma_f32_16x16x32_bf16 a[96:99], a[160:163], v[84:87], a[96:99]
v_exp_f32 v42, v42
v_mfma_f32_16x16x32_bf16 a[100:103], a[164:167], v[84:87], a[100:103]
ds_read_b64_tr_b16 a[160:161], v220 offset:24576
ds_read_b64_tr_b16 a[162:163], v220 offset:28672
v_mfma_f32_16x16x32_bf16 a[68:71], a[164:167], v[80:83], a[68:71]
v_exp_f32 v43, v43
v_mfma_f32_16x16x32_bf16 a[36:39], a[164:167], v[76:79], a[36:39]
v_cvt_pk_bf16_f32 v88, v40, v41
v_cvt_pk_bf16_f32 v89, v42, v43
v_mfma_f32_16x16x32_bf16 a[4:7], a[164:167], v[72:75], a[4:7]
v_exp_f32 v44, v44
v_mfma_f32_16x16x32_bf16 a[8:11], a[168:171], v[72:75], a[8:11]
ds_read_b64_tr_b16 a[164:165], v221 offset:24576
ds_read_b64_tr_b16 a[166:167], v221 offset:28672
v_mfma_f32_16x16x32_bf16 a[40:43], a[168:171], v[76:79], a[40:43]
v_exp_f32 v45, v45
v_mfma_f32_16x16x32_bf16 a[72:75], a[168:171], v[80:83], a[72:75]
v_cvt_pk_bf16_f32 v90, v44, v45
v_add_u32 v246, s49, v246
v_mfma_f32_16x16x32_bf16 a[104:107], a[168:171], v[84:87], a[104:107]
v_exp_f32 v46, v46
v_mfma_f32_16x16x32_bf16 a[108:111], a[172:175], v[84:87], a[108:111]
ds_read_b64_tr_b16 a[168:169], v222 offset:24576
ds_read_b64_tr_b16 a[170:171], v222 offset:28672
v_mfma_f32_16x16x32_bf16 a[76:79], a[172:175], v[80:83], a[76:79]
v_exp_f32 v47, v47
v_mfma_f32_16x16x32_bf16 a[44:47], a[172:175], v[76:79], a[44:47]
v_cvt_pk_bf16_f32 v91, v46, v47
v_xor_b32 v5, 64, v245
v_mfma_f32_16x16x32_bf16 a[12:15], a[172:175], v[72:75], a[12:15]
s_waitcnt lgkmcnt(4)
v_exp_f32 v48, v48
v_smfmac_f32_16x16x64_bf16 a[248:251], a[208:211], v[72:79], v235
s_add_u32 s42, s42, s43
buffer_load_dword v255, v243, s[28:31], s45 offen
v_mfma_f32_16x16x32_bf16 v[8:11], a[128:131], v[152:155], v[136:139]
v_exp_f32 v49, v49
v_mfma_f32_16x16x32_bf16 v[8:11], a[132:135], v[156:159], v[8:11]
ds_read_b64_tr_b16 a[172:173], v223 offset:24576
ds_read_b64_tr_b16 a[174:175], v223 offset:28672
v_mfma_f32_16x16x32_bf16 v[8:11], a[136:139], v[160:163], v[8:11]
v_exp_f32 v50, v50
v_mfma_f32_16x16x32_bf16 v[8:11], a[140:143], v[164:167], v[8:11]
v_cvt_pk_bf16_f32 v92, v48, v49
v_xor_b32 v6, 128, v245
v_mfma_f32_16x16x32_bf16 v[16:19], a[140:143], v[180:183], v[140:143]
v_exp_f32 v51, v51
v_mfma_f32_16x16x32_bf16 v[16:19], a[136:139], v[176:179], v[16:19]
v_cvt_pk_bf16_f32 v93, v50, v51
v_xor_b32 v7, 192, v245
v_mfma_f32_16x16x32_bf16 v[16:19], a[132:135], v[172:175], v[16:19]
v_exp_f32 v52, v52
v_mfma_f32_16x16x32_bf16 v[16:19], a[128:131], v[168:171], v[16:19]
v_lshrrev_b32 v249, 2, v1
v_lshlrev_b32 v249, 5, v249
v_mfma_f32_16x16x32_bf16 v[24:27], a[128:131], v[184:187], v[144:147]
v_exp_f32 v53, v53
v_mfma_f32_16x16x32_bf16 v[24:27], a[132:135], v[188:191], v[24:27]
v_cvt_pk_bf16_f32 v94, v52, v53
v_lshl_add_u32 v249, v250, 3, v249
v_mfma_f32_16x16x32_bf16 v[24:27], a[136:139], v[192:195], v[24:27]
v_exp_f32 v54, v54
v_mfma_f32_16x16x32_bf16 v[24:27], a[140:143], v[196:199], v[24:27]
v_add_u32 v249, s49, v249
v_mfma_f32_16x16x32_bf16 v[32:35], a[140:143], v[212:215], v[148:151]
v_exp_f32 v55, v55
v_mfma_f32_16x16x32_bf16 v[32:35], a[136:139], v[208:211], v[32:35]
ds_read_b128 a[140:143], v219 offset:40960
ds_read_b128 a[136:139], v218 offset:40960
v_mfma_f32_16x16x32_bf16 v[32:35], a[132:135], v[204:207], v[32:35]
v_exp_f32 v56, v56
v_mfma_f32_16x16x32_bf16 v[32:35], a[128:131], v[200:203], v[32:35]
s_add_u32 s45, s45, 589824
v_exp_f32 v57, v57
v_mfma_f32_16x16x32_bf16 a[16:19], a[176:179], v[72:75], a[16:19]
global_load_dword v255, v242, s[72:73]
v_mfma_f32_16x16x32_bf16 a[48:51], a[176:179], v[76:79], a[48:51]
v_exp_f32 v58, v58
v_mfma_f32_16x16x32_bf16 a[80:83], a[176:179], v[80:83], a[80:83]
ds_read_b128 a[132:135], v217 offset:40960
ds_read_b128 a[128:131], v216 offset:40960
v_mfma_f32_16x16x32_bf16 a[112:115], a[176:179], v[84:87], a[112:115]
v_exp_f32 v59, v59
v_mfma_f32_16x16x32_bf16 a[116:119], a[180:183], v[84:87], a[116:119]
ds_read_b64_tr_b16 a[176:177], v224 offset:24576
ds_read_b64_tr_b16 a[178:179], v224 offset:28672
v_mfma_f32_16x16x32_bf16 a[84:87], a[180:183], v[80:83], a[84:87]
v_exp_f32 v60, v60
v_mfma_f32_16x16x32_bf16 a[52:55], a[180:183], v[76:79], a[52:55]
v_cvt_pk_bf16_f32 v95, v54, v55
v_cvt_pk_bf16_f32 v96, v56, v57
v_mfma_f32_16x16x32_bf16 a[20:23], a[180:183], v[72:75], a[20:23]
v_exp_f32 v61, v61
v_mfma_f32_16x16x32_bf16 a[24:27], a[184:187], v[72:75], a[24:27]
ds_read_b64_tr_b16 a[180:181], v225 offset:24576
ds_read_b64_tr_b16 a[182:183], v225 offset:28672
v_mfma_f32_16x16x32_bf16 a[56:59], a[184:187], v[76:79], a[56:59]
v_exp_f32 v62, v62
v_mfma_f32_16x16x32_bf16 a[88:91], a[184:187], v[80:83], a[88:91]
v_cvt_pk_bf16_f32 v97, v58, v59
v_cvt_pk_bf16_f32 v98, v60, v61
v_mfma_f32_16x16x32_bf16 a[120:123], a[184:187], v[84:87], a[120:123]
v_exp_f32 v63, v63
v_mfma_f32_16x16x32_bf16 a[124:127], a[188:191], v[84:87], a[124:127]
ds_read_b64_tr_b16 a[184:185], v226 offset:24576
ds_read_b64_tr_b16 a[186:187], v226 offset:28672
v_mfma_f32_16x16x32_bf16 a[92:95], a[188:191], v[80:83], a[92:95]
v_exp_f32 v64, v64
v_mfma_f32_16x16x32_bf16 a[60:63], a[188:191], v[76:79], a[60:63]
buffer_load_dword v255, v0, s[24:27], s44 offen
v_mfma_f32_16x16x32_bf16 a[28:31], a[188:191], v[72:75], a[28:31]
v_exp_f32 v65, v65
v_smfmac_f32_16x16x64_bf16 a[252:255], a[208:211], v[80:87], v235
ds_read_b64_tr_b16 a[188:189], v227 offset:24576
ds_read_b64_tr_b16 a[190:191], v227 offset:28672
v_mfma_f32_16x16x32_bf16 v[12:15], a[144:147], v[152:155], v[136:139]
v_exp_f32 v66, v66
v_mfma_f32_16x16x32_bf16 v[12:15], a[148:151], v[156:159], v[12:15]
v_cvt_pk_bf16_f32 v99, v62, v63
v_cvt_pk_bf16_f32 v100, v64, v65
v_mfma_f32_16x16x32_bf16 v[12:15], a[152:155], v[160:163], v[12:15]
v_exp_f32 v67, v67
v_mfma_f32_16x16x32_bf16 v[12:15], a[156:159], v[164:167], v[12:15]
v_cvt_pk_bf16_f32 v101, v66, v67
v_mfma_f32_16x16x32_bf16 v[20:23], a[156:159], v[180:183], v[140:143]
v_exp_f32 v68, v68
v_mfma_f32_16x16x32_bf16 v[20:23], a[152:155], v[176:179], v[20:23]
v_mfma_f32_16x16x32_bf16 v[20:23], a[148:151], v[172:175], v[20:23]
v_exp_f32 v69, v69
v_mfma_f32_16x16x32_bf16 v[20:23], a[144:147], v[168:171], v[20:23]
v_cvt_pk_bf16_f32 v102, v68, v69
v_mfma_f32_16x16x32_bf16 v[28:31], a[144:147], v[184:187], v[144:147]
v_exp_f32 v70, v70
v_mfma_f32_16x16x32_bf16 v[28:31], a[148:151], v[188:191], v[28:31]
v_mfma_f32_16x16x32_bf16 v[28:31], a[152:155], v[192:195], v[28:31]
v_exp_f32 v71, v71
v_mfma_f32_16x16x32_bf16 v[28:31], a[156:159], v[196:199], v[28:31]
v_cvt_pk_bf16_f32 v103, v70, v71
v_mfma_f32_16x16x32_bf16 v[36:39], a[156:159], v[212:215], v[148:151]
ds_read_b128 a[156:159], v219 offset:45056
v_mfma_f32_16x16x32_bf16 v[36:39], a[152:155], v[208:211], v[36:39]
s_add_u32 s44, s44, 4096
ds_read_b128 a[152:155], v218 offset:45056
v_mfma_f32_16x16x32_bf16 v[36:39], a[148:151], v[204:207], v[36:39]
ds_read_b128 a[148:151], v217 offset:45056
v_mfma_f32_16x16x32_bf16 v[36:39], a[144:147], v[200:203], v[36:39]
ds_read_b128 a[144:147], v216 offset:45056
v_mfma_f32_16x16x32_bf16 a[0:3], a[160:163], v[88:91], a[0:3]
v_exp_f32 v8, v8
v_mfma_f32_16x16x32_bf16 a[32:35], a[160:163], v[92:95], a[32:35]
v_exp_f32 v9, v9
v_mfma_f32_16x16x32_bf16 a[64:67], a[160:163], v[96:99], a[64:67]
v_cvt_pk_bf16_f32 v72, v8, v9
v_mfma_f32_16x16x32_bf16 a[96:99], a[160:163], v[100:103], a[96:99]
s_waitcnt lgkmcnt(4)
v_exp_f32 v10, v10
v_mfma_f32_16x16x32_bf16 a[100:103], a[164:167], v[100:103], a[100:103]
v_mfma_f32_16x16x32_bf16 a[68:71], a[164:167], v[96:99], a[68:71]
v_exp_f32 v11, v11
s_waitcnt vmcnt(4) lgkmcnt(0)
s_barrier
v_mfma_f32_16x16x32_bf16 a[36:39], a[164:167], v[92:95], a[36:39]
ds_read_b64_tr_b16 a[160:161], v220 offset:32768
ds_read_b64_tr_b16 a[162:163], v220 offset:36864
v_mfma_f32_16x16x32_bf16 a[4:7], a[164:167], v[88:91], a[4:7]
s_add_u32 m0, s37, 65536
v_exp_f32 v12, v12
v_mfma_f32_16x16x32_bf16 a[8:11], a[168:171], v[88:91], a[8:11]
s_waitcnt vmcnt(9)
s_nop 0
buffer_load_dwordx4 v232, s[12:15], s39 offen offset:0 lds
v_mfma_f32_16x16x32_bf16 a[40:43], a[168:171], v[92:95], a[40:43]
v_exp_f32 v13, v13
v_mfma_f32_16x16x32_bf16 a[72:75], a[168:171], v[96:99], a[72:75]
ds_read_b64_tr_b16 a[164:165], v221 offset:32768
ds_read_b64_tr_b16 a[166:167], v221 offset:36864
v_mfma_f32_16x16x32_bf16 a[104:107], a[168:171], v[100:103], a[104:107]
v_exp_f32 v14, v14
v_mfma_f32_16x16x32_bf16 a[108:111], a[172:175], v[100:103], a[108:111]
ds_read_b64_tr_b16 a[168:169], v222 offset:32768
ds_read_b64_tr_b16 a[170:171], v222 offset:36864
v_mfma_f32_16x16x32_bf16 a[76:79], a[172:175], v[96:99], a[76:79]
v_exp_f32 v15, v15
v_mfma_f32_16x16x32_bf16 a[44:47], a[172:175], v[92:95], a[44:47]
v_cvt_pk_bf16_f32 v73, v10, v11
v_cvt_pk_bf16_f32 v74, v12, v13
v_mfma_f32_16x16x32_bf16 a[12:15], a[172:175], v[88:91], a[12:15]
v_exp_f32 v16, v16
v_smfmac_f32_16x16x64_bf16 a[248:251], a[208:211], v[88:95], v235
buffer_load_dwordx4 v233, s[12:15], s39 offen offset:1024 lds
v_mfma_f32_16x16x32_bf16 v[40:43], a[128:131], v[152:155], v[136:139]
v_exp_f32 v17, v17
v_mfma_f32_16x16x32_bf16 v[40:43], a[132:135], v[156:159], v[40:43]
ds_read_b64_tr_b16 a[172:173], v223 offset:32768
ds_read_b64_tr_b16 a[174:175], v223 offset:36864
v_mfma_f32_16x16x32_bf16 v[40:43], a[136:139], v[160:163], v[40:43]
v_exp_f32 v18, v18
v_mfma_f32_16x16x32_bf16 v[40:43], a[140:143], v[164:167], v[40:43]
v_cvt_pk_bf16_f32 v75, v14, v15
v_cvt_pk_bf16_f32 v76, v16, v17
v_mfma_f32_16x16x32_bf16 v[48:51], a[140:143], v[180:183], v[140:143]
v_exp_f32 v19, v19
v_mfma_f32_16x16x32_bf16 v[48:51], a[136:139], v[176:179], v[48:51]
ds_read_b64_tr_b16 a[192:193], v248 offset:4096
v_cvt_pk_bf16_f32 v77, v18, v19
v_mfma_f32_16x16x32_bf16 v[48:51], a[132:135], v[172:175], v[48:51]
v_exp_f32 v20, v20
v_mfma_f32_16x16x32_bf16 v[48:51], a[128:131], v[168:171], v[48:51]
ds_read_b64_tr_b16 a[194:195], v248 offset:4352
ds_read_b64_tr_b16 a[196:197], v248 offset:4128
v_mfma_f32_16x16x32_bf16 v[56:59], a[128:131], v[184:187], v[144:147]
v_exp_f32 v21, v21
v_mfma_f32_16x16x32_bf16 v[56:59], a[132:135], v[188:191], v[56:59]
buffer_load_dwordx4 v232, s[12:15], s39 offen offset:2048 lds
v_mfma_f32_16x16x32_bf16 v[56:59], a[136:139], v[192:195], v[56:59]
v_exp_f32 v22, v22
v_mfma_f32_16x16x32_bf16 v[56:59], a[140:143], v[196:199], v[56:59]
ds_read_b64_tr_b16 a[198:199], v248 offset:4384
v_cvt_pk_bf16_f32 v78, v20, v21
v_mfma_f32_16x16x32_bf16 v[64:67], a[140:143], v[212:215], v[148:151]
v_exp_f32 v23, v23
v_mfma_f32_16x16x32_bf16 v[64:67], a[136:139], v[208:211], v[64:67]
ds_read_b128 a[140:143], v219 offset:16384
ds_read_b128 a[136:139], v218 offset:16384
v_mfma_f32_16x16x32_bf16 v[64:67], a[132:135], v[204:207], v[64:67]
v_exp_f32 v24, v24
v_mfma_f32_16x16x32_bf16 v[64:67], a[128:131], v[200:203], v[64:67]
v_exp_f32 v25, v25
v_mfma_f32_16x16x32_bf16 a[16:19], a[176:179], v[88:91], a[16:19]
ds_read_b128 a[132:135], v217 offset:16384
ds_read_b128 a[128:131], v216 offset:16384
v_mfma_f32_16x16x32_bf16 a[48:51], a[176:179], v[92:95], a[48:51]
v_exp_f32 v26, v26
v_mfma_f32_16x16x32_bf16 a[80:83], a[176:179], v[96:99], a[80:83]
buffer_load_dwordx4 v233, s[12:15], s39 offen offset:3072 lds
v_mfma_f32_16x16x32_bf16 a[112:115], a[176:179], v[100:103], a[112:115]
v_exp_f32 v27, v27
v_mfma_f32_16x16x32_bf16 a[116:119], a[180:183], v[100:103], a[116:119]
ds_read_b64_tr_b16 a[176:177], v224 offset:32768
ds_read_b64_tr_b16 a[178:179], v224 offset:36864
v_mfma_f32_16x16x32_bf16 a[84:87], a[180:183], v[96:99], a[84:87]
v_exp_f32 v28, v28
v_mfma_f32_16x16x32_bf16 a[52:55], a[180:183], v[92:95], a[52:55]
v_cvt_pk_bf16_f32 v79, v22, v23
v_cvt_pk_bf16_f32 v80, v24, v25
v_mfma_f32_16x16x32_bf16 a[20:23], a[180:183], v[88:91], a[20:23]
v_exp_f32 v29, v29
v_mfma_f32_16x16x32_bf16 a[24:27], a[184:187], v[88:91], a[24:27]
ds_read_b64_tr_b16 a[180:181], v225 offset:32768
ds_read_b64_tr_b16 a[182:183], v225 offset:36864
v_mfma_f32_16x16x32_bf16 a[56:59], a[184:187], v[92:95], a[56:59]
v_exp_f32 v30, v30
v_mfma_f32_16x16x32_bf16 a[88:91], a[184:187], v[96:99], a[88:91]
v_cvt_pk_bf16_f32 v81, v26, v27
v_cvt_pk_bf16_f32 v82, v28, v29
v_mfma_f32_16x16x32_bf16 a[120:123], a[184:187], v[100:103], a[120:123]
s_add_u32 s39, s39, 16384
v_exp_f32 v31, v31
v_mfma_f32_16x16x32_bf16 a[124:127], a[188:191], v[100:103], a[124:127]
s_add_u32 m0, s37, 49152
ds_read_b64_tr_b16 a[184:185], v226 offset:32768
ds_read_b64_tr_b16 a[186:187], v226 offset:36864
v_mfma_f32_16x16x32_bf16 a[92:95], a[188:191], v[96:99], a[92:95]
v_exp_f32 v32, v32
v_mfma_f32_16x16x32_bf16 a[60:63], a[188:191], v[92:95], a[60:63]
buffer_load_dwordx4 v228, s[8:11], s38 offen offset:0 lds
v_mfma_f32_16x16x32_bf16 a[28:31], a[188:191], v[88:91], a[28:31]
v_exp_f32 v33, v33
v_smfmac_f32_16x16x64_bf16 a[252:255], a[208:211], v[96:103], v235
ds_read_b64_tr_b16 a[188:189], v227 offset:32768
ds_read_b64_tr_b16 a[190:191], v227 offset:36864
v_mfma_f32_16x16x32_bf16 v[44:47], a[144:147], v[152:155], v[136:139]
v_exp_f32 v34, v34
v_mfma_f32_16x16x32_bf16 v[44:47], a[148:151], v[156:159], v[44:47]
v_cvt_pk_bf16_f32 v83, v30, v31
v_cvt_pk_bf16_f32 v84, v32, v33
v_mfma_f32_16x16x32_bf16 v[44:47], a[152:155], v[160:163], v[44:47]
v_exp_f32 v35, v35
v_mfma_f32_16x16x32_bf16 v[44:47], a[156:159], v[164:167], v[44:47]
buffer_load_dwordx4 v229, s[8:11], s38 offen offset:1024 lds
v_mfma_f32_16x16x32_bf16 v[52:55], a[156:159], v[180:183], v[140:143]
v_exp_f32 v36, v36
v_mfma_f32_16x16x32_bf16 v[52:55], a[152:155], v[176:179], v[52:55]
ds_read_b64_tr_b16 a[200:201], v248 offset:6144
v_cvt_pk_bf16_f32 v85, v34, v35
v_mfma_f32_16x16x32_bf16 v[52:55], a[148:151], v[172:175], v[52:55]
v_exp_f32 v37, v37
v_mfma_f32_16x16x32_bf16 v[52:55], a[144:147], v[168:171], v[52:55]
ds_read_b64_tr_b16 a[202:203], v248 offset:6400
v_cvt_pk_bf16_f32 v86, v36, v37
v_mfma_f32_16x16x32_bf16 v[60:63], a[144:147], v[184:187], v[144:147]
v_exp_f32 v38, v38
v_mfma_f32_16x16x32_bf16 v[60:63], a[148:151], v[188:191], v[60:63]
ds_read_b64_tr_b16 a[204:205], v248 offset:6176
ds_read_b64_tr_b16 a[206:207], v248 offset:6432
v_mfma_f32_16x16x32_bf16 v[60:63], a[152:155], v[192:195], v[60:63]
v_exp_f32 v39, v39
v_mfma_f32_16x16x32_bf16 v[60:63], a[156:159], v[196:199], v[60:63]
ds_read_b128 a[228:231], v246 offset:2048
v_cvt_pk_bf16_f32 v87, v38, v39
v_mfma_f32_16x16x32_bf16 v[68:71], a[156:159], v[212:215], v[148:151]
ds_read_b128 a[156:159], v219 offset:20480
ds_read_b128 a[212:215], v245
v_mfma_f32_16x16x32_bf16 v[68:71], a[152:155], v[208:211], v[68:71]
ds_read_b128 a[152:155], v218 offset:20480
ds_read_b128 a[216:219], v5
v_mfma_f32_16x16x32_bf16 v[68:71], a[148:151], v[204:207], v[68:71]
ds_read_b128 a[148:151], v217 offset:20480
v_mfma_f32_16x16x32_bf16 v[68:71], a[144:147], v[200:203], v[68:71]
s_waitcnt lgkmcnt(9)
ds_read_b128 a[144:147], v216 offset:20480
v_mfma_f32_16x16x32_bf16 a[0:3], a[160:163], v[72:75], a[0:3]
v_exp_f32 v40, v40
v_mfma_f32_16x16x32_bf16 a[32:35], a[160:163], v[76:79], a[32:35]
buffer_load_dwordx4 v230, s[8:11], s38 offen offset:2048 lds
v_mfma_f32_16x16x32_bf16 a[64:67], a[160:163], v[80:83], a[64:67]
v_exp_f32 v41, v41
v_mfma_f32_16x16x32_bf16 a[96:99], a[160:163], v[84:87], a[96:99]
ds_read_b64_tr_b16 a[160:161], v220 offset:40960
ds_read_b64_tr_b16 a[162:163], v220 offset:45056
v_mfma_f32_16x16x32_bf16 a[100:103], a[164:167], v[84:87], a[100:103]
v_exp_f32 v42, v42
v_mfma_f32_16x16x32_bf16 a[68:71], a[164:167], v[80:83], a[68:71]
ds_read_b128 a[220:223], v6
v_cvt_pk_bf16_f32 v88, v40, v41
v_mfma_f32_16x16x32_bf16 a[36:39], a[164:167], v[76:79], a[36:39]
v_exp_f32 v43, v43
v_mfma_f32_16x16x32_bf16 a[4:7], a[164:167], v[72:75], a[4:7]
ds_read_b64_tr_b16 a[164:165], v221 offset:40960
ds_read_b64_tr_b16 a[166:167], v221 offset:45056
v_mfma_f32_16x16x32_bf16 a[8:11], a[168:171], v[72:75], a[8:11]
v_exp_f32 v44, v44
v_mfma_f32_16x16x32_bf16 a[40:43], a[168:171], v[76:79], a[40:43]
s_add_u32 m0, s49, 4096
ds_read_b128 a[224:227], v7
v_cvt_pk_bf16_f32 v89, v42, v43
v_mfma_f32_16x16x32_bf16 a[72:75], a[168:171], v[80:83], a[72:75]
s_add_u32 s48, s50, 0
v_exp_f32 v45, v45
v_mfma_f32_16x16x32_bf16 a[104:107], a[168:171], v[84:87], a[104:107]
s_waitcnt lgkmcnt(13)
buffer_load_dwordx4 v238, s[60:63], s48 offen  lds
v_mfma_f32_16x16x32_bf16 a[108:111], a[172:175], v[84:87], a[108:111]
v_exp_f32 v46, v46
v_mfma_f32_16x16x32_bf16 a[76:79], a[172:175], v[80:83], a[76:79]
ds_read_b64_tr_b16 a[168:169], v222 offset:40960
ds_read_b64_tr_b16 a[170:171], v222 offset:45056
v_mfma_f32_16x16x32_bf16 a[44:47], a[172:175], v[76:79], a[44:47]
v_exp_f32 v47, v47
v_mfma_f32_16x16x32_bf16 a[12:15], a[172:175], v[72:75], a[12:15]
ds_read_b64_tr_b16 a[172:173], v223 offset:40960
ds_read_b64_tr_b16 a[174:175], v223 offset:45056
v_smfmac_f32_16x16x64_bf16 a[248:251], a[208:211], v[72:79], v235
s_waitcnt lgkmcnt(7)
v_exp_f32 v48, v48
v_mfma_f32_16x16x32_bf16 v[104:107], a[192:195], a[228:231], 0
s_add_u32 m0, s37, 49152
v_cvt_pk_bf16_f32 v90, v44, v45
v_cvt_pk_bf16_f32 v91, v46, v47
v_mfma_f32_16x16x32_bf16 v[8:11], a[128:131], v[152:155], v[136:139]
v_exp_f32 v49, v49
v_mfma_f32_16x16x32_bf16 v[8:11], a[132:135], v[156:159], v[8:11]
buffer_load_dwordx4 v231, s[8:11], s38 offen offset:3072 lds
v_mfma_f32_16x16x32_bf16 v[8:11], a[136:139], v[160:163], v[8:11]
v_exp_f32 v50, v50
v_mfma_f32_16x16x32_bf16 v[8:11], a[140:143], v[164:167], v[8:11]
ds_read_b64_tr_b16 a[232:233], v249 offset:3072
v_cvt_pk_bf16_f32 v92, v48, v49
v_mfma_f32_16x16x32_bf16 v[16:19], a[140:143], v[180:183], v[140:143]
v_exp_f32 v51, v51
v_mfma_f32_16x16x32_bf16 v[16:19], a[136:139], v[176:179], v[16:19]
ds_read_b64_tr_b16 a[234:235], v249 offset:3584
v_cvt_pk_bf16_f32 v93, v50, v51
v_mfma_f32_16x16x32_bf16 v[16:19], a[132:135], v[172:175], v[16:19]
v_exp_f32 v52, v52
v_mfma_f32_16x16x32_bf16 v[16:19], a[128:131], v[168:171], v[16:19]
s_add_u32 m0, s49, 5120
v_mfma_f32_16x16x32_bf16 v[24:27], a[128:131], v[184:187], v[144:147]
s_add_u32 s48, s50, 147456
v_exp_f32 v53, v53
v_mfma_f32_16x16x32_bf16 v[24:27], a[132:135], v[188:191], v[24:27]
buffer_load_dwordx4 v238, s[60:63], s48 offen  lds
v_mfma_f32_16x16x32_bf16 v[24:27], a[136:139], v[192:195], v[24:27]
v_exp_f32 v54, v54
v_mfma_f32_16x16x32_bf16 v[24:27], a[140:143], v[196:199], v[24:27]
v_cvt_pk_bf16_f32 v94, v52, v53
v_mfma_f32_16x16x32_bf16 v[32:35], a[140:143], v[212:215], v[148:151]
v_exp_f32 v55, v55
v_mfma_f32_16x16x32_bf16 v[32:35], a[136:139], v[208:211], v[32:35]
ds_read_b128 a[140:143], v219 offset:24576
ds_read_b128 a[136:139], v218 offset:24576
v_mfma_f32_16x16x32_bf16 v[32:35], a[132:135], v[204:207], v[32:35]
ds_read_b128 a[132:135], v217 offset:24576
v_cvt_pk_bf16_f32 v95, v54, v55
v_mfma_f32_16x16x32_bf16 v[32:35], a[128:131], v[200:203], v[32:35]
v_exp_f32 v56, v56
v_mfma_f32_16x16x32_bf16 v[108:111], a[196:199], a[228:231], 0
s_add_u32 s38, s38, 16384
ds_read_b128 a[128:131], v216 offset:24576
v_mfma_f32_16x16x32_bf16 a[16:19], a[176:179], v[72:75], a[16:19]
s_add_u32 m0, s37, 81920
v_exp_f32 v57, v57
v_mfma_f32_16x16x32_bf16 a[48:51], a[176:179], v[76:79], a[48:51]
buffer_load_dwordx4 v232, s[12:15], s39 offen offset:0 lds
v_mfma_f32_16x16x32_bf16 a[80:83], a[176:179], v[80:83], a[80:83]
v_exp_f32 v58, v58
v_mfma_f32_16x16x32_bf16 a[112:115], a[176:179], v[84:87], a[112:115]
ds_read_b64_tr_b16 a[176:177], v224 offset:40960
ds_read_b64_tr_b16 a[178:179], v224 offset:45056
v_mfma_f32_16x16x32_bf16 a[116:119], a[180:183], v[84:87], a[116:119]
v_exp_f32 v59, v59
v_mfma_f32_16x16x32_bf16 a[84:87], a[180:183], v[80:83], a[84:87]
v_cvt_pk_bf16_f32 v96, v56, v57
v_cvt_pk_bf16_f32 v97, v58, v59
v_mfma_f32_16x16x32_bf16 a[52:55], a[180:183], v[76:79], a[52:55]
v_exp_f32 v60, v60
v_mfma_f32_16x16x32_bf16 a[20:23], a[180:183], v[72:75], a[20:23]
s_add_u32 m0, s49, 6144
ds_read_b64_tr_b16 a[180:181], v225 offset:40960
ds_read_b64_tr_b16 a[182:183], v225 offset:45056
v_mfma_f32_16x16x32_bf16 a[24:27], a[184:187], v[72:75], a[24:27]
s_add_u32 s48, s50, 294912
v_exp_f32 v61, v61
v_mfma_f32_16x16x32_bf16 a[56:59], a[184:187], v[76:79], a[56:59]
buffer_load_dwordx4 v238, s[60:63], s48 offen  lds
v_mfma_f32_16x16x32_bf16 a[88:91], a[184:187], v[80:83], a[88:91]
v_exp_f32 v62, v62
v_mfma_f32_16x16x32_bf16 a[120:123], a[184:187], v[84:87], a[120:123]
ds_read_b64_tr_b16 a[184:185], v226 offset:40960
ds_read_b64_tr_b16 a[186:187], v226 offset:45056
v_mfma_f32_16x16x32_bf16 a[124:127], a[188:191], v[84:87], a[124:127]
v_exp_f32 v63, v63
v_mfma_f32_16x16x32_bf16 a[92:95], a[188:191], v[80:83], a[92:95]
v_cvt_pk_bf16_f32 v98, v60, v61
v_cvt_pk_bf16_f32 v99, v62, v63
v_mfma_f32_16x16x32_bf16 a[60:63], a[188:191], v[76:79], a[60:63]
v_exp_f32 v64, v64
v_mfma_f32_16x16x32_bf16 a[28:31], a[188:191], v[72:75], a[28:31]
s_add_u32 m0, s37, 81920
ds_read_b64_tr_b16 a[188:189], v227 offset:40960
ds_read_b64_tr_b16 a[190:191], v227 offset:45056
v_smfmac_f32_16x16x64_bf16 a[252:255], a[208:211], v[80:87], v235
v_exp_f32 v65, v65
v_mfma_f32_16x16x32_bf16 v[112:115], a[200:203], a[228:231], 0
buffer_load_dwordx4 v233, s[12:15], s39 offen offset:1024 lds
v_mfma_f32_16x16x32_bf16 v[12:15], a[144:147], v[152:155], v[136:139]
v_exp_f32 v66, v66
v_mfma_f32_16x16x32_bf16 v[12:15], a[148:151], v[156:159], v[12:15]
v_cvt_pk_bf16_f32 v100, v64, v65
v_mfma_f32_16x16x32_bf16 v[12:15], a[152:155], v[160:163], v[12:15]
v_exp_f32 v67, v67
v_mfma_f32_16x16x32_bf16 v[12:15], a[156:159], v[164:167], v[12:15]
v_cvt_pk_bf16_f32 v101, v66, v67
v_mfma_f32_16x16x32_bf16 v[20:23], a[156:159], v[180:183], v[140:143]
v_exp_f32 v68, v68
v_mfma_f32_16x16x32_bf16 v[20:23], a[152:155], v[176:179], v[20:23]
buffer_load_dwordx4 v232, s[12:15], s39 offen offset:2048 lds
v_mfma_f32_16x16x32_bf16 v[20:23], a[148:151], v[172:175], v[20:23]
v_exp_f32 v69, v69
v_mfma_f32_16x16x32_bf16 v[20:23], a[144:147], v[168:171], v[20:23]
v_cvt_pk_bf16_f32 v102, v68, v69
v_mfma_f32_16x16x32_bf16 v[28:31], a[144:147], v[184:187], v[144:147]
v_exp_f32 v70, v70
v_mfma_f32_16x16x32_bf16 v[28:31], a[148:151], v[188:191], v[28:31]
v_mfma_f32_16x16x32_bf16 v[28:31], a[152:155], v[192:195], v[28:31]
v_exp_f32 v71, v71
v_mfma_f32_16x16x32_bf16 v[28:31], a[156:159], v[196:199], v[28:31]
v_cvt_pk_bf16_f32 v103, v70, v71
v_mfma_f32_16x16x32_bf16 v[36:39], a[156:159], v[212:215], v[148:151]
ds_read_b128 a[156:159], v219 offset:28672
v_mfma_f32_16x16x32_bf16 v[36:39], a[152:155], v[208:211], v[36:39]
ds_read_b128 a[152:155], v218 offset:28672
v_mfma_f32_16x16x32_bf16 v[36:39], a[148:151], v[204:207], v[36:39]
ds_read_b128 a[148:151], v217 offset:28672
v_mfma_f32_16x16x32_bf16 v[36:39], a[144:147], v[200:203], v[36:39]
ds_read_b128 a[144:147], v216 offset:28672
v_mfma_f32_16x16x32_bf16 v[116:119], a[204:207], a[228:231], 0
v_mfma_f32_16x16x32_bf16 a[0:3], a[160:163], v[88:91], a[0:3]
v_exp_f32 v8, v8
v_mfma_f32_16x16x32_bf16 a[32:35], a[160:163], v[92:95], a[32:35]
v_exp_f32 v9, v9
v_mfma_f32_16x16x32_bf16 a[64:67], a[160:163], v[96:99], a[64:67]
buffer_load_dwordx4 v233, s[12:15], s39 offen offset:3072 lds
v_mfma_f32_16x16x32_bf16 a[96:99], a[160:163], v[100:103], a[96:99]
s_waitcnt lgkmcnt(4)
v_exp_f32 v10, v10
v_mfma_f32_16x16x32_bf16 a[100:103], a[164:167], v[100:103], a[100:103]
ds_read_b64_tr_b16 a[160:161], v220 offset:49152
ds_read_b64_tr_b16 a[162:163], v220 offset:53248
v_mfma_f32_16x16x32_bf16 a[68:71], a[164:167], v[96:99], a[68:71]
v_exp_f32 v11, v11
v_mfma_f32_16x16x32_bf16 a[36:39], a[164:167], v[92:95], a[36:39]
v_cvt_pk_bf16_f32 v72, v8, v9
v_cvt_pk_bf16_f32 v73, v10, v11
v_mfma_f32_16x16x32_bf16 a[4:7], a[164:167], v[88:91], a[4:7]
v_exp_f32 v12, v12
v_mfma_f32_16x16x32_bf16 a[8:11], a[168:171], v[88:91], a[8:11]
s_add_u32 m0, s49, 7168
ds_read_b64_tr_b16 a[164:165], v221 offset:49152
ds_read_b64_tr_b16 a[166:167], v221 offset:53248
v_mfma_f32_16x16x32_bf16 a[40:43], a[168:171], v[92:95], a[40:43]
s_add_u32 s48, s50, 442368
v_exp_f32 v13, v13
v_mfma_f32_16x16x32_bf16 a[72:75], a[168:171], v[96:99], a[72:75]
buffer_load_dwordx4 v238, s[60:63], s48 offen  lds
v_mfma_f32_16x16x32_bf16 a[104:107], a[168:171], v[100:103], a[104:107]
v_exp_f32 v14, v14
v_mfma_f32_16x16x32_bf16 a[108:111], a[172:175], v[100:103], a[108:111]
ds_read_b64_tr_b16 a[168:169], v222 offset:49152
ds_read_b64_tr_b16 a[170:171], v222 offset:53248
v_mfma_f32_16x16x32_bf16 a[76:79], a[172:175], v[96:99], a[76:79]
v_exp_f32 v15, v15
v_mfma_f32_16x16x32_bf16 a[44:47], a[172:175], v[92:95], a[44:47]
v_cvt_pk_bf16_f32 v74, v12, v13
v_cvt_pk_bf16_f32 v75, v14, v15
v_mfma_f32_16x16x32_bf16 a[12:15], a[172:175], v[88:91], a[12:15]
v_exp_f32 v16, v16
v_smfmac_f32_16x16x64_bf16 a[248:251], a[208:211], v[88:95], v235
s_add_u32 s39, s39, 16384
ds_read_b64_tr_b16 a[172:173], v223 offset:49152
ds_read_b64_tr_b16 a[174:175], v223 offset:53248
v_mfma_f32_16x16x32_bf16 v[40:43], a[128:131], v[152:155], v[136:139]
s_add_u32 m0, s37, 32768
v_exp_f32 v17, v17
v_mfma_f32_16x16x32_bf16 v[40:43], a[132:135], v[156:159], v[40:43]
buffer_load_dwordx4 v228, s[8:11], s38 offen offset:0 lds
v_mfma_f32_16x16x32_bf16 v[40:43], a[136:139], v[160:163], v[40:43]
v_exp_f32 v18, v18
v_mfma_f32_16x16x32_bf16 v[40:43], a[140:143], v[164:167], v[40:43]
v_cvt_pk_bf16_f32 v76, v16, v17
v_mfma_f32_16x16x32_bf16 v[48:51], a[140:143], v[180:183], v[140:143]
v_exp_f32 v19, v19
v_mfma_f32_16x16x32_bf16 v[48:51], a[136:139], v[176:179], v[48:51]
v_cvt_pk_bf16_f32 v77, v18, v19
v_mfma_f32_16x16x32_bf16 v[48:51], a[132:135], v[172:175], v[48:51]
v_exp_f32 v20, v20
v_mfma_f32_16x16x32_bf16 v[48:51], a[128:131], v[168:171], v[48:51]
s_add_u32 m0, s49, 0
v_mfma_f32_16x16x32_bf16 v[56:59], a[128:131], v[184:187], v[144:147]
s_add_u32 s48, s50, 0
v_exp_f32 v21, v21
v_mfma_f32_16x16x32_bf16 v[56:59], a[132:135], v[188:191], v[56:59]
buffer_load_dwordx4 v238, s[56:59], s48 offen  lds
v_mfma_f32_16x16x32_bf16 v[56:59], a[136:139], v[192:195], v[56:59]
v_exp_f32 v22, v22
v_mfma_f32_16x16x32_bf16 v[56:59], a[140:143], v[196:199], v[56:59]
v_cvt_pk_bf16_f32 v78, v20, v21
v_mfma_f32_16x16x32_bf16 v[64:67], a[140:143], v[212:215], v[148:151]
v_exp_f32 v23, v23
v_mfma_f32_16x16x32_bf16 v[64:67], a[136:139], v[208:211], v[64:67]
ds_read_b128 a[140:143], v219 offset:0
ds_read_b128 a[136:139], v218 offset:0
v_mfma_f32_16x16x32_bf16 v[64:67], a[132:135], v[204:207], v[64:67]
v_exp_f32 v24, v24
v_mfma_f32_16x16x32_bf16 v[64:67], a[128:131], v[200:203], v[64:67]
s_add_u32 m0, s37, 32768
v_exp_f32 v25, v25
v_mfma_f32_16x16x32_bf16 a[16:19], a[176:179], v[88:91], a[16:19]
buffer_load_dwordx4 v229, s[8:11], s38 offen offset:1024 lds
v_mfma_f32_16x16x32_bf16 a[48:51], a[176:179], v[92:95], a[48:51]
v_exp_f32 v26, v26
v_mfma_f32_16x16x32_bf16 a[80:83], a[176:179], v[96:99], a[80:83]
ds_read_b128 a[132:135], v217 offset:0
ds_read_b128 a[128:131], v216 offset:0
v_mfma_f32_16x16x32_bf16 a[112:115], a[176:179], v[100:103], a[112:115]
v_exp_f32 v27, v27
v_mfma_f32_16x16x32_bf16 a[116:119], a[180:183], v[100:103], a[116:119]
ds_read_b64_tr_b16 a[176:177], v224 offset:49152
ds_read_b64_tr_b16 a[178:179], v224 offset:53248
v_mfma_f32_16x16x32_bf16 a[84:87], a[180:183], v[96:99], a[84:87]
v_exp_f32 v28, v28
v_mfma_f32_16x16x32_bf16 a[52:55], a[180:183], v[92:95], a[52:55]
s_add_u32 m0, s49, 1024
v_cvt_pk_bf16_f32 v79, v22, v23
v_cvt_pk_bf16_f32 v80, v24, v25
v_mfma_f32_16x16x32_bf16 a[20:23], a[180:183], v[88:91], a[20:23]
s_add_u32 s48, s50, 147456
v_exp_f32 v29, v29
v_mfma_f32_16x16x32_bf16 a[24:27], a[184:187], v[88:91], a[24:27]
buffer_load_dwordx4 v238, s[56:59], s48 offen  lds
v_mfma_f32_16x16x32_bf16 a[56:59], a[184:187], v[92:95], a[56:59]
v_exp_f32 v30, v30
v_mfma_f32_16x16x32_bf16 a[88:91], a[184:187], v[96:99], a[88:91]
ds_read_b64_tr_b16 a[180:181], v225 offset:49152
ds_read_b64_tr_b16 a[182:183], v225 offset:53248
v_mfma_f32_16x16x32_bf16 a[120:123], a[184:187], v[100:103], a[120:123]
v_exp_f32 v31, v31
v_mfma_f32_16x16x32_bf16 a[124:127], a[188:191], v[100:103], a[124:127]
ds_read_b64_tr_b16 a[184:185], v226 offset:49152
ds_read_b64_tr_b16 a[186:187], v226 offset:53248
v_mfma_f32_16x16x32_bf16 a[92:95], a[188:191], v[96:99], a[92:95]
v_exp_f32 v32, v32
v_mfma_f32_16x16x32_bf16 a[60:63], a[188:191], v[92:95], a[60:63]
s_add_u32 m0, s37, 32768
v_cvt_pk_bf16_f32 v81, v26, v27
v_cvt_pk_bf16_f32 v82, v28, v29
v_mfma_f32_16x16x32_bf16 a[28:31], a[188:191], v[88:91], a[28:31]
v_exp_f32 v33, v33
v_smfmac_f32_16x16x64_bf16 a[252:255], a[208:211], v[96:103], v235
s_waitcnt lgkmcnt(4)
buffer_load_dwordx4 v230, s[8:11], s38 offen offset:2048 lds
v_mfma_f32_16x16x32_bf16 v[44:47], a[144:147], v[152:155], v[136:139]
v_exp_f32 v34, v34
v_mfma_f32_16x16x32_bf16 v[44:47], a[148:151], v[156:159], v[44:47]
ds_read_b64_tr_b16 a[188:189], v227 offset:49152
ds_read_b64_tr_b16 a[190:191], v227 offset:53248
v_mfma_f32_16x16x32_bf16 v[44:47], a[152:155], v[160:163], v[44:47]
v_exp_f32 v35, v35
v_mfma_f32_16x16x32_bf16 v[44:47], a[156:159], v[164:167], v[44:47]
v_cvt_pk_bf16_f32 v83, v30, v31
v_cvt_pk_bf16_f32 v84, v32, v33
v_mfma_f32_16x16x32_bf16 v[52:55], a[156:159], v[180:183], v[140:143]
v_exp_f32 v36, v36
v_mfma_f32_16x16x32_bf16 v[52:55], a[152:155], v[176:179], v[52:55]
buffer_load_dwordx4 v231, s[8:11], s38 offen offset:3072 lds
v_mfma_f32_16x16x32_bf16 v[52:55], a[148:151], v[172:175], v[52:55]
v_exp_f32 v37, v37
v_mfma_f32_16x16x32_bf16 v[52:55], a[144:147], v[168:171], v[52:55]
v_cvt_pk_bf16_f32 v85, v34, v35
v_cvt_pk_bf16_f32 v86, v36, v37
v_mfma_f32_16x16x32_bf16 v[60:63], a[144:147], v[184:187], v[144:147]
v_exp_f32 v38, v38
v_mfma_f32_16x16x32_bf16 v[60:63], a[148:151], v[188:191], v[60:63]
v_mfma_f32_16x16x32_bf16 v[60:63], a[152:155], v[192:195], v[60:63]
v_exp_f32 v39, v39
v_mfma_f32_16x16x32_bf16 v[60:63], a[156:159], v[196:199], v[60:63]
v_cvt_pk_bf16_f32 v87, v38, v39
v_mfma_f32_16x16x32_bf16 v[68:71], a[156:159], v[212:215], v[148:151]
ds_read_b128 a[156:159], v219 offset:4096
v_mfma_f32_16x16x32_bf16 v[68:71], a[152:155], v[208:211], v[68:71]
s_add_u32 s38, s38, 16384
ds_read_b128 a[152:155], v218 offset:4096
v_mfma_f32_16x16x32_bf16 v[68:71], a[148:151], v[204:207], v[68:71]
ds_read_b128 a[148:151], v217 offset:4096
v_mfma_f32_16x16x32_bf16 v[68:71], a[144:147], v[200:203], v[68:71]
ds_read_b128 a[144:147], v216 offset:4096
v_mfma_f32_16x16x32_bf16 a[0:3], a[160:163], v[72:75], a[0:3]
v_exp_f32 v40, v40
v_mfma_f32_16x16x32_bf16 a[32:35], a[160:163], v[76:79], a[32:35]
s_add_u32 m0, s49, 2048
v_exp_f32 v41, v41
v_mfma_f32_16x16x32_bf16 a[64:67], a[160:163], v[80:83], a[64:67]
s_add_u32 s48, s50, 294912
buffer_load_dwordx4 v238, s[56:59], s48 offen  lds
v_mfma_f32_16x16x32_bf16 a[96:99], a[160:163], v[84:87], a[96:99]
v_exp_f32 v42, v42
v_mfma_f32_16x16x32_bf16 a[100:103], a[164:167], v[84:87], a[100:103]
ds_read_b64_tr_b16 a[160:161], v220 offset:57344
ds_read_b64_tr_b16 a[162:163], v220 offset:61440
v_mfma_f32_16x16x32_bf16 a[68:71], a[164:167], v[80:83], a[68:71]
v_exp_f32 v43, v43
v_mfma_f32_16x16x32_bf16 a[36:39], a[164:167], v[76:79], a[36:39]
v_cvt_pk_bf16_f32 v88, v40, v41
v_cvt_pk_bf16_f32 v89, v42, v43
v_mfma_f32_16x16x32_bf16 a[4:7], a[164:167], v[72:75], a[4:7]
v_exp_f32 v44, v44
v_mfma_f32_16x16x32_bf16 a[8:11], a[168:171], v[72:75], a[8:11]
ds_read_b64_tr_b16 a[164:165], v221 offset:57344
ds_read_b64_tr_b16 a[166:167], v221 offset:61440
v_mfma_f32_16x16x32_bf16 a[40:43], a[168:171], v[76:79], a[40:43]
v_exp_f32 v45, v45
v_mfma_f32_16x16x32_bf16 a[72:75], a[168:171], v[80:83], a[72:75]
v_cvt_pk_bf16_f32 v90, v44, v45
v_mfma_f32_16x16x32_bf16 a[104:107], a[168:171], v[84:87], a[104:107]
s_add_u32 m0, s49, 3072
v_exp_f32 v46, v46
v_mfma_f32_16x16x32_bf16 a[108:111], a[172:175], v[84:87], a[108:111]
s_add_u32 s48, s50, 442368
buffer_load_dwordx4 v238, s[56:59], s48 offen  lds
v_mfma_f32_16x16x32_bf16 a[76:79], a[172:175], v[80:83], a[76:79]
v_exp_f32 v47, v47
v_mfma_f32_16x16x32_bf16 a[44:47], a[172:175], v[76:79], a[44:47]
ds_read_b64_tr_b16 a[168:169], v222 offset:57344
ds_read_b64_tr_b16 a[170:171], v222 offset:61440
v_mfma_f32_16x16x32_bf16 a[12:15], a[172:175], v[72:75], a[12:15]
v_exp_f32 v48, v48
v_smfmac_f32_16x16x64_bf16 a[248:251], a[208:211], v[72:79], v235
ds_read_b64_tr_b16 a[172:173], v223 offset:57344
ds_read_b64_tr_b16 a[174:175], v223 offset:61440
v_mfma_f32_16x16x32_bf16 v[8:11], a[128:131], v[152:155], v[136:139]
v_exp_f32 v49, v49
v_mfma_f32_16x16x32_bf16 v[8:11], a[132:135], v[156:159], v[8:11]
v_cvt_pk_bf16_f32 v91, v46, v47
v_cvt_pk_bf16_f32 v92, v48, v49
v_mfma_f32_16x16x32_bf16 v[8:11], a[136:139], v[160:163], v[8:11]
v_exp_f32 v50, v50
v_mfma_f32_16x16x32_bf16 v[8:11], a[140:143], v[164:167], v[8:11]
v_mfma_f32_16x16x32_bf16 v[16:19], a[140:143], v[180:183], v[140:143]
v_exp_f32 v51, v51
v_mfma_f32_16x16x32_bf16 v[16:19], a[136:139], v[176:179], v[16:19]
buffer_load_dwordx2 v[252:253], v251, s[76:79], s42 offen sc1
v_mfma_f32_16x16x32_bf16 v[16:19], a[132:135], v[172:175], v[16:19]
v_exp_f32 v52, v52
v_mfma_f32_16x16x32_bf16 v[16:19], a[128:131], v[168:171], v[16:19]
v_cvt_pk_bf16_f32 v93, v50, v51
v_mfma_f32_16x16x32_bf16 v[24:27], a[128:131], v[184:187], v[144:147]
v_exp_f32 v53, v53
v_mfma_f32_16x16x32_bf16 v[24:27], a[132:135], v[188:191], v[24:27]
v_cvt_pk_bf16_f32 v94, v52, v53
v_mfma_f32_16x16x32_bf16 v[24:27], a[136:139], v[192:195], v[24:27]
v_exp_f32 v54, v54
v_mfma_f32_16x16x32_bf16 v[24:27], a[140:143], v[196:199], v[24:27]
v_mfma_f32_16x16x32_bf16 v[32:35], a[140:143], v[212:215], v[148:151]
v_exp_f32 v55, v55
v_mfma_f32_16x16x32_bf16 v[32:35], a[136:139], v[208:211], v[32:35]
ds_read_b128 a[140:143], v219 offset:8192
ds_read_b128 a[136:139], v218 offset:8192
v_mfma_f32_16x16x32_bf16 v[32:35], a[132:135], v[204:207], v[32:35]
v_exp_f32 v56, v56
v_mfma_f32_16x16x32_bf16 v[32:35], a[128:131], v[200:203], v[32:35]
s_add_u32 s42, s42, s43
v_exp_f32 v57, v57
v_mfma_f32_16x16x32_bf16 a[16:19], a[176:179], v[72:75], a[16:19]
buffer_load_dword v255, v243, s[28:31], s45 offen
v_mfma_f32_16x16x32_bf16 a[48:51], a[176:179], v[76:79], a[48:51]
v_exp_f32 v58, v58
v_mfma_f32_16x16x32_bf16 a[80:83], a[176:179], v[80:83], a[80:83]
ds_read_b128 a[132:135], v217 offset:8192
ds_read_b128 a[128:131], v216 offset:8192
v_mfma_f32_16x16x32_bf16 a[112:115], a[176:179], v[84:87], a[112:115]
s_waitcnt lgkmcnt(4)
v_exp_f32 v59, v59
v_mfma_f32_16x16x32_bf16 a[116:119], a[180:183], v[84:87], a[116:119]
ds_read_b64_tr_b16 a[176:177], v224 offset:57344
ds_read_b64_tr_b16 a[178:179], v224 offset:61440
v_mfma_f32_16x16x32_bf16 a[84:87], a[180:183], v[80:83], a[84:87]
v_exp_f32 v60, v60
v_mfma_f32_16x16x32_bf16 a[52:55], a[180:183], v[76:79], a[52:55]
v_cvt_pk_bf16_f32 v95, v54, v55
v_cvt_pk_bf16_f32 v96, v56, v57
v_mfma_f32_16x16x32_bf16 a[20:23], a[180:183], v[72:75], a[20:23]
v_exp_f32 v61, v61
v_mfma_f32_16x16x32_bf16 a[24:27], a[184:187], v[72:75], a[24:27]
ds_read_b64_tr_b16 a[180:181], v225 offset:57344
ds_read_b64_tr_b16 a[182:183], v225 offset:61440
v_mfma_f32_16x16x32_bf16 a[56:59], a[184:187], v[76:79], a[56:59]
s_add_u32 s45, s45, 589824
v_exp_f32 v62, v62
v_mfma_f32_16x16x32_bf16 a[88:91], a[184:187], v[80:83], a[88:91]
global_load_dword v255, v242, s[72:73]
v_mfma_f32_16x16x32_bf16 a[120:123], a[184:187], v[84:87], a[120:123]
v_exp_f32 v63, v63
v_mfma_f32_16x16x32_bf16 a[124:127], a[188:191], v[84:87], a[124:127]
ds_read_b64_tr_b16 a[184:185], v226 offset:57344
ds_read_b64_tr_b16 a[186:187], v226 offset:61440
v_mfma_f32_16x16x32_bf16 a[92:95], a[188:191], v[80:83], a[92:95]
v_exp_f32 v64, v64
v_mfma_f32_16x16x32_bf16 a[60:63], a[188:191], v[76:79], a[60:63]
v_cvt_pk_bf16_f32 v97, v58, v59
v_cvt_pk_bf16_f32 v98, v60, v61
v_mfma_f32_16x16x32_bf16 a[28:31], a[188:191], v[72:75], a[28:31]
v_exp_f32 v65, v65
v_smfmac_f32_16x16x64_bf16 a[252:255], a[208:211], v[80:87], v235
ds_read_b64_tr_b16 a[188:189], v227 offset:57344
ds_read_b64_tr_b16 a[190:191], v227 offset:61440
v_mfma_f32_16x16x32_bf16 v[12:15], a[144:147], v[152:155], v[136:139]
v_exp_f32 v66, v66
v_mfma_f32_16x16x32_bf16 v[12:15], a[148:151], v[156:159], v[12:15]
v_cvt_pk_bf16_f32 v99, v62, v63
v_cvt_pk_bf16_f32 v100, v64, v65
v_mfma_f32_16x16x32_bf16 v[12:15], a[152:155], v[160:163], v[12:15]
v_exp_f32 v67, v67
v_mfma_f32_16x16x32_bf16 v[12:15], a[156:159], v[164:167], v[12:15]
buffer_load_dword v255, v0, s[24:27], s44 offen
v_mfma_f32_16x16x32_bf16 v[20:23], a[156:159], v[180:183], v[140:143]
v_exp_f32 v68, v68
v_mfma_f32_16x16x32_bf16 v[20:23], a[152:155], v[176:179], v[20:23]
v_cvt_pk_bf16_f32 v101, v66, v67
v_mfma_f32_16x16x32_bf16 v[20:23], a[148:151], v[172:175], v[20:23]
v_exp_f32 v69, v69
v_mfma_f32_16x16x32_bf16 v[20:23], a[144:147], v[168:171], v[20:23]
v_cvt_pk_bf16_f32 v102, v68, v69
v_mfma_f32_16x16x32_bf16 v[28:31], a[144:147], v[184:187], v[144:147]
v_exp_f32 v70, v70
v_mfma_f32_16x16x32_bf16 v[28:31], a[148:151], v[188:191], v[28:31]
v_mfma_f32_16x16x32_bf16 v[28:31], a[152:155], v[192:195], v[28:31]
v_exp_f32 v71, v71
v_mfma_f32_16x16x32_bf16 v[28:31], a[156:159], v[196:199], v[28:31]
v_cvt_pk_bf16_f32 v103, v70, v71
v_mfma_f32_16x16x32_bf16 v[36:39], a[156:159], v[212:215], v[148:151]
ds_read_b128 a[156:159], v219 offset:12288
v_mfma_f32_16x16x32_bf16 v[36:39], a[152:155], v[208:211], v[36:39]
s_add_u32 s44, s44, 4096
ds_read_b128 a[152:155], v218 offset:12288
v_mfma_f32_16x16x32_bf16 v[36:39], a[148:151], v[204:207], v[36:39]
ds_read_b128 a[148:151], v217 offset:12288
v_mfma_f32_16x16x32_bf16 v[36:39], a[144:147], v[200:203], v[36:39]
ds_read_b128 a[144:147], v216 offset:12288
v_mfma_f32_16x16x32_bf16 a[0:3], a[160:163], v[88:91], a[0:3]
v_exp_f32 v8, v8
v_mfma_f32_16x16x32_bf16 a[32:35], a[160:163], v[92:95], a[32:35]
v_exp_f32 v9, v9
v_mfma_f32_16x16x32_bf16 a[64:67], a[160:163], v[96:99], a[64:67]
v_cvt_pk_bf16_f32 v72, v8, v9
v_add_u32 v5, s49, v234
v_mfma_f32_16x16x32_bf16 a[96:99], a[160:163], v[100:103], a[96:99]
s_add_u32 s46, s3, 131072
v_exp_f32 v10, v10
v_mfma_f32_16x16x32_bf16 a[100:103], a[164:167], v[100:103], a[100:103]
v_add_u32 v6, s46, v234
v_lshlrev_b32 v7, 1, v4
v_mfma_f32_16x16x32_bf16 a[68:71], a[164:167], v[96:99], a[68:71]
v_exp_f32 v11, v11
s_waitcnt vmcnt(6) lgkmcnt(0)
s_barrier
v_mfma_f32_16x16x32_bf16 a[36:39], a[164:167], v[92:95], a[36:39]
ds_read_b64_tr_b16 a[160:161], v220 offset:0
ds_read_b64_tr_b16 a[162:163], v220 offset:4096
v_mfma_f32_16x16x32_bf16 a[4:7], a[164:167], v[88:91], a[4:7]
s_add_u32 m0, s37, 98304
v_exp_f32 v12, v12
v_mfma_f32_16x16x32_bf16 a[8:11], a[168:171], v[88:91], a[8:11]
buffer_load_dwordx4 v232, s[12:15], s39 offen offset:0 lds
v_mfma_f32_16x16x32_bf16 a[40:43], a[168:171], v[92:95], a[40:43]
v_exp_f32 v13, v13
v_mfma_f32_16x16x32_bf16 a[72:75], a[168:171], v[96:99], a[72:75]
ds_read_b64_tr_b16 a[164:165], v221 offset:0
ds_read_b64_tr_b16 a[166:167], v221 offset:4096
v_mfma_f32_16x16x32_bf16 a[104:107], a[168:171], v[100:103], a[104:107]
v_exp_f32 v14, v14
v_mfma_f32_16x16x32_bf16 a[108:111], a[172:175], v[100:103], a[108:111]
ds_read_b64_tr_b16 a[168:169], v222 offset:0
ds_read_b64_tr_b16 a[170:171], v222 offset:4096
v_mfma_f32_16x16x32_bf16 a[76:79], a[172:175], v[96:99], a[76:79]
v_exp_f32 v15, v15
v_mfma_f32_16x16x32_bf16 a[44:47], a[172:175], v[92:95], a[44:47]
v_cvt_pk_bf16_f32 v73, v10, v11
v_cvt_pk_bf16_f32 v74, v12, v13
v_mfma_f32_16x16x32_bf16 a[12:15], a[172:175], v[88:91], a[12:15]
v_exp_f32 v16, v16
v_smfmac_f32_16x16x64_bf16 a[248:251], a[208:211], v[88:95], v235
buffer_load_dwordx4 v233, s[12:15], s39 offen offset:1024 lds
v_mfma_f32_16x16x32_bf16 v[40:43], a[128:131], v[152:155], v[136:139]
v_exp_f32 v17, v17
v_mfma_f32_16x16x32_bf16 v[40:43], a[132:135], v[156:159], v[40:43]
ds_read_b64_tr_b16 a[172:173], v223 offset:0
ds_read_b64_tr_b16 a[174:175], v223 offset:4096
v_mfma_f32_16x16x32_bf16 v[40:43], a[136:139], v[160:163], v[40:43]
v_exp_f32 v18, v18
v_mfma_f32_16x16x32_bf16 v[40:43], a[140:143], v[164:167], v[40:43]
v_cvt_pk_bf16_f32 v75, v14, v15
v_cvt_pk_bf16_f32 v76, v16, v17
v_mfma_f32_16x16x32_bf16 v[48:51], a[140:143], v[180:183], v[140:143]
v_exp_f32 v19, v19
v_mfma_f32_16x16x32_bf16 v[48:51], a[136:139], v[176:179], v[48:51]
v_cvt_pk_bf16_f32 v77, v18, v19
v_xor_b32 v7, v7, v3
v_mfma_f32_16x16x32_bf16 v[48:51], a[132:135], v[172:175], v[48:51]
v_exp_f32 v20, v20
v_mfma_f32_16x16x32_bf16 v[48:51], a[128:131], v[168:171], v[48:51]
v_mul_u32_u24 v249, 0x480, v4
v_lshl_add_u32 v249, v7, 4, v249
v_mfma_f32_16x16x32_bf16 v[56:59], a[128:131], v[184:187], v[144:147]
v_exp_f32 v21, v21
v_mfma_f32_16x16x32_bf16 v[56:59], a[132:135], v[188:191], v[56:59]
buffer_load_dwordx4 v232, s[12:15], s39 offen offset:2048 lds
v_mfma_f32_16x16x32_bf16 v[56:59], a[136:139], v[192:195], v[56:59]
v_exp_f32 v22, v22
v_mfma_f32_16x16x32_bf16 v[56:59], a[140:143], v[196:199], v[56:59]
v_cvt_pk_bf16_f32 v78, v20, v21
v_and_b32 v7, 8, v7
v_mfma_f32_16x16x32_bf16 v[64:67], a[140:143], v[212:215], v[148:151]
v_exp_f32 v23, v23
v_mfma_f32_16x16x32_bf16 v[64:67], a[136:139], v[208:211], v[64:67]
ds_read_b128 a[140:143], v219 offset:49152
ds_read_b128 a[136:139], v218 offset:49152
v_mfma_f32_16x16x32_bf16 v[64:67], a[132:135], v[204:207], v[64:67]
v_exp_f32 v24, v24
v_mfma_f32_16x16x32_bf16 v[64:67], a[128:131], v[200:203], v[64:67]
v_exp_f32 v25, v25
v_mfma_f32_16x16x32_bf16 a[16:19], a[176:179], v[88:91], a[16:19]
ds_read_b128 a[132:135], v217 offset:49152
ds_read_b128 a[128:131], v216 offset:49152
v_mfma_f32_16x16x32_bf16 a[48:51], a[176:179], v[92:95], a[48:51]
v_exp_f32 v26, v26
v_mfma_f32_16x16x32_bf16 a[80:83], a[176:179], v[96:99], a[80:83]
buffer_load_dwordx4 v233, s[12:15], s39 offen offset:3072 lds
v_mfma_f32_16x16x32_bf16 a[112:115], a[176:179], v[100:103], a[112:115]
v_exp_f32 v27, v27
v_mfma_f32_16x16x32_bf16 a[116:119], a[180:183], v[100:103], a[116:119]
ds_read_b64_tr_b16 a[176:177], v224 offset:0
ds_read_b64_tr_b16 a[178:179], v224 offset:4096
v_mfma_f32_16x16x32_bf16 a[84:87], a[180:183], v[96:99], a[84:87]
v_exp_f32 v28, v28
v_mfma_f32_16x16x32_bf16 a[52:55], a[180:183], v[92:95], a[52:55]
v_cvt_pk_bf16_f32 v79, v22, v23
v_cvt_pk_bf16_f32 v80, v24, v25
v_mfma_f32_16x16x32_bf16 a[20:23], a[180:183], v[88:91], a[20:23]
v_exp_f32 v29, v29
v_mfma_f32_16x16x32_bf16 a[24:27], a[184:187], v[88:91], a[24:27]
ds_read_b64_tr_b16 a[180:181], v225 offset:0
ds_read_b64_tr_b16 a[182:183], v225 offset:4096
v_mfma_f32_16x16x32_bf16 a[56:59], a[184:187], v[92:95], a[56:59]
v_exp_f32 v30, v30
v_mfma_f32_16x16x32_bf16 a[88:91], a[184:187], v[96:99], a[88:91]
v_cvt_pk_bf16_f32 v81, v26, v27
v_cvt_pk_bf16_f32 v82, v28, v29
v_mfma_f32_16x16x32_bf16 a[120:123], a[184:187], v[100:103], a[120:123]
s_add_u32 s39, s39, 16384
v_exp_f32 v31, v31
v_mfma_f32_16x16x32_bf16 a[124:127], a[188:191], v[100:103], a[124:127]
s_add_u32 m0, s37, 16384
ds_read_b64_tr_b16 a[184:185], v226 offset:0
ds_read_b64_tr_b16 a[186:187], v226 offset:4096
v_mfma_f32_16x16x32_bf16 a[92:95], a[188:191], v[96:99], a[92:95]
v_exp_f32 v32, v32
v_mfma_f32_16x16x32_bf16 a[60:63], a[188:191], v[92:95], a[60:63]
buffer_load_dwordx4 v228, s[8:11], s38 offen offset:0 lds
v_mfma_f32_16x16x32_bf16 a[28:31], a[188:191], v[88:91], a[28:31]
v_exp_f32 v33, v33
v_smfmac_f32_16x16x64_bf16 a[252:255], a[208:211], v[96:103], v235
ds_read_b64_tr_b16 a[188:189], v227 offset:0
ds_read_b64_tr_b16 a[190:191], v227 offset:4096
v_mfma_f32_16x16x32_bf16 v[44:47], a[144:147], v[152:155], v[136:139]
v_exp_f32 v34, v34
v_mfma_f32_16x16x32_bf16 v[44:47], a[148:151], v[156:159], v[44:47]
v_cvt_pk_bf16_f32 v83, v30, v31
v_cvt_pk_bf16_f32 v84, v32, v33
v_mfma_f32_16x16x32_bf16 v[44:47], a[152:155], v[160:163], v[44:47]
v_exp_f32 v35, v35
v_mfma_f32_16x16x32_bf16 v[44:47], a[156:159], v[164:167], v[44:47]
buffer_load_dwordx4 v229, s[8:11], s38 offen offset:1024 lds
v_mfma_f32_16x16x32_bf16 v[52:55], a[156:159], v[180:183], v[140:143]
v_exp_f32 v36, v36
v_mfma_f32_16x16x32_bf16 v[52:55], a[152:155], v[176:179], v[52:55]
v_cvt_pk_bf16_f32 v85, v34, v35
v_lshlrev_b32 v7, 5, v7
v_mfma_f32_16x16x32_bf16 v[52:55], a[148:151], v[172:175], v[52:55]
v_exp_f32 v37, v37
v_mfma_f32_16x16x32_bf16 v[52:55], a[144:147], v[168:171], v[52:55]
v_cvt_pk_bf16_f32 v86, v36, v37
v_sub_u32 v250, v249, v7
v_mfma_f32_16x16x32_bf16 v[60:63], a[144:147], v[184:187], v[144:147]
v_exp_f32 v38, v38
v_mfma_f32_16x16x32_bf16 v[60:63], a[148:151], v[188:191], v[60:63]
v_add_u32 v250, 128, v250
v_mfma_f32_16x16x32_bf16 v[60:63], a[152:155], v[192:195], v[60:63]
v_exp_f32 v39, v39
v_mfma_f32_16x16x32_bf16 v[60:63], a[156:159], v[196:199], v[60:63]
v_cvt_pk_bf16_f32 v87, v38, v39
v_mfma_f32_16x16x32_bf16 v[68:71], a[156:159], v[212:215], v[148:151]
ds_read_b128 a[156:159], v219 offset:53248
v_mfma_f32_16x16x32_bf16 v[68:71], a[152:155], v[208:211], v[68:71]
ds_read_b128 a[152:155], v218 offset:53248
v_mfma_f32_16x16x32_bf16 v[68:71], a[148:151], v[204:207], v[68:71]
ds_read_b128 a[148:151], v217 offset:53248
v_mfma_f32_16x16x32_bf16 v[68:71], a[144:147], v[200:203], v[68:71]
s_waitcnt lgkmcnt(3)
ds_read_b128 a[144:147], v216 offset:53248
v_mfma_f32_16x16x32_bf16 a[0:3], a[160:163], v[72:75], a[0:3]
s_waitcnt vmcnt(10)
s_nop 0
v_exp_f32 v40, v40
v_mfma_f32_16x16x32_bf16 a[32:35], a[160:163], v[76:79], a[32:35]
v_exp_f32 v41, v41
v_mfma_f32_16x16x32_bf16 a[64:67], a[160:163], v[80:83], a[64:67]
buffer_load_dwordx4 v230, s[8:11], s38 offen offset:2048 lds
v_mfma_f32_16x16x32_bf16 a[96:99], a[160:163], v[84:87], a[96:99]
v_exp_f32 v42, v42
v_mfma_f32_16x16x32_bf16 a[100:103], a[164:167], v[84:87], a[100:103]
ds_read_b64_tr_b16 a[160:161], v220 offset:8192
ds_read_b64_tr_b16 a[162:163], v220 offset:12288
v_mfma_f32_16x16x32_bf16 a[68:71], a[164:167], v[80:83], a[68:71]
v_exp_f32 v43, v43
v_mfma_f32_16x16x32_bf16 a[36:39], a[164:167], v[76:79], a[36:39]
v_cvt_pk_bf16_f32 v88, v40, v41
v_cvt_pk_bf16_f32 v89, v42, v43
v_mfma_f32_16x16x32_bf16 a[4:7], a[164:167], v[72:75], a[4:7]
v_exp_f32 v44, v44
v_mfma_f32_16x16x32_bf16 a[8:11], a[168:171], v[72:75], a[8:11]
ds_read_b64_tr_b16 a[164:165], v221 offset:8192
ds_read_b64_tr_b16 a[166:167], v221 offset:12288
v_mfma_f32_16x16x32_bf16 a[40:43], a[168:171], v[76:79], a[40:43]
v_exp_f32 v45, v45
v_mfma_f32_16x16x32_bf16 a[72:75], a[168:171], v[80:83], a[72:75]
ds_read_b64_tr_b16 a[192:193], v248 offset:0
v_cvt_pk_bf16_f32 v90, v44, v45
v_mfma_f32_16x16x32_bf16 a[104:107], a[168:171], v[84:87], a[104:107]
v_exp_f32 v46, v46
v_mfma_f32_16x16x32_bf16 a[108:111], a[172:175], v[84:87], a[108:111]
ds_read_b64_tr_b16 a[168:169], v222 offset:8192
ds_read_b64_tr_b16 a[170:171], v222 offset:12288
v_mfma_f32_16x16x32_bf16 a[76:79], a[172:175], v[80:83], a[76:79]
v_exp_f32 v47, v47
v_mfma_f32_16x16x32_bf16 a[44:47], a[172:175], v[76:79], a[44:47]
buffer_load_dwordx4 v231, s[8:11], s38 offen offset:3072 lds
v_mfma_f32_16x16x32_bf16 a[12:15], a[172:175], v[72:75], a[12:15]
v_exp_f32 v48, v48
v_smfmac_f32_16x16x64_bf16 a[248:251], a[208:211], v[72:79], v235
ds_read_b64_tr_b16 a[172:173], v223 offset:8192
ds_read_b64_tr_b16 a[174:175], v223 offset:12288
v_mfma_f32_16x16x32_bf16 v[8:11], a[128:131], v[152:155], v[136:139]
v_exp_f32 v49, v49
v_mfma_f32_16x16x32_bf16 v[8:11], a[132:135], v[156:159], v[8:11]
v_cvt_pk_bf16_f32 v91, v46, v47
v_cvt_pk_bf16_f32 v92, v48, v49
v_mfma_f32_16x16x32_bf16 v[8:11], a[136:139], v[160:163], v[8:11]
v_exp_f32 v50, v50
v_mfma_f32_16x16x32_bf16 v[8:11], a[140:143], v[164:167], v[8:11]
ds_read_b64_tr_b16 a[194:195], v248 offset:256
ds_read_b64_tr_b16 a[196:197], v248 offset:32
v_mfma_f32_16x16x32_bf16 v[16:19], a[140:143], v[180:183], v[140:143]
v_exp_f32 v51, v51
v_mfma_f32_16x16x32_bf16 v[16:19], a[136:139], v[176:179], v[16:19]
ds_read_b64_tr_b16 a[198:199], v248 offset:288
v_cvt_pk_bf16_f32 v93, v50, v51
v_mfma_f32_16x16x32_bf16 v[16:19], a[132:135], v[172:175], v[16:19]
v_exp_f32 v52, v52
v_mfma_f32_16x16x32_bf16 v[16:19], a[128:131], v[168:171], v[16:19]
ds_read_b64_tr_b16 a[200:201], v248 offset:4096
ds_read_b64_tr_b16 a[202:203], v248 offset:4352
v_mfma_f32_16x16x32_bf16 v[24:27], a[128:131], v[184:187], v[144:147]
s_add_u32 s38, s38, 16384
v_exp_f32 v53, v53
v_mfma_f32_16x16x32_bf16 v[24:27], a[132:135], v[188:191], v[24:27]
s_add_u32 m0, s37, 114688
ds_read_b64_tr_b16 a[204:205], v248 offset:4128
v_cvt_pk_bf16_f32 v94, v52, v53
v_mfma_f32_16x16x32_bf16 v[24:27], a[136:139], v[192:195], v[24:27]
v_exp_f32 v54, v54
v_mfma_f32_16x16x32_bf16 v[24:27], a[140:143], v[196:199], v[24:27]
buffer_load_dwordx4 v232, s[12:15], s39 offen offset:0 lds
v_mfma_f32_16x16x32_bf16 v[32:35], a[140:143], v[212:215], v[148:151]
v_exp_f32 v55, v55
v_mfma_f32_16x16x32_bf16 v[32:35], a[136:139], v[208:211], v[32:35]
ds_read_b128 a[140:143], v219 offset:57344
ds_read_b128 a[136:139], v218 offset:57344
v_mfma_f32_16x16x32_bf16 v[32:35], a[132:135], v[204:207], v[32:35]
v_exp_f32 v56, v56
v_mfma_f32_16x16x32_bf16 v[32:35], a[128:131], v[200:203], v[32:35]
v_exp_f32 v57, v57
v_mfma_f32_16x16x32_bf16 a[16:19], a[176:179], v[72:75], a[16:19]
ds_read_b128 a[132:135], v217 offset:57344
ds_read_b128 a[128:131], v216 offset:57344
v_mfma_f32_16x16x32_bf16 a[48:51], a[176:179], v[76:79], a[48:51]
v_exp_f32 v58, v58
v_mfma_f32_16x16x32_bf16 a[80:83], a[176:179], v[80:83], a[80:83]
v_cvt_pk_bf16_f32 v95, v54, v55
v_cvt_pk_bf16_f32 v96, v56, v57
v_mfma_f32_16x16x32_bf16 a[112:115], a[176:179], v[84:87], a[112:115]
v_exp_f32 v59, v59
v_mfma_f32_16x16x32_bf16 a[116:119], a[180:183], v[84:87], a[116:119]
ds_read_b64_tr_b16 a[176:177], v224 offset:8192
ds_read_b64_tr_b16 a[178:179], v224 offset:12288
v_mfma_f32_16x16x32_bf16 a[84:87], a[180:183], v[80:83], a[84:87]
v_exp_f32 v60, v60
v_mfma_f32_16x16x32_bf16 a[52:55], a[180:183], v[76:79], a[52:55]
buffer_load_dwordx4 v233, s[12:15], s39 offen offset:1024 lds
v_mfma_f32_16x16x32_bf16 a[20:23], a[180:183], v[72:75], a[20:23]
v_exp_f32 v61, v61
v_mfma_f32_16x16x32_bf16 a[24:27], a[184:187], v[72:75], a[24:27]
ds_read_b64_tr_b16 a[180:181], v225 offset:8192
ds_read_b64_tr_b16 a[182:183], v225 offset:12288
v_mfma_f32_16x16x32_bf16 a[56:59], a[184:187], v[76:79], a[56:59]
v_exp_f32 v62, v62
v_mfma_f32_16x16x32_bf16 a[88:91], a[184:187], v[80:83], a[88:91]
v_cvt_pk_bf16_f32 v97, v58, v59
v_cvt_pk_bf16_f32 v98, v60, v61
v_mfma_f32_16x16x32_bf16 a[120:123], a[184:187], v[84:87], a[120:123]
v_exp_f32 v63, v63
v_mfma_f32_16x16x32_bf16 a[124:127], a[188:191], v[84:87], a[124:127]
ds_read_b64_tr_b16 a[184:185], v226 offset:8192
ds_read_b64_tr_b16 a[186:187], v226 offset:12288
v_mfma_f32_16x16x32_bf16 a[92:95], a[188:191], v[80:83], a[92:95]
v_exp_f32 v64, v64
v_mfma_f32_16x16x32_bf16 a[60:63], a[188:191], v[76:79], a[60:63]
ds_read_b64_tr_b16 a[206:207], v248 offset:4384
v_cvt_pk_bf16_f32 v99, v62, v63
v_mfma_f32_16x16x32_bf16 a[28:31], a[188:191], v[72:75], a[28:31]
v_exp_f32 v65, v65
v_smfmac_f32_16x16x64_bf16 a[252:255], a[208:211], v[80:87], v235
s_waitcnt lgkmcnt(5)
ds_read_b64_tr_b16 a[188:189], v227 offset:8192
ds_read_b64_tr_b16 a[190:191], v227 offset:12288
v_mfma_f32_16x16x32_bf16 v[12:15], a[144:147], v[152:155], v[136:139]
v_exp_f32 v66, v66
v_mfma_f32_16x16x32_bf16 v[12:15], a[148:151], v[156:159], v[12:15]
buffer_load_dwordx4 v232, s[12:15], s39 offen offset:2048 lds
v_mfma_f32_16x16x32_bf16 v[12:15], a[152:155], v[160:163], v[12:15]
v_exp_f32 v67, v67
v_mfma_f32_16x16x32_bf16 v[12:15], a[156:159], v[164:167], v[12:15]
v_cvt_pk_bf16_f32 v100, v64, v65
v_cvt_pk_bf16_f32 v101, v66, v67
v_mfma_f32_16x16x32_bf16 v[20:23], a[156:159], v[180:183], v[140:143]
v_exp_f32 v68, v68
v_mfma_f32_16x16x32_bf16 v[20:23], a[152:155], v[176:179], v[20:23]
ds_read_b64_tr_b16 v[120:121], v248 offset:2048
ds_read_b64_tr_b16 v[122:123], v248 offset:2304
v_mfma_f32_16x16x32_bf16 v[20:23], a[148:151], v[172:175], v[20:23]
v_exp_f32 v69, v69
v_mfma_f32_16x16x32_bf16 v[20:23], a[144:147], v[168:171], v[20:23]
ds_read_b64_tr_b16 v[124:125], v248 offset:2080
v_cvt_pk_bf16_f32 v102, v68, v69
v_mfma_f32_16x16x32_bf16 v[28:31], a[144:147], v[184:187], v[144:147]
v_exp_f32 v70, v70
v_mfma_f32_16x16x32_bf16 v[28:31], a[148:151], v[188:191], v[28:31]
ds_read_b64_tr_b16 v[126:127], v248 offset:2336
ds_read_b64_tr_b16 v[128:129], v248 offset:6144
v_mfma_f32_16x16x32_bf16 v[28:31], a[152:155], v[192:195], v[28:31]
v_exp_f32 v71, v71
v_mfma_f32_16x16x32_bf16 v[28:31], a[156:159], v[196:199], v[28:31]
ds_read_b64_tr_b16 v[130:131], v248 offset:6400
v_cvt_pk_bf16_f32 v103, v70, v71
v_mfma_f32_16x16x32_bf16 v[36:39], a[156:159], v[212:215], v[148:151]
ds_read_b128 a[156:159], v219 offset:61440
ds_read_b64_tr_b16 v[132:133], v248 offset:6176
v_mfma_f32_16x16x32_bf16 v[36:39], a[152:155], v[208:211], v[36:39]
ds_read_b128 a[152:155], v218 offset:61440
ds_read_b64_tr_b16 v[134:135], v248 offset:6432
v_mfma_f32_16x16x32_bf16 v[36:39], a[148:151], v[204:207], v[36:39]
ds_read_b128 a[148:151], v217 offset:61440
v_mfma_f32_16x16x32_bf16 v[36:39], a[144:147], v[200:203], v[36:39]
ds_read_b128 a[144:147], v216 offset:61440
v_mfma_f32_16x16x32_bf16 a[0:3], a[160:163], v[88:91], a[0:3]
v_exp_f32 v8, v8
v_mfma_f32_16x16x32_bf16 a[32:35], a[160:163], v[92:95], a[32:35]
buffer_load_dwordx4 v233, s[12:15], s39 offen offset:3072 lds
v_mfma_f32_16x16x32_bf16 a[64:67], a[160:163], v[96:99], a[64:67]
v_exp_f32 v9, v9
v_mfma_f32_16x16x32_bf16 a[96:99], a[160:163], v[100:103], a[96:99]
ds_read_b64_tr_b16 a[160:161], v220 offset:16384
ds_read_b64_tr_b16 a[162:163], v220 offset:20480
v_mfma_f32_16x16x32_bf16 a[100:103], a[164:167], v[100:103], a[100:103]
v_exp_f32 v10, v10
v_mfma_f32_16x16x32_bf16 a[68:71], a[164:167], v[96:99], a[68:71]
v_cvt_pk_bf16_f32 v72, v8, v9
v_mfma_f32_16x16x32_bf16 a[36:39], a[164:167], v[92:95], a[36:39]
v_exp_f32 v11, v11
v_mfma_f32_16x16x32_bf16 a[4:7], a[164:167], v[88:91], a[4:7]
ds_read_b64_tr_b16 a[164:165], v221 offset:16384
ds_read_b64_tr_b16 a[166:167], v221 offset:20480
v_mfma_f32_16x16x32_bf16 v[104:107], a[192:195], a[212:215], v[104:107]
s_add_u32 m0, s49, 0
v_exp_f32 v12, v12
v_mfma_f32_16x16x32_bf16 a[8:11], a[168:171], v[88:91], a[8:11]
s_add_u32 s48, s50, 589824
s_waitcnt lgkmcnt(6)
buffer_load_dwordx4 v238, s[56:59], s48 offen  lds
v_mfma_f32_16x16x32_bf16 a[40:43], a[168:171], v[92:95], a[40:43]
v_exp_f32 v13, v13
v_mfma_f32_16x16x32_bf16 a[72:75], a[168:171], v[96:99], a[72:75]
v_cvt_pk_bf16_f32 v73, v10, v11
v_cvt_pk_bf16_f32 v74, v12, v13
v_mfma_f32_16x16x32_bf16 a[104:107], a[168:171], v[100:103], a[104:107]
ds_read_b64_tr_b16 a[168:169], v222 offset:16384
ds_read_b64_tr_b16 a[170:171], v222 offset:20480
v_mfma_f32_16x16x32_bf16 a[108:111], a[172:175], v[100:103], a[108:111]
v_exp_f32 v14, v14
v_mfma_f32_16x16x32_bf16 a[76:79], a[172:175], v[96:99], a[76:79]
v_mfma_f32_16x16x32_bf16 a[44:47], a[172:175], v[92:95], a[44:47]
v_exp_f32 v15, v15
v_mfma_f32_16x16x32_bf16 a[12:15], a[172:175], v[88:91], a[12:15]
s_add_u32 s39, s39, 16384
ds_read_b64_tr_b16 a[172:173], v223 offset:16384
ds_read_b64_tr_b16 a[174:175], v223 offset:20480
v_smfmac_f32_16x16x64_bf16 a[248:251], a[208:211], v[88:95], v235
s_add_u32 m0, s37, 0
v_exp_f32 v16, v16
v_mfma_f32_16x16x32_bf16 v[108:111], a[196:199], a[212:215], v[108:111]
buffer_load_dwordx4 v228, s[8:11], s38 offen offset:0 lds
v_mfma_f32_16x16x32_bf16 v[40:43], a[128:131], v[152:155], v[136:139]
v_exp_f32 v17, v17
v_mfma_f32_16x16x32_bf16 v[40:43], a[132:135], v[156:159], v[40:43]
v_cvt_pk_bf16_f32 v75, v14, v15
v_cvt_pk_bf16_f32 v76, v16, v17
v_mfma_f32_16x16x32_bf16 v[40:43], a[136:139], v[160:163], v[40:43]
v_exp_f32 v18, v18
v_mfma_f32_16x16x32_bf16 v[40:43], a[140:143], v[164:167], v[40:43]
v_mfma_f32_16x16x32_bf16 v[48:51], a[140:143], v[180:183], v[140:143]
v_mfma_f32_16x16x32_bf16 v[48:51], a[136:139], v[176:179], v[48:51]
s_add_u32 m0, s49, 1024
v_exp_f32 v19, v19
v_mfma_f32_16x16x32_bf16 v[48:51], a[132:135], v[172:175], v[48:51]
s_add_u32 s48, s50, 737280
buffer_load_dwordx4 v238, s[56:59], s48 offen  lds
v_mfma_f32_16x16x32_bf16 v[48:51], a[128:131], v[168:171], v[48:51]
v_exp_f32 v20, v20
v_mfma_f32_16x16x32_bf16 v[112:115], a[200:203], a[212:215], v[112:115]
v_cvt_pk_bf16_f32 v77, v18, v19
v_mfma_f32_16x16x32_bf16 v[56:59], a[128:131], v[184:187], v[144:147]
v_exp_f32 v21, v21
v_mfma_f32_16x16x32_bf16 v[56:59], a[132:135], v[188:191], v[56:59]
v_cvt_pk_bf16_f32 v78, v20, v21
v_mfma_f32_16x16x32_bf16 v[56:59], a[136:139], v[192:195], v[56:59]
v_exp_f32 v22, v22
v_mfma_f32_16x16x32_bf16 v[56:59], a[140:143], v[196:199], v[56:59]
v_mfma_f32_16x16x32_bf16 v[64:67], a[140:143], v[212:215], v[148:151]
s_add_u32 m0, s37, 0
v_exp_f32 v23, v23
v_mfma_f32_16x16x32_bf16 v[64:67], a[136:139], v[208:211], v[64:67]
buffer_load_dwordx4 v229, s[8:11], s38 offen offset:1024 lds
v_mfma_f32_16x16x32_bf16 v[64:67], a[132:135], v[204:207], v[64:67]
ds_read_b128 a[140:143], v219 offset:32768
ds_read_b128 a[136:139], v218 offset:32768
v_mfma_f32_16x16x32_bf16 v[64:67], a[128:131], v[200:203], v[64:67]
v_exp_f32 v24, v24
v_mfma_f32_16x16x32_bf16 v[116:119], a[204:207], a[212:215], v[116:119]
ds_read_b128 a[132:135], v217 offset:32768
ds_read_b128 a[128:131], v216 offset:32768
v_mfma_f32_16x16x32_bf16 a[16:19], a[176:179], v[88:91], a[16:19]
v_exp_f32 v25, v25
v_mfma_f32_16x16x32_bf16 a[48:51], a[176:179], v[92:95], a[48:51]
v_cvt_pk_bf16_f32 v79, v22, v23
v_cvt_pk_bf16_f32 v80, v24, v25
v_mfma_f32_16x16x32_bf16 a[80:83], a[176:179], v[96:99], a[80:83]
s_add_u32 m0, s49, 2048
v_exp_f32 v26, v26
v_mfma_f32_16x16x32_bf16 a[112:115], a[176:179], v[100:103], a[112:115]
s_add_u32 s48, s50, 884736
buffer_load_dwordx4 v238, s[56:59], s48 offen  lds
v_mfma_f32_16x16x32_bf16 a[116:119], a[180:183], v[100:103], a[116:119]
v_exp_f32 v27, v27
v_mfma_f32_16x16x32_bf16 a[84:87], a[180:183], v[96:99], a[84:87]
ds_read_b64_tr_b16 a[176:177], v224 offset:16384
ds_read_b64_tr_b16 a[178:179], v224 offset:20480
v_mfma_f32_16x16x32_bf16 a[52:55], a[180:183], v[92:95], a[52:55]
v_exp_f32 v28, v28
v_mfma_f32_16x16x32_bf16 a[20:23], a[180:183], v[88:91], a[20:23]
ds_read_b64_tr_b16 a[180:181], v225 offset:16384
ds_read_b64_tr_b16 a[182:183], v225 offset:20480
v_mfma_f32_16x16x32_bf16 v[104:107], v[120:123], a[216:219], v[104:107]
v_exp_f32 v29, v29
v_mfma_f32_16x16x32_bf16 a[24:27], a[184:187], v[88:91], a[24:27]
v_cvt_pk_bf16_f32 v81, v26, v27
v_cvt_pk_bf16_f32 v82, v28, v29
v_mfma_f32_16x16x32_bf16 a[56:59], a[184:187], v[92:95], a[56:59]
s_add_u32 m0, s37, 0
v_mfma_f32_16x16x32_bf16 a[88:91], a[184:187], v[96:99], a[88:91]
v_exp_f32 v30, v30
v_mfma_f32_16x16x32_bf16 a[120:123], a[184:187], v[100:103], a[120:123]
buffer_load_dwordx4 v230, s[8:11], s38 offen offset:2048 lds
v_mfma_f32_16x16x32_bf16 a[124:127], a[188:191], v[100:103], a[124:127]
v_exp_f32 v31, v31
v_mfma_f32_16x16x32_bf16 a[92:95], a[188:191], v[96:99], a[92:95]
ds_read_b64_tr_b16 a[184:185], v226 offset:16384
ds_read_b64_tr_b16 a[186:187], v226 offset:20480
v_mfma_f32_16x16x32_bf16 a[60:63], a[188:191], v[92:95], a[60:63]
v_exp_f32 v32, v32
v_mfma_f32_16x16x32_bf16 a[28:31], a[188:191], v[88:91], a[28:31]
ds_read_b64_tr_b16 a[188:189], v227 offset:16384
ds_read_b64_tr_b16 a[190:191], v227 offset:20480
v_smfmac_f32_16x16x64_bf16 a[252:255], a[208:211], v[96:103], v235
s_waitcnt lgkmcnt(4)
v_exp_f32 v33, v33
v_mfma_f32_16x16x32_bf16 v[108:111], v[124:127], a[216:219], v[108:111]
s_add_u32 m0, s49, 3072
v_cvt_pk_bf16_f32 v83, v30, v31
v_cvt_pk_bf16_f32 v84, v32, v33
v_mfma_f32_16x16x32_bf16 v[44:47], a[144:147], v[152:155], v[136:139]
s_add_u32 s48, s50, 1032192
v_exp_f32 v34, v34
v_mfma_f32_16x16x32_bf16 v[44:47], a[148:151], v[156:159], v[44:47]
buffer_load_dwordx4 v238, s[56:59], s48 offen  lds
v_mfma_f32_16x16x32_bf16 v[44:47], a[152:155], v[160:163], v[44:47]
v_mfma_f32_16x16x32_bf16 v[44:47], a[156:159], v[164:167], v[44:47]
v_exp_f32 v35, v35
v_mfma_f32_16x16x32_bf16 v[52:55], a[156:159], v[180:183], v[140:143]
v_cvt_pk_bf16_f32 v85, v34, v35
v_mfma_f32_16x16x32_bf16 v[52:55], a[152:155], v[176:179], v[52:55]
v_exp_f32 v36, v36
v_mfma_f32_16x16x32_bf16 v[52:55], a[148:151], v[172:175], v[52:55]
v_mfma_f32_16x16x32_bf16 v[52:55], a[144:147], v[168:171], v[52:55]
s_add_u32 m0, s37, 0
v_exp_f32 v37, v37
v_mfma_f32_16x16x32_bf16 v[112:115], v[128:131], a[216:219], v[112:115]
buffer_load_dwordx4 v231, s[8:11], s38 offen offset:3072 lds
v_mfma_f32_16x16x32_bf16 v[60:63], a[144:147], v[184:187], v[144:147]
v_exp_f32 v38, v38
v_mfma_f32_16x16x32_bf16 v[60:63], a[148:151], v[188:191], v[60:63]
v_cvt_pk_bf16_f32 v86, v36, v37
v_mfma_f32_16x16x32_bf16 v[60:63], a[152:155], v[192:195], v[60:63]
v_exp_f32 v39, v39
v_mfma_f32_16x16x32_bf16 v[60:63], a[156:159], v[196:199], v[60:63]
v_cvt_pk_bf16_f32 v87, v38, v39
v_mfma_f32_16x16x32_bf16 v[68:71], a[156:159], v[212:215], v[148:151]
ds_read_b128 a[156:159], v219 offset:36864
v_mfma_f32_16x16x32_bf16 v[68:71], a[152:155], v[208:211], v[68:71]
ds_read_b128 a[152:155], v218 offset:36864
v_mfma_f32_16x16x32_bf16 v[68:71], a[148:151], v[204:207], v[68:71]
s_add_u32 s38, s38, 16384
ds_read_b128 a[148:151], v217 offset:36864
v_mfma_f32_16x16x32_bf16 v[68:71], a[144:147], v[200:203], v[68:71]
ds_read_b128 a[144:147], v216 offset:36864
v_mfma_f32_16x16x32_bf16 v[116:119], v[132:135], a[216:219], v[116:119]
v_mfma_f32_16x16x32_bf16 a[0:3], a[160:163], v[72:75], a[0:3]
v_exp_f32 v40, v40
v_mfma_f32_16x16x32_bf16 a[32:35], a[160:163], v[76:79], a[32:35]
s_add_u32 m0, s49, 4096
v_exp_f32 v41, v41
v_mfma_f32_16x16x32_bf16 a[64:67], a[160:163], v[80:83], a[64:67]
s_add_u32 s48, s50, 589824
buffer_load_dwordx4 v238, s[60:63], s48 offen  lds
v_mfma_f32_16x16x32_bf16 a[96:99], a[160:163], v[84:87], a[96:99]
v_exp_f32 v42, v42
v_mfma_f32_16x16x32_bf16 a[100:103], a[164:167], v[84:87], a[100:103]
ds_read_b64_tr_b16 a[160:161], v220 offset:24576
ds_read_b64_tr_b16 a[162:163], v220 offset:28672
v_mfma_f32_16x16x32_bf16 a[68:71], a[164:167], v[80:83], a[68:71]
v_exp_f32 v43, v43
v_mfma_f32_16x16x32_bf16 a[36:39], a[164:167], v[76:79], a[36:39]
v_cvt_pk_bf16_f32 v88, v40, v41
v_cvt_pk_bf16_f32 v89, v42, v43
v_mfma_f32_16x16x32_bf16 a[4:7], a[164:167], v[72:75], a[4:7]
v_exp_f32 v44, v44
v_mfma_f32_16x16x32_bf16 a[8:11], a[168:171], v[72:75], a[8:11]
s_add_u32 m0, s49, 5120
ds_read_b64_tr_b16 a[164:165], v221 offset:24576
ds_read_b64_tr_b16 a[166:167], v221 offset:28672
v_mfma_f32_16x16x32_bf16 a[40:43], a[168:171], v[76:79], a[40:43]
s_add_u32 s48, s50, 737280
v_exp_f32 v45, v45
v_mfma_f32_16x16x32_bf16 a[72:75], a[168:171], v[80:83], a[72:75]
buffer_load_dwordx4 v238, s[60:63], s48 offen  lds
v_mfma_f32_16x16x32_bf16 a[104:107], a[168:171], v[84:87], a[104:107]
v_exp_f32 v46, v46
v_mfma_f32_16x16x32_bf16 a[108:111], a[172:175], v[84:87], a[108:111]
ds_read_b64_tr_b16 a[168:169], v222 offset:24576
ds_read_b64_tr_b16 a[170:171], v222 offset:28672
v_mfma_f32_16x16x32_bf16 a[76:79], a[172:175], v[80:83], a[76:79]
v_exp_f32 v47, v47
v_mfma_f32_16x16x32_bf16 a[44:47], a[172:175], v[76:79], a[44:47]
v_cvt_pk_bf16_f32 v90, v44, v45
v_cvt_pk_bf16_f32 v91, v46, v47
v_mfma_f32_16x16x32_bf16 a[12:15], a[172:175], v[72:75], a[12:15]
v_exp_f32 v48, v48
v_smfmac_f32_16x16x64_bf16 a[248:251], a[208:211], v[72:79], v235
s_add_u32 m0, s49, 6144
ds_read_b64_tr_b16 a[172:173], v223 offset:24576
ds_read_b64_tr_b16 a[174:175], v223 offset:28672
v_mfma_f32_16x16x32_bf16 v[8:11], a[128:131], v[152:155], v[136:139]
s_add_u32 s48, s50, 884736
v_exp_f32 v49, v49
v_mfma_f32_16x16x32_bf16 v[8:11], a[132:135], v[156:159], v[8:11]
buffer_load_dwordx4 v238, s[60:63], s48 offen  lds
v_mfma_f32_16x16x32_bf16 v[8:11], a[136:139], v[160:163], v[8:11]
v_exp_f32 v50, v50
v_mfma_f32_16x16x32_bf16 v[8:11], a[140:143], v[164:167], v[8:11]
v_cvt_pk_bf16_f32 v92, v48, v49
v_mfma_f32_16x16x32_bf16 v[16:19], a[140:143], v[180:183], v[140:143]
v_exp_f32 v51, v51
v_mfma_f32_16x16x32_bf16 v[16:19], a[136:139], v[176:179], v[16:19]
v_cvt_pk_bf16_f32 v93, v50, v51
v_mfma_f32_16x16x32_bf16 v[16:19], a[132:135], v[172:175], v[16:19]
v_exp_f32 v52, v52
v_mfma_f32_16x16x32_bf16 v[16:19], a[128:131], v[168:171], v[16:19]
s_add_u32 m0, s49, 7168
v_mfma_f32_16x16x32_bf16 v[24:27], a[128:131], v[184:187], v[144:147]
s_add_u32 s48, s50, 1032192
v_exp_f32 v53, v53
v_mfma_f32_16x16x32_bf16 v[24:27], a[132:135], v[188:191], v[24:27]
buffer_load_dwordx4 v238, s[60:63], s48 offen  lds
v_mfma_f32_16x16x32_bf16 v[24:27], a[136:139], v[192:195], v[24:27]
v_exp_f32 v54, v54
v_mfma_f32_16x16x32_bf16 v[24:27], a[140:143], v[196:199], v[24:27]
v_cvt_pk_bf16_f32 v94, v52, v53
v_mfma_f32_16x16x32_bf16 v[32:35], a[140:143], v[212:215], v[148:151]
v_exp_f32 v55, v55
v_mfma_f32_16x16x32_bf16 v[32:35], a[136:139], v[208:211], v[32:35]
ds_read_b128 a[140:143], v219 offset:40960
ds_read_b128 a[136:139], v218 offset:40960
v_mfma_f32_16x16x32_bf16 v[32:35], a[132:135], v[204:207], v[32:35]
v_exp_f32 v56, v56
v_mfma_f32_16x16x32_bf16 v[32:35], a[128:131], v[200:203], v[32:35]
v_exp_f32 v57, v57
v_mfma_f32_16x16x32_bf16 a[16:19], a[176:179], v[72:75], a[16:19]
buffer_load_dwordx2 v[252:253], v251, s[76:79], s42 offen sc1
v_mfma_f32_16x16x32_bf16 a[48:51], a[176:179], v[76:79], a[48:51]
v_exp_f32 v58, v58
v_mfma_f32_16x16x32_bf16 a[80:83], a[176:179], v[80:83], a[80:83]
ds_read_b128 a[132:135], v217 offset:40960
ds_read_b128 a[128:131], v216 offset:40960
v_mfma_f32_16x16x32_bf16 a[112:115], a[176:179], v[84:87], a[112:115]
v_exp_f32 v59, v59
v_mfma_f32_16x16x32_bf16 a[116:119], a[180:183], v[84:87], a[116:119]
ds_read_b64_tr_b16 a[176:177], v224 offset:24576
ds_read_b64_tr_b16 a[178:179], v224 offset:28672
v_mfma_f32_16x16x32_bf16 a[84:87], a[180:183], v[80:83], a[84:87]
v_exp_f32 v60, v60
v_mfma_f32_16x16x32_bf16 a[52:55], a[180:183], v[76:79], a[52:55]
s_add_u32 s42, s42, s43
buffer_load_dword v255, v243, s[28:31], s45 offen
v_mfma_f32_16x16x32_bf16 a[20:23], a[180:183], v[72:75], a[20:23]
s_waitcnt lgkmcnt(4)
v_exp_f32 v61, v61
v_mfma_f32_16x16x32_bf16 a[24:27], a[184:187], v[72:75], a[24:27]
ds_read_b64_tr_b16 a[180:181], v225 offset:24576
ds_read_b64_tr_b16 a[182:183], v225 offset:28672
v_mfma_f32_16x16x32_bf16 a[56:59], a[184:187], v[76:79], a[56:59]
v_exp_f32 v62, v62
v_mfma_f32_16x16x32_bf16 a[88:91], a[184:187], v[80:83], a[88:91]
v_cvt_pk_bf16_f32 v95, v54, v55
v_cvt_pk_bf16_f32 v96, v56, v57
v_mfma_f32_16x16x32_bf16 a[120:123], a[184:187], v[84:87], a[120:123]
v_exp_f32 v63, v63
v_mfma_f32_16x16x32_bf16 a[124:127], a[188:191], v[84:87], a[124:127]
ds_read_b64_tr_b16 a[184:185], v226 offset:24576
ds_read_b64_tr_b16 a[186:187], v226 offset:28672
v_mfma_f32_16x16x32_bf16 a[92:95], a[188:191], v[80:83], a[92:95]
v_exp_f32 v64, v64
v_mfma_f32_16x16x32_bf16 a[60:63], a[188:191], v[76:79], a[60:63]
s_add_u32 s45, s45, 589824
global_load_dword v255, v242, s[72:73]
v_mfma_f32_16x16x32_bf16 a[28:31], a[188:191], v[72:75], a[28:31]
v_exp_f32 v65, v65
v_smfmac_f32_16x16x64_bf16 a[252:255], a[208:211], v[80:87], v235
ds_read_b64_tr_b16 a[188:189], v227 offset:24576
ds_read_b64_tr_b16 a[190:191], v227 offset:28672
v_mfma_f32_16x16x32_bf16 v[12:15], a[144:147], v[152:155], v[136:139]
v_exp_f32 v66, v66
v_mfma_f32_16x16x32_bf16 v[12:15], a[148:151], v[156:159], v[12:15]
v_cvt_pk_bf16_f32 v97, v58, v59
v_cvt_pk_bf16_f32 v98, v60, v61
v_mfma_f32_16x16x32_bf16 v[12:15], a[152:155], v[160:163], v[12:15]
v_exp_f32 v67, v67
v_mfma_f32_16x16x32_bf16 v[12:15], a[156:159], v[164:167], v[12:15]
v_cvt_pk_bf16_f32 v99, v62, v63
v_cvt_pk_bf16_f32 v100, v64, v65
v_mfma_f32_16x16x32_bf16 v[20:23], a[156:159], v[180:183], v[140:143]
v_exp_f32 v68, v68
v_mfma_f32_16x16x32_bf16 v[20:23], a[152:155], v[176:179], v[20:23]
buffer_load_dword v255, v0, s[24:27], s44 offen
v_mfma_f32_16x16x32_bf16 v[20:23], a[148:151], v[172:175], v[20:23]
v_exp_f32 v69, v69
v_mfma_f32_16x16x32_bf16 v[20:23], a[144:147], v[168:171], v[20:23]
v_cvt_pk_bf16_f32 v101, v66, v67
v_cvt_pk_bf16_f32 v102, v68, v69
v_mfma_f32_16x16x32_bf16 v[28:31], a[144:147], v[184:187], v[144:147]
v_exp_f32 v70, v70
v_mfma_f32_16x16x32_bf16 v[28:31], a[148:151], v[188:191], v[28:31]
v_mfma_f32_16x16x32_bf16 v[28:31], a[152:155], v[192:195], v[28:31]
v_exp_f32 v71, v71
v_mfma_f32_16x16x32_bf16 v[28:31], a[156:159], v[196:199], v[28:31]
v_cvt_pk_bf16_f32 v103, v70, v71
v_mfma_f32_16x16x32_bf16 v[36:39], a[156:159], v[212:215], v[148:151]
ds_read_b128 a[156:159], v219 offset:45056
v_mfma_f32_16x16x32_bf16 v[36:39], a[152:155], v[208:211], v[36:39]
s_add_u32 s44, s44, 4096
ds_read_b128 a[152:155], v218 offset:45056
v_mfma_f32_16x16x32_bf16 v[36:39], a[148:151], v[204:207], v[36:39]
ds_read_b128 a[148:151], v217 offset:45056
v_mfma_f32_16x16x32_bf16 v[36:39], a[144:147], v[200:203], v[36:39]
ds_read_b128 a[144:147], v216 offset:45056
v_mfma_f32_16x16x32_bf16 a[0:3], a[160:163], v[88:91], a[0:3]
v_exp_f32 v8, v8
v_mfma_f32_16x16x32_bf16 a[32:35], a[160:163], v[92:95], a[32:35]
v_exp_f32 v9, v9
v_mfma_f32_16x16x32_bf16 a[64:67], a[160:163], v[96:99], a[64:67]
v_cvt_pk_bf16_f32 v72, v8, v9
v_mfma_f32_16x16x32_bf16 a[96:99], a[160:163], v[100:103], a[96:99]
v_exp_f32 v10, v10
v_mfma_f32_16x16x32_bf16 a[100:103], a[164:167], v[100:103], a[100:103]
v_mfma_f32_16x16x32_bf16 a[68:71], a[164:167], v[96:99], a[68:71]
v_exp_f32 v11, v11
s_waitcnt vmcnt(8) lgkmcnt(0)
s_barrier
v_mfma_f32_16x16x32_bf16 a[36:39], a[164:167], v[92:95], a[36:39]
ds_read_b64_tr_b16 a[160:161], v220 offset:32768
ds_read_b64_tr_b16 a[162:163], v220 offset:36864
v_mfma_f32_16x16x32_bf16 a[4:7], a[164:167], v[88:91], a[4:7]
s_add_u32 m0, s37, 65536
v_exp_f32 v12, v12
v_mfma_f32_16x16x32_bf16 a[8:11], a[168:171], v[88:91], a[8:11]
buffer_load_dwordx4 v232, s[12:15], s39 offen offset:0 lds
v_mfma_f32_16x16x32_bf16 a[40:43], a[168:171], v[92:95], a[40:43]
v_exp_f32 v13, v13
v_mfma_f32_16x16x32_bf16 a[72:75], a[168:171], v[96:99], a[72:75]
ds_read_b64_tr_b16 a[164:165], v221 offset:32768
ds_read_b64_tr_b16 a[166:167], v221 offset:36864
v_mfma_f32_16x16x32_bf16 a[104:107], a[168:171], v[100:103], a[104:107]
v_exp_f32 v14, v14
v_mfma_f32_16x16x32_bf16 a[108:111], a[172:175], v[100:103], a[108:111]
ds_read_b64_tr_b16 a[168:169], v222 offset:32768
ds_read_b64_tr_b16 a[170:171], v222 offset:36864
v_mfma_f32_16x16x32_bf16 a[76:79], a[172:175], v[96:99], a[76:79]
v_exp_f32 v15, v15
v_mfma_f32_16x16x32_bf16 a[44:47], a[172:175], v[92:95], a[44:47]
v_cvt_pk_bf16_f32 v73, v10, v11
v_cvt_pk_bf16_f32 v74, v12, v13
v_mfma_f32_16x16x32_bf16 a[12:15], a[172:175], v[88:91], a[12:15]
v_exp_f32 v16, v16
v_smfmac_f32_16x16x64_bf16 a[248:251], a[208:211], v[88:95], v235
buffer_load_dwordx4 v233, s[12:15], s39 offen offset:1024 lds
v_mfma_f32_16x16x32_bf16 v[40:43], a[128:131], v[152:155], v[136:139]
v_exp_f32 v17, v17
v_mfma_f32_16x16x32_bf16 v[40:43], a[132:135], v[156:159], v[40:43]
ds_read_b64_tr_b16 a[172:173], v223 offset:32768
ds_read_b64_tr_b16 a[174:175], v223 offset:36864
v_mfma_f32_16x16x32_bf16 v[40:43], a[136:139], v[160:163], v[40:43]
v_exp_f32 v18, v18
v_mfma_f32_16x16x32_bf16 v[40:43], a[140:143], v[164:167], v[40:43]
v_cvt_pk_bf16_f32 v75, v14, v15
v_cvt_pk_bf16_f32 v76, v16, v17
v_mfma_f32_16x16x32_bf16 v[48:51], a[140:143], v[180:183], v[140:143]
v_exp_f32 v19, v19
v_mfma_f32_16x16x32_bf16 v[48:51], a[136:139], v[176:179], v[48:51]
v_cvt_pk_bf16_f32 v77, v18, v19
v_mfma_f32_16x16x32_bf16 v[48:51], a[132:135], v[172:175], v[48:51]
v_exp_f32 v20, v20
v_mfma_f32_16x16x32_bf16 v[48:51], a[128:131], v[168:171], v[48:51]
v_mfma_f32_16x16x32_bf16 v[56:59], a[128:131], v[184:187], v[144:147]
v_exp_f32 v21, v21
v_mfma_f32_16x16x32_bf16 v[56:59], a[132:135], v[188:191], v[56:59]
buffer_load_dwordx4 v232, s[12:15], s39 offen offset:2048 lds
v_mfma_f32_16x16x32_bf16 v[56:59], a[136:139], v[192:195], v[56:59]
v_exp_f32 v22, v22
v_mfma_f32_16x16x32_bf16 v[56:59], a[140:143], v[196:199], v[56:59]
v_cvt_pk_bf16_f32 v78, v20, v21
v_mfma_f32_16x16x32_bf16 v[64:67], a[140:143], v[212:215], v[148:151]
v_exp_f32 v23, v23
v_mfma_f32_16x16x32_bf16 v[64:67], a[136:139], v[208:211], v[64:67]
ds_read_b128 a[140:143], v219 offset:16384
ds_read_b128 a[136:139], v218 offset:16384
v_mfma_f32_16x16x32_bf16 v[64:67], a[132:135], v[204:207], v[64:67]
v_exp_f32 v24, v24
v_mfma_f32_16x16x32_bf16 v[64:67], a[128:131], v[200:203], v[64:67]
v_exp_f32 v25, v25
v_mfma_f32_16x16x32_bf16 a[16:19], a[176:179], v[88:91], a[16:19]
ds_read_b128 a[132:135], v217 offset:16384
ds_read_b128 a[128:131], v216 offset:16384
v_mfma_f32_16x16x32_bf16 a[48:51], a[176:179], v[92:95], a[48:51]
v_exp_f32 v26, v26
v_mfma_f32_16x16x32_bf16 a[80:83], a[176:179], v[96:99], a[80:83]
buffer_load_dwordx4 v233, s[12:15], s39 offen offset:3072 lds
v_mfma_f32_16x16x32_bf16 a[112:115], a[176:179], v[100:103], a[112:115]
v_exp_f32 v27, v27
v_mfma_f32_16x16x32_bf16 a[116:119], a[180:183], v[100:103], a[116:119]
ds_read_b64_tr_b16 a[176:177], v224 offset:32768
ds_read_b64_tr_b16 a[178:179], v224 offset:36864
v_mfma_f32_16x16x32_bf16 a[84:87], a[180:183], v[96:99], a[84:87]
v_exp_f32 v28, v28
v_mfma_f32_16x16x32_bf16 a[52:55], a[180:183], v[92:95], a[52:55]
v_cvt_pk_bf16_f32 v79, v22, v23
v_cvt_pk_bf16_f32 v80, v24, v25
v_mfma_f32_16x16x32_bf16 a[20:23], a[180:183], v[88:91], a[20:23]
v_exp_f32 v29, v29
v_mfma_f32_16x16x32_bf16 a[24:27], a[184:187], v[88:91], a[24:27]
ds_read_b64_tr_b16 a[180:181], v225 offset:32768
ds_read_b64_tr_b16 a[182:183], v225 offset:36864
v_mfma_f32_16x16x32_bf16 a[56:59], a[184:187], v[92:95], a[56:59]
v_exp_f32 v30, v30
v_mfma_f32_16x16x32_bf16 a[88:91], a[184:187], v[96:99], a[88:91]
v_cvt_pk_bf16_f32 v81, v26, v27
v_cvt_pk_bf16_f32 v82, v28, v29
v_mfma_f32_16x16x32_bf16 a[120:123], a[184:187], v[100:103], a[120:123]
s_add_u32 s39, s39, 16384
v_exp_f32 v31, v31
v_mfma_f32_16x16x32_bf16 a[124:127], a[188:191], v[100:103], a[124:127]
s_add_u32 m0, s37, 49152
ds_read_b64_tr_b16 a[184:185], v226 offset:32768
ds_read_b64_tr_b16 a[186:187], v226 offset:36864
v_mfma_f32_16x16x32_bf16 a[92:95], a[188:191], v[96:99], a[92:95]
v_exp_f32 v32, v32
v_mfma_f32_16x16x32_bf16 a[60:63], a[188:191], v[92:95], a[60:63]
buffer_load_dwordx4 v228, s[8:11], s38 offen offset:0 lds
v_mfma_f32_16x16x32_bf16 a[28:31], a[188:191], v[88:91], a[28:31]
v_exp_f32 v33, v33
v_smfmac_f32_16x16x64_bf16 a[252:255], a[208:211], v[96:103], v235
ds_read_b64_tr_b16 a[188:189], v227 offset:32768
ds_read_b64_tr_b16 a[190:191], v227 offset:36864
v_mfma_f32_16x16x32_bf16 v[44:47], a[144:147], v[152:155], v[136:139]
v_exp_f32 v34, v34
v_mfma_f32_16x16x32_bf16 v[44:47], a[148:151], v[156:159], v[44:47]
v_cvt_pk_bf16_f32 v83, v30, v31
v_cvt_pk_bf16_f32 v84, v32, v33
v_mfma_f32_16x16x32_bf16 v[44:47], a[152:155], v[160:163], v[44:47]
v_exp_f32 v35, v35
v_mfma_f32_16x16x32_bf16 v[44:47], a[156:159], v[164:167], v[44:47]
buffer_load_dwordx4 v229, s[8:11], s38 offen offset:1024 lds
v_mfma_f32_16x16x32_bf16 v[52:55], a[156:159], v[180:183], v[140:143]
v_exp_f32 v36, v36
v_mfma_f32_16x16x32_bf16 v[52:55], a[152:155], v[176:179], v[52:55]
v_cvt_pk_bf16_f32 v85, v34, v35
v_mfma_f32_16x16x32_bf16 v[52:55], a[148:151], v[172:175], v[52:55]
v_exp_f32 v37, v37
v_mfma_f32_16x16x32_bf16 v[52:55], a[144:147], v[168:171], v[52:55]
v_cvt_pk_bf16_f32 v86, v36, v37
v_mfma_f32_16x16x32_bf16 v[60:63], a[144:147], v[184:187], v[144:147]
v_exp_f32 v38, v38
v_mfma_f32_16x16x32_bf16 v[60:63], a[148:151], v[188:191], v[60:63]
v_mfma_f32_16x16x32_bf16 v[60:63], a[152:155], v[192:195], v[60:63]
v_exp_f32 v39, v39
v_mfma_f32_16x16x32_bf16 v[60:63], a[156:159], v[196:199], v[60:63]
v_cvt_pk_bf16_f32 v87, v38, v39
v_mfma_f32_16x16x32_bf16 v[68:71], a[156:159], v[212:215], v[148:151]
ds_read_b128 a[156:159], v219 offset:20480
v_mfma_f32_16x16x32_bf16 v[68:71], a[152:155], v[208:211], v[68:71]
ds_read_b128 a[152:155], v218 offset:20480
v_mfma_f32_16x16x32_bf16 v[68:71], a[148:151], v[204:207], v[68:71]
ds_read_b128 a[148:151], v217 offset:20480
v_mfma_f32_16x16x32_bf16 v[68:71], a[144:147], v[200:203], v[68:71]
s_waitcnt lgkmcnt(3)
ds_read_b128 a[144:147], v216 offset:20480
v_mfma_f32_16x16x32_bf16 a[0:3], a[160:163], v[72:75], a[0:3]
v_exp_f32 v40, v40
v_mfma_f32_16x16x32_bf16 a[32:35], a[160:163], v[76:79], a[32:35]
v_exp_f32 v41, v41
v_mfma_f32_16x16x32_bf16 a[64:67], a[160:163], v[80:83], a[64:67]
buffer_load_dwordx4 v230, s[8:11], s38 offen offset:2048 lds
v_mfma_f32_16x16x32_bf16 a[96:99], a[160:163], v[84:87], a[96:99]
v_exp_f32 v42, v42
v_mfma_f32_16x16x32_bf16 a[100:103], a[164:167], v[84:87], a[100:103]
ds_read_b64_tr_b16 a[160:161], v220 offset:40960
ds_read_b64_tr_b16 a[162:163], v220 offset:45056
v_mfma_f32_16x16x32_bf16 a[68:71], a[164:167], v[80:83], a[68:71]
v_exp_f32 v43, v43
v_mfma_f32_16x16x32_bf16 a[36:39], a[164:167], v[76:79], a[36:39]
v_cvt_pk_bf16_f32 v88, v40, v41
v_cvt_pk_bf16_f32 v89, v42, v43
v_mfma_f32_16x16x32_bf16 a[4:7], a[164:167], v[72:75], a[4:7]
v_exp_f32 v44, v44
v_mfma_f32_16x16x32_bf16 a[8:11], a[168:171], v[72:75], a[8:11]
ds_read_b64_tr_b16 a[164:165], v221 offset:40960
ds_read_b64_tr_b16 a[166:167], v221 offset:45056
v_mfma_f32_16x16x32_bf16 a[40:43], a[168:171], v[76:79], a[40:43]
v_exp_f32 v45, v45
v_mfma_f32_16x16x32_bf16 a[72:75], a[168:171], v[80:83], a[72:75]
v_cvt_pk_bf16_f32 v90, v44, v45
v_mfma_f32_16x16x32_bf16 a[104:107], a[168:171], v[84:87], a[104:107]
v_exp_f32 v46, v46
v_mfma_f32_16x16x32_bf16 a[108:111], a[172:175], v[84:87], a[108:111]
ds_read_b64_tr_b16 a[168:169], v222 offset:40960
ds_read_b64_tr_b16 a[170:171], v222 offset:45056
v_mfma_f32_16x16x32_bf16 a[76:79], a[172:175], v[80:83], a[76:79]
v_exp_f32 v47, v47
v_mfma_f32_16x16x32_bf16 a[44:47], a[172:175], v[76:79], a[44:47]
buffer_load_dwordx4 v231, s[8:11], s38 offen offset:3072 lds
v_mfma_f32_16x16x32_bf16 a[12:15], a[172:175], v[72:75], a[12:15]
v_exp_f32 v48, v48
v_smfmac_f32_16x16x64_bf16 a[248:251], a[208:211], v[72:79], v235
ds_read_b64_tr_b16 a[172:173], v223 offset:40960
ds_read_b64_tr_b16 a[174:175], v223 offset:45056
v_mfma_f32_16x16x32_bf16 v[8:11], a[128:131], v[152:155], v[136:139]
v_exp_f32 v49, v49
v_mfma_f32_16x16x32_bf16 v[8:11], a[132:135], v[156:159], v[8:11]
v_cvt_pk_bf16_f32 v91, v46, v47
v_cvt_pk_bf16_f32 v92, v48, v49
v_mfma_f32_16x16x32_bf16 v[8:11], a[136:139], v[160:163], v[8:11]
v_exp_f32 v50, v50
v_mfma_f32_16x16x32_bf16 v[8:11], a[140:143], v[164:167], v[8:11]
s_waitcnt vmcnt(12)
s_nop 0
ds_read_b64_tr_b16 a[192:193], v248 offset:0
ds_read_b64_tr_b16 a[194:195], v248 offset:256
v_mfma_f32_16x16x32_bf16 v[16:19], a[140:143], v[180:183], v[140:143]
v_exp_f32 v51, v51
v_mfma_f32_16x16x32_bf16 v[16:19], a[136:139], v[176:179], v[16:19]
ds_read_b64_tr_b16 a[196:197], v248 offset:32
v_cvt_pk_bf16_f32 v93, v50, v51
v_mfma_f32_16x16x32_bf16 v[16:19], a[132:135], v[172:175], v[16:19]
v_exp_f32 v52, v52
v_mfma_f32_16x16x32_bf16 v[16:19], a[128:131], v[168:171], v[16:19]
ds_read_b64_tr_b16 a[198:199], v248 offset:288
ds_read_b64_tr_b16 a[200:201], v248 offset:4096
v_mfma_f32_16x16x32_bf16 v[24:27], a[128:131], v[184:187], v[144:147]
s_add_u32 s38, s38, 16384
v_exp_f32 v53, v53
v_mfma_f32_16x16x32_bf16 v[24:27], a[132:135], v[188:191], v[24:27]
s_add_u32 m0, s37, 81920
ds_read_b64_tr_b16 a[202:203], v248 offset:4352
v_cvt_pk_bf16_f32 v94, v52, v53
v_mfma_f32_16x16x32_bf16 v[24:27], a[136:139], v[192:195], v[24:27]
v_exp_f32 v54, v54
v_mfma_f32_16x16x32_bf16 v[24:27], a[140:143], v[196:199], v[24:27]
buffer_load_dwordx4 v232, s[12:15], s39 offen offset:0 lds
v_mfma_f32_16x16x32_bf16 v[32:35], a[140:143], v[212:215], v[148:151]
v_exp_f32 v55, v55
v_mfma_f32_16x16x32_bf16 v[32:35], a[136:139], v[208:211], v[32:35]
ds_read_b128 a[140:143], v219 offset:24576
ds_read_b128 a[136:139], v218 offset:24576
v_mfma_f32_16x16x32_bf16 v[32:35], a[132:135], v[204:207], v[32:35]
v_exp_f32 v56, v56
v_mfma_f32_16x16x32_bf16 v[32:35], a[128:131], v[200:203], v[32:35]
v_exp_f32 v57, v57
v_mfma_f32_16x16x32_bf16 a[16:19], a[176:179], v[72:75], a[16:19]
ds_read_b128 a[132:135], v217 offset:24576
ds_read_b128 a[128:131], v216 offset:24576
v_mfma_f32_16x16x32_bf16 a[48:51], a[176:179], v[76:79], a[48:51]
v_exp_f32 v58, v58
v_mfma_f32_16x16x32_bf16 a[80:83], a[176:179], v[80:83], a[80:83]
v_cvt_pk_bf16_f32 v95, v54, v55
v_cvt_pk_bf16_f32 v96, v56, v57
v_mfma_f32_16x16x32_bf16 a[112:115], a[176:179], v[84:87], a[112:115]
v_exp_f32 v59, v59
v_mfma_f32_16x16x32_bf16 a[116:119], a[180:183], v[84:87], a[116:119]
ds_read_b64_tr_b16 a[176:177], v224 offset:40960
ds_read_b64_tr_b16 a[178:179], v224 offset:45056
v_mfma_f32_16x16x32_bf16 a[84:87], a[180:183], v[80:83], a[84:87]
v_exp_f32 v60, v60
v_mfma_f32_16x16x32_bf16 a[52:55], a[180:183], v[76:79], a[52:55]
buffer_load_dwordx4 v233, s[12:15], s39 offen offset:1024 lds
v_mfma_f32_16x16x32_bf16 a[20:23], a[180:183], v[72:75], a[20:23]
v_exp_f32 v61, v61
v_mfma_f32_16x16x32_bf16 a[24:27], a[184:187], v[72:75], a[24:27]
ds_read_b64_tr_b16 a[180:181], v225 offset:40960
ds_read_b64_tr_b16 a[182:183], v225 offset:45056
v_mfma_f32_16x16x32_bf16 a[56:59], a[184:187], v[76:79], a[56:59]
v_exp_f32 v62, v62
v_mfma_f32_16x16x32_bf16 a[88:91], a[184:187], v[80:83], a[88:91]
v_cvt_pk_bf16_f32 v97, v58, v59
v_cvt_pk_bf16_f32 v98, v60, v61
v_mfma_f32_16x16x32_bf16 a[120:123], a[184:187], v[84:87], a[120:123]
v_exp_f32 v63, v63
v_mfma_f32_16x16x32_bf16 a[124:127], a[188:191], v[84:87], a[124:127]
ds_read_b64_tr_b16 a[184:185], v226 offset:40960
ds_read_b64_tr_b16 a[186:187], v226 offset:45056
v_mfma_f32_16x16x32_bf16 a[92:95], a[188:191], v[80:83], a[92:95]
v_exp_f32 v64, v64
v_mfma_f32_16x16x32_bf16 a[60:63], a[188:191], v[76:79], a[60:63]
ds_read_b64_tr_b16 a[204:205], v248 offset:4128
v_cvt_pk_bf16_f32 v99, v62, v63
v_mfma_f32_16x16x32_bf16 a[28:31], a[188:191], v[72:75], a[28:31]
v_exp_f32 v65, v65
v_smfmac_f32_16x16x64_bf16 a[252:255], a[208:211], v[80:87], v235
s_waitcnt lgkmcnt(5)
ds_read_b64_tr_b16 a[188:189], v227 offset:40960
ds_read_b64_tr_b16 a[190:191], v227 offset:45056
v_mfma_f32_16x16x32_bf16 v[12:15], a[144:147], v[152:155], v[136:139]
v_exp_f32 v66, v66
v_mfma_f32_16x16x32_bf16 v[12:15], a[148:151], v[156:159], v[12:15]
buffer_load_dwordx4 v232, s[12:15], s39 offen offset:2048 lds
v_mfma_f32_16x16x32_bf16 v[12:15], a[152:155], v[160:163], v[12:15]
v_exp_f32 v67, v67
v_mfma_f32_16x16x32_bf16 v[12:15], a[156:159], v[164:167], v[12:15]
v_cvt_pk_bf16_f32 v100, v64, v65
v_cvt_pk_bf16_f32 v101, v66, v67
v_mfma_f32_16x16x32_bf16 v[20:23], a[156:159], v[180:183], v[140:143]
v_exp_f32 v68, v68
v_mfma_f32_16x16x32_bf16 v[20:23], a[152:155], v[176:179], v[20:23]
ds_read_b64_tr_b16 a[206:207], v248 offset:4384
ds_read_b64_tr_b16 v[120:121], v248 offset:2048
v_mfma_f32_16x16x32_bf16 v[20:23], a[148:151], v[172:175], v[20:23]
v_exp_f32 v69, v69
v_mfma_f32_16x16x32_bf16 v[20:23], a[144:147], v[168:171], v[20:23]
ds_read_b64_tr_b16 v[122:123], v248 offset:2304
v_cvt_pk_bf16_f32 v102, v68, v69
v_mfma_f32_16x16x32_bf16 v[28:31], a[144:147], v[184:187], v[144:147]
v_exp_f32 v70, v70
v_mfma_f32_16x16x32_bf16 v[28:31], a[148:151], v[188:191], v[28:31]
v_mfma_f32_16x16x32_bf16 v[28:31], a[152:155], v[192:195], v[28:31]
v_exp_f32 v71, v71
v_mfma_f32_16x16x32_bf16 v[28:31], a[156:159], v[196:199], v[28:31]
v_cvt_pk_bf16_f32 v103, v70, v71
v_mfma_f32_16x16x32_bf16 v[36:39], a[156:159], v[212:215], v[148:151]
ds_read_b128 a[156:159], v219 offset:28672
v_mfma_f32_16x16x32_bf16 v[36:39], a[152:155], v[208:211], v[36:39]
ds_read_b128 a[152:155], v218 offset:28672
v_mfma_f32_16x16x32_bf16 v[36:39], a[148:151], v[204:207], v[36:39]
ds_read_b128 a[148:151], v217 offset:28672
v_mfma_f32_16x16x32_bf16 v[36:39], a[144:147], v[200:203], v[36:39]
ds_read_b128 a[144:147], v216 offset:28672
v_mfma_f32_16x16x32_bf16 a[0:3], a[160:163], v[88:91], a[0:3]
s_sub_u32 s90, s49, 0xf000
v_exp_f32 v8, v8
v_mfma_f32_16x16x32_bf16 a[32:35], a[160:163], v[92:95], a[32:35]
buffer_load_dwordx4 v233, s[12:15], s39 offen offset:3072 lds
v_mfma_f32_16x16x32_bf16 a[64:67], a[160:163], v[96:99], a[64:67]
v_exp_f32 v9, v9
v_mfma_f32_16x16x32_bf16 a[96:99], a[160:163], v[100:103], a[96:99]
ds_read_b64_tr_b16 a[160:161], v220 offset:49152
ds_read_b64_tr_b16 a[162:163], v220 offset:53248
v_mfma_f32_16x16x32_bf16 a[100:103], a[164:167], v[100:103], a[100:103]
v_exp_f32 v10, v10
v_mfma_f32_16x16x32_bf16 a[68:71], a[164:167], v[96:99], a[68:71]
ds_read_b64_tr_b16 v[124:125], v248 offset:2080
v_cvt_pk_bf16_f32 v72, v8, v9
v_mfma_f32_16x16x32_bf16 a[36:39], a[164:167], v[92:95], a[36:39]
v_exp_f32 v11, v11
v_mfma_f32_16x16x32_bf16 a[4:7], a[164:167], v[88:91], a[4:7]
ds_read_b64_tr_b16 a[164:165], v221 offset:49152
ds_read_b64_tr_b16 a[166:167], v221 offset:53248
v_mfma_f32_16x16x32_bf16 v[104:107], a[192:195], a[220:223], v[104:107]
v_exp_f32 v12, v12
v_mfma_f32_16x16x32_bf16 a[8:11], a[168:171], v[88:91], a[8:11]
ds_read_b64_tr_b16 v[126:127], v248 offset:2336
v_cvt_pk_bf16_f32 v73, v10, v11
v_mfma_f32_16x16x32_bf16 a[40:43], a[168:171], v[92:95], a[40:43]
v_exp_f32 v13, v13
v_mfma_f32_16x16x32_bf16 a[72:75], a[168:171], v[96:99], a[72:75]
ds_read_b64_tr_b16 v[128:129], v248 offset:6144
v_cvt_pk_bf16_f32 v74, v12, v13
v_mfma_f32_16x16x32_bf16 a[104:107], a[168:171], v[100:103], a[104:107]
ds_read_b64_tr_b16 a[168:169], v222 offset:49152
ds_read_b64_tr_b16 a[170:171], v222 offset:53248
v_mfma_f32_16x16x32_bf16 a[108:111], a[172:175], v[100:103], a[108:111]
v_exp_f32 v14, v14
v_mfma_f32_16x16x32_bf16 a[76:79], a[172:175], v[96:99], a[76:79]
ds_read_b64_tr_b16 v[130:131], v248 offset:6400
ds_read_b64_tr_b16 v[132:133], v248 offset:6176
v_mfma_f32_16x16x32_bf16 a[44:47], a[172:175], v[92:95], a[44:47]
s_add_u32 s39, s39, 16384
v_exp_f32 v15, v15
v_mfma_f32_16x16x32_bf16 a[12:15], a[172:175], v[88:91], a[12:15]
s_add_u32 m0, s37, 32768
ds_read_b64_tr_b16 a[172:173], v223 offset:49152
ds_read_b64_tr_b16 a[174:175], v223 offset:53248
v_smfmac_f32_16x16x64_bf16 a[248:251], a[208:211], v[88:95], v235
v_exp_f32 v16, v16
v_mfma_f32_16x16x32_bf16 v[108:111], a[196:199], a[220:223], v[108:111]
buffer_load_dwordx4 v228, s[8:11], s38 offen offset:0 lds
v_mfma_f32_16x16x32_bf16 v[40:43], a[128:131], v[152:155], v[136:139]
v_exp_f32 v17, v17
v_mfma_f32_16x16x32_bf16 v[40:43], a[132:135], v[156:159], v[40:43]
v_cvt_pk_bf16_f32 v75, v14, v15
v_cvt_pk_bf16_f32 v76, v16, v17
v_mfma_f32_16x16x32_bf16 v[40:43], a[136:139], v[160:163], v[40:43]
v_exp_f32 v18, v18
v_mfma_f32_16x16x32_bf16 v[40:43], a[140:143], v[164:167], v[40:43]
ds_read_b64_tr_b16 v[134:135], v248 offset:6432
v_mfma_f32_16x16x32_bf16 v[48:51], a[140:143], v[180:183], v[140:143]
v_mfma_f32_16x16x32_bf16 v[48:51], a[136:139], v[176:179], v[48:51]
v_exp_f32 v19, v19
v_mfma_f32_16x16x32_bf16 v[48:51], a[132:135], v[172:175], v[48:51]
v_cvt_pk_bf16_f32 v77, v18, v19
v_mfma_f32_16x16x32_bf16 v[48:51], a[128:131], v[168:171], v[48:51]
v_exp_f32 v20, v20
v_mfma_f32_16x16x32_bf16 v[112:115], a[200:203], a[220:223], v[112:115]
v_mfma_f32_16x16x32_bf16 v[56:59], a[128:131], v[184:187], v[144:147]
v_exp_f32 v21, v21
v_mfma_f32_16x16x32_bf16 v[56:59], a[132:135], v[188:191], v[56:59]
buffer_load_dwordx4 v229, s[8:11], s38 offen offset:1024 lds
v_mfma_f32_16x16x32_bf16 v[56:59], a[136:139], v[192:195], v[56:59]
v_exp_f32 v22, v22
v_mfma_f32_16x16x32_bf16 v[56:59], a[140:143], v[196:199], v[56:59]
v_cvt_pk_bf16_f32 v78, v20, v21
v_mfma_f32_16x16x32_bf16 v[64:67], a[140:143], v[212:215], v[148:151]
v_exp_f32 v23, v23
v_mfma_f32_16x16x32_bf16 v[64:67], a[136:139], v[208:211], v[64:67]
ds_read_b128 a[140:143], v219 offset:0
ds_read_b128 a[136:139], v218 offset:0
v_mfma_f32_16x16x32_bf16 v[64:67], a[132:135], v[204:207], v[64:67]
ds_read_b128 a[132:135], v217 offset:0
v_cvt_pk_bf16_f32 v79, v22, v23
v_mfma_f32_16x16x32_bf16 v[64:67], a[128:131], v[200:203], v[64:67]
s_waitcnt lgkmcnt(3)
v_exp_f32 v24, v24
v_mfma_f32_16x16x32_bf16 v[116:119], a[204:207], a[220:223], v[116:119]
ds_read_b128 a[128:131], v216 offset:0
v_mfma_f32_16x16x32_bf16 a[16:19], a[176:179], v[88:91], a[16:19]
v_exp_f32 v25, v25
v_mfma_f32_16x16x32_bf16 a[48:51], a[176:179], v[92:95], a[48:51]
v_cvt_pk_bf16_f32 v80, v24, v25
v_mfma_f32_16x16x32_bf16 a[80:83], a[176:179], v[96:99], a[80:83]
v_exp_f32 v26, v26
v_mfma_f32_16x16x32_bf16 a[112:115], a[176:179], v[100:103], a[112:115]
ds_read_b64_tr_b16 a[176:177], v224 offset:49152
ds_read_b64_tr_b16 a[178:179], v224 offset:53248
v_mfma_f32_16x16x32_bf16 a[116:119], a[180:183], v[100:103], a[116:119]
v_exp_f32 v27, v27
v_mfma_f32_16x16x32_bf16 a[84:87], a[180:183], v[96:99], a[84:87]
v_cvt_pk_bf16_f32 v81, v26, v27
v_mfma_f32_16x16x32_bf16 a[52:55], a[180:183], v[92:95], a[52:55]
v_exp_f32 v28, v28
v_mfma_f32_16x16x32_bf16 a[20:23], a[180:183], v[88:91], a[20:23]
buffer_load_dwordx4 v230, s[8:11], s38 offen offset:2048 lds
v_mfma_f32_16x16x32_bf16 a[24:27], a[184:187], v[88:91], a[24:27]
v_exp_f32 v29, v29
v_mfma_f32_16x16x32_bf16 a[56:59], a[184:187], v[92:95], a[56:59]
ds_read_b64_tr_b16 a[180:181], v225 offset:49152
ds_read_b64_tr_b16 a[182:183], v225 offset:53248
v_mfma_f32_16x16x32_bf16 a[88:91], a[184:187], v[96:99], a[88:91]
v_cvt_pk_bf16_f32 v82, v28, v29
v_mfma_f32_16x16x32_bf16 a[120:123], a[184:187], v[100:103], a[120:123]
v_exp_f32 v30, v30
v_mfma_f32_16x16x32_bf16 a[124:127], a[188:191], v[100:103], a[124:127]
ds_read_b64_tr_b16 a[184:185], v226 offset:49152
ds_read_b64_tr_b16 a[186:187], v226 offset:53248
v_mfma_f32_16x16x32_bf16 a[92:95], a[188:191], v[96:99], a[92:95]
v_exp_f32 v31, v31
v_mfma_f32_16x16x32_bf16 a[60:63], a[188:191], v[92:95], a[60:63]
v_cvt_pk_bf16_f32 v83, v30, v31
v_mfma_f32_16x16x32_bf16 a[28:31], a[188:191], v[88:91], a[28:31]
v_exp_f32 v32, v32
v_smfmac_f32_16x16x64_bf16 a[252:255], a[208:211], v[96:103], v235
ds_read_b64_tr_b16 a[188:189], v227 offset:49152
ds_read_b64_tr_b16 a[190:191], v227 offset:53248
v_mfma_f32_16x16x32_bf16 v[104:107], v[120:123], a[224:227], v[104:107]
v_exp_f32 v33, v33
v_mfma_f32_16x16x32_bf16 v[44:47], a[144:147], v[152:155], v[136:139]
v_cvt_pk_bf16_f32 v84, v32, v33
v_mfma_f32_16x16x32_bf16 v[44:47], a[148:151], v[156:159], v[44:47]
v_exp_f32 v34, v34
v_mfma_f32_16x16x32_bf16 v[44:47], a[152:155], v[160:163], v[44:47]
buffer_load_dwordx4 v231, s[8:11], s38 offen offset:3072 lds
v_mfma_f32_16x16x32_bf16 v[44:47], a[156:159], v[164:167], v[44:47]
v_mfma_f32_16x16x32_bf16 v[52:55], a[156:159], v[180:183], v[140:143]
v_exp_f32 v35, v35
v_mfma_f32_16x16x32_bf16 v[52:55], a[152:155], v[176:179], v[52:55]
v_cvt_pk_bf16_f32 v85, v34, v35
v_mfma_f32_16x16x32_bf16 v[52:55], a[148:151], v[172:175], v[52:55]
v_exp_f32 v36, v36
v_mfma_f32_16x16x32_bf16 v[52:55], a[144:147], v[168:171], v[52:55]
v_mfma_f32_16x16x32_bf16 v[108:111], v[124:127], a[224:227], v[108:111]
v_exp_f32 v37, v37
v_mfma_f32_16x16x32_bf16 v[60:63], a[144:147], v[184:187], v[144:147]
v_cvt_pk_bf16_f32 v86, v36, v37
v_mfma_f32_16x16x32_bf16 v[60:63], a[148:151], v[188:191], v[60:63]
v_exp_f32 v38, v38
v_mfma_f32_16x16x32_bf16 v[60:63], a[152:155], v[192:195], v[60:63]
v_mfma_f32_16x16x32_bf16 v[60:63], a[156:159], v[196:199], v[60:63]
v_exp_f32 v39, v39
v_mfma_f32_16x16x32_bf16 v[68:71], a[156:159], v[212:215], v[148:151]
ds_read_b128 a[156:159], v219 offset:4096
v_cvt_pk_bf16_f32 v87, v38, v39
v_mfma_f32_16x16x32_bf16 v[68:71], a[152:155], v[208:211], v[68:71]
ds_read_b128 a[152:155], v218 offset:4096
v_mfma_f32_16x16x32_bf16 v[68:71], a[148:151], v[204:207], v[68:71]
ds_read_b128 a[148:151], v217 offset:4096
v_mfma_f32_16x16x32_bf16 v[68:71], a[144:147], v[200:203], v[68:71]
s_add_u32 s38, s38, 16384
ds_read_b128 a[144:147], v216 offset:4096
v_mfma_f32_16x16x32_bf16 v[112:115], v[128:131], a[224:227], v[112:115]
v_mfma_f32_16x16x32_bf16 v[116:119], v[132:135], a[224:227], v[116:119]
v_mfma_f32_16x16x32_bf16 a[0:3], a[160:163], v[72:75], a[0:3]
v_exp_f32 v40, v40
v_mfma_f32_16x16x32_bf16 a[32:35], a[160:163], v[76:79], a[32:35]
s_add_u32 m0, s49, 4096
v_exp_f32 v41, v41
v_mfma_f32_16x16x32_bf16 a[64:67], a[160:163], v[80:83], a[64:67]
s_add_u32 s48, s91, 0
buffer_load_dwordx4 v249, s[64:67], s48 offen  lds
v_mfma_f32_16x16x32_bf16 a[96:99], a[160:163], v[84:87], a[96:99]
v_exp_f32 v42, v42
v_mfma_f32_16x16x32_bf16 a[100:103], a[164:167], v[84:87], a[100:103]
ds_read_b64_tr_b16 a[160:161], v220 offset:57344
ds_read_b64_tr_b16 a[162:163], v220 offset:61440
v_mfma_f32_16x16x32_bf16 a[68:71], a[164:167], v[80:83], a[68:71]
v_exp_f32 v43, v43
v_mfma_f32_16x16x32_bf16 a[36:39], a[164:167], v[76:79], a[36:39]
v_cvt_pk_bf16_f32 v88, v40, v41
v_cvt_pk_bf16_f32 v89, v42, v43
v_mfma_f32_16x16x32_bf16 a[4:7], a[164:167], v[72:75], a[4:7]
v_exp_f32 v44, v44
v_mfma_f32_16x16x32_bf16 a[8:11], a[168:171], v[72:75], a[8:11]
s_add_u32 m0, s49, 5120
ds_read_b64_tr_b16 a[164:165], v221 offset:57344
ds_read_b64_tr_b16 a[166:167], v221 offset:61440
v_mfma_f32_16x16x32_bf16 a[40:43], a[168:171], v[76:79], a[40:43]
s_add_u32 s48, s91, 4608
v_exp_f32 v45, v45
v_mfma_f32_16x16x32_bf16 a[72:75], a[168:171], v[80:83], a[72:75]
buffer_load_dwordx4 v250, s[64:67], s48 offen  lds
v_mfma_f32_16x16x32_bf16 a[104:107], a[168:171], v[84:87], a[104:107]
v_exp_f32 v46, v46
v_mfma_f32_16x16x32_bf16 a[108:111], a[172:175], v[84:87], a[108:111]
ds_read_b64_tr_b16 a[168:169], v222 offset:57344
ds_read_b64_tr_b16 a[170:171], v222 offset:61440
v_mfma_f32_16x16x32_bf16 a[76:79], a[172:175], v[80:83], a[76:79]
v_exp_f32 v47, v47
v_mfma_f32_16x16x32_bf16 a[44:47], a[172:175], v[76:79], a[44:47]
v_cvt_pk_bf16_f32 v90, v44, v45
v_cvt_pk_bf16_f32 v91, v46, v47
v_mfma_f32_16x16x32_bf16 a[12:15], a[172:175], v[72:75], a[12:15]
s_waitcnt lgkmcnt(4)
v_exp_f32 v48, v48
v_smfmac_f32_16x16x64_bf16 a[248:251], a[208:211], v[72:79], v235
s_add_u32 m0, s49, 6144
ds_read_b64_tr_b16 a[172:173], v223 offset:57344
ds_read_b64_tr_b16 a[174:175], v223 offset:61440
v_mfma_f32_16x16x32_bf16 v[8:11], a[128:131], v[152:155], v[136:139]
s_add_u32 s48, s91, 9216
v_exp_f32 v49, v49
v_mfma_f32_16x16x32_bf16 v[8:11], a[132:135], v[156:159], v[8:11]
buffer_load_dwordx4 v249, s[64:67], s48 offen  lds
v_mfma_f32_16x16x32_bf16 v[8:11], a[136:139], v[160:163], v[8:11]
v_exp_f32 v50, v50
v_mfma_f32_16x16x32_bf16 v[8:11], a[140:143], v[164:167], v[8:11]
v_cvt_pk_bf16_f32 v92, v48, v49
v_add_u32 v131, s90, v223
v_mfma_f32_16x16x32_bf16 v[16:19], a[140:143], v[180:183], v[140:143]
v_exp_f32 v51, v51
v_mfma_f32_16x16x32_bf16 v[16:19], a[136:139], v[176:179], v[16:19]
v_cvt_pk_bf16_f32 v93, v50, v51
v_add_u32 v132, s90, v224
v_mfma_f32_16x16x32_bf16 v[16:19], a[132:135], v[172:175], v[16:19]
v_exp_f32 v52, v52
v_mfma_f32_16x16x32_bf16 v[16:19], a[128:131], v[168:171], v[16:19]
s_add_u32 m0, s49, 7168
ds_write_b128 v5, v[104:107] offset:0
v_mfma_f32_16x16x32_bf16 v[24:27], a[128:131], v[184:187], v[144:147]
s_add_u32 s48, s91, 13824
v_exp_f32 v53, v53
v_mfma_f32_16x16x32_bf16 v[24:27], a[132:135], v[188:191], v[24:27]
buffer_load_dwordx4 v250, s[64:67], s48 offen  lds
v_mfma_f32_16x16x32_bf16 v[24:27], a[136:139], v[192:195], v[24:27]
v_exp_f32 v54, v54
v_mfma_f32_16x16x32_bf16 v[24:27], a[140:143], v[196:199], v[24:27]
v_cvt_pk_bf16_f32 v94, v52, v53
v_add_u32 v133, s90, v225
v_mfma_f32_16x16x32_bf16 v[32:35], a[140:143], v[212:215], v[148:151]
v_exp_f32 v55, v55
v_mfma_f32_16x16x32_bf16 v[32:35], a[136:139], v[208:211], v[32:35]
ds_read_b128 a[140:143], v219 offset:8192
ds_read_b128 a[136:139], v218 offset:8192
v_mfma_f32_16x16x32_bf16 v[32:35], a[132:135], v[204:207], v[32:35]
v_exp_f32 v56, v56
v_mfma_f32_16x16x32_bf16 v[32:35], a[128:131], v[200:203], v[32:35]
v_exp_f32 v57, v57
v_mfma_f32_16x16x32_bf16 a[16:19], a[176:179], v[72:75], a[16:19]
buffer_load_dwordx2 v[252:253], v251, s[76:79], s42 offen sc1
v_mfma_f32_16x16x32_bf16 a[48:51], a[176:179], v[76:79], a[48:51]
v_exp_f32 v58, v58
v_mfma_f32_16x16x32_bf16 a[80:83], a[176:179], v[80:83], a[80:83]
ds_read_b128 a[132:135], v217 offset:8192
ds_read_b128 a[128:131], v216 offset:8192
v_mfma_f32_16x16x32_bf16 a[112:115], a[176:179], v[84:87], a[112:115]
v_exp_f32 v59, v59
v_mfma_f32_16x16x32_bf16 a[116:119], a[180:183], v[84:87], a[116:119]
ds_read_b64_tr_b16 a[176:177], v224 offset:57344
ds_read_b64_tr_b16 a[178:179], v224 offset:61440
v_mfma_f32_16x16x32_bf16 a[84:87], a[180:183], v[80:83], a[84:87]
v_exp_f32 v60, v60
v_mfma_f32_16x16x32_bf16 a[52:55], a[180:183], v[76:79], a[52:55]
s_add_u32 s42, s42, s43
buffer_load_dword v255, v243, s[28:31], s45 offen
v_mfma_f32_16x16x32_bf16 a[20:23], a[180:183], v[72:75], a[20:23]
v_exp_f32 v61, v61
v_mfma_f32_16x16x32_bf16 a[24:27], a[184:187], v[72:75], a[24:27]
ds_read_b64_tr_b16 a[180:181], v225 offset:57344
ds_read_b64_tr_b16 a[182:183], v225 offset:61440
v_mfma_f32_16x16x32_bf16 a[56:59], a[184:187], v[76:79], a[56:59]
v_exp_f32 v62, v62
v_mfma_f32_16x16x32_bf16 a[88:91], a[184:187], v[80:83], a[88:91]
v_cvt_pk_bf16_f32 v95, v54, v55
v_cvt_pk_bf16_f32 v96, v56, v57
v_mfma_f32_16x16x32_bf16 a[120:123], a[184:187], v[84:87], a[120:123]
v_exp_f32 v63, v63
v_mfma_f32_16x16x32_bf16 a[124:127], a[188:191], v[84:87], a[124:127]
ds_read_b64_tr_b16 a[184:185], v226 offset:57344
ds_read_b64_tr_b16 a[186:187], v226 offset:61440
v_mfma_f32_16x16x32_bf16 a[92:95], a[188:191], v[80:83], a[92:95]
v_exp_f32 v64, v64
v_mfma_f32_16x16x32_bf16 a[60:63], a[188:191], v[76:79], a[60:63]
s_add_u32 s45, s45, 589824
global_load_dword v255, v242, s[72:73]
v_mfma_f32_16x16x32_bf16 a[28:31], a[188:191], v[72:75], a[28:31]
v_exp_f32 v65, v65
v_smfmac_f32_16x16x64_bf16 a[252:255], a[208:211], v[80:87], v235
ds_read_b64_tr_b16 a[188:189], v227 offset:57344
ds_read_b64_tr_b16 a[190:191], v227 offset:61440
v_mfma_f32_16x16x32_bf16 v[12:15], a[144:147], v[152:155], v[136:139]
v_exp_f32 v66, v66
v_mfma_f32_16x16x32_bf16 v[12:15], a[148:151], v[156:159], v[12:15]
v_cvt_pk_bf16_f32 v97, v58, v59
v_cvt_pk_bf16_f32 v98, v60, v61
v_mfma_f32_16x16x32_bf16 v[12:15], a[152:155], v[160:163], v[12:15]
v_exp_f32 v67, v67
v_mfma_f32_16x16x32_bf16 v[12:15], a[156:159], v[164:167], v[12:15]
v_cvt_pk_bf16_f32 v99, v62, v63
v_cvt_pk_bf16_f32 v100, v64, v65
v_mfma_f32_16x16x32_bf16 v[20:23], a[156:159], v[180:183], v[140:143]
v_exp_f32 v68, v68
v_mfma_f32_16x16x32_bf16 v[20:23], a[152:155], v[176:179], v[20:23]
buffer_load_dword v255, v0, s[24:27], s44 offen
v_mfma_f32_16x16x32_bf16 v[20:23], a[148:151], v[172:175], v[20:23]
v_exp_f32 v69, v69
v_mfma_f32_16x16x32_bf16 v[20:23], a[144:147], v[168:171], v[20:23]
v_cvt_pk_bf16_f32 v101, v66, v67
v_cvt_pk_bf16_f32 v102, v68, v69
v_mfma_f32_16x16x32_bf16 v[28:31], a[144:147], v[184:187], v[144:147]
v_exp_f32 v70, v70
v_mfma_f32_16x16x32_bf16 v[28:31], a[148:151], v[188:191], v[28:31]
ds_write_b128 v5, v[108:111] offset:1024
v_mfma_f32_16x16x32_bf16 v[28:31], a[152:155], v[192:195], v[28:31]
v_exp_f32 v71, v71
v_mfma_f32_16x16x32_bf16 v[28:31], a[156:159], v[196:199], v[28:31]
v_cvt_pk_bf16_f32 v103, v70, v71
v_add_u32 v134, s90, v226
v_mfma_f32_16x16x32_bf16 v[36:39], a[156:159], v[212:215], v[148:151]
ds_read_b128 a[156:159], v219 offset:12288
v_add_u32 v135, s90, v227
v_mfma_f32_16x16x32_bf16 v[36:39], a[152:155], v[208:211], v[36:39]
s_add_u32 s44, s44, 4096
ds_read_b128 a[152:155], v218 offset:12288
v_mfma_f32_16x16x32_bf16 v[36:39], a[148:151], v[204:207], v[36:39]
ds_read_b128 a[148:151], v217 offset:12288
v_mfma_f32_16x16x32_bf16 v[36:39], a[144:147], v[200:203], v[36:39]
ds_read_b128 a[144:147], v216 offset:12288
ds_write_b128 v5, v[112:115] offset:2048
ds_write_b128 v5, v[116:119] offset:3072
s_sub_u32 s46, s49, 0xf000
v_mfma_f32_16x16x32_bf16 a[0:3], a[160:163], v[88:91], a[0:3]
v_exp_f32 v8, v8
v_mfma_f32_16x16x32_bf16 a[32:35], a[160:163], v[92:95], a[32:35]
v_exp_f32 v9, v9
v_mfma_f32_16x16x32_bf16 a[64:67], a[160:163], v[96:99], a[64:67]
v_cvt_pk_bf16_f32 v72, v8, v9
v_add_u32 v128, s46, v220
v_mfma_f32_16x16x32_bf16 a[96:99], a[160:163], v[100:103], a[96:99]
s_waitcnt lgkmcnt(6)
v_exp_f32 v10, v10
v_mfma_f32_16x16x32_bf16 a[100:103], a[164:167], v[100:103], a[100:103]
v_add_u32 v129, s46, v221
v_add_u32 v130, s46, v222
v_mfma_f32_16x16x32_bf16 a[68:71], a[164:167], v[96:99], a[68:71]
v_exp_f32 v11, v11
s_waitcnt vmcnt(8) lgkmcnt(0)
s_barrier
v_mfma_f32_16x16x32_bf16 a[36:39], a[164:167], v[92:95], a[36:39]
ds_read_b64_tr_b16 a[160:161], v220 offset:0
ds_read_b64_tr_b16 a[162:163], v220 offset:4096
v_mfma_f32_16x16x32_bf16 a[4:7], a[164:167], v[88:91], a[4:7]
s_add_u32 m0, s37, 98304
v_exp_f32 v12, v12
v_mfma_f32_16x16x32_bf16 a[8:11], a[168:171], v[88:91], a[8:11]
buffer_load_dwordx4 v232, s[12:15], s39 offen offset:0 lds
v_mfma_f32_16x16x32_bf16 a[40:43], a[168:171], v[92:95], a[40:43]
v_exp_f32 v13, v13
v_mfma_f32_16x16x32_bf16 a[72:75], a[168:171], v[96:99], a[72:75]
ds_read_b64_tr_b16 a[164:165], v221 offset:0
ds_read_b64_tr_b16 a[166:167], v221 offset:4096
v_mfma_f32_16x16x32_bf16 a[104:107], a[168:171], v[100:103], a[104:107]
v_exp_f32 v14, v14
v_mfma_f32_16x16x32_bf16 a[108:111], a[172:175], v[100:103], a[108:111]
ds_read_b64_tr_b16 a[168:169], v222 offset:0
ds_read_b64_tr_b16 a[170:171], v222 offset:4096
v_mfma_f32_16x16x32_bf16 a[76:79], a[172:175], v[96:99], a[76:79]
v_exp_f32 v15, v15
v_mfma_f32_16x16x32_bf16 a[44:47], a[172:175], v[92:95], a[44:47]
v_cvt_pk_bf16_f32 v73, v10, v11
v_cvt_pk_bf16_f32 v74, v12, v13
v_mfma_f32_16x16x32_bf16 a[12:15], a[172:175], v[88:91], a[12:15]
v_exp_f32 v16, v16
v_smfmac_f32_16x16x64_bf16 a[248:251], a[208:211], v[88:95], v235
buffer_load_dwordx4 v233, s[12:15], s39 offen offset:1024 lds
v_mfma_f32_16x16x32_bf16 v[40:43], a[128:131], v[152:155], v[136:139]
v_exp_f32 v17, v17
v_mfma_f32_16x16x32_bf16 v[40:43], a[132:135], v[156:159], v[40:43]
ds_read_b64_tr_b16 a[172:173], v223 offset:0
ds_read_b64_tr_b16 a[174:175], v223 offset:4096
v_mfma_f32_16x16x32_bf16 v[40:43], a[136:139], v[160:163], v[40:43]
v_exp_f32 v18, v18
v_mfma_f32_16x16x32_bf16 v[40:43], a[140:143], v[164:167], v[40:43]
v_cvt_pk_bf16_f32 v75, v14, v15
v_cvt_pk_bf16_f32 v76, v16, v17
v_mfma_f32_16x16x32_bf16 v[48:51], a[140:143], v[180:183], v[140:143]
v_exp_f32 v19, v19
v_mfma_f32_16x16x32_bf16 v[48:51], a[136:139], v[176:179], v[48:51]
ds_read_b128 v[104:107], v6 offset:0
v_cvt_pk_bf16_f32 v77, v18, v19
v_mfma_f32_16x16x32_bf16 v[48:51], a[132:135], v[172:175], v[48:51]
v_exp_f32 v20, v20
v_mfma_f32_16x16x32_bf16 v[48:51], a[128:131], v[168:171], v[48:51]
ds_read_b128 v[108:111], v6 offset:8192
ds_read_b128 v[112:115], v6 offset:16384
v_mfma_f32_16x16x32_bf16 v[56:59], a[128:131], v[184:187], v[144:147]
v_exp_f32 v21, v21
v_mfma_f32_16x16x32_bf16 v[56:59], a[132:135], v[188:191], v[56:59]
buffer_load_dwordx4 v232, s[12:15], s39 offen offset:2048 lds
v_mfma_f32_16x16x32_bf16 v[56:59], a[136:139], v[192:195], v[56:59]
v_exp_f32 v22, v22
v_mfma_f32_16x16x32_bf16 v[56:59], a[140:143], v[196:199], v[56:59]
ds_read_b128 v[116:119], v6 offset:24576
v_cvt_pk_bf16_f32 v78, v20, v21
v_mfma_f32_16x16x32_bf16 v[64:67], a[140:143], v[212:215], v[148:151]
v_exp_f32 v23, v23
v_mfma_f32_16x16x32_bf16 v[64:67], a[136:139], v[208:211], v[64:67]
ds_read_b128 a[140:143], v219 offset:49152
ds_read_b128 a[136:139], v218 offset:49152
v_mfma_f32_16x16x32_bf16 v[64:67], a[132:135], v[204:207], v[64:67]
v_exp_f32 v24, v24
v_mfma_f32_16x16x32_bf16 v[64:67], a[128:131], v[200:203], v[64:67]
v_exp_f32 v25, v25
v_mfma_f32_16x16x32_bf16 a[16:19], a[176:179], v[88:91], a[16:19]
ds_read_b128 a[132:135], v217 offset:49152
ds_read_b128 a[128:131], v216 offset:49152
v_mfma_f32_16x16x32_bf16 a[48:51], a[176:179], v[92:95], a[48:51]
v_exp_f32 v26, v26
v_mfma_f32_16x16x32_bf16 a[80:83], a[176:179], v[96:99], a[80:83]
buffer_load_dwordx4 v233, s[12:15], s39 offen offset:3072 lds
v_mfma_f32_16x16x32_bf16 a[112:115], a[176:179], v[100:103], a[112:115]
v_exp_f32 v27, v27
v_mfma_f32_16x16x32_bf16 a[116:119], a[180:183], v[100:103], a[116:119]
ds_read_b64_tr_b16 a[176:177], v224 offset:0
ds_read_b64_tr_b16 a[178:179], v224 offset:4096
v_mfma_f32_16x16x32_bf16 a[84:87], a[180:183], v[96:99], a[84:87]
v_exp_f32 v28, v28
v_mfma_f32_16x16x32_bf16 a[52:55], a[180:183], v[92:95], a[52:55]
v_cvt_pk_bf16_f32 v79, v22, v23
v_cvt_pk_bf16_f32 v80, v24, v25
v_mfma_f32_16x16x32_bf16 a[20:23], a[180:183], v[88:91], a[20:23]
v_exp_f32 v29, v29
v_mfma_f32_16x16x32_bf16 a[24:27], a[184:187], v[88:91], a[24:27]
ds_read_b64_tr_b16 a[180:181], v225 offset:0
ds_read_b64_tr_b16 a[182:183], v225 offset:4096
v_mfma_f32_16x16x32_bf16 a[56:59], a[184:187], v[92:95], a[56:59]
v_exp_f32 v30, v30
v_mfma_f32_16x16x32_bf16 a[88:91], a[184:187], v[96:99], a[88:91]
v_cvt_pk_bf16_f32 v81, v26, v27
v_cvt_pk_bf16_f32 v82, v28, v29
v_mfma_f32_16x16x32_bf16 a[120:123], a[184:187], v[100:103], a[120:123]
s_add_u32 s39, s39, 16384
v_exp_f32 v31, v31
v_mfma_f32_16x16x32_bf16 a[124:127], a[188:191], v[100:103], a[124:127]
s_add_u32 m0, s37, 16384
ds_read_b64_tr_b16 a[184:185], v226 offset:0
ds_read_b64_tr_b16 a[186:187], v226 offset:4096
v_mfma_f32_16x16x32_bf16 a[92:95], a[188:191], v[96:99], a[92:95]
v_exp_f32 v32, v32
v_mfma_f32_16x16x32_bf16 a[60:63], a[188:191], v[92:95], a[60:63]
buffer_load_dwordx4 v228, s[8:11], s38 offen offset:0 lds
v_mfma_f32_16x16x32_bf16 a[28:31], a[188:191], v[88:91], a[28:31]
v_exp_f32 v33, v33
v_smfmac_f32_16x16x64_bf16 a[252:255], a[208:211], v[96:103], v235
ds_read_b64_tr_b16 a[188:189], v227 offset:0
ds_read_b64_tr_b16 a[190:191], v227 offset:4096
v_mfma_f32_16x16x32_bf16 v[44:47], a[144:147], v[152:155], v[136:139]
v_exp_f32 v34, v34
v_mfma_f32_16x16x32_bf16 v[44:47], a[148:151], v[156:159], v[44:47]
v_cvt_pk_bf16_f32 v83, v30, v31
v_cvt_pk_bf16_f32 v84, v32, v33
v_mfma_f32_16x16x32_bf16 v[44:47], a[152:155], v[160:163], v[44:47]
v_exp_f32 v35, v35
v_mfma_f32_16x16x32_bf16 v[44:47], a[156:159], v[164:167], v[44:47]
buffer_load_dwordx4 v229, s[8:11], s38 offen offset:1024 lds
v_mfma_f32_16x16x32_bf16 v[52:55], a[156:159], v[180:183], v[140:143]
v_exp_f32 v36, v36
v_mfma_f32_16x16x32_bf16 v[52:55], a[152:155], v[176:179], v[52:55]
v_cvt_pk_bf16_f32 v85, v34, v35
s_waitcnt lgkmcnt(2)
v_add_f32 v104, v104, v108
v_mfma_f32_16x16x32_bf16 v[52:55], a[148:151], v[172:175], v[52:55]
v_exp_f32 v37, v37
v_mfma_f32_16x16x32_bf16 v[52:55], a[144:147], v[168:171], v[52:55]
v_cvt_pk_bf16_f32 v86, v36, v37
v_add_f32 v112, v112, v116
v_mfma_f32_16x16x32_bf16 v[60:63], a[144:147], v[184:187], v[144:147]
v_exp_f32 v38, v38
v_mfma_f32_16x16x32_bf16 v[60:63], a[148:151], v[188:191], v[60:63]
v_add_f32 v105, v105, v109
v_add_f32 v113, v113, v117
v_mfma_f32_16x16x32_bf16 v[60:63], a[152:155], v[192:195], v[60:63]
v_exp_f32 v39, v39
v_mfma_f32_16x16x32_bf16 v[60:63], a[156:159], v[196:199], v[60:63]
v_cvt_pk_bf16_f32 v87, v38, v39
v_add_f32 v106, v106, v110
v_mfma_f32_16x16x32_bf16 v[68:71], a[156:159], v[212:215], v[148:151]
ds_read_b128 a[156:159], v219 offset:53248
v_add_f32 v114, v114, v118
v_mfma_f32_16x16x32_bf16 v[68:71], a[152:155], v[208:211], v[68:71]
ds_read_b128 a[152:155], v218 offset:53248
v_add_f32 v107, v107, v111
v_mfma_f32_16x16x32_bf16 v[68:71], a[148:151], v[204:207], v[68:71]
ds_read_b128 a[148:151], v217 offset:53248
v_add_f32 v115, v115, v119
v_mfma_f32_16x16x32_bf16 v[68:71], a[144:147], v[200:203], v[68:71]
ds_read_b128 a[144:147], v216 offset:53248
v_mfma_f32_16x16x32_bf16 a[0:3], a[160:163], v[72:75], a[0:3]
v_exp_f32 v40, v40
v_mfma_f32_16x16x32_bf16 a[32:35], a[160:163], v[76:79], a[32:35]
v_exp_f32 v41, v41
v_mfma_f32_16x16x32_bf16 a[64:67], a[160:163], v[80:83], a[64:67]
buffer_load_dwordx4 v230, s[8:11], s38 offen offset:2048 lds
v_mfma_f32_16x16x32_bf16 a[96:99], a[160:163], v[84:87], a[96:99]
v_exp_f32 v42, v42
v_mfma_f32_16x16x32_bf16 a[100:103], a[164:167], v[84:87], a[100:103]
ds_read_b64_tr_b16 a[160:161], v220 offset:8192
ds_read_b64_tr_b16 a[162:163], v220 offset:12288
v_mfma_f32_16x16x32_bf16 a[68:71], a[164:167], v[80:83], a[68:71]
v_exp_f32 v43, v43
v_mfma_f32_16x16x32_bf16 a[36:39], a[164:167], v[76:79], a[36:39]
v_cvt_pk_bf16_f32 v88, v40, v41
v_cvt_pk_bf16_f32 v89, v42, v43
v_mfma_f32_16x16x32_bf16 a[4:7], a[164:167], v[72:75], a[4:7]
v_exp_f32 v44, v44
v_mfma_f32_16x16x32_bf16 a[8:11], a[168:171], v[72:75], a[8:11]
ds_read_b64_tr_b16 a[164:165], v221 offset:8192
ds_read_b64_tr_b16 a[166:167], v221 offset:12288
v_mfma_f32_16x16x32_bf16 a[40:43], a[168:171], v[76:79], a[40:43]
v_exp_f32 v45, v45
v_mfma_f32_16x16x32_bf16 a[72:75], a[168:171], v[80:83], a[72:75]
v_cvt_pk_bf16_f32 v90, v44, v45
v_add_f32 v104, v104, v112
v_mfma_f32_16x16x32_bf16 a[104:107], a[168:171], v[84:87], a[104:107]
v_exp_f32 v46, v46
v_mfma_f32_16x16x32_bf16 a[108:111], a[172:175], v[84:87], a[108:111]
ds_read_b64_tr_b16 a[168:169], v222 offset:8192
ds_read_b64_tr_b16 a[170:171], v222 offset:12288
v_mfma_f32_16x16x32_bf16 a[76:79], a[172:175], v[80:83], a[76:79]
v_exp_f32 v47, v47
v_mfma_f32_16x16x32_bf16 a[44:47], a[172:175], v[76:79], a[44:47]
buffer_load_dwordx4 v231, s[8:11], s38 offen offset:3072 lds
v_mfma_f32_16x16x32_bf16 a[12:15], a[172:175], v[72:75], a[12:15]
v_exp_f32 v48, v48
v_smfmac_f32_16x16x64_bf16 a[248:251], a[208:211], v[72:79], v235
ds_read_b64_tr_b16 a[172:173], v223 offset:8192
ds_read_b64_tr_b16 a[174:175], v223 offset:12288
v_mfma_f32_16x16x32_bf16 v[8:11], a[128:131], v[152:155], v[136:139]
v_exp_f32 v49, v49
v_mfma_f32_16x16x32_bf16 v[8:11], a[132:135], v[156:159], v[8:11]
v_cvt_pk_bf16_f32 v91, v46, v47
v_cvt_pk_bf16_f32 v92, v48, v49
v_mfma_f32_16x16x32_bf16 v[8:11], a[136:139], v[160:163], v[8:11]
v_exp_f32 v50, v50
v_mfma_f32_16x16x32_bf16 v[8:11], a[140:143], v[164:167], v[8:11]
v_add_f32 v105, v105, v113
v_add_f32 v106, v106, v114
v_mfma_f32_16x16x32_bf16 v[16:19], a[140:143], v[180:183], v[140:143]
v_exp_f32 v51, v51
v_mfma_f32_16x16x32_bf16 v[16:19], a[136:139], v[176:179], v[16:19]
v_cvt_pk_bf16_f32 v93, v50, v51
v_add_f32 v107, v107, v115
v_mfma_f32_16x16x32_bf16 v[16:19], a[132:135], v[172:175], v[16:19]
v_exp_f32 v52, v52
v_mfma_f32_16x16x32_bf16 v[16:19], a[128:131], v[168:171], v[16:19]
v_cvt_pk_bf16_f32 v244, v104, v105
v_cvt_pk_bf16_f32 v245, v106, v107
v_mfma_f32_16x16x32_bf16 v[24:27], a[128:131], v[184:187], v[144:147]
s_add_u32 s38, s38, 16384
v_exp_f32 v53, v53
v_mfma_f32_16x16x32_bf16 v[24:27], a[132:135], v[188:191], v[24:27]
s_add_u32 m0, s37, 114688
v_cvt_pk_bf16_f32 v94, v52, v53
v_lshlrev_b32 v104, 16, v244
v_mfma_f32_16x16x32_bf16 v[24:27], a[136:139], v[192:195], v[24:27]
v_exp_f32 v54, v54
v_mfma_f32_16x16x32_bf16 v[24:27], a[140:143], v[196:199], v[24:27]
buffer_load_dwordx4 v232, s[12:15], s39 offen offset:0 lds
v_mfma_f32_16x16x32_bf16 v[32:35], a[140:143], v[212:215], v[148:151]
v_exp_f32 v55, v55
v_mfma_f32_16x16x32_bf16 v[32:35], a[136:139], v[208:211], v[32:35]
ds_read_b128 a[140:143], v219 offset:57344
ds_read_b128 a[136:139], v218 offset:57344
v_mfma_f32_16x16x32_bf16 v[32:35], a[132:135], v[204:207], v[32:35]
v_exp_f32 v56, v56
v_mfma_f32_16x16x32_bf16 v[32:35], a[128:131], v[200:203], v[32:35]
v_exp_f32 v57, v57
v_mfma_f32_16x16x32_bf16 a[16:19], a[176:179], v[72:75], a[16:19]
ds_read_b128 a[132:135], v217 offset:57344
ds_read_b128 a[128:131], v216 offset:57344
v_mfma_f32_16x16x32_bf16 a[48:51], a[176:179], v[76:79], a[48:51]
v_exp_f32 v58, v58
v_mfma_f32_16x16x32_bf16 a[80:83], a[176:179], v[80:83], a[80:83]
v_cvt_pk_bf16_f32 v95, v54, v55
v_cvt_pk_bf16_f32 v96, v56, v57
v_mfma_f32_16x16x32_bf16 a[112:115], a[176:179], v[84:87], a[112:115]
v_exp_f32 v59, v59
v_mfma_f32_16x16x32_bf16 a[116:119], a[180:183], v[84:87], a[116:119]
ds_read_b64_tr_b16 a[176:177], v224 offset:8192
ds_read_b64_tr_b16 a[178:179], v224 offset:12288
v_mfma_f32_16x16x32_bf16 a[84:87], a[180:183], v[80:83], a[84:87]
v_exp_f32 v60, v60
v_mfma_f32_16x16x32_bf16 a[52:55], a[180:183], v[76:79], a[52:55]
buffer_load_dwordx4 v233, s[12:15], s39 offen offset:1024 lds
v_mfma_f32_16x16x32_bf16 a[20:23], a[180:183], v[72:75], a[20:23]
v_exp_f32 v61, v61
v_mfma_f32_16x16x32_bf16 a[24:27], a[184:187], v[72:75], a[24:27]
ds_read_b64_tr_b16 a[180:181], v225 offset:8192
ds_read_b64_tr_b16 a[182:183], v225 offset:12288
v_mfma_f32_16x16x32_bf16 a[56:59], a[184:187], v[76:79], a[56:59]
v_exp_f32 v62, v62
v_mfma_f32_16x16x32_bf16 a[88:91], a[184:187], v[80:83], a[88:91]
v_cvt_pk_bf16_f32 v97, v58, v59
v_cvt_pk_bf16_f32 v98, v60, v61
v_mfma_f32_16x16x32_bf16 a[120:123], a[184:187], v[84:87], a[120:123]
s_waitcnt lgkmcnt(4)
v_exp_f32 v63, v63
v_mfma_f32_16x16x32_bf16 a[124:127], a[188:191], v[84:87], a[124:127]
ds_read_b64_tr_b16 a[184:185], v226 offset:8192
ds_read_b64_tr_b16 a[186:187], v226 offset:12288
v_mfma_f32_16x16x32_bf16 a[92:95], a[188:191], v[80:83], a[92:95]
v_exp_f32 v64, v64
v_mfma_f32_16x16x32_bf16 a[60:63], a[188:191], v[76:79], a[60:63]
v_cvt_pk_bf16_f32 v99, v62, v63
v_and_b32 v105, 0xffff0000, v244
v_mfma_f32_16x16x32_bf16 a[28:31], a[188:191], v[72:75], a[28:31]
v_exp_f32 v65, v65
v_smfmac_f32_16x16x64_bf16 a[252:255], a[208:211], v[80:87], v235
ds_read_b64_tr_b16 a[188:189], v227 offset:8192
ds_read_b64_tr_b16 a[190:191], v227 offset:12288
v_mfma_f32_16x16x32_bf16 v[12:15], a[144:147], v[152:155], v[136:139]
v_exp_f32 v66, v66
v_mfma_f32_16x16x32_bf16 v[12:15], a[148:151], v[156:159], v[12:15]
buffer_load_dwordx4 v232, s[12:15], s39 offen offset:2048 lds
v_mfma_f32_16x16x32_bf16 v[12:15], a[152:155], v[160:163], v[12:15]
v_exp_f32 v67, v67
v_mfma_f32_16x16x32_bf16 v[12:15], a[156:159], v[164:167], v[12:15]
v_cvt_pk_bf16_f32 v100, v64, v65
v_cvt_pk_bf16_f32 v101, v66, v67
v_mfma_f32_16x16x32_bf16 v[20:23], a[156:159], v[180:183], v[140:143]
v_exp_f32 v68, v68
v_mfma_f32_16x16x32_bf16 v[20:23], a[152:155], v[176:179], v[20:23]
v_lshlrev_b32 v106, 16, v245
v_and_b32 v107, 0xffff0000, v245
v_mfma_f32_16x16x32_bf16 v[20:23], a[148:151], v[172:175], v[20:23]
v_exp_f32 v69, v69
v_mfma_f32_16x16x32_bf16 v[20:23], a[144:147], v[168:171], v[20:23]
v_cvt_pk_bf16_f32 v102, v68, v69
v_mul_f32 v120, 0xbfb8aa3b, v104
v_mfma_f32_16x16x32_bf16 v[28:31], a[144:147], v[184:187], v[144:147]
v_exp_f32 v70, v70
v_mfma_f32_16x16x32_bf16 v[28:31], a[148:151], v[188:191], v[28:31]
v_mul_f32 v121, 0xbfb8aa3b, v105
v_mul_f32 v122, 0xbfb8aa3b, v106
v_mfma_f32_16x16x32_bf16 v[28:31], a[152:155], v[192:195], v[28:31]
v_exp_f32 v71, v71
v_mfma_f32_16x16x32_bf16 v[28:31], a[156:159], v[196:199], v[28:31]
v_cvt_pk_bf16_f32 v103, v70, v71
v_mul_f32 v123, 0xbfb8aa3b, v107
v_mfma_f32_16x16x32_bf16 v[36:39], a[156:159], v[212:215], v[148:151]
ds_read_b128 a[156:159], v219 offset:61440
v_mfma_f32_16x16x32_bf16 v[36:39], a[152:155], v[208:211], v[36:39]
ds_read_b128 a[152:155], v218 offset:61440
v_mfma_f32_16x16x32_bf16 v[36:39], a[148:151], v[204:207], v[36:39]
ds_read_b128 a[148:151], v217 offset:61440
v_mfma_f32_16x16x32_bf16 v[36:39], a[144:147], v[200:203], v[36:39]
ds_read_b128 a[144:147], v216 offset:61440
v_exp_f32 v120, v120
v_exp_f32 v121, v121
v_mfma_f32_16x16x32_bf16 a[0:3], a[160:163], v[88:91], a[0:3]
v_exp_f32 v8, v8
v_mfma_f32_16x16x32_bf16 a[32:35], a[160:163], v[92:95], a[32:35]
v_exp_f32 v9, v9
v_mfma_f32_16x16x32_bf16 a[64:67], a[160:163], v[96:99], a[64:67]
buffer_load_dwordx4 v233, s[12:15], s39 offen offset:3072 lds
v_mfma_f32_16x16x32_bf16 a[96:99], a[160:163], v[100:103], a[96:99]
v_exp_f32 v10, v10
v_mfma_f32_16x16x32_bf16 a[100:103], a[164:167], v[100:103], a[100:103]
ds_read_b64_tr_b16 a[160:161], v220 offset:16384
ds_read_b64_tr_b16 a[162:163], v220 offset:20480
v_mfma_f32_16x16x32_bf16 a[68:71], a[164:167], v[96:99], a[68:71]
v_exp_f32 v11, v11
v_mfma_f32_16x16x32_bf16 a[36:39], a[164:167], v[92:95], a[36:39]
v_cvt_pk_bf16_f32 v72, v8, v9
v_cvt_pk_bf16_f32 v73, v10, v11
v_mfma_f32_16x16x32_bf16 a[4:7], a[164:167], v[88:91], a[4:7]
v_exp_f32 v12, v12
v_mfma_f32_16x16x32_bf16 a[8:11], a[168:171], v[88:91], a[8:11]
ds_read_b64_tr_b16 a[164:165], v221 offset:16384
ds_read_b64_tr_b16 a[166:167], v221 offset:20480
v_mfma_f32_16x16x32_bf16 a[40:43], a[168:171], v[92:95], a[40:43]
v_exp_f32 v13, v13
v_mfma_f32_16x16x32_bf16 a[72:75], a[168:171], v[96:99], a[72:75]
s_waitcnt vmcnt(16)
ds_read_b64_tr_b16 a[192:193], v128
v_cvt_pk_bf16_f32 v74, v12, v13
v_mfma_f32_16x16x32_bf16 a[104:107], a[168:171], v[100:103], a[104:107]
v_exp_f32 v14, v14
v_mfma_f32_16x16x32_bf16 a[108:111], a[172:175], v[100:103], a[108:111]
ds_read_b64_tr_b16 a[168:169], v222 offset:16384
ds_read_b64_tr_b16 a[170:171], v222 offset:20480
v_mfma_f32_16x16x32_bf16 a[76:79], a[172:175], v[96:99], a[76:79]
s_add_u32 s39, s39, 16384
v_exp_f32 v15, v15
v_mfma_f32_16x16x32_bf16 a[44:47], a[172:175], v[92:95], a[44:47]
s_add_u32 m0, s37, 0
ds_read_b64_tr_b16 a[196:197], v129
v_cvt_pk_bf16_f32 v75, v14, v15
v_mfma_f32_16x16x32_bf16 a[12:15], a[172:175], v[88:91], a[12:15]
v_exp_f32 v16, v16
v_smfmac_f32_16x16x64_bf16 a[248:251], a[208:211], v[88:95], v235
buffer_load_dwordx4 v228, s[8:11], s38 offen offset:0 lds
v_mfma_f32_16x16x32_bf16 v[40:43], a[128:131], v[152:155], v[136:139]
v_exp_f32 v17, v17
v_mfma_f32_16x16x32_bf16 v[40:43], a[132:135], v[156:159], v[40:43]
ds_read_b64_tr_b16 a[172:173], v223 offset:16384
ds_read_b64_tr_b16 a[174:175], v223 offset:20480
v_mfma_f32_16x16x32_bf16 v[40:43], a[136:139], v[160:163], v[40:43]
v_exp_f32 v18, v18
v_mfma_f32_16x16x32_bf16 v[40:43], a[140:143], v[164:167], v[40:43]
ds_read_b64_tr_b16 a[200:201], v130
v_cvt_pk_bf16_f32 v76, v16, v17
v_mfma_f32_16x16x32_bf16 v[48:51], a[140:143], v[180:183], v[140:143]
v_exp_f32 v19, v19
v_mfma_f32_16x16x32_bf16 v[48:51], a[136:139], v[176:179], v[48:51]
ds_read_b64_tr_b16 a[204:205], v131
v_cvt_pk_bf16_f32 v77, v18, v19
v_mfma_f32_16x16x32_bf16 v[48:51], a[132:135], v[172:175], v[48:51]
v_exp_f32 v20, v20
v_mfma_f32_16x16x32_bf16 v[48:51], a[128:131], v[168:171], v[48:51]
v_exp_f32 v122, v122
v_mfma_f32_16x16x32_bf16 v[56:59], a[128:131], v[184:187], v[144:147]
v_exp_f32 v21, v21
v_mfma_f32_16x16x32_bf16 v[56:59], a[132:135], v[188:191], v[56:59]
buffer_load_dwordx4 v229, s[8:11], s38 offen offset:1024 lds
v_mfma_f32_16x16x32_bf16 v[56:59], a[136:139], v[192:195], v[56:59]
v_exp_f32 v22, v22
v_mfma_f32_16x16x32_bf16 v[56:59], a[140:143], v[196:199], v[56:59]
v_cvt_pk_bf16_f32 v78, v20, v21
v_mfma_f32_16x16x32_bf16 v[64:67], a[140:143], v[212:215], v[148:151]
v_exp_f32 v23, v23
v_mfma_f32_16x16x32_bf16 v[64:67], a[136:139], v[208:211], v[64:67]
ds_read_b128 a[140:143], v219 offset:32768
ds_read_b128 a[136:139], v218 offset:32768
v_mfma_f32_16x16x32_bf16 v[64:67], a[132:135], v[204:207], v[64:67]
v_exp_f32 v24, v24
v_mfma_f32_16x16x32_bf16 v[64:67], a[128:131], v[200:203], v[64:67]
s_waitcnt lgkmcnt(2)
v_exp_f32 v25, v25
v_mfma_f32_16x16x32_bf16 a[16:19], a[176:179], v[88:91], a[16:19]
ds_read_b128 a[132:135], v217 offset:32768
ds_read_b128 a[128:131], v216 offset:32768
v_mfma_f32_16x16x32_bf16 a[48:51], a[176:179], v[92:95], a[48:51]
v_exp_f32 v26, v26
v_mfma_f32_16x16x32_bf16 a[80:83], a[176:179], v[96:99], a[80:83]
v_cvt_pk_bf16_f32 v79, v22, v23
v_cvt_pk_bf16_f32 v80, v24, v25
v_mfma_f32_16x16x32_bf16 a[112:115], a[176:179], v[100:103], a[112:115]
v_exp_f32 v27, v27
v_mfma_f32_16x16x32_bf16 a[116:119], a[180:183], v[100:103], a[116:119]
ds_read_b64_tr_b16 a[176:177], v224 offset:16384
ds_read_b64_tr_b16 a[178:179], v224 offset:20480
v_mfma_f32_16x16x32_bf16 a[84:87], a[180:183], v[96:99], a[84:87]
v_exp_f32 v28, v28
v_mfma_f32_16x16x32_bf16 a[52:55], a[180:183], v[92:95], a[52:55]
buffer_load_dwordx4 v230, s[8:11], s38 offen offset:2048 lds
v_mfma_f32_16x16x32_bf16 a[20:23], a[180:183], v[88:91], a[20:23]
v_exp_f32 v29, v29
v_mfma_f32_16x16x32_bf16 a[24:27], a[184:187], v[88:91], a[24:27]
ds_read_b64_tr_b16 a[180:181], v225 offset:16384
ds_read_b64_tr_b16 a[182:183], v225 offset:20480
v_mfma_f32_16x16x32_bf16 a[56:59], a[184:187], v[92:95], a[56:59]
v_exp_f32 v30, v30
v_mfma_f32_16x16x32_bf16 a[88:91], a[184:187], v[96:99], a[88:91]
v_cvt_pk_bf16_f32 v81, v26, v27
v_cvt_pk_bf16_f32 v82, v28, v29
v_mfma_f32_16x16x32_bf16 a[120:123], a[184:187], v[100:103], a[120:123]
v_exp_f32 v31, v31
v_mfma_f32_16x16x32_bf16 a[124:127], a[188:191], v[100:103], a[124:127]
ds_read_b64_tr_b16 a[184:185], v226 offset:16384
ds_read_b64_tr_b16 a[186:187], v226 offset:20480
v_mfma_f32_16x16x32_bf16 a[92:95], a[188:191], v[96:99], a[92:95]
v_exp_f32 v32, v32
v_mfma_f32_16x16x32_bf16 a[60:63], a[188:191], v[92:95], a[60:63]
v_cvt_pk_bf16_f32 v83, v30, v31
v_mfma_f32_16x16x32_bf16 a[28:31], a[188:191], v[88:91], a[28:31]
v_exp_f32 v33, v33
v_smfmac_f32_16x16x64_bf16 a[252:255], a[208:211], v[96:103], v235
ds_read_b64_tr_b16 a[188:189], v227 offset:16384
ds_read_b64_tr_b16 a[190:191], v227 offset:20480
v_mfma_f32_16x16x32_bf16 v[44:47], a[144:147], v[152:155], v[136:139]
v_exp_f32 v34, v34
v_mfma_f32_16x16x32_bf16 v[44:47], a[148:151], v[156:159], v[44:47]
buffer_load_dwordx4 v231, s[8:11], s38 offen offset:3072 lds
v_mfma_f32_16x16x32_bf16 v[44:47], a[152:155], v[160:163], v[44:47]
v_exp_f32 v35, v35
v_mfma_f32_16x16x32_bf16 v[44:47], a[156:159], v[164:167], v[44:47]
v_cvt_pk_bf16_f32 v84, v32, v33
v_cvt_pk_bf16_f32 v85, v34, v35
v_mfma_f32_16x16x32_bf16 v[52:55], a[156:159], v[180:183], v[140:143]
v_exp_f32 v36, v36
v_mfma_f32_16x16x32_bf16 v[52:55], a[152:155], v[176:179], v[52:55]
v_exp_f32 v123, v123
v_mfma_f32_16x16x32_bf16 v[52:55], a[148:151], v[172:175], v[52:55]
v_exp_f32 v37, v37
v_mfma_f32_16x16x32_bf16 v[52:55], a[144:147], v[168:171], v[52:55]
v_cvt_pk_bf16_f32 v86, v36, v37
v_add_f32 v120, 1.0, v120
v_mfma_f32_16x16x32_bf16 v[60:63], a[144:147], v[184:187], v[144:147]
v_exp_f32 v38, v38
v_mfma_f32_16x16x32_bf16 v[60:63], a[148:151], v[188:191], v[60:63]
v_add_f32 v121, 1.0, v121
v_add_f32 v122, 1.0, v122
v_mfma_f32_16x16x32_bf16 v[60:63], a[152:155], v[192:195], v[60:63]
v_exp_f32 v39, v39
v_mfma_f32_16x16x32_bf16 v[60:63], a[156:159], v[196:199], v[60:63]
v_cvt_pk_bf16_f32 v87, v38, v39
v_add_f32 v123, 1.0, v123
v_mfma_f32_16x16x32_bf16 v[68:71], a[156:159], v[212:215], v[148:151]
ds_read_b128 a[156:159], v219 offset:36864
v_mfma_f32_16x16x32_bf16 v[68:71], a[152:155], v[208:211], v[68:71]
s_add_u32 s38, s38, 16384
ds_read_b128 a[152:155], v218 offset:36864
v_mfma_f32_16x16x32_bf16 v[68:71], a[148:151], v[204:207], v[68:71]
ds_read_b128 a[148:151], v217 offset:36864
v_mfma_f32_16x16x32_bf16 v[68:71], a[144:147], v[200:203], v[68:71]
ds_read_b128 a[144:147], v216 offset:36864
v_rcp_f32 v120, v120
v_rcp_f32 v121, v121
v_rcp_f32 v122, v122
v_mfma_f32_16x16x32_bf16 a[0:3], a[160:163], v[72:75], a[0:3]
v_exp_f32 v40, v40
v_mfma_f32_16x16x32_bf16 a[32:35], a[160:163], v[76:79], a[32:35]
v_exp_f32 v41, v41
v_mfma_f32_16x16x32_bf16 a[64:67], a[160:163], v[80:83], a[64:67]
buffer_load_dwordx2 v[252:253], v251, s[76:79], s42 offen sc1
v_mfma_f32_16x16x32_bf16 a[96:99], a[160:163], v[84:87], a[96:99]
v_exp_f32 v42, v42
v_mfma_f32_16x16x32_bf16 a[100:103], a[164:167], v[84:87], a[100:103]
ds_read_b64_tr_b16 a[160:161], v220 offset:24576
ds_read_b64_tr_b16 a[162:163], v220 offset:28672
v_mfma_f32_16x16x32_bf16 a[68:71], a[164:167], v[80:83], a[68:71]
v_exp_f32 v43, v43
v_mfma_f32_16x16x32_bf16 a[36:39], a[164:167], v[76:79], a[36:39]
v_cvt_pk_bf16_f32 v88, v40, v41
v_cvt_pk_bf16_f32 v89, v42, v43
v_mfma_f32_16x16x32_bf16 a[4:7], a[164:167], v[72:75], a[4:7]
v_exp_f32 v44, v44
v_mfma_f32_16x16x32_bf16 a[8:11], a[168:171], v[72:75], a[8:11]
ds_read_b64_tr_b16 a[164:165], v221 offset:24576
ds_read_b64_tr_b16 a[166:167], v221 offset:28672
v_mfma_f32_16x16x32_bf16 a[40:43], a[168:171], v[76:79], a[40:43]
v_exp_f32 v45, v45
v_mfma_f32_16x16x32_bf16 a[72:75], a[168:171], v[80:83], a[72:75]
ds_read_b64_tr_b16 a[212:213], v132
v_cvt_pk_bf16_f32 v90, v44, v45
v_mfma_f32_16x16x32_bf16 a[104:107], a[168:171], v[84:87], a[104:107]
v_exp_f32 v46, v46
v_mfma_f32_16x16x32_bf16 a[108:111], a[172:175], v[84:87], a[108:111]
ds_read_b64_tr_b16 a[168:169], v222 offset:24576
ds_read_b64_tr_b16 a[170:171], v222 offset:28672
v_mfma_f32_16x16x32_bf16 a[76:79], a[172:175], v[80:83], a[76:79]
v_exp_f32 v47, v47
v_mfma_f32_16x16x32_bf16 a[44:47], a[172:175], v[76:79], a[44:47]
ds_read_b64_tr_b16 a[216:217], v133
v_cvt_pk_bf16_f32 v91, v46, v47
v_mfma_f32_16x16x32_bf16 a[12:15], a[172:175], v[72:75], a[12:15]
s_waitcnt lgkmcnt(6)
v_exp_f32 v48, v48
v_smfmac_f32_16x16x64_bf16 a[248:251], a[208:211], v[72:79], v235
s_add_u32 s42, s42, s43
buffer_load_dword v255, v243, s[28:31], s45 offen
v_mfma_f32_16x16x32_bf16 v[8:11], a[128:131], v[152:155], v[136:139]
v_exp_f32 v49, v49
v_mfma_f32_16x16x32_bf16 v[8:11], a[132:135], v[156:159], v[8:11]
ds_read_b64_tr_b16 a[172:173], v223 offset:24576
ds_read_b64_tr_b16 a[174:175], v223 offset:28672
v_mfma_f32_16x16x32_bf16 v[8:11], a[136:139], v[160:163], v[8:11]
v_exp_f32 v50, v50
v_mfma_f32_16x16x32_bf16 v[8:11], a[140:143], v[164:167], v[8:11]
ds_read_b64_tr_b16 a[220:221], v134
v_cvt_pk_bf16_f32 v92, v48, v49
v_mfma_f32_16x16x32_bf16 v[16:19], a[140:143], v[180:183], v[140:143]
v_exp_f32 v51, v51
v_mfma_f32_16x16x32_bf16 v[16:19], a[136:139], v[176:179], v[16:19]
ds_read_b64_tr_b16 a[224:225], v135
v_cvt_pk_bf16_f32 v93, v50, v51
v_mfma_f32_16x16x32_bf16 v[16:19], a[132:135], v[172:175], v[16:19]
v_exp_f32 v52, v52
v_mfma_f32_16x16x32_bf16 v[16:19], a[128:131], v[168:171], v[16:19]
v_rcp_f32 v123, v123
v_mfma_f32_16x16x32_bf16 v[24:27], a[128:131], v[184:187], v[144:147]
v_exp_f32 v53, v53
v_mfma_f32_16x16x32_bf16 v[24:27], a[132:135], v[188:191], v[24:27]
v_cvt_pk_bf16_f32 v94, v52, v53
v_mul_f32 v104, v104, v120
v_mfma_f32_16x16x32_bf16 v[24:27], a[136:139], v[192:195], v[24:27]
v_exp_f32 v54, v54
v_mfma_f32_16x16x32_bf16 v[24:27], a[140:143], v[196:199], v[24:27]
v_mul_f32 v105, v105, v121
v_mul_f32 v106, v106, v122
v_mfma_f32_16x16x32_bf16 v[32:35], a[140:143], v[212:215], v[148:151]
v_exp_f32 v55, v55
v_mfma_f32_16x16x32_bf16 v[32:35], a[136:139], v[208:211], v[32:35]
ds_read_b128 a[140:143], v219 offset:40960
ds_read_b128 a[136:139], v218 offset:40960
v_mfma_f32_16x16x32_bf16 v[32:35], a[132:135], v[204:207], v[32:35]
v_exp_f32 v56, v56
v_mfma_f32_16x16x32_bf16 v[32:35], a[128:131], v[200:203], v[32:35]
s_add_u32 s45, s45, 589824
v_exp_f32 v57, v57
v_mfma_f32_16x16x32_bf16 a[16:19], a[176:179], v[72:75], a[16:19]
global_load_dword v255, v242, s[72:73]
v_mfma_f32_16x16x32_bf16 a[48:51], a[176:179], v[76:79], a[48:51]
v_exp_f32 v58, v58
v_mfma_f32_16x16x32_bf16 a[80:83], a[176:179], v[80:83], a[80:83]
ds_read_b128 a[132:135], v217 offset:40960
ds_read_b128 a[128:131], v216 offset:40960
v_mfma_f32_16x16x32_bf16 a[112:115], a[176:179], v[84:87], a[112:115]
v_exp_f32 v59, v59
v_mfma_f32_16x16x32_bf16 a[116:119], a[180:183], v[84:87], a[116:119]
ds_read_b64_tr_b16 a[176:177], v224 offset:24576
ds_read_b64_tr_b16 a[178:179], v224 offset:28672
v_mfma_f32_16x16x32_bf16 a[84:87], a[180:183], v[80:83], a[84:87]
v_exp_f32 v60, v60
v_mfma_f32_16x16x32_bf16 a[52:55], a[180:183], v[76:79], a[52:55]
v_cvt_pk_bf16_f32 v95, v54, v55
v_cvt_pk_bf16_f32 v96, v56, v57
v_mfma_f32_16x16x32_bf16 a[20:23], a[180:183], v[72:75], a[20:23]
v_exp_f32 v61, v61
v_mfma_f32_16x16x32_bf16 a[24:27], a[184:187], v[72:75], a[24:27]
ds_read_b64_tr_b16 a[180:181], v225 offset:24576
ds_read_b64_tr_b16 a[182:183], v225 offset:28672
v_mfma_f32_16x16x32_bf16 a[56:59], a[184:187], v[76:79], a[56:59]
v_exp_f32 v62, v62
v_mfma_f32_16x16x32_bf16 a[88:91], a[184:187], v[80:83], a[88:91]
v_cvt_pk_bf16_f32 v97, v58, v59
v_cvt_pk_bf16_f32 v98, v60, v61
v_mfma_f32_16x16x32_bf16 a[120:123], a[184:187], v[84:87], a[120:123]
v_exp_f32 v63, v63
v_mfma_f32_16x16x32_bf16 a[124:127], a[188:191], v[84:87], a[124:127]
ds_read_b64_tr_b16 a[184:185], v226 offset:24576
ds_read_b64_tr_b16 a[186:187], v226 offset:28672
v_mfma_f32_16x16x32_bf16 a[92:95], a[188:191], v[80:83], a[92:95]
v_exp_f32 v64, v64
v_mfma_f32_16x16x32_bf16 a[60:63], a[188:191], v[76:79], a[60:63]
buffer_load_dword v255, v0, s[24:27], s44 offen
v_mfma_f32_16x16x32_bf16 a[28:31], a[188:191], v[72:75], a[28:31]
v_exp_f32 v65, v65
v_smfmac_f32_16x16x64_bf16 a[252:255], a[208:211], v[80:87], v235
ds_read_b64_tr_b16 a[188:189], v227 offset:24576
ds_read_b64_tr_b16 a[190:191], v227 offset:28672
v_mfma_f32_16x16x32_bf16 v[12:15], a[144:147], v[152:155], v[136:139]
v_exp_f32 v66, v66
v_mfma_f32_16x16x32_bf16 v[12:15], a[148:151], v[156:159], v[12:15]
v_cvt_pk_bf16_f32 v99, v62, v63
v_cvt_pk_bf16_f32 v100, v64, v65
v_mfma_f32_16x16x32_bf16 v[12:15], a[152:155], v[160:163], v[12:15]
v_exp_f32 v67, v67
v_mfma_f32_16x16x32_bf16 v[12:15], a[156:159], v[164:167], v[12:15]
v_cvt_pk_bf16_f32 v101, v66, v67
v_mul_f32 v107, v107, v123
v_mfma_f32_16x16x32_bf16 v[20:23], a[156:159], v[180:183], v[140:143]
v_exp_f32 v68, v68
v_mfma_f32_16x16x32_bf16 v[20:23], a[152:155], v[176:179], v[20:23]
v_cvt_pk_bf16_f32 v120, v104, v105
v_cvt_pk_bf16_f32 v121, v106, v107
v_mfma_f32_16x16x32_bf16 v[20:23], a[148:151], v[172:175], v[20:23]
v_exp_f32 v69, v69
v_mfma_f32_16x16x32_bf16 v[20:23], a[144:147], v[168:171], v[20:23]
v_cvt_pk_bf16_f32 v102, v68, v69
v_cndmask_b32 v244, v244, v120, s[88:89]
v_mfma_f32_16x16x32_bf16 v[28:31], a[144:147], v[184:187], v[144:147]
v_exp_f32 v70, v70
v_mfma_f32_16x16x32_bf16 v[28:31], a[148:151], v[188:191], v[28:31]
v_cndmask_b32 v245, v245, v121, s[88:89]
v_mfma_f32_16x16x32_bf16 v[28:31], a[152:155], v[192:195], v[28:31]
v_exp_f32 v71, v71
v_mfma_f32_16x16x32_bf16 v[28:31], a[156:159], v[196:199], v[28:31]
ds_write_b64 v6, v[244:245] offset:0
v_cvt_pk_bf16_f32 v103, v70, v71
v_mfma_f32_16x16x32_bf16 v[36:39], a[156:159], v[212:215], v[148:151]
ds_read_b128 a[156:159], v219 offset:45056
ds_write_b64 v6, v[244:245] offset:8192
v_mfma_f32_16x16x32_bf16 v[36:39], a[152:155], v[208:211], v[36:39]
s_add_u32 s44, s44, 4096
ds_read_b128 a[152:155], v218 offset:45056
ds_write_b64 v6, v[244:245] offset:16384
v_mfma_f32_16x16x32_bf16 v[36:39], a[148:151], v[204:207], v[36:39]
ds_read_b128 a[148:151], v217 offset:45056
ds_write_b64 v6, v[244:245] offset:24576
v_mfma_f32_16x16x32_bf16 v[36:39], a[144:147], v[200:203], v[36:39]
ds_read_b128 a[144:147], v216 offset:45056
v_mfma_f32_16x16x32_bf16 a[0:3], a[160:163], v[88:91], a[0:3]
s_lshl_b32 s90, s52, 7
v_exp_f32 v8, v8
v_mfma_f32_16x16x32_bf16 a[32:35], a[160:163], v[92:95], a[32:35]
s_add_u32 s90, s90, 0x2400000
v_exp_f32 v9, v9
v_mfma_f32_16x16x32_bf16 a[64:67], a[160:163], v[96:99], a[64:67]
s_add_u32 s47, s32, 32
v_cvt_pk_bf16_f32 v72, v8, v9
v_mfma_f32_16x16x32_bf16 a[96:99], a[160:163], v[100:103], a[96:99]
s_waitcnt lgkmcnt(8)
s_mul_i32 s92, s47, 74240
v_exp_f32 v10, v10
v_mfma_f32_16x16x32_bf16 a[100:103], a[164:167], v[100:103], a[100:103]
s_add_u32 s92, s92, s90
v_mfma_f32_16x16x32_bf16 a[68:71], a[164:167], v[96:99], a[68:71]
s_mul_i32 s47, s32, 593920
v_exp_f32 v11, v11
s_waitcnt vmcnt(4) lgkmcnt(0)
s_barrier
v_mfma_f32_16x16x32_bf16 a[36:39], a[164:167], v[92:95], a[36:39]
s_add_u32 s90, s90, s47
ds_read_b64_tr_b16 a[160:161], v220 offset:32768
ds_read_b64_tr_b16 a[162:163], v220 offset:36864
v_mfma_f32_16x16x32_bf16 a[4:7], a[164:167], v[88:91], a[4:7]
s_add_u32 m0, s49, 4096
v_exp_f32 v12, v12
v_mfma_f32_16x16x32_bf16 a[8:11], a[168:171], v[88:91], a[8:11]
s_add_u32 s48, s91, 18432
buffer_load_dwordx4 v249, s[64:67], s48 offen  lds
v_mfma_f32_16x16x32_bf16 a[40:43], a[168:171], v[92:95], a[40:43]
v_exp_f32 v13, v13
v_mfma_f32_16x16x32_bf16 a[72:75], a[168:171], v[96:99], a[72:75]
ds_read_b64_tr_b16 a[164:165], v221 offset:32768
ds_read_b64_tr_b16 a[166:167], v221 offset:36864
v_mfma_f32_16x16x32_bf16 a[104:107], a[168:171], v[100:103], a[104:107]
v_exp_f32 v14, v14
v_mfma_f32_16x16x32_bf16 a[108:111], a[172:175], v[100:103], a[108:111]
s_add_u32 m0, s49, 5120
ds_read_b64_tr_b16 a[168:169], v222 offset:32768
ds_read_b64_tr_b16 a[170:171], v222 offset:36864
v_mfma_f32_16x16x32_bf16 a[76:79], a[172:175], v[96:99], a[76:79]
s_add_u32 s48, s91, 23040
v_exp_f32 v15, v15
v_mfma_f32_16x16x32_bf16 a[44:47], a[172:175], v[92:95], a[44:47]
buffer_load_dwordx4 v250, s[64:67], s48 offen  lds
v_mfma_f32_16x16x32_bf16 a[12:15], a[172:175], v[88:91], a[12:15]
v_exp_f32 v16, v16
v_smfmac_f32_16x16x64_bf16 a[248:251], a[208:211], v[88:95], v235
ds_read_b64_tr_b16 a[172:173], v223 offset:32768
ds_read_b64_tr_b16 a[174:175], v223 offset:36864
v_mfma_f32_16x16x32_bf16 v[40:43], a[128:131], v[152:155], v[136:139]
v_exp_f32 v17, v17
v_mfma_f32_16x16x32_bf16 v[40:43], a[132:135], v[156:159], v[40:43]
s_add_u32 m0, s49, 6144
v_cvt_pk_bf16_f32 v73, v10, v11
v_cvt_pk_bf16_f32 v74, v12, v13
v_mfma_f32_16x16x32_bf16 v[40:43], a[136:139], v[160:163], v[40:43]
s_add_u32 s48, s91, 27648
v_exp_f32 v18, v18
v_mfma_f32_16x16x32_bf16 v[40:43], a[140:143], v[164:167], v[40:43]
buffer_load_dwordx4 v249, s[64:67], s48 offen  lds
v_mfma_f32_16x16x32_bf16 v[48:51], a[140:143], v[180:183], v[140:143]
v_exp_f32 v19, v19
v_mfma_f32_16x16x32_bf16 v[48:51], a[136:139], v[176:179], v[48:51]
v_cvt_pk_bf16_f32 v75, v14, v15
v_cvt_pk_bf16_f32 v76, v16, v17
v_mfma_f32_16x16x32_bf16 v[48:51], a[132:135], v[172:175], v[48:51]
s_add_u32 m0, s49, 7168
v_exp_f32 v20, v20
v_mfma_f32_16x16x32_bf16 v[48:51], a[128:131], v[168:171], v[48:51]
s_add_u32 s48, s91, 32256
buffer_load_dwordx4 v250, s[64:67], s48 offen  lds
v_mfma_f32_16x16x32_bf16 v[56:59], a[128:131], v[184:187], v[144:147]
v_exp_f32 v21, v21
v_mfma_f32_16x16x32_bf16 v[56:59], a[132:135], v[188:191], v[56:59]
v_cvt_pk_bf16_f32 v77, v18, v19
v_cvt_pk_bf16_f32 v78, v20, v21
v_mfma_f32_16x16x32_bf16 v[56:59], a[136:139], v[192:195], v[56:59]
v_exp_f32 v22, v22
v_mfma_f32_16x16x32_bf16 v[56:59], a[140:143], v[196:199], v[56:59]
ds_read_b64 v[104:105], v5 offset:0
ds_read_b64 v[106:107], v5 offset:1024
v_mfma_f32_16x16x32_bf16 v[64:67], a[140:143], v[212:215], v[148:151]
s_add_u32 m0, s37, 65536
v_exp_f32 v23, v23
v_mfma_f32_16x16x32_bf16 v[64:67], a[136:139], v[208:211], v[64:67]
buffer_load_dwordx4 v232, s[12:15], s39 offen offset:0 lds
v_mfma_f32_16x16x32_bf16 v[64:67], a[132:135], v[204:207], v[64:67]
v_exp_f32 v24, v24
v_mfma_f32_16x16x32_bf16 v[64:67], a[128:131], v[200:203], v[64:67]
v_exp_f32 v25, v25
v_mfma_f32_16x16x32_bf16 a[16:19], a[176:179], v[88:91], a[16:19]
ds_read_b128 a[140:143], v219 offset:16384
ds_read_b128 a[136:139], v218 offset:16384
v_mfma_f32_16x16x32_bf16 a[48:51], a[176:179], v[92:95], a[48:51]
v_exp_f32 v26, v26
v_mfma_f32_16x16x32_bf16 a[80:83], a[176:179], v[96:99], a[80:83]
buffer_load_dwordx4 v233, s[12:15], s39 offen offset:1024 lds
v_mfma_f32_16x16x32_bf16 a[112:115], a[176:179], v[100:103], a[112:115]
v_exp_f32 v27, v27
v_mfma_f32_16x16x32_bf16 a[116:119], a[180:183], v[100:103], a[116:119]
ds_read_b128 a[132:135], v217 offset:16384
ds_read_b128 a[128:131], v216 offset:16384
v_mfma_f32_16x16x32_bf16 a[84:87], a[180:183], v[96:99], a[84:87]
v_exp_f32 v28, v28
v_mfma_f32_16x16x32_bf16 a[52:55], a[180:183], v[92:95], a[52:55]
ds_read_b64_tr_b16 a[176:177], v224 offset:32768
ds_read_b64_tr_b16 a[178:179], v224 offset:36864
v_mfma_f32_16x16x32_bf16 a[20:23], a[180:183], v[88:91], a[20:23]
v_exp_f32 v29, v29
v_mfma_f32_16x16x32_bf16 a[24:27], a[184:187], v[88:91], a[24:27]
buffer_load_dwordx4 v232, s[12:15], s39 offen offset:2048 lds
v_mfma_f32_16x16x32_bf16 a[56:59], a[184:187], v[92:95], a[56:59]
v_exp_f32 v30, v30
v_mfma_f32_16x16x32_bf16 a[88:91], a[184:187], v[96:99], a[88:91]
ds_read_b64_tr_b16 a[180:181], v225 offset:32768
ds_read_b64_tr_b16 a[182:183], v225 offset:36864
v_mfma_f32_16x16x32_bf16 a[120:123], a[184:187], v[100:103], a[120:123]
v_exp_f32 v31, v31
v_mfma_f32_16x16x32_bf16 a[124:127], a[188:191], v[100:103], a[124:127]
ds_read_b64_tr_b16 a[184:185], v226 offset:32768
ds_read_b64_tr_b16 a[186:187], v226 offset:36864
v_mfma_f32_16x16x32_bf16 a[92:95], a[188:191], v[96:99], a[92:95]
v_exp_f32 v32, v32
v_mfma_f32_16x16x32_bf16 a[60:63], a[188:191], v[92:95], a[60:63]
buffer_load_dwordx4 v233, s[12:15], s39 offen offset:3072 lds
v_mfma_f32_16x16x32_bf16 a[28:31], a[188:191], v[88:91], a[28:31]
v_exp_f32 v33, v33
v_smfmac_f32_16x16x64_bf16 a[252:255], a[208:211], v[96:103], v235
ds_read_b64_tr_b16 a[188:189], v227 offset:32768
ds_read_b64_tr_b16 a[190:191], v227 offset:36864
v_mfma_f32_16x16x32_bf16 v[44:47], a[144:147], v[152:155], v[136:139]
v_exp_f32 v34, v34
v_mfma_f32_16x16x32_bf16 v[44:47], a[148:151], v[156:159], v[44:47]
s_add_u32 s39, s39, 16384
v_cvt_pk_bf16_f32 v79, v22, v23
v_cvt_pk_bf16_f32 v80, v24, v25
v_mfma_f32_16x16x32_bf16 v[44:47], a[152:155], v[160:163], v[44:47]
s_add_u32 m0, s37, 49152
v_exp_f32 v35, v35
v_mfma_f32_16x16x32_bf16 v[44:47], a[156:159], v[164:167], v[44:47]
buffer_load_dwordx4 v228, s[8:11], s38 offen offset:0 lds
v_mfma_f32_16x16x32_bf16 v[52:55], a[156:159], v[180:183], v[140:143]
v_exp_f32 v36, v36
v_mfma_f32_16x16x32_bf16 v[52:55], a[152:155], v[176:179], v[52:55]
v_cvt_pk_bf16_f32 v81, v26, v27
v_cvt_pk_bf16_f32 v82, v28, v29
v_mfma_f32_16x16x32_bf16 v[52:55], a[148:151], v[172:175], v[52:55]
v_exp_f32 v37, v37
v_mfma_f32_16x16x32_bf16 v[52:55], a[144:147], v[168:171], v[52:55]
buffer_load_dwordx4 v229, s[8:11], s38 offen offset:1024 lds
v_mfma_f32_16x16x32_bf16 v[60:63], a[144:147], v[184:187], v[144:147]
v_exp_f32 v38, v38
v_mfma_f32_16x16x32_bf16 v[60:63], a[148:151], v[188:191], v[60:63]
v_cvt_pk_bf16_f32 v83, v30, v31
v_cvt_pk_bf16_f32 v84, v32, v33
v_mfma_f32_16x16x32_bf16 v[60:63], a[152:155], v[192:195], v[60:63]
v_exp_f32 v39, v39
v_mfma_f32_16x16x32_bf16 v[60:63], a[156:159], v[196:199], v[60:63]
v_cvt_pk_bf16_f32 v85, v34, v35
v_cvt_pk_bf16_f32 v86, v36, v37
v_mfma_f32_16x16x32_bf16 v[68:71], a[156:159], v[212:215], v[148:151]
ds_read_b128 a[156:159], v219 offset:20480
v_cvt_pk_bf16_f32 v87, v38, v39
v_mfma_f32_16x16x32_bf16 v[68:71], a[152:155], v[208:211], v[68:71]
ds_read_b128 a[152:155], v218 offset:20480
ds_read_b64 v[108:109], v5 offset:2048
v_mfma_f32_16x16x32_bf16 v[68:71], a[148:151], v[204:207], v[68:71]
ds_read_b128 a[148:151], v217 offset:20480
ds_read_b64 v[110:111], v5 offset:3072
v_mfma_f32_16x16x32_bf16 v[68:71], a[144:147], v[200:203], v[68:71]
s_waitcnt lgkmcnt(5)
ds_read_b128 a[144:147], v216 offset:20480
v_and_b32 v7, 7, v1
v_mul_u32_u24 v248, 18560, v4
v_lshl_add_u32 v248, v7, 4, v248
v_mfma_f32_16x16x32_bf16 a[0:3], a[160:163], v[72:75], a[0:3]
v_exp_f32 v40, v40
v_mfma_f32_16x16x32_bf16 a[32:35], a[160:163], v[76:79], a[32:35]
v_exp_f32 v41, v41
v_mfma_f32_16x16x32_bf16 a[64:67], a[160:163], v[80:83], a[64:67]
buffer_load_dwordx4 v230, s[8:11], s38 offen offset:2048 lds
v_mfma_f32_16x16x32_bf16 a[96:99], a[160:163], v[84:87], a[96:99]
v_exp_f32 v42, v42
v_mfma_f32_16x16x32_bf16 a[100:103], a[164:167], v[84:87], a[100:103]
ds_read_b64_tr_b16 a[160:161], v220 offset:40960
ds_read_b64_tr_b16 a[162:163], v220 offset:45056
v_mfma_f32_16x16x32_bf16 a[68:71], a[164:167], v[80:83], a[68:71]
v_exp_f32 v43, v43
v_mfma_f32_16x16x32_bf16 a[36:39], a[164:167], v[76:79], a[36:39]
v_cvt_pk_bf16_f32 v88, v40, v41
v_cvt_pk_bf16_f32 v89, v42, v43
v_mfma_f32_16x16x32_bf16 a[4:7], a[164:167], v[72:75], a[4:7]
v_exp_f32 v44, v44
v_mfma_f32_16x16x32_bf16 a[8:11], a[168:171], v[72:75], a[8:11]
ds_read_b64_tr_b16 a[164:165], v221 offset:40960
ds_read_b64_tr_b16 a[166:167], v221 offset:45056
v_mfma_f32_16x16x32_bf16 a[40:43], a[168:171], v[76:79], a[40:43]
v_exp_f32 v45, v45
v_mfma_f32_16x16x32_bf16 a[72:75], a[168:171], v[80:83], a[72:75]
v_cvt_pk_bf16_f32 v90, v44, v45
s_waitcnt lgkmcnt(4)
v_lshlrev_b32 v112, 16, v104
v_mfma_f32_16x16x32_bf16 a[104:107], a[168:171], v[84:87], a[104:107]
v_exp_f32 v46, v46
v_mfma_f32_16x16x32_bf16 a[108:111], a[172:175], v[84:87], a[108:111]
ds_read_b64_tr_b16 a[168:169], v222 offset:40960
ds_read_b64_tr_b16 a[170:171], v222 offset:45056
v_mfma_f32_16x16x32_bf16 a[76:79], a[172:175], v[80:83], a[76:79]
v_exp_f32 v47, v47
v_mfma_f32_16x16x32_bf16 a[44:47], a[172:175], v[76:79], a[44:47]
buffer_load_dwordx4 v231, s[8:11], s38 offen offset:3072 lds
v_mfma_f32_16x16x32_bf16 a[12:15], a[172:175], v[72:75], a[12:15]
v_exp_f32 v48, v48
v_smfmac_f32_16x16x64_bf16 a[248:251], a[208:211], v[72:79], v235
ds_read_b64_tr_b16 a[172:173], v223 offset:40960
ds_read_b64_tr_b16 a[174:175], v223 offset:45056
v_mfma_f32_16x16x32_bf16 v[8:11], a[128:131], v[152:155], v[136:139]
v_exp_f32 v49, v49
v_mfma_f32_16x16x32_bf16 v[8:11], a[132:135], v[156:159], v[8:11]
v_cvt_pk_bf16_f32 v91, v46, v47
v_cvt_pk_bf16_f32 v92, v48, v49
v_mfma_f32_16x16x32_bf16 v[8:11], a[136:139], v[160:163], v[8:11]
v_exp_f32 v50, v50
v_mfma_f32_16x16x32_bf16 v[8:11], a[140:143], v[164:167], v[8:11]
v_and_b32 v113, 0xffff0000, v104
v_lshlrev_b32 v114, 16, v105
v_mfma_f32_16x16x32_bf16 v[16:19], a[140:143], v[180:183], v[140:143]
v_exp_f32 v51, v51
v_mfma_f32_16x16x32_bf16 v[16:19], a[136:139], v[176:179], v[16:19]
v_cvt_pk_bf16_f32 v93, v50, v51
v_and_b32 v115, 0xffff0000, v105
v_mfma_f32_16x16x32_bf16 v[16:19], a[132:135], v[172:175], v[16:19]
v_exp_f32 v52, v52
v_mfma_f32_16x16x32_bf16 v[16:19], a[128:131], v[168:171], v[16:19]
v_lshlrev_b32 v116, 16, v106
v_and_b32 v117, 0xffff0000, v106
v_mfma_f32_16x16x32_bf16 v[24:27], a[128:131], v[184:187], v[144:147]
s_add_u32 s38, s38, 16384
v_exp_f32 v53, v53
v_mfma_f32_16x16x32_bf16 v[24:27], a[132:135], v[188:191], v[24:27]
s_add_u32 m0, s37, 81920
v_cvt_pk_bf16_f32 v94, v52, v53
v_lshlrev_b32 v118, 16, v107
v_mfma_f32_16x16x32_bf16 v[24:27], a[136:139], v[192:195], v[24:27]
v_exp_f32 v54, v54
v_mfma_f32_16x16x32_bf16 v[24:27], a[140:143], v[196:199], v[24:27]
buffer_load_dwordx4 v232, s[12:15], s39 offen offset:0 lds
v_mfma_f32_16x16x32_bf16 v[32:35], a[140:143], v[212:215], v[148:151]
v_exp_f32 v55, v55
v_mfma_f32_16x16x32_bf16 v[32:35], a[136:139], v[208:211], v[32:35]
ds_read_b128 a[140:143], v219 offset:24576
ds_read_b128 a[136:139], v218 offset:24576
v_mfma_f32_16x16x32_bf16 v[32:35], a[132:135], v[204:207], v[32:35]
v_exp_f32 v56, v56
v_mfma_f32_16x16x32_bf16 v[32:35], a[128:131], v[200:203], v[32:35]
v_exp_f32 v57, v57
v_mfma_f32_16x16x32_bf16 a[16:19], a[176:179], v[72:75], a[16:19]
ds_read_b128 a[132:135], v217 offset:24576
ds_read_b128 a[128:131], v216 offset:24576
v_mfma_f32_16x16x32_bf16 a[48:51], a[176:179], v[76:79], a[48:51]
v_exp_f32 v58, v58
v_mfma_f32_16x16x32_bf16 a[80:83], a[176:179], v[80:83], a[80:83]
v_cvt_pk_bf16_f32 v95, v54, v55
v_cvt_pk_bf16_f32 v96, v56, v57
v_mfma_f32_16x16x32_bf16 a[112:115], a[176:179], v[84:87], a[112:115]
v_exp_f32 v59, v59
v_mfma_f32_16x16x32_bf16 a[116:119], a[180:183], v[84:87], a[116:119]
ds_read_b64_tr_b16 a[176:177], v224 offset:40960
ds_read_b64_tr_b16 a[178:179], v224 offset:45056
v_mfma_f32_16x16x32_bf16 a[84:87], a[180:183], v[80:83], a[84:87]
v_exp_f32 v60, v60
v_mfma_f32_16x16x32_bf16 a[52:55], a[180:183], v[76:79], a[52:55]
buffer_load_dwordx4 v233, s[12:15], s39 offen offset:1024 lds
v_mfma_f32_16x16x32_bf16 a[20:23], a[180:183], v[72:75], a[20:23]
v_exp_f32 v61, v61
v_mfma_f32_16x16x32_bf16 a[24:27], a[184:187], v[72:75], a[24:27]
ds_read_b64_tr_b16 a[180:181], v225 offset:40960
ds_read_b64_tr_b16 a[182:183], v225 offset:45056
v_mfma_f32_16x16x32_bf16 a[56:59], a[184:187], v[76:79], a[56:59]
v_exp_f32 v62, v62
v_mfma_f32_16x16x32_bf16 a[88:91], a[184:187], v[80:83], a[88:91]
v_cvt_pk_bf16_f32 v97, v58, v59
v_cvt_pk_bf16_f32 v98, v60, v61
v_mfma_f32_16x16x32_bf16 a[120:123], a[184:187], v[84:87], a[120:123]
v_exp_f32 v63, v63
v_mfma_f32_16x16x32_bf16 a[124:127], a[188:191], v[84:87], a[124:127]
ds_read_b64_tr_b16 a[184:185], v226 offset:40960
ds_read_b64_tr_b16 a[186:187], v226 offset:45056
v_mfma_f32_16x16x32_bf16 a[92:95], a[188:191], v[80:83], a[92:95]
v_exp_f32 v64, v64
v_mfma_f32_16x16x32_bf16 a[60:63], a[188:191], v[76:79], a[60:63]
v_cvt_pk_bf16_f32 v99, v62, v63
v_and_b32 v119, 0xffff0000, v107
v_mfma_f32_16x16x32_bf16 a[28:31], a[188:191], v[72:75], a[28:31]
v_exp_f32 v65, v65
v_smfmac_f32_16x16x64_bf16 a[252:255], a[208:211], v[80:87], v235
ds_read_b64_tr_b16 a[188:189], v227 offset:40960
ds_read_b64_tr_b16 a[190:191], v227 offset:45056
v_mfma_f32_16x16x32_bf16 v[12:15], a[144:147], v[152:155], v[136:139]
v_exp_f32 v66, v66
v_mfma_f32_16x16x32_bf16 v[12:15], a[148:151], v[156:159], v[12:15]
buffer_load_dwordx4 v232, s[12:15], s39 offen offset:2048 lds
v_mfma_f32_16x16x32_bf16 v[12:15], a[152:155], v[160:163], v[12:15]
v_exp_f32 v67, v67
v_mfma_f32_16x16x32_bf16 v[12:15], a[156:159], v[164:167], v[12:15]
v_cvt_pk_bf16_f32 v100, v64, v65
v_cvt_pk_bf16_f32 v101, v66, v67
v_mfma_f32_16x16x32_bf16 v[20:23], a[156:159], v[180:183], v[140:143]
v_exp_f32 v68, v68
v_mfma_f32_16x16x32_bf16 v[20:23], a[152:155], v[176:179], v[20:23]
v_lshlrev_b32 v120, 16, v108
v_and_b32 v121, 0xffff0000, v108
v_mfma_f32_16x16x32_bf16 v[20:23], a[148:151], v[172:175], v[20:23]
v_exp_f32 v69, v69
v_mfma_f32_16x16x32_bf16 v[20:23], a[144:147], v[168:171], v[20:23]
v_cvt_pk_bf16_f32 v102, v68, v69
v_lshlrev_b32 v122, 16, v109
v_mfma_f32_16x16x32_bf16 v[28:31], a[144:147], v[184:187], v[144:147]
v_exp_f32 v70, v70
v_mfma_f32_16x16x32_bf16 v[28:31], a[148:151], v[188:191], v[28:31]
v_and_b32 v123, 0xffff0000, v109
v_lshlrev_b32 v124, 16, v110
v_mfma_f32_16x16x32_bf16 v[28:31], a[152:155], v[192:195], v[28:31]
v_exp_f32 v71, v71
v_mfma_f32_16x16x32_bf16 v[28:31], a[156:159], v[196:199], v[28:31]
v_cvt_pk_bf16_f32 v103, v70, v71
v_and_b32 v125, 0xffff0000, v110
v_mfma_f32_16x16x32_bf16 v[36:39], a[156:159], v[212:215], v[148:151]
ds_read_b128 a[156:159], v219 offset:28672
v_lshlrev_b32 v126, 16, v111
v_mfma_f32_16x16x32_bf16 v[36:39], a[152:155], v[208:211], v[36:39]
ds_read_b128 a[152:155], v218 offset:28672
v_and_b32 v127, 0xffff0000, v111
v_mfma_f32_16x16x32_bf16 v[36:39], a[148:151], v[204:207], v[36:39]
ds_read_b128 a[148:151], v217 offset:28672
v_mul_f32 v112, v112, v120
v_mfma_f32_16x16x32_bf16 v[36:39], a[144:147], v[200:203], v[36:39]
s_waitcnt lgkmcnt(3)
ds_read_b128 a[144:147], v216 offset:28672
v_mul_f32 v113, v113, v121
v_mfma_f32_16x16x32_bf16 a[0:3], a[160:163], v[88:91], a[0:3]
v_exp_f32 v8, v8
v_mfma_f32_16x16x32_bf16 a[32:35], a[160:163], v[92:95], a[32:35]
v_exp_f32 v9, v9
v_mfma_f32_16x16x32_bf16 a[64:67], a[160:163], v[96:99], a[64:67]
buffer_load_dwordx4 v233, s[12:15], s39 offen offset:3072 lds
v_mfma_f32_16x16x32_bf16 a[96:99], a[160:163], v[100:103], a[96:99]
v_exp_f32 v10, v10
v_mfma_f32_16x16x32_bf16 a[100:103], a[164:167], v[100:103], a[100:103]
ds_read_b64_tr_b16 a[160:161], v220 offset:49152
ds_read_b64_tr_b16 a[162:163], v220 offset:53248
v_mfma_f32_16x16x32_bf16 a[68:71], a[164:167], v[96:99], a[68:71]
v_exp_f32 v11, v11
v_mfma_f32_16x16x32_bf16 a[36:39], a[164:167], v[92:95], a[36:39]
v_cvt_pk_bf16_f32 v72, v8, v9
v_cvt_pk_bf16_f32 v73, v10, v11
v_mfma_f32_16x16x32_bf16 a[4:7], a[164:167], v[88:91], a[4:7]
v_exp_f32 v12, v12
v_mfma_f32_16x16x32_bf16 a[8:11], a[168:171], v[88:91], a[8:11]
ds_read_b64_tr_b16 a[164:165], v221 offset:49152
ds_read_b64_tr_b16 a[166:167], v221 offset:53248
v_mfma_f32_16x16x32_bf16 a[40:43], a[168:171], v[92:95], a[40:43]
v_exp_f32 v13, v13
v_mfma_f32_16x16x32_bf16 a[72:75], a[168:171], v[96:99], a[72:75]
v_cvt_pk_bf16_f32 v74, v12, v13
v_mul_f32 v114, v114, v122
v_mfma_f32_16x16x32_bf16 a[104:107], a[168:171], v[100:103], a[104:107]
v_exp_f32 v14, v14
v_mfma_f32_16x16x32_bf16 a[108:111], a[172:175], v[100:103], a[108:111]
ds_read_b64_tr_b16 a[168:169], v222 offset:49152
ds_read_b64_tr_b16 a[170:171], v222 offset:53248
v_mfma_f32_16x16x32_bf16 a[76:79], a[172:175], v[96:99], a[76:79]
s_add_u32 s39, s39, 16384
v_exp_f32 v15, v15
v_mfma_f32_16x16x32_bf16 a[44:47], a[172:175], v[92:95], a[44:47]
s_add_u32 m0, s37, 32768
v_cvt_pk_bf16_f32 v75, v14, v15
v_mul_f32 v115, v115, v123
v_mfma_f32_16x16x32_bf16 a[12:15], a[172:175], v[88:91], a[12:15]
v_exp_f32 v16, v16
v_smfmac_f32_16x16x64_bf16 a[248:251], a[208:211], v[88:95], v235
buffer_load_dwordx4 v228, s[8:11], s38 offen offset:0 lds
v_mfma_f32_16x16x32_bf16 v[40:43], a[128:131], v[152:155], v[136:139]
v_exp_f32 v17, v17
v_mfma_f32_16x16x32_bf16 v[40:43], a[132:135], v[156:159], v[40:43]
ds_read_b64_tr_b16 a[172:173], v223 offset:49152
ds_read_b64_tr_b16 a[174:175], v223 offset:53248
v_mfma_f32_16x16x32_bf16 v[40:43], a[136:139], v[160:163], v[40:43]
v_exp_f32 v18, v18
v_mfma_f32_16x16x32_bf16 v[40:43], a[140:143], v[164:167], v[40:43]
v_cvt_pk_bf16_f32 v76, v16, v17
v_mul_f32 v116, v116, v124
v_mfma_f32_16x16x32_bf16 v[48:51], a[140:143], v[180:183], v[140:143]
v_exp_f32 v19, v19
v_mfma_f32_16x16x32_bf16 v[48:51], a[136:139], v[176:179], v[48:51]
v_cvt_pk_bf16_f32 v77, v18, v19
v_mul_f32 v117, v117, v125
v_mfma_f32_16x16x32_bf16 v[48:51], a[132:135], v[172:175], v[48:51]
v_exp_f32 v20, v20
v_mfma_f32_16x16x32_bf16 v[48:51], a[128:131], v[168:171], v[48:51]
v_mul_f32 v118, v118, v126
v_mul_f32 v119, v119, v127
v_mfma_f32_16x16x32_bf16 v[56:59], a[128:131], v[184:187], v[144:147]
v_exp_f32 v21, v21
v_mfma_f32_16x16x32_bf16 v[56:59], a[132:135], v[188:191], v[56:59]
buffer_load_dwordx4 v229, s[8:11], s38 offen offset:1024 lds
v_mfma_f32_16x16x32_bf16 v[56:59], a[136:139], v[192:195], v[56:59]
v_exp_f32 v22, v22
v_mfma_f32_16x16x32_bf16 v[56:59], a[140:143], v[196:199], v[56:59]
v_cvt_pk_bf16_f32 v78, v20, v21
v_cvt_pk_bf16_f32 v244, v112, v113
v_mfma_f32_16x16x32_bf16 v[64:67], a[140:143], v[212:215], v[148:151]
v_exp_f32 v23, v23
v_mfma_f32_16x16x32_bf16 v[64:67], a[136:139], v[208:211], v[64:67]
ds_read_b128 a[140:143], v219 offset:0
ds_read_b128 a[136:139], v218 offset:0
v_mfma_f32_16x16x32_bf16 v[64:67], a[132:135], v[204:207], v[64:67]
v_exp_f32 v24, v24
v_mfma_f32_16x16x32_bf16 v[64:67], a[128:131], v[200:203], v[64:67]
v_exp_f32 v25, v25
v_mfma_f32_16x16x32_bf16 a[16:19], a[176:179], v[88:91], a[16:19]
ds_read_b128 a[132:135], v217 offset:0
ds_read_b128 a[128:131], v216 offset:0
v_mfma_f32_16x16x32_bf16 a[48:51], a[176:179], v[92:95], a[48:51]
v_exp_f32 v26, v26
v_mfma_f32_16x16x32_bf16 a[80:83], a[176:179], v[96:99], a[80:83]
v_cvt_pk_bf16_f32 v79, v22, v23
v_cvt_pk_bf16_f32 v80, v24, v25
v_mfma_f32_16x16x32_bf16 a[112:115], a[176:179], v[100:103], a[112:115]
v_exp_f32 v27, v27
v_mfma_f32_16x16x32_bf16 a[116:119], a[180:183], v[100:103], a[116:119]
ds_read_b64_tr_b16 a[176:177], v224 offset:49152
ds_read_b64_tr_b16 a[178:179], v224 offset:53248
v_mfma_f32_16x16x32_bf16 a[84:87], a[180:183], v[96:99], a[84:87]
v_exp_f32 v28, v28
v_mfma_f32_16x16x32_bf16 a[52:55], a[180:183], v[92:95], a[52:55]
buffer_load_dwordx4 v230, s[8:11], s38 offen offset:2048 lds
v_mfma_f32_16x16x32_bf16 a[20:23], a[180:183], v[88:91], a[20:23]
v_exp_f32 v29, v29
v_mfma_f32_16x16x32_bf16 a[24:27], a[184:187], v[88:91], a[24:27]
ds_read_b64_tr_b16 a[180:181], v225 offset:49152
ds_read_b64_tr_b16 a[182:183], v225 offset:53248
v_mfma_f32_16x16x32_bf16 a[56:59], a[184:187], v[92:95], a[56:59]
v_exp_f32 v30, v30
v_mfma_f32_16x16x32_bf16 a[88:91], a[184:187], v[96:99], a[88:91]
v_cvt_pk_bf16_f32 v81, v26, v27
v_cvt_pk_bf16_f32 v82, v28, v29
v_mfma_f32_16x16x32_bf16 a[120:123], a[184:187], v[100:103], a[120:123]
v_exp_f32 v31, v31
v_mfma_f32_16x16x32_bf16 a[124:127], a[188:191], v[100:103], a[124:127]
ds_read_b64_tr_b16 a[184:185], v226 offset:49152
ds_read_b64_tr_b16 a[186:187], v226 offset:53248
v_mfma_f32_16x16x32_bf16 a[92:95], a[188:191], v[96:99], a[92:95]
v_exp_f32 v32, v32
v_mfma_f32_16x16x32_bf16 a[60:63], a[188:191], v[92:95], a[60:63]
v_cvt_pk_bf16_f32 v83, v30, v31
v_cvt_pk_bf16_f32 v245, v114, v115
v_mfma_f32_16x16x32_bf16 a[28:31], a[188:191], v[88:91], a[28:31]
v_exp_f32 v33, v33
v_smfmac_f32_16x16x64_bf16 a[252:255], a[208:211], v[96:103], v235
s_waitcnt lgkmcnt(4)
ds_read_b64_tr_b16 a[188:189], v227 offset:49152
ds_read_b64_tr_b16 a[190:191], v227 offset:53248
v_mfma_f32_16x16x32_bf16 v[44:47], a[144:147], v[152:155], v[136:139]
v_exp_f32 v34, v34
v_mfma_f32_16x16x32_bf16 v[44:47], a[148:151], v[156:159], v[44:47]
buffer_load_dwordx4 v231, s[8:11], s38 offen offset:3072 lds
v_mfma_f32_16x16x32_bf16 v[44:47], a[152:155], v[160:163], v[44:47]
v_exp_f32 v35, v35
v_mfma_f32_16x16x32_bf16 v[44:47], a[156:159], v[164:167], v[44:47]
v_cvt_pk_bf16_f32 v84, v32, v33
v_cvt_pk_bf16_f32 v85, v34, v35
v_mfma_f32_16x16x32_bf16 v[52:55], a[156:159], v[180:183], v[140:143]
v_exp_f32 v36, v36
v_mfma_f32_16x16x32_bf16 v[52:55], a[152:155], v[176:179], v[52:55]
v_cvt_pk_bf16_f32 v246, v116, v117
v_cvt_pk_bf16_f32 v247, v118, v119
v_mfma_f32_16x16x32_bf16 v[52:55], a[148:151], v[172:175], v[52:55]
v_exp_f32 v37, v37
v_mfma_f32_16x16x32_bf16 v[52:55], a[144:147], v[168:171], v[52:55]
s_waitcnt vmcnt(16)
ds_read_b64_tr_b16 a[194:195], v128
v_cvt_pk_bf16_f32 v86, v36, v37
v_mfma_f32_16x16x32_bf16 v[60:63], a[144:147], v[184:187], v[144:147]
v_exp_f32 v38, v38
v_mfma_f32_16x16x32_bf16 v[60:63], a[148:151], v[188:191], v[60:63]
ds_read_b64_tr_b16 a[198:199], v129
ds_read_b64_tr_b16 a[202:203], v130
v_mfma_f32_16x16x32_bf16 v[60:63], a[152:155], v[192:195], v[60:63]
v_exp_f32 v39, v39
v_mfma_f32_16x16x32_bf16 v[60:63], a[156:159], v[196:199], v[60:63]
ds_read_b64_tr_b16 a[206:207], v131
v_cvt_pk_bf16_f32 v87, v38, v39
v_mfma_f32_16x16x32_bf16 v[68:71], a[156:159], v[212:215], v[148:151]
ds_read_b128 a[156:159], v219 offset:4096
ds_read_b64_tr_b16 a[214:215], v132
v_mfma_f32_16x16x32_bf16 v[68:71], a[152:155], v[208:211], v[68:71]
s_add_u32 s38, s38, 16384
ds_read_b128 a[152:155], v218 offset:4096
ds_read_b64_tr_b16 a[218:219], v133
v_mfma_f32_16x16x32_bf16 v[68:71], a[148:151], v[204:207], v[68:71]
ds_read_b128 a[148:151], v217 offset:4096
ds_read_b64_tr_b16 a[222:223], v134
v_mfma_f32_16x16x32_bf16 v[68:71], a[144:147], v[200:203], v[68:71]
ds_read_b128 a[144:147], v216 offset:4096
ds_read_b64_tr_b16 a[226:227], v135
v_mfma_f32_16x16x32_bf16 a[0:3], a[160:163], v[72:75], a[0:3]
s_mov_b32 s40, 6
v_exp_f32 v40, v40
v_mfma_f32_16x16x32_bf16 a[32:35], a[160:163], v[76:79], a[32:35]
s_mov_b32 s74, 0x180
buffer_load_dwordx2 v[252:253], v251, s[76:79], s42 offen sc1
v_mfma_f32_16x16x32_bf16 a[64:67], a[160:163], v[80:83], a[64:67]
s_add_u32 s52, s52, 1
v_exp_f32 v41, v41
v_mfma_f32_16x16x32_bf16 a[96:99], a[160:163], v[84:87], a[96:99]
ds_read_b64_tr_b16 a[160:161], v220 offset:57344
ds_read_b64_tr_b16 a[162:163], v220 offset:61440
v_mfma_f32_16x16x32_bf16 a[100:103], a[164:167], v[84:87], a[100:103]
v_exp_f32 v42, v42
v_mfma_f32_16x16x32_bf16 a[68:71], a[164:167], v[80:83], a[68:71]
v_cvt_pk_bf16_f32 v88, v40, v41
v_mov_b32 v5, 0
v_mfma_f32_16x16x32_bf16 a[36:39], a[164:167], v[76:79], a[36:39]
s_add_u32 s42, s42, s43
v_exp_f32 v43, v43
v_mfma_f32_16x16x32_bf16 a[4:7], a[164:167], v[72:75], a[4:7]
s_lshl_b32 s46, s32, 2
buffer_load_dword v255, v243, s[28:31], s45 offen
v_mfma_f32_16x16x32_bf16 a[228:231], a[232:235], v[244:247], 0
s_waitcnt lgkmcnt(4)
s_add_u32 s46, s46, 163776
v_exp_f32 v44, v44
v_mfma_f32_16x16x32_bf16 v[104:107], a[192:195], v[244:247], 0
ds_read_b64_tr_b16 a[164:165], v221 offset:57344
ds_read_b64_tr_b16 a[166:167], v221 offset:61440
v_mfma_f32_16x16x32_bf16 v[108:111], a[196:199], v[244:247], 0
v_cvt_pk_bf16_f32 v89, v42, v43
v_mov_b32 v6, s46
v_mfma_f32_16x16x32_bf16 v[112:115], a[200:203], v[244:247], 0
s_add_u32 s45, s45, 589824
v_exp_f32 v45, v45
v_mfma_f32_16x16x32_bf16 v[116:119], a[204:207], v[244:247], 0
global_load_dword v255, v242, s[72:73]
v_mfma_f32_16x16x32_bf16 a[8:11], a[168:171], v[72:75], a[8:11]
v_exp_f32 v46, v46
v_mfma_f32_16x16x32_bf16 a[40:43], a[168:171], v[76:79], a[40:43]
v_cvt_pk_bf16_f32 v90, v44, v45
v_and_b32 v7, 12, v1
v_mfma_f32_16x16x32_bf16 a[72:75], a[168:171], v[80:83], a[72:75]
v_exp_f32 v47, v47
v_mfma_f32_16x16x32_bf16 a[104:107], a[168:171], v[84:87], a[104:107]
ds_read_b64_tr_b16 a[168:169], v222 offset:57344
ds_read_b64_tr_b16 a[170:171], v222 offset:61440
v_mfma_f32_16x16x32_bf16 a[108:111], a[172:175], v[84:87], a[108:111]
v_exp_f32 v48, v48
v_mfma_f32_16x16x32_bf16 a[76:79], a[172:175], v[80:83], a[76:79]
buffer_load_dword v255, v0, s[24:27], s44 offen
v_mfma_f32_16x16x32_bf16 a[44:47], a[172:175], v[76:79], a[44:47]
v_exp_f32 v49, v49
v_mfma_f32_16x16x32_bf16 a[12:15], a[172:175], v[72:75], a[12:15]
ds_read_b64_tr_b16 a[172:173], v223 offset:57344
ds_read_b64_tr_b16 a[174:175], v223 offset:61440
v_smfmac_f32_16x16x64_bf16 a[248:251], a[208:211], v[72:79], v235
v_cvt_pk_bf16_f32 v91, v46, v47
v_cvt_pk_bf16_f32 v92, v48, v49
v_mfma_f32_16x16x32_bf16 v[120:123], a[212:215], v[244:247], 0
s_add_u32 s44, s44, 4096
v_exp_f32 v50, v50
v_mfma_f32_16x16x32_bf16 v[124:127], a[216:219], v[244:247], 0
buffer_store_dwordx4 a[228:231], v248, s[20:23], s92 offen sc0 sc1
v_mfma_f32_16x16x32_bf16 v[128:131], a[220:223], v[244:247], 0
s_waitcnt lgkmcnt(4)
v_exp_f32 v51, v51
v_mfma_f32_16x16x32_bf16 v[132:135], a[224:227], v[244:247], 0
v_cvt_pk_bf16_f32 v93, v50, v51
v_add_u32 v7, 163776, v7
v_mfma_f32_16x16x32_bf16 v[8:11], a[128:131], v[152:155], v[136:139]
v_exp_f32 v52, v52
v_mfma_f32_16x16x32_bf16 v[8:11], a[132:135], v[156:159], v[8:11]
v_mfma_f32_16x16x32_bf16 v[8:11], a[136:139], v[160:163], v[8:11]
s_add_u32 s48, s90, 0
v_exp_f32 v53, v53
v_mfma_f32_16x16x32_bf16 v[8:11], a[140:143], v[164:167], v[8:11]
buffer_store_dwordx4 v[104:107], v248, s[20:23], s48 offen sc0 sc1
v_mfma_f32_16x16x32_bf16 v[16:19], a[140:143], v[180:183], v[140:143]
v_cvt_pk_bf16_f32 v94, v52, v53
v_mfma_f32_16x16x32_bf16 v[16:19], a[136:139], v[176:179], v[16:19]
v_exp_f32 v54, v54
v_mfma_f32_16x16x32_bf16 v[16:19], a[132:135], v[172:175], v[16:19]
v_mfma_f32_16x16x32_bf16 v[16:19], a[128:131], v[168:171], v[16:19]
s_add_u32 s48, s90, 74240
v_exp_f32 v55, v55
v_mfma_f32_16x16x32_bf16 v[24:27], a[128:131], v[184:187], v[144:147]
buffer_store_dwordx4 v[108:111], v248, s[20:23], s48 offen sc0 sc1
v_mfma_f32_16x16x32_bf16 v[24:27], a[132:135], v[188:191], v[24:27]
v_exp_f32 v56, v56
v_mfma_f32_16x16x32_bf16 v[24:27], a[136:139], v[192:195], v[24:27]
v_cvt_pk_bf16_f32 v95, v54, v55
v_mfma_f32_16x16x32_bf16 v[24:27], a[140:143], v[196:199], v[24:27]
v_exp_f32 v57, v57
v_mfma_f32_16x16x32_bf16 v[32:35], a[140:143], v[212:215], v[148:151]
ds_read_b128 a[140:143], v219 offset:8192
v_cvt_pk_bf16_f32 v96, v56, v57
v_mfma_f32_16x16x32_bf16 v[32:35], a[136:139], v[208:211], v[32:35]
s_add_u32 s48, s90, 148480
v_exp_f32 v58, v58
v_mfma_f32_16x16x32_bf16 v[32:35], a[132:135], v[204:207], v[32:35]
buffer_store_dwordx4 v[112:115], v248, s[20:23], s48 offen sc0 sc1
v_mfma_f32_16x16x32_bf16 v[32:35], a[128:131], v[200:203], v[32:35]
ds_read_b128 a[136:139], v218 offset:8192
ds_read_b128 a[132:135], v217 offset:8192
v_mfma_f32_16x16x32_bf16 a[16:19], a[176:179], v[72:75], a[16:19]
v_exp_f32 v59, v59
v_mfma_f32_16x16x32_bf16 a[48:51], a[176:179], v[76:79], a[48:51]
ds_read_b128 a[128:131], v216 offset:8192
v_cvt_pk_bf16_f32 v97, v58, v59
v_mfma_f32_16x16x32_bf16 a[80:83], a[176:179], v[80:83], a[80:83]
s_add_u32 s48, s90, 222720
v_exp_f32 v60, v60
v_mfma_f32_16x16x32_bf16 a[112:115], a[176:179], v[84:87], a[112:115]
buffer_store_dwordx4 v[116:119], v248, s[20:23], s48 offen sc0 sc1
v_mfma_f32_16x16x32_bf16 a[116:119], a[180:183], v[84:87], a[116:119]
v_exp_f32 v61, v61
v_mfma_f32_16x16x32_bf16 a[84:87], a[180:183], v[80:83], a[84:87]
ds_read_b64_tr_b16 a[176:177], v224 offset:57344
ds_read_b64_tr_b16 a[178:179], v224 offset:61440
v_mfma_f32_16x16x32_bf16 a[52:55], a[180:183], v[76:79], a[52:55]
v_exp_f32 v62, v62
v_mfma_f32_16x16x32_bf16 a[20:23], a[180:183], v[72:75], a[20:23]
ds_read_b64_tr_b16 a[180:181], v225 offset:57344
ds_read_b64_tr_b16 a[182:183], v225 offset:61440
v_mfma_f32_16x16x32_bf16 a[24:27], a[184:187], v[72:75], a[24:27]
s_add_u32 s48, s90, 296960
buffer_store_dwordx4 v[120:123], v248, s[20:23], s48 offen sc0 sc1
v_mfma_f32_16x16x32_bf16 a[56:59], a[184:187], v[76:79], a[56:59]
v_exp_f32 v63, v63
v_mfma_f32_16x16x32_bf16 a[88:91], a[184:187], v[80:83], a[88:91]
v_cvt_pk_bf16_f32 v98, v60, v61
v_cvt_pk_bf16_f32 v99, v62, v63
v_mfma_f32_16x16x32_bf16 a[120:123], a[184:187], v[84:87], a[120:123]
v_exp_f32 v64, v64
v_mfma_f32_16x16x32_bf16 a[124:127], a[188:191], v[84:87], a[124:127]
ds_read_b64_tr_b16 a[184:185], v226 offset:57344
ds_read_b64_tr_b16 a[186:187], v226 offset:61440
v_mfma_f32_16x16x32_bf16 a[92:95], a[188:191], v[80:83], a[92:95]
s_add_u32 s48, s90, 371200
v_exp_f32 v65, v65
v_mfma_f32_16x16x32_bf16 a[60:63], a[188:191], v[76:79], a[60:63]
buffer_store_dwordx4 v[124:127], v248, s[20:23], s48 offen sc0 sc1
v_mfma_f32_16x16x32_bf16 a[28:31], a[188:191], v[72:75], a[28:31]
v_exp_f32 v66, v66
v_smfmac_f32_16x16x64_bf16 a[252:255], a[208:211], v[80:87], v235
ds_read_b64_tr_b16 a[188:189], v227 offset:57344
ds_read_b64_tr_b16 a[190:191], v227 offset:61440
v_mfma_f32_16x16x32_bf16 v[12:15], a[144:147], v[152:155], v[136:139]
v_exp_f32 v67, v67
v_mfma_f32_16x16x32_bf16 v[12:15], a[148:151], v[156:159], v[12:15]
v_cvt_pk_bf16_f32 v100, v64, v65
v_cvt_pk_bf16_f32 v101, v66, v67
v_mfma_f32_16x16x32_bf16 v[12:15], a[152:155], v[160:163], v[12:15]
s_add_u32 s48, s90, 445440
buffer_store_dwordx4 v[128:131], v248, s[20:23], s48 offen sc0 sc1
v_mfma_f32_16x16x32_bf16 v[12:15], a[156:159], v[164:167], v[12:15]
v_exp_f32 v68, v68
v_mfma_f32_16x16x32_bf16 v[20:23], a[156:159], v[180:183], v[140:143]
ds_write_b32 v6, v5
v_mfma_f32_16x16x32_bf16 v[20:23], a[152:155], v[176:179], v[20:23]
v_exp_f32 v69, v69
v_mfma_f32_16x16x32_bf16 v[20:23], a[148:151], v[172:175], v[20:23]
v_cvt_pk_bf16_f32 v102, v68, v69
v_mfma_f32_16x16x32_bf16 v[20:23], a[144:147], v[168:171], v[20:23]
s_add_u32 s48, s90, 519680
v_exp_f32 v70, v70
v_mfma_f32_16x16x32_bf16 v[28:31], a[144:147], v[184:187], v[144:147]
buffer_store_dwordx4 v[132:135], v248, s[20:23], s48 offen sc0 sc1
v_mfma_f32_16x16x32_bf16 v[28:31], a[148:151], v[188:191], v[28:31]
v_exp_f32 v71, v71
v_mfma_f32_16x16x32_bf16 v[28:31], a[152:155], v[192:195], v[28:31]
v_cvt_pk_bf16_f32 v103, v70, v71
v_mfma_f32_16x16x32_bf16 v[28:31], a[156:159], v[196:199], v[28:31]
v_mfma_f32_16x16x32_bf16 v[36:39], a[156:159], v[212:215], v[148:151]
ds_read_b128 a[156:159], v219 offset:12288
v_mfma_f32_16x16x32_bf16 v[36:39], a[152:155], v[208:211], v[36:39]
ds_read_b128 a[152:155], v218 offset:12288
v_mfma_f32_16x16x32_bf16 v[36:39], a[148:151], v[204:207], v[36:39]
ds_read_b128 a[148:151], v217 offset:12288
v_mfma_f32_16x16x32_bf16 v[36:39], a[144:147], v[200:203], v[36:39]
ds_read_b128 a[144:147], v216 offset:12288
v_mfma_f32_16x16x32_bf16 a[0:3], a[160:163], v[88:91], a[0:3]
v_exp_f32 v8, v8
v_mfma_f32_16x16x32_bf16 a[32:35], a[160:163], v[92:95], a[32:35]
v_exp_f32 v9, v9
v_mfma_f32_16x16x32_bf16 a[64:67], a[160:163], v[96:99], a[64:67]
v_cvt_pk_bf16_f32 v72, v8, v9
v_mfma_f32_16x16x32_bf16 a[96:99], a[160:163], v[100:103], a[96:99]
v_exp_f32 v10, v10
v_mfma_f32_16x16x32_bf16 a[100:103], a[164:167], v[100:103], a[100:103]
v_mfma_f32_16x16x32_bf16 a[68:71], a[164:167], v[96:99], a[68:71]
v_exp_f32 v11, v11
s_waitcnt vmcnt(13) lgkmcnt(0)
s_barrier
v_mfma_f32_16x16x32_bf16 a[36:39], a[164:167], v[92:95], a[36:39]
ds_read_b64_tr_b16 a[160:161], v220 offset:0
ds_read_b64_tr_b16 a[162:163], v220 offset:4096
v_mfma_f32_16x16x32_bf16 a[4:7], a[164:167], v[88:91], a[4:7]
s_add_u32 m0, s37, 98304
v_exp_f32 v12, v12
v_mfma_f32_16x16x32_bf16 a[8:11], a[168:171], v[88:91], a[8:11]
buffer_load_dwordx4 v232, s[12:15], s39 offen offset:0 lds
v_mfma_f32_16x16x32_bf16 a[40:43], a[168:171], v[92:95], a[40:43]
v_exp_f32 v13, v13
v_mfma_f32_16x16x32_bf16 a[72:75], a[168:171], v[96:99], a[72:75]
ds_read_b64_tr_b16 a[164:165], v221 offset:0
ds_read_b64_tr_b16 a[166:167], v221 offset:4096
v_mfma_f32_16x16x32_bf16 a[104:107], a[168:171], v[100:103], a[104:107]
v_exp_f32 v14, v14
v_mfma_f32_16x16x32_bf16 a[108:111], a[172:175], v[100:103], a[108:111]
ds_read_b64_tr_b16 a[168:169], v222 offset:0
ds_read_b64_tr_b16 a[170:171], v222 offset:4096
v_mfma_f32_16x16x32_bf16 a[76:79], a[172:175], v[96:99], a[76:79]
v_exp_f32 v15, v15
v_mfma_f32_16x16x32_bf16 a[44:47], a[172:175], v[92:95], a[44:47]
v_cvt_pk_bf16_f32 v73, v10, v11
v_cvt_pk_bf16_f32 v74, v12, v13
v_mfma_f32_16x16x32_bf16 a[12:15], a[172:175], v[88:91], a[12:15]
v_exp_f32 v16, v16
v_smfmac_f32_16x16x64_bf16 a[248:251], a[208:211], v[88:95], v235
buffer_load_dwordx4 v233, s[12:15], s39 offen offset:1024 lds
v_mfma_f32_16x16x32_bf16 v[40:43], a[128:131], v[152:155], v[136:139]
v_exp_f32 v17, v17
v_mfma_f32_16x16x32_bf16 v[40:43], a[132:135], v[156:159], v[40:43]
ds_read_b64_tr_b16 a[172:173], v223 offset:0
ds_read_b64_tr_b16 a[174:175], v223 offset:4096
v_mfma_f32_16x16x32_bf16 v[40:43], a[136:139], v[160:163], v[40:43]
v_exp_f32 v18, v18
v_mfma_f32_16x16x32_bf16 v[40:43], a[140:143], v[164:167], v[40:43]
v_cvt_pk_bf16_f32 v75, v14, v15
v_cvt_pk_bf16_f32 v76, v16, v17
v_mfma_f32_16x16x32_bf16 v[48:51], a[140:143], v[180:183], v[140:143]
v_exp_f32 v19, v19
v_mfma_f32_16x16x32_bf16 v[48:51], a[136:139], v[176:179], v[48:51]
v_cvt_pk_bf16_f32 v77, v18, v19
v_mfma_f32_16x16x32_bf16 v[48:51], a[132:135], v[172:175], v[48:51]
v_exp_f32 v20, v20
v_mfma_f32_16x16x32_bf16 v[48:51], a[128:131], v[168:171], v[48:51]
v_mfma_f32_16x16x32_bf16 v[56:59], a[128:131], v[184:187], v[144:147]
v_exp_f32 v21, v21
v_mfma_f32_16x16x32_bf16 v[56:59], a[132:135], v[188:191], v[56:59]
buffer_load_dwordx4 v232, s[12:15], s39 offen offset:2048 lds
v_mfma_f32_16x16x32_bf16 v[56:59], a[136:139], v[192:195], v[56:59]
v_exp_f32 v22, v22
v_mfma_f32_16x16x32_bf16 v[56:59], a[140:143], v[196:199], v[56:59]
v_cvt_pk_bf16_f32 v78, v20, v21
v_mfma_f32_16x16x32_bf16 v[64:67], a[140:143], v[212:215], v[148:151]
v_exp_f32 v23, v23
v_mfma_f32_16x16x32_bf16 v[64:67], a[136:139], v[208:211], v[64:67]
ds_read_b128 a[140:143], v219 offset:49152
ds_read_b128 a[136:139], v218 offset:49152
v_mfma_f32_16x16x32_bf16 v[64:67], a[132:135], v[204:207], v[64:67]
v_exp_f32 v24, v24
v_mfma_f32_16x16x32_bf16 v[64:67], a[128:131], v[200:203], v[64:67]
v_exp_f32 v25, v25
v_mfma_f32_16x16x32_bf16 a[16:19], a[176:179], v[88:91], a[16:19]
ds_read_b128 a[132:135], v217 offset:49152
ds_read_b128 a[128:131], v216 offset:49152
v_mfma_f32_16x16x32_bf16 a[48:51], a[176:179], v[92:95], a[48:51]
v_exp_f32 v26, v26
v_mfma_f32_16x16x32_bf16 a[80:83], a[176:179], v[96:99], a[80:83]
buffer_load_dwordx4 v233, s[12:15], s39 offen offset:3072 lds
v_mfma_f32_16x16x32_bf16 a[112:115], a[176:179], v[100:103], a[112:115]
v_exp_f32 v27, v27
v_mfma_f32_16x16x32_bf16 a[116:119], a[180:183], v[100:103], a[116:119]
ds_read_b64_tr_b16 a[176:177], v224 offset:0
ds_read_b64_tr_b16 a[178:179], v224 offset:4096
v_mfma_f32_16x16x32_bf16 a[84:87], a[180:183], v[96:99], a[84:87]
v_exp_f32 v28, v28
v_mfma_f32_16x16x32_bf16 a[52:55], a[180:183], v[92:95], a[52:55]
v_cvt_pk_bf16_f32 v79, v22, v23
v_cvt_pk_bf16_f32 v80, v24, v25
v_mfma_f32_16x16x32_bf16 a[20:23], a[180:183], v[88:91], a[20:23]
v_exp_f32 v29, v29
v_mfma_f32_16x16x32_bf16 a[24:27], a[184:187], v[88:91], a[24:27]
ds_read_b64_tr_b16 a[180:181], v225 offset:0
ds_read_b64_tr_b16 a[182:183], v225 offset:4096
v_mfma_f32_16x16x32_bf16 a[56:59], a[184:187], v[92:95], a[56:59]
v_exp_f32 v30, v30
v_mfma_f32_16x16x32_bf16 a[88:91], a[184:187], v[96:99], a[88:91]
v_cvt_pk_bf16_f32 v81, v26, v27
v_cvt_pk_bf16_f32 v82, v28, v29
v_mfma_f32_16x16x32_bf16 a[120:123], a[184:187], v[100:103], a[120:123]
s_add_u32 s39, s39, 16384
v_exp_f32 v31, v31
v_mfma_f32_16x16x32_bf16 a[124:127], a[188:191], v[100:103], a[124:127]
s_add_u32 m0, s37, 16384
ds_read_b64_tr_b16 a[184:185], v226 offset:0
ds_read_b64_tr_b16 a[186:187], v226 offset:4096
v_mfma_f32_16x16x32_bf16 a[92:95], a[188:191], v[96:99], a[92:95]
v_exp_f32 v32, v32
v_mfma_f32_16x16x32_bf16 a[60:63], a[188:191], v[92:95], a[60:63]
buffer_load_dwordx4 v228, s[8:11], s38 offen offset:0 lds
v_mfma_f32_16x16x32_bf16 a[28:31], a[188:191], v[88:91], a[28:31]
v_exp_f32 v33, v33
v_smfmac_f32_16x16x64_bf16 a[252:255], a[208:211], v[96:103], v235
ds_read_b64_tr_b16 a[188:189], v227 offset:0
ds_read_b64_tr_b16 a[190:191], v227 offset:4096
v_mfma_f32_16x16x32_bf16 v[44:47], a[144:147], v[152:155], v[136:139]
v_exp_f32 v34, v34
v_mfma_f32_16x16x32_bf16 v[44:47], a[148:151], v[156:159], v[44:47]
v_cvt_pk_bf16_f32 v83, v30, v31
v_cvt_pk_bf16_f32 v84, v32, v33
v_mfma_f32_16x16x32_bf16 v[44:47], a[152:155], v[160:163], v[44:47]
v_exp_f32 v35, v35
v_mfma_f32_16x16x32_bf16 v[44:47], a[156:159], v[164:167], v[44:47]
buffer_load_dwordx4 v229, s[8:11], s38 offen offset:1024 lds
v_mfma_f32_16x16x32_bf16 v[52:55], a[156:159], v[180:183], v[140:143]
v_exp_f32 v36, v36
v_mfma_f32_16x16x32_bf16 v[52:55], a[152:155], v[176:179], v[52:55]
v_cvt_pk_bf16_f32 v85, v34, v35
v_mfma_f32_16x16x32_bf16 v[52:55], a[148:151], v[172:175], v[52:55]
v_exp_f32 v37, v37
v_mfma_f32_16x16x32_bf16 v[52:55], a[144:147], v[168:171], v[52:55]
v_cvt_pk_bf16_f32 v86, v36, v37
v_mfma_f32_16x16x32_bf16 v[60:63], a[144:147], v[184:187], v[144:147]
v_exp_f32 v38, v38
v_mfma_f32_16x16x32_bf16 v[60:63], a[148:151], v[188:191], v[60:63]
v_mfma_f32_16x16x32_bf16 v[60:63], a[152:155], v[192:195], v[60:63]
v_exp_f32 v39, v39
v_mfma_f32_16x16x32_bf16 v[60:63], a[156:159], v[196:199], v[60:63]
v_cvt_pk_bf16_f32 v87, v38, v39
v_mfma_f32_16x16x32_bf16 v[68:71], a[156:159], v[212:215], v[148:151]
ds_read_b128 a[156:159], v219 offset:53248
v_mfma_f32_16x16x32_bf16 v[68:71], a[152:155], v[208:211], v[68:71]
ds_read_b128 a[152:155], v218 offset:53248
v_mfma_f32_16x16x32_bf16 v[68:71], a[148:151], v[204:207], v[68:71]
ds_read_b128 a[148:151], v217 offset:53248
v_mfma_f32_16x16x32_bf16 v[68:71], a[144:147], v[200:203], v[68:71]
s_waitcnt lgkmcnt(3)
ds_read_b128 a[144:147], v216 offset:53248
s_waitcnt lgkmcnt(4)
s_branch K_B5
K_PUB:
s_mov_b32 s78, 0x4000
v_lshlrev_b32 v251, 7, v3
s_mov_b32 s42, 0x2000
s_mov_b32 s43, 0
s_cmp_lg_u32 s32, 0
s_cbranch_scc1 K_B4
v_mov_b32 v244, 1
s_and_b32 s46, s52, 15
s_lshl_b32 s46, s46, 7
s_add_u32 s46, s46, 0x272000
s_mov_b64 exec, 1
buffer_atomic_add v244, v234, s[20:23], s46 offen sc1
s_mov_b64 exec, -1
s_branch K_B4
K_RANK:
s_mov_b32 s46, 2
K_RANK1:
v_cmp_lt_u32 vcc, s92, v255
s_bcnt1_i32_b64 s48, vcc
s_cmp_lt_u32 s48, 8
s_cbranch_scc0 K_RANK2
v_mov_b32 v246, 0
v_cmp_lt_u32 vcc, s92, v104
v_addc_co_u32 v246, vcc, 0, v246, vcc
v_cmp_lt_u32 vcc, s92, v105
v_addc_co_u32 v246, vcc, 0, v246, vcc
v_cmp_lt_u32 vcc, s92, v106
v_addc_co_u32 v246, vcc, 0, v246, vcc
v_cmp_lt_u32 vcc, s92, v107
v_addc_co_u32 v246, vcc, 0, v246, vcc
v_cmp_lt_u32 vcc, s92, v108
v_addc_co_u32 v246, vcc, 0, v246, vcc
v_cmp_lt_u32 vcc, s92, v109
v_addc_co_u32 v246, vcc, 0, v246, vcc
v_cmp_lt_u32 vcc, s92, v110
v_addc_co_u32 v246, vcc, 0, v246, vcc
v_cmp_lt_u32 vcc, s92, v111
v_addc_co_u32 v246, vcc, 0, v246, vcc
v_cmp_lt_u32 vcc, s92, v112
v_addc_co_u32 v246, vcc, 0, v246, vcc
v_cmp_lt_u32 vcc, s92, v113
v_addc_co_u32 v246, vcc, 0, v246, vcc
v_cmp_lt_u32 vcc, s92, v114
v_addc_co_u32 v246, vcc, 0, v246, vcc
v_cmp_lt_u32 vcc, s92, v115
v_addc_co_u32 v246, vcc, 0, v246, vcc
v_cmp_lt_u32 vcc, s92, v116
v_addc_co_u32 v246, vcc, 0, v246, vcc
v_cmp_lt_u32 vcc, s92, v117
v_addc_co_u32 v246, vcc, 0, v246, vcc
v_cmp_lt_u32 vcc, s92, v118
v_addc_co_u32 v246, vcc, 0, v246, vcc
v_cmp_lt_u32 vcc, s92, v119
v_addc_co_u32 v246, vcc, 0, v246, vcc
v_cmp_lt_u32 vcc, s92, v120
v_addc_co_u32 v246, vcc, 0, v246, vcc
v_cmp_lt_u32 vcc, s92, v121
v_addc_co_u32 v246, vcc, 0, v246, vcc
v_cmp_lt_u32 vcc, s92, v122
v_addc_co_u32 v246, vcc, 0, v246, vcc
v_cmp_lt_u32 vcc, s92, v123
v_addc_co_u32 v246, vcc, 0, v246, vcc
v_cmp_lt_u32 vcc, s92, v124
v_addc_co_u32 v246, vcc, 0, v246, vcc
v_cmp_lt_u32 vcc, s92, v125
v_addc_co_u32 v246, vcc, 0, v246, vcc
v_cmp_lt_u32 vcc, s92, v126
v_addc_co_u32 v246, vcc, 0, v246, vcc
v_cmp_lt_u32 vcc, s92, v127
v_addc_co_u32 v246, vcc, 0, v246, vcc
v_cmp_lt_u32 vcc, s92, v128
v_addc_co_u32 v246, vcc, 0, v246, vcc
v_cmp_lt_u32 vcc, s92, v129
v_addc_co_u32 v246, vcc, 0, v246, vcc
v_cmp_lt_u32 vcc, s92, v130
v_addc_co_u32 v246, vcc, 0, v246, vcc
v_cmp_lt_u32 vcc, s92, v131
v_addc_co_u32 v246, vcc, 0, v246, vcc
v_cmp_lt_u32 vcc, s92, v132
v_addc_co_u32 v246, vcc, 0, v246, vcc
v_cmp_lt_u32 vcc, s92, v133
v_addc_co_u32 v246, vcc, 0, v246, vcc
v_cmp_lt_u32 vcc, s92, v134
v_addc_co_u32 v246, vcc, 0, v246, vcc
v_cmp_lt_u32 vcc, s92, v135
v_addc_co_u32 v246, vcc, 0, v246, vcc
s_mov_b32 s48, 0
v_cmp_lt_u32 vcc, 0, v246
s_bcnt1_i32_b64 s47, vcc
s_add_u32 s48, s48, s47
v_cmp_lt_u32 vcc, 1, v246
s_bcnt1_i32_b64 s47, vcc
s_add_u32 s48, s48, s47
v_cmp_lt_u32 vcc, 2, v246
s_bcnt1_i32_b64 s47, vcc
s_add_u32 s48, s48, s47
v_cmp_lt_u32 vcc, 3, v246
s_bcnt1_i32_b64 s47, vcc
s_add_u32 s48, s48, s47
v_cmp_lt_u32 vcc, 4, v246
s_bcnt1_i32_b64 s47, vcc
s_add_u32 s48, s48, s47
v_cmp_lt_u32 vcc, 5, v246
s_bcnt1_i32_b64 s47, vcc
s_add_u32 s48, s48, s47
v_cmp_lt_u32 vcc, 6, v246
s_bcnt1_i32_b64 s47, vcc
s_add_u32 s48, s48, s47
v_cmp_lt_u32 vcc, 7, v246
s_bcnt1_i32_b64 s47, vcc
s_add_u32 s48, s48, s47
s_cmp_lt_u32 s48, 8
s_cbranch_scc0 K_RANK2
s_and_b32 s47, s92, 0xffff
s_sub_u32 s47, 2048, s47
s_ashr_i32 s94, s92, 31
s_not_b32 s94, s94
s_or_b32 s94, s94, 0x80000000
s_xor_b32 s94, s94, s92
s_and_b32 s94, s94, 0xffff0000
v_mov_b32 v247, s94
v_mul_f32 v247, 0xbfb8aa3b, v247
v_exp_f32 v247, v247
s_nop 0
v_add_f32 v247, 1.0, v247
v_rcp_f32 v247, v247
s_nop 0
v_cvt_pk_bf16_f32 v247, v247, v247
v_lshlrev_b32 v247, 16, v247
v_or_b32 v247, 1, v247
v_mov_b32 v246, s47
s_lshl_b32 s48, s48, 3
s_add_u32 s48, s48, 0x270000
s_mov_b64 exec, 1
buffer_store_dword v246, v234, s[20:23], s48 offen offset:4 sc0 sc1
buffer_store_dword v247, v234, s[20:23], s48 offen offset:68 sc0 sc1
s_mov_b64 exec, -1
K_RANK2:
s_mov_b32 s92, s93
s_sub_u32 s46, s46, 1
s_cmp_lg_u32 s46, 0
s_cbranch_scc1 K_RANK1
s_branch K_RANKED
K_CODE_END:
K_FB:
s_mov_b32 s41, 1
s_waitcnt vmcnt(0) lgkmcnt(0)
s_barrier
v_mov_b32 v136, 0xff800000
v_mov_b32 v140, 0xff800000
v_mov_b32 v144, 0xff800000
v_mov_b32 v148, 0xff800000
s_mov_b32 s38, 0
s_mov_b32 s40, 32
K_FBLOOP:
s_add_u32 m0, s37, 0
s_nop 0
buffer_load_dwordx4 v228, s[8:11], s38 offen offset:0 lds
buffer_load_dwordx4 v229, s[8:11], s38 offen offset:1024 lds
buffer_load_dwordx4 v230, s[8:11], s38 offen offset:2048 lds
buffer_load_dwordx4 v231, s[8:11], s38 offen offset:3072 lds
s_add_u32 s38, s38, 16384
s_waitcnt vmcnt(0)
s_barrier
ds_read_b128 a[128:131], v216 offset:0
ds_read_b128 a[132:135], v217 offset:0
ds_read_b128 a[136:139], v218 offset:0
ds_read_b128 a[140:143], v219 offset:0
ds_read_b128 a[144:147], v216 offset:4096
ds_read_b128 a[148:151], v217 offset:4096
ds_read_b128 a[152:155], v218 offset:4096
ds_read_b128 a[156:159], v219 offset:4096
s_waitcnt lgkmcnt(0)
v_mfma_f32_16x16x32_bf16 v[8:11], a[128:131], v[152:155], 0
v_mfma_f32_16x16x32_bf16 v[8:11], a[132:135], v[156:159], v[8:11]
v_mfma_f32_16x16x32_bf16 v[8:11], a[136:139], v[160:163], v[8:11]
v_mfma_f32_16x16x32_bf16 v[8:11], a[140:143], v[164:167], v[8:11]
v_mfma_f32_16x16x32_bf16 v[12:15], a[144:147], v[152:155], 0
v_mfma_f32_16x16x32_bf16 v[12:15], a[148:151], v[156:159], v[12:15]
v_mfma_f32_16x16x32_bf16 v[12:15], a[152:155], v[160:163], v[12:15]
v_mfma_f32_16x16x32_bf16 v[12:15], a[156:159], v[164:167], v[12:15]
v_mfma_f32_16x16x32_bf16 v[16:19], a[128:131], v[168:171], 0
v_mfma_f32_16x16x32_bf16 v[16:19], a[132:135], v[172:175], v[16:19]
v_mfma_f32_16x16x32_bf16 v[16:19], a[136:139], v[176:179], v[16:19]
v_mfma_f32_16x16x32_bf16 v[16:19], a[140:143], v[180:183], v[16:19]
v_mfma_f32_16x16x32_bf16 v[20:23], a[144:147], v[168:171], 0
v_mfma_f32_16x16x32_bf16 v[20:23], a[148:151], v[172:175], v[20:23]
v_mfma_f32_16x16x32_bf16 v[20:23], a[152:155], v[176:179], v[20:23]
v_mfma_f32_16x16x32_bf16 v[20:23], a[156:159], v[180:183], v[20:23]
v_mfma_f32_16x16x32_bf16 v[24:27], a[128:131], v[184:187], 0
v_mfma_f32_16x16x32_bf16 v[24:27], a[132:135], v[188:191], v[24:27]
v_mfma_f32_16x16x32_bf16 v[24:27], a[136:139], v[192:195], v[24:27]
v_mfma_f32_16x16x32_bf16 v[24:27], a[140:143], v[196:199], v[24:27]
v_mfma_f32_16x16x32_bf16 v[28:31], a[144:147], v[184:187], 0
v_mfma_f32_16x16x32_bf16 v[28:31], a[148:151], v[188:191], v[28:31]
v_mfma_f32_16x16x32_bf16 v[28:31], a[152:155], v[192:195], v[28:31]
v_mfma_f32_16x16x32_bf16 v[28:31], a[156:159], v[196:199], v[28:31]
v_mfma_f32_16x16x32_bf16 v[32:35], a[128:131], v[200:203], 0
v_mfma_f32_16x16x32_bf16 v[32:35], a[132:135], v[204:207], v[32:35]
v_mfma_f32_16x16x32_bf16 v[32:35], a[136:139], v[208:211], v[32:35]
v_mfma_f32_16x16x32_bf16 v[32:35], a[140:143], v[212:215], v[32:35]
v_mfma_f32_16x16x32_bf16 v[36:39], a[144:147], v[200:203], 0
v_mfma_f32_16x16x32_bf16 v[36:39], a[148:151], v[204:207], v[36:39]
v_mfma_f32_16x16x32_bf16 v[36:39], a[152:155], v[208:211], v[36:39]
v_mfma_f32_16x16x32_bf16 v[36:39], a[156:159], v[212:215], v[36:39]
s_nop 7
v_max3_f32 v136, v136, v8, v9
v_max3_f32 v136, v136, v10, v11
v_max3_f32 v136, v136, v12, v13
v_max3_f32 v136, v136, v14, v15
v_max3_f32 v140, v140, v16, v17
v_max3_f32 v140, v140, v18, v19
v_max3_f32 v140, v140, v20, v21
v_max3_f32 v140, v140, v22, v23
v_max3_f32 v144, v144, v24, v25
v_max3_f32 v144, v144, v26, v27
v_max3_f32 v144, v144, v28, v29
v_max3_f32 v144, v144, v30, v31
v_max3_f32 v148, v148, v32, v33
v_max3_f32 v148, v148, v34, v35
v_max3_f32 v148, v148, v36, v37
v_max3_f32 v148, v148, v38, v39
ds_read_b128 a[128:131], v216 offset:8192
ds_read_b128 a[132:135], v217 offset:8192
ds_read_b128 a[136:139], v218 offset:8192
ds_read_b128 a[140:143], v219 offset:8192
ds_read_b128 a[144:147], v216 offset:12288
ds_read_b128 a[148:151], v217 offset:12288
ds_read_b128 a[152:155], v218 offset:12288
ds_read_b128 a[156:159], v219 offset:12288
s_waitcnt lgkmcnt(0)
v_mfma_f32_16x16x32_bf16 v[8:11], a[128:131], v[152:155], 0
v_mfma_f32_16x16x32_bf16 v[8:11], a[132:135], v[156:159], v[8:11]
v_mfma_f32_16x16x32_bf16 v[8:11], a[136:139], v[160:163], v[8:11]
v_mfma_f32_16x16x32_bf16 v[8:11], a[140:143], v[164:167], v[8:11]
v_mfma_f32_16x16x32_bf16 v[12:15], a[144:147], v[152:155], 0
v_mfma_f32_16x16x32_bf16 v[12:15], a[148:151], v[156:159], v[12:15]
v_mfma_f32_16x16x32_bf16 v[12:15], a[152:155], v[160:163], v[12:15]
v_mfma_f32_16x16x32_bf16 v[12:15], a[156:159], v[164:167], v[12:15]
v_mfma_f32_16x16x32_bf16 v[16:19], a[128:131], v[168:171], 0
v_mfma_f32_16x16x32_bf16 v[16:19], a[132:135], v[172:175], v[16:19]
v_mfma_f32_16x16x32_bf16 v[16:19], a[136:139], v[176:179], v[16:19]
v_mfma_f32_16x16x32_bf16 v[16:19], a[140:143], v[180:183], v[16:19]
v_mfma_f32_16x16x32_bf16 v[20:23], a[144:147], v[168:171], 0
v_mfma_f32_16x16x32_bf16 v[20:23], a[148:151], v[172:175], v[20:23]
v_mfma_f32_16x16x32_bf16 v[20:23], a[152:155], v[176:179], v[20:23]
v_mfma_f32_16x16x32_bf16 v[20:23], a[156:159], v[180:183], v[20:23]
v_mfma_f32_16x16x32_bf16 v[24:27], a[128:131], v[184:187], 0
v_mfma_f32_16x16x32_bf16 v[24:27], a[132:135], v[188:191], v[24:27]
v_mfma_f32_16x16x32_bf16 v[24:27], a[136:139], v[192:195], v[24:27]
v_mfma_f32_16x16x32_bf16 v[24:27], a[140:143], v[196:199], v[24:27]
v_mfma_f32_16x16x32_bf16 v[28:31], a[144:147], v[184:187], 0
v_mfma_f32_16x16x32_bf16 v[28:31], a[148:151], v[188:191], v[28:31]
v_mfma_f32_16x16x32_bf16 v[28:31], a[152:155], v[192:195], v[28:31]
v_mfma_f32_16x16x32_bf16 v[28:31], a[156:159], v[196:199], v[28:31]
v_mfma_f32_16x16x32_bf16 v[32:35], a[128:131], v[200:203], 0
v_mfma_f32_16x16x32_bf16 v[32:35], a[132:135], v[204:207], v[32:35]
v_mfma_f32_16x16x32_bf16 v[32:35], a[136:139], v[208:211], v[32:35]
v_mfma_f32_16x16x32_bf16 v[32:35], a[140:143], v[212:215], v[32:35]
v_mfma_f32_16x16x32_bf16 v[36:39], a[144:147], v[200:203], 0
v_mfma_f32_16x16x32_bf16 v[36:39], a[148:151], v[204:207], v[36:39]
v_mfma_f32_16x16x32_bf16 v[36:39], a[152:155], v[208:211], v[36:39]
v_mfma_f32_16x16x32_bf16 v[36:39], a[156:159], v[212:215], v[36:39]
s_nop 7
v_max3_f32 v136, v136, v8, v9
v_max3_f32 v136, v136, v10, v11
v_max3_f32 v136, v136, v12, v13
v_max3_f32 v136, v136, v14, v15
v_max3_f32 v140, v140, v16, v17
v_max3_f32 v140, v140, v18, v19
v_max3_f32 v140, v140, v20, v21
v_max3_f32 v140, v140, v22, v23
v_max3_f32 v144, v144, v24, v25
v_max3_f32 v144, v144, v26, v27
v_max3_f32 v144, v144, v28, v29
v_max3_f32 v144, v144, v30, v31
v_max3_f32 v148, v148, v32, v33
v_max3_f32 v148, v148, v34, v35
v_max3_f32 v148, v148, v36, v37
v_max3_f32 v148, v148, v38, v39
s_barrier
s_sub_u32 s40, s40, 1
s_cmp_lg_u32 s40, 0
s_cbranch_scc1 K_FBLOOP
v_mov_b32 v137, v136
s_nop 1
v_permlane16_swap_b32 v136, v137
v_max_f32 v136, v136, v137
v_mov_b32 v137, v136
s_nop 1
v_permlane32_swap_b32 v136, v137
v_max_f32 v136, v136, v137
v_sub_f32 v139, 0, v136
v_sub_f32 v138, 0, v136
v_sub_f32 v137, 0, v136
v_sub_f32 v136, 0, v136
v_mov_b32 v141, v140
s_nop 1
v_permlane16_swap_b32 v140, v141
v_max_f32 v140, v140, v141
v_mov_b32 v141, v140
s_nop 1
v_permlane32_swap_b32 v140, v141
v_max_f32 v140, v140, v141
v_sub_f32 v143, 0, v140
v_sub_f32 v142, 0, v140
v_sub_f32 v141, 0, v140
v_sub_f32 v140, 0, v140
v_mov_b32 v145, v144
s_nop 1
v_permlane16_swap_b32 v144, v145
v_max_f32 v144, v144, v145
v_mov_b32 v145, v144
s_nop 1
v_permlane32_swap_b32 v144, v145
v_max_f32 v144, v144, v145
v_sub_f32 v147, 0, v144
v_sub_f32 v146, 0, v144
v_sub_f32 v145, 0, v144
v_sub_f32 v144, 0, v144
v_mov_b32 v149, v148
s_nop 1
v_permlane16_swap_b32 v148, v149
v_max_f32 v148, v148, v149
v_mov_b32 v149, v148
s_nop 1
v_permlane32_swap_b32 v148, v149
v_max_f32 v148, v148, v149
v_sub_f32 v151, 0, v148
v_sub_f32 v150, 0, v148
v_sub_f32 v149, 0, v148
v_sub_f32 v148, 0, v148
s_mov_b32 s38, 0
s_add_u32 m0, s37, 32768
s_nop 0
buffer_load_dwordx4 v228, s[8:11], s38 offen offset:0 lds
buffer_load_dwordx4 v229, s[8:11], s38 offen offset:1024 lds
buffer_load_dwordx4 v230, s[8:11], s38 offen offset:2048 lds
buffer_load_dwordx4 v231, s[8:11], s38 offen offset:3072 lds
s_add_u32 s38, s38, 16384
s_add_u32 m0, s37, 16384
s_nop 0
buffer_load_dwordx4 v228, s[8:11], s38 offen offset:0 lds
buffer_load_dwordx4 v229, s[8:11], s38 offen offset:1024 lds
buffer_load_dwordx4 v230, s[8:11], s38 offen offset:2048 lds
buffer_load_dwordx4 v231, s[8:11], s38 offen offset:3072 lds
s_add_u32 s38, s38, 16384
s_add_u32 m0, s37, 0
s_nop 0
buffer_load_dwordx4 v228, s[8:11], s38 offen offset:0 lds
buffer_load_dwordx4 v229, s[8:11], s38 offen offset:1024 lds
buffer_load_dwordx4 v230, s[8:11], s38 offen offset:2048 lds
buffer_load_dwordx4 v231, s[8:11], s38 offen offset:3072 lds
s_add_u32 s38, s38, 16384
s_mov_b32 s39, 0
s_add_u32 m0, s37, 98304
s_nop 0
buffer_load_dwordx4 v232, s[12:15], s39 offen offset:0 lds
buffer_load_dwordx4 v233, s[12:15], s39 offen offset:1024 lds
buffer_load_dwordx4 v232, s[12:15], s39 offen offset:2048 lds
buffer_load_dwordx4 v233, s[12:15], s39 offen offset:3072 lds
s_add_u32 s39, s39, 16384
s_add_u32 m0, s37, 114688
s_nop 0
buffer_load_dwordx4 v232, s[12:15], s39 offen offset:0 lds
buffer_load_dwordx4 v233, s[12:15], s39 offen offset:1024 lds
buffer_load_dwordx4 v232, s[12:15], s39 offen offset:2048 lds
buffer_load_dwordx4 v233, s[12:15], s39 offen offset:3072 lds
s_add_u32 s39, s39, 16384
s_mov_b32 s78, 0
s_mov_b32 s42, 0
s_mov_b32 s43, 0
s_mov_b32 s44, 0x100000
s_mov_b32 s74, 0x100
s_mov_b32 s97, 0
s_mov_b32 s40, 0
v_accvgpr_write_b32 a0, 0
v_accvgpr_write_b32 a1, 0
v_accvgpr_write_b32 a2, 0
v_accvgpr_write_b32 a3, 0
v_accvgpr_write_b32 a4, 0
v_accvgpr_write_b32 a5, 0
v_accvgpr_write_b32 a6, 0
v_accvgpr_write_b32 a7, 0
v_accvgpr_write_b32 a8, 0
v_accvgpr_write_b32 a9, 0
v_accvgpr_write_b32 a10, 0
v_accvgpr_write_b32 a11, 0
v_accvgpr_write_b32 a12, 0
v_accvgpr_write_b32 a13, 0
v_accvgpr_write_b32 a14, 0
v_accvgpr_write_b32 a15, 0
v_accvgpr_write_b32 a16, 0
v_accvgpr_write_b32 a17, 0
v_accvgpr_write_b32 a18, 0
v_accvgpr_write_b32 a19, 0
v_accvgpr_write_b32 a20, 0
v_accvgpr_write_b32 a21, 0
v_accvgpr_write_b32 a22, 0
v_accvgpr_write_b32 a23, 0
v_accvgpr_write_b32 a24, 0
v_accvgpr_write_b32 a25, 0
v_accvgpr_write_b32 a26, 0
v_accvgpr_write_b32 a27, 0
v_accvgpr_write_b32 a28, 0
v_accvgpr_write_b32 a29, 0
v_accvgpr_write_b32 a30, 0
v_accvgpr_write_b32 a31, 0
v_accvgpr_write_b32 a32, 0
v_accvgpr_write_b32 a33, 0
v_accvgpr_write_b32 a34, 0
v_accvgpr_write_b32 a35, 0
v_accvgpr_write_b32 a36, 0
v_accvgpr_write_b32 a37, 0
v_accvgpr_write_b32 a38, 0
v_accvgpr_write_b32 a39, 0
v_accvgpr_write_b32 a40, 0
v_accvgpr_write_b32 a41, 0
v_accvgpr_write_b32 a42, 0
v_accvgpr_write_b32 a43, 0
v_accvgpr_write_b32 a44, 0
v_accvgpr_write_b32 a45, 0
v_accvgpr_write_b32 a46, 0
v_accvgpr_write_b32 a47, 0
v_accvgpr_write_b32 a48, 0
v_accvgpr_write_b32 a49, 0
v_accvgpr_write_b32 a50, 0
v_accvgpr_write_b32 a51, 0
v_accvgpr_write_b32 a52, 0
v_accvgpr_write_b32 a53, 0
v_accvgpr_write_b32 a54, 0
v_accvgpr_write_b32 a55, 0
v_accvgpr_write_b32 a56, 0
v_accvgpr_write_b32 a57, 0
v_accvgpr_write_b32 a58, 0
v_accvgpr_write_b32 a59, 0
v_accvgpr_write_b32 a60, 0
v_accvgpr_write_b32 a61, 0
v_accvgpr_write_b32 a62, 0
v_accvgpr_write_b32 a63, 0
v_accvgpr_write_b32 a64, 0
v_accvgpr_write_b32 a65, 0
v_accvgpr_write_b32 a66, 0
v_accvgpr_write_b32 a67, 0
v_accvgpr_write_b32 a68, 0
v_accvgpr_write_b32 a69, 0
v_accvgpr_write_b32 a70, 0
v_accvgpr_write_b32 a71, 0
v_accvgpr_write_b32 a72, 0
v_accvgpr_write_b32 a73, 0
v_accvgpr_write_b32 a74, 0
v_accvgpr_write_b32 a75, 0
v_accvgpr_write_b32 a76, 0
v_accvgpr_write_b32 a77, 0
v_accvgpr_write_b32 a78, 0
v_accvgpr_write_b32 a79, 0
v_accvgpr_write_b32 a80, 0
v_accvgpr_write_b32 a81, 0
v_accvgpr_write_b32 a82, 0
v_accvgpr_write_b32 a83, 0
v_accvgpr_write_b32 a84, 0
v_accvgpr_write_b32 a85, 0
v_accvgpr_write_b32 a86, 0
v_accvgpr_write_b32 a87, 0
v_accvgpr_write_b32 a88, 0
v_accvgpr_write_b32 a89, 0
v_accvgpr_write_b32 a90, 0
v_accvgpr_write_b32 a91, 0
v_accvgpr_write_b32 a92, 0
v_accvgpr_write_b32 a93, 0
v_accvgpr_write_b32 a94, 0
v_accvgpr_write_b32 a95, 0
v_accvgpr_write_b32 a96, 0
v_accvgpr_write_b32 a97, 0
v_accvgpr_write_b32 a98, 0
v_accvgpr_write_b32 a99, 0
v_accvgpr_write_b32 a100, 0
v_accvgpr_write_b32 a101, 0
v_accvgpr_write_b32 a102, 0
v_accvgpr_write_b32 a103, 0
v_accvgpr_write_b32 a104, 0
v_accvgpr_write_b32 a105, 0
v_accvgpr_write_b32 a106, 0
v_accvgpr_write_b32 a107, 0
v_accvgpr_write_b32 a108, 0
v_accvgpr_write_b32 a109, 0
v_accvgpr_write_b32 a110, 0
v_accvgpr_write_b32 a111, 0
v_accvgpr_write_b32 a112, 0
v_accvgpr_write_b32 a113, 0
v_accvgpr_write_b32 a114, 0
v_accvgpr_write_b32 a115, 0
v_accvgpr_write_b32 a116, 0
v_accvgpr_write_b32 a117, 0
v_accvgpr_write_b32 a118, 0
v_accvgpr_write_b32 a119, 0
v_accvgpr_write_b32 a120, 0
v_accvgpr_write_b32 a121, 0
v_accvgpr_write_b32 a122, 0
v_accvgpr_write_b32 a123, 0
v_accvgpr_write_b32 a124, 0
v_accvgpr_write_b32 a125, 0
v_accvgpr_write_b32 a126, 0
v_accvgpr_write_b32 a127, 0
v_accvgpr_write_b32 a248, 0
v_accvgpr_write_b32 a249, 0
v_accvgpr_write_b32 a250, 0
v_accvgpr_write_b32 a251, 0
v_accvgpr_write_b32 a252, 0
v_accvgpr_write_b32 a253, 0
v_accvgpr_write_b32 a254, 0
v_accvgpr_write_b32 a255, 0
s_waitcnt vmcnt(0)
s_barrier
ds_read_b128 a[128:131], v216 offset:32768
ds_read_b128 a[132:135], v217 offset:32768
ds_read_b128 a[136:139], v218 offset:32768
ds_read_b128 a[140:143], v219 offset:32768
ds_read_b128 a[144:147], v216 offset:36864
ds_read_b128 a[148:151], v217 offset:36864
ds_read_b128 a[152:155], v218 offset:36864
ds_read_b128 a[156:159], v219 offset:36864
s_waitcnt lgkmcnt(0)
v_mfma_f32_16x16x32_bf16 v[8:11], a[128:131], v[152:155], 0
v_mfma_f32_16x16x32_bf16 v[8:11], a[132:135], v[156:159], v[8:11]
v_mfma_f32_16x16x32_bf16 v[8:11], a[136:139], v[160:163], v[8:11]
v_mfma_f32_16x16x32_bf16 v[8:11], a[140:143], v[164:167], v[8:11]
v_mfma_f32_16x16x32_bf16 v[12:15], a[144:147], v[152:155], 0
v_mfma_f32_16x16x32_bf16 v[12:15], a[148:151], v[156:159], v[12:15]
v_mfma_f32_16x16x32_bf16 v[12:15], a[152:155], v[160:163], v[12:15]
v_mfma_f32_16x16x32_bf16 v[12:15], a[156:159], v[164:167], v[12:15]
v_mfma_f32_16x16x32_bf16 v[16:19], a[128:131], v[168:171], 0
v_mfma_f32_16x16x32_bf16 v[16:19], a[132:135], v[172:175], v[16:19]
v_mfma_f32_16x16x32_bf16 v[16:19], a[136:139], v[176:179], v[16:19]
v_mfma_f32_16x16x32_bf16 v[16:19], a[140:143], v[180:183], v[16:19]
v_mfma_f32_16x16x32_bf16 v[20:23], a[144:147], v[168:171], 0
v_mfma_f32_16x16x32_bf16 v[20:23], a[148:151], v[172:175], v[20:23]
v_mfma_f32_16x16x32_bf16 v[20:23], a[152:155], v[176:179], v[20:23]
v_mfma_f32_16x16x32_bf16 v[20:23], a[156:159], v[180:183], v[20:23]
v_mfma_f32_16x16x32_bf16 v[24:27], a[128:131], v[184:187], 0
v_mfma_f32_16x16x32_bf16 v[24:27], a[132:135], v[188:191], v[24:27]
v_mfma_f32_16x16x32_bf16 v[24:27], a[136:139], v[192:195], v[24:27]
v_mfma_f32_16x16x32_bf16 v[24:27], a[140:143], v[196:199], v[24:27]
v_mfma_f32_16x16x32_bf16 v[28:31], a[144:147], v[184:187], 0
v_mfma_f32_16x16x32_bf16 v[28:31], a[148:151], v[188:191], v[28:31]
v_mfma_f32_16x16x32_bf16 v[28:31], a[152:155], v[192:195], v[28:31]
v_mfma_f32_16x16x32_bf16 v[28:31], a[156:159], v[196:199], v[28:31]
v_mfma_f32_16x16x32_bf16 v[32:35], a[128:131], v[200:203], 0
v_mfma_f32_16x16x32_bf16 v[32:35], a[132:135], v[204:207], v[32:35]
v_mfma_f32_16x16x32_bf16 v[32:35], a[136:139], v[208:211], v[32:35]
v_mfma_f32_16x16x32_bf16 v[32:35], a[140:143], v[212:215], v[32:35]
v_mfma_f32_16x16x32_bf16 v[36:39], a[144:147], v[200:203], 0
v_mfma_f32_16x16x32_bf16 v[36:39], a[148:151], v[204:207], v[36:39]
v_mfma_f32_16x16x32_bf16 v[36:39], a[152:155], v[208:211], v[36:39]
v_mfma_f32_16x16x32_bf16 v[36:39], a[156:159], v[212:215], v[36:39]
ds_read_b128 a[128:131], v216 offset:40960
ds_read_b128 a[132:135], v217 offset:40960
ds_read_b128 a[136:139], v218 offset:40960
ds_read_b128 a[140:143], v219 offset:40960
ds_read_b128 a[144:147], v216 offset:45056
ds_read_b128 a[148:151], v217 offset:45056
ds_read_b128 a[152:155], v218 offset:45056
ds_read_b128 a[156:159], v219 offset:45056
s_waitcnt lgkmcnt(0)
s_branch K_HAVEMAX
.section .rodata,"a"
.p2align 6
.amdhsa_kernel recurrent_scan__gqa_block_cached__moe_arch_mod__prompt_kernel
  .amdhsa_next_free_vgpr 512
  .amdhsa_next_free_sgpr 102
  .amdhsa_accum_offset 256
  .amdhsa_group_segment_fixed_size 0
  .amdhsa_kernarg_size 104
  .amdhsa_user_sgpr_count 2
  .amdhsa_user_sgpr_kernarg_segment_ptr 1
  .amdhsa_system_sgpr_workgroup_id_x 1
  .amdhsa_float_denorm_mode_32 3
.end_amdhsa_kernel
```

```asm
; @launch grid=(256,1,1) block=(256,1,1) lds=163840
.amdgcn_target "amdgcn-amd-amdhsa--gfx950"
.text
.globl recurrent_scan__gqa_block_cached__moe_arch_mod__prompt_kernel
.p2align 8
.type recurrent_scan__gqa_block_cached__moe_arch_mod__prompt_kernel,@function
recurrent_scan__gqa_block_cached__moe_arch_mod__prompt_kernel:
s_cmp_ge_u32 s2, 256
s_cbranch_scc1 K_END
s_getpc_b64 s[96:97]
v_lshlrev_b32 v7, 5, v0
global_load_dword a4, v7, s[96:97]
s_load_dwordx8 s[88:95], s[0:1], 0
s_load_dwordx2 s[86:87], s[0:1], 48
s_load_dwordx4 s[4:7], s[0:1], 88
v_and_b32 v1, 63, v0
v_lshrrev_b32 v5, 6, v0
s_bfe_u32 s35, s2, 0x20001
s_bfe_u32 s36, s2, 0x20003
v_readfirstlane_b32 s32, v5
s_lshl_b32 s33, s35, 2
s_add_u32 s33, s33, s36
s_and_b32 s34, s2, 1
s_lshl_b32 s34, s34, 3
s_lshr_b32 s46, s2, 5
s_add_u32 s34, s34, s46
s_lshl_b32 s46, s34, 7
s_lshl_b32 s47, s33, 3
s_add_u32 s3, s46, s47
v_lshrrev_b32 v8, 5, v0
v_add_u32 v8, s3, v8
v_and_b32 v9, 31, v0
v_mul_u32_u24 v11, 12, v9
v_mul_u32_u24 v10, 0x480, v8
v_add_u32 v10, v10, v11
v_lshrrev_b32 v5, 3, v1
v_and_b32 v6, 7, v1
v_xor_b32 v6, v6, v5
v_mul_u32_u24 v5, 0x480, v5
v_lshl_add_u32 v144, v6, 4, v5
v_add_u32 v145, 8192, v144
v_add_u32 v146, 18432, v144
v_add_u32 v147, 26624, v144
s_lshl_b32 s47, s32, 5
s_add_u32 s55, s46, s47
s_mul_i32 s43, s55, 1152
s_and_b32 s74, s34, 7
s_mul_i32 s74, s74, 1
s_mul_i32 s47, s36, 2
s_add_u32 s74, s74, s47
s_mul_i32 s47, s74, 57
s_lshr_b32 s47, s47, 9
s_mul_i32 s47, s47, 9
s_sub_u32 s74, s74, s47
s_movk_i32 s73, -1024
s_lshl_b32 s47, s74, 7
s_add_u32 s43, s43, s47
s_lshl_b32 s37, s32, 12
s_lshr_b32 s46, s35, 1
s_lshl_b32 s47, s46, 11
s_or_b32 s45, s37, s47
s_xor_b32 s85, s45, 2048
s_lshl_b32 s46, s46, 4
s_add_u32 s55, s55, s46
s_mov_b32 s26, 0x240000
s_mov_b32 s27, 0x00020000
s_waitcnt lgkmcnt(0)
s_mov_b32 s24, s88
s_and_b32 s25, s89, 0xffff
buffer_load_dwordx3 v[12:14], v10, s[24:27], 0 offen offset:0
buffer_load_dwordx3 v[16:18], v10, s[24:27], 0 offen offset:384
buffer_load_dwordx3 v[20:22], v10, s[24:27], 0 offen offset:768
s_mov_b32 s28, s86
s_and_b32 s29, s87, 0xffff
s_mov_b32 s30, 0x480
s_mov_b32 s31, 0x00020000
s_add_u32 m0, s45, 32768
s_nop 0
buffer_load_dwordx4 v144, s[24:27], s43 offen offset:0 lds
buffer_load_dwordx4 v145, s[24:27], s43 offen offset:1024 lds
s_add_u32 m0, s85, 32768
s_nop 0
buffer_load_dwordx4 v146, s[24:27], s43 offen offset:0 lds
buffer_load_dwordx4 v147, s[24:27], s43 offen offset:1024 lds
s_cmp_eq_u32 s74, 8
s_cselect_b32 s72, s73, 128
s_add_u32 s43, s43, s72
s_mov_b32 s16, s94
s_and_b32 s17, s95, 0xffff
s_mov_b32 s18, 0x480000
s_mov_b32 s19, 0x00020000
v_lshrrev_b32 v5, 5, v1
v_and_b32 v6, 31, v1
v_lshlrev_b32 v7, 1, v5
v_xor_b32 v6, v6, v7
v_lshlrev_b32 v6, 4, v6
v_lshl_add_u32 v136, v5, 13, v6
s_lshl_b32 s42, s33, 9
s_lshl_b32 s46, s32, 17
s_add_u32 s42, s42, s46
s_lshl_b32 s44, s32, 13
s_lshl_b32 s46, s74, 19
s_add_u32 s42, s42, s46
v_xor_b32 v137, 64, v136
v_add_u32 v137, 15360, v137
v_add_u32 v138, 30720, v136
v_xor_b32 v139, 64, v136
v_add_u32 v139, 46080, v139
v_xor_b32 v140, 128, v136
v_add_u32 v140, 65536, v140
v_xor_b32 v141, 192, v136
v_add_u32 v141, 80896, v141
v_xor_b32 v142, 128, v136
v_add_u32 v142, 96256, v142
v_xor_b32 v143, 192, v136
v_add_u32 v143, 111616, v143
s_add_u32 m0, s44, 0
s_nop 0
buffer_load_dwordx4 v136, s[16:19], s42 offen offset:0 lds
buffer_load_dwordx4 v137, s[16:19], s42 offen offset:1024 lds
buffer_load_dwordx4 v138, s[16:19], s42 offen offset:2048 lds
buffer_load_dwordx4 v139, s[16:19], s42 offen offset:3072 lds
s_add_u32 m0, s44, 4096
s_nop 0
buffer_load_dwordx4 v140, s[16:19], s42 offen offset:0 lds
s_load_dwordx2 s[68:69], s[0:1], 32
s_load_dwordx4 s[56:59], s[0:1], 56
s_load_dwordx4 s[64:67], s[0:1], 72
s_mov_b32 s100, 0
v_and_b32 v3, 15, v1
v_lshrrev_b32 v4, 4, v1
v_lshlrev_b32 v234, 4, v1
v_mov_b32 v255, 1
s_lshl_b32 s46, s33, 19
s_add_u32 s8, s90, s46
s_addc_u32 s9, s91, 0
s_and_b32 s9, s9, 0xffff
s_mov_b32 s10, 0x80000
s_mov_b32 s11, 0x00020000
s_add_u32 s12, s92, s46
s_addc_u32 s13, s93, 0
s_and_b32 s13, s13, 0xffff
s_mov_b32 s14, 0x80000
s_mov_b32 s15, 0x00020000
s_mov_b32 s20, s6
s_and_b32 s21, s7, 0xffff
s_mov_b32 s22, 0x4000000
s_mov_b32 s23, 0x00020000
v_bfe_u32 v248, v1, 2, 2
v_and_b32 v249, 3, v1
v_and_b32 v5, 1, v4
v_lshl_add_u32 v5, v5, 2, v248
s_lshl_b32 s46, s32, 1
v_xor_b32 v5, s46, v5
v_lshlrev_b32 v5, 5, v5
v_lshl_add_u32 v6, v4, 3, v248
v_lshl_add_u32 v5, v6, 9, v5
v_lshl_add_u32 v184, v249, 3, v5
v_xor_b32 v185, 32, v184
v_xor_b32 v186, 64, v184
v_xor_b32 v187, 96, v184
v_xor_b32 v188, 128, v184
v_xor_b32 v189, 160, v184
v_xor_b32 v190, 192, v184
v_xor_b32 v191, 224, v184
v_and_b32 v5, 7, v3
v_xor_b32 v5, v5, v4
v_lshlrev_b32 v5, 4, v5
v_lshl_add_u32 v5, v3, 7, v5
v_add_u32 v5, s37, v5
v_add_u32 v192, 0x8000, v5
v_xor_b32 v193, 64, v192
v_add_u32 v194, 0x18000, v184
v_add_u32 v195, 0x18000, v185
v_add_u32 v196, 0x18000, v186
v_add_u32 v197, 0x18000, v187
v_add_u32 v198, 0x18000, v188
v_add_u32 v199, 0x18000, v189
v_add_u32 v200, 0x18000, v190
v_add_u32 v201, 0x18000, v191
v_add_u32 v202, 0x18000, v192
v_add_u32 v203, 0x18000, v193
v_add_u32 v204, 0xc000, v184
v_add_u32 v205, 0xc000, v185
v_add_u32 v206, 0xc000, v186
v_add_u32 v207, 0xc000, v187
v_add_u32 v208, 0xc000, v188
v_add_u32 v209, 0xc000, v189
v_add_u32 v210, 0xc000, v190
v_add_u32 v211, 0xc000, v191
v_add_u32 v212, 0xc000, v192
v_add_u32 v213, 0xc000, v193
v_lshrrev_b32 v5, 1, v4
v_and_b32 v6, 7, v3
v_xor_b32 v5, v5, v6
v_lshlrev_b32 v5, 4, v5
v_lshl_add_u32 v5, v3, 7, v5
v_and_b32 v6, 1, v4
v_lshl_add_u32 v241, v6, 3, v5
s_lshl_b32 s83, s32, 11
s_add_u32 s83, s83, 155648
v_add_u32 v152, s83, v241
v_xor_b32 v153, 32, v152
v_xor_b32 v154, 64, v152
v_xor_b32 v155, 96, v152
v_bfe_u32 v5, v1, 1, 1
v_bfe_u32 v6, v1, 5, 1
v_cmp_eq_u32 vcc, v5, v6
v_mov_b32 v7, 0x3f803f80
v_and_b32 v5, 1, v1
v_cndmask_b32 v7, 0, v7, vcc
v_accvgpr_write_b32 a208, v7
v_accvgpr_write_b32 a209, v7
v_accvgpr_write_b32 a210, v7
v_accvgpr_write_b32 a211, v7
v_mul_u32_u24 v5, 0xaaaa, v5
v_add_u32 v235, 0x4444, v5
v_accvgpr_write_b32 a248, 0
v_accvgpr_write_b32 a249, 0
v_accvgpr_write_b32 a250, 0
v_accvgpr_write_b32 a251, 0
v_accvgpr_write_b32 a252, 0
v_accvgpr_write_b32 a253, 0
v_accvgpr_write_b32 a254, 0
v_accvgpr_write_b32 a255, 0
s_lshl_b32 s46, s34, 2
s_add_u32 s47, s46, s35
s_lshl_b32 s47, s47, 2
s_add_u32 s47, s47, s32
s_lshl_b32 s54, s47, 7
s_add_u32 s54, s54, 0x250000
s_add_u32 s47, s46, s36
s_lshl_b32 s47, s47, 2
s_add_u32 s47, s47, s32
s_lshl_b32 s47, s47, 7
s_add_u32 s47, s47, s35
s_lshl_b32 s47, s47, 2
s_add_u32 s38, s47, 0x280000
s_add_u32 s46, s46, s32
s_lshl_b32 s46, s46, 5
s_add_u32 s46, s46, s33
s_lshl_b32 s46, s46, 2
s_add_u32 s39, s46, 0x260000
s_lshl_b32 s46, s36, 3
s_add_u32 s46, s46, s54
s_add_u32 s47, s46, 4
v_lshl_add_u32 v60, v1, 7, s38
v_mov_b32 v61, 0
v_writelane_b32 v60, s46, 4
buffer_load_dwordx4 v141, s[16:19], s42 offen offset:1024 lds
v_writelane_b32 v60, s47, 5
v_writelane_b32 v60, s39, 6
s_lshl_b32 s46, s34, 2
s_add_u32 s46, s46, s35
s_lshl_b32 s46, s46, 3
s_add_u32 s46, s46, 0x270000
s_or_b32 s47, s36, s32
s_cselect_b32 s46, 0x7f000000, s46
v_writelane_b32 v60, s46, 7
s_add_u32 s46, s46, 4
v_writelane_b32 v60, s46, 8
s_lshl_b32 s47, s32, 8
s_or_b32 s47, s47, s2
s_lshl_b32 s46, s2, 7
s_add_u32 s46, s46, 0x272000
s_cmp_lt_u32 s47, 32
s_cselect_b32 s46, s46, 0x7f000000
v_writelane_b32 v60, s46, 9
s_getpc_b64 s[96:97]
PC_a:
s_sub_u32 s96, s96, PC_a-recurrent_scan__gqa_block_cached__moe_arch_mod__prompt_kernel
s_subb_u32 s97, s97, 0
s_lshr_b32 s46, s2, 3
s_lshl_b32 s46, s46, 2
s_add_u32 s46, s46, s32
s_min_u32 s46, s46, (K_CODE_END-recurrent_scan__gqa_block_cached__moe_arch_mod__prompt_kernel)>>10
s_lshl_b32 s46, s46, 10
v_lshlrev_b32 v7, 4, v1
buffer_load_dwordx4 v142, s[16:19], s42 offen offset:2048 lds
v_add_u32 v7, s46, v7
global_load_dwordx4 a[0:3], v7, s[96:97]
s_waitcnt lgkmcnt(0)
s_lshl_b32 s46, s32, 2
v_bfrev_b32 v5, v4
v_lshrrev_b32 v5, 30, v5
v_xor_b32 v5, s46, v5
v_xor_b32 v5, v5, v3
v_lshlrev_b32 v5, 4, v5
v_lshl_add_u32 v216, v3, 8, v5
v_xor_b32 v217, 64, v216
v_xor_b32 v218, 128, v216
v_xor_b32 v219, 192, v216
v_lshl_add_u32 v6, v4, 2, v248
v_and_b32 v5, 7, v6
v_lshlrev_b32 v5, 5, v5
v_lshl_add_u32 v5, v6, 8, v5
v_lshl_add_u32 v5, v249, 3, v5
v_add_u32 v220, 0x10000, v5
v_xor_b32 v221, 32, v220
v_xor_b32 v222, 64, v220
v_xor_b32 v223, 96, v220
v_xor_b32 v224, 128, v220
v_xor_b32 v225, 160, v220
buffer_load_dwordx4 v143, s[16:19], s42 offen offset:3072 lds
v_xor_b32 v226, 192, v220
v_xor_b32 v227, 224, v220
v_xor_b32 v5, v4, v3
v_lshlrev_b32 v5, 4, v5
v_lshl_add_u32 v5, v4, 8, v5
v_add_u32 v228, s37, v5
v_xor_b32 v229, 64, v228
v_xor_b32 v230, 128, v228
v_xor_b32 v231, 192, v228
v_lshlrev_b32 v5, 1, v4
v_xor_b32 v5, v5, v3
v_lshlrev_b32 v5, 4, v5
v_lshl_add_u32 v5, v4, 8, v5
v_add_u32 v232, s37, v5
v_xor_b32 v233, 128, v232
s_mov_b32 s41, 0
s_lshl_b32 s49, s32, 13
s_add_u32 s49, s49, 131072
s_lshl_b32 s3, s32, 10
s_lshl_b32 s53, s34, 4
s_add_u32 s53, s53, s33
s_lshl_b32 s53, s53, 2
s_add_u32 s53, s53, s32
s_lshl_b32 s53, s53, 14
s_add_u32 s53, s53, 0x400000
v_add_u32 v5, s46, v4
s_lshl_b32 s72, s72, 12
s_add_u32 s42, s42, s72
s_nop 0
buffer_load_dwordx3 v[24:26], v11, s[28:31], 0 offen offset:0
v_and_b32 v6, 7, v5
v_lshlrev_b32 v6, 1, v6
v_xor_b32 v6, v6, v3
v_mul_u32_u24 v5, 0x480, v5
v_lshl_add_u32 v236, v6, 4, v5
v_lshrrev_b32 v5, 3, v0
v_and_b32 v6, 6, v5
v_and_b32 v7, 7, v1
v_xor_b32 v6, v6, v7
v_mul_u32_u24 v5, 0x480, v5
v_lshl_add_u32 v237, v6, 4, v5
v_lshrrev_b32 v5, 2, v1
v_mul_u32_u24 v5, 0x2400, v5
v_lshl_add_u32 v238, v249, 4, v5
s_lshl_b32 s47, s36, 8
s_mul_i32 s84, s35, 1179648
s_add_u32 s84, s84, s47
s_mul_i32 s75, s33, 294912
s_add_u32 s51, s75, s47
s_add_u32 s75, s75, 1024
s_mov_b64 s[86:87], s[68:69]
s_mov_b64 s[88:89], s[56:57]
s_mov_b64 s[90:91], s[58:59]
s_mov_b32 s68, s66
s_and_b32 s69, s67, 0xffff
s_mov_b32 s70, 0x240000
s_mov_b32 s71, 0x00020000
s_mov_b32 s64, s64
s_and_b32 s65, s65, 0xffff
s_mov_b32 s66, 0x510000
s_mov_b32 s67, 0x00020000
s_mov_b32 s56, s88
s_and_b32 s57, s89, 0xffff
s_mov_b32 s58, 0x510000
s_mov_b32 s59, 0x00020000
s_mov_b32 s60, s90
s_and_b32 s61, s91, 0xffff
s_mov_b32 s62, 0x510000
s_mov_b32 s63, 0x00020000
s_mov_b32 s52, 0
s_and_b32 s82, s35, 1
s_lshl_b32 s82, s82, 7
s_mul_i32 s80, s55, 1152
s_lshl_b32 s46, s36, 5
s_add_u32 s81, s80, s46
s_add_u32 s81, s81, 1024
s_add_u32 s80, s80, s47
s_add_u32 s80, s80, s82
s_bitcmp1_b32 s35, 0
s_cselect_b32 s81, 0x7f000000, s81
v_mov_b32 v239, v144
buffer_load_dwordx3 v[28:30], v11, s[28:31], 0 offen offset:384
v_mul_u32_u24 v5, 0x480, v3
v_lshl_add_u32 v240, v4, 3, v5
v_min_u32 v243, 35, v1
v_lshlrev_b32 v243, 7, v243
v_lshlrev_b32 v251, 3, v1
s_mov_b32 s92, 0x3ae38e39
s_mov_b32 s93, 0x3727c5ac
s_mov_b32 s94, 0xffff0000
v_and_b32 v5, 3, v1
v_lshlrev_b32 v5, 21, v5
buffer_load_dword a7, v61, s[8:11], 0 offen
buffer_load_dwordx4 v[160:163], v234, s[12:15], 0 offen
buffer_load_dword a9, v5, s[16:19], 0 offen
s_mov_b64 exec, 0x3ff
buffer_store_dword v61, v60, s[20:23], 0 offen sc0 sc1
s_mov_b64 exec, -1
s_waitcnt vmcnt(19)
v_lshlrev_b32 v40, 16, v12
v_and_b32 v41, s94, v12
v_lshlrev_b32 v42, 16, v13
v_and_b32 v43, s94, v13
v_lshlrev_b32 v44, 16, v14
v_and_b32 v45, s94, v14
v_lshlrev_b32 v46, 16, v16
buffer_load_dwordx3 v[32:34], v11, s[28:31], 0 offen offset:768
v_and_b32 v47, s94, v16
v_lshlrev_b32 v48, 16, v17
v_and_b32 v49, s94, v17
v_lshlrev_b32 v50, 16, v18
v_and_b32 v51, s94, v18
v_lshlrev_b32 v52, 16, v20
v_and_b32 v53, s94, v20
v_lshlrev_b32 v54, 16, v21
v_and_b32 v55, s94, v21
v_lshlrev_b32 v56, 16, v22
v_and_b32 v57, s94, v22
v_pk_add_f32 v[64:65], v[40:41], v[42:43]
v_pk_add_f32 v[66:67], v[44:45], v[46:47]
v_pk_add_f32 v[64:65], v[64:65], v[48:49]
v_pk_add_f32 v[66:67], v[66:67], v[50:51]
v_pk_add_f32 v[64:65], v[64:65], v[52:53]
v_pk_add_f32 v[66:67], v[66:67], v[54:55]
v_pk_add_f32 v[64:65], v[64:65], v[56:57]
v_pk_add_f32 v[64:65], v[64:65], v[66:67]
v_add_f32 v64, v64, v65
s_nop 1
v_add_f32_dpp v65, v64, v64 row_ror:8 row_mask:0xf bank_mask:0xf
s_nop 1
v_add_f32_dpp v64, v65, v65 row_ror:4 row_mask:0xf bank_mask:0xf
s_add_u32 m0, s45, 131072
s_nop 0
buffer_load_dwordx4 v144, s[24:27], s43 offen offset:0 lds
s_nop 1
v_add_f32_dpp v65, v64, v64 row_ror:2 row_mask:0xf bank_mask:0xf
s_nop 1
v_add_f32_dpp v64, v65, v65 row_ror:1 row_mask:0xf bank_mask:0xf
v_mov_b32 v65, v64
s_nop 1
v_permlane16_swap_b32 v64, v65
v_add_f32 v64, v64, v65
v_mul_f32 v64, s92, v64
v_pk_add_f32 v[72:73], v[40:41], v[64:65] op_sel_hi:[1,0] neg_lo:[0,1] neg_hi:[0,1]
v_pk_add_f32 v[74:75], v[42:43], v[64:65] op_sel_hi:[1,0] neg_lo:[0,1] neg_hi:[0,1]
v_pk_add_f32 v[76:77], v[44:45], v[64:65] op_sel_hi:[1,0] neg_lo:[0,1] neg_hi:[0,1]
v_pk_add_f32 v[78:79], v[46:47], v[64:65] op_sel_hi:[1,0] neg_lo:[0,1] neg_hi:[0,1]
v_pk_add_f32 v[80:81], v[48:49], v[64:65] op_sel_hi:[1,0] neg_lo:[0,1] neg_hi:[0,1]
v_pk_add_f32 v[82:83], v[50:51], v[64:65] op_sel_hi:[1,0] neg_lo:[0,1] neg_hi:[0,1]
v_pk_add_f32 v[84:85], v[52:53], v[64:65] op_sel_hi:[1,0] neg_lo:[0,1] neg_hi:[0,1]
v_pk_add_f32 v[86:87], v[54:55], v[64:65] op_sel_hi:[1,0] neg_lo:[0,1] neg_hi:[0,1]
v_pk_add_f32 v[88:89], v[56:57], v[64:65] op_sel_hi:[1,0] neg_lo:[0,1] neg_hi:[0,1]
v_pk_mul_f32 v[66:67], v[72:73], v[72:73]
v_pk_mul_f32 v[68:69], v[74:75], v[74:75]
v_pk_fma_f32 v[66:67], v[76:77], v[76:77], v[66:67]
v_pk_fma_f32 v[68:69], v[78:79], v[78:79], v[68:69]
v_pk_fma_f32 v[66:67], v[80:81], v[80:81], v[66:67]
v_pk_fma_f32 v[68:69], v[82:83], v[82:83], v[68:69]
buffer_load_dwordx4 v145, s[24:27], s43 offen offset:1024 lds
v_pk_fma_f32 v[66:67], v[84:85], v[84:85], v[66:67]
v_pk_fma_f32 v[68:69], v[86:87], v[86:87], v[68:69]
v_pk_fma_f32 v[66:67], v[88:89], v[88:89], v[66:67]
v_pk_add_f32 v[66:67], v[66:67], v[68:69]
v_add_f32 v69, v66, v67
v_cvt_pk_bf16_f32 v64, v64, v64
v_lshlrev_b32 v64, 16, v64
v_pk_add_f32 v[40:41], v[40:41], v[64:65] op_sel_hi:[1,0] neg_lo:[0,1] neg_hi:[0,1]
v_cvt_pk_bf16_f32 v12, v40, v41
v_add_f32_dpp v68, v69, v69 row_ror:8 row_mask:0xf bank_mask:0xf
v_pk_add_f32 v[42:43], v[42:43], v[64:65] op_sel_hi:[1,0] neg_lo:[0,1] neg_hi:[0,1]
v_cvt_pk_bf16_f32 v13, v42, v43
v_add_f32_dpp v69, v68, v68 row_ror:4 row_mask:0xf bank_mask:0xf
v_pk_add_f32 v[44:45], v[44:45], v[64:65] op_sel_hi:[1,0] neg_lo:[0,1] neg_hi:[0,1]
v_cvt_pk_bf16_f32 v14, v44, v45
v_add_f32_dpp v68, v69, v69 row_ror:2 row_mask:0xf bank_mask:0xf
v_pk_add_f32 v[46:47], v[46:47], v[64:65] op_sel_hi:[1,0] neg_lo:[0,1] neg_hi:[0,1]
v_cvt_pk_bf16_f32 v16, v46, v47
v_add_f32_dpp v69, v68, v68 row_ror:1 row_mask:0xf bank_mask:0xf
v_mov_b32 v68, v69
v_pk_add_f32 v[48:49], v[48:49], v[64:65] op_sel_hi:[1,0] neg_lo:[0,1] neg_hi:[0,1]
v_cvt_pk_bf16_f32 v17, v48, v49
v_permlane16_swap_b32 v69, v68
v_add_f32 v69, v69, v68
s_add_u32 m0, s85, 131072
s_nop 0
buffer_load_dwordx4 v146, s[24:27], s43 offen offset:0 lds
v_mul_f32 v69, s92, v69
v_cvt_pk_bf16_f32 v69, v69, v69
v_lshlrev_b32 v69, 16, v69
v_add_f32 v69, s93, v69
v_cvt_pk_bf16_f32 v69, v69, v69
v_lshlrev_b32 v69, 16, v69
v_sqrt_f32 v69, v69
v_pk_add_f32 v[50:51], v[50:51], v[64:65] op_sel_hi:[1,0] neg_lo:[0,1] neg_hi:[0,1]
v_cvt_pk_bf16_f32 v18, v50, v51
v_cvt_pk_bf16_f32 v65, v69, v69
v_lshlrev_b32 v65, 16, v65
v_rcp_f32 v66, v65
v_pk_add_f32 v[52:53], v[52:53], v[64:65] op_sel_hi:[1,0] neg_lo:[0,1] neg_hi:[0,1]
v_cvt_pk_bf16_f32 v20, v52, v53
v_pk_add_f32 v[54:55], v[54:55], v[64:65] op_sel_hi:[1,0] neg_lo:[0,1] neg_hi:[0,1]
v_cvt_pk_bf16_f32 v21, v54, v55
v_pk_add_f32 v[56:57], v[56:57], v[64:65] op_sel_hi:[1,0] neg_lo:[0,1] neg_hi:[0,1]
v_cvt_pk_bf16_f32 v22, v56, v57
v_lshlrev_b32 v40, 16, v12
v_and_b32 v41, s94, v12
v_lshlrev_b32 v42, 16, v13
v_and_b32 v43, s94, v13
v_lshlrev_b32 v44, 16, v14
v_and_b32 v45, s94, v14
buffer_load_dwordx4 v147, s[24:27], s43 offen offset:1024 lds
v_lshlrev_b32 v46, 16, v16
v_and_b32 v47, s94, v16
v_lshlrev_b32 v48, 16, v17
v_and_b32 v49, s94, v17
v_lshlrev_b32 v50, 16, v18
v_and_b32 v51, s94, v18
v_lshlrev_b32 v52, 16, v20
v_and_b32 v53, s94, v20
v_lshlrev_b32 v54, 16, v21
v_and_b32 v55, s94, v21
v_lshlrev_b32 v56, 16, v22
v_and_b32 v57, s94, v22
v_lshlrev_b32 v5, 3, v8
s_mov_b32 s46, 0x240000
s_mov_b32 exec_lo, 1
s_mov_b32 exec_hi, 1
buffer_store_dwordx2 v[64:65], v5, s[20:23], s46 offen sc0 sc1
s_mov_b64 exec, -1
v_mov_b32 v70, 0
s_waitcnt lgkmcnt(0)
v_pk_mul_f32 v[72:73], v[40:41], v[66:67] op_sel_hi:[1,0]
v_pk_fma_f32 v[40:41], v[72:73], v[64:65], v[40:41] op_sel:[0,1,0] op_sel_hi:[1,1,1] neg_lo:[1,0,0] neg_hi:[1,0,0]
v_pk_fma_f32 v[72:73], v[40:41], v[66:67], v[72:73] op_sel_hi:[1,0,1]
v_cvt_pk_bf16_f32 v12, v72, v73
s_cmp_eq_u32 s74, 7
s_cselect_b32 s72, s73, 128
s_add_u32 s43, s43, s72
s_add_u32 m0, s44, 98304
s_nop 0
buffer_load_dwordx4 v136, s[16:19], s42 offen offset:0 lds
v_pk_mul_f32 v[74:75], v[42:43], v[66:67] op_sel_hi:[1,0]
v_pk_fma_f32 v[42:43], v[74:75], v[64:65], v[42:43] op_sel:[0,1,0] op_sel_hi:[1,1,1] neg_lo:[1,0,0] neg_hi:[1,0,0]
v_pk_fma_f32 v[74:75], v[42:43], v[66:67], v[74:75] op_sel_hi:[1,0,1]
v_cvt_pk_bf16_f32 v13, v74, v75
v_pk_mul_f32 v[76:77], v[44:45], v[66:67] op_sel_hi:[1,0]
v_pk_fma_f32 v[44:45], v[76:77], v[64:65], v[44:45] op_sel:[0,1,0] op_sel_hi:[1,1,1] neg_lo:[1,0,0] neg_hi:[1,0,0]
v_pk_fma_f32 v[76:77], v[44:45], v[66:67], v[76:77] op_sel_hi:[1,0,1]
v_cvt_pk_bf16_f32 v14, v76, v77
buffer_store_dwordx3 v[12:14], v10, s[20:23], 0 offen offset:0 sc0 sc1
v_pk_mul_f32 v[78:79], v[46:47], v[66:67] op_sel_hi:[1,0]
v_pk_fma_f32 v[46:47], v[78:79], v[64:65], v[46:47] op_sel:[0,1,0] op_sel_hi:[1,1,1] neg_lo:[1,0,0] neg_hi:[1,0,0]
v_pk_fma_f32 v[78:79], v[46:47], v[66:67], v[78:79] op_sel_hi:[1,0,1]
v_cvt_pk_bf16_f32 v16, v78, v79
v_pk_mul_f32 v[80:81], v[48:49], v[66:67] op_sel_hi:[1,0]
v_pk_fma_f32 v[48:49], v[80:81], v[64:65], v[48:49] op_sel:[0,1,0] op_sel_hi:[1,1,1] neg_lo:[1,0,0] neg_hi:[1,0,0]
v_pk_fma_f32 v[80:81], v[48:49], v[66:67], v[80:81] op_sel_hi:[1,0,1]
v_cvt_pk_bf16_f32 v17, v80, v81
v_pk_mul_f32 v[82:83], v[50:51], v[66:67] op_sel_hi:[1,0]
v_pk_fma_f32 v[50:51], v[82:83], v[64:65], v[50:51] op_sel:[0,1,0] op_sel_hi:[1,1,1] neg_lo:[1,0,0] neg_hi:[1,0,0]
v_pk_fma_f32 v[82:83], v[50:51], v[66:67], v[82:83] op_sel_hi:[1,0,1]
v_cvt_pk_bf16_f32 v18, v82, v83
buffer_store_dwordx3 v[16:18], v10, s[20:23], 0 offen offset:384 sc0 sc1
v_pk_mul_f32 v[84:85], v[52:53], v[66:67] op_sel_hi:[1,0]
v_pk_fma_f32 v[52:53], v[84:85], v[64:65], v[52:53] op_sel:[0,1,0] op_sel_hi:[1,1,1] neg_lo:[1,0,0] neg_hi:[1,0,0]
buffer_load_dwordx4 v137, s[16:19], s42 offen offset:1024 lds
v_pk_fma_f32 v[84:85], v[52:53], v[66:67], v[84:85] op_sel_hi:[1,0,1]
v_cvt_pk_bf16_f32 v20, v84, v85
v_pk_mul_f32 v[86:87], v[54:55], v[66:67] op_sel_hi:[1,0]
v_pk_fma_f32 v[54:55], v[86:87], v[64:65], v[54:55] op_sel:[0,1,0] op_sel_hi:[1,1,1] neg_lo:[1,0,0] neg_hi:[1,0,0]
v_pk_fma_f32 v[86:87], v[54:55], v[66:67], v[86:87] op_sel_hi:[1,0,1]
v_cvt_pk_bf16_f32 v21, v86, v87
v_pk_mul_f32 v[88:89], v[56:57], v[66:67] op_sel_hi:[1,0]
v_pk_fma_f32 v[56:57], v[88:89], v[64:65], v[56:57] op_sel:[0,1,0] op_sel_hi:[1,1,1] neg_lo:[1,0,0] neg_hi:[1,0,0]
v_pk_fma_f32 v[88:89], v[56:57], v[66:67], v[88:89] op_sel_hi:[1,0,1]
v_cvt_pk_bf16_f32 v22, v88, v89
buffer_store_dwordx3 v[20:22], v10, s[20:23], 0 offen offset:768 sc0 sc1
s_waitcnt vmcnt(10)
v_dot2_f32_bf16 v70, v12, v24, v70
v_dot2_f32_bf16 v70, v13, v25, v70
v_dot2_f32_bf16 v70, v14, v26, v70
v_dot2_f32_bf16 v70, v16, v28, v70
v_dot2_f32_bf16 v70, v17, v29, v70
v_dot2_f32_bf16 v70, v18, v30, v70
v_dot2_f32_bf16 v70, v20, v32, v70
v_dot2_f32_bf16 v70, v21, v33, v70
v_dot2_f32_bf16 v70, v22, v34, v70
v_sub_u32 v68, 2047, v8
v_lshlrev_b32 v5, 2, v8
s_nop 1
v_add_f32_dpp v71, v70, v70 row_ror:8 row_mask:0xf bank_mask:0xf
buffer_load_dwordx4 v138, s[16:19], s42 offen offset:2048 lds
s_nop 1
v_add_f32_dpp v70, v71, v71 row_ror:4 row_mask:0xf bank_mask:0xf
s_nop 1
v_add_f32_dpp v71, v70, v70 row_ror:2 row_mask:0xf bank_mask:0xf
s_nop 1
v_add_f32_dpp v70, v71, v71 row_ror:1 row_mask:0xf bank_mask:0xf
v_mov_b32 v71, v70
s_nop 1
v_permlane16_swap_b32 v70, v71
v_add_f32 v70, v70, v71
v_cvt_pk_bf16_f32 v70, v70, v70
v_ashrrev_i32 v71, 31, v70
v_or_b32 v71, 0x80000000, v71
v_xor_b32 v70, v70, v71
v_and_or_b32 v214, v70, s94, v68
buffer_load_dwordx4 v139, s[16:19], s42 offen offset:3072 lds
s_add_u32 m0, s44, 102400
s_nop 0
buffer_load_dwordx4 v140, s[16:19], s42 offen offset:0 lds
buffer_load_dwordx4 v141, s[16:19], s42 offen offset:1024 lds
buffer_load_dwordx4 v142, s[16:19], s42 offen offset:2048 lds
buffer_load_dwordx4 v143, s[16:19], s42 offen offset:3072 lds
s_lshl_b32 s72, s72, 12
s_add_u32 s42, s42, s72
s_mov_b32 s46, 0x244000
s_mov_b32 exec_lo, 1
s_mov_b32 exec_hi, 1
buffer_store_dword v214, v5, s[20:23], s46 offen sc0 sc1
s_mov_b64 exec, -1
s_mov_b32 s28, s4
s_and_b32 s29, s5, 0xffff
s_mov_b32 s30, 0x100
s_mov_b32 s31, 0x00020000
s_waitcnt vmcnt(24)
s_barrier
ds_read_b128 a[192:195], v192 offset:0
ds_read_b128 a[196:199], v192 offset:2048
ds_read_b64_tr_b16 a[128:129], v184 offset:0
ds_read_b64_tr_b16 a[130:131], v184 offset:2048
ds_read_b64_tr_b16 a[132:133], v185 offset:0
ds_read_b64_tr_b16 a[134:135], v185 offset:2048
ds_read_b64_tr_b16 a[160:161], v184 offset:256
ds_read_b64_tr_b16 a[162:163], v184 offset:2304
ds_read_b64_tr_b16 a[164:165], v185 offset:256
ds_read_b64_tr_b16 a[166:167], v185 offset:2304
ds_read_b64_tr_b16 a[136:137], v186 offset:0
ds_read_b64_tr_b16 a[138:139], v186 offset:2048
ds_read_b64_tr_b16 a[140:141], v187 offset:0
ds_read_b64_tr_b16 a[142:143], v187 offset:2048
ds_read_b64_tr_b16 a[144:145], v188 offset:0
ds_read_b64_tr_b16 a[146:147], v188 offset:2048
ds_read_b64_tr_b16 a[148:149], v189 offset:0
ds_read_b64_tr_b16 a[150:151], v189 offset:2048
ds_read_b64_tr_b16 a[152:153], v190 offset:0
ds_read_b64_tr_b16 a[154:155], v190 offset:2048
ds_read_b64_tr_b16 a[156:157], v191 offset:0
ds_read_b64_tr_b16 a[158:159], v191 offset:2048
ds_read_b64_tr_b16 a[168:169], v186 offset:256
ds_read_b64_tr_b16 a[170:171], v186 offset:2304
ds_read_b64_tr_b16 a[172:173], v187 offset:256
ds_read_b64_tr_b16 a[174:175], v187 offset:2304
ds_read_b64_tr_b16 a[176:177], v188 offset:256
ds_read_b64_tr_b16 a[178:179], v188 offset:2304
ds_read_b64_tr_b16 a[180:181], v189 offset:256
ds_read_b64_tr_b16 a[182:183], v189 offset:2304
ds_read_b64_tr_b16 a[184:185], v190 offset:256
ds_read_b64_tr_b16 a[186:187], v190 offset:2304
ds_read_b64_tr_b16 a[188:189], v191 offset:256
ds_read_b64_tr_b16 a[190:191], v191 offset:2304
s_waitcnt lgkmcnt(15)
v_mfma_f32_16x16x32_bf16 v[8:11], a[128:131], a[192:195], 0
ds_read_b128 a[200:203], v193 offset:0
ds_read_b128 a[204:207], v193 offset:2048
v_mfma_f32_16x16x32_bf16 v[40:43], a[128:131], a[196:199], 0
s_add_u32 m0, s45, 81920
v_mfma_f32_16x16x32_bf16 v[12:15], a[132:135], a[192:195], 0
buffer_load_dwordx4 v144, s[24:27], s43 offen offset:0 lds
v_mfma_f32_16x16x32_bf16 v[44:47], a[132:135], a[196:199], 0
v_smfmac_f32_16x16x64_bf16 a[248:251], a[208:211], a[128:135], v235
ds_read_b64_tr_b16 a[128:129], v184 offset:16384
ds_read_b64_tr_b16 a[130:131], v184 offset:18432
v_mfma_f32_16x16x32_bf16 v[72:75], a[160:163], a[192:195], 0
ds_read_b64_tr_b16 a[132:133], v185 offset:16384
ds_read_b64_tr_b16 a[134:135], v185 offset:18432
v_mfma_f32_16x16x32_bf16 v[104:107], a[160:163], a[196:199], 0
buffer_load_dwordx4 v145, s[24:27], s43 offen offset:1024 lds
v_mfma_f32_16x16x32_bf16 v[76:79], a[164:167], a[192:195], 0
v_mfma_f32_16x16x32_bf16 v[108:111], a[164:167], a[196:199], 0
v_smfmac_f32_16x16x64_bf16 a[252:255], a[208:211], a[160:167], v235
s_add_u32 m0, s85, 81920
ds_read_b64_tr_b16 a[160:161], v184 offset:16640
ds_read_b64_tr_b16 a[162:163], v184 offset:18688
v_mfma_f32_16x16x32_bf16 v[16:19], a[136:139], a[192:195], 0
buffer_load_dwordx4 v146, s[24:27], s43 offen offset:0 lds
v_mfma_f32_16x16x32_bf16 v[48:51], a[136:139], a[196:199], 0
ds_read_b64_tr_b16 a[164:165], v185 offset:16640
ds_read_b64_tr_b16 a[166:167], v185 offset:18688
v_mfma_f32_16x16x32_bf16 v[20:23], a[140:143], a[192:195], 0
ds_read_b64_tr_b16 a[136:137], v186 offset:16384
ds_read_b64_tr_b16 a[138:139], v186 offset:18432
v_mfma_f32_16x16x32_bf16 v[52:55], a[140:143], a[196:199], 0
ds_read_b64_tr_b16 a[140:141], v187 offset:16384
ds_read_b64_tr_b16 a[142:143], v187 offset:18432
v_mfma_f32_16x16x32_bf16 v[24:27], a[144:147], a[192:195], 0
buffer_load_dwordx4 v147, s[24:27], s43 offen offset:1024 lds
v_mfma_f32_16x16x32_bf16 v[56:59], a[144:147], a[196:199], 0
s_cmp_eq_u32 s74, 6
s_cselect_b32 s72, s73, 128
ds_read_b64_tr_b16 a[144:145], v188 offset:16384
ds_read_b64_tr_b16 a[146:147], v188 offset:18432
v_mfma_f32_16x16x32_bf16 v[28:31], a[148:151], a[192:195], 0
s_add_u32 s43, s43, s72
v_mfma_f32_16x16x32_bf16 v[60:63], a[148:151], a[196:199], 0
s_waitcnt lgkmcnt(10)
s_add_u32 m0, s44, 49152
ds_read_b64_tr_b16 a[148:149], v189 offset:16384
ds_read_b64_tr_b16 a[150:151], v189 offset:18432
v_mfma_f32_16x16x32_bf16 v[32:35], a[152:155], a[192:195], 0
buffer_load_dwordx4 v136, s[16:19], s42 offen offset:0 lds
v_mfma_f32_16x16x32_bf16 v[64:67], a[152:155], a[196:199], 0
ds_read_b64_tr_b16 a[152:153], v190 offset:16384
ds_read_b64_tr_b16 a[154:155], v190 offset:18432
v_mfma_f32_16x16x32_bf16 v[36:39], a[156:159], a[192:195], 0
v_mfma_f32_16x16x32_bf16 v[68:71], a[156:159], a[196:199], 0
ds_read_b64_tr_b16 a[156:157], v191 offset:16384
ds_read_b64_tr_b16 a[158:159], v191 offset:18432
v_mfma_f32_16x16x32_bf16 v[80:83], a[168:171], a[192:195], 0
v_mfma_f32_16x16x32_bf16 v[112:115], a[168:171], a[196:199], 0
buffer_load_dwordx4 v137, s[16:19], s42 offen offset:1024 lds
v_mfma_f32_16x16x32_bf16 v[84:87], a[172:175], a[192:195], 0
ds_read_b64_tr_b16 a[168:169], v186 offset:16640
ds_read_b64_tr_b16 a[170:171], v186 offset:18688
v_mfma_f32_16x16x32_bf16 v[116:119], a[172:175], a[196:199], 0
ds_read_b64_tr_b16 a[172:173], v187 offset:16640
ds_read_b64_tr_b16 a[174:175], v187 offset:18688
v_mfma_f32_16x16x32_bf16 v[88:91], a[176:179], a[192:195], 0
v_mfma_f32_16x16x32_bf16 v[120:123], a[176:179], a[196:199], 0
buffer_load_dwordx4 v138, s[16:19], s42 offen offset:2048 lds
v_mfma_f32_16x16x32_bf16 v[92:95], a[180:183], a[192:195], 0
ds_read_b64_tr_b16 a[176:177], v188 offset:16640
ds_read_b64_tr_b16 a[178:179], v188 offset:18688
v_mfma_f32_16x16x32_bf16 v[124:127], a[180:183], a[196:199], 0
ds_read_b64_tr_b16 a[180:181], v189 offset:16640
ds_read_b64_tr_b16 a[182:183], v189 offset:18688
v_mfma_f32_16x16x32_bf16 v[96:99], a[184:187], a[192:195], 0
v_mfma_f32_16x16x32_bf16 v[128:131], a[184:187], a[196:199], 0
buffer_load_dwordx4 v139, s[16:19], s42 offen offset:3072 lds
v_mfma_f32_16x16x32_bf16 v[100:103], a[188:191], a[192:195], 0
ds_read_b64_tr_b16 a[184:185], v190 offset:16640
ds_read_b64_tr_b16 a[186:187], v190 offset:18688
v_mfma_f32_16x16x32_bf16 v[132:135], a[188:191], a[196:199], 0
ds_read_b64_tr_b16 a[188:189], v191 offset:16640
ds_read_b64_tr_b16 a[190:191], v191 offset:18688
v_mfma_f32_16x16x32_bf16 v[8:11], a[128:131], a[200:203], v[8:11]
s_add_u32 m0, s44, 53248
v_mfma_f32_16x16x32_bf16 v[40:43], a[128:131], a[204:207], v[40:43]
buffer_load_dwordx4 v140, s[16:19], s42 offen offset:0 lds
v_mfma_f32_16x16x32_bf16 v[12:15], a[132:135], a[200:203], v[12:15]
v_mfma_f32_16x16x32_bf16 v[44:47], a[132:135], a[204:207], v[44:47]
v_smfmac_f32_16x16x64_bf16 a[248:251], a[208:211], a[128:135], v235
s_waitcnt lgkmcnt(6)
v_mfma_f32_16x16x32_bf16 v[72:75], a[160:163], a[200:203], v[72:75]
v_mfma_f32_16x16x32_bf16 v[104:107], a[160:163], a[204:207], v[104:107]
s_waitcnt vmcnt(10) lgkmcnt(0)
s_barrier
v_mfma_f32_16x16x32_bf16 v[76:79], a[164:167], a[200:203], v[76:79]
ds_read_b128 a[192:195], v202 offset:0
ds_read_b128 a[196:199], v202 offset:2048
v_mfma_f32_16x16x32_bf16 v[108:111], a[164:167], a[204:207], v[108:111]
buffer_load_dwordx4 v141, s[16:19], s42 offen offset:1024 lds
v_smfmac_f32_16x16x64_bf16 a[252:255], a[208:211], a[160:167], v235
ds_read_b64_tr_b16 a[128:129], v194 offset:0
ds_read_b64_tr_b16 a[130:131], v194 offset:2048
v_mfma_f32_16x16x32_bf16 v[16:19], a[136:139], a[200:203], v[16:19]
ds_read_b64_tr_b16 a[132:133], v195 offset:0
ds_read_b64_tr_b16 a[134:135], v195 offset:2048
v_mfma_f32_16x16x32_bf16 v[48:51], a[136:139], a[204:207], v[48:51]
ds_read_b64_tr_b16 a[160:161], v194 offset:256
ds_read_b64_tr_b16 a[162:163], v194 offset:2304
v_mfma_f32_16x16x32_bf16 v[20:23], a[140:143], a[200:203], v[20:23]
ds_read_b64_tr_b16 a[164:165], v195 offset:256
ds_read_b64_tr_b16 a[166:167], v195 offset:2304
v_mfma_f32_16x16x32_bf16 v[52:55], a[140:143], a[204:207], v[52:55]
buffer_load_dwordx4 v142, s[16:19], s42 offen offset:2048 lds
v_mfma_f32_16x16x32_bf16 v[24:27], a[144:147], a[200:203], v[24:27]
ds_read_b64_tr_b16 a[136:137], v196 offset:0
ds_read_b64_tr_b16 a[138:139], v196 offset:2048
v_mfma_f32_16x16x32_bf16 v[56:59], a[144:147], a[204:207], v[56:59]
ds_read_b64_tr_b16 a[140:141], v197 offset:0
ds_read_b64_tr_b16 a[142:143], v197 offset:2048
v_mfma_f32_16x16x32_bf16 v[28:31], a[148:151], a[200:203], v[28:31]
ds_read_b64_tr_b16 a[144:145], v198 offset:0
ds_read_b64_tr_b16 a[146:147], v198 offset:2048
v_mfma_f32_16x16x32_bf16 v[60:63], a[148:151], a[204:207], v[60:63]
buffer_load_dwordx4 v143, s[16:19], s42 offen offset:3072 lds
v_mfma_f32_16x16x32_bf16 v[32:35], a[152:155], a[200:203], v[32:35]
s_lshl_b32 s72, s72, 12
ds_read_b64_tr_b16 a[148:149], v199 offset:0
ds_read_b64_tr_b16 a[150:151], v199 offset:2048
v_mfma_f32_16x16x32_bf16 v[64:67], a[152:155], a[204:207], v[64:67]
s_add_u32 s42, s42, s72
ds_read_b64_tr_b16 a[152:153], v200 offset:0
ds_read_b64_tr_b16 a[154:155], v200 offset:2048
v_mfma_f32_16x16x32_bf16 v[36:39], a[156:159], a[200:203], v[36:39]
s_add_u32 m0, s45, 32768
v_mfma_f32_16x16x32_bf16 v[68:71], a[156:159], a[204:207], v[68:71]
buffer_load_dwordx4 v144, s[24:27], s43 offen offset:0 lds
v_mfma_f32_16x16x32_bf16 v[80:83], a[168:171], a[200:203], v[80:83]
ds_read_b64_tr_b16 a[156:157], v201 offset:0
ds_read_b64_tr_b16 a[158:159], v201 offset:2048
v_mfma_f32_16x16x32_bf16 v[112:115], a[168:171], a[204:207], v[112:115]
ds_read_b64_tr_b16 a[168:169], v196 offset:256
ds_read_b64_tr_b16 a[170:171], v196 offset:2304
v_mfma_f32_16x16x32_bf16 v[84:87], a[172:175], a[200:203], v[84:87]
v_mfma_f32_16x16x32_bf16 v[116:119], a[172:175], a[204:207], v[116:119]
buffer_load_dwordx4 v145, s[24:27], s43 offen offset:1024 lds
v_mfma_f32_16x16x32_bf16 v[88:91], a[176:179], a[200:203], v[88:91]
ds_read_b64_tr_b16 a[172:173], v197 offset:256
ds_read_b64_tr_b16 a[174:175], v197 offset:2304
v_mfma_f32_16x16x32_bf16 v[120:123], a[176:179], a[204:207], v[120:123]
ds_read_b64_tr_b16 a[176:177], v198 offset:256
ds_read_b64_tr_b16 a[178:179], v198 offset:2304
v_mfma_f32_16x16x32_bf16 v[92:95], a[180:183], a[200:203], v[92:95]
s_add_u32 m0, s85, 32768
v_mfma_f32_16x16x32_bf16 v[124:127], a[180:183], a[204:207], v[124:127]
buffer_load_dwordx4 v146, s[24:27], s43 offen offset:0 lds
v_mfma_f32_16x16x32_bf16 v[96:99], a[184:187], a[200:203], v[96:99]
ds_read_b64_tr_b16 a[180:181], v199 offset:256
ds_read_b64_tr_b16 a[182:183], v199 offset:2304
v_mfma_f32_16x16x32_bf16 v[128:131], a[184:187], a[204:207], v[128:131]
ds_read_b64_tr_b16 a[184:185], v200 offset:256
ds_read_b64_tr_b16 a[186:187], v200 offset:2304
v_mfma_f32_16x16x32_bf16 v[100:103], a[188:191], a[200:203], v[100:103]
v_mfma_f32_16x16x32_bf16 v[132:135], a[188:191], a[204:207], v[132:135]
s_waitcnt lgkmcnt(8)
ds_read_b64_tr_b16 a[188:189], v201 offset:256
ds_read_b64_tr_b16 a[190:191], v201 offset:2304
v_mfma_f32_16x16x32_bf16 v[8:11], a[128:131], a[192:195], v[8:11]
buffer_load_dwordx4 v147, s[24:27], s43 offen offset:1024 lds
v_mfma_f32_16x16x32_bf16 v[40:43], a[128:131], a[196:199], v[40:43]
s_cmp_eq_u32 s74, 5
s_cselect_b32 s72, s73, 128
ds_read_b128 a[200:203], v203 offset:0
ds_read_b128 a[204:207], v203 offset:2048
v_mfma_f32_16x16x32_bf16 v[12:15], a[132:135], a[192:195], v[12:15]
s_add_u32 s43, s43, s72
v_mfma_f32_16x16x32_bf16 v[44:47], a[132:135], a[196:199], v[44:47]
s_add_u32 m0, s44, 0
v_smfmac_f32_16x16x64_bf16 a[248:251], a[208:211], a[128:135], v235
buffer_load_dwordx4 v136, s[16:19], s42 offen offset:0 lds
v_mfma_f32_16x16x32_bf16 v[72:75], a[160:163], a[192:195], v[72:75]
ds_read_b64_tr_b16 a[128:129], v194 offset:16384
ds_read_b64_tr_b16 a[130:131], v194 offset:18432
v_mfma_f32_16x16x32_bf16 v[104:107], a[160:163], a[196:199], v[104:107]
ds_read_b64_tr_b16 a[132:133], v195 offset:16384
ds_read_b64_tr_b16 a[134:135], v195 offset:18432
v_mfma_f32_16x16x32_bf16 v[76:79], a[164:167], a[192:195], v[76:79]
v_mfma_f32_16x16x32_bf16 v[108:111], a[164:167], a[196:199], v[108:111]
buffer_load_dwordx4 v137, s[16:19], s42 offen offset:1024 lds
v_smfmac_f32_16x16x64_bf16 a[252:255], a[208:211], a[160:167], v235
ds_read_b64_tr_b16 a[160:161], v194 offset:16640
ds_read_b64_tr_b16 a[162:163], v194 offset:18688
v_mfma_f32_16x16x32_bf16 v[16:19], a[136:139], a[192:195], v[16:19]
ds_read_b64_tr_b16 a[164:165], v195 offset:16640
ds_read_b64_tr_b16 a[166:167], v195 offset:18688
v_mfma_f32_16x16x32_bf16 v[48:51], a[136:139], a[196:199], v[48:51]
ds_read_b64_tr_b16 a[136:137], v196 offset:16384
ds_read_b64_tr_b16 a[138:139], v196 offset:18432
v_mfma_f32_16x16x32_bf16 v[20:23], a[140:143], a[192:195], v[20:23]
buffer_load_dwordx4 v138, s[16:19], s42 offen offset:2048 lds
v_mfma_f32_16x16x32_bf16 v[52:55], a[140:143], a[196:199], v[52:55]
ds_read_b64_tr_b16 a[140:141], v197 offset:16384
ds_read_b64_tr_b16 a[142:143], v197 offset:18432
v_mfma_f32_16x16x32_bf16 v[24:27], a[144:147], a[192:195], v[24:27]
v_mfma_f32_16x16x32_bf16 v[56:59], a[144:147], a[196:199], v[56:59]
ds_read_b64_tr_b16 a[144:145], v198 offset:16384
ds_read_b64_tr_b16 a[146:147], v198 offset:18432
v_mfma_f32_16x16x32_bf16 v[28:31], a[148:151], a[192:195], v[28:31]
buffer_load_dwordx4 v139, s[16:19], s42 offen offset:3072 lds
v_mfma_f32_16x16x32_bf16 v[60:63], a[148:151], a[196:199], v[60:63]
ds_read_b64_tr_b16 a[148:149], v199 offset:16384
ds_read_b64_tr_b16 a[150:151], v199 offset:18432
v_mfma_f32_16x16x32_bf16 v[32:35], a[152:155], a[192:195], v[32:35]
v_mfma_f32_16x16x32_bf16 v[64:67], a[152:155], a[196:199], v[64:67]
ds_read_b64_tr_b16 a[152:153], v200 offset:16384
ds_read_b64_tr_b16 a[154:155], v200 offset:18432
v_mfma_f32_16x16x32_bf16 v[36:39], a[156:159], a[192:195], v[36:39]
s_add_u32 m0, s44, 4096
v_mfma_f32_16x16x32_bf16 v[68:71], a[156:159], a[196:199], v[68:71]
buffer_load_dwordx4 v140, s[16:19], s42 offen offset:0 lds
v_mfma_f32_16x16x32_bf16 v[80:83], a[168:171], a[192:195], v[80:83]
ds_read_b64_tr_b16 a[156:157], v201 offset:16384
ds_read_b64_tr_b16 a[158:159], v201 offset:18432
v_mfma_f32_16x16x32_bf16 v[112:115], a[168:171], a[196:199], v[112:115]
s_waitcnt lgkmcnt(8)
ds_read_b64_tr_b16 a[168:169], v196 offset:16640
ds_read_b64_tr_b16 a[170:171], v196 offset:18688
v_mfma_f32_16x16x32_bf16 v[84:87], a[172:175], a[192:195], v[84:87]
v_mfma_f32_16x16x32_bf16 v[116:119], a[172:175], a[196:199], v[116:119]
buffer_load_dwordx4 v141, s[16:19], s42 offen offset:1024 lds
v_mfma_f32_16x16x32_bf16 v[88:91], a[176:179], a[192:195], v[88:91]
ds_read_b64_tr_b16 a[172:173], v197 offset:16640
ds_read_b64_tr_b16 a[174:175], v197 offset:18688
v_mfma_f32_16x16x32_bf16 v[120:123], a[176:179], a[196:199], v[120:123]
ds_read_b64_tr_b16 a[176:177], v198 offset:16640
ds_read_b64_tr_b16 a[178:179], v198 offset:18688
v_mfma_f32_16x16x32_bf16 v[92:95], a[180:183], a[192:195], v[92:95]
v_mfma_f32_16x16x32_bf16 v[124:127], a[180:183], a[196:199], v[124:127]
buffer_load_dwordx4 v142, s[16:19], s42 offen offset:2048 lds
v_mfma_f32_16x16x32_bf16 v[96:99], a[184:187], a[192:195], v[96:99]
ds_read_b64_tr_b16 a[180:181], v199 offset:16640
ds_read_b64_tr_b16 a[182:183], v199 offset:18688
v_mfma_f32_16x16x32_bf16 v[128:131], a[184:187], a[196:199], v[128:131]
ds_read_b64_tr_b16 a[184:185], v200 offset:16640
ds_read_b64_tr_b16 a[186:187], v200 offset:18688
v_mfma_f32_16x16x32_bf16 v[100:103], a[188:191], a[192:195], v[100:103]
v_mfma_f32_16x16x32_bf16 v[132:135], a[188:191], a[196:199], v[132:135]
ds_read_b64_tr_b16 a[188:189], v201 offset:16640
ds_read_b64_tr_b16 a[190:191], v201 offset:18688
v_mfma_f32_16x16x32_bf16 v[8:11], a[128:131], a[200:203], v[8:11]
buffer_load_dwordx4 v143, s[16:19], s42 offen offset:3072 lds
v_mfma_f32_16x16x32_bf16 v[40:43], a[128:131], a[204:207], v[40:43]
v_mfma_f32_16x16x32_bf16 v[12:15], a[132:135], a[200:203], v[12:15]
s_lshl_b32 s72, s72, 12
v_mfma_f32_16x16x32_bf16 v[44:47], a[132:135], a[204:207], v[44:47]
s_add_u32 s42, s42, s72
v_smfmac_f32_16x16x64_bf16 a[248:251], a[208:211], a[128:135], v235
v_mfma_f32_16x16x32_bf16 v[72:75], a[160:163], a[200:203], v[72:75]
v_mfma_f32_16x16x32_bf16 v[104:107], a[160:163], a[204:207], v[104:107]
s_waitcnt vmcnt(12) lgkmcnt(0)
s_barrier
s_cmp_lg_u32 s32, 0
s_cbranch_scc1 K_W0_3
s_lshl_b32 s48, s34, 4
s_mov_b64 exec, 1
buffer_atomic_add v255, v234, s[28:31], s48 offen sc1
s_mov_b64 exec, -1
K_W0_3:
v_mfma_f32_16x16x32_bf16 v[76:79], a[164:167], a[200:203], v[76:79]
s_add_u32 m0, s45, 131072
ds_read_b128 a[192:195], v212 offset:0
ds_read_b128 a[196:199], v212 offset:2048
v_mfma_f32_16x16x32_bf16 v[108:111], a[164:167], a[204:207], v[108:111]
buffer_load_dwordx4 v144, s[24:27], s43 offen offset:0 lds
v_smfmac_f32_16x16x64_bf16 a[252:255], a[208:211], a[160:167], v235
ds_read_b64_tr_b16 a[128:129], v204 offset:0
ds_read_b64_tr_b16 a[130:131], v204 offset:2048
v_mfma_f32_16x16x32_bf16 v[16:19], a[136:139], a[200:203], v[16:19]
ds_read_b64_tr_b16 a[132:133], v205 offset:0
ds_read_b64_tr_b16 a[134:135], v205 offset:2048
v_mfma_f32_16x16x32_bf16 v[48:51], a[136:139], a[204:207], v[48:51]
ds_read_b64_tr_b16 a[160:161], v204 offset:256
ds_read_b64_tr_b16 a[162:163], v204 offset:2304
v_mfma_f32_16x16x32_bf16 v[20:23], a[140:143], a[200:203], v[20:23]
ds_read_b64_tr_b16 a[164:165], v205 offset:256
ds_read_b64_tr_b16 a[166:167], v205 offset:2304
v_mfma_f32_16x16x32_bf16 v[52:55], a[140:143], a[204:207], v[52:55]
buffer_load_dwordx4 v145, s[24:27], s43 offen offset:1024 lds
v_mfma_f32_16x16x32_bf16 v[24:27], a[144:147], a[200:203], v[24:27]
ds_read_b64_tr_b16 a[136:137], v206 offset:0
ds_read_b64_tr_b16 a[138:139], v206 offset:2048
v_mfma_f32_16x16x32_bf16 v[56:59], a[144:147], a[204:207], v[56:59]
ds_read_b64_tr_b16 a[140:141], v207 offset:0
ds_read_b64_tr_b16 a[142:143], v207 offset:2048
v_mfma_f32_16x16x32_bf16 v[28:31], a[148:151], a[200:203], v[28:31]
s_add_u32 m0, s85, 131072
ds_read_b64_tr_b16 a[144:145], v208 offset:0
ds_read_b64_tr_b16 a[146:147], v208 offset:2048
v_mfma_f32_16x16x32_bf16 v[60:63], a[148:151], a[204:207], v[60:63]
buffer_load_dwordx4 v146, s[24:27], s43 offen offset:0 lds
v_mfma_f32_16x16x32_bf16 v[32:35], a[152:155], a[200:203], v[32:35]
ds_read_b64_tr_b16 a[148:149], v209 offset:0
ds_read_b64_tr_b16 a[150:151], v209 offset:2048
v_mfma_f32_16x16x32_bf16 v[64:67], a[152:155], a[204:207], v[64:67]
ds_read_b64_tr_b16 a[152:153], v210 offset:0
ds_read_b64_tr_b16 a[154:155], v210 offset:2048
v_mfma_f32_16x16x32_bf16 v[36:39], a[156:159], a[200:203], v[36:39]
v_mfma_f32_16x16x32_bf16 v[68:71], a[156:159], a[204:207], v[68:71]
buffer_load_dwordx4 v147, s[24:27], s43 offen offset:1024 lds
v_mfma_f32_16x16x32_bf16 v[80:83], a[168:171], a[200:203], v[80:83]
s_cmp_eq_u32 s74, 4
s_cselect_b32 s72, s73, 128
ds_read_b64_tr_b16 a[156:157], v211 offset:0
ds_read_b64_tr_b16 a[158:159], v211 offset:2048
v_mfma_f32_16x16x32_bf16 v[112:115], a[168:171], a[204:207], v[112:115]
s_add_u32 s43, s43, s72
ds_read_b64_tr_b16 a[168:169], v206 offset:256
ds_read_b64_tr_b16 a[170:171], v206 offset:2304
v_mfma_f32_16x16x32_bf16 v[84:87], a[172:175], a[200:203], v[84:87]
s_add_u32 m0, s44, 98304
v_mfma_f32_16x16x32_bf16 v[116:119], a[172:175], a[204:207], v[116:119]
buffer_load_dwordx4 v136, s[16:19], s42 offen offset:0 lds
v_mfma_f32_16x16x32_bf16 v[88:91], a[176:179], a[200:203], v[88:91]
ds_read_b64_tr_b16 a[172:173], v207 offset:256
ds_read_b64_tr_b16 a[174:175], v207 offset:2304
v_mfma_f32_16x16x32_bf16 v[120:123], a[176:179], a[204:207], v[120:123]
ds_read_b64_tr_b16 a[176:177], v208 offset:256
ds_read_b64_tr_b16 a[178:179], v208 offset:2304
v_mfma_f32_16x16x32_bf16 v[92:95], a[180:183], a[200:203], v[92:95]
v_mfma_f32_16x16x32_bf16 v[124:127], a[180:183], a[204:207], v[124:127]
buffer_load_dwordx4 v137, s[16:19], s42 offen offset:1024 lds
v_mfma_f32_16x16x32_bf16 v[96:99], a[184:187], a[200:203], v[96:99]
ds_read_b64_tr_b16 a[180:181], v209 offset:256
ds_read_b64_tr_b16 a[182:183], v209 offset:2304
v_mfma_f32_16x16x32_bf16 v[128:131], a[184:187], a[204:207], v[128:131]
ds_read_b64_tr_b16 a[184:185], v210 offset:256
ds_read_b64_tr_b16 a[186:187], v210 offset:2304
v_mfma_f32_16x16x32_bf16 v[100:103], a[188:191], a[200:203], v[100:103]
v_mfma_f32_16x16x32_bf16 v[132:135], a[188:191], a[204:207], v[132:135]
s_waitcnt lgkmcnt(8)
ds_read_b64_tr_b16 a[188:189], v211 offset:256
ds_read_b64_tr_b16 a[190:191], v211 offset:2304
v_mfma_f32_16x16x32_bf16 v[8:11], a[128:131], a[192:195], v[8:11]
buffer_load_dwordx4 v138, s[16:19], s42 offen offset:2048 lds
v_mfma_f32_16x16x32_bf16 v[40:43], a[128:131], a[196:199], v[40:43]
ds_read_b128 a[200:203], v213 offset:0
ds_read_b128 a[204:207], v213 offset:2048
v_mfma_f32_16x16x32_bf16 v[12:15], a[132:135], a[192:195], v[12:15]
s_waitcnt vmcnt(51)
v_and_b32 v160, 0x7f807f80, v160
v_and_b32 v161, 0x7f807f80, v161
v_mfma_f32_16x16x32_bf16 v[44:47], a[132:135], a[196:199], v[44:47]
v_and_b32 v162, 0x7f807f80, v162
v_and_b32 v163, 0x7f807f80, v163
v_smfmac_f32_16x16x64_bf16 a[248:251], a[208:211], a[128:135], v235
buffer_load_dwordx4 v139, s[16:19], s42 offen offset:3072 lds
v_mfma_f32_16x16x32_bf16 v[72:75], a[160:163], a[192:195], v[72:75]
ds_read_b64_tr_b16 a[128:129], v204 offset:16384
ds_read_b64_tr_b16 a[130:131], v204 offset:18432
v_mfma_f32_16x16x32_bf16 v[104:107], a[160:163], a[196:199], v[104:107]
ds_read_b64_tr_b16 a[132:133], v205 offset:16384
ds_read_b64_tr_b16 a[134:135], v205 offset:18432
v_mfma_f32_16x16x32_bf16 v[76:79], a[164:167], a[192:195], v[76:79]
s_add_u32 m0, s44, 102400
v_pk_max_u16 v160, v160, v161
v_pk_max_u16 v162, v162, v163
v_mfma_f32_16x16x32_bf16 v[108:111], a[164:167], a[196:199], v[108:111]
buffer_load_dwordx4 v140, s[16:19], s42 offen offset:0 lds
v_smfmac_f32_16x16x64_bf16 a[252:255], a[208:211], a[160:167], v235
ds_read_b64_tr_b16 a[160:161], v204 offset:16640
ds_read_b64_tr_b16 a[162:163], v204 offset:18688
v_mfma_f32_16x16x32_bf16 v[16:19], a[136:139], a[192:195], v[16:19]
ds_read_b64_tr_b16 a[164:165], v205 offset:16640
ds_read_b64_tr_b16 a[166:167], v205 offset:18688
v_mfma_f32_16x16x32_bf16 v[48:51], a[136:139], a[196:199], v[48:51]
ds_read_b64_tr_b16 a[136:137], v206 offset:16384
ds_read_b64_tr_b16 a[138:139], v206 offset:18432
v_mfma_f32_16x16x32_bf16 v[20:23], a[140:143], a[192:195], v[20:23]
buffer_load_dwordx4 v141, s[16:19], s42 offen offset:1024 lds
v_mfma_f32_16x16x32_bf16 v[52:55], a[140:143], a[196:199], v[52:55]
ds_read_b64_tr_b16 a[140:141], v207 offset:16384
ds_read_b64_tr_b16 a[142:143], v207 offset:18432
v_mfma_f32_16x16x32_bf16 v[24:27], a[144:147], a[192:195], v[24:27]
v_pk_max_u16 v160, v160, v162
v_lshlrev_b32 v161, 16, v160
v_mfma_f32_16x16x32_bf16 v[56:59], a[144:147], a[196:199], v[56:59]
ds_read_b64_tr_b16 a[144:145], v208 offset:16384
ds_read_b64_tr_b16 a[146:147], v208 offset:18432
v_mfma_f32_16x16x32_bf16 v[28:31], a[148:151], a[192:195], v[28:31]
buffer_load_dwordx4 v142, s[16:19], s42 offen offset:2048 lds
v_mfma_f32_16x16x32_bf16 v[60:63], a[148:151], a[196:199], v[60:63]
ds_read_b64_tr_b16 a[148:149], v209 offset:16384
ds_read_b64_tr_b16 a[150:151], v209 offset:18432
v_mfma_f32_16x16x32_bf16 v[32:35], a[152:155], a[192:195], v[32:35]
v_max_u32 v160, v160, v161
v_and_b32 v160, 0x7f800000, v160
v_mfma_f32_16x16x32_bf16 v[64:67], a[152:155], a[196:199], v[64:67]
ds_read_b64_tr_b16 a[152:153], v210 offset:16384
ds_read_b64_tr_b16 a[154:155], v210 offset:18432
v_mfma_f32_16x16x32_bf16 v[36:39], a[156:159], a[192:195], v[36:39]
v_nop
v_nop
v_mfma_f32_16x16x32_bf16 v[68:71], a[156:159], a[196:199], v[68:71]
buffer_load_dwordx4 v143, s[16:19], s42 offen offset:3072 lds
v_mfma_f32_16x16x32_bf16 v[80:83], a[168:171], a[192:195], v[80:83]
s_waitcnt lgkmcnt(8)
ds_read_b64_tr_b16 a[156:157], v211 offset:16384
ds_read_b64_tr_b16 a[158:159], v211 offset:18432
v_mfma_f32_16x16x32_bf16 v[112:115], a[168:171], a[196:199], v[112:115]
s_lshl_b32 s72, s72, 12
ds_read_b64_tr_b16 a[168:169], v206 offset:16640
ds_read_b64_tr_b16 a[170:171], v206 offset:18688
v_mfma_f32_16x16x32_bf16 v[84:87], a[172:175], a[192:195], v[84:87]
s_add_u32 s42, s42, s72
v_min_u32_dpp v160, v160, v160 row_ror:8 row_mask:0xf bank_mask:0xf
v_nop
v_mfma_f32_16x16x32_bf16 v[116:119], a[172:175], a[196:199], v[116:119]
ds_read_b64_tr_b16 a[172:173], v207 offset:16640
ds_read_b64_tr_b16 a[174:175], v207 offset:18688
v_mfma_f32_16x16x32_bf16 v[88:91], a[176:179], a[192:195], v[88:91]
v_nop
v_min_u32_dpp v160, v160, v160 row_ror:4 row_mask:0xf bank_mask:0xf
v_mfma_f32_16x16x32_bf16 v[120:123], a[176:179], a[196:199], v[120:123]
ds_read_b64_tr_b16 a[176:177], v208 offset:16640
ds_read_b64_tr_b16 a[178:179], v208 offset:18688
v_mfma_f32_16x16x32_bf16 v[92:95], a[180:183], a[192:195], v[92:95]
v_nop
v_nop
v_mfma_f32_16x16x32_bf16 v[124:127], a[180:183], a[196:199], v[124:127]
ds_read_b64_tr_b16 a[180:181], v209 offset:16640
ds_read_b64_tr_b16 a[182:183], v209 offset:18688
v_mfma_f32_16x16x32_bf16 v[96:99], a[184:187], a[192:195], v[96:99]
v_min_u32_dpp v160, v160, v160 row_ror:2 row_mask:0xf bank_mask:0xf
v_nop
v_mfma_f32_16x16x32_bf16 v[128:131], a[184:187], a[196:199], v[128:131]
ds_read_b64_tr_b16 a[184:185], v210 offset:16640
ds_read_b64_tr_b16 a[186:187], v210 offset:18688
v_mfma_f32_16x16x32_bf16 v[100:103], a[188:191], a[192:195], v[100:103]
v_mfma_f32_16x16x32_bf16 v[132:135], a[188:191], a[196:199], v[132:135]
ds_read_b64_tr_b16 a[188:189], v211 offset:16640
ds_read_b64_tr_b16 a[190:191], v211 offset:18688
v_mfma_f32_16x16x32_bf16 v[8:11], a[128:131], a[200:203], v[8:11]
v_nop
v_min_u32_dpp v160, v160, v160 row_ror:1 row_mask:0xf bank_mask:0xf
v_mfma_f32_16x16x32_bf16 v[40:43], a[128:131], a[204:207], v[40:43]
v_nop
v_readlane_b32 s97, v160, 0
v_mfma_f32_16x16x32_bf16 v[12:15], a[132:135], a[200:203], v[12:15]
v_readlane_b32 s46, v160, 16
v_readlane_b32 s47, v160, 32
v_mfma_f32_16x16x32_bf16 v[44:47], a[132:135], a[204:207], v[44:47]
s_min_u32 s97, s97, s46
v_readlane_b32 s46, v160, 48
v_smfmac_f32_16x16x64_bf16 a[248:251], a[208:211], a[128:135], v235
s_min_u32 s97, s97, s47
v_mfma_f32_16x16x32_bf16 v[72:75], a[160:163], a[200:203], v[72:75]
s_min_u32 s97, s97, s46
v_mfma_f32_16x16x32_bf16 v[104:107], a[160:163], a[204:207], v[104:107]
s_waitcnt vmcnt(12) lgkmcnt(0)
s_barrier
s_min_u32 s97, s97, 0x70000000
v_mfma_f32_16x16x32_bf16 v[76:79], a[164:167], a[200:203], v[76:79]
s_add_u32 m0, s45, 81920
ds_read_b128 a[192:195], v192 offset:0
ds_read_b128 a[196:199], v192 offset:2048
v_mfma_f32_16x16x32_bf16 v[108:111], a[164:167], a[204:207], v[108:111]
s_add_u32 s46, s97, 0x2400000
buffer_load_dwordx4 v144, s[24:27], s43 offen offset:0 lds
v_smfmac_f32_16x16x64_bf16 a[252:255], a[208:211], a[160:167], v235
s_cmp_lg_u32 s97, 0
s_cselect_b32 s97, s46, 0
ds_read_b64_tr_b16 a[128:129], v184 offset:0
ds_read_b64_tr_b16 a[130:131], v184 offset:2048
v_mfma_f32_16x16x32_bf16 v[16:19], a[136:139], a[200:203], v[16:19]
ds_read_b64_tr_b16 a[132:133], v185 offset:0
ds_read_b64_tr_b16 a[134:135], v185 offset:2048
v_mfma_f32_16x16x32_bf16 v[48:51], a[136:139], a[204:207], v[48:51]
ds_read_b64_tr_b16 a[160:161], v184 offset:256
ds_read_b64_tr_b16 a[162:163], v184 offset:2304
v_mfma_f32_16x16x32_bf16 v[20:23], a[140:143], a[200:203], v[20:23]
buffer_load_dwordx4 v145, s[24:27], s43 offen offset:1024 lds
v_mfma_f32_16x16x32_bf16 v[52:55], a[140:143], a[204:207], v[52:55]
ds_read_b64_tr_b16 a[164:165], v185 offset:256
ds_read_b64_tr_b16 a[166:167], v185 offset:2304
v_mfma_f32_16x16x32_bf16 v[24:27], a[144:147], a[200:203], v[24:27]
ds_read_b64_tr_b16 a[136:137], v186 offset:0
ds_read_b64_tr_b16 a[138:139], v186 offset:2048
v_mfma_f32_16x16x32_bf16 v[56:59], a[144:147], a[204:207], v[56:59]
s_add_u32 m0, s85, 81920
ds_read_b64_tr_b16 a[140:141], v187 offset:0
ds_read_b64_tr_b16 a[142:143], v187 offset:2048
v_mfma_f32_16x16x32_bf16 v[28:31], a[148:151], a[200:203], v[28:31]
buffer_load_dwordx4 v146, s[24:27], s43 offen offset:0 lds
v_mfma_f32_16x16x32_bf16 v[60:63], a[148:151], a[204:207], v[60:63]
ds_read_b64_tr_b16 a[144:145], v188 offset:0
ds_read_b64_tr_b16 a[146:147], v188 offset:2048
v_mfma_f32_16x16x32_bf16 v[32:35], a[152:155], a[200:203], v[32:35]
ds_read_b64_tr_b16 a[148:149], v189 offset:0
ds_read_b64_tr_b16 a[150:151], v189 offset:2048
v_mfma_f32_16x16x32_bf16 v[64:67], a[152:155], a[204:207], v[64:67]
ds_read_b64_tr_b16 a[152:153], v190 offset:0
ds_read_b64_tr_b16 a[154:155], v190 offset:2048
v_mfma_f32_16x16x32_bf16 v[36:39], a[156:159], a[200:203], v[36:39]
buffer_load_dwordx4 v147, s[24:27], s43 offen offset:1024 lds
v_mfma_f32_16x16x32_bf16 v[68:71], a[156:159], a[204:207], v[68:71]
ds_read_b64_tr_b16 a[156:157], v191 offset:0
ds_read_b64_tr_b16 a[158:159], v191 offset:2048
v_mfma_f32_16x16x32_bf16 v[80:83], a[168:171], a[200:203], v[80:83]
s_cmp_eq_u32 s74, 3
s_cselect_b32 s72, s73, 128
v_mov_b32 v160, s97
v_accvgpr_write_b32 a0, v160
v_mfma_f32_16x16x32_bf16 v[112:115], a[168:171], a[204:207], v[112:115]
s_add_u32 s43, s43, s72
ds_read_b64_tr_b16 a[168:169], v186 offset:256
ds_read_b64_tr_b16 a[170:171], v186 offset:2304
v_mfma_f32_16x16x32_bf16 v[84:87], a[172:175], a[200:203], v[84:87]
s_add_u32 m0, s44, 49152
v_accvgpr_write_b32 a1, v160
v_accvgpr_write_b32 a2, v160
v_mfma_f32_16x16x32_bf16 v[116:119], a[172:175], a[204:207], v[116:119]
buffer_load_dwordx4 v136, s[16:19], s42 offen offset:0 lds
v_mfma_f32_16x16x32_bf16 v[88:91], a[176:179], a[200:203], v[88:91]
ds_read_b64_tr_b16 a[172:173], v187 offset:256
ds_read_b64_tr_b16 a[174:175], v187 offset:2304
v_mfma_f32_16x16x32_bf16 v[120:123], a[176:179], a[204:207], v[120:123]
ds_read_b64_tr_b16 a[176:177], v188 offset:256
ds_read_b64_tr_b16 a[178:179], v188 offset:2304
v_mfma_f32_16x16x32_bf16 v[92:95], a[180:183], a[200:203], v[92:95]
v_accvgpr_write_b32 a3, v160
v_mfma_f32_16x16x32_bf16 v[124:127], a[180:183], a[204:207], v[124:127]
buffer_load_dwordx4 v137, s[16:19], s42 offen offset:1024 lds
v_mfma_f32_16x16x32_bf16 v[96:99], a[184:187], a[200:203], v[96:99]
ds_read_b64_tr_b16 a[180:181], v189 offset:256
ds_read_b64_tr_b16 a[182:183], v189 offset:2304
v_mfma_f32_16x16x32_bf16 v[128:131], a[184:187], a[204:207], v[128:131]
ds_read_b64_tr_b16 a[184:185], v190 offset:256
ds_read_b64_tr_b16 a[186:187], v190 offset:2304
v_mfma_f32_16x16x32_bf16 v[100:103], a[188:191], a[200:203], v[100:103]
v_mfma_f32_16x16x32_bf16 v[132:135], a[188:191], a[204:207], v[132:135]
s_waitcnt lgkmcnt(8)
ds_read_b64_tr_b16 a[188:189], v191 offset:256
ds_read_b64_tr_b16 a[190:191], v191 offset:2304
v_mfma_f32_16x16x32_bf16 v[8:11], a[128:131], a[192:195], v[8:11]
buffer_load_dwordx4 v138, s[16:19], s42 offen offset:2048 lds
v_mfma_f32_16x16x32_bf16 v[40:43], a[128:131], a[196:199], v[40:43]
ds_read_b128 a[200:203], v193 offset:0
ds_read_b128 a[204:207], v193 offset:2048
v_mfma_f32_16x16x32_bf16 v[12:15], a[132:135], a[192:195], v[12:15]
v_accvgpr_write_b32 a4, v160
v_accvgpr_write_b32 a5, v160
v_mfma_f32_16x16x32_bf16 v[44:47], a[132:135], a[196:199], v[44:47]
v_accvgpr_write_b32 a6, v160
v_accvgpr_write_b32 a7, v160
v_smfmac_f32_16x16x64_bf16 a[248:251], a[208:211], a[128:135], v235
buffer_load_dwordx4 v139, s[16:19], s42 offen offset:3072 lds
v_mfma_f32_16x16x32_bf16 v[72:75], a[160:163], a[192:195], v[72:75]
ds_read_b64_tr_b16 a[128:129], v184 offset:16384
ds_read_b64_tr_b16 a[130:131], v184 offset:18432
v_mfma_f32_16x16x32_bf16 v[104:107], a[160:163], a[196:199], v[104:107]
ds_read_b64_tr_b16 a[132:133], v185 offset:16384
ds_read_b64_tr_b16 a[134:135], v185 offset:18432
v_mfma_f32_16x16x32_bf16 v[76:79], a[164:167], a[192:195], v[76:79]
s_add_u32 m0, s44, 53248
v_accvgpr_write_b32 a8, v160
v_accvgpr_write_b32 a9, v160
v_mfma_f32_16x16x32_bf16 v[108:111], a[164:167], a[196:199], v[108:111]
buffer_load_dwordx4 v140, s[16:19], s42 offen offset:0 lds
v_smfmac_f32_16x16x64_bf16 a[252:255], a[208:211], a[160:167], v235
ds_read_b64_tr_b16 a[160:161], v184 offset:16640
ds_read_b64_tr_b16 a[162:163], v184 offset:18688
v_mfma_f32_16x16x32_bf16 v[16:19], a[136:139], a[192:195], v[16:19]
ds_read_b64_tr_b16 a[164:165], v185 offset:16640
ds_read_b64_tr_b16 a[166:167], v185 offset:18688
v_mfma_f32_16x16x32_bf16 v[48:51], a[136:139], a[196:199], v[48:51]
ds_read_b64_tr_b16 a[136:137], v186 offset:16384
ds_read_b64_tr_b16 a[138:139], v186 offset:18432
v_mfma_f32_16x16x32_bf16 v[20:23], a[140:143], a[192:195], v[20:23]
v_accvgpr_write_b32 a10, v160
v_accvgpr_write_b32 a11, v160
v_mfma_f32_16x16x32_bf16 v[52:55], a[140:143], a[196:199], v[52:55]
buffer_load_dwordx4 v141, s[16:19], s42 offen offset:1024 lds
v_mfma_f32_16x16x32_bf16 v[24:27], a[144:147], a[192:195], v[24:27]
ds_read_b64_tr_b16 a[140:141], v187 offset:16384
ds_read_b64_tr_b16 a[142:143], v187 offset:18432
v_mfma_f32_16x16x32_bf16 v[56:59], a[144:147], a[196:199], v[56:59]
ds_read_b64_tr_b16 a[144:145], v188 offset:16384
ds_read_b64_tr_b16 a[146:147], v188 offset:18432
v_mfma_f32_16x16x32_bf16 v[28:31], a[148:151], a[192:195], v[28:31]
v_accvgpr_write_b32 a12, v160
v_accvgpr_write_b32 a13, v160
v_mfma_f32_16x16x32_bf16 v[60:63], a[148:151], a[196:199], v[60:63]
buffer_load_dwordx4 v142, s[16:19], s42 offen offset:2048 lds
v_mfma_f32_16x16x32_bf16 v[32:35], a[152:155], a[192:195], v[32:35]
ds_read_b64_tr_b16 a[148:149], v189 offset:16384
ds_read_b64_tr_b16 a[150:151], v189 offset:18432
v_mfma_f32_16x16x32_bf16 v[64:67], a[152:155], a[196:199], v[64:67]
ds_read_b64_tr_b16 a[152:153], v190 offset:16384
ds_read_b64_tr_b16 a[154:155], v190 offset:18432
v_mfma_f32_16x16x32_bf16 v[36:39], a[156:159], a[192:195], v[36:39]
v_accvgpr_write_b32 a14, v160
v_accvgpr_write_b32 a15, v160
v_mfma_f32_16x16x32_bf16 v[68:71], a[156:159], a[196:199], v[68:71]
buffer_load_dwordx4 v143, s[16:19], s42 offen offset:3072 lds
v_mfma_f32_16x16x32_bf16 v[80:83], a[168:171], a[192:195], v[80:83]
s_waitcnt lgkmcnt(8)
ds_read_b64_tr_b16 a[156:157], v191 offset:16384
ds_read_b64_tr_b16 a[158:159], v191 offset:18432
v_mfma_f32_16x16x32_bf16 v[112:115], a[168:171], a[196:199], v[112:115]
s_lshl_b32 s72, s72, 12
ds_read_b64_tr_b16 a[168:169], v186 offset:16640
ds_read_b64_tr_b16 a[170:171], v186 offset:18688
v_mfma_f32_16x16x32_bf16 v[84:87], a[172:175], a[192:195], v[84:87]
s_add_u32 s42, s42, s72
v_accvgpr_write_b32 a16, v160
v_accvgpr_write_b32 a17, v160
v_mfma_f32_16x16x32_bf16 v[116:119], a[172:175], a[196:199], v[116:119]
ds_read_b64_tr_b16 a[172:173], v187 offset:16640
ds_read_b64_tr_b16 a[174:175], v187 offset:18688
v_mfma_f32_16x16x32_bf16 v[88:91], a[176:179], a[192:195], v[88:91]
v_accvgpr_write_b32 a18, v160
v_accvgpr_write_b32 a19, v160
v_mfma_f32_16x16x32_bf16 v[120:123], a[176:179], a[196:199], v[120:123]
ds_read_b64_tr_b16 a[176:177], v188 offset:16640
ds_read_b64_tr_b16 a[178:179], v188 offset:18688
v_mfma_f32_16x16x32_bf16 v[92:95], a[180:183], a[192:195], v[92:95]
v_accvgpr_write_b32 a20, v160
v_accvgpr_write_b32 a21, v160
v_mfma_f32_16x16x32_bf16 v[124:127], a[180:183], a[196:199], v[124:127]
ds_read_b64_tr_b16 a[180:181], v189 offset:16640
ds_read_b64_tr_b16 a[182:183], v189 offset:18688
v_mfma_f32_16x16x32_bf16 v[96:99], a[184:187], a[192:195], v[96:99]
v_accvgpr_write_b32 a22, v160
v_accvgpr_write_b32 a23, v160
v_mfma_f32_16x16x32_bf16 v[128:131], a[184:187], a[196:199], v[128:131]
ds_read_b64_tr_b16 a[184:185], v190 offset:16640
ds_read_b64_tr_b16 a[186:187], v190 offset:18688
v_mfma_f32_16x16x32_bf16 v[100:103], a[188:191], a[192:195], v[100:103]
v_mfma_f32_16x16x32_bf16 v[132:135], a[188:191], a[196:199], v[132:135]
ds_read_b64_tr_b16 a[188:189], v191 offset:16640
ds_read_b64_tr_b16 a[190:191], v191 offset:18688
v_mfma_f32_16x16x32_bf16 v[8:11], a[128:131], a[200:203], v[8:11]
v_accvgpr_write_b32 a24, v160
v_accvgpr_write_b32 a25, v160
v_mfma_f32_16x16x32_bf16 v[40:43], a[128:131], a[204:207], v[40:43]
v_accvgpr_write_b32 a26, v160
v_accvgpr_write_b32 a27, v160
v_mfma_f32_16x16x32_bf16 v[12:15], a[132:135], a[200:203], v[12:15]
v_accvgpr_write_b32 a28, v160
v_accvgpr_write_b32 a29, v160
v_mfma_f32_16x16x32_bf16 v[44:47], a[132:135], a[204:207], v[44:47]
v_accvgpr_write_b32 a30, v160
v_accvgpr_write_b32 a31, v160
v_smfmac_f32_16x16x64_bf16 a[248:251], a[208:211], a[128:135], v235
v_accvgpr_write_b32 a32, v160
v_accvgpr_write_b32 a33, v160
v_mfma_f32_16x16x32_bf16 v[72:75], a[160:163], a[200:203], v[72:75]
v_accvgpr_write_b32 a34, v160
v_accvgpr_write_b32 a35, v160
v_mfma_f32_16x16x32_bf16 v[104:107], a[160:163], a[204:207], v[104:107]
s_waitcnt vmcnt(12) lgkmcnt(0)
s_barrier
v_mfma_f32_16x16x32_bf16 v[76:79], a[164:167], a[200:203], v[76:79]
s_add_u32 m0, s45, 32768
ds_read_b128 a[192:195], v202 offset:0
ds_read_b128 a[196:199], v202 offset:2048
v_mfma_f32_16x16x32_bf16 v[108:111], a[164:167], a[204:207], v[108:111]
buffer_load_dwordx4 v144, s[24:27], s43 offen offset:0 lds
v_smfmac_f32_16x16x64_bf16 a[252:255], a[208:211], a[160:167], v235
ds_read_b64_tr_b16 a[128:129], v194 offset:0
ds_read_b64_tr_b16 a[130:131], v194 offset:2048
v_mfma_f32_16x16x32_bf16 v[16:19], a[136:139], a[200:203], v[16:19]
ds_read_b64_tr_b16 a[132:133], v195 offset:0
ds_read_b64_tr_b16 a[134:135], v195 offset:2048
v_mfma_f32_16x16x32_bf16 v[48:51], a[136:139], a[204:207], v[48:51]
ds_read_b64_tr_b16 a[160:161], v194 offset:256
ds_read_b64_tr_b16 a[162:163], v194 offset:2304
v_mfma_f32_16x16x32_bf16 v[20:23], a[140:143], a[200:203], v[20:23]
buffer_load_dwordx4 v145, s[24:27], s43 offen offset:1024 lds
v_mfma_f32_16x16x32_bf16 v[52:55], a[140:143], a[204:207], v[52:55]
ds_read_b64_tr_b16 a[164:165], v195 offset:256
ds_read_b64_tr_b16 a[166:167], v195 offset:2304
v_mfma_f32_16x16x32_bf16 v[24:27], a[144:147], a[200:203], v[24:27]
ds_read_b64_tr_b16 a[136:137], v196 offset:0
ds_read_b64_tr_b16 a[138:139], v196 offset:2048
v_mfma_f32_16x16x32_bf16 v[56:59], a[144:147], a[204:207], v[56:59]
ds_read_b64_tr_b16 a[140:141], v197 offset:0
ds_read_b64_tr_b16 a[142:143], v197 offset:2048
v_mfma_f32_16x16x32_bf16 v[28:31], a[148:151], a[200:203], v[28:31]
s_add_u32 m0, s85, 32768
ds_read_b64_tr_b16 a[144:145], v198 offset:0
ds_read_b64_tr_b16 a[146:147], v198 offset:2048
v_mfma_f32_16x16x32_bf16 v[60:63], a[148:151], a[204:207], v[60:63]
buffer_load_dwordx4 v146, s[24:27], s43 offen offset:0 lds
v_mfma_f32_16x16x32_bf16 v[32:35], a[152:155], a[200:203], v[32:35]
ds_read_b64_tr_b16 a[148:149], v199 offset:0
ds_read_b64_tr_b16 a[150:151], v199 offset:2048
v_mfma_f32_16x16x32_bf16 v[64:67], a[152:155], a[204:207], v[64:67]
ds_read_b64_tr_b16 a[152:153], v200 offset:0
ds_read_b64_tr_b16 a[154:155], v200 offset:2048
v_mfma_f32_16x16x32_bf16 v[36:39], a[156:159], a[200:203], v[36:39]
v_accvgpr_write_b32 a36, v160
v_accvgpr_write_b32 a37, v160
v_mfma_f32_16x16x32_bf16 v[68:71], a[156:159], a[204:207], v[68:71]
buffer_load_dwordx4 v147, s[24:27], s43 offen offset:1024 lds
v_mfma_f32_16x16x32_bf16 v[80:83], a[168:171], a[200:203], v[80:83]
s_cmp_eq_u32 s74, 2
s_cselect_b32 s72, s73, 128
ds_read_b64_tr_b16 a[156:157], v201 offset:0
ds_read_b64_tr_b16 a[158:159], v201 offset:2048
v_mfma_f32_16x16x32_bf16 v[112:115], a[168:171], a[204:207], v[112:115]
s_add_u32 s43, s43, s72
ds_read_b64_tr_b16 a[168:169], v196 offset:256
ds_read_b64_tr_b16 a[170:171], v196 offset:2304
v_mfma_f32_16x16x32_bf16 v[84:87], a[172:175], a[200:203], v[84:87]
s_add_u32 m0, s44, 0
v_accvgpr_write_b32 a38, v160
v_accvgpr_write_b32 a39, v160
v_mfma_f32_16x16x32_bf16 v[116:119], a[172:175], a[204:207], v[116:119]
buffer_load_dwordx4 v136, s[16:19], s42 offen offset:0 lds
v_mfma_f32_16x16x32_bf16 v[88:91], a[176:179], a[200:203], v[88:91]
ds_read_b64_tr_b16 a[172:173], v197 offset:256
ds_read_b64_tr_b16 a[174:175], v197 offset:2304
v_mfma_f32_16x16x32_bf16 v[120:123], a[176:179], a[204:207], v[120:123]
ds_read_b64_tr_b16 a[176:177], v198 offset:256
ds_read_b64_tr_b16 a[178:179], v198 offset:2304
v_mfma_f32_16x16x32_bf16 v[92:95], a[180:183], a[200:203], v[92:95]
v_accvgpr_write_b32 a40, v160
v_accvgpr_write_b32 a41, v160
v_mfma_f32_16x16x32_bf16 v[124:127], a[180:183], a[204:207], v[124:127]
buffer_load_dwordx4 v137, s[16:19], s42 offen offset:1024 lds
v_mfma_f32_16x16x32_bf16 v[96:99], a[184:187], a[200:203], v[96:99]
ds_read_b64_tr_b16 a[180:181], v199 offset:256
ds_read_b64_tr_b16 a[182:183], v199 offset:2304
v_mfma_f32_16x16x32_bf16 v[128:131], a[184:187], a[204:207], v[128:131]
ds_read_b64_tr_b16 a[184:185], v200 offset:256
ds_read_b64_tr_b16 a[186:187], v200 offset:2304
v_mfma_f32_16x16x32_bf16 v[100:103], a[188:191], a[200:203], v[100:103]
v_mfma_f32_16x16x32_bf16 v[132:135], a[188:191], a[204:207], v[132:135]
s_waitcnt lgkmcnt(8)
ds_read_b64_tr_b16 a[188:189], v201 offset:256
ds_read_b64_tr_b16 a[190:191], v201 offset:2304
v_mfma_f32_16x16x32_bf16 v[8:11], a[128:131], a[192:195], v[8:11]
buffer_load_dwordx4 v138, s[16:19], s42 offen offset:2048 lds
v_mfma_f32_16x16x32_bf16 v[40:43], a[128:131], a[196:199], v[40:43]
ds_read_b128 a[200:203], v203 offset:0
ds_read_b128 a[204:207], v203 offset:2048
v_mfma_f32_16x16x32_bf16 v[12:15], a[132:135], a[192:195], v[12:15]
v_accvgpr_write_b32 a42, v160
v_accvgpr_write_b32 a43, v160
v_mfma_f32_16x16x32_bf16 v[44:47], a[132:135], a[196:199], v[44:47]
v_accvgpr_write_b32 a44, v160
v_accvgpr_write_b32 a45, v160
v_smfmac_f32_16x16x64_bf16 a[248:251], a[208:211], a[128:135], v235
ds_read_b64_tr_b16 a[128:129], v194 offset:16384
ds_read_b64_tr_b16 a[130:131], v194 offset:18432
v_mfma_f32_16x16x32_bf16 v[72:75], a[160:163], a[192:195], v[72:75]
buffer_load_dwordx4 v139, s[16:19], s42 offen offset:3072 lds
v_mfma_f32_16x16x32_bf16 v[104:107], a[160:163], a[196:199], v[104:107]
ds_read_b64_tr_b16 a[132:133], v195 offset:16384
ds_read_b64_tr_b16 a[134:135], v195 offset:18432
v_mfma_f32_16x16x32_bf16 v[76:79], a[164:167], a[192:195], v[76:79]
v_accvgpr_write_b32 a46, v160
v_accvgpr_write_b32 a47, v160
v_mfma_f32_16x16x32_bf16 v[108:111], a[164:167], a[196:199], v[108:111]
s_add_u32 m0, s44, 4096
v_accvgpr_write_b32 a48, v160
v_accvgpr_write_b32 a49, v160
v_smfmac_f32_16x16x64_bf16 a[252:255], a[208:211], a[160:167], v235
buffer_load_dwordx4 v140, s[16:19], s42 offen offset:0 lds
v_mfma_f32_16x16x32_bf16 v[16:19], a[136:139], a[192:195], v[16:19]
ds_read_b64_tr_b16 a[160:161], v194 offset:16640
ds_read_b64_tr_b16 a[162:163], v194 offset:18688
v_mfma_f32_16x16x32_bf16 v[48:51], a[136:139], a[196:199], v[48:51]
ds_read_b64_tr_b16 a[164:165], v195 offset:16640
ds_read_b64_tr_b16 a[166:167], v195 offset:18688
v_mfma_f32_16x16x32_bf16 v[20:23], a[140:143], a[192:195], v[20:23]
ds_read_b64_tr_b16 a[136:137], v196 offset:16384
ds_read_b64_tr_b16 a[138:139], v196 offset:18432
v_mfma_f32_16x16x32_bf16 v[52:55], a[140:143], a[196:199], v[52:55]
buffer_load_dwordx4 v141, s[16:19], s42 offen offset:1024 lds
v_mfma_f32_16x16x32_bf16 v[24:27], a[144:147], a[192:195], v[24:27]
ds_read_b64_tr_b16 a[140:141], v197 offset:16384
ds_read_b64_tr_b16 a[142:143], v197 offset:18432
v_mfma_f32_16x16x32_bf16 v[56:59], a[144:147], a[196:199], v[56:59]
ds_read_b64_tr_b16 a[144:145], v198 offset:16384
ds_read_b64_tr_b16 a[146:147], v198 offset:18432
v_mfma_f32_16x16x32_bf16 v[28:31], a[148:151], a[192:195], v[28:31]
v_accvgpr_write_b32 a50, v160
v_accvgpr_write_b32 a51, v160
v_mfma_f32_16x16x32_bf16 v[60:63], a[148:151], a[196:199], v[60:63]
buffer_load_dwordx4 v142, s[16:19], s42 offen offset:2048 lds
v_mfma_f32_16x16x32_bf16 v[32:35], a[152:155], a[192:195], v[32:35]
ds_read_b64_tr_b16 a[148:149], v199 offset:16384
ds_read_b64_tr_b16 a[150:151], v199 offset:18432
v_mfma_f32_16x16x32_bf16 v[64:67], a[152:155], a[196:199], v[64:67]
ds_read_b64_tr_b16 a[152:153], v200 offset:16384
ds_read_b64_tr_b16 a[154:155], v200 offset:18432
v_mfma_f32_16x16x32_bf16 v[36:39], a[156:159], a[192:195], v[36:39]
v_accvgpr_write_b32 a52, v160
v_accvgpr_write_b32 a53, v160
v_mfma_f32_16x16x32_bf16 v[68:71], a[156:159], a[196:199], v[68:71]
buffer_load_dwordx4 v143, s[16:19], s42 offen offset:3072 lds
v_mfma_f32_16x16x32_bf16 v[80:83], a[168:171], a[192:195], v[80:83]
s_lshl_b32 s72, s72, 12
ds_read_b64_tr_b16 a[156:157], v201 offset:16384
ds_read_b64_tr_b16 a[158:159], v201 offset:18432
v_mfma_f32_16x16x32_bf16 v[112:115], a[168:171], a[196:199], v[112:115]
s_waitcnt lgkmcnt(10)
s_add_u32 s42, s42, s72
ds_read_b64_tr_b16 a[168:169], v196 offset:16640
ds_read_b64_tr_b16 a[170:171], v196 offset:18688
v_mfma_f32_16x16x32_bf16 v[84:87], a[172:175], a[192:195], v[84:87]
s_lshr_b32 s48, s2, 5
v_accvgpr_write_b32 a54, v160
v_accvgpr_write_b32 a55, v160
v_mfma_f32_16x16x32_bf16 v[116:119], a[172:175], a[196:199], v[116:119]
s_lshl_b32 s48, s48, 13
ds_read_b64_tr_b16 a[172:173], v197 offset:16640
v_lshlrev_b32 v254, 5, v0
v_mfma_f32_16x16x32_bf16 v[88:91], a[176:179], a[192:195], v[88:91]
buffer_load_dword v252, v254, s[8:11], s48 offen
v_mfma_f32_16x16x32_bf16 v[120:123], a[176:179], a[196:199], v[120:123]
ds_read_b64_tr_b16 a[174:175], v197 offset:18688
ds_read_b64_tr_b16 a[176:177], v198 offset:16640
v_mfma_f32_16x16x32_bf16 v[92:95], a[180:183], a[192:195], v[92:95]
ds_read_b64_tr_b16 a[178:179], v198 offset:18688
v_accvgpr_write_b32 a56, v160
v_mfma_f32_16x16x32_bf16 v[124:127], a[180:183], a[196:199], v[124:127]
ds_read_b64_tr_b16 a[180:181], v199 offset:16640
ds_read_b64_tr_b16 a[182:183], v199 offset:18688
v_mfma_f32_16x16x32_bf16 v[96:99], a[184:187], a[192:195], v[96:99]
buffer_load_dword v253, v254, s[12:15], s48 offen
v_mfma_f32_16x16x32_bf16 v[128:131], a[184:187], a[196:199], v[128:131]
ds_read_b64_tr_b16 a[184:185], v200 offset:16640
ds_read_b64_tr_b16 a[186:187], v200 offset:18688
v_mfma_f32_16x16x32_bf16 v[100:103], a[188:191], a[192:195], v[100:103]
v_accvgpr_write_b32 a57, v160
v_mfma_f32_16x16x32_bf16 v[132:135], a[188:191], a[196:199], v[132:135]
ds_read_b64_tr_b16 a[188:189], v201 offset:16640
ds_read_b64_tr_b16 a[190:191], v201 offset:18688
v_mfma_f32_16x16x32_bf16 v[8:11], a[128:131], a[200:203], v[8:11]
v_accvgpr_write_b32 a58, v160
v_accvgpr_write_b32 a59, v160
v_mfma_f32_16x16x32_bf16 v[40:43], a[128:131], a[204:207], v[40:43]
v_accvgpr_write_b32 a60, v160
v_accvgpr_write_b32 a61, v160
v_mfma_f32_16x16x32_bf16 v[12:15], a[132:135], a[200:203], v[12:15]
v_accvgpr_write_b32 a62, v160
v_accvgpr_write_b32 a63, v160
v_mfma_f32_16x16x32_bf16 v[44:47], a[132:135], a[204:207], v[44:47]
v_accvgpr_write_b32 a64, v160
v_accvgpr_write_b32 a65, v160
v_smfmac_f32_16x16x64_bf16 a[248:251], a[208:211], a[128:135], v235
v_accvgpr_write_b32 a66, v160
v_accvgpr_write_b32 a67, v160
v_mfma_f32_16x16x32_bf16 v[72:75], a[160:163], a[200:203], v[72:75]
v_accvgpr_write_b32 a68, v160
v_accvgpr_write_b32 a69, v160
v_mfma_f32_16x16x32_bf16 v[104:107], a[160:163], a[204:207], v[104:107]
s_waitcnt vmcnt(14) lgkmcnt(0)
s_barrier
v_mfma_f32_16x16x32_bf16 v[76:79], a[164:167], a[200:203], v[76:79]
s_add_u32 m0, s45, 131072
ds_read_b128 a[192:195], v212 offset:0
ds_read_b128 a[196:199], v212 offset:2048
v_mfma_f32_16x16x32_bf16 v[108:111], a[164:167], a[204:207], v[108:111]
buffer_load_dwordx4 v144, s[24:27], s43 offen offset:0 lds
v_smfmac_f32_16x16x64_bf16 a[252:255], a[208:211], a[160:167], v235
ds_read_b64_tr_b16 a[128:129], v204 offset:0
ds_read_b64_tr_b16 a[130:131], v204 offset:2048
v_mfma_f32_16x16x32_bf16 v[16:19], a[136:139], a[200:203], v[16:19]
ds_read_b64_tr_b16 a[132:133], v205 offset:0
ds_read_b64_tr_b16 a[134:135], v205 offset:2048
v_mfma_f32_16x16x32_bf16 v[48:51], a[136:139], a[204:207], v[48:51]
ds_read_b64_tr_b16 a[160:161], v204 offset:256
ds_read_b64_tr_b16 a[162:163], v204 offset:2304
v_mfma_f32_16x16x32_bf16 v[20:23], a[140:143], a[200:203], v[20:23]
buffer_load_dwordx4 v145, s[24:27], s43 offen offset:1024 lds
v_mfma_f32_16x16x32_bf16 v[52:55], a[140:143], a[204:207], v[52:55]
ds_read_b64_tr_b16 a[164:165], v205 offset:256
ds_read_b64_tr_b16 a[166:167], v205 offset:2304
v_mfma_f32_16x16x32_bf16 v[24:27], a[144:147], a[200:203], v[24:27]
ds_read_b64_tr_b16 a[136:137], v206 offset:0
ds_read_b64_tr_b16 a[138:139], v206 offset:2048
v_mfma_f32_16x16x32_bf16 v[56:59], a[144:147], a[204:207], v[56:59]
s_add_u32 m0, s85, 131072
ds_read_b64_tr_b16 a[140:141], v207 offset:0
ds_read_b64_tr_b16 a[142:143], v207 offset:2048
v_mfma_f32_16x16x32_bf16 v[28:31], a[148:151], a[200:203], v[28:31]
buffer_load_dwordx4 v146, s[24:27], s43 offen offset:0 lds
v_mfma_f32_16x16x32_bf16 v[60:63], a[148:151], a[204:207], v[60:63]
ds_read_b64_tr_b16 a[144:145], v208 offset:0
ds_read_b64_tr_b16 a[146:147], v208 offset:2048
v_mfma_f32_16x16x32_bf16 v[32:35], a[152:155], a[200:203], v[32:35]
ds_read_b64_tr_b16 a[148:149], v209 offset:0
ds_read_b64_tr_b16 a[150:151], v209 offset:2048
v_mfma_f32_16x16x32_bf16 v[64:67], a[152:155], a[204:207], v[64:67]
ds_read_b64_tr_b16 a[152:153], v210 offset:0
ds_read_b64_tr_b16 a[154:155], v210 offset:2048
v_mfma_f32_16x16x32_bf16 v[36:39], a[156:159], a[200:203], v[36:39]
v_accvgpr_write_b32 a70, v160
v_accvgpr_write_b32 a71, v160
v_mfma_f32_16x16x32_bf16 v[68:71], a[156:159], a[204:207], v[68:71]
buffer_load_dwordx4 v147, s[24:27], s43 offen offset:1024 lds
v_mfma_f32_16x16x32_bf16 v[80:83], a[168:171], a[200:203], v[80:83]
s_cmp_eq_u32 s74, 1
s_cselect_b32 s72, s73, 128
ds_read_b64_tr_b16 a[156:157], v211 offset:0
ds_read_b64_tr_b16 a[158:159], v211 offset:2048
v_mfma_f32_16x16x32_bf16 v[112:115], a[168:171], a[204:207], v[112:115]
s_add_u32 s43, s43, s72
ds_read_b64_tr_b16 a[168:169], v206 offset:256
ds_read_b64_tr_b16 a[170:171], v206 offset:2304
v_mfma_f32_16x16x32_bf16 v[84:87], a[172:175], a[200:203], v[84:87]
s_add_u32 m0, s44, 98304
v_accvgpr_write_b32 a72, v160
v_accvgpr_write_b32 a73, v160
v_mfma_f32_16x16x32_bf16 v[116:119], a[172:175], a[204:207], v[116:119]
buffer_load_dwordx4 v136, s[16:19], s42 offen offset:0 lds
v_mfma_f32_16x16x32_bf16 v[88:91], a[176:179], a[200:203], v[88:91]
ds_read_b64_tr_b16 a[172:173], v207 offset:256
ds_read_b64_tr_b16 a[174:175], v207 offset:2304
v_mfma_f32_16x16x32_bf16 v[120:123], a[176:179], a[204:207], v[120:123]
ds_read_b64_tr_b16 a[176:177], v208 offset:256
ds_read_b64_tr_b16 a[178:179], v208 offset:2304
v_mfma_f32_16x16x32_bf16 v[92:95], a[180:183], a[200:203], v[92:95]
v_accvgpr_write_b32 a74, v160
v_accvgpr_write_b32 a75, v160
v_mfma_f32_16x16x32_bf16 v[124:127], a[180:183], a[204:207], v[124:127]
buffer_load_dwordx4 v137, s[16:19], s42 offen offset:1024 lds
v_mfma_f32_16x16x32_bf16 v[96:99], a[184:187], a[200:203], v[96:99]
ds_read_b64_tr_b16 a[180:181], v209 offset:256
ds_read_b64_tr_b16 a[182:183], v209 offset:2304
v_mfma_f32_16x16x32_bf16 v[128:131], a[184:187], a[204:207], v[128:131]
ds_read_b64_tr_b16 a[184:185], v210 offset:256
ds_read_b64_tr_b16 a[186:187], v210 offset:2304
v_mfma_f32_16x16x32_bf16 v[100:103], a[188:191], a[200:203], v[100:103]
v_mfma_f32_16x16x32_bf16 v[132:135], a[188:191], a[204:207], v[132:135]
s_waitcnt lgkmcnt(8)
ds_read_b64_tr_b16 a[188:189], v211 offset:256
ds_read_b64_tr_b16 a[190:191], v211 offset:2304
v_mfma_f32_16x16x32_bf16 v[8:11], a[128:131], a[192:195], v[8:11]
buffer_load_dwordx4 v138, s[16:19], s42 offen offset:2048 lds
v_mfma_f32_16x16x32_bf16 v[40:43], a[128:131], a[196:199], v[40:43]
ds_read_b128 a[200:203], v213 offset:0
ds_read_b128 a[204:207], v213 offset:2048
v_mfma_f32_16x16x32_bf16 v[12:15], a[132:135], a[192:195], v[12:15]
v_accvgpr_write_b32 a76, v160
v_accvgpr_write_b32 a77, v160
v_mfma_f32_16x16x32_bf16 v[44:47], a[132:135], a[196:199], v[44:47]
v_accvgpr_write_b32 a78, v160
v_accvgpr_write_b32 a79, v160
v_smfmac_f32_16x16x64_bf16 a[248:251], a[208:211], a[128:135], v235
buffer_load_dwordx4 v139, s[16:19], s42 offen offset:3072 lds
v_mfma_f32_16x16x32_bf16 v[72:75], a[160:163], a[192:195], v[72:75]
ds_read_b64_tr_b16 a[128:129], v204 offset:16384
ds_read_b64_tr_b16 a[130:131], v204 offset:18432
v_mfma_f32_16x16x32_bf16 v[104:107], a[160:163], a[196:199], v[104:107]
ds_read_b64_tr_b16 a[132:133], v205 offset:16384
ds_read_b64_tr_b16 a[134:135], v205 offset:18432
v_mfma_f32_16x16x32_bf16 v[76:79], a[164:167], a[192:195], v[76:79]
v_accvgpr_write_b32 a80, v160
v_accvgpr_write_b32 a81, v160
v_mfma_f32_16x16x32_bf16 v[108:111], a[164:167], a[196:199], v[108:111]
s_add_u32 m0, s44, 102400
v_accvgpr_write_b32 a82, v160
v_accvgpr_write_b32 a83, v160
v_smfmac_f32_16x16x64_bf16 a[252:255], a[208:211], a[160:167], v235
buffer_load_dwordx4 v140, s[16:19], s42 offen offset:0 lds
v_mfma_f32_16x16x32_bf16 v[16:19], a[136:139], a[192:195], v[16:19]
ds_read_b64_tr_b16 a[160:161], v204 offset:16640
ds_read_b64_tr_b16 a[162:163], v204 offset:18688
v_mfma_f32_16x16x32_bf16 v[48:51], a[136:139], a[196:199], v[48:51]
ds_read_b64_tr_b16 a[164:165], v205 offset:16640
ds_read_b64_tr_b16 a[166:167], v205 offset:18688
v_mfma_f32_16x16x32_bf16 v[20:23], a[140:143], a[192:195], v[20:23]
ds_read_b64_tr_b16 a[136:137], v206 offset:16384
ds_read_b64_tr_b16 a[138:139], v206 offset:18432
v_mfma_f32_16x16x32_bf16 v[52:55], a[140:143], a[196:199], v[52:55]
buffer_load_dwordx4 v141, s[16:19], s42 offen offset:1024 lds
v_mfma_f32_16x16x32_bf16 v[24:27], a[144:147], a[192:195], v[24:27]
ds_read_b64_tr_b16 a[140:141], v207 offset:16384
ds_read_b64_tr_b16 a[142:143], v207 offset:18432
v_mfma_f32_16x16x32_bf16 v[56:59], a[144:147], a[196:199], v[56:59]
ds_read_b64_tr_b16 a[144:145], v208 offset:16384
ds_read_b64_tr_b16 a[146:147], v208 offset:18432
v_mfma_f32_16x16x32_bf16 v[28:31], a[148:151], a[192:195], v[28:31]
v_accvgpr_write_b32 a84, v160
v_accvgpr_write_b32 a85, v160
v_mfma_f32_16x16x32_bf16 v[60:63], a[148:151], a[196:199], v[60:63]
buffer_load_dwordx4 v142, s[16:19], s42 offen offset:2048 lds
v_mfma_f32_16x16x32_bf16 v[32:35], a[152:155], a[192:195], v[32:35]
ds_read_b64_tr_b16 a[148:149], v209 offset:16384
ds_read_b64_tr_b16 a[150:151], v209 offset:18432
v_mfma_f32_16x16x32_bf16 v[64:67], a[152:155], a[196:199], v[64:67]
ds_read_b64_tr_b16 a[152:153], v210 offset:16384
ds_read_b64_tr_b16 a[154:155], v210 offset:18432
v_mfma_f32_16x16x32_bf16 v[36:39], a[156:159], a[192:195], v[36:39]
v_accvgpr_write_b32 a86, v160
v_accvgpr_write_b32 a87, v160
v_mfma_f32_16x16x32_bf16 v[68:71], a[156:159], a[196:199], v[68:71]
buffer_load_dwordx4 v143, s[16:19], s42 offen offset:3072 lds
v_mfma_f32_16x16x32_bf16 v[80:83], a[168:171], a[192:195], v[80:83]
s_lshl_b32 s72, s72, 12
ds_read_b64_tr_b16 a[156:157], v211 offset:16384
ds_read_b64_tr_b16 a[158:159], v211 offset:18432
v_mfma_f32_16x16x32_bf16 v[112:115], a[168:171], a[196:199], v[112:115]
s_waitcnt lgkmcnt(10)
s_add_u32 s42, s42, s72
ds_read_b64_tr_b16 a[168:169], v206 offset:16640
ds_read_b64_tr_b16 a[170:171], v206 offset:18688
v_mfma_f32_16x16x32_bf16 v[84:87], a[172:175], a[192:195], v[84:87]
s_mov_b32 m0, s83
v_accvgpr_write_b32 a88, v160
v_accvgpr_write_b32 a89, v160
v_mfma_f32_16x16x32_bf16 v[116:119], a[172:175], a[196:199], v[116:119]
buffer_load_dwordx4 v144, s[24:27], s80 offen lds
v_mfma_f32_16x16x32_bf16 v[88:91], a[176:179], a[192:195], v[88:91]
ds_read_b64_tr_b16 a[172:173], v207 offset:16640
ds_read_b64_tr_b16 a[174:175], v207 offset:18688
v_mfma_f32_16x16x32_bf16 v[120:123], a[176:179], a[196:199], v[120:123]
ds_read_b64_tr_b16 a[176:177], v208 offset:16640
ds_read_b64_tr_b16 a[178:179], v208 offset:18688
v_mfma_f32_16x16x32_bf16 v[92:95], a[180:183], a[192:195], v[92:95]
v_accvgpr_write_b32 a90, v160
v_accvgpr_write_b32 a91, v160
v_mfma_f32_16x16x32_bf16 v[124:127], a[180:183], a[196:199], v[124:127]
ds_read_b64_tr_b16 a[180:181], v209 offset:16640
ds_read_b64_tr_b16 a[182:183], v209 offset:18688
v_mfma_f32_16x16x32_bf16 v[96:99], a[184:187], a[192:195], v[96:99]
buffer_load_dwordx4 v145, s[24:27], s80 offen offset:1024 lds
v_mfma_f32_16x16x32_bf16 v[128:131], a[184:187], a[196:199], v[128:131]
ds_read_b64_tr_b16 a[184:185], v210 offset:16640
ds_read_b64_tr_b16 a[186:187], v210 offset:18688
v_mfma_f32_16x16x32_bf16 v[100:103], a[188:191], a[192:195], v[100:103]
v_mfma_f32_16x16x32_bf16 v[132:135], a[188:191], a[196:199], v[132:135]
ds_read_b64_tr_b16 a[188:189], v211 offset:16640
ds_read_b64_tr_b16 a[190:191], v211 offset:18688
v_mfma_f32_16x16x32_bf16 v[8:11], a[128:131], a[200:203], v[8:11]
buffer_load_dwordx2 a[244:245], v240, s[24:27], s81 offen
v_mfma_f32_16x16x32_bf16 v[40:43], a[128:131], a[204:207], v[40:43]
v_accvgpr_write_b32 a92, v160
v_accvgpr_write_b32 a93, v160
v_mfma_f32_16x16x32_bf16 v[12:15], a[132:135], a[200:203], v[12:15]
v_accvgpr_write_b32 a94, v160
v_accvgpr_write_b32 a95, v160
v_mfma_f32_16x16x32_bf16 v[44:47], a[132:135], a[204:207], v[44:47]
v_accvgpr_write_b32 a96, v160
v_accvgpr_write_b32 a97, v160
v_smfmac_f32_16x16x64_bf16 a[248:251], a[208:211], a[128:135], v235
v_accvgpr_write_b32 a98, v160
v_accvgpr_write_b32 a99, v160
v_mfma_f32_16x16x32_bf16 v[72:75], a[160:163], a[200:203], v[72:75]
v_accvgpr_write_b32 a100, v160
v_accvgpr_write_b32 a101, v160
v_mfma_f32_16x16x32_bf16 v[104:107], a[160:163], a[204:207], v[104:107]
s_waitcnt vmcnt(17) lgkmcnt(0)
s_barrier
s_cmp_lg_u32 s32, 0
s_cbranch_scc1 K_W0_11
v_lshlrev_b32 v255, 4, v3
buffer_load_dword v254, v255, s[28:31], 0 offen sc0 sc1
K_W0_11:
v_mfma_f32_16x16x32_bf16 v[76:79], a[164:167], a[200:203], v[76:79]
s_add_u32 m0, s45, 81920
ds_read_b128 a[192:195], v192 offset:0
ds_read_b128 a[196:199], v192 offset:2048
v_mfma_f32_16x16x32_bf16 v[108:111], a[164:167], a[204:207], v[108:111]
buffer_load_dwordx4 v144, s[24:27], s43 offen offset:0 lds
v_smfmac_f32_16x16x64_bf16 a[252:255], a[208:211], a[160:167], v235
ds_read_b64_tr_b16 a[128:129], v184 offset:0
ds_read_b64_tr_b16 a[130:131], v184 offset:2048
v_mfma_f32_16x16x32_bf16 v[16:19], a[136:139], a[200:203], v[16:19]
ds_read_b64_tr_b16 a[132:133], v185 offset:0
ds_read_b64_tr_b16 a[134:135], v185 offset:2048
v_mfma_f32_16x16x32_bf16 v[48:51], a[136:139], a[204:207], v[48:51]
ds_read_b64_tr_b16 a[160:161], v184 offset:256
ds_read_b64_tr_b16 a[162:163], v184 offset:2304
v_mfma_f32_16x16x32_bf16 v[20:23], a[140:143], a[200:203], v[20:23]
buffer_load_dwordx4 v145, s[24:27], s43 offen offset:1024 lds
v_mfma_f32_16x16x32_bf16 v[52:55], a[140:143], a[204:207], v[52:55]
ds_read_b64_tr_b16 a[164:165], v185 offset:256
ds_read_b64_tr_b16 a[166:167], v185 offset:2304
v_mfma_f32_16x16x32_bf16 v[24:27], a[144:147], a[200:203], v[24:27]
ds_read_b64_tr_b16 a[136:137], v186 offset:0
ds_read_b64_tr_b16 a[138:139], v186 offset:2048
v_mfma_f32_16x16x32_bf16 v[56:59], a[144:147], a[204:207], v[56:59]
s_add_u32 m0, s85, 81920
ds_read_b64_tr_b16 a[140:141], v187 offset:0
ds_read_b64_tr_b16 a[142:143], v187 offset:2048
v_mfma_f32_16x16x32_bf16 v[28:31], a[148:151], a[200:203], v[28:31]
buffer_load_dwordx4 v146, s[24:27], s43 offen offset:0 lds
v_mfma_f32_16x16x32_bf16 v[60:63], a[148:151], a[204:207], v[60:63]
ds_read_b64_tr_b16 a[144:145], v188 offset:0
ds_read_b64_tr_b16 a[146:147], v188 offset:2048
v_mfma_f32_16x16x32_bf16 v[32:35], a[152:155], a[200:203], v[32:35]
ds_read_b64_tr_b16 a[148:149], v189 offset:0
ds_read_b64_tr_b16 a[150:151], v189 offset:2048
v_mfma_f32_16x16x32_bf16 v[64:67], a[152:155], a[204:207], v[64:67]
ds_read_b64_tr_b16 a[152:153], v190 offset:0
ds_read_b64_tr_b16 a[154:155], v190 offset:2048
v_mfma_f32_16x16x32_bf16 v[36:39], a[156:159], a[200:203], v[36:39]
v_accvgpr_write_b32 a102, v160
v_accvgpr_write_b32 a103, v160
v_mfma_f32_16x16x32_bf16 v[68:71], a[156:159], a[204:207], v[68:71]
buffer_load_dwordx4 v147, s[24:27], s43 offen offset:1024 lds
v_mfma_f32_16x16x32_bf16 v[80:83], a[168:171], a[200:203], v[80:83]
s_cmp_eq_u32 s74, 0
s_cselect_b32 s72, s73, 128
ds_read_b64_tr_b16 a[156:157], v191 offset:0
ds_read_b64_tr_b16 a[158:159], v191 offset:2048
v_mfma_f32_16x16x32_bf16 v[112:115], a[168:171], a[204:207], v[112:115]
s_add_u32 s43, s43, s72
ds_read_b64_tr_b16 a[168:169], v186 offset:256
ds_read_b64_tr_b16 a[170:171], v186 offset:2304
v_mfma_f32_16x16x32_bf16 v[84:87], a[172:175], a[200:203], v[84:87]
s_add_u32 m0, s44, 49152
v_accvgpr_write_b32 a104, v160
v_accvgpr_write_b32 a105, v160
v_mfma_f32_16x16x32_bf16 v[116:119], a[172:175], a[204:207], v[116:119]
buffer_load_dwordx4 v136, s[16:19], s42 offen offset:0 lds
v_mfma_f32_16x16x32_bf16 v[88:91], a[176:179], a[200:203], v[88:91]
ds_read_b64_tr_b16 a[172:173], v187 offset:256
ds_read_b64_tr_b16 a[174:175], v187 offset:2304
v_mfma_f32_16x16x32_bf16 v[120:123], a[176:179], a[204:207], v[120:123]
ds_read_b64_tr_b16 a[176:177], v188 offset:256
ds_read_b64_tr_b16 a[178:179], v188 offset:2304
v_mfma_f32_16x16x32_bf16 v[92:95], a[180:183], a[200:203], v[92:95]
v_accvgpr_write_b32 a106, v160
v_accvgpr_write_b32 a107, v160
v_mfma_f32_16x16x32_bf16 v[124:127], a[180:183], a[204:207], v[124:127]
buffer_load_dwordx4 v137, s[16:19], s42 offen offset:1024 lds
v_mfma_f32_16x16x32_bf16 v[96:99], a[184:187], a[200:203], v[96:99]
ds_read_b64_tr_b16 a[180:181], v189 offset:256
ds_read_b64_tr_b16 a[182:183], v189 offset:2304
v_mfma_f32_16x16x32_bf16 v[128:131], a[184:187], a[204:207], v[128:131]
ds_read_b64_tr_b16 a[184:185], v190 offset:256
ds_read_b64_tr_b16 a[186:187], v190 offset:2304
v_mfma_f32_16x16x32_bf16 v[100:103], a[188:191], a[200:203], v[100:103]
v_mfma_f32_16x16x32_bf16 v[132:135], a[188:191], a[204:207], v[132:135]
s_waitcnt lgkmcnt(8)
ds_read_b64_tr_b16 a[188:189], v191 offset:256
ds_read_b64_tr_b16 a[190:191], v191 offset:2304
v_mfma_f32_16x16x32_bf16 v[8:11], a[128:131], a[192:195], v[8:11]
buffer_load_dwordx4 v138, s[16:19], s42 offen offset:2048 lds
v_mfma_f32_16x16x32_bf16 v[40:43], a[128:131], a[196:199], v[40:43]
ds_read_b128 a[200:203], v193 offset:0
ds_read_b128 a[204:207], v193 offset:2048
v_mfma_f32_16x16x32_bf16 v[12:15], a[132:135], a[192:195], v[12:15]
v_accvgpr_write_b32 a108, v160
v_accvgpr_write_b32 a109, v160
v_mfma_f32_16x16x32_bf16 v[44:47], a[132:135], a[196:199], v[44:47]
v_accvgpr_write_b32 a110, v160
v_accvgpr_write_b32 a111, v160
v_smfmac_f32_16x16x64_bf16 a[248:251], a[208:211], a[128:135], v235
buffer_load_dwordx4 v139, s[16:19], s42 offen offset:3072 lds
v_mfma_f32_16x16x32_bf16 v[72:75], a[160:163], a[192:195], v[72:75]
ds_read_b64_tr_b16 a[128:129], v184 offset:16384
ds_read_b64_tr_b16 a[130:131], v184 offset:18432
v_mfma_f32_16x16x32_bf16 v[104:107], a[160:163], a[196:199], v[104:107]
ds_read_b64_tr_b16 a[132:133], v185 offset:16384
ds_read_b64_tr_b16 a[134:135], v185 offset:18432
v_mfma_f32_16x16x32_bf16 v[76:79], a[164:167], a[192:195], v[76:79]
v_accvgpr_write_b32 a112, v160
v_accvgpr_write_b32 a113, v160
v_mfma_f32_16x16x32_bf16 v[108:111], a[164:167], a[196:199], v[108:111]
s_add_u32 m0, s44, 53248
v_accvgpr_write_b32 a114, v160
v_accvgpr_write_b32 a115, v160
v_smfmac_f32_16x16x64_bf16 a[252:255], a[208:211], a[160:167], v235
buffer_load_dwordx4 v140, s[16:19], s42 offen offset:0 lds
v_mfma_f32_16x16x32_bf16 v[16:19], a[136:139], a[192:195], v[16:19]
ds_read_b64_tr_b16 a[160:161], v184 offset:16640
ds_read_b64_tr_b16 a[162:163], v184 offset:18688
v_mfma_f32_16x16x32_bf16 v[48:51], a[136:139], a[196:199], v[48:51]
ds_read_b64_tr_b16 a[164:165], v185 offset:16640
ds_read_b64_tr_b16 a[166:167], v185 offset:18688
v_mfma_f32_16x16x32_bf16 v[20:23], a[140:143], a[192:195], v[20:23]
ds_read_b64_tr_b16 a[136:137], v186 offset:16384
ds_read_b64_tr_b16 a[138:139], v186 offset:18432
v_mfma_f32_16x16x32_bf16 v[52:55], a[140:143], a[196:199], v[52:55]
buffer_load_dwordx4 v141, s[16:19], s42 offen offset:1024 lds
v_mfma_f32_16x16x32_bf16 v[24:27], a[144:147], a[192:195], v[24:27]
ds_read_b64_tr_b16 a[140:141], v187 offset:16384
ds_read_b64_tr_b16 a[142:143], v187 offset:18432
v_mfma_f32_16x16x32_bf16 v[56:59], a[144:147], a[196:199], v[56:59]
ds_read_b64_tr_b16 a[144:145], v188 offset:16384
ds_read_b64_tr_b16 a[146:147], v188 offset:18432
v_mfma_f32_16x16x32_bf16 v[28:31], a[148:151], a[192:195], v[28:31]
v_accvgpr_write_b32 a116, v160
v_accvgpr_write_b32 a117, v160
v_mfma_f32_16x16x32_bf16 v[60:63], a[148:151], a[196:199], v[60:63]
buffer_load_dwordx4 v142, s[16:19], s42 offen offset:2048 lds
v_mfma_f32_16x16x32_bf16 v[32:35], a[152:155], a[192:195], v[32:35]
ds_read_b64_tr_b16 a[148:149], v189 offset:16384
ds_read_b64_tr_b16 a[150:151], v189 offset:18432
v_mfma_f32_16x16x32_bf16 v[64:67], a[152:155], a[196:199], v[64:67]
ds_read_b64_tr_b16 a[152:153], v190 offset:16384
ds_read_b64_tr_b16 a[154:155], v190 offset:18432
v_mfma_f32_16x16x32_bf16 v[36:39], a[156:159], a[192:195], v[36:39]
v_accvgpr_write_b32 a118, v160
v_accvgpr_write_b32 a119, v160
v_mfma_f32_16x16x32_bf16 v[68:71], a[156:159], a[196:199], v[68:71]
buffer_load_dwordx4 v143, s[16:19], s42 offen offset:3072 lds
v_mfma_f32_16x16x32_bf16 v[80:83], a[168:171], a[192:195], v[80:83]
s_waitcnt lgkmcnt(8)
ds_read_b64_tr_b16 a[156:157], v191 offset:16384
ds_read_b64_tr_b16 a[158:159], v191 offset:18432
v_mfma_f32_16x16x32_bf16 v[112:115], a[168:171], a[196:199], v[112:115]
s_lshl_b32 s72, s72, 12
ds_read_b64_tr_b16 a[168:169], v186 offset:16640
ds_read_b64_tr_b16 a[170:171], v186 offset:18688
v_mfma_f32_16x16x32_bf16 v[84:87], a[172:175], a[192:195], v[84:87]
s_add_u32 s42, s42, s72
v_accvgpr_write_b32 a120, v160
v_accvgpr_write_b32 a121, v160
v_mfma_f32_16x16x32_bf16 v[116:119], a[172:175], a[196:199], v[116:119]
ds_read_b64_tr_b16 a[172:173], v187 offset:16640
ds_read_b64_tr_b16 a[174:175], v187 offset:18688
v_mfma_f32_16x16x32_bf16 v[88:91], a[176:179], a[192:195], v[88:91]
v_accvgpr_write_b32 a122, v160
v_accvgpr_write_b32 a123, v160
v_mfma_f32_16x16x32_bf16 v[120:123], a[176:179], a[196:199], v[120:123]
ds_read_b64_tr_b16 a[176:177], v188 offset:16640
ds_read_b64_tr_b16 a[178:179], v188 offset:18688
v_mfma_f32_16x16x32_bf16 v[92:95], a[180:183], a[192:195], v[92:95]
v_accvgpr_write_b32 a124, v160
v_accvgpr_write_b32 a125, v160
v_mfma_f32_16x16x32_bf16 v[124:127], a[180:183], a[196:199], v[124:127]
ds_read_b64_tr_b16 a[180:181], v189 offset:16640
ds_read_b64_tr_b16 a[182:183], v189 offset:18688
v_mfma_f32_16x16x32_bf16 v[96:99], a[184:187], a[192:195], v[96:99]
v_accvgpr_write_b32 a126, v160
v_accvgpr_write_b32 a127, v160
v_mfma_f32_16x16x32_bf16 v[128:131], a[184:187], a[196:199], v[128:131]
ds_read_b64_tr_b16 a[184:185], v190 offset:16640
ds_read_b64_tr_b16 a[186:187], v190 offset:18688
v_mfma_f32_16x16x32_bf16 v[100:103], a[188:191], a[192:195], v[100:103]
v_mfma_f32_16x16x32_bf16 v[132:135], a[188:191], a[196:199], v[132:135]
ds_read_b64_tr_b16 a[188:189], v191 offset:16640
ds_read_b64_tr_b16 a[190:191], v191 offset:18688
v_mfma_f32_16x16x32_bf16 v[8:11], a[128:131], a[200:203], v[8:11]
v_mfma_f32_16x16x32_bf16 v[40:43], a[128:131], a[204:207], v[40:43]
v_mfma_f32_16x16x32_bf16 v[12:15], a[132:135], a[200:203], v[12:15]
v_mfma_f32_16x16x32_bf16 v[44:47], a[132:135], a[204:207], v[44:47]
v_smfmac_f32_16x16x64_bf16 a[248:251], a[208:211], a[128:135], v235
v_mfma_f32_16x16x32_bf16 v[72:75], a[160:163], a[200:203], v[72:75]
v_mfma_f32_16x16x32_bf16 v[104:107], a[160:163], a[204:207], v[104:107]
s_cmp_lg_u32 s32, 0
s_cbranch_scc1 K_CNTOK
s_waitcnt vmcnt(12)
v_cmp_gt_u32 vcc, 16, v254
s_cbranch_vccz K_CNTOK
K_CNTSPIN:
s_sleep 2
s_add_u32 s100, s100, 1
s_bitcmp1_b32 s100, 19
s_cbranch_scc1 K_END
buffer_load_dword v254, v255, s[28:31], 0 offen sc0 sc1
s_waitcnt vmcnt(0)
v_cmp_gt_u32 vcc, 16, v254
s_cbranch_vccnz K_CNTSPIN
K_CNTOK:
s_waitcnt vmcnt(15) lgkmcnt(0)
s_barrier
v_mfma_f32_16x16x32_bf16 v[76:79], a[164:167], a[200:203], v[76:79]
s_mov_b32 s38, 0
ds_read_b128 a[192:195], v202 offset:0
ds_read_b128 a[196:199], v202 offset:2048
v_mfma_f32_16x16x32_bf16 v[108:111], a[164:167], a[204:207], v[108:111]
s_add_u32 m0, s37, 32768
ds_read_b64_tr_b16 a[128:129], v194 offset:0
ds_read_b64_tr_b16 a[130:131], v194 offset:2048
v_smfmac_f32_16x16x64_bf16 a[252:255], a[208:211], a[160:167], v235
buffer_load_dwordx4 v228, s[8:11], s38 offen offset:0 lds
v_mfma_f32_16x16x32_bf16 v[16:19], a[136:139], a[200:203], v[16:19]
ds_read_b64_tr_b16 a[132:133], v195 offset:0
ds_read_b64_tr_b16 a[134:135], v195 offset:2048
v_mfma_f32_16x16x32_bf16 v[48:51], a[136:139], a[204:207], v[48:51]
ds_read_b64_tr_b16 a[160:161], v194 offset:256
ds_read_b64_tr_b16 a[162:163], v194 offset:2304
v_mfma_f32_16x16x32_bf16 v[20:23], a[140:143], a[200:203], v[20:23]
ds_read_b64_tr_b16 a[164:165], v195 offset:256
ds_read_b64_tr_b16 a[166:167], v195 offset:2304
v_mfma_f32_16x16x32_bf16 v[52:55], a[140:143], a[204:207], v[52:55]
ds_read_b64_tr_b16 a[136:137], v196 offset:0
ds_read_b64_tr_b16 a[138:139], v196 offset:2048
v_mfma_f32_16x16x32_bf16 v[24:27], a[144:147], a[200:203], v[24:27]
buffer_load_dwordx4 v229, s[8:11], s38 offen offset:1024 lds
v_mfma_f32_16x16x32_bf16 v[56:59], a[144:147], a[204:207], v[56:59]
ds_read_b64_tr_b16 a[140:141], v197 offset:0
ds_read_b64_tr_b16 a[142:143], v197 offset:2048
v_mfma_f32_16x16x32_bf16 v[28:31], a[148:151], a[200:203], v[28:31]
ds_read_b64_tr_b16 a[144:145], v198 offset:0
ds_read_b64_tr_b16 a[146:147], v198 offset:2048
v_mfma_f32_16x16x32_bf16 v[60:63], a[148:151], a[204:207], v[60:63]
ds_read_b64_tr_b16 a[148:149], v199 offset:0
ds_read_b64_tr_b16 a[150:151], v199 offset:2048
v_mfma_f32_16x16x32_bf16 v[32:35], a[152:155], a[200:203], v[32:35]
buffer_load_dwordx4 v230, s[8:11], s38 offen offset:2048 lds
v_mfma_f32_16x16x32_bf16 v[64:67], a[152:155], a[204:207], v[64:67]
ds_read_b64_tr_b16 a[152:153], v200 offset:0
ds_read_b64_tr_b16 a[154:155], v200 offset:2048
v_mfma_f32_16x16x32_bf16 v[36:39], a[156:159], a[200:203], v[36:39]
v_mfma_f32_16x16x32_bf16 v[68:71], a[156:159], a[204:207], v[68:71]
ds_read_b64_tr_b16 a[156:157], v201 offset:0
ds_read_b64_tr_b16 a[158:159], v201 offset:2048
v_mfma_f32_16x16x32_bf16 v[80:83], a[168:171], a[200:203], v[80:83]
buffer_load_dwordx4 v231, s[8:11], s38 offen offset:3072 lds
v_mfma_f32_16x16x32_bf16 v[112:115], a[168:171], a[204:207], v[112:115]
ds_read_b64_tr_b16 a[168:169], v196 offset:256
ds_read_b64_tr_b16 a[170:171], v196 offset:2304
v_mfma_f32_16x16x32_bf16 v[84:87], a[172:175], a[200:203], v[84:87]
s_add_u32 s38, s38, 16384
v_mfma_f32_16x16x32_bf16 v[116:119], a[172:175], a[204:207], v[116:119]
s_add_u32 m0, s37, 16384
ds_read_b64_tr_b16 a[172:173], v197 offset:256
ds_read_b64_tr_b16 a[174:175], v197 offset:2304
v_mfma_f32_16x16x32_bf16 v[88:91], a[176:179], a[200:203], v[88:91]
buffer_load_dwordx4 v228, s[8:11], s38 offen offset:0 lds
v_mfma_f32_16x16x32_bf16 v[120:123], a[176:179], a[204:207], v[120:123]
ds_read_b64_tr_b16 a[176:177], v198 offset:256
ds_read_b64_tr_b16 a[178:179], v198 offset:2304
v_mfma_f32_16x16x32_bf16 v[92:95], a[180:183], a[200:203], v[92:95]
v_mfma_f32_16x16x32_bf16 v[124:127], a[180:183], a[204:207], v[124:127]
ds_read_b64_tr_b16 a[180:181], v199 offset:256
ds_read_b64_tr_b16 a[182:183], v199 offset:2304
v_mfma_f32_16x16x32_bf16 v[96:99], a[184:187], a[200:203], v[96:99]
buffer_load_dwordx4 v229, s[8:11], s38 offen offset:1024 lds
v_mfma_f32_16x16x32_bf16 v[128:131], a[184:187], a[204:207], v[128:131]
ds_read_b64_tr_b16 a[184:185], v200 offset:256
ds_read_b64_tr_b16 a[186:187], v200 offset:2304
v_mfma_f32_16x16x32_bf16 v[100:103], a[188:191], a[200:203], v[100:103]
v_mfma_f32_16x16x32_bf16 v[132:135], a[188:191], a[204:207], v[132:135]
s_waitcnt lgkmcnt(8)
ds_read_b64_tr_b16 a[188:189], v201 offset:256
ds_read_b64_tr_b16 a[190:191], v201 offset:2304
v_mfma_f32_16x16x32_bf16 v[8:11], a[128:131], a[192:195], v[8:11]
s_add_u32 s76, s6, 0x270000
s_addc_u32 s77, s7, 0
ds_read_b128 a[200:203], v203 offset:0
ds_read_b128 a[204:207], v203 offset:2048
v_mfma_f32_16x16x32_bf16 v[40:43], a[128:131], a[196:199], v[40:43]
s_and_b32 s77, s77, 0xffff
buffer_load_dwordx4 v230, s[8:11], s38 offen offset:2048 lds
v_mfma_f32_16x16x32_bf16 v[12:15], a[132:135], a[192:195], v[12:15]
s_mov_b32 s78, 512
v_mfma_f32_16x16x32_bf16 v[44:47], a[132:135], a[196:199], v[44:47]
s_mov_b32 s79, 0x00020000
v_smfmac_f32_16x16x64_bf16 a[248:251], a[208:211], a[128:135], v235
s_mov_b32 s16, s86
ds_read_b64_tr_b16 a[128:129], v194 offset:16384
ds_read_b64_tr_b16 a[130:131], v194 offset:18432
v_mfma_f32_16x16x32_bf16 v[72:75], a[160:163], a[192:195], v[72:75]
s_and_b32 s17, s87, 0xffff
buffer_load_dwordx4 v231, s[8:11], s38 offen offset:3072 lds
v_mfma_f32_16x16x32_bf16 v[104:107], a[160:163], a[196:199], v[104:107]
s_mov_b32 s18, 4718592
ds_read_b64_tr_b16 a[132:133], v195 offset:16384
ds_read_b64_tr_b16 a[134:135], v195 offset:18432
v_mfma_f32_16x16x32_bf16 v[76:79], a[164:167], a[192:195], v[76:79]
s_add_u32 s38, s38, 16384
v_mfma_f32_16x16x32_bf16 v[108:111], a[164:167], a[196:199], v[108:111]
s_add_u32 m0, s37, 0
v_smfmac_f32_16x16x64_bf16 a[252:255], a[208:211], a[160:167], v235
s_mul_i32 s47, s35, 1179648
buffer_load_dwordx4 v228, s[8:11], s38 offen offset:0 lds
v_mfma_f32_16x16x32_bf16 v[16:19], a[136:139], a[192:195], v[16:19]
s_add_u32 s28, s86, s47
s_addc_u32 s29, s87, 0
ds_read_b64_tr_b16 a[160:161], v194 offset:16640
ds_read_b64_tr_b16 a[162:163], v194 offset:18688
v_mfma_f32_16x16x32_bf16 v[48:51], a[136:139], a[196:199], v[48:51]
s_and_b32 s29, s29, 0xffff
ds_read_b64_tr_b16 a[164:165], v195 offset:16640
ds_read_b64_tr_b16 a[166:167], v195 offset:18688
v_mfma_f32_16x16x32_bf16 v[20:23], a[140:143], a[192:195], v[20:23]
s_mov_b32 s30, 1179648
ds_read_b64_tr_b16 a[136:137], v196 offset:16384
ds_read_b64_tr_b16 a[138:139], v196 offset:18432
v_mfma_f32_16x16x32_bf16 v[52:55], a[140:143], a[196:199], v[52:55]
s_mov_b32 s42, 0xffc00000
buffer_load_dwordx4 v229, s[8:11], s38 offen offset:1024 lds
v_mfma_f32_16x16x32_bf16 v[24:27], a[144:147], a[192:195], v[24:27]
s_mov_b32 s43, 0x100000
ds_read_b64_tr_b16 a[140:141], v197 offset:16384
ds_read_b64_tr_b16 a[142:143], v197 offset:18432
v_mfma_f32_16x16x32_bf16 v[56:59], a[144:147], a[196:199], v[56:59]
s_lshr_b32 s46, s2, 3
ds_read_b64_tr_b16 a[144:145], v198 offset:16384
ds_read_b64_tr_b16 a[146:147], v198 offset:18432
v_mfma_f32_16x16x32_bf16 v[28:31], a[148:151], a[192:195], v[28:31]
s_lshl_b32 s46, s46, 2
v_mfma_f32_16x16x32_bf16 v[60:63], a[148:151], a[196:199], v[60:63]
s_add_u32 s46, s46, s32
buffer_load_dwordx4 v230, s[8:11], s38 offen offset:2048 lds
v_mfma_f32_16x16x32_bf16 v[32:35], a[152:155], a[192:195], v[32:35]
s_mul_i32 s45, s46, 4608
ds_read_b64_tr_b16 a[148:149], v199 offset:16384
ds_read_b64_tr_b16 a[150:151], v199 offset:18432
v_mfma_f32_16x16x32_bf16 v[64:67], a[152:155], a[196:199], v[64:67]
s_sub_u32 s45, s45, 6488064
ds_read_b64_tr_b16 a[152:153], v200 offset:16384
ds_read_b64_tr_b16 a[154:155], v200 offset:18432
v_mfma_f32_16x16x32_bf16 v[36:39], a[156:159], a[192:195], v[36:39]
s_min_u32 s46, s46, (K_CODE_END-K_LAST)>>10
v_mfma_f32_16x16x32_bf16 v[68:71], a[156:159], a[196:199], v[68:71]
s_lshl_b32 s46, s46, 10
ds_read_b64_tr_b16 a[156:157], v201 offset:16384
ds_read_b64_tr_b16 a[158:159], v201 offset:18432
v_mfma_f32_16x16x32_bf16 v[80:83], a[168:171], a[192:195], v[80:83]
s_waitcnt lgkmcnt(10)
buffer_load_dwordx4 v231, s[8:11], s38 offen offset:3072 lds
v_mfma_f32_16x16x32_bf16 v[112:115], a[168:171], a[196:199], v[112:115]
s_add_u32 s38, s38, 16384
ds_read_b64_tr_b16 a[168:169], v196 offset:16640
v_lshlrev_b32 v255, 3, v3
v_mfma_f32_16x16x32_bf16 v[84:87], a[172:175], a[192:195], v[84:87]
s_lshl_b32 s48, s55, 3
ds_read_b64_tr_b16 a[170:171], v196 offset:18688
v_add_u32 v242, s46, v234
v_mfma_f32_16x16x32_bf16 v[116:119], a[172:175], a[196:199], v[116:119]
s_add_u32 s48, s48, 0x240000
ds_read_b64_tr_b16 a[172:173], v197 offset:16640
ds_read_b64_tr_b16 a[174:175], v197 offset:18688
v_mfma_f32_16x16x32_bf16 v[88:91], a[176:179], a[192:195], v[88:91]
s_lshl_b32 s47, s2, 2
buffer_load_dwordx2 v[148:149], v255, s[20:23], s48 offen sc0 sc1
v_mfma_f32_16x16x32_bf16 v[120:123], a[176:179], a[196:199], v[120:123]
s_add_u32 s47, s47, s32
ds_read_b64_tr_b16 a[176:177], v198 offset:16640
ds_read_b64_tr_b16 a[178:179], v198 offset:18688
v_mfma_f32_16x16x32_bf16 v[92:95], a[180:183], a[192:195], v[92:95]
s_cmp_ge_u32 s47, 324
s_cselect_b64 s[24:25], s[60:61], s[56:57]
s_cselect_b32 s46, 324, 0
v_mfma_f32_16x16x32_bf16 v[124:127], a[180:183], a[196:199], v[124:127]
s_xor_b32 s48, s48, 128
ds_read_b64_tr_b16 a[180:181], v199 offset:16640
ds_read_b64_tr_b16 a[182:183], v199 offset:18688
v_mfma_f32_16x16x32_bf16 v[96:99], a[184:187], a[192:195], v[96:99]
s_cmp_ge_u32 s47, 648
s_cselect_b64 s[24:25], s[64:65], s[24:25]
s_cselect_b32 s46, 648, s46
buffer_load_dwordx2 v[150:151], v255, s[20:23], s48 offen sc0 sc1
v_mfma_f32_16x16x32_bf16 v[128:131], a[184:187], a[196:199], v[128:131]
s_sub_u32 s47, s47, s46
ds_read_b64_tr_b16 a[184:185], v200 offset:16640
ds_read_b64_tr_b16 a[186:187], v200 offset:18688
v_mfma_f32_16x16x32_bf16 v[100:103], a[188:191], a[192:195], v[100:103]
s_min_u32 s47, s47, 323
v_mfma_f32_16x16x32_bf16 v[132:135], a[188:191], a[196:199], v[132:135]
s_lshl_b32 s47, s47, 14
ds_read_b64_tr_b16 a[188:189], v201 offset:16640
ds_read_b64_tr_b16 a[190:191], v201 offset:18688
s_add_u32 s24, s24, s47
s_addc_u32 s25, s25, 0
s_mov_b32 s26, 16384
v_mfma_f32_16x16x32_bf16 v[8:11], a[128:131], a[200:203], v[8:11]
s_mov_b32 s44, 0
v_lshlrev_b32 v0, 6, v1
v_mfma_f32_16x16x32_bf16 v[40:43], a[128:131], a[204:207], v[40:43]
s_or_b32 s46, s32, s36
s_cselect_b32 s74, 8, 12
v_mfma_f32_16x16x32_bf16 v[12:15], a[132:135], a[200:203], v[12:15]
s_bitset1_b32 s74, 8
v_mfma_f32_16x16x32_bf16 v[44:47], a[132:135], a[204:207], v[44:47]
s_getpc_b64 s[72:73]
PC_c:
s_add_u32 s72, s72, K_LAST-PC_c
s_addc_u32 s73, s73, 0
v_smfmac_f32_16x16x64_bf16 a[248:251], a[208:211], a[128:135], v235
v_mfma_f32_16x16x32_bf16 v[72:75], a[160:163], a[200:203], v[72:75]
v_mfma_f32_16x16x32_bf16 v[104:107], a[160:163], a[204:207], v[104:107]
s_waitcnt vmcnt(2) lgkmcnt(0)
s_barrier
v_mfma_f32_16x16x32_bf16 v[76:79], a[164:167], a[200:203], v[76:79]
s_mov_b32 s39, 0
ds_read_b128 a[192:195], v212 offset:0
ds_read_b128 a[196:199], v212 offset:2048
v_mfma_f32_16x16x32_bf16 v[108:111], a[164:167], a[204:207], v[108:111]
s_add_u32 m0, s37, 98304
ds_read_b64_tr_b16 a[128:129], v204 offset:0
ds_read_b64_tr_b16 a[130:131], v204 offset:2048
v_smfmac_f32_16x16x64_bf16 a[252:255], a[208:211], a[160:167], v235
buffer_load_dwordx4 v232, s[12:15], s39 offen offset:0 lds
v_mfma_f32_16x16x32_bf16 v[16:19], a[136:139], a[200:203], v[16:19]
ds_read_b64_tr_b16 a[132:133], v205 offset:0
ds_read_b64_tr_b16 a[134:135], v205 offset:2048
v_mfma_f32_16x16x32_bf16 v[48:51], a[136:139], a[204:207], v[48:51]
ds_read_b64_tr_b16 a[160:161], v204 offset:256
ds_read_b64_tr_b16 a[162:163], v204 offset:2304
v_mfma_f32_16x16x32_bf16 v[20:23], a[140:143], a[200:203], v[20:23]
ds_read_b64_tr_b16 a[164:165], v205 offset:256
ds_read_b64_tr_b16 a[166:167], v205 offset:2304
v_mfma_f32_16x16x32_bf16 v[52:55], a[140:143], a[204:207], v[52:55]
buffer_load_dwordx4 v233, s[12:15], s39 offen offset:1024 lds
v_mfma_f32_16x16x32_bf16 v[24:27], a[144:147], a[200:203], v[24:27]
ds_read_b64_tr_b16 a[136:137], v206 offset:0
ds_read_b64_tr_b16 a[138:139], v206 offset:2048
v_mfma_f32_16x16x32_bf16 v[56:59], a[144:147], a[204:207], v[56:59]
ds_read_b64_tr_b16 a[140:141], v207 offset:0
ds_read_b64_tr_b16 a[142:143], v207 offset:2048
v_mfma_f32_16x16x32_bf16 v[28:31], a[148:151], a[200:203], v[28:31]
ds_read_b64_tr_b16 a[144:145], v208 offset:0
ds_read_b64_tr_b16 a[146:147], v208 offset:2048
v_mfma_f32_16x16x32_bf16 v[60:63], a[148:151], a[204:207], v[60:63]
ds_read_b64_tr_b16 a[148:149], v209 offset:0
ds_read_b64_tr_b16 a[150:151], v209 offset:2048
v_mfma_f32_16x16x32_bf16 v[32:35], a[152:155], a[200:203], v[32:35]
buffer_load_dwordx4 v232, s[12:15], s39 offen offset:2048 lds
v_mfma_f32_16x16x32_bf16 v[64:67], a[152:155], a[204:207], v[64:67]
ds_read_b64_tr_b16 a[152:153], v210 offset:0
ds_read_b64_tr_b16 a[154:155], v210 offset:2048
v_mfma_f32_16x16x32_bf16 v[36:39], a[156:159], a[200:203], v[36:39]
v_mfma_f32_16x16x32_bf16 v[68:71], a[156:159], a[204:207], v[68:71]
ds_read_b64_tr_b16 a[156:157], v211 offset:0
ds_read_b64_tr_b16 a[158:159], v211 offset:2048
v_mfma_f32_16x16x32_bf16 v[80:83], a[168:171], a[200:203], v[80:83]
buffer_load_dwordx4 v233, s[12:15], s39 offen offset:3072 lds
v_mfma_f32_16x16x32_bf16 v[112:115], a[168:171], a[204:207], v[112:115]
ds_read_b64_tr_b16 a[168:169], v206 offset:256
ds_read_b64_tr_b16 a[170:171], v206 offset:2304
v_mfma_f32_16x16x32_bf16 v[84:87], a[172:175], a[200:203], v[84:87]
s_add_u32 s39, s39, 16384
v_mfma_f32_16x16x32_bf16 v[116:119], a[172:175], a[204:207], v[116:119]
s_add_u32 m0, s37, 114688
ds_read_b64_tr_b16 a[172:173], v207 offset:256
ds_read_b64_tr_b16 a[174:175], v207 offset:2304
v_mfma_f32_16x16x32_bf16 v[88:91], a[176:179], a[200:203], v[88:91]
buffer_load_dwordx4 v232, s[12:15], s39 offen offset:0 lds
v_mfma_f32_16x16x32_bf16 v[120:123], a[176:179], a[204:207], v[120:123]
ds_read_b64_tr_b16 a[176:177], v208 offset:256
ds_read_b64_tr_b16 a[178:179], v208 offset:2304
v_mfma_f32_16x16x32_bf16 v[92:95], a[180:183], a[200:203], v[92:95]
v_mfma_f32_16x16x32_bf16 v[124:127], a[180:183], a[204:207], v[124:127]
ds_read_b64_tr_b16 a[180:181], v209 offset:256
ds_read_b64_tr_b16 a[182:183], v209 offset:2304
v_mfma_f32_16x16x32_bf16 v[96:99], a[184:187], a[200:203], v[96:99]
buffer_load_dwordx4 v233, s[12:15], s39 offen offset:1024 lds
v_mfma_f32_16x16x32_bf16 v[128:131], a[184:187], a[204:207], v[128:131]
ds_read_b64_tr_b16 a[184:185], v210 offset:256
ds_read_b64_tr_b16 a[186:187], v210 offset:2304
v_mfma_f32_16x16x32_bf16 v[100:103], a[188:191], a[200:203], v[100:103]
v_mfma_f32_16x16x32_bf16 v[132:135], a[188:191], a[204:207], v[132:135]
s_waitcnt lgkmcnt(8)
ds_read_b64_tr_b16 a[188:189], v211 offset:256
ds_read_b64_tr_b16 a[190:191], v211 offset:2304
v_mfma_f32_16x16x32_bf16 v[8:11], a[128:131], a[192:195], v[8:11]
s_lshl_b32 s46, s32, 7
buffer_load_dwordx4 v232, s[12:15], s39 offen offset:2048 lds
v_mfma_f32_16x16x32_bf16 v[40:43], a[128:131], a[196:199], v[40:43]
s_add_u32 s46, s46, 147456
ds_read_b128 a[200:203], v213 offset:0
ds_read_b128 a[204:207], v213 offset:2048
v_mfma_f32_16x16x32_bf16 v[12:15], a[132:135], a[192:195], v[12:15]
v_lshl_add_u32 v144, v3, 2, s46
v_lshl_add_u32 v5, v4, 4, s46
v_mfma_f32_16x16x32_bf16 v[44:47], a[132:135], a[196:199], v[44:47]
v_xor_b32 v6, 128, v5
v_xor_b32 v7, 256, v5
v_smfmac_f32_16x16x64_bf16 a[248:251], a[208:211], a[128:135], v235
ds_read_b64_tr_b16 a[128:129], v204 offset:16384
ds_read_b64_tr_b16 a[130:131], v204 offset:18432
v_mfma_f32_16x16x32_bf16 v[72:75], a[160:163], a[192:195], v[72:75]
buffer_load_dwordx4 v233, s[12:15], s39 offen offset:3072 lds
v_mfma_f32_16x16x32_bf16 v[104:107], a[160:163], a[196:199], v[104:107]
ds_read_b64_tr_b16 a[132:133], v205 offset:16384
ds_read_b64_tr_b16 a[134:135], v205 offset:18432
v_mfma_f32_16x16x32_bf16 v[76:79], a[164:167], a[192:195], v[76:79]
v_xor_b32 v254, 384, v5
v_mfma_f32_16x16x32_bf16 v[108:111], a[164:167], a[196:199], v[108:111]
s_add_u32 s39, s39, 16384
ds_read_b64 a[236:237], v152
ds_read_b64 a[238:239], v153
v_smfmac_f32_16x16x64_bf16 a[252:255], a[208:211], a[160:167], v235
ds_read_b64_tr_b16 a[160:161], v204 offset:16640
ds_read_b64_tr_b16 a[162:163], v204 offset:18688
v_mfma_f32_16x16x32_bf16 v[16:19], a[136:139], a[192:195], v[16:19]
ds_read_b64_tr_b16 a[164:165], v205 offset:16640
ds_read_b64_tr_b16 a[166:167], v205 offset:18688
v_mfma_f32_16x16x32_bf16 v[48:51], a[136:139], a[196:199], v[48:51]
ds_read_b64_tr_b16 a[136:137], v206 offset:16384
ds_read_b64_tr_b16 a[138:139], v206 offset:18432
v_mfma_f32_16x16x32_bf16 v[20:23], a[140:143], a[192:195], v[20:23]
ds_read_b64 a[240:241], v154
ds_read_b64 a[242:243], v155
v_mfma_f32_16x16x32_bf16 v[52:55], a[140:143], a[196:199], v[52:55]
ds_read_b64_tr_b16 a[140:141], v207 offset:16384
ds_read_b64_tr_b16 a[142:143], v207 offset:18432
v_mfma_f32_16x16x32_bf16 v[24:27], a[144:147], a[192:195], v[24:27]
v_readlane_b32 s92, v214, 0
v_readlane_b32 s93, v214, 32
v_mfma_f32_16x16x32_bf16 v[56:59], a[144:147], a[196:199], v[56:59]
ds_read_b64_tr_b16 a[144:145], v208 offset:16384
ds_read_b64_tr_b16 a[146:147], v208 offset:18432
v_mfma_f32_16x16x32_bf16 v[28:31], a[148:151], a[192:195], v[28:31]
v_mfma_f32_16x16x32_bf16 v[60:63], a[148:151], a[196:199], v[60:63]
ds_read_b64_tr_b16 a[148:149], v209 offset:16384
ds_read_b64_tr_b16 a[150:151], v209 offset:18432
v_mfma_f32_16x16x32_bf16 v[32:35], a[152:155], a[192:195], v[32:35]
v_mfma_f32_16x16x32_bf16 v[64:67], a[152:155], a[196:199], v[64:67]
ds_read_b64_tr_b16 a[152:153], v210 offset:16384
ds_read_b64_tr_b16 a[154:155], v210 offset:18432
v_mfma_f32_16x16x32_bf16 v[36:39], a[156:159], a[192:195], v[36:39]
v_mfma_f32_16x16x32_bf16 v[68:71], a[156:159], a[196:199], v[68:71]
ds_read_b64_tr_b16 a[156:157], v211 offset:16384
ds_read_b64_tr_b16 a[158:159], v211 offset:18432
v_mfma_f32_16x16x32_bf16 v[80:83], a[168:171], a[192:195], v[80:83]
v_mfma_f32_16x16x32_bf16 v[112:115], a[168:171], a[196:199], v[112:115]
s_waitcnt lgkmcnt(8)
ds_read_b64_tr_b16 a[168:169], v206 offset:16640
ds_read_b64_tr_b16 a[170:171], v206 offset:18688
v_mfma_f32_16x16x32_bf16 v[84:87], a[172:175], a[192:195], v[84:87]
v_mfma_f32_16x16x32_bf16 v[116:119], a[172:175], a[196:199], v[116:119]
ds_read_b64_tr_b16 a[172:173], v207 offset:16640
ds_read_b64_tr_b16 a[174:175], v207 offset:18688
v_mfma_f32_16x16x32_bf16 v[88:91], a[176:179], a[192:195], v[88:91]
v_mfma_f32_16x16x32_bf16 v[120:123], a[176:179], a[196:199], v[120:123]
ds_read_b64_tr_b16 a[176:177], v208 offset:16640
ds_read_b64_tr_b16 a[178:179], v208 offset:18688
v_mfma_f32_16x16x32_bf16 v[92:95], a[180:183], a[192:195], v[92:95]
v_mfma_f32_16x16x32_bf16 v[124:127], a[180:183], a[196:199], v[124:127]
ds_read_b64_tr_b16 a[180:181], v209 offset:16640
ds_read_b64_tr_b16 a[182:183], v209 offset:18688
v_mfma_f32_16x16x32_bf16 v[96:99], a[184:187], a[192:195], v[96:99]
v_mfma_f32_16x16x32_bf16 v[128:131], a[184:187], a[196:199], v[128:131]
ds_read_b64_tr_b16 a[184:185], v210 offset:16640
ds_read_b64_tr_b16 a[186:187], v210 offset:18688
v_mfma_f32_16x16x32_bf16 v[100:103], a[188:191], a[192:195], v[100:103]
v_mfma_f32_16x16x32_bf16 v[132:135], a[188:191], a[196:199], v[132:135]
ds_read_b64_tr_b16 a[188:189], v211 offset:16640
ds_read_b64_tr_b16 a[190:191], v211 offset:18688
v_mfma_f32_16x16x32_bf16 v[8:11], a[128:131], a[200:203], v[8:11]
v_mfma_f32_16x16x32_bf16 v[40:43], a[128:131], a[204:207], v[40:43]
v_mfma_f32_16x16x32_bf16 v[12:15], a[132:135], a[200:203], v[12:15]
v_mfma_f32_16x16x32_bf16 v[44:47], a[132:135], a[204:207], v[44:47]
v_smfmac_f32_16x16x64_bf16 a[248:251], a[208:211], a[128:135], v235
ds_read_b128 a[128:131], v216 offset:32768
ds_read_b128 a[132:135], v217 offset:32768
v_mfma_f32_16x16x32_bf16 v[72:75], a[160:163], a[200:203], v[72:75]
v_mfma_f32_16x16x32_bf16 v[104:107], a[160:163], a[204:207], v[104:107]
v_mfma_f32_16x16x32_bf16 v[76:79], a[164:167], a[200:203], v[76:79]
v_mfma_f32_16x16x32_bf16 v[108:111], a[164:167], a[204:207], v[108:111]
v_smfmac_f32_16x16x64_bf16 a[252:255], a[208:211], a[160:167], v235
v_mfma_f32_16x16x32_bf16 v[16:19], a[136:139], a[200:203], v[16:19]
v_accvgpr_read_b32 v136, a248
v_accvgpr_read_b32 v137, a249
v_mfma_f32_16x16x32_bf16 v[48:51], a[136:139], a[204:207], v[48:51]
v_accvgpr_read_b32 v138, a250
v_accvgpr_read_b32 v139, a251
v_mfma_f32_16x16x32_bf16 v[20:23], a[140:143], a[200:203], v[20:23]
ds_read_b128 a[136:139], v218 offset:32768
v_mfma_f32_16x16x32_bf16 v[52:55], a[140:143], a[204:207], v[52:55]
s_waitcnt lgkmcnt(3)
ds_read_b128 a[140:143], v219 offset:32768
v_mfma_f32_16x16x32_bf16 v[24:27], a[144:147], a[200:203], v[24:27]
v_mfma_f32_16x16x32_bf16 v[56:59], a[144:147], a[204:207], v[56:59]
v_accvgpr_read_b32 v140, a252
v_accvgpr_read_b32 v141, a253
v_mfma_f32_16x16x32_bf16 v[28:31], a[148:151], a[200:203], v[28:31]
v_accvgpr_read_b32 v142, a254
v_accvgpr_read_b32 v143, a255
v_mfma_f32_16x16x32_bf16 v[60:63], a[148:151], a[204:207], v[60:63]
v_add_f32 v136, v136, v137
v_add_f32 v138, v138, v139
v_mfma_f32_16x16x32_bf16 v[32:35], a[152:155], a[200:203], v[32:35]
v_add_f32 v140, v140, v141
v_add_f32 v142, v142, v143
v_mfma_f32_16x16x32_bf16 v[64:67], a[152:155], a[204:207], v[64:67]
ds_write_b32 v144, v136 offset:0
ds_write_b32 v144, v138 offset:64
v_mfma_f32_16x16x32_bf16 v[36:39], a[156:159], a[200:203], v[36:39]
ds_write_b32 v144, v140 offset:512
ds_write_b32 v144, v142 offset:576
v_mfma_f32_16x16x32_bf16 v[68:71], a[156:159], a[204:207], v[68:71]
s_waitcnt vmcnt(8)
s_nop 0
ds_read_b128 a[144:147], v216 offset:36864
ds_read_b128 a[148:151], v217 offset:36864
v_mfma_f32_16x16x32_bf16 v[80:83], a[168:171], a[200:203], v[80:83]
ds_read_b128 a[152:155], v218 offset:36864
ds_read_b128 a[156:159], v219 offset:36864
v_mfma_f32_16x16x32_bf16 v[112:115], a[168:171], a[204:207], v[112:115]
v_accvgpr_write_b32 a246, v148
v_accvgpr_write_b32 a247, v149
v_mfma_f32_16x16x32_bf16 v[84:87], a[172:175], a[200:203], v[84:87]
v_rcp_f32 v149, v149
v_mfma_f32_16x16x32_bf16 v[116:119], a[172:175], a[204:207], v[116:119]
s_waitcnt lgkmcnt(0)
s_barrier
v_mfma_f32_16x16x32_bf16 v[88:91], a[176:179], a[200:203], v[88:91]
ds_read_b128 v[184:187], v5 offset:0
ds_read_b128 v[188:191], v5 offset:64
v_mfma_f32_16x16x32_bf16 v[120:123], a[176:179], a[204:207], v[120:123]
ds_read_b128 v[192:195], v6 offset:0
ds_read_b128 v[196:199], v6 offset:64
v_mfma_f32_16x16x32_bf16 v[92:95], a[180:183], a[200:203], v[92:95]
ds_read_b128 v[200:203], v7 offset:0
ds_read_b128 v[204:207], v7 offset:64
v_mfma_f32_16x16x32_bf16 v[124:127], a[180:183], a[204:207], v[124:127]
ds_read_b128 v[208:211], v254 offset:0
ds_read_b128 v[212:215], v254 offset:64
v_mfma_f32_16x16x32_bf16 v[96:99], a[184:187], a[200:203], v[96:99]
v_rcp_f32 v151, v151
v_mfma_f32_16x16x32_bf16 v[128:131], a[184:187], a[204:207], v[128:131]
v_sub_f32 v148, 0, v148
v_sub_f32 v150, 0, v150
v_mfma_f32_16x16x32_bf16 v[100:103], a[188:191], a[200:203], v[100:103]
v_mul_f32 v149, 0x3e0293ee, v149
v_mul_f32 v151, 0x3e0293ee, v151
v_mfma_f32_16x16x32_bf16 v[132:135], a[188:191], a[204:207], v[132:135]
v_accvgpr_write_b32 a248, 0
v_accvgpr_write_b32 a249, 0
v_accvgpr_write_b32 a250, 0
v_accvgpr_write_b32 a251, 0
v_accvgpr_write_b32 a252, 0
v_accvgpr_write_b32 a253, 0
v_accvgpr_write_b32 a254, 0
v_accvgpr_write_b32 a255, 0
s_waitcnt lgkmcnt(0)
v_pk_fma_f32 v[8:9], v[184:185], v[148:149], v[8:9] op_sel:[0,0,0] op_sel_hi:[1,0,1]
v_pk_fma_f32 v[10:11], v[186:187], v[148:149], v[10:11] op_sel:[0,0,0] op_sel_hi:[1,0,1]
v_pk_mul_f32 v[8:9], v[8:9], v[148:149] op_sel:[0,1] op_sel_hi:[1,1]
v_pk_mul_f32 v[10:11], v[10:11], v[148:149] op_sel:[0,1] op_sel_hi:[1,1]
v_pk_fma_f32 v[12:13], v[188:189], v[148:149], v[12:13] op_sel:[0,0,0] op_sel_hi:[1,0,1]
v_pk_fma_f32 v[14:15], v[190:191], v[148:149], v[14:15] op_sel:[0,0,0] op_sel_hi:[1,0,1]
v_pk_mul_f32 v[12:13], v[12:13], v[148:149] op_sel:[0,1] op_sel_hi:[1,1]
v_pk_mul_f32 v[14:15], v[14:15], v[148:149] op_sel:[0,1] op_sel_hi:[1,1]
v_pk_fma_f32 v[16:17], v[192:193], v[148:149], v[16:17] op_sel:[0,0,0] op_sel_hi:[1,0,1]
v_pk_fma_f32 v[18:19], v[194:195], v[148:149], v[18:19] op_sel:[0,0,0] op_sel_hi:[1,0,1]
v_pk_mul_f32 v[16:17], v[16:17], v[148:149] op_sel:[0,1] op_sel_hi:[1,1]
v_pk_mul_f32 v[18:19], v[18:19], v[148:149] op_sel:[0,1] op_sel_hi:[1,1]
v_pk_fma_f32 v[20:21], v[196:197], v[148:149], v[20:21] op_sel:[0,0,0] op_sel_hi:[1,0,1]
v_pk_fma_f32 v[22:23], v[198:199], v[148:149], v[22:23] op_sel:[0,0,0] op_sel_hi:[1,0,1]
v_pk_mul_f32 v[20:21], v[20:21], v[148:149] op_sel:[0,1] op_sel_hi:[1,1]
v_pk_mul_f32 v[22:23], v[22:23], v[148:149] op_sel:[0,1] op_sel_hi:[1,1]
v_pk_fma_f32 v[24:25], v[200:201], v[148:149], v[24:25] op_sel:[0,0,0] op_sel_hi:[1,0,1]
v_pk_fma_f32 v[26:27], v[202:203], v[148:149], v[26:27] op_sel:[0,0,0] op_sel_hi:[1,0,1]
v_pk_mul_f32 v[24:25], v[24:25], v[148:149] op_sel:[0,1] op_sel_hi:[1,1]
v_pk_mul_f32 v[26:27], v[26:27], v[148:149] op_sel:[0,1] op_sel_hi:[1,1]
v_pk_fma_f32 v[28:29], v[204:205], v[148:149], v[28:29] op_sel:[0,0,0] op_sel_hi:[1,0,1]
v_pk_fma_f32 v[30:31], v[206:207], v[148:149], v[30:31] op_sel:[0,0,0] op_sel_hi:[1,0,1]
v_pk_mul_f32 v[28:29], v[28:29], v[148:149] op_sel:[0,1] op_sel_hi:[1,1]
v_pk_mul_f32 v[30:31], v[30:31], v[148:149] op_sel:[0,1] op_sel_hi:[1,1]
v_pk_fma_f32 v[32:33], v[208:209], v[148:149], v[32:33] op_sel:[0,0,0] op_sel_hi:[1,0,1]
v_pk_fma_f32 v[34:35], v[210:211], v[148:149], v[34:35] op_sel:[0,0,0] op_sel_hi:[1,0,1]
v_pk_mul_f32 v[32:33], v[32:33], v[148:149] op_sel:[0,1] op_sel_hi:[1,1]
v_pk_mul_f32 v[34:35], v[34:35], v[148:149] op_sel:[0,1] op_sel_hi:[1,1]
v_pk_fma_f32 v[36:37], v[212:213], v[148:149], v[36:37] op_sel:[0,0,0] op_sel_hi:[1,0,1]
v_pk_fma_f32 v[38:39], v[214:215], v[148:149], v[38:39] op_sel:[0,0,0] op_sel_hi:[1,0,1]
v_pk_mul_f32 v[36:37], v[36:37], v[148:149] op_sel:[0,1] op_sel_hi:[1,1]
v_pk_mul_f32 v[38:39], v[38:39], v[148:149] op_sel:[0,1] op_sel_hi:[1,1]
v_cvt_pk_bf16_f32 v152, v8, v9
v_cvt_pk_bf16_f32 v153, v10, v11
v_cvt_pk_bf16_f32 v154, v12, v13
v_cvt_pk_bf16_f32 v155, v14, v15
v_cvt_pk_bf16_f32 v156, v16, v17
v_cvt_pk_bf16_f32 v157, v18, v19
v_cvt_pk_bf16_f32 v158, v20, v21
v_cvt_pk_bf16_f32 v159, v22, v23
v_cvt_pk_bf16_f32 v160, v24, v25
v_cvt_pk_bf16_f32 v161, v26, v27
v_cvt_pk_bf16_f32 v162, v28, v29
v_cvt_pk_bf16_f32 v163, v30, v31
v_cvt_pk_bf16_f32 v164, v32, v33
v_cvt_pk_bf16_f32 v165, v34, v35
v_cvt_pk_bf16_f32 v166, v36, v37
v_cvt_pk_bf16_f32 v167, v38, v39
v_permlane16_swap_b32 v152, v154
v_permlane16_swap_b32 v153, v155
v_permlane16_swap_b32 v156, v158
v_permlane16_swap_b32 v157, v159
v_permlane16_swap_b32 v160, v162
v_permlane16_swap_b32 v161, v163
v_permlane16_swap_b32 v164, v166
v_permlane16_swap_b32 v165, v167
v_pk_fma_f32 v[40:41], v[184:185], v[150:151], v[40:41] op_sel:[0,0,0] op_sel_hi:[1,0,1]
v_pk_fma_f32 v[42:43], v[186:187], v[150:151], v[42:43] op_sel:[0,0,0] op_sel_hi:[1,0,1]
v_pk_mul_f32 v[40:41], v[40:41], v[150:151] op_sel:[0,1] op_sel_hi:[1,1]
v_pk_mul_f32 v[42:43], v[42:43], v[150:151] op_sel:[0,1] op_sel_hi:[1,1]
v_pk_fma_f32 v[44:45], v[188:189], v[150:151], v[44:45] op_sel:[0,0,0] op_sel_hi:[1,0,1]
v_pk_fma_f32 v[46:47], v[190:191], v[150:151], v[46:47] op_sel:[0,0,0] op_sel_hi:[1,0,1]
v_pk_mul_f32 v[44:45], v[44:45], v[150:151] op_sel:[0,1] op_sel_hi:[1,1]
v_pk_mul_f32 v[46:47], v[46:47], v[150:151] op_sel:[0,1] op_sel_hi:[1,1]
v_pk_fma_f32 v[48:49], v[192:193], v[150:151], v[48:49] op_sel:[0,0,0] op_sel_hi:[1,0,1]
v_pk_fma_f32 v[50:51], v[194:195], v[150:151], v[50:51] op_sel:[0,0,0] op_sel_hi:[1,0,1]
v_pk_mul_f32 v[48:49], v[48:49], v[150:151] op_sel:[0,1] op_sel_hi:[1,1]
v_pk_mul_f32 v[50:51], v[50:51], v[150:151] op_sel:[0,1] op_sel_hi:[1,1]
v_pk_fma_f32 v[52:53], v[196:197], v[150:151], v[52:53] op_sel:[0,0,0] op_sel_hi:[1,0,1]
v_pk_fma_f32 v[54:55], v[198:199], v[150:151], v[54:55] op_sel:[0,0,0] op_sel_hi:[1,0,1]
v_pk_mul_f32 v[52:53], v[52:53], v[150:151] op_sel:[0,1] op_sel_hi:[1,1]
v_pk_mul_f32 v[54:55], v[54:55], v[150:151] op_sel:[0,1] op_sel_hi:[1,1]
v_pk_fma_f32 v[56:57], v[200:201], v[150:151], v[56:57] op_sel:[0,0,0] op_sel_hi:[1,0,1]
v_pk_fma_f32 v[58:59], v[202:203], v[150:151], v[58:59] op_sel:[0,0,0] op_sel_hi:[1,0,1]
v_pk_mul_f32 v[56:57], v[56:57], v[150:151] op_sel:[0,1] op_sel_hi:[1,1]
v_pk_mul_f32 v[58:59], v[58:59], v[150:151] op_sel:[0,1] op_sel_hi:[1,1]
v_pk_fma_f32 v[60:61], v[204:205], v[150:151], v[60:61] op_sel:[0,0,0] op_sel_hi:[1,0,1]
v_pk_fma_f32 v[62:63], v[206:207], v[150:151], v[62:63] op_sel:[0,0,0] op_sel_hi:[1,0,1]
v_pk_mul_f32 v[60:61], v[60:61], v[150:151] op_sel:[0,1] op_sel_hi:[1,1]
v_pk_mul_f32 v[62:63], v[62:63], v[150:151] op_sel:[0,1] op_sel_hi:[1,1]
v_pk_fma_f32 v[64:65], v[208:209], v[150:151], v[64:65] op_sel:[0,0,0] op_sel_hi:[1,0,1]
v_pk_fma_f32 v[66:67], v[210:211], v[150:151], v[66:67] op_sel:[0,0,0] op_sel_hi:[1,0,1]
v_pk_mul_f32 v[64:65], v[64:65], v[150:151] op_sel:[0,1] op_sel_hi:[1,1]
v_pk_mul_f32 v[66:67], v[66:67], v[150:151] op_sel:[0,1] op_sel_hi:[1,1]
v_pk_fma_f32 v[68:69], v[212:213], v[150:151], v[68:69] op_sel:[0,0,0] op_sel_hi:[1,0,1]
v_pk_fma_f32 v[70:71], v[214:215], v[150:151], v[70:71] op_sel:[0,0,0] op_sel_hi:[1,0,1]
v_pk_mul_f32 v[68:69], v[68:69], v[150:151] op_sel:[0,1] op_sel_hi:[1,1]
v_pk_mul_f32 v[70:71], v[70:71], v[150:151] op_sel:[0,1] op_sel_hi:[1,1]
v_mfma_f32_16x16x32_bf16 v[8:11], a[128:131], v[152:155], 0
ds_read_b128 v[24:27], v5 offset:512
ds_read_b128 v[28:31], v5 offset:576
v_mfma_f32_16x16x32_bf16 v[8:11], a[132:135], v[156:159], v[8:11]
ds_read_b128 v[32:35], v6 offset:512
ds_read_b128 v[36:39], v6 offset:576
v_mfma_f32_16x16x32_bf16 v[8:11], a[136:139], v[160:163], v[8:11]
ds_read_b128 v[136:139], v7 offset:512
ds_read_b128 v[140:143], v7 offset:576
v_mfma_f32_16x16x32_bf16 v[8:11], a[140:143], v[164:167], v[8:11]
ds_read_b128 v[144:147], v254 offset:512
ds_read_b128 v[244:247], v254 offset:576
v_cvt_pk_bf16_f32 v168, v40, v41
v_cvt_pk_bf16_f32 v169, v42, v43
v_cvt_pk_bf16_f32 v170, v44, v45
v_cvt_pk_bf16_f32 v171, v46, v47
v_cvt_pk_bf16_f32 v172, v48, v49
v_cvt_pk_bf16_f32 v173, v50, v51
v_cvt_pk_bf16_f32 v174, v52, v53
v_cvt_pk_bf16_f32 v175, v54, v55
v_cvt_pk_bf16_f32 v176, v56, v57
v_cvt_pk_bf16_f32 v177, v58, v59
v_cvt_pk_bf16_f32 v178, v60, v61
v_cvt_pk_bf16_f32 v179, v62, v63
v_cvt_pk_bf16_f32 v180, v64, v65
v_cvt_pk_bf16_f32 v181, v66, v67
v_cvt_pk_bf16_f32 v182, v68, v69
v_cvt_pk_bf16_f32 v183, v70, v71
v_permlane16_swap_b32 v168, v170
v_permlane16_swap_b32 v169, v171
v_permlane16_swap_b32 v172, v174
v_permlane16_swap_b32 v173, v175
v_permlane16_swap_b32 v176, v178
v_permlane16_swap_b32 v177, v179
v_permlane16_swap_b32 v180, v182
v_permlane16_swap_b32 v181, v183
s_waitcnt lgkmcnt(0)
v_pk_fma_f32 v[72:73], v[24:25], v[148:149], v[72:73] op_sel:[0,0,0] op_sel_hi:[1,0,1]
v_pk_fma_f32 v[74:75], v[26:27], v[148:149], v[74:75] op_sel:[0,0,0] op_sel_hi:[1,0,1]
v_pk_mul_f32 v[72:73], v[72:73], v[148:149] op_sel:[0,1] op_sel_hi:[1,1]
v_pk_mul_f32 v[74:75], v[74:75], v[148:149] op_sel:[0,1] op_sel_hi:[1,1]
v_pk_fma_f32 v[76:77], v[28:29], v[148:149], v[76:77] op_sel:[0,0,0] op_sel_hi:[1,0,1]
v_pk_fma_f32 v[78:79], v[30:31], v[148:149], v[78:79] op_sel:[0,0,0] op_sel_hi:[1,0,1]
v_pk_mul_f32 v[76:77], v[76:77], v[148:149] op_sel:[0,1] op_sel_hi:[1,1]
v_pk_mul_f32 v[78:79], v[78:79], v[148:149] op_sel:[0,1] op_sel_hi:[1,1]
v_pk_fma_f32 v[80:81], v[32:33], v[148:149], v[80:81] op_sel:[0,0,0] op_sel_hi:[1,0,1]
v_pk_fma_f32 v[82:83], v[34:35], v[148:149], v[82:83] op_sel:[0,0,0] op_sel_hi:[1,0,1]
v_pk_mul_f32 v[80:81], v[80:81], v[148:149] op_sel:[0,1] op_sel_hi:[1,1]
v_pk_mul_f32 v[82:83], v[82:83], v[148:149] op_sel:[0,1] op_sel_hi:[1,1]
v_pk_fma_f32 v[84:85], v[36:37], v[148:149], v[84:85] op_sel:[0,0,0] op_sel_hi:[1,0,1]
v_pk_fma_f32 v[86:87], v[38:39], v[148:149], v[86:87] op_sel:[0,0,0] op_sel_hi:[1,0,1]
v_pk_mul_f32 v[84:85], v[84:85], v[148:149] op_sel:[0,1] op_sel_hi:[1,1]
v_pk_mul_f32 v[86:87], v[86:87], v[148:149] op_sel:[0,1] op_sel_hi:[1,1]
v_pk_fma_f32 v[88:89], v[136:137], v[148:149], v[88:89] op_sel:[0,0,0] op_sel_hi:[1,0,1]
v_pk_fma_f32 v[90:91], v[138:139], v[148:149], v[90:91] op_sel:[0,0,0] op_sel_hi:[1,0,1]
v_pk_mul_f32 v[88:89], v[88:89], v[148:149] op_sel:[0,1] op_sel_hi:[1,1]
v_pk_mul_f32 v[90:91], v[90:91], v[148:149] op_sel:[0,1] op_sel_hi:[1,1]
v_pk_fma_f32 v[92:93], v[140:141], v[148:149], v[92:93] op_sel:[0,0,0] op_sel_hi:[1,0,1]
v_pk_fma_f32 v[94:95], v[142:143], v[148:149], v[94:95] op_sel:[0,0,0] op_sel_hi:[1,0,1]
v_pk_mul_f32 v[92:93], v[92:93], v[148:149] op_sel:[0,1] op_sel_hi:[1,1]
v_pk_mul_f32 v[94:95], v[94:95], v[148:149] op_sel:[0,1] op_sel_hi:[1,1]
v_pk_fma_f32 v[96:97], v[144:145], v[148:149], v[96:97] op_sel:[0,0,0] op_sel_hi:[1,0,1]
v_pk_fma_f32 v[98:99], v[146:147], v[148:149], v[98:99] op_sel:[0,0,0] op_sel_hi:[1,0,1]
v_pk_mul_f32 v[96:97], v[96:97], v[148:149] op_sel:[0,1] op_sel_hi:[1,1]
v_pk_mul_f32 v[98:99], v[98:99], v[148:149] op_sel:[0,1] op_sel_hi:[1,1]
v_pk_fma_f32 v[100:101], v[244:245], v[148:149], v[100:101] op_sel:[0,0,0] op_sel_hi:[1,0,1]
v_pk_fma_f32 v[102:103], v[246:247], v[148:149], v[102:103] op_sel:[0,0,0] op_sel_hi:[1,0,1]
v_pk_mul_f32 v[100:101], v[100:101], v[148:149] op_sel:[0,1] op_sel_hi:[1,1]
v_pk_mul_f32 v[102:103], v[102:103], v[148:149] op_sel:[0,1] op_sel_hi:[1,1]
v_mfma_f32_16x16x32_bf16 v[16:19], a[128:131], v[168:171], 0
v_cvt_pk_bf16_f32 v184, v72, v73
v_cvt_pk_bf16_f32 v185, v74, v75
v_mfma_f32_16x16x32_bf16 v[16:19], a[132:135], v[172:175], v[16:19]
v_cvt_pk_bf16_f32 v186, v76, v77
v_cvt_pk_bf16_f32 v187, v78, v79
v_mfma_f32_16x16x32_bf16 v[16:19], a[136:139], v[176:179], v[16:19]
v_cvt_pk_bf16_f32 v188, v80, v81
v_cvt_pk_bf16_f32 v189, v82, v83
v_mfma_f32_16x16x32_bf16 v[16:19], a[140:143], v[180:183], v[16:19]
v_cvt_pk_bf16_f32 v190, v84, v85
v_cvt_pk_bf16_f32 v191, v86, v87
v_cvt_pk_bf16_f32 v192, v88, v89
v_cvt_pk_bf16_f32 v193, v90, v91
v_cvt_pk_bf16_f32 v194, v92, v93
v_cvt_pk_bf16_f32 v195, v94, v95
v_cvt_pk_bf16_f32 v196, v96, v97
v_cvt_pk_bf16_f32 v197, v98, v99
v_cvt_pk_bf16_f32 v198, v100, v101
v_cvt_pk_bf16_f32 v199, v102, v103
v_permlane16_swap_b32 v184, v186
v_permlane16_swap_b32 v185, v187
v_permlane16_swap_b32 v188, v190
v_permlane16_swap_b32 v189, v191
v_permlane16_swap_b32 v192, v194
v_permlane16_swap_b32 v193, v195
v_permlane16_swap_b32 v196, v198
v_permlane16_swap_b32 v197, v199
v_pk_fma_f32 v[104:105], v[24:25], v[150:151], v[104:105] op_sel:[0,0,0] op_sel_hi:[1,0,1]
v_pk_fma_f32 v[106:107], v[26:27], v[150:151], v[106:107] op_sel:[0,0,0] op_sel_hi:[1,0,1]
v_pk_mul_f32 v[104:105], v[104:105], v[150:151] op_sel:[0,1] op_sel_hi:[1,1]
v_pk_mul_f32 v[106:107], v[106:107], v[150:151] op_sel:[0,1] op_sel_hi:[1,1]
v_pk_fma_f32 v[108:109], v[28:29], v[150:151], v[108:109] op_sel:[0,0,0] op_sel_hi:[1,0,1]
v_pk_fma_f32 v[110:111], v[30:31], v[150:151], v[110:111] op_sel:[0,0,0] op_sel_hi:[1,0,1]
v_pk_mul_f32 v[108:109], v[108:109], v[150:151] op_sel:[0,1] op_sel_hi:[1,1]
v_pk_mul_f32 v[110:111], v[110:111], v[150:151] op_sel:[0,1] op_sel_hi:[1,1]
v_pk_fma_f32 v[112:113], v[32:33], v[150:151], v[112:113] op_sel:[0,0,0] op_sel_hi:[1,0,1]
v_pk_fma_f32 v[114:115], v[34:35], v[150:151], v[114:115] op_sel:[0,0,0] op_sel_hi:[1,0,1]
v_pk_mul_f32 v[112:113], v[112:113], v[150:151] op_sel:[0,1] op_sel_hi:[1,1]
v_pk_mul_f32 v[114:115], v[114:115], v[150:151] op_sel:[0,1] op_sel_hi:[1,1]
v_pk_fma_f32 v[116:117], v[36:37], v[150:151], v[116:117] op_sel:[0,0,0] op_sel_hi:[1,0,1]
v_pk_fma_f32 v[118:119], v[38:39], v[150:151], v[118:119] op_sel:[0,0,0] op_sel_hi:[1,0,1]
v_pk_mul_f32 v[116:117], v[116:117], v[150:151] op_sel:[0,1] op_sel_hi:[1,1]
v_pk_mul_f32 v[118:119], v[118:119], v[150:151] op_sel:[0,1] op_sel_hi:[1,1]
v_pk_fma_f32 v[120:121], v[136:137], v[150:151], v[120:121] op_sel:[0,0,0] op_sel_hi:[1,0,1]
v_pk_fma_f32 v[122:123], v[138:139], v[150:151], v[122:123] op_sel:[0,0,0] op_sel_hi:[1,0,1]
v_pk_mul_f32 v[120:121], v[120:121], v[150:151] op_sel:[0,1] op_sel_hi:[1,1]
v_pk_mul_f32 v[122:123], v[122:123], v[150:151] op_sel:[0,1] op_sel_hi:[1,1]
v_pk_fma_f32 v[124:125], v[140:141], v[150:151], v[124:125] op_sel:[0,0,0] op_sel_hi:[1,0,1]
v_pk_fma_f32 v[126:127], v[142:143], v[150:151], v[126:127] op_sel:[0,0,0] op_sel_hi:[1,0,1]
v_pk_mul_f32 v[124:125], v[124:125], v[150:151] op_sel:[0,1] op_sel_hi:[1,1]
v_pk_mul_f32 v[126:127], v[126:127], v[150:151] op_sel:[0,1] op_sel_hi:[1,1]
v_pk_fma_f32 v[128:129], v[144:145], v[150:151], v[128:129] op_sel:[0,0,0] op_sel_hi:[1,0,1]
v_pk_fma_f32 v[130:131], v[146:147], v[150:151], v[130:131] op_sel:[0,0,0] op_sel_hi:[1,0,1]
v_pk_mul_f32 v[128:129], v[128:129], v[150:151] op_sel:[0,1] op_sel_hi:[1,1]
v_pk_mul_f32 v[130:131], v[130:131], v[150:151] op_sel:[0,1] op_sel_hi:[1,1]
v_pk_fma_f32 v[132:133], v[244:245], v[150:151], v[132:133] op_sel:[0,0,0] op_sel_hi:[1,0,1]
v_pk_fma_f32 v[134:135], v[246:247], v[150:151], v[134:135] op_sel:[0,0,0] op_sel_hi:[1,0,1]
v_pk_mul_f32 v[132:133], v[132:133], v[150:151] op_sel:[0,1] op_sel_hi:[1,1]
v_pk_mul_f32 v[134:135], v[134:135], v[150:151] op_sel:[0,1] op_sel_hi:[1,1]
v_mfma_f32_16x16x32_bf16 v[24:27], a[128:131], v[184:187], 0
v_cvt_pk_bf16_f32 v200, v104, v105
v_cvt_pk_bf16_f32 v201, v106, v107
v_mfma_f32_16x16x32_bf16 v[24:27], a[132:135], v[188:191], v[24:27]
v_cvt_pk_bf16_f32 v202, v108, v109
v_cvt_pk_bf16_f32 v203, v110, v111
v_mfma_f32_16x16x32_bf16 v[24:27], a[136:139], v[192:195], v[24:27]
v_cvt_pk_bf16_f32 v204, v112, v113
v_cvt_pk_bf16_f32 v205, v114, v115
v_mfma_f32_16x16x32_bf16 v[24:27], a[140:143], v[196:199], v[24:27]
v_cvt_pk_bf16_f32 v206, v116, v117
v_cvt_pk_bf16_f32 v207, v118, v119
v_cvt_pk_bf16_f32 v208, v120, v121
v_cvt_pk_bf16_f32 v209, v122, v123
v_cvt_pk_bf16_f32 v210, v124, v125
v_cvt_pk_bf16_f32 v211, v126, v127
v_cvt_pk_bf16_f32 v212, v128, v129
v_cvt_pk_bf16_f32 v213, v130, v131
v_cvt_pk_bf16_f32 v214, v132, v133
v_cvt_pk_bf16_f32 v215, v134, v135
v_permlane16_swap_b32 v200, v202
v_permlane16_swap_b32 v201, v203
v_permlane16_swap_b32 v204, v206
v_permlane16_swap_b32 v205, v207
v_permlane16_swap_b32 v208, v210
v_permlane16_swap_b32 v209, v211
v_permlane16_swap_b32 v212, v214
v_permlane16_swap_b32 v213, v215
v_max3_f32 v136, v8, v9, v10
v_max_f32 v136, v136, v11
v_mfma_f32_16x16x32_bf16 v[32:35], a[128:131], v[200:203], 0
v_mov_b32 v137, v136
v_mfma_f32_16x16x32_bf16 v[32:35], a[132:135], v[204:207], v[32:35]
v_max3_f32 v140, v16, v17, v18
v_mfma_f32_16x16x32_bf16 v[32:35], a[136:139], v[208:211], v[32:35]
v_max_f32 v140, v140, v19
v_mfma_f32_16x16x32_bf16 v[32:35], a[140:143], v[212:215], v[32:35]
v_mov_b32 v141, v140
v_max3_f32 v144, v24, v25, v26
v_max_f32 v144, v144, v27
v_mov_b32 v145, v144
s_mov_b32 s48, 0x244000
buffer_load_dwordx4 v[104:107], v234, s[20:23], s48 offen offset:0 sc0 sc1
buffer_load_dwordx4 v[108:111], v234, s[20:23], s48 offen offset:1024 sc0 sc1
buffer_load_dwordx4 v[112:115], v234, s[20:23], s48 offen offset:2048 sc0 sc1
buffer_load_dwordx4 v[116:119], v234, s[20:23], s48 offen offset:3072 sc0 sc1
s_mov_b32 s48, 0x245000
buffer_load_dwordx4 v[120:123], v234, s[20:23], s48 offen offset:0 sc0 sc1
buffer_load_dwordx4 v[124:127], v234, s[20:23], s48 offen offset:1024 sc0 sc1
buffer_load_dwordx4 v[128:131], v234, s[20:23], s48 offen offset:2048 sc0 sc1
buffer_load_dwordx4 v[132:135], v234, s[20:23], s48 offen offset:3072 sc0 sc1
v_max3_f32 v148, v32, v33, v34
v_max_f32 v148, v148, v35
v_mov_b32 v149, v148
v_permlane16_swap_b32 v136, v137
v_permlane16_swap_b32 v140, v141
v_permlane16_swap_b32 v144, v145
v_permlane16_swap_b32 v148, v149
v_max_f32 v136, v136, v137
v_mov_b32 v137, v136
v_max_f32 v140, v140, v141
v_mov_b32 v141, v140
v_max_f32 v144, v144, v145
v_mov_b32 v145, v144
v_max_f32 v148, v148, v149
v_mov_b32 v149, v148
v_permlane32_swap_b32 v136, v137
v_permlane32_swap_b32 v140, v141
v_permlane32_swap_b32 v144, v145
v_permlane32_swap_b32 v148, v149
v_max_f32 v136, v136, v137
v_max_f32 v140, v140, v141
v_max_f32 v144, v144, v145
v_max_f32 v148, v148, v149
v_sub_f32 v139, -4.0, v136
v_sub_f32 v138, -4.0, v136
v_sub_f32 v137, -4.0, v136
v_sub_f32 v136, -4.0, v136
v_sub_f32 v143, -4.0, v140
v_sub_f32 v142, -4.0, v140
v_sub_f32 v141, -4.0, v140
v_sub_f32 v140, -4.0, v140
v_sub_f32 v147, -4.0, v144
v_sub_f32 v146, -4.0, v144
v_sub_f32 v145, -4.0, v144
v_sub_f32 v144, -4.0, v144
v_sub_f32 v151, -4.0, v148
v_sub_f32 v150, -4.0, v148
v_sub_f32 v149, -4.0, v148
v_sub_f32 v148, -4.0, v148
K_HAVEMAX:
v_pk_add_f32 v[8:9], v[8:9], v[136:137]
v_pk_add_f32 v[10:11], v[10:11], v[136:137]
v_pk_add_f32 v[16:17], v[16:17], v[140:141]
v_pk_add_f32 v[18:19], v[18:19], v[140:141]
v_pk_add_f32 v[24:25], v[24:25], v[144:145]
v_pk_add_f32 v[26:27], v[26:27], v[144:145]
v_pk_add_f32 v[32:33], v[32:33], v[148:149]
v_pk_add_f32 v[34:35], v[34:35], v[148:149]
v_mfma_f32_16x16x32_bf16 v[12:15], a[144:147], v[152:155], v[136:139]
v_exp_f32 v8, v8
v_exp_f32 v9, v9
v_mfma_f32_16x16x32_bf16 v[12:15], a[148:151], v[156:159], v[12:15]
ds_read_b128 a[128:131], v216 offset:40960
ds_read_b128 a[132:135], v217 offset:40960
v_exp_f32 v10, v10
v_mfma_f32_16x16x32_bf16 v[12:15], a[152:155], v[160:163], v[12:15]
ds_read_b128 a[136:139], v218 offset:40960
ds_read_b128 a[140:143], v219 offset:40960
v_exp_f32 v11, v11
v_mfma_f32_16x16x32_bf16 v[12:15], a[156:159], v[164:167], v[12:15]
v_cvt_pk_bf16_f32 v40, v8, v9
v_cvt_pk_bf16_f32 v41, v10, v11
v_exp_f32 v16, v16
v_mfma_f32_16x16x32_bf16 v[20:23], a[156:159], v[180:183], v[140:143]
v_exp_f32 v17, v17
v_mfma_f32_16x16x32_bf16 v[20:23], a[152:155], v[176:179], v[20:23]
v_cvt_pk_bf16_f32 v44, v16, v17
v_exp_f32 v18, v18
v_mfma_f32_16x16x32_bf16 v[20:23], a[148:151], v[172:175], v[20:23]
v_exp_f32 v19, v19
v_mfma_f32_16x16x32_bf16 v[20:23], a[144:147], v[168:171], v[20:23]
v_exp_f32 v24, v24
v_exp_f32 v25, v25
v_mfma_f32_16x16x32_bf16 v[28:31], a[144:147], v[184:187], v[144:147]
v_cvt_pk_bf16_f32 v45, v18, v19
v_cvt_pk_bf16_f32 v48, v24, v25
v_exp_f32 v26, v26
v_mfma_f32_16x16x32_bf16 v[28:31], a[148:151], v[188:191], v[28:31]
v_exp_f32 v27, v27
v_mfma_f32_16x16x32_bf16 v[28:31], a[152:155], v[192:195], v[28:31]
v_cvt_pk_bf16_f32 v49, v26, v27
v_exp_f32 v32, v32
v_mfma_f32_16x16x32_bf16 v[28:31], a[156:159], v[196:199], v[28:31]
v_exp_f32 v33, v33
v_mfma_f32_16x16x32_bf16 v[36:39], a[156:159], v[212:215], v[148:151]
ds_read_b128 a[156:159], v219 offset:45056
v_cvt_pk_bf16_f32 v52, v32, v33
v_exp_f32 v34, v34
v_mfma_f32_16x16x32_bf16 v[36:39], a[152:155], v[208:211], v[36:39]
ds_read_b128 a[152:155], v218 offset:45056
v_exp_f32 v35, v35
v_mfma_f32_16x16x32_bf16 v[36:39], a[148:151], v[204:207], v[36:39]
v_exp_f32 v12, v12
v_exp_f32 v13, v13
v_mfma_f32_16x16x32_bf16 v[36:39], a[144:147], v[200:203], v[36:39]
s_waitcnt lgkmcnt(2)
ds_read_b128 a[148:151], v217 offset:45056
ds_read_b128 a[144:147], v216 offset:45056
v_exp_f32 v14, v14
v_mfma_f32_16x16x32_bf16 v[8:11], a[128:131], v[152:155], v[136:139]
v_cvt_pk_bf16_f32 v53, v34, v35
v_cvt_pk_bf16_f32 v42, v12, v13
v_exp_f32 v15, v15
v_mfma_f32_16x16x32_bf16 v[8:11], a[132:135], v[156:159], v[8:11]
v_cvt_pk_bf16_f32 v43, v14, v15
v_exp_f32 v20, v20
v_mfma_f32_16x16x32_bf16 v[8:11], a[136:139], v[160:163], v[8:11]
v_exp_f32 v21, v21
v_mfma_f32_16x16x32_bf16 v[8:11], a[140:143], v[164:167], v[8:11]
v_cvt_pk_bf16_f32 v46, v20, v21
v_exp_f32 v22, v22
v_mfma_f32_16x16x32_bf16 v[16:19], a[140:143], v[180:183], v[140:143]
v_exp_f32 v23, v23
v_mfma_f32_16x16x32_bf16 v[16:19], a[136:139], v[176:179], v[16:19]
v_exp_f32 v28, v28
v_exp_f32 v29, v29
v_mfma_f32_16x16x32_bf16 v[16:19], a[132:135], v[172:175], v[16:19]
v_cvt_pk_bf16_f32 v47, v22, v23
v_cvt_pk_bf16_f32 v50, v28, v29
v_exp_f32 v30, v30
v_mfma_f32_16x16x32_bf16 v[16:19], a[128:131], v[168:171], v[16:19]
v_exp_f32 v31, v31
v_mfma_f32_16x16x32_bf16 v[24:27], a[128:131], v[184:187], v[144:147]
v_cvt_pk_bf16_f32 v51, v30, v31
v_exp_f32 v36, v36
v_mfma_f32_16x16x32_bf16 v[24:27], a[132:135], v[188:191], v[24:27]
v_exp_f32 v37, v37
v_mfma_f32_16x16x32_bf16 v[24:27], a[136:139], v[192:195], v[24:27]
v_cvt_pk_bf16_f32 v54, v36, v37
v_exp_f32 v38, v38
v_mfma_f32_16x16x32_bf16 v[24:27], a[140:143], v[196:199], v[24:27]
v_exp_f32 v39, v39
v_mfma_f32_16x16x32_bf16 v[32:35], a[140:143], v[212:215], v[148:151]
v_cvt_pk_bf16_f32 v55, v38, v39
v_mfma_f32_16x16x32_bf16 v[32:35], a[136:139], v[208:211], v[32:35]
v_mfma_f32_16x16x32_bf16 v[32:35], a[132:135], v[204:207], v[32:35]
v_mfma_f32_16x16x32_bf16 v[32:35], a[128:131], v[200:203], v[32:35]
v_smfmac_f32_16x16x64_bf16 a[248:251], a[208:211], v[40:47], v235
s_waitcnt lgkmcnt(0)
v_exp_f32 v8, v8
v_exp_f32 v9, v9
v_mfma_f32_16x16x32_bf16 v[12:15], a[144:147], v[152:155], v[136:139]
v_cvt_pk_bf16_f32 v56, v8, v9
v_exp_f32 v10, v10
v_mfma_f32_16x16x32_bf16 v[12:15], a[148:151], v[156:159], v[12:15]
v_exp_f32 v11, v11
v_mfma_f32_16x16x32_bf16 v[12:15], a[152:155], v[160:163], v[12:15]
v_cvt_pk_bf16_f32 v57, v10, v11
v_exp_f32 v16, v16
v_mfma_f32_16x16x32_bf16 v[12:15], a[156:159], v[164:167], v[12:15]
v_exp_f32 v17, v17
v_mfma_f32_16x16x32_bf16 v[20:23], a[156:159], v[180:183], v[140:143]
v_cvt_pk_bf16_f32 v60, v16, v17
v_exp_f32 v18, v18
s_waitcnt vmcnt(8) lgkmcnt(0)
s_barrier
v_mfma_f32_16x16x32_bf16 v[20:23], a[152:155], v[176:179], v[20:23]
ds_read_b128 a[128:131], v216 offset:16384
ds_read_b128 a[132:135], v217 offset:16384
v_exp_f32 v19, v19
v_mfma_f32_16x16x32_bf16 v[20:23], a[148:151], v[172:175], v[20:23]
s_add_u32 m0, s37, 65536
ds_read_b128 a[136:139], v218 offset:16384
ds_read_b128 a[140:143], v219 offset:16384
v_exp_f32 v24, v24
v_mfma_f32_16x16x32_bf16 v[20:23], a[144:147], v[168:171], v[20:23]
v_cvt_pk_bf16_f32 v61, v18, v19
v_exp_f32 v25, v25
v_mfma_f32_16x16x32_bf16 v[28:31], a[144:147], v[184:187], v[144:147]
v_cvt_pk_bf16_f32 v64, v24, v25
v_exp_f32 v26, v26
v_mfma_f32_16x16x32_bf16 v[28:31], a[148:151], v[188:191], v[28:31]
buffer_load_dwordx4 v232, s[12:15], s39 offen offset:0 lds
v_exp_f32 v27, v27
v_mfma_f32_16x16x32_bf16 v[28:31], a[152:155], v[192:195], v[28:31]
v_cvt_pk_bf16_f32 v65, v26, v27
v_exp_f32 v32, v32
v_mfma_f32_16x16x32_bf16 v[28:31], a[156:159], v[196:199], v[28:31]
ds_read_b64_tr_b16 a[160:161], v220 offset:32768
ds_read_b64_tr_b16 a[162:163], v220 offset:36864
v_exp_f32 v33, v33
v_mfma_f32_16x16x32_bf16 v[36:39], a[156:159], v[212:215], v[148:151]
ds_read_b128 a[156:159], v219 offset:20480
v_cvt_pk_bf16_f32 v68, v32, v33
v_exp_f32 v34, v34
v_mfma_f32_16x16x32_bf16 v[36:39], a[152:155], v[208:211], v[36:39]
ds_read_b128 a[152:155], v218 offset:20480
ds_read_b64_tr_b16 a[164:165], v220 offset:40960
v_exp_f32 v35, v35
v_mfma_f32_16x16x32_bf16 v[36:39], a[148:151], v[204:207], v[36:39]
v_exp_f32 v12, v12
v_exp_f32 v13, v13
v_mfma_f32_16x16x32_bf16 v[36:39], a[144:147], v[200:203], v[36:39]
ds_read_b64_tr_b16 a[166:167], v220 offset:45056
ds_read_b128 a[148:151], v217 offset:20480
v_exp_f32 v14, v14
v_smfmac_f32_16x16x64_bf16 a[252:255], a[208:211], v[48:55], v235
s_waitcnt lgkmcnt(7)
ds_read_b128 a[144:147], v216 offset:20480
ds_read_b64_tr_b16 a[168:169], v221 offset:32768
v_exp_f32 v15, v15
v_mfma_f32_16x16x32_bf16 v[8:11], a[128:131], v[152:155], v[136:139]
ds_read_b64_tr_b16 a[170:171], v221 offset:36864
ds_read_b64_tr_b16 a[172:173], v221 offset:40960
v_exp_f32 v20, v20
v_mfma_f32_16x16x32_bf16 v[8:11], a[132:135], v[156:159], v[8:11]
ds_read_b64_tr_b16 a[174:175], v221 offset:45056
v_cvt_pk_bf16_f32 v69, v34, v35
v_exp_f32 v21, v21
v_mfma_f32_16x16x32_bf16 v[8:11], a[136:139], v[160:163], v[8:11]
ds_read_b64_tr_b16 a[176:177], v222 offset:32768
ds_read_b64_tr_b16 a[178:179], v222 offset:36864
v_exp_f32 v22, v22
v_mfma_f32_16x16x32_bf16 v[8:11], a[140:143], v[164:167], v[8:11]
v_cvt_pk_bf16_f32 v58, v12, v13
v_cvt_pk_bf16_f32 v59, v14, v15
v_exp_f32 v23, v23
v_mfma_f32_16x16x32_bf16 v[16:19], a[140:143], v[180:183], v[140:143]
ds_read_b64_tr_b16 a[180:181], v222 offset:40960
ds_read_b64_tr_b16 a[182:183], v222 offset:45056
v_exp_f32 v28, v28
v_mfma_f32_16x16x32_bf16 v[16:19], a[136:139], v[176:179], v[16:19]
v_cvt_pk_bf16_f32 v62, v20, v21
v_cvt_pk_bf16_f32 v63, v22, v23
v_exp_f32 v29, v29
v_mfma_f32_16x16x32_bf16 v[16:19], a[132:135], v[172:175], v[16:19]
ds_read_b64_tr_b16 a[184:185], v223 offset:32768
ds_read_b64_tr_b16 a[186:187], v223 offset:36864
v_exp_f32 v30, v30
v_mfma_f32_16x16x32_bf16 v[16:19], a[128:131], v[168:171], v[16:19]
v_cvt_pk_bf16_f32 v66, v28, v29
v_exp_f32 v31, v31
v_mfma_f32_16x16x32_bf16 v[24:27], a[128:131], v[184:187], v[144:147]
ds_read_b64_tr_b16 a[188:189], v223 offset:40960
ds_read_b64_tr_b16 a[190:191], v223 offset:45056
v_exp_f32 v36, v36
v_mfma_f32_16x16x32_bf16 v[24:27], a[132:135], v[188:191], v[24:27]
v_cvt_pk_bf16_f32 v67, v30, v31
v_exp_f32 v37, v37
v_mfma_f32_16x16x32_bf16 v[24:27], a[136:139], v[192:195], v[24:27]
v_cvt_pk_bf16_f32 v70, v36, v37
v_exp_f32 v38, v38
v_mfma_f32_16x16x32_bf16 v[24:27], a[140:143], v[196:199], v[24:27]
buffer_load_dwordx4 v233, s[12:15], s39 offen offset:1024 lds
v_exp_f32 v39, v39
v_mfma_f32_16x16x32_bf16 v[32:35], a[140:143], v[212:215], v[148:151]
buffer_load_dwordx4 v232, s[12:15], s39 offen offset:2048 lds
v_cvt_pk_bf16_f32 v71, v38, v39
v_mfma_f32_16x16x32_bf16 v[32:35], a[136:139], v[208:211], v[32:35]
buffer_load_dwordx4 v233, s[12:15], s39 offen offset:3072 lds
v_mfma_f32_16x16x32_bf16 v[32:35], a[132:135], v[204:207], v[32:35]
s_add_u32 s39, s39, 16384
v_mfma_f32_16x16x32_bf16 v[32:35], a[128:131], v[200:203], v[32:35]
s_add_u32 m0, s37, 49152
s_nop 0
buffer_load_dwordx4 v228, s[8:11], s38 offen offset:0 lds
buffer_load_dwordx4 v229, s[8:11], s38 offen offset:1024 lds
s_cmp_lg_u32 s41, 0
s_cbranch_scc1 K_RANKED
s_waitcnt vmcnt(6)
v_max3_u32 v255, v104, v105, v106
s_max_u32 s48, s92, s93
v_max3_u32 v255, v255, v107, v108
v_max3_u32 v255, v255, v109, v110
v_max3_u32 v255, v255, v111, v112
v_max3_u32 v255, v255, v113, v114
v_max3_u32 v255, v255, v115, v116
v_max3_u32 v255, v255, v117, v118
v_max3_u32 v255, v255, v119, v120
v_max3_u32 v255, v255, v121, v122
v_max3_u32 v255, v255, v123, v124
v_max3_u32 v255, v255, v125, v126
v_max3_u32 v255, v255, v127, v128
v_max3_u32 v255, v255, v129, v130
v_max3_u32 v255, v255, v131, v132
v_max3_u32 v255, v255, v133, v134
v_max_u32 v255, v255, v135
v_cmp_lt_u32 vcc, s48, v255
s_bcnt1_i32_b64 s48, vcc
s_cmp_lt_u32 s48, 8
s_cbranch_scc1 K_RANK
K_RANKED:
s_memrealtime s[94:95]
s_waitcnt lgkmcnt(0)
s_mov_b32 s40, 0
.p2align 6
K_LOOP:
v_mfma_f32_16x16x32_bf16 a[0:3], a[160:163], v[40:43], a[0:3]
v_exp_f32 v8, v8
v_mfma_f32_16x16x32_bf16 a[0:3], a[164:167], v[56:59], a[0:3]
v_exp_f32 v9, v9
v_mfma_f32_16x16x32_bf16 a[32:35], a[164:167], v[60:63], a[32:35]
buffer_load_dwordx4 v230, s[8:11], s38 offen offset:2048 lds
v_mfma_f32_16x16x32_bf16 a[32:35], a[160:163], v[44:47], a[32:35]
v_exp_f32 v10, v10
v_mfma_f32_16x16x32_bf16 a[64:67], a[160:163], v[48:51], a[64:67]
v_cvt_pk_bf16_f32 v72, v8, v9
v_mfma_f32_16x16x32_bf16 a[64:67], a[164:167], v[64:67], a[64:67]
v_exp_f32 v11, v11
v_mfma_f32_16x16x32_bf16 a[96:99], a[164:167], v[68:71], a[96:99]
ds_read_b64_tr_b16 a[164:165], v224 offset:40960
ds_read_b64_tr_b16 a[166:167], v224 offset:45056
v_mfma_f32_16x16x32_bf16 a[96:99], a[160:163], v[52:55], a[96:99]
v_exp_f32 v16, v16
v_mfma_f32_16x16x32_bf16 a[100:103], a[168:171], v[52:55], a[100:103]
ds_read_b64_tr_b16 a[160:161], v224 offset:32768
ds_read_b64_tr_b16 a[162:163], v224 offset:36864
v_mfma_f32_16x16x32_bf16 a[100:103], a[172:175], v[68:71], a[100:103]
v_exp_f32 v17, v17
v_mfma_f32_16x16x32_bf16 a[68:71], a[172:175], v[64:67], a[68:71]
v_cvt_pk_bf16_f32 v73, v10, v11
v_cvt_pk_bf16_f32 v76, v16, v17
v_mfma_f32_16x16x32_bf16 a[68:71], a[168:171], v[48:51], a[68:71]
v_exp_f32 v18, v18
v_mfma_f32_16x16x32_bf16 a[36:39], a[168:171], v[44:47], a[36:39]
v_mfma_f32_16x16x32_bf16 a[36:39], a[172:175], v[60:63], a[36:39]
v_exp_f32 v19, v19
v_mfma_f32_16x16x32_bf16 a[4:7], a[172:175], v[56:59], a[4:7]
buffer_load_dwordx4 v231, s[8:11], s38 offen offset:3072 lds
v_mfma_f32_16x16x32_bf16 a[4:7], a[168:171], v[40:43], a[4:7]
v_exp_f32 v24, v24
v_smfmac_f32_16x16x64_bf16 a[248:251], a[208:211], v[56:63], v235
ds_read_b64_tr_b16 a[172:173], v225 offset:40960
ds_read_b64_tr_b16 a[174:175], v225 offset:45056
v_mfma_f32_16x16x32_bf16 v[12:15], a[144:147], v[152:155], v[136:139]
v_exp_f32 v25, v25
v_mfma_f32_16x16x32_bf16 v[12:15], a[148:151], v[156:159], v[12:15]
ds_read_b64_tr_b16 a[168:169], v225 offset:32768
ds_read_b64_tr_b16 a[170:171], v225 offset:36864
v_mfma_f32_16x16x32_bf16 v[12:15], a[152:155], v[160:163], v[12:15]
v_exp_f32 v26, v26
v_mfma_f32_16x16x32_bf16 v[12:15], a[156:159], v[164:167], v[12:15]
ds_read_b128 a[128:131], v216 offset:24576
ds_read_b128 a[132:135], v217 offset:24576
v_mfma_f32_16x16x32_bf16 v[20:23], a[156:159], v[180:183], v[140:143]
v_exp_f32 v27, v27
v_mfma_f32_16x16x32_bf16 v[20:23], a[152:155], v[176:179], v[20:23]
ds_read_b128 a[136:139], v218 offset:24576
v_cvt_pk_bf16_f32 v77, v18, v19
v_mfma_f32_16x16x32_bf16 v[20:23], a[148:151], v[172:175], v[20:23]
v_exp_f32 v32, v32
v_mfma_f32_16x16x32_bf16 v[20:23], a[144:147], v[168:171], v[20:23]
ds_read_b128 a[140:143], v219 offset:24576
v_cvt_pk_bf16_f32 v80, v24, v25
v_mfma_f32_16x16x32_bf16 v[28:31], a[144:147], v[184:187], v[144:147]
s_add_u32 s38, s38, 16384
v_exp_f32 v33, v33
v_mfma_f32_16x16x32_bf16 v[28:31], a[148:151], v[188:191], v[28:31]
s_add_u32 m0, s37, 81920
v_cvt_pk_bf16_f32 v81, v26, v27
v_cvt_pk_bf16_f32 v84, v32, v33
v_mfma_f32_16x16x32_bf16 v[28:31], a[152:155], v[192:195], v[28:31]
v_exp_f32 v34, v34
v_mfma_f32_16x16x32_bf16 v[28:31], a[156:159], v[196:199], v[28:31]
buffer_load_dwordx4 v232, s[12:15], s39 offen offset:0 lds
v_mfma_f32_16x16x32_bf16 v[36:39], a[156:159], v[212:215], v[148:151]
v_exp_f32 v35, v35
v_mfma_f32_16x16x32_bf16 v[36:39], a[152:155], v[208:211], v[36:39]
ds_read_b128 a[156:159], v219 offset:28672
ds_read_b128 a[152:155], v218 offset:28672
v_mfma_f32_16x16x32_bf16 v[36:39], a[148:151], v[204:207], v[36:39]
v_exp_f32 v12, v12
v_mfma_f32_16x16x32_bf16 v[36:39], a[144:147], v[200:203], v[36:39]
s_waitcnt lgkmcnt(3)
v_exp_f32 v13, v13
v_mfma_f32_16x16x32_bf16 a[8:11], a[176:179], v[40:43], a[8:11]
ds_read_b128 a[148:151], v217 offset:28672
ds_read_b128 a[144:147], v216 offset:28672
v_mfma_f32_16x16x32_bf16 a[8:11], a[180:183], v[56:59], a[8:11]
v_exp_f32 v14, v14
v_mfma_f32_16x16x32_bf16 a[40:43], a[180:183], v[60:63], a[40:43]
v_cvt_pk_bf16_f32 v85, v34, v35
v_cvt_pk_bf16_f32 v74, v12, v13
v_mfma_f32_16x16x32_bf16 a[40:43], a[176:179], v[44:47], a[40:43]
v_exp_f32 v15, v15
v_mfma_f32_16x16x32_bf16 a[72:75], a[176:179], v[48:51], a[72:75]
v_cvt_pk_bf16_f32 v75, v14, v15
v_mfma_f32_16x16x32_bf16 a[72:75], a[180:183], v[64:67], a[72:75]
v_exp_f32 v20, v20
v_mfma_f32_16x16x32_bf16 a[104:107], a[180:183], v[68:71], a[104:107]
buffer_load_dwordx4 v233, s[12:15], s39 offen offset:1024 lds
v_mfma_f32_16x16x32_bf16 a[104:107], a[176:179], v[52:55], a[104:107]
v_exp_f32 v21, v21
v_mfma_f32_16x16x32_bf16 a[108:111], a[184:187], v[52:55], a[108:111]
ds_read_b64_tr_b16 a[180:181], v226 offset:40960
ds_read_b64_tr_b16 a[182:183], v226 offset:45056
v_mfma_f32_16x16x32_bf16 a[108:111], a[188:191], v[68:71], a[108:111]
v_exp_f32 v22, v22
v_mfma_f32_16x16x32_bf16 a[76:79], a[188:191], v[64:67], a[76:79]
ds_read_b64_tr_b16 a[176:177], v226 offset:32768
ds_read_b64_tr_b16 a[178:179], v226 offset:36864
v_mfma_f32_16x16x32_bf16 a[76:79], a[184:187], v[48:51], a[76:79]
v_exp_f32 v23, v23
v_mfma_f32_16x16x32_bf16 a[44:47], a[184:187], v[44:47], a[44:47]
v_cvt_pk_bf16_f32 v78, v20, v21
v_cvt_pk_bf16_f32 v79, v22, v23
v_mfma_f32_16x16x32_bf16 a[44:47], a[188:191], v[60:63], a[44:47]
v_exp_f32 v28, v28
v_mfma_f32_16x16x32_bf16 a[12:15], a[188:191], v[56:59], a[12:15]
ds_read_b64_tr_b16 a[188:189], v227 offset:40960
ds_read_b64_tr_b16 a[190:191], v227 offset:45056
v_mfma_f32_16x16x32_bf16 a[12:15], a[184:187], v[40:43], a[12:15]
v_exp_f32 v29, v29
v_smfmac_f32_16x16x64_bf16 a[252:255], a[208:211], v[64:71], v235
ds_read_b64_tr_b16 a[184:185], v227 offset:32768
ds_read_b64_tr_b16 a[186:187], v227 offset:36864
v_mfma_f32_16x16x32_bf16 v[8:11], a[128:131], v[152:155], v[136:139]
v_exp_f32 v30, v30
v_mfma_f32_16x16x32_bf16 v[8:11], a[132:135], v[156:159], v[8:11]
buffer_load_dwordx4 v232, s[12:15], s39 offen offset:2048 lds
v_mfma_f32_16x16x32_bf16 v[8:11], a[136:139], v[160:163], v[8:11]
s_waitcnt lgkmcnt(6)
v_exp_f32 v31, v31
v_mfma_f32_16x16x32_bf16 v[8:11], a[140:143], v[164:167], v[8:11]
v_cvt_pk_bf16_f32 v82, v28, v29
v_cvt_pk_bf16_f32 v83, v30, v31
v_mfma_f32_16x16x32_bf16 v[16:19], a[140:143], v[180:183], v[140:143]
v_exp_f32 v36, v36
v_mfma_f32_16x16x32_bf16 v[16:19], a[136:139], v[176:179], v[16:19]
v_mfma_f32_16x16x32_bf16 v[16:19], a[132:135], v[172:175], v[16:19]
v_exp_f32 v37, v37
v_mfma_f32_16x16x32_bf16 v[16:19], a[128:131], v[168:171], v[16:19]
v_cvt_pk_bf16_f32 v86, v36, v37
v_mfma_f32_16x16x32_bf16 v[24:27], a[128:131], v[184:187], v[144:147]
v_exp_f32 v38, v38
v_mfma_f32_16x16x32_bf16 v[24:27], a[132:135], v[188:191], v[24:27]
v_mfma_f32_16x16x32_bf16 v[24:27], a[136:139], v[192:195], v[24:27]
v_exp_f32 v39, v39
v_mfma_f32_16x16x32_bf16 v[24:27], a[140:143], v[196:199], v[24:27]
v_cvt_pk_bf16_f32 v87, v38, v39
v_mfma_f32_16x16x32_bf16 v[32:35], a[140:143], v[212:215], v[148:151]
v_mfma_f32_16x16x32_bf16 v[32:35], a[136:139], v[208:211], v[32:35]
v_mfma_f32_16x16x32_bf16 v[32:35], a[132:135], v[204:207], v[32:35]
v_mfma_f32_16x16x32_bf16 v[32:35], a[128:131], v[200:203], v[32:35]
v_mfma_f32_16x16x32_bf16 a[16:19], a[160:163], v[40:43], a[16:19]
v_exp_f32 v8, v8
v_mfma_f32_16x16x32_bf16 a[16:19], a[164:167], v[56:59], a[16:19]
v_exp_f32 v9, v9
v_mfma_f32_16x16x32_bf16 a[48:51], a[164:167], v[60:63], a[48:51]
buffer_load_dwordx4 v233, s[12:15], s39 offen offset:3072 lds
v_mfma_f32_16x16x32_bf16 a[48:51], a[160:163], v[44:47], a[48:51]
v_exp_f32 v10, v10
v_mfma_f32_16x16x32_bf16 a[80:83], a[160:163], v[48:51], a[80:83]
v_cvt_pk_bf16_f32 v88, v8, v9
v_mfma_f32_16x16x32_bf16 a[80:83], a[164:167], v[64:67], a[80:83]
v_exp_f32 v11, v11
v_mfma_f32_16x16x32_bf16 a[112:115], a[164:167], v[68:71], a[112:115]
ds_read_b64_tr_b16 a[164:165], v220 offset:57344
ds_read_b64_tr_b16 a[166:167], v220 offset:61440
v_mfma_f32_16x16x32_bf16 a[112:115], a[160:163], v[52:55], a[112:115]
v_exp_f32 v16, v16
v_mfma_f32_16x16x32_bf16 a[116:119], a[168:171], v[52:55], a[116:119]
ds_read_b64_tr_b16 a[160:161], v220 offset:49152
ds_read_b64_tr_b16 a[162:163], v220 offset:53248
v_mfma_f32_16x16x32_bf16 a[116:119], a[172:175], v[68:71], a[116:119]
v_exp_f32 v17, v17
v_mfma_f32_16x16x32_bf16 a[84:87], a[172:175], v[64:67], a[84:87]
v_cvt_pk_bf16_f32 v89, v10, v11
v_cvt_pk_bf16_f32 v92, v16, v17
v_mfma_f32_16x16x32_bf16 a[84:87], a[168:171], v[48:51], a[84:87]
v_exp_f32 v18, v18
v_mfma_f32_16x16x32_bf16 a[52:55], a[168:171], v[44:47], a[52:55]
v_mfma_f32_16x16x32_bf16 a[52:55], a[172:175], v[60:63], a[52:55]
s_add_u32 s39, s39, 16384
v_exp_f32 v19, v19
v_mfma_f32_16x16x32_bf16 a[20:23], a[172:175], v[56:59], a[20:23]
s_add_u32 m0, s37, 32768
ds_read_b64_tr_b16 a[172:173], v221 offset:57344
ds_read_b64_tr_b16 a[174:175], v221 offset:61440
v_mfma_f32_16x16x32_bf16 a[20:23], a[168:171], v[40:43], a[20:23]
v_exp_f32 v24, v24
v_smfmac_f32_16x16x64_bf16 a[248:251], a[208:211], v[72:79], v235
buffer_load_dwordx4 v228, s[8:11], s38 offen offset:0 lds
v_mfma_f32_16x16x32_bf16 v[12:15], a[144:147], v[152:155], v[136:139]
v_exp_f32 v25, v25
v_mfma_f32_16x16x32_bf16 v[12:15], a[148:151], v[156:159], v[12:15]
ds_read_b64_tr_b16 a[168:169], v221 offset:49152
ds_read_b64_tr_b16 a[170:171], v221 offset:53248
v_mfma_f32_16x16x32_bf16 v[12:15], a[152:155], v[160:163], v[12:15]
v_exp_f32 v26, v26
v_mfma_f32_16x16x32_bf16 v[12:15], a[156:159], v[164:167], v[12:15]
ds_read_b128 a[128:131], v216 offset:0
ds_read_b128 a[132:135], v217 offset:0
v_mfma_f32_16x16x32_bf16 v[20:23], a[156:159], v[180:183], v[140:143]
v_exp_f32 v27, v27
v_mfma_f32_16x16x32_bf16 v[20:23], a[152:155], v[176:179], v[20:23]
ds_read_b128 a[136:139], v218 offset:0
v_cvt_pk_bf16_f32 v93, v18, v19
v_mfma_f32_16x16x32_bf16 v[20:23], a[148:151], v[172:175], v[20:23]
v_exp_f32 v32, v32
v_mfma_f32_16x16x32_bf16 v[20:23], a[144:147], v[168:171], v[20:23]
ds_read_b128 a[140:143], v219 offset:0
v_cvt_pk_bf16_f32 v96, v24, v25
v_mfma_f32_16x16x32_bf16 v[28:31], a[144:147], v[184:187], v[144:147]
v_exp_f32 v33, v33
v_mfma_f32_16x16x32_bf16 v[28:31], a[148:151], v[188:191], v[28:31]
buffer_load_dwordx4 v229, s[8:11], s38 offen offset:1024 lds
v_mfma_f32_16x16x32_bf16 v[28:31], a[152:155], v[192:195], v[28:31]
v_exp_f32 v34, v34
v_mfma_f32_16x16x32_bf16 v[28:31], a[156:159], v[196:199], v[28:31]
v_cvt_pk_bf16_f32 v97, v26, v27
v_cvt_pk_bf16_f32 v100, v32, v33
v_mfma_f32_16x16x32_bf16 v[36:39], a[156:159], v[212:215], v[148:151]
v_exp_f32 v35, v35
v_mfma_f32_16x16x32_bf16 v[36:39], a[152:155], v[208:211], v[36:39]
ds_read_b128 a[156:159], v219 offset:4096
ds_read_b128 a[152:155], v218 offset:4096
v_mfma_f32_16x16x32_bf16 v[36:39], a[148:151], v[204:207], v[36:39]
v_exp_f32 v12, v12
v_mfma_f32_16x16x32_bf16 v[36:39], a[144:147], v[200:203], v[36:39]
s_waitcnt lgkmcnt(3)
v_exp_f32 v13, v13
v_mfma_f32_16x16x32_bf16 a[24:27], a[176:179], v[40:43], a[24:27]
ds_read_b128 a[148:151], v217 offset:4096
ds_read_b128 a[144:147], v216 offset:4096
v_mfma_f32_16x16x32_bf16 a[24:27], a[180:183], v[56:59], a[24:27]
v_exp_f32 v14, v14
v_mfma_f32_16x16x32_bf16 a[56:59], a[180:183], v[60:63], a[56:59]
v_cvt_pk_bf16_f32 v101, v34, v35
v_cvt_pk_bf16_f32 v90, v12, v13
v_mfma_f32_16x16x32_bf16 a[56:59], a[176:179], v[44:47], a[56:59]
v_exp_f32 v15, v15
v_mfma_f32_16x16x32_bf16 a[88:91], a[176:179], v[48:51], a[88:91]
v_cvt_pk_bf16_f32 v91, v14, v15
v_mfma_f32_16x16x32_bf16 a[88:91], a[180:183], v[64:67], a[88:91]
v_exp_f32 v20, v20
v_mfma_f32_16x16x32_bf16 a[120:123], a[180:183], v[68:71], a[120:123]
buffer_load_dwordx4 v230, s[8:11], s38 offen offset:2048 lds
v_mfma_f32_16x16x32_bf16 a[120:123], a[176:179], v[52:55], a[120:123]
v_exp_f32 v21, v21
v_mfma_f32_16x16x32_bf16 a[124:127], a[184:187], v[52:55], a[124:127]
ds_read_b64_tr_b16 a[180:181], v222 offset:57344
ds_read_b64_tr_b16 a[182:183], v222 offset:61440
v_mfma_f32_16x16x32_bf16 a[124:127], a[188:191], v[68:71], a[124:127]
v_exp_f32 v22, v22
v_mfma_f32_16x16x32_bf16 a[92:95], a[188:191], v[64:67], a[92:95]
ds_read_b64_tr_b16 a[176:177], v222 offset:49152
ds_read_b64_tr_b16 a[178:179], v222 offset:53248
v_mfma_f32_16x16x32_bf16 a[92:95], a[184:187], v[48:51], a[92:95]
v_exp_f32 v23, v23
v_mfma_f32_16x16x32_bf16 a[60:63], a[184:187], v[44:47], a[60:63]
v_cvt_pk_bf16_f32 v94, v20, v21
v_cvt_pk_bf16_f32 v95, v22, v23
v_mfma_f32_16x16x32_bf16 a[60:63], a[188:191], v[60:63], a[60:63]
v_exp_f32 v28, v28
v_mfma_f32_16x16x32_bf16 a[28:31], a[188:191], v[56:59], a[28:31]
ds_read_b64_tr_b16 a[188:189], v223 offset:57344
ds_read_b64_tr_b16 a[190:191], v223 offset:61440
v_mfma_f32_16x16x32_bf16 a[28:31], a[184:187], v[40:43], a[28:31]
v_exp_f32 v29, v29
v_smfmac_f32_16x16x64_bf16 a[252:255], a[208:211], v[80:87], v235
ds_read_b64_tr_b16 a[184:185], v223 offset:49152
ds_read_b64_tr_b16 a[186:187], v223 offset:53248
v_mfma_f32_16x16x32_bf16 v[8:11], a[128:131], v[152:155], v[136:139]
v_exp_f32 v30, v30
v_mfma_f32_16x16x32_bf16 v[8:11], a[132:135], v[156:159], v[8:11]
buffer_load_dwordx4 v231, s[8:11], s38 offen offset:3072 lds
v_mfma_f32_16x16x32_bf16 v[8:11], a[136:139], v[160:163], v[8:11]
s_waitcnt lgkmcnt(6)
v_exp_f32 v31, v31
v_mfma_f32_16x16x32_bf16 v[8:11], a[140:143], v[164:167], v[8:11]
v_cvt_pk_bf16_f32 v98, v28, v29
v_cvt_pk_bf16_f32 v99, v30, v31
v_mfma_f32_16x16x32_bf16 v[16:19], a[140:143], v[180:183], v[140:143]
v_exp_f32 v36, v36
v_mfma_f32_16x16x32_bf16 v[16:19], a[136:139], v[176:179], v[16:19]
v_mfma_f32_16x16x32_bf16 v[16:19], a[132:135], v[172:175], v[16:19]
v_exp_f32 v37, v37
v_mfma_f32_16x16x32_bf16 v[16:19], a[128:131], v[168:171], v[16:19]
v_cvt_pk_bf16_f32 v102, v36, v37
v_mfma_f32_16x16x32_bf16 v[24:27], a[128:131], v[184:187], v[144:147]
v_exp_f32 v38, v38
v_mfma_f32_16x16x32_bf16 v[24:27], a[132:135], v[188:191], v[24:27]
v_mfma_f32_16x16x32_bf16 v[24:27], a[136:139], v[192:195], v[24:27]
v_exp_f32 v39, v39
v_mfma_f32_16x16x32_bf16 v[24:27], a[140:143], v[196:199], v[24:27]
v_cvt_pk_bf16_f32 v103, v38, v39
v_mfma_f32_16x16x32_bf16 v[32:35], a[140:143], v[212:215], v[148:151]
v_mfma_f32_16x16x32_bf16 v[32:35], a[136:139], v[208:211], v[32:35]
s_add_u32 s38, s38, 16384
v_mfma_f32_16x16x32_bf16 v[32:35], a[132:135], v[204:207], v[32:35]
v_mfma_f32_16x16x32_bf16 v[32:35], a[128:131], v[200:203], v[32:35]
v_mfma_f32_16x16x32_bf16 a[0:3], a[160:163], v[72:75], a[0:3]
v_exp_f32 v8, v8
v_mfma_f32_16x16x32_bf16 a[0:3], a[164:167], v[88:91], a[0:3]
v_exp_f32 v9, v9
v_mfma_f32_16x16x32_bf16 a[32:35], a[164:167], v[92:95], a[32:35]
buffer_load_dwordx2 v[252:253], v251, s[76:79], s42 offen sc1
v_mfma_f32_16x16x32_bf16 a[32:35], a[160:163], v[76:79], a[32:35]
v_exp_f32 v10, v10
v_mfma_f32_16x16x32_bf16 a[64:67], a[160:163], v[80:83], a[64:67]
v_cvt_pk_bf16_f32 v40, v8, v9
v_mfma_f32_16x16x32_bf16 a[64:67], a[164:167], v[96:99], a[64:67]
v_exp_f32 v11, v11
v_mfma_f32_16x16x32_bf16 a[96:99], a[164:167], v[100:103], a[96:99]
ds_read_b64_tr_b16 a[164:165], v224 offset:57344
ds_read_b64_tr_b16 a[166:167], v224 offset:61440
v_mfma_f32_16x16x32_bf16 a[96:99], a[160:163], v[84:87], a[96:99]
v_exp_f32 v16, v16
v_mfma_f32_16x16x32_bf16 a[100:103], a[168:171], v[84:87], a[100:103]
ds_read_b64_tr_b16 a[160:161], v224 offset:49152
ds_read_b64_tr_b16 a[162:163], v224 offset:53248
v_mfma_f32_16x16x32_bf16 a[100:103], a[172:175], v[100:103], a[100:103]
v_exp_f32 v17, v17
v_mfma_f32_16x16x32_bf16 a[68:71], a[172:175], v[96:99], a[68:71]
s_add_u32 s42, s42, s43
buffer_load_dword v255, v243, s[28:31], s45 offen
v_mfma_f32_16x16x32_bf16 a[68:71], a[168:171], v[80:83], a[68:71]
v_exp_f32 v18, v18
v_mfma_f32_16x16x32_bf16 a[36:39], a[168:171], v[76:79], a[36:39]
v_cvt_pk_bf16_f32 v41, v10, v11
v_cvt_pk_bf16_f32 v44, v16, v17
v_mfma_f32_16x16x32_bf16 a[36:39], a[172:175], v[92:95], a[36:39]
v_exp_f32 v19, v19
v_mfma_f32_16x16x32_bf16 a[4:7], a[172:175], v[88:91], a[4:7]
ds_read_b64_tr_b16 a[172:173], v225 offset:57344
ds_read_b64_tr_b16 a[174:175], v225 offset:61440
v_mfma_f32_16x16x32_bf16 a[4:7], a[168:171], v[72:75], a[4:7]
v_exp_f32 v24, v24
v_smfmac_f32_16x16x64_bf16 a[248:251], a[208:211], v[88:95], v235
ds_read_b64_tr_b16 a[168:169], v225 offset:49152
ds_read_b64_tr_b16 a[170:171], v225 offset:53248
v_mfma_f32_16x16x32_bf16 v[12:15], a[144:147], v[152:155], v[136:139]
v_exp_f32 v25, v25
v_mfma_f32_16x16x32_bf16 v[12:15], a[148:151], v[156:159], v[12:15]
ds_read_b128 a[128:131], v216 offset:8192
v_cvt_pk_bf16_f32 v45, v18, v19
v_mfma_f32_16x16x32_bf16 v[12:15], a[152:155], v[160:163], v[12:15]
s_add_u32 s45, s45, 589824
v_exp_f32 v26, v26
v_mfma_f32_16x16x32_bf16 v[12:15], a[156:159], v[164:167], v[12:15]
global_load_dword v255, v242, s[72:73]
v_mfma_f32_16x16x32_bf16 v[20:23], a[156:159], v[180:183], v[140:143]
v_exp_f32 v27, v27
v_mfma_f32_16x16x32_bf16 v[20:23], a[152:155], v[176:179], v[20:23]
ds_read_b128 a[132:135], v217 offset:8192
ds_read_b128 a[136:139], v218 offset:8192
v_mfma_f32_16x16x32_bf16 v[20:23], a[148:151], v[172:175], v[20:23]
v_exp_f32 v32, v32
v_mfma_f32_16x16x32_bf16 v[20:23], a[144:147], v[168:171], v[20:23]
ds_read_b128 a[140:143], v219 offset:8192
v_cvt_pk_bf16_f32 v48, v24, v25
v_mfma_f32_16x16x32_bf16 v[28:31], a[144:147], v[184:187], v[144:147]
v_exp_f32 v33, v33
v_mfma_f32_16x16x32_bf16 v[28:31], a[148:151], v[188:191], v[28:31]
v_cvt_pk_bf16_f32 v49, v26, v27
v_cvt_pk_bf16_f32 v52, v32, v33
v_mfma_f32_16x16x32_bf16 v[28:31], a[152:155], v[192:195], v[28:31]
v_exp_f32 v34, v34
v_mfma_f32_16x16x32_bf16 v[28:31], a[156:159], v[196:199], v[28:31]
buffer_load_dword v255, v0, s[24:27], s44 offen
v_mfma_f32_16x16x32_bf16 v[36:39], a[156:159], v[212:215], v[148:151]
v_exp_f32 v35, v35
v_mfma_f32_16x16x32_bf16 v[36:39], a[152:155], v[208:211], v[36:39]
ds_read_b128 a[156:159], v219 offset:12288
ds_read_b128 a[152:155], v218 offset:12288
v_mfma_f32_16x16x32_bf16 v[36:39], a[148:151], v[204:207], v[36:39]
v_exp_f32 v12, v12
v_mfma_f32_16x16x32_bf16 v[36:39], a[144:147], v[200:203], v[36:39]
s_waitcnt lgkmcnt(3)
v_exp_f32 v13, v13
v_mfma_f32_16x16x32_bf16 a[8:11], a[176:179], v[72:75], a[8:11]
ds_read_b128 a[148:151], v217 offset:12288
ds_read_b128 a[144:147], v216 offset:12288
v_mfma_f32_16x16x32_bf16 a[8:11], a[180:183], v[88:91], a[8:11]
v_exp_f32 v14, v14
v_mfma_f32_16x16x32_bf16 a[40:43], a[180:183], v[92:95], a[40:43]
v_cvt_pk_bf16_f32 v53, v34, v35
v_cvt_pk_bf16_f32 v42, v12, v13
v_mfma_f32_16x16x32_bf16 a[40:43], a[176:179], v[76:79], a[40:43]
v_exp_f32 v15, v15
v_mfma_f32_16x16x32_bf16 a[72:75], a[176:179], v[80:83], a[72:75]
s_add_u32 s44, s44, 4096
v_cvt_pk_bf16_f32 v43, v14, v15
v_mfma_f32_16x16x32_bf16 a[72:75], a[180:183], v[96:99], a[72:75]
v_exp_f32 v20, v20
v_mfma_f32_16x16x32_bf16 a[104:107], a[180:183], v[100:103], a[104:107]
ds_read_b64_tr_b16 a[180:181], v226 offset:57344
ds_read_b64_tr_b16 a[182:183], v226 offset:61440
v_mfma_f32_16x16x32_bf16 a[104:107], a[176:179], v[84:87], a[104:107]
v_exp_f32 v21, v21
v_mfma_f32_16x16x32_bf16 a[108:111], a[184:187], v[84:87], a[108:111]
ds_read_b64_tr_b16 a[176:177], v226 offset:49152
ds_read_b64_tr_b16 a[178:179], v226 offset:53248
v_mfma_f32_16x16x32_bf16 a[108:111], a[188:191], v[100:103], a[108:111]
v_exp_f32 v22, v22
v_mfma_f32_16x16x32_bf16 a[76:79], a[188:191], v[96:99], a[76:79]
v_cvt_pk_bf16_f32 v46, v20, v21
v_mfma_f32_16x16x32_bf16 a[76:79], a[184:187], v[80:83], a[76:79]
v_exp_f32 v23, v23
v_mfma_f32_16x16x32_bf16 a[44:47], a[184:187], v[76:79], a[44:47]
v_cvt_pk_bf16_f32 v47, v22, v23
v_mfma_f32_16x16x32_bf16 a[44:47], a[188:191], v[92:95], a[44:47]
v_exp_f32 v28, v28
v_mfma_f32_16x16x32_bf16 a[12:15], a[188:191], v[88:91], a[12:15]
ds_read_b64_tr_b16 a[188:189], v227 offset:57344
ds_read_b64_tr_b16 a[190:191], v227 offset:61440
v_mfma_f32_16x16x32_bf16 a[12:15], a[184:187], v[72:75], a[12:15]
v_exp_f32 v29, v29
v_smfmac_f32_16x16x64_bf16 a[252:255], a[208:211], v[96:103], v235
ds_read_b64_tr_b16 a[184:185], v227 offset:49152
ds_read_b64_tr_b16 a[186:187], v227 offset:53248
v_mfma_f32_16x16x32_bf16 v[8:11], a[128:131], v[152:155], v[136:139]
v_exp_f32 v30, v30
v_mfma_f32_16x16x32_bf16 v[8:11], a[132:135], v[156:159], v[8:11]
v_cvt_pk_bf16_f32 v50, v28, v29
v_mfma_f32_16x16x32_bf16 v[8:11], a[136:139], v[160:163], v[8:11]
s_waitcnt lgkmcnt(4)
v_exp_f32 v31, v31
v_mfma_f32_16x16x32_bf16 v[8:11], a[140:143], v[164:167], v[8:11]
v_cvt_pk_bf16_f32 v51, v30, v31
v_mfma_f32_16x16x32_bf16 v[16:19], a[140:143], v[180:183], v[140:143]
v_exp_f32 v36, v36
v_mfma_f32_16x16x32_bf16 v[16:19], a[136:139], v[176:179], v[16:19]
v_mfma_f32_16x16x32_bf16 v[16:19], a[132:135], v[172:175], v[16:19]
v_exp_f32 v37, v37
v_mfma_f32_16x16x32_bf16 v[16:19], a[128:131], v[168:171], v[16:19]
v_cvt_pk_bf16_f32 v54, v36, v37
v_mfma_f32_16x16x32_bf16 v[24:27], a[128:131], v[184:187], v[144:147]
v_exp_f32 v38, v38
v_mfma_f32_16x16x32_bf16 v[24:27], a[132:135], v[188:191], v[24:27]
v_mfma_f32_16x16x32_bf16 v[24:27], a[136:139], v[192:195], v[24:27]
v_exp_f32 v39, v39
v_mfma_f32_16x16x32_bf16 v[24:27], a[140:143], v[196:199], v[24:27]
v_cvt_pk_bf16_f32 v55, v38, v39
v_mfma_f32_16x16x32_bf16 v[32:35], a[140:143], v[212:215], v[148:151]
s_add_u32 s40, s40, 1
v_mfma_f32_16x16x32_bf16 v[32:35], a[136:139], v[208:211], v[32:35]
s_bitcmp1_b32 s74, s40
v_mfma_f32_16x16x32_bf16 v[32:35], a[132:135], v[204:207], v[32:35]
v_mfma_f32_16x16x32_bf16 v[32:35], a[128:131], v[200:203], v[32:35]
s_cbranch_scc1 K_EXIT
K_B4:
v_mfma_f32_16x16x32_bf16 a[16:19], a[160:163], v[72:75], a[16:19]
v_exp_f32 v8, v8
v_mfma_f32_16x16x32_bf16 a[16:19], a[164:167], v[88:91], a[16:19]
v_exp_f32 v9, v9
v_mfma_f32_16x16x32_bf16 a[48:51], a[164:167], v[92:95], a[48:51]
v_cvt_pk_bf16_f32 v56, v8, v9
v_mfma_f32_16x16x32_bf16 a[48:51], a[160:163], v[76:79], a[48:51]
v_exp_f32 v10, v10
v_mfma_f32_16x16x32_bf16 a[80:83], a[160:163], v[80:83], a[80:83]
v_mfma_f32_16x16x32_bf16 a[80:83], a[164:167], v[96:99], a[80:83]
v_exp_f32 v11, v11
s_waitcnt vmcnt(4) lgkmcnt(0)
s_barrier
v_mfma_f32_16x16x32_bf16 a[112:115], a[164:167], v[100:103], a[112:115]
ds_read_b64_tr_b16 a[164:165], v220 offset:8192
ds_read_b64_tr_b16 a[166:167], v220 offset:12288
v_mfma_f32_16x16x32_bf16 a[112:115], a[160:163], v[84:87], a[112:115]
s_add_u32 m0, s37, 98304
v_exp_f32 v16, v16
v_mfma_f32_16x16x32_bf16 a[116:119], a[168:171], v[84:87], a[116:119]
buffer_load_dwordx4 v232, s[12:15], s39 offen offset:0 lds
v_mfma_f32_16x16x32_bf16 a[116:119], a[172:175], v[100:103], a[116:119]
v_exp_f32 v17, v17
v_mfma_f32_16x16x32_bf16 a[84:87], a[172:175], v[96:99], a[84:87]
ds_read_b64_tr_b16 a[160:161], v220 offset:0
ds_read_b64_tr_b16 a[162:163], v220 offset:4096
v_mfma_f32_16x16x32_bf16 a[84:87], a[168:171], v[80:83], a[84:87]
v_exp_f32 v18, v18
v_mfma_f32_16x16x32_bf16 a[52:55], a[168:171], v[76:79], a[52:55]
v_cvt_pk_bf16_f32 v57, v10, v11
v_cvt_pk_bf16_f32 v60, v16, v17
v_mfma_f32_16x16x32_bf16 a[52:55], a[172:175], v[92:95], a[52:55]
v_exp_f32 v19, v19
v_mfma_f32_16x16x32_bf16 a[20:23], a[172:175], v[88:91], a[20:23]
ds_read_b64_tr_b16 a[172:173], v221 offset:8192
ds_read_b64_tr_b16 a[174:175], v221 offset:12288
v_mfma_f32_16x16x32_bf16 a[20:23], a[168:171], v[72:75], a[20:23]
v_exp_f32 v24, v24
v_smfmac_f32_16x16x64_bf16 a[248:251], a[208:211], v[40:47], v235
buffer_load_dwordx4 v233, s[12:15], s39 offen offset:1024 lds
v_mfma_f32_16x16x32_bf16 v[12:15], a[144:147], v[152:155], v[136:139]
v_exp_f32 v25, v25
v_mfma_f32_16x16x32_bf16 v[12:15], a[148:151], v[156:159], v[12:15]
ds_read_b64_tr_b16 a[168:169], v221 offset:0
ds_read_b64_tr_b16 a[170:171], v221 offset:4096
v_mfma_f32_16x16x32_bf16 v[12:15], a[152:155], v[160:163], v[12:15]
v_exp_f32 v26, v26
v_mfma_f32_16x16x32_bf16 v[12:15], a[156:159], v[164:167], v[12:15]
ds_read_b128 a[128:131], v216 offset:49152
ds_read_b128 a[132:135], v217 offset:49152
v_mfma_f32_16x16x32_bf16 v[20:23], a[156:159], v[180:183], v[140:143]
v_exp_f32 v27, v27
v_mfma_f32_16x16x32_bf16 v[20:23], a[152:155], v[176:179], v[20:23]
ds_read_b128 a[136:139], v218 offset:49152
v_cvt_pk_bf16_f32 v61, v18, v19
v_mfma_f32_16x16x32_bf16 v[20:23], a[148:151], v[172:175], v[20:23]
v_exp_f32 v32, v32
v_mfma_f32_16x16x32_bf16 v[20:23], a[144:147], v[168:171], v[20:23]
ds_read_b128 a[140:143], v219 offset:49152
v_cvt_pk_bf16_f32 v64, v24, v25
v_mfma_f32_16x16x32_bf16 v[28:31], a[144:147], v[184:187], v[144:147]
v_exp_f32 v33, v33
v_mfma_f32_16x16x32_bf16 v[28:31], a[148:151], v[188:191], v[28:31]
buffer_load_dwordx4 v232, s[12:15], s39 offen offset:2048 lds
v_mfma_f32_16x16x32_bf16 v[28:31], a[152:155], v[192:195], v[28:31]
v_exp_f32 v34, v34
v_mfma_f32_16x16x32_bf16 v[28:31], a[156:159], v[196:199], v[28:31]
v_cvt_pk_bf16_f32 v65, v26, v27
v_cvt_pk_bf16_f32 v68, v32, v33
v_mfma_f32_16x16x32_bf16 v[36:39], a[156:159], v[212:215], v[148:151]
v_exp_f32 v35, v35
v_mfma_f32_16x16x32_bf16 v[36:39], a[152:155], v[208:211], v[36:39]
ds_read_b128 a[156:159], v219 offset:53248
ds_read_b128 a[152:155], v218 offset:53248
v_mfma_f32_16x16x32_bf16 v[36:39], a[148:151], v[204:207], v[36:39]
v_exp_f32 v12, v12
v_mfma_f32_16x16x32_bf16 v[36:39], a[144:147], v[200:203], v[36:39]
v_exp_f32 v13, v13
v_mfma_f32_16x16x32_bf16 a[24:27], a[176:179], v[72:75], a[24:27]
ds_read_b128 a[148:151], v217 offset:53248
ds_read_b128 a[144:147], v216 offset:53248
v_mfma_f32_16x16x32_bf16 a[24:27], a[180:183], v[88:91], a[24:27]
v_exp_f32 v14, v14
v_mfma_f32_16x16x32_bf16 a[56:59], a[180:183], v[92:95], a[56:59]
buffer_load_dwordx4 v233, s[12:15], s39 offen offset:3072 lds
v_mfma_f32_16x16x32_bf16 a[56:59], a[176:179], v[76:79], a[56:59]
v_exp_f32 v15, v15
v_mfma_f32_16x16x32_bf16 a[88:91], a[176:179], v[80:83], a[88:91]
v_cvt_pk_bf16_f32 v69, v34, v35
v_cvt_pk_bf16_f32 v58, v12, v13
v_mfma_f32_16x16x32_bf16 a[88:91], a[180:183], v[96:99], a[88:91]
v_exp_f32 v20, v20
v_mfma_f32_16x16x32_bf16 a[120:123], a[180:183], v[100:103], a[120:123]
ds_read_b64_tr_b16 a[180:181], v222 offset:8192
ds_read_b64_tr_b16 a[182:183], v222 offset:12288
v_mfma_f32_16x16x32_bf16 a[120:123], a[176:179], v[84:87], a[120:123]
v_exp_f32 v21, v21
v_mfma_f32_16x16x32_bf16 a[124:127], a[184:187], v[84:87], a[124:127]
ds_read_b64_tr_b16 a[176:177], v222 offset:0
ds_read_b64_tr_b16 a[178:179], v222 offset:4096
v_mfma_f32_16x16x32_bf16 a[124:127], a[188:191], v[100:103], a[124:127]
v_exp_f32 v22, v22
v_mfma_f32_16x16x32_bf16 a[92:95], a[188:191], v[96:99], a[92:95]
v_cvt_pk_bf16_f32 v59, v14, v15
v_cvt_pk_bf16_f32 v62, v20, v21
v_mfma_f32_16x16x32_bf16 a[92:95], a[184:187], v[80:83], a[92:95]
s_add_u32 s39, s39, 16384
v_exp_f32 v23, v23
v_mfma_f32_16x16x32_bf16 a[60:63], a[184:187], v[76:79], a[60:63]
s_add_u32 m0, s37, 16384
v_cvt_pk_bf16_f32 v63, v22, v23
v_mfma_f32_16x16x32_bf16 a[60:63], a[188:191], v[92:95], a[60:63]
v_exp_f32 v28, v28
v_mfma_f32_16x16x32_bf16 a[28:31], a[188:191], v[88:91], a[28:31]
buffer_load_dwordx4 v228, s[8:11], s38 offen offset:0 lds
v_mfma_f32_16x16x32_bf16 a[28:31], a[184:187], v[72:75], a[28:31]
v_exp_f32 v29, v29
v_smfmac_f32_16x16x64_bf16 a[252:255], a[208:211], v[48:55], v235
s_waitcnt lgkmcnt(2)
ds_read_b64_tr_b16 a[188:189], v223 offset:8192
ds_read_b64_tr_b16 a[190:191], v223 offset:12288
v_mfma_f32_16x16x32_bf16 v[8:11], a[128:131], v[152:155], v[136:139]
v_exp_f32 v30, v30
v_mfma_f32_16x16x32_bf16 v[8:11], a[132:135], v[156:159], v[8:11]
ds_read_b64_tr_b16 a[184:185], v223 offset:0
ds_read_b64_tr_b16 a[186:187], v223 offset:4096
v_mfma_f32_16x16x32_bf16 v[8:11], a[136:139], v[160:163], v[8:11]
v_exp_f32 v31, v31
v_mfma_f32_16x16x32_bf16 v[8:11], a[140:143], v[164:167], v[8:11]
buffer_load_dwordx4 v229, s[8:11], s38 offen offset:1024 lds
v_mfma_f32_16x16x32_bf16 v[16:19], a[140:143], v[180:183], v[140:143]
v_exp_f32 v36, v36
v_mfma_f32_16x16x32_bf16 v[16:19], a[136:139], v[176:179], v[16:19]
v_cvt_pk_bf16_f32 v66, v28, v29
v_cvt_pk_bf16_f32 v67, v30, v31
v_mfma_f32_16x16x32_bf16 v[16:19], a[132:135], v[172:175], v[16:19]
v_exp_f32 v37, v37
v_mfma_f32_16x16x32_bf16 v[16:19], a[128:131], v[168:171], v[16:19]
v_cvt_pk_bf16_f32 v70, v36, v37
v_mfma_f32_16x16x32_bf16 v[24:27], a[128:131], v[184:187], v[144:147]
v_exp_f32 v38, v38
v_mfma_f32_16x16x32_bf16 v[24:27], a[132:135], v[188:191], v[24:27]
v_mfma_f32_16x16x32_bf16 v[24:27], a[136:139], v[192:195], v[24:27]
v_exp_f32 v39, v39
v_mfma_f32_16x16x32_bf16 v[24:27], a[140:143], v[196:199], v[24:27]
v_cvt_pk_bf16_f32 v71, v38, v39
v_mfma_f32_16x16x32_bf16 v[32:35], a[140:143], v[212:215], v[148:151]
v_mfma_f32_16x16x32_bf16 v[32:35], a[136:139], v[208:211], v[32:35]
v_mfma_f32_16x16x32_bf16 v[32:35], a[132:135], v[204:207], v[32:35]
v_mfma_f32_16x16x32_bf16 v[32:35], a[128:131], v[200:203], v[32:35]
K_B5:
v_mfma_f32_16x16x32_bf16 a[0:3], a[160:163], v[40:43], a[0:3]
v_exp_f32 v8, v8
v_mfma_f32_16x16x32_bf16 a[0:3], a[164:167], v[56:59], a[0:3]
v_exp_f32 v9, v9
v_mfma_f32_16x16x32_bf16 a[32:35], a[164:167], v[60:63], a[32:35]
buffer_load_dwordx4 v230, s[8:11], s38 offen offset:2048 lds
v_mfma_f32_16x16x32_bf16 a[32:35], a[160:163], v[44:47], a[32:35]
v_exp_f32 v10, v10
v_mfma_f32_16x16x32_bf16 a[64:67], a[160:163], v[48:51], a[64:67]
v_cvt_pk_bf16_f32 v72, v8, v9
v_mfma_f32_16x16x32_bf16 a[64:67], a[164:167], v[64:67], a[64:67]
v_exp_f32 v11, v11
v_mfma_f32_16x16x32_bf16 a[96:99], a[164:167], v[68:71], a[96:99]
ds_read_b64_tr_b16 a[164:165], v224 offset:8192
ds_read_b64_tr_b16 a[166:167], v224 offset:12288
v_mfma_f32_16x16x32_bf16 a[96:99], a[160:163], v[52:55], a[96:99]
v_exp_f32 v16, v16
v_mfma_f32_16x16x32_bf16 a[100:103], a[168:171], v[52:55], a[100:103]
ds_read_b64_tr_b16 a[160:161], v224 offset:0
ds_read_b64_tr_b16 a[162:163], v224 offset:4096
v_mfma_f32_16x16x32_bf16 a[100:103], a[172:175], v[68:71], a[100:103]
v_exp_f32 v17, v17
v_mfma_f32_16x16x32_bf16 a[68:71], a[172:175], v[64:67], a[68:71]
v_cvt_pk_bf16_f32 v73, v10, v11
v_cvt_pk_bf16_f32 v76, v16, v17
v_mfma_f32_16x16x32_bf16 a[68:71], a[168:171], v[48:51], a[68:71]
v_exp_f32 v18, v18
v_mfma_f32_16x16x32_bf16 a[36:39], a[168:171], v[44:47], a[36:39]
v_mfma_f32_16x16x32_bf16 a[36:39], a[172:175], v[60:63], a[36:39]
v_exp_f32 v19, v19
v_mfma_f32_16x16x32_bf16 a[4:7], a[172:175], v[56:59], a[4:7]
buffer_load_dwordx4 v231, s[8:11], s38 offen offset:3072 lds
v_mfma_f32_16x16x32_bf16 a[4:7], a[168:171], v[40:43], a[4:7]
v_exp_f32 v24, v24
v_smfmac_f32_16x16x64_bf16 a[248:251], a[208:211], v[56:63], v235
ds_read_b64_tr_b16 a[172:173], v225 offset:8192
ds_read_b64_tr_b16 a[174:175], v225 offset:12288
v_mfma_f32_16x16x32_bf16 v[12:15], a[144:147], v[152:155], v[136:139]
v_exp_f32 v25, v25
v_mfma_f32_16x16x32_bf16 v[12:15], a[148:151], v[156:159], v[12:15]
ds_read_b64_tr_b16 a[168:169], v225 offset:0
ds_read_b64_tr_b16 a[170:171], v225 offset:4096
v_mfma_f32_16x16x32_bf16 v[12:15], a[152:155], v[160:163], v[12:15]
v_exp_f32 v26, v26
v_mfma_f32_16x16x32_bf16 v[12:15], a[156:159], v[164:167], v[12:15]
ds_read_b128 a[128:131], v216 offset:57344
ds_read_b128 a[132:135], v217 offset:57344
v_mfma_f32_16x16x32_bf16 v[20:23], a[156:159], v[180:183], v[140:143]
v_exp_f32 v27, v27
v_mfma_f32_16x16x32_bf16 v[20:23], a[152:155], v[176:179], v[20:23]
ds_read_b128 a[136:139], v218 offset:57344
v_cvt_pk_bf16_f32 v77, v18, v19
v_mfma_f32_16x16x32_bf16 v[20:23], a[148:151], v[172:175], v[20:23]
v_exp_f32 v32, v32
v_mfma_f32_16x16x32_bf16 v[20:23], a[144:147], v[168:171], v[20:23]
ds_read_b128 a[140:143], v219 offset:57344
v_cvt_pk_bf16_f32 v80, v24, v25
v_mfma_f32_16x16x32_bf16 v[28:31], a[144:147], v[184:187], v[144:147]
s_add_u32 s38, s38, 16384
v_exp_f32 v33, v33
v_mfma_f32_16x16x32_bf16 v[28:31], a[148:151], v[188:191], v[28:31]
s_add_u32 m0, s37, 114688
v_cvt_pk_bf16_f32 v81, v26, v27
v_cvt_pk_bf16_f32 v84, v32, v33
v_mfma_f32_16x16x32_bf16 v[28:31], a[152:155], v[192:195], v[28:31]
v_exp_f32 v34, v34
v_mfma_f32_16x16x32_bf16 v[28:31], a[156:159], v[196:199], v[28:31]
buffer_load_dwordx4 v232, s[12:15], s39 offen offset:0 lds
v_mfma_f32_16x16x32_bf16 v[36:39], a[156:159], v[212:215], v[148:151]
v_exp_f32 v35, v35
v_mfma_f32_16x16x32_bf16 v[36:39], a[152:155], v[208:211], v[36:39]
ds_read_b128 a[156:159], v219 offset:61440
ds_read_b128 a[152:155], v218 offset:61440
v_mfma_f32_16x16x32_bf16 v[36:39], a[148:151], v[204:207], v[36:39]
v_exp_f32 v12, v12
v_mfma_f32_16x16x32_bf16 v[36:39], a[144:147], v[200:203], v[36:39]
s_waitcnt lgkmcnt(3)
v_exp_f32 v13, v13
v_mfma_f32_16x16x32_bf16 a[8:11], a[176:179], v[40:43], a[8:11]
ds_read_b128 a[148:151], v217 offset:61440
ds_read_b128 a[144:147], v216 offset:61440
v_mfma_f32_16x16x32_bf16 a[8:11], a[180:183], v[56:59], a[8:11]
v_exp_f32 v14, v14
v_mfma_f32_16x16x32_bf16 a[40:43], a[180:183], v[60:63], a[40:43]
v_cvt_pk_bf16_f32 v85, v34, v35
v_cvt_pk_bf16_f32 v74, v12, v13
v_mfma_f32_16x16x32_bf16 a[40:43], a[176:179], v[44:47], a[40:43]
v_exp_f32 v15, v15
v_mfma_f32_16x16x32_bf16 a[72:75], a[176:179], v[48:51], a[72:75]
v_cvt_pk_bf16_f32 v75, v14, v15
v_mfma_f32_16x16x32_bf16 a[72:75], a[180:183], v[64:67], a[72:75]
v_exp_f32 v20, v20
v_mfma_f32_16x16x32_bf16 a[104:107], a[180:183], v[68:71], a[104:107]
buffer_load_dwordx4 v233, s[12:15], s39 offen offset:1024 lds
v_mfma_f32_16x16x32_bf16 a[104:107], a[176:179], v[52:55], a[104:107]
v_exp_f32 v21, v21
v_mfma_f32_16x16x32_bf16 a[108:111], a[184:187], v[52:55], a[108:111]
ds_read_b64_tr_b16 a[180:181], v226 offset:8192
ds_read_b64_tr_b16 a[182:183], v226 offset:12288
v_mfma_f32_16x16x32_bf16 a[108:111], a[188:191], v[68:71], a[108:111]
v_exp_f32 v22, v22
v_mfma_f32_16x16x32_bf16 a[76:79], a[188:191], v[64:67], a[76:79]
ds_read_b64_tr_b16 a[176:177], v226 offset:0
ds_read_b64_tr_b16 a[178:179], v226 offset:4096
v_mfma_f32_16x16x32_bf16 a[76:79], a[184:187], v[48:51], a[76:79]
v_exp_f32 v23, v23
v_mfma_f32_16x16x32_bf16 a[44:47], a[184:187], v[44:47], a[44:47]
v_cvt_pk_bf16_f32 v78, v20, v21
v_cvt_pk_bf16_f32 v79, v22, v23
v_mfma_f32_16x16x32_bf16 a[44:47], a[188:191], v[60:63], a[44:47]
v_exp_f32 v28, v28
v_mfma_f32_16x16x32_bf16 a[12:15], a[188:191], v[56:59], a[12:15]
ds_read_b64_tr_b16 a[188:189], v227 offset:8192
ds_read_b64_tr_b16 a[190:191], v227 offset:12288
v_mfma_f32_16x16x32_bf16 a[12:15], a[184:187], v[40:43], a[12:15]
v_exp_f32 v29, v29
v_smfmac_f32_16x16x64_bf16 a[252:255], a[208:211], v[64:71], v235
ds_read_b64_tr_b16 a[184:185], v227 offset:0
ds_read_b64_tr_b16 a[186:187], v227 offset:4096
v_mfma_f32_16x16x32_bf16 v[8:11], a[128:131], v[152:155], v[136:139]
v_exp_f32 v30, v30
v_mfma_f32_16x16x32_bf16 v[8:11], a[132:135], v[156:159], v[8:11]
buffer_load_dwordx4 v232, s[12:15], s39 offen offset:2048 lds
v_mfma_f32_16x16x32_bf16 v[8:11], a[136:139], v[160:163], v[8:11]
s_waitcnt lgkmcnt(6)
v_exp_f32 v31, v31
v_mfma_f32_16x16x32_bf16 v[8:11], a[140:143], v[164:167], v[8:11]
v_cvt_pk_bf16_f32 v82, v28, v29
v_cvt_pk_bf16_f32 v83, v30, v31
v_mfma_f32_16x16x32_bf16 v[16:19], a[140:143], v[180:183], v[140:143]
v_exp_f32 v36, v36
v_mfma_f32_16x16x32_bf16 v[16:19], a[136:139], v[176:179], v[16:19]
v_mfma_f32_16x16x32_bf16 v[16:19], a[132:135], v[172:175], v[16:19]
v_exp_f32 v37, v37
v_mfma_f32_16x16x32_bf16 v[16:19], a[128:131], v[168:171], v[16:19]
v_cvt_pk_bf16_f32 v86, v36, v37
v_mfma_f32_16x16x32_bf16 v[24:27], a[128:131], v[184:187], v[144:147]
v_exp_f32 v38, v38
v_mfma_f32_16x16x32_bf16 v[24:27], a[132:135], v[188:191], v[24:27]
v_mfma_f32_16x16x32_bf16 v[24:27], a[136:139], v[192:195], v[24:27]
v_exp_f32 v39, v39
v_mfma_f32_16x16x32_bf16 v[24:27], a[140:143], v[196:199], v[24:27]
v_cvt_pk_bf16_f32 v87, v38, v39
v_mfma_f32_16x16x32_bf16 v[32:35], a[140:143], v[212:215], v[148:151]
v_mfma_f32_16x16x32_bf16 v[32:35], a[136:139], v[208:211], v[32:35]
v_mfma_f32_16x16x32_bf16 v[32:35], a[132:135], v[204:207], v[32:35]
v_mfma_f32_16x16x32_bf16 v[32:35], a[128:131], v[200:203], v[32:35]
v_mfma_f32_16x16x32_bf16 a[16:19], a[160:163], v[40:43], a[16:19]
v_exp_f32 v8, v8
v_mfma_f32_16x16x32_bf16 a[16:19], a[164:167], v[56:59], a[16:19]
v_exp_f32 v9, v9
v_mfma_f32_16x16x32_bf16 a[48:51], a[164:167], v[60:63], a[48:51]
buffer_load_dwordx4 v233, s[12:15], s39 offen offset:3072 lds
v_mfma_f32_16x16x32_bf16 a[48:51], a[160:163], v[44:47], a[48:51]
v_exp_f32 v10, v10
v_mfma_f32_16x16x32_bf16 a[80:83], a[160:163], v[48:51], a[80:83]
v_cvt_pk_bf16_f32 v88, v8, v9
v_mfma_f32_16x16x32_bf16 a[80:83], a[164:167], v[64:67], a[80:83]
v_exp_f32 v11, v11
v_mfma_f32_16x16x32_bf16 a[112:115], a[164:167], v[68:71], a[112:115]
ds_read_b64_tr_b16 a[164:165], v220 offset:24576
ds_read_b64_tr_b16 a[166:167], v220 offset:28672
v_mfma_f32_16x16x32_bf16 a[112:115], a[160:163], v[52:55], a[112:115]
v_exp_f32 v16, v16
v_mfma_f32_16x16x32_bf16 a[116:119], a[168:171], v[52:55], a[116:119]
ds_read_b64_tr_b16 a[160:161], v220 offset:16384
ds_read_b64_tr_b16 a[162:163], v220 offset:20480
v_mfma_f32_16x16x32_bf16 a[116:119], a[172:175], v[68:71], a[116:119]
v_exp_f32 v17, v17
v_mfma_f32_16x16x32_bf16 a[84:87], a[172:175], v[64:67], a[84:87]
v_cvt_pk_bf16_f32 v89, v10, v11
v_cvt_pk_bf16_f32 v92, v16, v17
v_mfma_f32_16x16x32_bf16 a[84:87], a[168:171], v[48:51], a[84:87]
v_exp_f32 v18, v18
v_mfma_f32_16x16x32_bf16 a[52:55], a[168:171], v[44:47], a[52:55]
v_mfma_f32_16x16x32_bf16 a[52:55], a[172:175], v[60:63], a[52:55]
s_add_u32 s39, s39, 16384
v_exp_f32 v19, v19
v_mfma_f32_16x16x32_bf16 a[20:23], a[172:175], v[56:59], a[20:23]
s_add_u32 m0, s37, 0
ds_read_b64_tr_b16 a[172:173], v221 offset:24576
ds_read_b64_tr_b16 a[174:175], v221 offset:28672
v_mfma_f32_16x16x32_bf16 a[20:23], a[168:171], v[40:43], a[20:23]
v_exp_f32 v24, v24
v_smfmac_f32_16x16x64_bf16 a[248:251], a[208:211], v[72:79], v235
buffer_load_dwordx4 v228, s[8:11], s38 offen offset:0 lds
v_mfma_f32_16x16x32_bf16 v[12:15], a[144:147], v[152:155], v[136:139]
v_exp_f32 v25, v25
v_mfma_f32_16x16x32_bf16 v[12:15], a[148:151], v[156:159], v[12:15]
ds_read_b64_tr_b16 a[168:169], v221 offset:16384
ds_read_b64_tr_b16 a[170:171], v221 offset:20480
v_mfma_f32_16x16x32_bf16 v[12:15], a[152:155], v[160:163], v[12:15]
v_exp_f32 v26, v26
v_mfma_f32_16x16x32_bf16 v[12:15], a[156:159], v[164:167], v[12:15]
ds_read_b128 a[128:131], v216 offset:32768
ds_read_b128 a[132:135], v217 offset:32768
v_mfma_f32_16x16x32_bf16 v[20:23], a[156:159], v[180:183], v[140:143]
v_exp_f32 v27, v27
v_mfma_f32_16x16x32_bf16 v[20:23], a[152:155], v[176:179], v[20:23]
ds_read_b128 a[136:139], v218 offset:32768
v_cvt_pk_bf16_f32 v93, v18, v19
v_mfma_f32_16x16x32_bf16 v[20:23], a[148:151], v[172:175], v[20:23]
v_exp_f32 v32, v32
v_mfma_f32_16x16x32_bf16 v[20:23], a[144:147], v[168:171], v[20:23]
ds_read_b128 a[140:143], v219 offset:32768
v_cvt_pk_bf16_f32 v96, v24, v25
v_mfma_f32_16x16x32_bf16 v[28:31], a[144:147], v[184:187], v[144:147]
v_exp_f32 v33, v33
v_mfma_f32_16x16x32_bf16 v[28:31], a[148:151], v[188:191], v[28:31]
buffer_load_dwordx4 v229, s[8:11], s38 offen offset:1024 lds
v_mfma_f32_16x16x32_bf16 v[28:31], a[152:155], v[192:195], v[28:31]
v_exp_f32 v34, v34
v_mfma_f32_16x16x32_bf16 v[28:31], a[156:159], v[196:199], v[28:31]
v_cvt_pk_bf16_f32 v97, v26, v27
v_cvt_pk_bf16_f32 v100, v32, v33
v_mfma_f32_16x16x32_bf16 v[36:39], a[156:159], v[212:215], v[148:151]
v_exp_f32 v35, v35
v_mfma_f32_16x16x32_bf16 v[36:39], a[152:155], v[208:211], v[36:39]
ds_read_b128 a[156:159], v219 offset:36864
ds_read_b128 a[152:155], v218 offset:36864
v_mfma_f32_16x16x32_bf16 v[36:39], a[148:151], v[204:207], v[36:39]
v_exp_f32 v12, v12
v_mfma_f32_16x16x32_bf16 v[36:39], a[144:147], v[200:203], v[36:39]
s_waitcnt lgkmcnt(3)
v_exp_f32 v13, v13
v_mfma_f32_16x16x32_bf16 a[24:27], a[176:179], v[40:43], a[24:27]
ds_read_b128 a[148:151], v217 offset:36864
ds_read_b128 a[144:147], v216 offset:36864
v_mfma_f32_16x16x32_bf16 a[24:27], a[180:183], v[56:59], a[24:27]
v_exp_f32 v14, v14
v_mfma_f32_16x16x32_bf16 a[56:59], a[180:183], v[60:63], a[56:59]
v_cvt_pk_bf16_f32 v101, v34, v35
v_cvt_pk_bf16_f32 v90, v12, v13
v_mfma_f32_16x16x32_bf16 a[56:59], a[176:179], v[44:47], a[56:59]
v_exp_f32 v15, v15
v_mfma_f32_16x16x32_bf16 a[88:91], a[176:179], v[48:51], a[88:91]
v_cvt_pk_bf16_f32 v91, v14, v15
v_mfma_f32_16x16x32_bf16 a[88:91], a[180:183], v[64:67], a[88:91]
v_exp_f32 v20, v20
v_mfma_f32_16x16x32_bf16 a[120:123], a[180:183], v[68:71], a[120:123]
buffer_load_dwordx4 v230, s[8:11], s38 offen offset:2048 lds
v_mfma_f32_16x16x32_bf16 a[120:123], a[176:179], v[52:55], a[120:123]
v_exp_f32 v21, v21
v_mfma_f32_16x16x32_bf16 a[124:127], a[184:187], v[52:55], a[124:127]
ds_read_b64_tr_b16 a[180:181], v222 offset:24576
ds_read_b64_tr_b16 a[182:183], v222 offset:28672
v_mfma_f32_16x16x32_bf16 a[124:127], a[188:191], v[68:71], a[124:127]
v_exp_f32 v22, v22
v_mfma_f32_16x16x32_bf16 a[92:95], a[188:191], v[64:67], a[92:95]
ds_read_b64_tr_b16 a[176:177], v222 offset:16384
ds_read_b64_tr_b16 a[178:179], v222 offset:20480
v_mfma_f32_16x16x32_bf16 a[92:95], a[184:187], v[48:51], a[92:95]
v_exp_f32 v23, v23
v_mfma_f32_16x16x32_bf16 a[60:63], a[184:187], v[44:47], a[60:63]
v_cvt_pk_bf16_f32 v94, v20, v21
v_cvt_pk_bf16_f32 v95, v22, v23
v_mfma_f32_16x16x32_bf16 a[60:63], a[188:191], v[60:63], a[60:63]
v_exp_f32 v28, v28
v_mfma_f32_16x16x32_bf16 a[28:31], a[188:191], v[56:59], a[28:31]
ds_read_b64_tr_b16 a[188:189], v223 offset:24576
ds_read_b64_tr_b16 a[190:191], v223 offset:28672
v_mfma_f32_16x16x32_bf16 a[28:31], a[184:187], v[40:43], a[28:31]
v_exp_f32 v29, v29
v_smfmac_f32_16x16x64_bf16 a[252:255], a[208:211], v[80:87], v235
ds_read_b64_tr_b16 a[184:185], v223 offset:16384
ds_read_b64_tr_b16 a[186:187], v223 offset:20480
v_mfma_f32_16x16x32_bf16 v[8:11], a[128:131], v[152:155], v[136:139]
v_exp_f32 v30, v30
v_mfma_f32_16x16x32_bf16 v[8:11], a[132:135], v[156:159], v[8:11]
buffer_load_dwordx4 v231, s[8:11], s38 offen offset:3072 lds
v_mfma_f32_16x16x32_bf16 v[8:11], a[136:139], v[160:163], v[8:11]
s_waitcnt lgkmcnt(6)
v_exp_f32 v31, v31
v_mfma_f32_16x16x32_bf16 v[8:11], a[140:143], v[164:167], v[8:11]
v_cvt_pk_bf16_f32 v98, v28, v29
v_cvt_pk_bf16_f32 v99, v30, v31
v_mfma_f32_16x16x32_bf16 v[16:19], a[140:143], v[180:183], v[140:143]
v_exp_f32 v36, v36
v_mfma_f32_16x16x32_bf16 v[16:19], a[136:139], v[176:179], v[16:19]
v_mfma_f32_16x16x32_bf16 v[16:19], a[132:135], v[172:175], v[16:19]
v_exp_f32 v37, v37
v_mfma_f32_16x16x32_bf16 v[16:19], a[128:131], v[168:171], v[16:19]
v_cvt_pk_bf16_f32 v102, v36, v37
v_mfma_f32_16x16x32_bf16 v[24:27], a[128:131], v[184:187], v[144:147]
v_exp_f32 v38, v38
v_mfma_f32_16x16x32_bf16 v[24:27], a[132:135], v[188:191], v[24:27]
v_mfma_f32_16x16x32_bf16 v[24:27], a[136:139], v[192:195], v[24:27]
v_exp_f32 v39, v39
v_mfma_f32_16x16x32_bf16 v[24:27], a[140:143], v[196:199], v[24:27]
v_cvt_pk_bf16_f32 v103, v38, v39
v_mfma_f32_16x16x32_bf16 v[32:35], a[140:143], v[212:215], v[148:151]
v_mfma_f32_16x16x32_bf16 v[32:35], a[136:139], v[208:211], v[32:35]
s_add_u32 s38, s38, 16384
v_mfma_f32_16x16x32_bf16 v[32:35], a[132:135], v[204:207], v[32:35]
v_mfma_f32_16x16x32_bf16 v[32:35], a[128:131], v[200:203], v[32:35]
v_mfma_f32_16x16x32_bf16 a[0:3], a[160:163], v[72:75], a[0:3]
v_exp_f32 v8, v8
v_mfma_f32_16x16x32_bf16 a[0:3], a[164:167], v[88:91], a[0:3]
v_exp_f32 v9, v9
v_mfma_f32_16x16x32_bf16 a[32:35], a[164:167], v[92:95], a[32:35]
buffer_load_dwordx2 v[252:253], v251, s[76:79], s42 offen sc1
v_mfma_f32_16x16x32_bf16 a[32:35], a[160:163], v[76:79], a[32:35]
v_exp_f32 v10, v10
v_mfma_f32_16x16x32_bf16 a[64:67], a[160:163], v[80:83], a[64:67]
v_cvt_pk_bf16_f32 v40, v8, v9
v_mfma_f32_16x16x32_bf16 a[64:67], a[164:167], v[96:99], a[64:67]
v_exp_f32 v11, v11
v_mfma_f32_16x16x32_bf16 a[96:99], a[164:167], v[100:103], a[96:99]
ds_read_b64_tr_b16 a[164:165], v224 offset:24576
ds_read_b64_tr_b16 a[166:167], v224 offset:28672
v_mfma_f32_16x16x32_bf16 a[96:99], a[160:163], v[84:87], a[96:99]
v_exp_f32 v16, v16
v_mfma_f32_16x16x32_bf16 a[100:103], a[168:171], v[84:87], a[100:103]
ds_read_b64_tr_b16 a[160:161], v224 offset:16384
ds_read_b64_tr_b16 a[162:163], v224 offset:20480
v_mfma_f32_16x16x32_bf16 a[100:103], a[172:175], v[100:103], a[100:103]
v_exp_f32 v17, v17
v_mfma_f32_16x16x32_bf16 a[68:71], a[172:175], v[96:99], a[68:71]
s_add_u32 s42, s42, s43
buffer_load_dword v255, v243, s[28:31], s45 offen
v_mfma_f32_16x16x32_bf16 a[68:71], a[168:171], v[80:83], a[68:71]
v_exp_f32 v18, v18
v_mfma_f32_16x16x32_bf16 a[36:39], a[168:171], v[76:79], a[36:39]
v_cvt_pk_bf16_f32 v41, v10, v11
v_cvt_pk_bf16_f32 v44, v16, v17
v_mfma_f32_16x16x32_bf16 a[36:39], a[172:175], v[92:95], a[36:39]
v_exp_f32 v19, v19
v_mfma_f32_16x16x32_bf16 a[4:7], a[172:175], v[88:91], a[4:7]
ds_read_b64_tr_b16 a[172:173], v225 offset:24576
ds_read_b64_tr_b16 a[174:175], v225 offset:28672
v_mfma_f32_16x16x32_bf16 a[4:7], a[168:171], v[72:75], a[4:7]
v_exp_f32 v24, v24
v_smfmac_f32_16x16x64_bf16 a[248:251], a[208:211], v[88:95], v235
ds_read_b64_tr_b16 a[168:169], v225 offset:16384
ds_read_b64_tr_b16 a[170:171], v225 offset:20480
v_mfma_f32_16x16x32_bf16 v[12:15], a[144:147], v[152:155], v[136:139]
v_exp_f32 v25, v25
v_mfma_f32_16x16x32_bf16 v[12:15], a[148:151], v[156:159], v[12:15]
ds_read_b128 a[128:131], v216 offset:40960
v_cvt_pk_bf16_f32 v45, v18, v19
v_mfma_f32_16x16x32_bf16 v[12:15], a[152:155], v[160:163], v[12:15]
s_add_u32 s45, s45, 589824
v_exp_f32 v26, v26
v_mfma_f32_16x16x32_bf16 v[12:15], a[156:159], v[164:167], v[12:15]
global_load_dword v255, v242, s[72:73]
v_mfma_f32_16x16x32_bf16 v[20:23], a[156:159], v[180:183], v[140:143]
v_exp_f32 v27, v27
v_mfma_f32_16x16x32_bf16 v[20:23], a[152:155], v[176:179], v[20:23]
ds_read_b128 a[132:135], v217 offset:40960
ds_read_b128 a[136:139], v218 offset:40960
v_mfma_f32_16x16x32_bf16 v[20:23], a[148:151], v[172:175], v[20:23]
v_exp_f32 v32, v32
v_mfma_f32_16x16x32_bf16 v[20:23], a[144:147], v[168:171], v[20:23]
ds_read_b128 a[140:143], v219 offset:40960
v_cvt_pk_bf16_f32 v48, v24, v25
v_mfma_f32_16x16x32_bf16 v[28:31], a[144:147], v[184:187], v[144:147]
v_exp_f32 v33, v33
v_mfma_f32_16x16x32_bf16 v[28:31], a[148:151], v[188:191], v[28:31]
v_cvt_pk_bf16_f32 v49, v26, v27
v_cvt_pk_bf16_f32 v52, v32, v33
v_mfma_f32_16x16x32_bf16 v[28:31], a[152:155], v[192:195], v[28:31]
v_exp_f32 v34, v34
v_mfma_f32_16x16x32_bf16 v[28:31], a[156:159], v[196:199], v[28:31]
buffer_load_dword v255, v0, s[24:27], s44 offen
v_mfma_f32_16x16x32_bf16 v[36:39], a[156:159], v[212:215], v[148:151]
v_exp_f32 v35, v35
v_mfma_f32_16x16x32_bf16 v[36:39], a[152:155], v[208:211], v[36:39]
ds_read_b128 a[156:159], v219 offset:45056
ds_read_b128 a[152:155], v218 offset:45056
v_mfma_f32_16x16x32_bf16 v[36:39], a[148:151], v[204:207], v[36:39]
v_exp_f32 v12, v12
v_mfma_f32_16x16x32_bf16 v[36:39], a[144:147], v[200:203], v[36:39]
s_waitcnt lgkmcnt(3)
v_exp_f32 v13, v13
v_mfma_f32_16x16x32_bf16 a[8:11], a[176:179], v[72:75], a[8:11]
ds_read_b128 a[148:151], v217 offset:45056
ds_read_b128 a[144:147], v216 offset:45056
v_mfma_f32_16x16x32_bf16 a[8:11], a[180:183], v[88:91], a[8:11]
v_exp_f32 v14, v14
v_mfma_f32_16x16x32_bf16 a[40:43], a[180:183], v[92:95], a[40:43]
v_cvt_pk_bf16_f32 v53, v34, v35
v_cvt_pk_bf16_f32 v42, v12, v13
v_mfma_f32_16x16x32_bf16 a[40:43], a[176:179], v[76:79], a[40:43]
v_exp_f32 v15, v15
v_mfma_f32_16x16x32_bf16 a[72:75], a[176:179], v[80:83], a[72:75]
s_add_u32 s44, s44, 4096
v_cvt_pk_bf16_f32 v43, v14, v15
v_mfma_f32_16x16x32_bf16 a[72:75], a[180:183], v[96:99], a[72:75]
v_exp_f32 v20, v20
v_mfma_f32_16x16x32_bf16 a[104:107], a[180:183], v[100:103], a[104:107]
ds_read_b64_tr_b16 a[180:181], v226 offset:24576
ds_read_b64_tr_b16 a[182:183], v226 offset:28672
v_mfma_f32_16x16x32_bf16 a[104:107], a[176:179], v[84:87], a[104:107]
v_exp_f32 v21, v21
v_mfma_f32_16x16x32_bf16 a[108:111], a[184:187], v[84:87], a[108:111]
ds_read_b64_tr_b16 a[176:177], v226 offset:16384
ds_read_b64_tr_b16 a[178:179], v226 offset:20480
v_mfma_f32_16x16x32_bf16 a[108:111], a[188:191], v[100:103], a[108:111]
v_exp_f32 v22, v22
v_mfma_f32_16x16x32_bf16 a[76:79], a[188:191], v[96:99], a[76:79]
v_cvt_pk_bf16_f32 v46, v20, v21
v_mfma_f32_16x16x32_bf16 a[76:79], a[184:187], v[80:83], a[76:79]
v_exp_f32 v23, v23
v_mfma_f32_16x16x32_bf16 a[44:47], a[184:187], v[76:79], a[44:47]
v_cvt_pk_bf16_f32 v47, v22, v23
v_mfma_f32_16x16x32_bf16 a[44:47], a[188:191], v[92:95], a[44:47]
v_exp_f32 v28, v28
v_mfma_f32_16x16x32_bf16 a[12:15], a[188:191], v[88:91], a[12:15]
ds_read_b64_tr_b16 a[188:189], v227 offset:24576
ds_read_b64_tr_b16 a[190:191], v227 offset:28672
v_mfma_f32_16x16x32_bf16 a[12:15], a[184:187], v[72:75], a[12:15]
v_exp_f32 v29, v29
v_smfmac_f32_16x16x64_bf16 a[252:255], a[208:211], v[96:103], v235
ds_read_b64_tr_b16 a[184:185], v227 offset:16384
ds_read_b64_tr_b16 a[186:187], v227 offset:20480
v_mfma_f32_16x16x32_bf16 v[8:11], a[128:131], v[152:155], v[136:139]
v_exp_f32 v30, v30
v_mfma_f32_16x16x32_bf16 v[8:11], a[132:135], v[156:159], v[8:11]
v_cvt_pk_bf16_f32 v50, v28, v29
v_mfma_f32_16x16x32_bf16 v[8:11], a[136:139], v[160:163], v[8:11]
s_waitcnt lgkmcnt(4)
v_exp_f32 v31, v31
v_mfma_f32_16x16x32_bf16 v[8:11], a[140:143], v[164:167], v[8:11]
v_cvt_pk_bf16_f32 v51, v30, v31
v_mfma_f32_16x16x32_bf16 v[16:19], a[140:143], v[180:183], v[140:143]
v_exp_f32 v36, v36
v_mfma_f32_16x16x32_bf16 v[16:19], a[136:139], v[176:179], v[16:19]
v_mfma_f32_16x16x32_bf16 v[16:19], a[132:135], v[172:175], v[16:19]
v_exp_f32 v37, v37
v_mfma_f32_16x16x32_bf16 v[16:19], a[128:131], v[168:171], v[16:19]
v_cvt_pk_bf16_f32 v54, v36, v37
v_mfma_f32_16x16x32_bf16 v[24:27], a[128:131], v[184:187], v[144:147]
v_exp_f32 v38, v38
v_mfma_f32_16x16x32_bf16 v[24:27], a[132:135], v[188:191], v[24:27]
v_mfma_f32_16x16x32_bf16 v[24:27], a[136:139], v[192:195], v[24:27]
v_exp_f32 v39, v39
v_mfma_f32_16x16x32_bf16 v[24:27], a[140:143], v[196:199], v[24:27]
v_cvt_pk_bf16_f32 v55, v38, v39
v_mfma_f32_16x16x32_bf16 v[32:35], a[140:143], v[212:215], v[148:151]
v_mfma_f32_16x16x32_bf16 v[32:35], a[136:139], v[208:211], v[32:35]
v_mfma_f32_16x16x32_bf16 v[32:35], a[132:135], v[204:207], v[32:35]
v_mfma_f32_16x16x32_bf16 v[32:35], a[128:131], v[200:203], v[32:35]
v_mfma_f32_16x16x32_bf16 a[16:19], a[160:163], v[72:75], a[16:19]
v_exp_f32 v8, v8
v_mfma_f32_16x16x32_bf16 a[16:19], a[164:167], v[88:91], a[16:19]
v_exp_f32 v9, v9
v_mfma_f32_16x16x32_bf16 a[48:51], a[164:167], v[92:95], a[48:51]
v_cvt_pk_bf16_f32 v56, v8, v9
v_mfma_f32_16x16x32_bf16 a[48:51], a[160:163], v[76:79], a[48:51]
v_exp_f32 v10, v10
v_mfma_f32_16x16x32_bf16 a[80:83], a[160:163], v[80:83], a[80:83]
v_mfma_f32_16x16x32_bf16 a[80:83], a[164:167], v[96:99], a[80:83]
v_exp_f32 v11, v11
s_waitcnt vmcnt(4) lgkmcnt(0)
s_barrier
v_mfma_f32_16x16x32_bf16 a[112:115], a[164:167], v[100:103], a[112:115]
ds_read_b64_tr_b16 a[164:165], v220 offset:40960
ds_read_b64_tr_b16 a[166:167], v220 offset:45056
v_mfma_f32_16x16x32_bf16 a[112:115], a[160:163], v[84:87], a[112:115]
s_add_u32 m0, s37, 65536
v_exp_f32 v16, v16
v_mfma_f32_16x16x32_bf16 a[116:119], a[168:171], v[84:87], a[116:119]
buffer_load_dwordx4 v232, s[12:15], s39 offen offset:0 lds
v_mfma_f32_16x16x32_bf16 a[116:119], a[172:175], v[100:103], a[116:119]
v_exp_f32 v17, v17
v_mfma_f32_16x16x32_bf16 a[84:87], a[172:175], v[96:99], a[84:87]
ds_read_b64_tr_b16 a[160:161], v220 offset:32768
ds_read_b64_tr_b16 a[162:163], v220 offset:36864
v_mfma_f32_16x16x32_bf16 a[84:87], a[168:171], v[80:83], a[84:87]
v_exp_f32 v18, v18
v_mfma_f32_16x16x32_bf16 a[52:55], a[168:171], v[76:79], a[52:55]
v_cvt_pk_bf16_f32 v57, v10, v11
v_cvt_pk_bf16_f32 v60, v16, v17
v_mfma_f32_16x16x32_bf16 a[52:55], a[172:175], v[92:95], a[52:55]
v_exp_f32 v19, v19
v_mfma_f32_16x16x32_bf16 a[20:23], a[172:175], v[88:91], a[20:23]
ds_read_b64_tr_b16 a[172:173], v221 offset:40960
ds_read_b64_tr_b16 a[174:175], v221 offset:45056
v_mfma_f32_16x16x32_bf16 a[20:23], a[168:171], v[72:75], a[20:23]
v_exp_f32 v24, v24
v_smfmac_f32_16x16x64_bf16 a[248:251], a[208:211], v[40:47], v235
buffer_load_dwordx4 v233, s[12:15], s39 offen offset:1024 lds
v_mfma_f32_16x16x32_bf16 v[12:15], a[144:147], v[152:155], v[136:139]
v_exp_f32 v25, v25
v_mfma_f32_16x16x32_bf16 v[12:15], a[148:151], v[156:159], v[12:15]
ds_read_b64_tr_b16 a[168:169], v221 offset:32768
ds_read_b64_tr_b16 a[170:171], v221 offset:36864
v_mfma_f32_16x16x32_bf16 v[12:15], a[152:155], v[160:163], v[12:15]
v_exp_f32 v26, v26
v_mfma_f32_16x16x32_bf16 v[12:15], a[156:159], v[164:167], v[12:15]
ds_read_b128 a[128:131], v216 offset:16384
ds_read_b128 a[132:135], v217 offset:16384
v_mfma_f32_16x16x32_bf16 v[20:23], a[156:159], v[180:183], v[140:143]
v_exp_f32 v27, v27
v_mfma_f32_16x16x32_bf16 v[20:23], a[152:155], v[176:179], v[20:23]
ds_read_b128 a[136:139], v218 offset:16384
v_cvt_pk_bf16_f32 v61, v18, v19
v_mfma_f32_16x16x32_bf16 v[20:23], a[148:151], v[172:175], v[20:23]
v_exp_f32 v32, v32
v_mfma_f32_16x16x32_bf16 v[20:23], a[144:147], v[168:171], v[20:23]
ds_read_b128 a[140:143], v219 offset:16384
v_cvt_pk_bf16_f32 v64, v24, v25
v_mfma_f32_16x16x32_bf16 v[28:31], a[144:147], v[184:187], v[144:147]
v_exp_f32 v33, v33
v_mfma_f32_16x16x32_bf16 v[28:31], a[148:151], v[188:191], v[28:31]
buffer_load_dwordx4 v232, s[12:15], s39 offen offset:2048 lds
v_mfma_f32_16x16x32_bf16 v[28:31], a[152:155], v[192:195], v[28:31]
v_exp_f32 v34, v34
v_mfma_f32_16x16x32_bf16 v[28:31], a[156:159], v[196:199], v[28:31]
v_cvt_pk_bf16_f32 v65, v26, v27
v_cvt_pk_bf16_f32 v68, v32, v33
v_mfma_f32_16x16x32_bf16 v[36:39], a[156:159], v[212:215], v[148:151]
v_exp_f32 v35, v35
v_mfma_f32_16x16x32_bf16 v[36:39], a[152:155], v[208:211], v[36:39]
ds_read_b128 a[156:159], v219 offset:20480
ds_read_b128 a[152:155], v218 offset:20480
v_mfma_f32_16x16x32_bf16 v[36:39], a[148:151], v[204:207], v[36:39]
v_exp_f32 v12, v12
v_mfma_f32_16x16x32_bf16 v[36:39], a[144:147], v[200:203], v[36:39]
v_exp_f32 v13, v13
v_mfma_f32_16x16x32_bf16 a[24:27], a[176:179], v[72:75], a[24:27]
ds_read_b128 a[148:151], v217 offset:20480
ds_read_b128 a[144:147], v216 offset:20480
v_mfma_f32_16x16x32_bf16 a[24:27], a[180:183], v[88:91], a[24:27]
v_exp_f32 v14, v14
v_mfma_f32_16x16x32_bf16 a[56:59], a[180:183], v[92:95], a[56:59]
buffer_load_dwordx4 v233, s[12:15], s39 offen offset:3072 lds
v_mfma_f32_16x16x32_bf16 a[56:59], a[176:179], v[76:79], a[56:59]
v_exp_f32 v15, v15
v_mfma_f32_16x16x32_bf16 a[88:91], a[176:179], v[80:83], a[88:91]
v_cvt_pk_bf16_f32 v69, v34, v35
v_cvt_pk_bf16_f32 v58, v12, v13
v_mfma_f32_16x16x32_bf16 a[88:91], a[180:183], v[96:99], a[88:91]
v_exp_f32 v20, v20
v_mfma_f32_16x16x32_bf16 a[120:123], a[180:183], v[100:103], a[120:123]
ds_read_b64_tr_b16 a[180:181], v222 offset:40960
ds_read_b64_tr_b16 a[182:183], v222 offset:45056
v_mfma_f32_16x16x32_bf16 a[120:123], a[176:179], v[84:87], a[120:123]
v_exp_f32 v21, v21
v_mfma_f32_16x16x32_bf16 a[124:127], a[184:187], v[84:87], a[124:127]
ds_read_b64_tr_b16 a[176:177], v222 offset:32768
ds_read_b64_tr_b16 a[178:179], v222 offset:36864
v_mfma_f32_16x16x32_bf16 a[124:127], a[188:191], v[100:103], a[124:127]
v_exp_f32 v22, v22
v_mfma_f32_16x16x32_bf16 a[92:95], a[188:191], v[96:99], a[92:95]
v_cvt_pk_bf16_f32 v59, v14, v15
v_cvt_pk_bf16_f32 v62, v20, v21
v_mfma_f32_16x16x32_bf16 a[92:95], a[184:187], v[80:83], a[92:95]
s_add_u32 s39, s39, 16384
v_exp_f32 v23, v23
v_mfma_f32_16x16x32_bf16 a[60:63], a[184:187], v[76:79], a[60:63]
s_add_u32 m0, s37, 49152
v_cvt_pk_bf16_f32 v63, v22, v23
v_mfma_f32_16x16x32_bf16 a[60:63], a[188:191], v[92:95], a[60:63]
v_exp_f32 v28, v28
v_mfma_f32_16x16x32_bf16 a[28:31], a[188:191], v[88:91], a[28:31]
buffer_load_dwordx4 v228, s[8:11], s38 offen offset:0 lds
v_mfma_f32_16x16x32_bf16 a[28:31], a[184:187], v[72:75], a[28:31]
v_exp_f32 v29, v29
v_smfmac_f32_16x16x64_bf16 a[252:255], a[208:211], v[48:55], v235
s_waitcnt lgkmcnt(2)
ds_read_b64_tr_b16 a[188:189], v223 offset:40960
ds_read_b64_tr_b16 a[190:191], v223 offset:45056
v_mfma_f32_16x16x32_bf16 v[8:11], a[128:131], v[152:155], v[136:139]
v_exp_f32 v30, v30
v_mfma_f32_16x16x32_bf16 v[8:11], a[132:135], v[156:159], v[8:11]
ds_read_b64_tr_b16 a[184:185], v223 offset:32768
ds_read_b64_tr_b16 a[186:187], v223 offset:36864
v_mfma_f32_16x16x32_bf16 v[8:11], a[136:139], v[160:163], v[8:11]
v_exp_f32 v31, v31
v_mfma_f32_16x16x32_bf16 v[8:11], a[140:143], v[164:167], v[8:11]
buffer_load_dwordx4 v229, s[8:11], s38 offen offset:1024 lds
v_mfma_f32_16x16x32_bf16 v[16:19], a[140:143], v[180:183], v[140:143]
v_exp_f32 v36, v36
v_mfma_f32_16x16x32_bf16 v[16:19], a[136:139], v[176:179], v[16:19]
v_cvt_pk_bf16_f32 v66, v28, v29
v_cvt_pk_bf16_f32 v67, v30, v31
v_mfma_f32_16x16x32_bf16 v[16:19], a[132:135], v[172:175], v[16:19]
v_exp_f32 v37, v37
v_mfma_f32_16x16x32_bf16 v[16:19], a[128:131], v[168:171], v[16:19]
v_cvt_pk_bf16_f32 v70, v36, v37
v_mfma_f32_16x16x32_bf16 v[24:27], a[128:131], v[184:187], v[144:147]
v_exp_f32 v38, v38
v_mfma_f32_16x16x32_bf16 v[24:27], a[132:135], v[188:191], v[24:27]
v_mfma_f32_16x16x32_bf16 v[24:27], a[136:139], v[192:195], v[24:27]
v_exp_f32 v39, v39
v_mfma_f32_16x16x32_bf16 v[24:27], a[140:143], v[196:199], v[24:27]
v_cvt_pk_bf16_f32 v71, v38, v39
v_mfma_f32_16x16x32_bf16 v[32:35], a[140:143], v[212:215], v[148:151]
v_mfma_f32_16x16x32_bf16 v[32:35], a[136:139], v[208:211], v[32:35]
v_mfma_f32_16x16x32_bf16 v[32:35], a[132:135], v[204:207], v[32:35]
v_mfma_f32_16x16x32_bf16 v[32:35], a[128:131], v[200:203], v[32:35]
s_branch K_LOOP
K_EXIT:
s_cmp_lg_u32 s40, 8
s_cbranch_scc1 K_HOOK
s_cmp_lg_u32 s52, 0
s_cbranch_scc1 K_YR0
K_LAST:
v_mfma_f32_16x16x32_bf16 a[16:19], a[160:163], v[72:75], a[16:19]
s_add_u32 s46, s36, 1
v_exp_f32 v8, v8
v_mfma_f32_16x16x32_bf16 a[16:19], a[164:167], v[88:91], a[16:19]
s_and_b32 s46, s46, 3
v_exp_f32 v9, v9
v_mfma_f32_16x16x32_bf16 a[48:51], a[164:167], v[92:95], a[48:51]
s_mul_i32 s42, s46, 294912
v_cvt_pk_bf16_f32 v56, v8, v9
v_mfma_f32_16x16x32_bf16 a[48:51], a[160:163], v[76:79], a[48:51]
s_add_u32 s42, s42, s84
v_exp_f32 v10, v10
v_mfma_f32_16x16x32_bf16 a[80:83], a[160:163], v[80:83], a[80:83]
s_add_u32 s46, s36, 2
v_mfma_f32_16x16x32_bf16 a[80:83], a[164:167], v[96:99], a[80:83]
s_and_b32 s46, s46, 3
v_exp_f32 v11, v11
s_waitcnt vmcnt(4) lgkmcnt(0)
s_barrier
v_mfma_f32_16x16x32_bf16 a[112:115], a[164:167], v[100:103], a[112:115]
s_mul_i32 s43, s46, 294912
ds_read_b64_tr_b16 a[164:165], v220 offset:8192
ds_read_b64_tr_b16 a[166:167], v220 offset:12288
v_mfma_f32_16x16x32_bf16 a[112:115], a[160:163], v[84:87], a[112:115]
s_add_u32 m0, s3, 98304
v_exp_f32 v16, v16
v_mfma_f32_16x16x32_bf16 a[116:119], a[168:171], v[84:87], a[116:119]
s_add_u32 s48, s51, 0
buffer_load_dwordx4 v236, s[16:19], s48 offen lds
v_mfma_f32_16x16x32_bf16 a[116:119], a[172:175], v[100:103], a[116:119]
s_add_u32 s43, s43, s84
v_exp_f32 v17, v17
v_mfma_f32_16x16x32_bf16 a[84:87], a[172:175], v[96:99], a[84:87]
s_add_u32 s46, s36, 3
ds_read_b64_tr_b16 a[160:161], v220 offset:0
ds_read_b64_tr_b16 a[162:163], v220 offset:4096
v_mfma_f32_16x16x32_bf16 a[84:87], a[168:171], v[80:83], a[84:87]
s_add_u32 m0, s3, 102400
v_exp_f32 v18, v18
v_mfma_f32_16x16x32_bf16 a[52:55], a[168:171], v[76:79], a[52:55]
s_add_u32 s48, s51, 18432
buffer_load_dwordx4 v236, s[16:19], s48 offen lds
v_mfma_f32_16x16x32_bf16 a[52:55], a[172:175], v[92:95], a[52:55]
s_and_b32 s46, s46, 3
v_exp_f32 v19, v19
v_mfma_f32_16x16x32_bf16 a[20:23], a[172:175], v[88:91], a[20:23]
s_mul_i32 s44, s46, 294912
ds_read_b64_tr_b16 a[172:173], v221 offset:8192
ds_read_b64_tr_b16 a[174:175], v221 offset:12288
v_mfma_f32_16x16x32_bf16 a[20:23], a[168:171], v[72:75], a[20:23]
s_add_u32 s44, s44, s84
v_exp_f32 v24, v24
v_smfmac_f32_16x16x64_bf16 a[248:251], a[208:211], v[40:47], v235
s_add_u32 m0, s3, 106496
ds_read_b64_tr_b16 a[168:169], v221 offset:0
ds_read_b64_tr_b16 a[170:171], v221 offset:4096
v_mfma_f32_16x16x32_bf16 v[12:15], a[144:147], v[152:155], v[136:139]
s_add_u32 s48, s51, 36864
v_exp_f32 v25, v25
v_mfma_f32_16x16x32_bf16 v[12:15], a[148:151], v[156:159], v[12:15]
s_cmp_eq_u32 s32, s36
s_cselect_b32 s83, s52, 0
buffer_load_dwordx4 v236, s[16:19], s48 offen lds
v_mfma_f32_16x16x32_bf16 v[12:15], a[152:155], v[160:163], v[12:15]
v_exp_f32 v26, v26
v_mfma_f32_16x16x32_bf16 v[12:15], a[156:159], v[164:167], v[12:15]
ds_read_b128 a[128:131], v216 offset:49152
ds_read_b128 a[132:135], v217 offset:49152
v_mfma_f32_16x16x32_bf16 v[20:23], a[156:159], v[180:183], v[140:143]
s_add_u32 m0, s3, 110592
v_exp_f32 v27, v27
v_mfma_f32_16x16x32_bf16 v[20:23], a[152:155], v[176:179], v[20:23]
s_add_u32 s48, s51, 55296
buffer_load_dwordx4 v236, s[16:19], s48 offen lds
v_mfma_f32_16x16x32_bf16 v[20:23], a[148:151], v[172:175], v[20:23]
v_exp_f32 v32, v32
v_mfma_f32_16x16x32_bf16 v[20:23], a[144:147], v[168:171], v[20:23]
ds_read_b128 a[136:139], v218 offset:49152
ds_read_b128 a[140:143], v219 offset:49152
v_mfma_f32_16x16x32_bf16 v[28:31], a[144:147], v[184:187], v[144:147]
s_add_u32 m0, s3, 114688
v_exp_f32 v33, v33
v_mfma_f32_16x16x32_bf16 v[28:31], a[148:151], v[188:191], v[28:31]
s_add_u32 s48, s51, 73728
buffer_load_dwordx4 v236, s[16:19], s48 offen lds
v_mfma_f32_16x16x32_bf16 v[28:31], a[152:155], v[192:195], v[28:31]
v_exp_f32 v34, v34
v_mfma_f32_16x16x32_bf16 v[28:31], a[156:159], v[196:199], v[28:31]
v_cvt_pk_bf16_f32 v57, v10, v11
v_cvt_pk_bf16_f32 v60, v16, v17
v_mfma_f32_16x16x32_bf16 v[36:39], a[156:159], v[212:215], v[148:151]
v_exp_f32 v35, v35
v_mfma_f32_16x16x32_bf16 v[36:39], a[152:155], v[208:211], v[36:39]
s_add_u32 m0, s3, 118784
ds_read_b128 a[156:159], v219 offset:53248
ds_read_b128 a[152:155], v218 offset:53248
v_mfma_f32_16x16x32_bf16 v[36:39], a[148:151], v[204:207], v[36:39]
s_add_u32 s48, s51, 92160
v_exp_f32 v12, v12
v_mfma_f32_16x16x32_bf16 v[36:39], a[144:147], v[200:203], v[36:39]
v_exp_f32 v13, v13
v_mfma_f32_16x16x32_bf16 a[24:27], a[176:179], v[72:75], a[24:27]
buffer_load_dwordx4 v236, s[16:19], s48 offen lds
v_mfma_f32_16x16x32_bf16 a[24:27], a[180:183], v[88:91], a[24:27]
v_exp_f32 v14, v14
v_mfma_f32_16x16x32_bf16 a[56:59], a[180:183], v[92:95], a[56:59]
s_add_u32 m0, s3, 122880
ds_read_b128 a[148:151], v217 offset:53248
ds_read_b128 a[144:147], v216 offset:53248
v_mfma_f32_16x16x32_bf16 a[56:59], a[176:179], v[76:79], a[56:59]
s_add_u32 s48, s51, 110592
v_exp_f32 v15, v15
v_mfma_f32_16x16x32_bf16 a[88:91], a[176:179], v[80:83], a[88:91]
buffer_load_dwordx4 v236, s[16:19], s48 offen lds
v_mfma_f32_16x16x32_bf16 a[88:91], a[180:183], v[96:99], a[88:91]
v_exp_f32 v20, v20
v_mfma_f32_16x16x32_bf16 a[120:123], a[180:183], v[100:103], a[120:123]
s_add_u32 m0, s3, 126976
ds_read_b64_tr_b16 a[180:181], v222 offset:8192
ds_read_b64_tr_b16 a[182:183], v222 offset:12288
v_mfma_f32_16x16x32_bf16 a[120:123], a[176:179], v[84:87], a[120:123]
s_add_u32 s48, s51, 129024
v_exp_f32 v21, v21
v_mfma_f32_16x16x32_bf16 a[124:127], a[184:187], v[84:87], a[124:127]
buffer_load_dwordx4 v236, s[16:19], s48 offen lds
v_mfma_f32_16x16x32_bf16 a[124:127], a[188:191], v[100:103], a[124:127]
v_exp_f32 v22, v22
v_mfma_f32_16x16x32_bf16 a[92:95], a[188:191], v[96:99], a[92:95]
ds_read_b64_tr_b16 a[176:177], v222 offset:0
ds_read_b64_tr_b16 a[178:179], v222 offset:4096
v_mfma_f32_16x16x32_bf16 a[92:95], a[184:187], v[80:83], a[92:95]
s_add_u32 m0, s3, 0
v_exp_f32 v23, v23
v_mfma_f32_16x16x32_bf16 a[60:63], a[184:187], v[76:79], a[60:63]
s_add_u32 s48, s75, 0
buffer_load_dwordx4 v237, s[16:19], s48 offen lds
v_mfma_f32_16x16x32_bf16 a[60:63], a[188:191], v[92:95], a[60:63]
v_exp_f32 v28, v28
v_mfma_f32_16x16x32_bf16 a[28:31], a[188:191], v[88:91], a[28:31]
ds_read_b64_tr_b16 a[188:189], v223 offset:8192
ds_read_b64_tr_b16 a[190:191], v223 offset:12288
v_mfma_f32_16x16x32_bf16 a[28:31], a[184:187], v[72:75], a[28:31]
s_waitcnt lgkmcnt(6)
v_exp_f32 v29, v29
v_smfmac_f32_16x16x64_bf16 a[252:255], a[208:211], v[48:55], v235
s_add_u32 m0, s3, 4096
ds_read_b64_tr_b16 a[184:185], v223 offset:0
ds_read_b64_tr_b16 a[186:187], v223 offset:4096
v_mfma_f32_16x16x32_bf16 v[8:11], a[128:131], v[152:155], v[136:139]
s_add_u32 s48, s75, 36864
v_exp_f32 v30, v30
v_mfma_f32_16x16x32_bf16 v[8:11], a[132:135], v[156:159], v[8:11]
buffer_load_dwordx4 v237, s[16:19], s48 offen lds
v_mfma_f32_16x16x32_bf16 v[8:11], a[136:139], v[160:163], v[8:11]
v_exp_f32 v31, v31
v_mfma_f32_16x16x32_bf16 v[8:11], a[140:143], v[164:167], v[8:11]
s_add_u32 m0, s3, 8192
v_cvt_pk_bf16_f32 v61, v18, v19
v_cvt_pk_bf16_f32 v64, v24, v25
v_mfma_f32_16x16x32_bf16 v[16:19], a[140:143], v[180:183], v[140:143]
s_add_u32 s48, s75, 73728
v_exp_f32 v36, v36
v_mfma_f32_16x16x32_bf16 v[16:19], a[136:139], v[176:179], v[16:19]
buffer_load_dwordx4 v237, s[16:19], s48 offen lds
v_mfma_f32_16x16x32_bf16 v[16:19], a[132:135], v[172:175], v[16:19]
v_exp_f32 v37, v37
v_mfma_f32_16x16x32_bf16 v[16:19], a[128:131], v[168:171], v[16:19]
v_cvt_pk_bf16_f32 v65, v26, v27
v_cvt_pk_bf16_f32 v68, v32, v33
v_mfma_f32_16x16x32_bf16 v[24:27], a[128:131], v[184:187], v[144:147]
s_add_u32 m0, s3, 12288
v_exp_f32 v38, v38
v_mfma_f32_16x16x32_bf16 v[24:27], a[132:135], v[188:191], v[24:27]
s_add_u32 s48, s75, 110592
buffer_load_dwordx4 v237, s[16:19], s48 offen lds
v_mfma_f32_16x16x32_bf16 v[24:27], a[136:139], v[192:195], v[24:27]
v_exp_f32 v39, v39
v_mfma_f32_16x16x32_bf16 v[24:27], a[140:143], v[196:199], v[24:27]
v_cvt_pk_bf16_f32 v69, v34, v35
v_cvt_pk_bf16_f32 v58, v12, v13
v_mfma_f32_16x16x32_bf16 v[32:35], a[140:143], v[212:215], v[148:151]
v_cvt_pk_bf16_f32 v59, v14, v15
v_cvt_pk_bf16_f32 v62, v20, v21
v_mfma_f32_16x16x32_bf16 v[32:35], a[136:139], v[208:211], v[32:35]
v_cvt_pk_bf16_f32 v63, v22, v23
v_cvt_pk_bf16_f32 v66, v28, v29
v_mfma_f32_16x16x32_bf16 v[32:35], a[132:135], v[204:207], v[32:35]
v_cvt_pk_bf16_f32 v67, v30, v31
v_cvt_pk_bf16_f32 v70, v36, v37
v_mfma_f32_16x16x32_bf16 v[32:35], a[128:131], v[200:203], v[32:35]
v_cvt_pk_bf16_f32 v71, v38, v39
v_mfma_f32_16x16x32_bf16 a[0:3], a[160:163], v[40:43], a[0:3]
v_exp_f32 v8, v8
v_mfma_f32_16x16x32_bf16 a[0:3], a[164:167], v[56:59], a[0:3]
s_add_u32 m0, s3, 16384
v_exp_f32 v9, v9
v_mfma_f32_16x16x32_bf16 a[32:35], a[164:167], v[60:63], a[32:35]
s_add_u32 s48, s75, 147456
buffer_load_dwordx4 v237, s[16:19], s48 offen lds
v_mfma_f32_16x16x32_bf16 a[32:35], a[160:163], v[44:47], a[32:35]
v_exp_f32 v10, v10
v_mfma_f32_16x16x32_bf16 a[64:67], a[160:163], v[48:51], a[64:67]
v_cvt_pk_bf16_f32 v72, v8, v9
v_mfma_f32_16x16x32_bf16 a[64:67], a[164:167], v[64:67], a[64:67]
s_add_u32 m0, s3, 20480
v_exp_f32 v11, v11
v_mfma_f32_16x16x32_bf16 a[96:99], a[164:167], v[68:71], a[96:99]
s_add_u32 s48, s75, 184320
buffer_load_dwordx4 v237, s[16:19], s48 offen lds
v_mfma_f32_16x16x32_bf16 a[96:99], a[160:163], v[52:55], a[96:99]
v_exp_f32 v16, v16
v_mfma_f32_16x16x32_bf16 a[100:103], a[168:171], v[52:55], a[100:103]
ds_read_b64_tr_b16 a[164:165], v224 offset:8192
ds_read_b64_tr_b16 a[166:167], v224 offset:12288
v_mfma_f32_16x16x32_bf16 a[100:103], a[172:175], v[68:71], a[100:103]
v_exp_f32 v17, v17
v_mfma_f32_16x16x32_bf16 a[68:71], a[172:175], v[64:67], a[68:71]
s_add_u32 m0, s3, 24576
ds_read_b64_tr_b16 a[160:161], v224 offset:0
ds_read_b64_tr_b16 a[162:163], v224 offset:4096
v_mfma_f32_16x16x32_bf16 a[68:71], a[168:171], v[48:51], a[68:71]
s_add_u32 s48, s75, 221184
v_exp_f32 v18, v18
v_mfma_f32_16x16x32_bf16 a[36:39], a[168:171], v[44:47], a[36:39]
buffer_load_dwordx4 v237, s[16:19], s48 offen lds
v_mfma_f32_16x16x32_bf16 a[36:39], a[172:175], v[60:63], a[36:39]
v_exp_f32 v19, v19
v_mfma_f32_16x16x32_bf16 a[4:7], a[172:175], v[56:59], a[4:7]
ds_read_b64_tr_b16 a[172:173], v225 offset:8192
ds_read_b64_tr_b16 a[174:175], v225 offset:12288
v_mfma_f32_16x16x32_bf16 a[4:7], a[168:171], v[40:43], a[4:7]
s_add_u32 m0, s3, 28672
v_exp_f32 v24, v24
v_smfmac_f32_16x16x64_bf16 a[248:251], a[208:211], v[56:63], v235
s_add_u32 s48, s75, 258048
buffer_load_dwordx4 v237, s[16:19], s48 offen lds
v_mfma_f32_16x16x32_bf16 v[12:15], a[144:147], v[152:155], v[136:139]
v_exp_f32 v25, v25
v_mfma_f32_16x16x32_bf16 v[12:15], a[148:151], v[156:159], v[12:15]
ds_read_b64_tr_b16 a[168:169], v225 offset:0
ds_read_b64_tr_b16 a[170:171], v225 offset:4096
v_mfma_f32_16x16x32_bf16 v[12:15], a[152:155], v[160:163], v[12:15]
v_exp_f32 v26, v26
v_mfma_f32_16x16x32_bf16 v[12:15], a[156:159], v[164:167], v[12:15]
s_add_u32 m0, s3, 131072
ds_read_b128 a[128:131], v216 offset:57344
ds_read_b128 a[132:135], v217 offset:57344
v_mfma_f32_16x16x32_bf16 v[20:23], a[156:159], v[180:183], v[140:143]
s_add_u32 s48, s51, 147456
v_exp_f32 v27, v27
v_mfma_f32_16x16x32_bf16 v[20:23], a[152:155], v[176:179], v[20:23]
buffer_load_dwordx4 v236, s[16:19], s48 offen lds
v_mfma_f32_16x16x32_bf16 v[20:23], a[148:151], v[172:175], v[20:23]
v_exp_f32 v32, v32
v_mfma_f32_16x16x32_bf16 v[20:23], a[144:147], v[168:171], v[20:23]
s_add_u32 m0, s3, 135168
ds_read_b128 a[136:139], v218 offset:57344
ds_read_b128 a[140:143], v219 offset:57344
v_mfma_f32_16x16x32_bf16 v[28:31], a[144:147], v[184:187], v[144:147]
s_add_u32 s48, s51, 165888
v_exp_f32 v33, v33
v_mfma_f32_16x16x32_bf16 v[28:31], a[148:151], v[188:191], v[28:31]
buffer_load_dwordx4 v236, s[16:19], s48 offen lds
v_mfma_f32_16x16x32_bf16 v[28:31], a[152:155], v[192:195], v[28:31]
v_exp_f32 v34, v34
v_mfma_f32_16x16x32_bf16 v[28:31], a[156:159], v[196:199], v[28:31]
v_cvt_pk_bf16_f32 v73, v10, v11
v_cvt_pk_bf16_f32 v76, v16, v17
v_mfma_f32_16x16x32_bf16 v[36:39], a[156:159], v[212:215], v[148:151]
s_add_u32 m0, s3, 139264
v_exp_f32 v35, v35
v_mfma_f32_16x16x32_bf16 v[36:39], a[152:155], v[208:211], v[36:39]
s_add_u32 s48, s51, 184320
buffer_load_dwordx4 v236, s[16:19], s48 offen lds
v_mfma_f32_16x16x32_bf16 v[36:39], a[148:151], v[204:207], v[36:39]
v_exp_f32 v12, v12
v_mfma_f32_16x16x32_bf16 v[36:39], a[144:147], v[200:203], v[36:39]
s_waitcnt lgkmcnt(2)
v_exp_f32 v13, v13
v_mfma_f32_16x16x32_bf16 a[8:11], a[176:179], v[40:43], a[8:11]
ds_read_b128 a[156:159], v219 offset:61440
ds_read_b128 a[152:155], v218 offset:61440
v_mfma_f32_16x16x32_bf16 a[8:11], a[180:183], v[56:59], a[8:11]
s_add_u32 m0, s3, 143360
v_exp_f32 v14, v14
v_mfma_f32_16x16x32_bf16 a[40:43], a[180:183], v[60:63], a[40:43]
s_add_u32 s48, s51, 202752
buffer_load_dwordx4 v236, s[16:19], s48 offen lds
v_mfma_f32_16x16x32_bf16 a[40:43], a[176:179], v[44:47], a[40:43]
v_exp_f32 v15, v15
v_mfma_f32_16x16x32_bf16 a[72:75], a[176:179], v[48:51], a[72:75]
ds_read_b128 a[148:151], v217 offset:61440
ds_read_b128 a[144:147], v216 offset:61440
v_mfma_f32_16x16x32_bf16 a[72:75], a[180:183], v[64:67], a[72:75]
v_exp_f32 v20, v20
v_mfma_f32_16x16x32_bf16 a[104:107], a[180:183], v[68:71], a[104:107]
s_add_u32 m0, s3, 147456
ds_read_b64_tr_b16 a[180:181], v226 offset:8192
ds_read_b64_tr_b16 a[182:183], v226 offset:12288
v_mfma_f32_16x16x32_bf16 a[104:107], a[176:179], v[52:55], a[104:107]
s_add_u32 s48, s51, 221184
v_exp_f32 v21, v21
v_mfma_f32_16x16x32_bf16 a[108:111], a[184:187], v[52:55], a[108:111]
buffer_load_dwordx4 v236, s[16:19], s48 offen lds
v_mfma_f32_16x16x32_bf16 a[108:111], a[188:191], v[68:71], a[108:111]
v_exp_f32 v22, v22
v_mfma_f32_16x16x32_bf16 a[76:79], a[188:191], v[64:67], a[76:79]
s_add_u32 m0, s3, 151552
ds_read_b64_tr_b16 a[176:177], v226 offset:0
ds_read_b64_tr_b16 a[178:179], v226 offset:4096
v_mfma_f32_16x16x32_bf16 a[76:79], a[184:187], v[48:51], a[76:79]
s_add_u32 s48, s51, 239616
v_exp_f32 v23, v23
v_mfma_f32_16x16x32_bf16 a[44:47], a[184:187], v[44:47], a[44:47]
buffer_load_dwordx4 v236, s[16:19], s48 offen lds
v_mfma_f32_16x16x32_bf16 a[44:47], a[188:191], v[60:63], a[44:47]
v_exp_f32 v28, v28
v_mfma_f32_16x16x32_bf16 a[12:15], a[188:191], v[56:59], a[12:15]
ds_read_b64_tr_b16 a[188:189], v227 offset:8192
ds_read_b64_tr_b16 a[190:191], v227 offset:12288
v_mfma_f32_16x16x32_bf16 a[12:15], a[184:187], v[40:43], a[12:15]
s_add_u32 m0, s3, 155648
v_exp_f32 v29, v29
v_smfmac_f32_16x16x64_bf16 a[252:255], a[208:211], v[64:71], v235
s_add_u32 s48, s51, 258048
buffer_load_dwordx4 v236, s[16:19], s48 offen lds
v_mfma_f32_16x16x32_bf16 v[8:11], a[128:131], v[152:155], v[136:139]
v_exp_f32 v30, v30
v_mfma_f32_16x16x32_bf16 v[8:11], a[132:135], v[156:159], v[8:11]
s_waitcnt lgkmcnt(4)
ds_read_b64_tr_b16 a[184:185], v227 offset:0
ds_read_b64_tr_b16 a[186:187], v227 offset:4096
v_mfma_f32_16x16x32_bf16 v[8:11], a[136:139], v[160:163], v[8:11]
v_exp_f32 v31, v31
v_mfma_f32_16x16x32_bf16 v[8:11], a[140:143], v[164:167], v[8:11]
s_add_u32 m0, s3, 159744
v_cvt_pk_bf16_f32 v77, v18, v19
v_cvt_pk_bf16_f32 v80, v24, v25
v_mfma_f32_16x16x32_bf16 v[16:19], a[140:143], v[180:183], v[140:143]
s_add_u32 s48, s51, 276480
v_exp_f32 v36, v36
v_mfma_f32_16x16x32_bf16 v[16:19], a[136:139], v[176:179], v[16:19]
buffer_load_dwordx4 v236, s[16:19], s48 offen lds
v_mfma_f32_16x16x32_bf16 v[16:19], a[132:135], v[172:175], v[16:19]
v_exp_f32 v37, v37
v_mfma_f32_16x16x32_bf16 v[16:19], a[128:131], v[168:171], v[16:19]
v_cvt_pk_bf16_f32 v81, v26, v27
v_cvt_pk_bf16_f32 v84, v32, v33
v_mfma_f32_16x16x32_bf16 v[24:27], a[128:131], v[184:187], v[144:147]
s_add_u32 m0, s3, 32768
v_exp_f32 v38, v38
v_mfma_f32_16x16x32_bf16 v[24:27], a[132:135], v[188:191], v[24:27]
s_add_u32 s48, s42, 0
buffer_load_dwordx4 v236, s[16:19], s48 offen lds
v_mfma_f32_16x16x32_bf16 v[24:27], a[136:139], v[192:195], v[24:27]
v_exp_f32 v39, v39
v_mfma_f32_16x16x32_bf16 v[24:27], a[140:143], v[196:199], v[24:27]
v_cvt_pk_bf16_f32 v85, v34, v35
v_cvt_pk_bf16_f32 v74, v12, v13
v_mfma_f32_16x16x32_bf16 v[32:35], a[140:143], v[212:215], v[148:151]
v_cvt_pk_bf16_f32 v75, v14, v15
v_cvt_pk_bf16_f32 v78, v20, v21
v_mfma_f32_16x16x32_bf16 v[32:35], a[136:139], v[208:211], v[32:35]
v_cvt_pk_bf16_f32 v79, v22, v23
v_cvt_pk_bf16_f32 v82, v28, v29
v_mfma_f32_16x16x32_bf16 v[32:35], a[132:135], v[204:207], v[32:35]
v_cvt_pk_bf16_f32 v83, v30, v31
v_cvt_pk_bf16_f32 v86, v36, v37
v_mfma_f32_16x16x32_bf16 v[32:35], a[128:131], v[200:203], v[32:35]
v_cvt_pk_bf16_f32 v87, v38, v39
v_mfma_f32_16x16x32_bf16 a[16:19], a[160:163], v[40:43], a[16:19]
v_exp_f32 v8, v8
v_mfma_f32_16x16x32_bf16 a[16:19], a[164:167], v[56:59], a[16:19]
v_exp_f32 v9, v9
v_mfma_f32_16x16x32_bf16 a[48:51], a[164:167], v[60:63], a[48:51]
v_cvt_pk_bf16_f32 v88, v8, v9
v_exp_f32 v10, v10
v_mfma_f32_16x16x32_bf16 a[48:51], a[160:163], v[44:47], a[48:51]
v_mfma_f32_16x16x32_bf16 a[80:83], a[160:163], v[48:51], a[80:83]
v_exp_f32 v11, v11
v_mfma_f32_16x16x32_bf16 a[80:83], a[164:167], v[64:67], a[80:83]
v_cvt_pk_bf16_f32 v89, v10, v11
v_exp_f32 v16, v16
s_waitcnt lgkmcnt(0)
s_barrier
v_mfma_f32_16x16x32_bf16 a[112:115], a[164:167], v[68:71], a[112:115]
ds_read_b64_tr_b16 a[128:129], v224 offset:16384
ds_read_b64_tr_b16 a[130:131], v224 offset:20480
ds_read_b64_tr_b16 a[132:133], v224 offset:24576
v_mfma_f32_16x16x32_bf16 a[112:115], a[160:163], v[52:55], a[112:115]
s_add_u32 m0, s3, 36864
ds_read_b64_tr_b16 a[134:135], v224 offset:28672
v_exp_f32 v17, v17
v_mfma_f32_16x16x32_bf16 a[116:119], a[168:171], v[52:55], a[116:119]
s_add_u32 s48, s42, 18432
ds_read_b64_tr_b16 a[136:137], v225 offset:16384
v_exp_f32 v18, v18
v_mfma_f32_16x16x32_bf16 a[116:119], a[172:175], v[68:71], a[116:119]
buffer_load_dwordx4 v236, s[16:19], s48 offen lds
ds_read_b64_tr_b16 a[138:139], v225 offset:20480
v_mfma_f32_16x16x32_bf16 a[84:87], a[172:175], v[64:67], a[84:87]
ds_read_b64_tr_b16 a[164:165], v220 offset:24576
v_exp_f32 v19, v19
v_mfma_f32_16x16x32_bf16 a[84:87], a[168:171], v[48:51], a[84:87]
s_add_u32 m0, s3, 40960
ds_read_b64_tr_b16 a[166:167], v220 offset:28672
v_exp_f32 v24, v24
v_mfma_f32_16x16x32_bf16 a[52:55], a[168:171], v[44:47], a[52:55]
s_add_u32 s48, s42, 36864
ds_read_b64_tr_b16 a[140:141], v225 offset:24576
v_exp_f32 v25, v25
v_mfma_f32_16x16x32_bf16 a[52:55], a[172:175], v[60:63], a[52:55]
buffer_load_dwordx4 v236, s[16:19], s48 offen lds
ds_read_b64_tr_b16 a[142:143], v225 offset:28672
v_mfma_f32_16x16x32_bf16 a[20:23], a[172:175], v[56:59], a[20:23]
ds_read_b64_tr_b16 a[160:161], v220 offset:16384
v_exp_f32 v26, v26
v_mfma_f32_16x16x32_bf16 a[20:23], a[168:171], v[40:43], a[20:23]
s_add_u32 m0, s3, 45056
ds_read_b64_tr_b16 a[162:163], v220 offset:20480
v_exp_f32 v27, v27
v_smfmac_f32_16x16x64_bf16 a[248:251], a[208:211], v[72:79], v235
s_add_u32 s48, s42, 55296
buffer_load_dwordx4 v236, s[16:19], s48 offen lds
ds_read_b64_tr_b16 a[172:173], v221 offset:24576
v_mfma_f32_16x16x32_bf16 v[12:15], a[144:147], v[152:155], v[136:139]
ds_read_b64_tr_b16 a[174:175], v221 offset:28672
v_exp_f32 v32, v32
v_mfma_f32_16x16x32_bf16 v[12:15], a[148:151], v[156:159], v[12:15]
ds_read_b64_tr_b16 a[168:169], v221 offset:16384
v_exp_f32 v33, v33
v_mfma_f32_16x16x32_bf16 v[12:15], a[152:155], v[160:163], v[12:15]
s_add_u32 m0, s3, 49152
ds_read_b64_tr_b16 a[170:171], v221 offset:20480
v_cvt_pk_bf16_f32 v92, v16, v17
v_cvt_pk_bf16_f32 v93, v18, v19
v_mfma_f32_16x16x32_bf16 v[12:15], a[156:159], v[164:167], v[12:15]
s_add_u32 s48, s42, 73728
v_cvt_pk_bf16_f32 v96, v24, v25
v_exp_f32 v34, v34
v_mfma_f32_16x16x32_bf16 v[20:23], a[156:159], v[180:183], v[140:143]
v_cvt_pk_bf16_f32 v97, v26, v27
v_exp_f32 v35, v35
v_mfma_f32_16x16x32_bf16 v[20:23], a[152:155], v[176:179], v[20:23]
buffer_load_dwordx4 v236, s[16:19], s48 offen lds
v_cvt_pk_bf16_f32 v100, v32, v33
v_mfma_f32_16x16x32_bf16 v[20:23], a[148:151], v[172:175], v[20:23]
s_add_u32 m0, s3, 53248
v_cvt_pk_bf16_f32 v101, v34, v35
v_mfma_f32_16x16x32_bf16 v[20:23], a[144:147], v[168:171], v[20:23]
s_add_u32 s48, s42, 92160
v_exp_f32 v12, v12
v_mfma_f32_16x16x32_bf16 v[28:31], a[144:147], v[184:187], v[144:147]
v_exp_f32 v13, v13
v_mfma_f32_16x16x32_bf16 v[28:31], a[148:151], v[188:191], v[28:31]
v_cvt_pk_bf16_f32 v90, v12, v13
v_exp_f32 v14, v14
v_mfma_f32_16x16x32_bf16 v[28:31], a[152:155], v[192:195], v[28:31]
v_exp_f32 v15, v15
v_mfma_f32_16x16x32_bf16 v[28:31], a[156:159], v[196:199], v[28:31]
v_cvt_pk_bf16_f32 v91, v14, v15
v_exp_f32 v20, v20
v_mfma_f32_16x16x32_bf16 v[36:39], a[156:159], v[212:215], v[148:151]
buffer_load_dwordx4 v236, s[16:19], s48 offen lds
ds_read_b64_tr_b16 a[156:157], v227 offset:24576
v_mfma_f32_16x16x32_bf16 v[36:39], a[152:155], v[208:211], v[36:39]
s_add_u32 m0, s3, 57344
ds_read_b64_tr_b16 a[158:159], v227 offset:28672
v_exp_f32 v21, v21
v_mfma_f32_16x16x32_bf16 v[36:39], a[148:151], v[204:207], v[36:39]
s_add_u32 s48, s42, 110592
ds_read_b64_tr_b16 a[152:153], v227 offset:16384
v_exp_f32 v22, v22
v_mfma_f32_16x16x32_bf16 v[36:39], a[144:147], v[200:203], v[36:39]
buffer_load_dwordx4 v236, s[16:19], s48 offen lds
ds_read_b64_tr_b16 a[154:155], v227 offset:20480
v_mfma_f32_16x16x32_bf16 a[24:27], a[176:179], v[40:43], a[24:27]
s_add_u32 m0, s3, 61440
ds_read_b64_tr_b16 a[148:149], v226 offset:24576
v_exp_f32 v23, v23
v_mfma_f32_16x16x32_bf16 a[24:27], a[180:183], v[56:59], a[24:27]
s_add_u32 s48, s42, 129024
ds_read_b64_tr_b16 a[150:151], v226 offset:28672
v_exp_f32 v28, v28
v_mfma_f32_16x16x32_bf16 a[56:59], a[180:183], v[60:63], a[56:59]
ds_read_b64_tr_b16 a[144:145], v226 offset:16384
v_exp_f32 v29, v29
v_mfma_f32_16x16x32_bf16 a[56:59], a[176:179], v[44:47], a[56:59]
buffer_load_dwordx4 v236, s[16:19], s48 offen lds
ds_read_b64_tr_b16 a[146:147], v226 offset:20480
v_mfma_f32_16x16x32_bf16 a[88:91], a[176:179], v[48:51], a[88:91]
s_add_u32 m0, s3, 65536
v_cvt_pk_bf16_f32 v94, v20, v21
v_exp_f32 v30, v30
v_mfma_f32_16x16x32_bf16 a[88:91], a[180:183], v[64:67], a[88:91]
s_add_u32 s48, s43, 0
v_cvt_pk_bf16_f32 v95, v22, v23
v_exp_f32 v31, v31
v_mfma_f32_16x16x32_bf16 a[120:123], a[180:183], v[68:71], a[120:123]
buffer_load_dwordx4 v236, s[16:19], s48 offen lds
ds_read_b64_tr_b16 a[180:181], v222 offset:24576
v_mfma_f32_16x16x32_bf16 a[120:123], a[176:179], v[52:55], a[120:123]
s_add_u32 m0, s3, 69632
ds_read_b64_tr_b16 a[182:183], v222 offset:28672
v_exp_f32 v36, v36
v_mfma_f32_16x16x32_bf16 a[124:127], a[184:187], v[52:55], a[124:127]
s_add_u32 s48, s43, 18432
ds_read_b64_tr_b16 a[176:177], v222 offset:16384
v_exp_f32 v37, v37
v_mfma_f32_16x16x32_bf16 a[124:127], a[188:191], v[68:71], a[124:127]
buffer_load_dwordx4 v236, s[16:19], s48 offen lds
ds_read_b64_tr_b16 a[178:179], v222 offset:20480
v_mfma_f32_16x16x32_bf16 a[92:95], a[188:191], v[64:67], a[92:95]
s_add_u32 m0, s3, 73728
v_cvt_pk_bf16_f32 v98, v28, v29
v_exp_f32 v38, v38
v_mfma_f32_16x16x32_bf16 a[92:95], a[184:187], v[48:51], a[92:95]
s_add_u32 s48, s43, 36864
v_cvt_pk_bf16_f32 v99, v30, v31
v_exp_f32 v39, v39
v_mfma_f32_16x16x32_bf16 a[60:63], a[184:187], v[44:47], a[60:63]
buffer_load_dwordx4 v236, s[16:19], s48 offen lds
v_cvt_pk_bf16_f32 v102, v36, v37
v_mfma_f32_16x16x32_bf16 a[60:63], a[188:191], v[60:63], a[60:63]
v_cvt_pk_bf16_f32 v103, v38, v39
v_mfma_f32_16x16x32_bf16 a[28:31], a[188:191], v[56:59], a[28:31]
ds_read_b64_tr_b16 a[188:189], v223 offset:24576
ds_read_b64_tr_b16 a[190:191], v223 offset:28672
v_mfma_f32_16x16x32_bf16 a[28:31], a[184:187], v[40:43], a[28:31]
ds_read_b64_tr_b16 a[184:185], v223 offset:16384
ds_read_b64_tr_b16 a[186:187], v223 offset:20480
v_smfmac_f32_16x16x64_bf16 a[252:255], a[208:211], v[80:87], v235
v_smfmac_f32_16x16x64_bf16 a[248:251], a[208:211], v[88:95], v235
s_lshl_b32 s46, s32, 2
v_and_b32 v138, 3, v1
v_smfmac_f32_16x16x64_bf16 a[252:255], a[208:211], v[96:103], v235
s_add_u32 s46, s46, 77824
v_lshlrev_b32 v138, 10, v138
s_waitcnt lgkmcnt(5)
v_mfma_f32_16x16x32_bf16 a[0:3], a[160:163], v[72:75], a[0:3]
s_add_u32 s47, s3, 77824
v_add_u32 v138, s46, v138
v_mfma_f32_16x16x32_bf16 a[0:3], a[164:167], v[88:91], a[0:3]
v_mov_b32 v139, s47
v_mfma_f32_16x16x32_bf16 a[4:7], a[172:175], v[88:91], a[4:7]
s_nop 0
s_nop 0
v_mfma_f32_16x16x32_bf16 a[4:7], a[168:171], v[72:75], a[4:7]
v_accvgpr_read_b32 v104, a248
v_accvgpr_read_b32 v105, a249
s_waitcnt lgkmcnt(4)
v_mfma_f32_16x16x32_bf16 a[8:11], a[176:179], v[72:75], a[8:11]
v_accvgpr_read_b32 v106, a250
v_accvgpr_read_b32 v107, a251
v_mfma_f32_16x16x32_bf16 a[8:11], a[180:183], v[88:91], a[8:11]
v_accvgpr_read_b32 v108, a252
v_accvgpr_read_b32 v109, a253
s_waitcnt lgkmcnt(2)
v_mfma_f32_16x16x32_bf16 a[12:15], a[188:191], v[88:91], a[12:15]
v_accvgpr_read_b32 v110, a254
v_accvgpr_read_b32 v111, a255
s_waitcnt lgkmcnt(0)
v_mfma_f32_16x16x32_bf16 a[12:15], a[184:187], v[72:75], a[12:15]
v_add_f32 v104, v104, v105
v_add_f32 v106, v106, v107
v_mfma_f32_16x16x32_bf16 a[16:19], a[128:131], v[72:75], a[16:19]
v_add_f32 v108, v108, v109
v_add_f32 v110, v110, v111
v_mfma_f32_16x16x32_bf16 a[16:19], a[132:135], v[88:91], a[16:19]
v_max3_f32 v136, v104, v106, v108
v_add_f32 v137, v104, v106
v_mfma_f32_16x16x32_bf16 a[20:23], a[140:143], v[88:91], a[20:23]
v_max_f32 v136, v136, v110
v_add_f32 v137, v137, v108
v_mfma_f32_16x16x32_bf16 a[20:23], a[136:139], v[72:75], a[20:23]
v_cmp_nge_f32 vcc, 0x5f800000, v136
v_add_f32 v137, v137, v110
v_mfma_f32_16x16x32_bf16 a[24:27], a[144:147], v[72:75], a[24:27]
v_cmp_u_f32 s[94:95], v137, v137
v_mfma_f32_16x16x32_bf16 a[24:27], a[148:151], v[88:91], a[24:27]
v_mfma_f32_16x16x32_bf16 a[28:31], a[156:159], v[88:91], a[28:31]
v_mfma_f32_16x16x32_bf16 a[28:31], a[152:155], v[72:75], a[28:31]
s_or_b64 vcc, vcc, s[94:95]
s_cmp_lg_u64 vcc, 0
s_cselect_b32 s48, 1, 0
v_mov_b32 v136, s48
ds_write_b32 v138, v136
s_cmp_lg_u32 s52, 0
s_cbranch_scc1 K_YRA
K_YRAD:
v_rcp_f32 v104, v104
v_rcp_f32 v106, v106
v_rcp_f32 v108, v108
v_rcp_f32 v110, v110
v_mul_f32 v105, -s97, v104
v_mul_f32 v107, -s97, v106
v_mul_f32 v109, -s97, v108
v_mul_f32 v111, -s97, v110
s_waitcnt vmcnt(11) lgkmcnt(0)
s_barrier
ds_read_b128 v[140:143], v139
v_mfma_f32_16x16x32_bf16 a[32:35], a[160:163], v[76:79], a[32:35]
v_accvgpr_read_b32 v40, a0
v_accvgpr_read_b32 v41, a1
v_mfma_f32_16x16x32_bf16 a[32:35], a[164:167], v[92:95], a[32:35]
v_accvgpr_read_b32 v42, a2
v_accvgpr_read_b32 v43, a3
v_mfma_f32_16x16x32_bf16 a[36:39], a[172:175], v[92:95], a[36:39]
v_accvgpr_read_b32 v44, a4
v_accvgpr_read_b32 v45, a5
v_mfma_f32_16x16x32_bf16 a[36:39], a[168:171], v[76:79], a[36:39]
v_accvgpr_read_b32 v46, a6
v_accvgpr_read_b32 v47, a7
v_mfma_f32_16x16x32_bf16 a[40:43], a[176:179], v[76:79], a[40:43]
v_accvgpr_read_b32 v48, a8
v_accvgpr_read_b32 v49, a9
v_mfma_f32_16x16x32_bf16 a[40:43], a[180:183], v[92:95], a[40:43]
v_accvgpr_read_b32 v50, a10
v_accvgpr_read_b32 v51, a11
v_mfma_f32_16x16x32_bf16 a[44:47], a[188:191], v[92:95], a[44:47]
v_accvgpr_read_b32 v52, a12
v_accvgpr_read_b32 v53, a13
v_mfma_f32_16x16x32_bf16 a[44:47], a[184:187], v[76:79], a[44:47]
v_accvgpr_read_b32 v54, a14
v_accvgpr_read_b32 v55, a15
v_mfma_f32_16x16x32_bf16 a[48:51], a[128:131], v[76:79], a[48:51]
v_accvgpr_read_b32 v56, a16
v_accvgpr_read_b32 v57, a17
v_mfma_f32_16x16x32_bf16 a[48:51], a[132:135], v[92:95], a[48:51]
v_accvgpr_read_b32 v58, a18
v_accvgpr_read_b32 v59, a19
v_mfma_f32_16x16x32_bf16 a[52:55], a[140:143], v[92:95], a[52:55]
v_accvgpr_read_b32 v60, a20
v_accvgpr_read_b32 v61, a21
v_mfma_f32_16x16x32_bf16 a[52:55], a[136:139], v[76:79], a[52:55]
v_accvgpr_read_b32 v62, a22
v_accvgpr_read_b32 v63, a23
v_mfma_f32_16x16x32_bf16 a[56:59], a[144:147], v[76:79], a[56:59]
v_accvgpr_read_b32 v64, a24
v_accvgpr_read_b32 v65, a25
v_mfma_f32_16x16x32_bf16 a[56:59], a[148:151], v[92:95], a[56:59]
v_accvgpr_read_b32 v66, a26
v_accvgpr_read_b32 v67, a27
v_mfma_f32_16x16x32_bf16 a[60:63], a[156:159], v[92:95], a[60:63]
v_accvgpr_read_b32 v68, a28
v_accvgpr_read_b32 v69, a29
v_mfma_f32_16x16x32_bf16 a[60:63], a[152:155], v[76:79], a[60:63]
v_accvgpr_read_b32 v70, a30
v_accvgpr_read_b32 v71, a31
s_waitcnt lgkmcnt(0)
v_or3_b32 v140, v140, v141, v142
v_or_b32 v140, v140, v143
s_nop 0
v_readfirstlane_b32 s46, v140
s_andn2_b32 s46, s46, s41
s_cbranch_scc1 K_FB
v_pk_fma_f32 v[40:41], v[40:41], v[104:105], v[104:105] op_sel:[0,0,1] op_sel_hi:[1,0,1]
v_pk_fma_f32 v[42:43], v[42:43], v[104:105], v[104:105] op_sel:[0,0,1] op_sel_hi:[1,0,1]
v_pk_fma_f32 v[44:45], v[44:45], v[104:105], v[104:105] op_sel:[0,0,1] op_sel_hi:[1,0,1]
v_pk_fma_f32 v[46:47], v[46:47], v[104:105], v[104:105] op_sel:[0,0,1] op_sel_hi:[1,0,1]
v_cvt_pk_bf16_f32 v8, v40, v41
v_cvt_pk_bf16_f32 v9, v42, v43
v_cvt_pk_bf16_f32 v10, v44, v45
v_cvt_pk_bf16_f32 v11, v46, v47
s_add_u32 s94, s53, 0
buffer_store_dwordx4 v[8:11], v234, s[20:23], s94 offen offset:0 sc0 sc1
v_pk_fma_f32 v[48:49], v[48:49], v[104:105], v[104:105] op_sel:[0,0,1] op_sel_hi:[1,0,1]
v_pk_fma_f32 v[50:51], v[50:51], v[104:105], v[104:105] op_sel:[0,0,1] op_sel_hi:[1,0,1]
v_pk_fma_f32 v[52:53], v[52:53], v[104:105], v[104:105] op_sel:[0,0,1] op_sel_hi:[1,0,1]
v_pk_fma_f32 v[54:55], v[54:55], v[104:105], v[104:105] op_sel:[0,0,1] op_sel_hi:[1,0,1]
v_cvt_pk_bf16_f32 v16, v48, v49
v_cvt_pk_bf16_f32 v17, v50, v51
v_cvt_pk_bf16_f32 v18, v52, v53
v_cvt_pk_bf16_f32 v19, v54, v55
s_add_u32 s94, s53, 0
buffer_store_dwordx4 v[16:19], v234, s[20:23], s94 offen offset:2048 sc0 sc1
v_pk_fma_f32 v[56:57], v[56:57], v[104:105], v[104:105] op_sel:[0,0,1] op_sel_hi:[1,0,1]
v_pk_fma_f32 v[58:59], v[58:59], v[104:105], v[104:105] op_sel:[0,0,1] op_sel_hi:[1,0,1]
v_pk_fma_f32 v[60:61], v[60:61], v[104:105], v[104:105] op_sel:[0,0,1] op_sel_hi:[1,0,1]
v_pk_fma_f32 v[62:63], v[62:63], v[104:105], v[104:105] op_sel:[0,0,1] op_sel_hi:[1,0,1]
v_cvt_pk_bf16_f32 v24, v56, v57
v_cvt_pk_bf16_f32 v25, v58, v59
v_cvt_pk_bf16_f32 v26, v60, v61
v_cvt_pk_bf16_f32 v27, v62, v63
s_add_u32 s94, s53, 4096
buffer_store_dwordx4 v[24:27], v234, s[20:23], s94 offen offset:0 sc0 sc1
v_pk_fma_f32 v[64:65], v[64:65], v[104:105], v[104:105] op_sel:[0,0,1] op_sel_hi:[1,0,1]
v_pk_fma_f32 v[66:67], v[66:67], v[104:105], v[104:105] op_sel:[0,0,1] op_sel_hi:[1,0,1]
v_pk_fma_f32 v[68:69], v[68:69], v[104:105], v[104:105] op_sel:[0,0,1] op_sel_hi:[1,0,1]
v_pk_fma_f32 v[70:71], v[70:71], v[104:105], v[104:105] op_sel:[0,0,1] op_sel_hi:[1,0,1]
v_cvt_pk_bf16_f32 v32, v64, v65
v_cvt_pk_bf16_f32 v33, v66, v67
v_cvt_pk_bf16_f32 v34, v68, v69
v_cvt_pk_bf16_f32 v35, v70, v71
s_add_u32 s94, s53, 4096
buffer_store_dwordx4 v[32:35], v234, s[20:23], s94 offen offset:2048 sc0 sc1
v_mfma_f32_16x16x32_bf16 a[64:67], a[160:163], v[80:83], a[64:67]
v_accvgpr_read_b32 v168, a32
v_accvgpr_read_b32 v169, a33
v_mfma_f32_16x16x32_bf16 a[64:67], a[164:167], v[96:99], a[64:67]
v_accvgpr_read_b32 v170, a34
v_accvgpr_read_b32 v171, a35
v_mfma_f32_16x16x32_bf16 a[68:71], a[172:175], v[96:99], a[68:71]
v_accvgpr_read_b32 v172, a36
v_accvgpr_read_b32 v173, a37
v_mfma_f32_16x16x32_bf16 a[68:71], a[168:171], v[80:83], a[68:71]
v_accvgpr_read_b32 v174, a38
v_accvgpr_read_b32 v175, a39
v_mfma_f32_16x16x32_bf16 a[72:75], a[176:179], v[80:83], a[72:75]
v_accvgpr_read_b32 v176, a40
v_accvgpr_read_b32 v177, a41
v_mfma_f32_16x16x32_bf16 a[72:75], a[180:183], v[96:99], a[72:75]
v_accvgpr_read_b32 v178, a42
v_accvgpr_read_b32 v179, a43
v_mfma_f32_16x16x32_bf16 a[76:79], a[188:191], v[96:99], a[76:79]
v_accvgpr_read_b32 v180, a44
v_accvgpr_read_b32 v181, a45
v_mfma_f32_16x16x32_bf16 a[76:79], a[184:187], v[80:83], a[76:79]
v_accvgpr_read_b32 v182, a46
v_accvgpr_read_b32 v183, a47
v_mfma_f32_16x16x32_bf16 a[80:83], a[128:131], v[80:83], a[80:83]
v_accvgpr_read_b32 v184, a48
v_accvgpr_read_b32 v185, a49
v_mfma_f32_16x16x32_bf16 a[80:83], a[132:135], v[96:99], a[80:83]
v_accvgpr_read_b32 v186, a50
v_accvgpr_read_b32 v187, a51
v_mfma_f32_16x16x32_bf16 a[84:87], a[140:143], v[96:99], a[84:87]
v_accvgpr_read_b32 v188, a52
v_accvgpr_read_b32 v189, a53
v_mfma_f32_16x16x32_bf16 a[84:87], a[136:139], v[80:83], a[84:87]
v_accvgpr_read_b32 v190, a54
v_accvgpr_read_b32 v191, a55
v_mfma_f32_16x16x32_bf16 a[88:91], a[144:147], v[80:83], a[88:91]
v_accvgpr_read_b32 v192, a56
v_accvgpr_read_b32 v193, a57
v_mfma_f32_16x16x32_bf16 a[88:91], a[148:151], v[96:99], a[88:91]
v_accvgpr_read_b32 v194, a58
v_accvgpr_read_b32 v195, a59
v_mfma_f32_16x16x32_bf16 a[92:95], a[156:159], v[96:99], a[92:95]
v_accvgpr_read_b32 v196, a60
v_accvgpr_read_b32 v197, a61
v_mfma_f32_16x16x32_bf16 a[92:95], a[152:155], v[80:83], a[92:95]
v_accvgpr_read_b32 v198, a62
v_accvgpr_read_b32 v199, a63
v_pk_fma_f32 v[168:169], v[168:169], v[106:107], v[106:107] op_sel:[0,0,1] op_sel_hi:[1,0,1]
v_pk_fma_f32 v[170:171], v[170:171], v[106:107], v[106:107] op_sel:[0,0,1] op_sel_hi:[1,0,1]
v_pk_fma_f32 v[172:173], v[172:173], v[106:107], v[106:107] op_sel:[0,0,1] op_sel_hi:[1,0,1]
v_pk_fma_f32 v[174:175], v[174:175], v[106:107], v[106:107] op_sel:[0,0,1] op_sel_hi:[1,0,1]
v_cvt_pk_bf16_f32 v12, v168, v169
v_cvt_pk_bf16_f32 v13, v170, v171
v_cvt_pk_bf16_f32 v14, v172, v173
v_cvt_pk_bf16_f32 v15, v174, v175
s_add_u32 s94, s53, 0
buffer_store_dwordx4 v[12:15], v234, s[20:23], s94 offen offset:1024 sc0 sc1
v_pk_fma_f32 v[176:177], v[176:177], v[106:107], v[106:107] op_sel:[0,0,1] op_sel_hi:[1,0,1]
v_pk_fma_f32 v[178:179], v[178:179], v[106:107], v[106:107] op_sel:[0,0,1] op_sel_hi:[1,0,1]
v_pk_fma_f32 v[180:181], v[180:181], v[106:107], v[106:107] op_sel:[0,0,1] op_sel_hi:[1,0,1]
v_pk_fma_f32 v[182:183], v[182:183], v[106:107], v[106:107] op_sel:[0,0,1] op_sel_hi:[1,0,1]
v_cvt_pk_bf16_f32 v20, v176, v177
v_cvt_pk_bf16_f32 v21, v178, v179
v_cvt_pk_bf16_f32 v22, v180, v181
v_cvt_pk_bf16_f32 v23, v182, v183
s_add_u32 s94, s53, 0
buffer_store_dwordx4 v[20:23], v234, s[20:23], s94 offen offset:3072 sc0 sc1
v_pk_fma_f32 v[184:185], v[184:185], v[106:107], v[106:107] op_sel:[0,0,1] op_sel_hi:[1,0,1]
v_pk_fma_f32 v[186:187], v[186:187], v[106:107], v[106:107] op_sel:[0,0,1] op_sel_hi:[1,0,1]
v_pk_fma_f32 v[188:189], v[188:189], v[106:107], v[106:107] op_sel:[0,0,1] op_sel_hi:[1,0,1]
v_pk_fma_f32 v[190:191], v[190:191], v[106:107], v[106:107] op_sel:[0,0,1] op_sel_hi:[1,0,1]
v_cvt_pk_bf16_f32 v28, v184, v185
v_cvt_pk_bf16_f32 v29, v186, v187
v_cvt_pk_bf16_f32 v30, v188, v189
v_cvt_pk_bf16_f32 v31, v190, v191
s_add_u32 s94, s53, 4096
buffer_store_dwordx4 v[28:31], v234, s[20:23], s94 offen offset:1024 sc0 sc1
v_pk_fma_f32 v[192:193], v[192:193], v[106:107], v[106:107] op_sel:[0,0,1] op_sel_hi:[1,0,1]
v_pk_fma_f32 v[194:195], v[194:195], v[106:107], v[106:107] op_sel:[0,0,1] op_sel_hi:[1,0,1]
v_pk_fma_f32 v[196:197], v[196:197], v[106:107], v[106:107] op_sel:[0,0,1] op_sel_hi:[1,0,1]
v_pk_fma_f32 v[198:199], v[198:199], v[106:107], v[106:107] op_sel:[0,0,1] op_sel_hi:[1,0,1]
v_cvt_pk_bf16_f32 v36, v192, v193
v_cvt_pk_bf16_f32 v37, v194, v195
v_cvt_pk_bf16_f32 v38, v196, v197
v_cvt_pk_bf16_f32 v39, v198, v199
s_add_u32 s94, s53, 4096
buffer_store_dwordx4 v[36:39], v234, s[20:23], s94 offen offset:3072 sc0 sc1
v_mfma_f32_16x16x32_bf16 a[96:99], a[160:163], v[84:87], a[96:99]
v_accvgpr_read_b32 v168, a64
v_accvgpr_read_b32 v169, a65
v_mfma_f32_16x16x32_bf16 a[96:99], a[164:167], v[100:103], a[96:99]
v_accvgpr_read_b32 v170, a66
v_accvgpr_read_b32 v171, a67
v_mfma_f32_16x16x32_bf16 a[100:103], a[172:175], v[100:103], a[100:103]
v_accvgpr_read_b32 v172, a68
v_accvgpr_read_b32 v173, a69
v_mfma_f32_16x16x32_bf16 a[100:103], a[168:171], v[84:87], a[100:103]
v_accvgpr_read_b32 v174, a70
v_accvgpr_read_b32 v175, a71
v_mfma_f32_16x16x32_bf16 a[104:107], a[176:179], v[84:87], a[104:107]
v_accvgpr_read_b32 v176, a72
v_accvgpr_read_b32 v177, a73
v_mfma_f32_16x16x32_bf16 a[104:107], a[180:183], v[100:103], a[104:107]
v_accvgpr_read_b32 v178, a74
v_accvgpr_read_b32 v179, a75
v_mfma_f32_16x16x32_bf16 a[108:111], a[188:191], v[100:103], a[108:111]
v_accvgpr_read_b32 v180, a76
v_accvgpr_read_b32 v181, a77
v_mfma_f32_16x16x32_bf16 a[108:111], a[184:187], v[84:87], a[108:111]
v_accvgpr_read_b32 v182, a78
v_accvgpr_read_b32 v183, a79
v_mfma_f32_16x16x32_bf16 a[112:115], a[128:131], v[84:87], a[112:115]
v_accvgpr_read_b32 v184, a80
v_accvgpr_read_b32 v185, a81
v_mfma_f32_16x16x32_bf16 a[112:115], a[132:135], v[100:103], a[112:115]
v_accvgpr_read_b32 v186, a82
v_accvgpr_read_b32 v187, a83
v_mfma_f32_16x16x32_bf16 a[116:119], a[140:143], v[100:103], a[116:119]
v_accvgpr_read_b32 v188, a84
v_accvgpr_read_b32 v189, a85
v_mfma_f32_16x16x32_bf16 a[116:119], a[136:139], v[84:87], a[116:119]
v_accvgpr_read_b32 v190, a86
v_accvgpr_read_b32 v191, a87
v_mfma_f32_16x16x32_bf16 a[120:123], a[144:147], v[84:87], a[120:123]
v_accvgpr_read_b32 v192, a88
v_accvgpr_read_b32 v193, a89
v_mfma_f32_16x16x32_bf16 a[120:123], a[148:151], v[100:103], a[120:123]
v_accvgpr_read_b32 v194, a90
v_accvgpr_read_b32 v195, a91
v_mfma_f32_16x16x32_bf16 a[124:127], a[156:159], v[100:103], a[124:127]
v_accvgpr_read_b32 v196, a92
v_accvgpr_read_b32 v197, a93
v_mfma_f32_16x16x32_bf16 a[124:127], a[152:155], v[84:87], a[124:127]
v_accvgpr_read_b32 v198, a94
v_accvgpr_read_b32 v199, a95
s_cmp_lg_u32 s83, 0
s_cbranch_scc1 K_YR1
K_YR1D:
v_accvgpr_read_b32 v120, a236
v_accvgpr_read_b32 v121, a237
v_accvgpr_read_b32 v122, a238
v_accvgpr_read_b32 v123, a239
v_accvgpr_read_b32 v124, a240
v_accvgpr_read_b32 v125, a241
v_accvgpr_read_b32 v126, a242
v_accvgpr_read_b32 v127, a243
v_accvgpr_read_b32 v128, a244
v_accvgpr_read_b32 v129, a245
v_accvgpr_read_b32 v130, a246
v_accvgpr_read_b32 v131, a247
v_xor_b32 v220, s82, v220
v_xor_b32 v221, s82, v221
v_xor_b32 v222, s82, v222
v_xor_b32 v223, s82, v223
v_xor_b32 v224, s82, v224
v_xor_b32 v225, s82, v225
v_xor_b32 v226, s82, v226
v_xor_b32 v227, s82, v227
v_bfe_u32 v5, v1, 2, 2
v_lshl_add_u32 v5, v4, 2, v5
v_bfe_u32 v6, v5, 1, 2
v_lshlrev_b32 v6, 5, v6
v_lshl_add_u32 v6, v5, 7, v6
v_and_b32 v5, 3, v1
v_lshl_add_u32 v216, v5, 3, v6
v_xor_b32 v217, 32, v216
v_xor_b32 v218, 64, v216
v_xor_b32 v219, 96, v216
ds_read_b64_tr_b16 a[192:193], v220 offset:32768
ds_read_b64_tr_b16 a[194:195], v220 offset:36864
ds_read_b64_tr_b16 a[196:197], v221 offset:32768
ds_read_b64_tr_b16 a[198:199], v221 offset:36864
ds_read_b64_tr_b16 a[200:201], v222 offset:32768
ds_read_b64_tr_b16 a[202:203], v222 offset:36864
ds_read_b64_tr_b16 a[204:205], v223 offset:32768
ds_read_b64_tr_b16 a[206:207], v223 offset:36864
ds_read_b64_tr_b16 a[208:209], v224 offset:32768
ds_read_b64_tr_b16 a[210:211], v224 offset:36864
ds_read_b64_tr_b16 a[212:213], v225 offset:32768
ds_read_b64_tr_b16 a[214:215], v225 offset:36864
ds_read_b64_tr_b16 a[216:217], v226 offset:32768
ds_read_b64_tr_b16 a[218:219], v226 offset:36864
ds_read_b64_tr_b16 a[220:221], v227 offset:32768
ds_read_b64_tr_b16 a[222:223], v227 offset:36864
ds_read_b64_tr_b16 a[224:225], v216 offset:0
ds_read_b64_tr_b16 a[226:227], v216 offset:2048
ds_read_b64_tr_b16 a[228:229], v217 offset:0
ds_read_b64_tr_b16 a[230:231], v217 offset:2048
ds_read_b64_tr_b16 a[232:233], v218 offset:0
ds_read_b64_tr_b16 a[234:235], v218 offset:2048
ds_read_b64_tr_b16 a[236:237], v219 offset:0
ds_read_b64_tr_b16 a[238:239], v219 offset:2048
v_pk_fma_f32 v[168:169], v[168:169], v[108:109], v[108:109] op_sel:[0,0,1] op_sel_hi:[1,0,1]
v_pk_fma_f32 v[170:171], v[170:171], v[108:109], v[108:109] op_sel:[0,0,1] op_sel_hi:[1,0,1]
v_pk_fma_f32 v[172:173], v[172:173], v[108:109], v[108:109] op_sel:[0,0,1] op_sel_hi:[1,0,1]
v_pk_fma_f32 v[174:175], v[174:175], v[108:109], v[108:109] op_sel:[0,0,1] op_sel_hi:[1,0,1]
v_cvt_pk_bf16_f32 v40, v168, v169
v_cvt_pk_bf16_f32 v41, v170, v171
v_cvt_pk_bf16_f32 v42, v172, v173
v_cvt_pk_bf16_f32 v43, v174, v175
v_accvgpr_read_b32 v112, a96
v_accvgpr_read_b32 v113, a97
v_accvgpr_read_b32 v114, a98
v_accvgpr_read_b32 v115, a99
v_accvgpr_read_b32 v116, a100
v_accvgpr_read_b32 v117, a101
v_accvgpr_read_b32 v118, a102
v_accvgpr_read_b32 v119, a103
v_pk_fma_f32 v[112:113], v[112:113], v[110:111], v[110:111] op_sel:[0,0,1] op_sel_hi:[1,0,1]
v_pk_fma_f32 v[114:115], v[114:115], v[110:111], v[110:111] op_sel:[0,0,1] op_sel_hi:[1,0,1]
v_pk_fma_f32 v[116:117], v[116:117], v[110:111], v[110:111] op_sel:[0,0,1] op_sel_hi:[1,0,1]
v_pk_fma_f32 v[118:119], v[118:119], v[110:111], v[110:111] op_sel:[0,0,1] op_sel_hi:[1,0,1]
v_cvt_pk_bf16_f32 v44, v112, v113
v_cvt_pk_bf16_f32 v45, v114, v115
v_cvt_pk_bf16_f32 v46, v116, v117
v_cvt_pk_bf16_f32 v47, v118, v119
v_pk_fma_f32 v[176:177], v[176:177], v[108:109], v[108:109] op_sel:[0,0,1] op_sel_hi:[1,0,1]
v_pk_fma_f32 v[178:179], v[178:179], v[108:109], v[108:109] op_sel:[0,0,1] op_sel_hi:[1,0,1]
v_pk_fma_f32 v[180:181], v[180:181], v[108:109], v[108:109] op_sel:[0,0,1] op_sel_hi:[1,0,1]
v_pk_fma_f32 v[182:183], v[182:183], v[108:109], v[108:109] op_sel:[0,0,1] op_sel_hi:[1,0,1]
v_cvt_pk_bf16_f32 v48, v176, v177
v_cvt_pk_bf16_f32 v49, v178, v179
v_cvt_pk_bf16_f32 v50, v180, v181
v_cvt_pk_bf16_f32 v51, v182, v183
v_accvgpr_read_b32 v112, a104
v_accvgpr_read_b32 v113, a105
v_accvgpr_read_b32 v114, a106
v_accvgpr_read_b32 v115, a107
v_accvgpr_read_b32 v116, a108
v_accvgpr_read_b32 v117, a109
v_accvgpr_read_b32 v118, a110
v_accvgpr_read_b32 v119, a111
v_pk_fma_f32 v[112:113], v[112:113], v[110:111], v[110:111] op_sel:[0,0,1] op_sel_hi:[1,0,1]
v_pk_fma_f32 v[114:115], v[114:115], v[110:111], v[110:111] op_sel:[0,0,1] op_sel_hi:[1,0,1]
v_pk_fma_f32 v[116:117], v[116:117], v[110:111], v[110:111] op_sel:[0,0,1] op_sel_hi:[1,0,1]
v_pk_fma_f32 v[118:119], v[118:119], v[110:111], v[110:111] op_sel:[0,0,1] op_sel_hi:[1,0,1]
v_cvt_pk_bf16_f32 v52, v112, v113
v_cvt_pk_bf16_f32 v53, v114, v115
v_cvt_pk_bf16_f32 v54, v116, v117
v_cvt_pk_bf16_f32 v55, v118, v119
v_pk_fma_f32 v[184:185], v[184:185], v[108:109], v[108:109] op_sel:[0,0,1] op_sel_hi:[1,0,1]
v_pk_fma_f32 v[186:187], v[186:187], v[108:109], v[108:109] op_sel:[0,0,1] op_sel_hi:[1,0,1]
v_pk_fma_f32 v[188:189], v[188:189], v[108:109], v[108:109] op_sel:[0,0,1] op_sel_hi:[1,0,1]
v_pk_fma_f32 v[190:191], v[190:191], v[108:109], v[108:109] op_sel:[0,0,1] op_sel_hi:[1,0,1]
v_cvt_pk_bf16_f32 v56, v184, v185
v_cvt_pk_bf16_f32 v57, v186, v187
v_cvt_pk_bf16_f32 v58, v188, v189
v_cvt_pk_bf16_f32 v59, v190, v191
v_accvgpr_read_b32 v112, a112
v_accvgpr_read_b32 v113, a113
v_accvgpr_read_b32 v114, a114
v_accvgpr_read_b32 v115, a115
v_accvgpr_read_b32 v116, a116
v_accvgpr_read_b32 v117, a117
v_accvgpr_read_b32 v118, a118
v_accvgpr_read_b32 v119, a119
v_pk_fma_f32 v[112:113], v[112:113], v[110:111], v[110:111] op_sel:[0,0,1] op_sel_hi:[1,0,1]
v_pk_fma_f32 v[114:115], v[114:115], v[110:111], v[110:111] op_sel:[0,0,1] op_sel_hi:[1,0,1]
v_pk_fma_f32 v[116:117], v[116:117], v[110:111], v[110:111] op_sel:[0,0,1] op_sel_hi:[1,0,1]
v_pk_fma_f32 v[118:119], v[118:119], v[110:111], v[110:111] op_sel:[0,0,1] op_sel_hi:[1,0,1]
v_cvt_pk_bf16_f32 v60, v112, v113
v_cvt_pk_bf16_f32 v61, v114, v115
v_cvt_pk_bf16_f32 v62, v116, v117
v_cvt_pk_bf16_f32 v63, v118, v119
v_pk_fma_f32 v[192:193], v[192:193], v[108:109], v[108:109] op_sel:[0,0,1] op_sel_hi:[1,0,1]
v_pk_fma_f32 v[194:195], v[194:195], v[108:109], v[108:109] op_sel:[0,0,1] op_sel_hi:[1,0,1]
v_pk_fma_f32 v[196:197], v[196:197], v[108:109], v[108:109] op_sel:[0,0,1] op_sel_hi:[1,0,1]
v_pk_fma_f32 v[198:199], v[198:199], v[108:109], v[108:109] op_sel:[0,0,1] op_sel_hi:[1,0,1]
v_cvt_pk_bf16_f32 v64, v192, v193
v_cvt_pk_bf16_f32 v65, v194, v195
v_cvt_pk_bf16_f32 v66, v196, v197
v_cvt_pk_bf16_f32 v67, v198, v199
v_accvgpr_read_b32 v112, a120
v_accvgpr_read_b32 v113, a121
v_accvgpr_read_b32 v114, a122
v_accvgpr_read_b32 v115, a123
v_accvgpr_read_b32 v116, a124
v_accvgpr_read_b32 v117, a125
v_accvgpr_read_b32 v118, a126
v_accvgpr_read_b32 v119, a127
v_pk_fma_f32 v[112:113], v[112:113], v[110:111], v[110:111] op_sel:[0,0,1] op_sel_hi:[1,0,1]
v_pk_fma_f32 v[114:115], v[114:115], v[110:111], v[110:111] op_sel:[0,0,1] op_sel_hi:[1,0,1]
v_pk_fma_f32 v[116:117], v[116:117], v[110:111], v[110:111] op_sel:[0,0,1] op_sel_hi:[1,0,1]
v_pk_fma_f32 v[118:119], v[118:119], v[110:111], v[110:111] op_sel:[0,0,1] op_sel_hi:[1,0,1]
v_cvt_pk_bf16_f32 v68, v112, v113
v_cvt_pk_bf16_f32 v69, v114, v115
v_cvt_pk_bf16_f32 v70, v116, v117
v_cvt_pk_bf16_f32 v71, v118, v119
s_lshl_b32 s95, s36, 3
v_mov_b32 v5, 1
v_and_b32 v6, 7, v1
s_add_u32 s95, s95, s54
v_lshlrev_b32 v6, 2, v6
v_lshlrev_b32 v250, 3, v1
s_waitcnt vmcnt(0)
s_mov_b64 exec, 1
buffer_store_dword v5, v234, s[20:23], s95 offen offset:0 sc0 sc1
s_mov_b64 exec, -1
s_waitcnt lgkmcnt(15)
v_mfma_f32_16x16x32_bf16 v[136:139], a[192:195], v[8:11], 0
s_add_u32 s67, s36, 1
v_add_u32 v208, 0x10000, v220
v_add_u32 v209, 0x10000, v221
v_mfma_f32_16x16x32_bf16 v[168:171], a[192:195], v[12:15], 0
s_and_b32 s67, s67, 3
ds_read_b64_tr_b16 a[192:193], v220 offset:40960
ds_read_b64_tr_b16 a[194:195], v220 offset:45056
v_mfma_f32_16x16x32_bf16 v[140:143], a[196:199], v[8:11], 0
s_sub_u32 s67, s67, s36
v_add_u32 v210, 0x10000, v222
v_add_u32 v211, 0x10000, v223
v_mfma_f32_16x16x32_bf16 v[172:175], a[196:199], v[12:15], 0
s_lshl_b32 s67, s67, 16
ds_read_b64_tr_b16 a[196:197], v221 offset:40960
ds_read_b64_tr_b16 a[198:199], v221 offset:45056
v_mfma_f32_16x16x32_bf16 v[144:147], a[200:203], v[8:11], 0
s_add_u32 s90, s53, s67
v_add_u32 v212, 0x10000, v224
v_add_u32 v213, 0x10000, v225
v_mfma_f32_16x16x32_bf16 v[176:179], a[200:203], v[12:15], 0
s_add_u32 s67, s36, 2
ds_read_b64_tr_b16 a[200:201], v222 offset:40960
ds_read_b64_tr_b16 a[202:203], v222 offset:45056
v_mfma_f32_16x16x32_bf16 v[148:151], a[204:207], v[8:11], 0
s_add_u32 m0, s3, 77824
v_add_u32 v214, 0x10000, v226
v_add_u32 v215, 0x10000, v227
v_mfma_f32_16x16x32_bf16 v[180:183], a[204:207], v[12:15], 0
s_waitcnt lgkmcnt(15)
s_add_u32 s48, s43, 55296
ds_read_b64_tr_b16 a[204:205], v223 offset:40960
ds_read_b64_tr_b16 a[206:207], v223 offset:45056
v_mfma_f32_16x16x32_bf16 v[152:155], a[208:211], v[8:11], 0
s_and_b32 s67, s67, 3
buffer_load_dwordx4 v236, s[16:19], s48 offen lds
v_mfma_f32_16x16x32_bf16 v[184:187], a[208:211], v[12:15], 0
s_sub_u32 s67, s67, s36
ds_read_b64_tr_b16 a[208:209], v224 offset:40960
ds_read_b64_tr_b16 a[210:211], v224 offset:45056
v_mfma_f32_16x16x32_bf16 v[156:159], a[212:215], v[8:11], 0
s_add_u32 m0, s3, 81920
v_subrev_u32 v200, 0x10000, v220
v_subrev_u32 v201, 0x10000, v221
v_mfma_f32_16x16x32_bf16 v[188:191], a[212:215], v[12:15], 0
s_add_u32 s48, s43, 73728
ds_read_b64_tr_b16 a[212:213], v225 offset:40960
ds_read_b64_tr_b16 a[214:215], v225 offset:45056
v_mfma_f32_16x16x32_bf16 v[160:163], a[216:219], v[8:11], 0
s_lshl_b32 s67, s67, 16
buffer_load_dwordx4 v236, s[16:19], s48 offen lds
v_mfma_f32_16x16x32_bf16 v[192:195], a[216:219], v[12:15], 0
s_waitcnt lgkmcnt(8)
s_add_u32 s91, s53, s67
ds_read_b64_tr_b16 a[216:217], v226 offset:40960
ds_read_b64_tr_b16 a[218:219], v226 offset:45056
v_mfma_f32_16x16x32_bf16 v[164:167], a[220:223], v[8:11], 0
s_add_u32 m0, s3, 86016
v_subrev_u32 v202, 0x10000, v222
v_subrev_u32 v203, 0x10000, v223
v_mfma_f32_16x16x32_bf16 v[196:199], a[220:223], v[12:15], 0
s_add_u32 s48, s43, 92160
ds_read_b64_tr_b16 a[220:221], v227 offset:40960
ds_read_b64_tr_b16 a[222:223], v227 offset:45056
v_mfma_f32_16x16x32_bf16 v[72:75], a[224:227], v[8:11], 0
s_add_u32 s67, s36, 3
buffer_load_dwordx4 v236, s[16:19], s48 offen lds
v_mfma_f32_16x16x32_bf16 v[88:91], a[224:227], v[12:15], 0
s_and_b32 s67, s67, 3
ds_read_b64_tr_b16 a[224:225], v216 offset:4096
ds_read_b64_tr_b16 a[226:227], v216 offset:6144
v_mfma_f32_16x16x32_bf16 v[76:79], a[228:231], v[8:11], 0
s_add_u32 m0, s3, 90112
v_subrev_u32 v204, 0x10000, v224
v_subrev_u32 v205, 0x10000, v225
v_mfma_f32_16x16x32_bf16 v[92:95], a[228:231], v[12:15], 0
s_add_u32 s48, s43, 110592
ds_read_b64_tr_b16 a[228:229], v217 offset:4096
ds_read_b64_tr_b16 a[230:231], v217 offset:6144
v_mfma_f32_16x16x32_bf16 v[80:83], a[232:235], v[8:11], 0
s_sub_u32 s67, s67, s36
buffer_load_dwordx4 v236, s[16:19], s48 offen lds
v_mfma_f32_16x16x32_bf16 v[96:99], a[232:235], v[12:15], 0
ds_read_b64_tr_b16 a[232:233], v218 offset:4096
ds_read_b64_tr_b16 a[234:235], v218 offset:6144
v_mfma_f32_16x16x32_bf16 v[84:87], a[236:239], v[8:11], 0
v_subrev_u32 v206, 0x10000, v226
v_mfma_f32_16x16x32_bf16 v[100:103], a[236:239], v[12:15], 0
ds_read_b64_tr_b16 a[236:237], v219 offset:4096
ds_read_b64_tr_b16 a[238:239], v219 offset:6144
v_mfma_f32_16x16x32_bf16 v[136:139], a[192:195], v[16:19], v[136:139]
s_add_u32 m0, s3, 94208
v_subrev_u32 v207, 0x10000, v227
v_mfma_f32_16x16x32_bf16 v[168:171], a[192:195], v[20:23], v[168:171]
s_add_u32 s48, s43, 129024
ds_read_b64_tr_b16 a[192:193], v220 offset:49152
ds_read_b64_tr_b16 a[194:195], v220 offset:53248
v_mfma_f32_16x16x32_bf16 v[140:143], a[196:199], v[16:19], v[140:143]
s_lshl_b32 s67, s67, 16
buffer_load_dwordx4 v236, s[16:19], s48 offen lds
v_mfma_f32_16x16x32_bf16 v[172:175], a[196:199], v[20:23], v[172:175]
s_waitcnt lgkmcnt(8)
s_add_u32 s92, s53, s67
ds_read_b64_tr_b16 a[196:197], v221 offset:49152
ds_read_b64_tr_b16 a[198:199], v221 offset:53248
v_mfma_f32_16x16x32_bf16 v[144:147], a[200:203], v[16:19], v[144:147]
s_lshl_b32 s67, s34, 2
v_mfma_f32_16x16x32_bf16 v[176:179], a[200:203], v[20:23], v[176:179]
s_add_u32 s94, s53, 8192
ds_read_b64_tr_b16 a[200:201], v222 offset:49152
ds_read_b64_tr_b16 a[202:203], v222 offset:53248
v_mfma_f32_16x16x32_bf16 v[148:151], a[204:207], v[16:19], v[148:151]
s_add_u32 s67, s67, s32
buffer_store_dwordx4 v[40:43], v234, s[20:23], s94 offen offset:0 sc0 sc1
v_mfma_f32_16x16x32_bf16 v[180:183], a[204:207], v[20:23], v[180:183]
s_lshl_b32 s86, s67, 7
ds_read_b64_tr_b16 a[204:205], v223 offset:49152
ds_read_b64_tr_b16 a[206:207], v223 offset:53248
v_mfma_f32_16x16x32_bf16 v[152:155], a[208:211], v[16:19], v[152:155]
s_add_u32 s86, s86, 0x260000
v_mfma_f32_16x16x32_bf16 v[184:187], a[208:211], v[20:23], v[184:187]
s_lshl_b32 s67, s67, 1
ds_read_b64_tr_b16 a[208:209], v224 offset:49152
ds_read_b64_tr_b16 a[210:211], v224 offset:53248
v_mfma_f32_16x16x32_bf16 v[156:159], a[212:215], v[16:19], v[156:159]
s_lshr_b32 s47, s35, 1
v_mfma_f32_16x16x32_bf16 v[188:191], a[212:215], v[20:23], v[188:191]
s_add_u32 s67, s67, s47
ds_read_b64_tr_b16 a[212:213], v225 offset:49152
ds_read_b64_tr_b16 a[214:215], v225 offset:53248
v_mfma_f32_16x16x32_bf16 v[160:163], a[216:219], v[16:19], v[160:163]
s_lshl_b32 s87, s67, 15
v_mfma_f32_16x16x32_bf16 v[192:195], a[216:219], v[20:23], v[192:195]
s_add_u32 s87, s87, 0x2000000
ds_read_b64_tr_b16 a[216:217], v226 offset:49152
ds_read_b64_tr_b16 a[218:219], v226 offset:53248
v_mfma_f32_16x16x32_bf16 v[164:167], a[220:223], v[16:19], v[164:167]
s_lshl_b32 s67, s33, 9
v_mfma_f32_16x16x32_bf16 v[196:199], a[220:223], v[20:23], v[196:199]
s_add_u32 s88, s87, s67
ds_read_b64_tr_b16 a[220:221], v227 offset:49152
ds_read_b64_tr_b16 a[222:223], v227 offset:53248
v_mfma_f32_16x16x32_bf16 v[72:75], a[224:227], v[16:19], v[72:75]
s_xor_b32 s89, s88, 0x8000
v_mfma_f32_16x16x32_bf16 v[88:91], a[224:227], v[20:23], v[88:91]
s_waitcnt lgkmcnt(8)
s_add_u32 s94, s53, 8192
ds_read_b64_tr_b16 a[224:225], v216 offset:8192
ds_read_b64_tr_b16 a[226:227], v216 offset:10240
v_mfma_f32_16x16x32_bf16 v[76:79], a[228:231], v[16:19], v[76:79]
s_lshl_b32 s47, s34, 2
buffer_store_dwordx4 v[44:47], v234, s[20:23], s94 offen offset:1024 sc0 sc1
v_mfma_f32_16x16x32_bf16 v[92:95], a[228:231], v[20:23], v[92:95]
s_add_u32 s47, s47, s36
ds_read_b64_tr_b16 a[228:229], v217 offset:8192
ds_read_b64_tr_b16 a[230:231], v217 offset:10240
v_mfma_f32_16x16x32_bf16 v[80:83], a[232:235], v[16:19], v[80:83]
s_lshl_b32 s63, s47, 2
v_mfma_f32_16x16x32_bf16 v[96:99], a[232:235], v[20:23], v[96:99]
ds_read_b64_tr_b16 a[232:233], v218 offset:8192
ds_read_b64_tr_b16 a[234:235], v218 offset:10240
v_mfma_f32_16x16x32_bf16 v[84:87], a[236:239], v[16:19], v[84:87]
v_mfma_f32_16x16x32_bf16 v[100:103], a[236:239], v[20:23], v[100:103]
ds_read_b64_tr_b16 a[236:237], v219 offset:8192
ds_read_b64_tr_b16 a[238:239], v219 offset:10240
v_mfma_f32_16x16x32_bf16 v[136:139], a[192:195], v[24:27], v[136:139]
s_add_u32 s63, s63, s32
v_mfma_f32_16x16x32_bf16 v[168:171], a[192:195], v[28:31], v[168:171]
s_lshl_b32 s63, s63, 9
ds_read_b64_tr_b16 a[192:193], v220 offset:57344
ds_read_b64_tr_b16 a[194:195], v220 offset:61440
v_mfma_f32_16x16x32_bf16 v[140:143], a[196:199], v[24:27], v[140:143]
s_add_u32 s63, s63, 0x280000
v_mfma_f32_16x16x32_bf16 v[172:175], a[196:199], v[28:31], v[172:175]
s_lshl_b32 s47, s47, 6
ds_read_b64_tr_b16 a[196:197], v221 offset:57344
ds_read_b64_tr_b16 a[198:199], v221 offset:61440
v_mfma_f32_16x16x32_bf16 v[144:147], a[200:203], v[24:27], v[144:147]
s_add_u32 s47, s47, s32
v_mfma_f32_16x16x32_bf16 v[176:179], a[200:203], v[28:31], v[176:179]
s_add_u32 s94, s53, 8192
ds_read_b64_tr_b16 a[200:201], v222 offset:57344
ds_read_b64_tr_b16 a[202:203], v222 offset:61440
v_mfma_f32_16x16x32_bf16 v[148:151], a[204:207], v[24:27], v[148:151]
s_lshl_b32 s47, s47, 11
buffer_store_dwordx4 v[48:51], v234, s[20:23], s94 offen offset:2048 sc0 sc1
v_mfma_f32_16x16x32_bf16 v[180:183], a[204:207], v[28:31], v[180:183]
s_waitcnt lgkmcnt(8)
s_mul_i32 s67, s35, 40960
ds_read_b64_tr_b16 a[204:205], v223 offset:57344
ds_read_b64_tr_b16 a[206:207], v223 offset:61440
v_mfma_f32_16x16x32_bf16 v[152:155], a[208:211], v[24:27], v[152:155]
s_add_u32 s67, s67, s47
v_mfma_f32_16x16x32_bf16 v[184:187], a[208:211], v[28:31], v[184:187]
s_add_u32 s67, s67, 0x1400000
ds_read_b64_tr_b16 a[208:209], v224 offset:57344
ds_read_b64_tr_b16 a[210:211], v224 offset:61440
v_mfma_f32_16x16x32_bf16 v[156:159], a[212:215], v[24:27], v[156:159]
s_mov_b32 s57, 0xbfb8aa3b
v_mfma_f32_16x16x32_bf16 v[188:191], a[212:215], v[28:31], v[188:191]
s_mov_b32 s56, 0xffff0000
ds_read_b64_tr_b16 a[212:213], v225 offset:57344
ds_read_b64_tr_b16 a[214:215], v225 offset:61440
v_mfma_f32_16x16x32_bf16 v[160:163], a[216:219], v[24:27], v[160:163]
s_mov_b32 s58, 0x00003f80
v_mfma_f32_16x16x32_bf16 v[192:195], a[216:219], v[28:31], v[192:195]
s_mov_b32 s59, 0x3f800000
ds_read_b64_tr_b16 a[216:217], v226 offset:57344
ds_read_b64_tr_b16 a[218:219], v226 offset:61440
v_mfma_f32_16x16x32_bf16 v[164:167], a[220:223], v[24:27], v[164:167]
s_lshl_b32 s47, s36, 13
v_mfma_f32_16x16x32_bf16 v[196:199], a[220:223], v[28:31], v[196:199]
s_add_u32 s87, s87, s47
ds_read_b64_tr_b16 a[220:221], v227 offset:57344
ds_read_b64_tr_b16 a[222:223], v227 offset:61440
v_mfma_f32_16x16x32_bf16 v[72:75], a[224:227], v[24:27], v[72:75]
s_mov_b32 s38, 15
v_mfma_f32_16x16x32_bf16 v[88:91], a[224:227], v[28:31], v[88:91]
s_add_u32 s94, s53, 8192
ds_read_b64_tr_b16 a[224:225], v216 offset:12288
ds_read_b64_tr_b16 a[226:227], v216 offset:14336
v_mfma_f32_16x16x32_bf16 v[76:79], a[228:231], v[24:27], v[76:79]
s_bitset0_b32 s38, s35
buffer_store_dwordx4 v[52:55], v234, s[20:23], s94 offen offset:3072 sc0 sc1
v_mfma_f32_16x16x32_bf16 v[92:95], a[228:231], v[28:31], v[92:95]
s_xor_b32 s60, s67, 8192
ds_read_b64_tr_b16 a[228:229], v217 offset:12288
ds_read_b64_tr_b16 a[230:231], v217 offset:14336
v_mfma_f32_16x16x32_bf16 v[80:83], a[232:235], v[24:27], v[80:83]
s_xor_b32 s64, s67, 32768
v_mfma_f32_16x16x32_bf16 v[96:99], a[232:235], v[28:31], v[96:99]
s_waitcnt lgkmcnt(8)
ds_read_b64_tr_b16 a[232:233], v218 offset:12288
ds_read_b64_tr_b16 a[234:235], v218 offset:14336
v_mfma_f32_16x16x32_bf16 v[84:87], a[236:239], v[24:27], v[84:87]
v_mfma_f32_16x16x32_bf16 v[100:103], a[236:239], v[28:31], v[100:103]
ds_read_b64_tr_b16 a[236:237], v219 offset:12288
ds_read_b64_tr_b16 a[238:239], v219 offset:14336
v_mfma_f32_16x16x32_bf16 v[136:139], a[192:195], v[32:35], v[136:139]
v_mfma_f32_16x16x32_bf16 v[168:171], a[192:195], v[36:39], v[168:171]
v_mfma_f32_16x16x32_bf16 v[140:143], a[196:199], v[32:35], v[140:143]
v_mfma_f32_16x16x32_bf16 v[172:175], a[196:199], v[36:39], v[172:175]
v_mfma_f32_16x16x32_bf16 v[144:147], a[200:203], v[32:35], v[144:147]
s_waitcnt lgkmcnt(0)
s_barrier
v_mfma_f32_16x16x32_bf16 v[176:179], a[200:203], v[36:39], v[176:179]
s_xor_b32 s61, s67, 16384
ds_read_b64_tr_b16 a[192:193], v208 offset:0
ds_read_b64_tr_b16 a[194:195], v208 offset:4096
v_mfma_f32_16x16x32_bf16 v[148:151], a[204:207], v[32:35], v[148:151]
s_add_u32 s94, s53, 12288
ds_read_b64_tr_b16 a[196:197], v209 offset:0
ds_read_b64_tr_b16 a[198:199], v209 offset:4096
v_mfma_f32_16x16x32_bf16 v[180:183], a[204:207], v[36:39], v[180:183]
s_xor_b32 s65, s67, 65536
buffer_store_dwordx4 v[56:59], v234, s[20:23], s94 offen offset:0 sc0 sc1
v_mfma_f32_16x16x32_bf16 v[152:155], a[208:211], v[32:35], v[152:155]
s_xor_b32 s62, s67, 24576
ds_read_b64_tr_b16 a[200:201], v210 offset:0
ds_read_b64_tr_b16 a[202:203], v210 offset:4096
v_mfma_f32_16x16x32_bf16 v[184:187], a[208:211], v[36:39], v[184:187]
s_xor_b32 s66, s67, 98304
ds_read_b64_tr_b16 a[204:205], v211 offset:0
ds_read_b64_tr_b16 a[206:207], v211 offset:4096
v_mfma_f32_16x16x32_bf16 v[156:159], a[212:215], v[32:35], v[156:159]
ds_read_b64_tr_b16 a[208:209], v212 offset:0
ds_read_b64_tr_b16 a[210:211], v212 offset:4096
v_mfma_f32_16x16x32_bf16 v[188:191], a[212:215], v[36:39], v[188:191]
ds_read_b64_tr_b16 a[212:213], v213 offset:0
ds_read_b64_tr_b16 a[214:215], v213 offset:4096
v_mfma_f32_16x16x32_bf16 v[160:163], a[216:219], v[32:35], v[160:163]
v_mfma_f32_16x16x32_bf16 v[192:195], a[216:219], v[36:39], v[192:195]
ds_read_b64_tr_b16 a[216:217], v214 offset:0
ds_read_b64_tr_b16 a[218:219], v214 offset:4096
v_mfma_f32_16x16x32_bf16 v[164:167], a[220:223], v[32:35], v[164:167]
v_mfma_f32_16x16x32_bf16 v[196:199], a[220:223], v[36:39], v[196:199]
ds_read_b64_tr_b16 a[220:221], v215 offset:0
ds_read_b64_tr_b16 a[222:223], v215 offset:4096
v_mfma_f32_16x16x32_bf16 v[72:75], a[224:227], v[32:35], v[72:75]
v_mfma_f32_16x16x32_bf16 v[88:91], a[224:227], v[36:39], v[88:91]
ds_read_b64_tr_b16 a[224:225], v216 offset:16384
ds_read_b64_tr_b16 a[226:227], v216 offset:18432
v_mfma_f32_16x16x32_bf16 v[76:79], a[228:231], v[32:35], v[76:79]
s_add_u32 s94, s53, 12288
v_mfma_f32_16x16x32_bf16 v[92:95], a[228:231], v[36:39], v[92:95]
buffer_store_dwordx4 v[60:63], v234, s[20:23], s94 offen offset:1024 sc0 sc1
v_mfma_f32_16x16x32_bf16 v[80:83], a[232:235], v[32:35], v[80:83]
ds_read_b64_tr_b16 a[228:229], v217 offset:16384
ds_read_b64_tr_b16 a[230:231], v217 offset:18432
v_mfma_f32_16x16x32_bf16 v[96:99], a[232:235], v[36:39], v[96:99]
ds_read_b64_tr_b16 a[232:233], v218 offset:16384
ds_read_b64_tr_b16 a[234:235], v218 offset:18432
v_mfma_f32_16x16x32_bf16 v[84:87], a[236:239], v[32:35], v[84:87]
v_mfma_f32_16x16x32_bf16 v[100:103], a[236:239], v[36:39], v[100:103]
s_waitcnt lgkmcnt(8)
ds_read_b64_tr_b16 a[236:237], v219 offset:16384
ds_read_b64_tr_b16 a[238:239], v219 offset:18432
buffer_load_dword v246, v6, s[20:23], s54 offen sc0 sc1
v_mfma_f32_16x16x32_bf16 v[136:139], a[192:195], v[40:43], v[136:139]
v_mfma_f32_16x16x32_bf16 v[168:171], a[192:195], v[44:47], v[168:171]
ds_read_b64_tr_b16 a[192:193], v208 offset:8192
ds_read_b64_tr_b16 a[194:195], v208 offset:12288
v_mfma_f32_16x16x32_bf16 v[140:143], a[196:199], v[40:43], v[140:143]
v_mfma_f32_16x16x32_bf16 v[172:175], a[196:199], v[44:47], v[172:175]
ds_read_b64_tr_b16 a[196:197], v209 offset:8192
ds_read_b64_tr_b16 a[198:199], v209 offset:12288
v_mfma_f32_16x16x32_bf16 v[144:147], a[200:203], v[40:43], v[144:147]
v_mfma_f32_16x16x32_bf16 v[176:179], a[200:203], v[44:47], v[176:179]
ds_read_b64_tr_b16 a[200:201], v210 offset:8192
ds_read_b64_tr_b16 a[202:203], v210 offset:12288
v_mfma_f32_16x16x32_bf16 v[148:151], a[204:207], v[40:43], v[148:151]
s_add_u32 s94, s53, 12288
v_mfma_f32_16x16x32_bf16 v[180:183], a[204:207], v[44:47], v[180:183]
buffer_store_dwordx4 v[64:67], v234, s[20:23], s94 offen offset:2048 sc0 sc1
v_mfma_f32_16x16x32_bf16 v[152:155], a[208:211], v[40:43], v[152:155]
ds_read_b64_tr_b16 a[204:205], v211 offset:8192
ds_read_b64_tr_b16 a[206:207], v211 offset:12288
v_mfma_f32_16x16x32_bf16 v[184:187], a[208:211], v[44:47], v[184:187]
ds_read_b64_tr_b16 a[208:209], v212 offset:8192
ds_read_b64_tr_b16 a[210:211], v212 offset:12288
v_mfma_f32_16x16x32_bf16 v[156:159], a[212:215], v[40:43], v[156:159]
v_mfma_f32_16x16x32_bf16 v[188:191], a[212:215], v[44:47], v[188:191]
ds_read_b64_tr_b16 a[212:213], v213 offset:8192
ds_read_b64_tr_b16 a[214:215], v213 offset:12288
v_mfma_f32_16x16x32_bf16 v[160:163], a[216:219], v[40:43], v[160:163]
v_mfma_f32_16x16x32_bf16 v[192:195], a[216:219], v[44:47], v[192:195]
s_waitcnt lgkmcnt(8)
ds_read_b64_tr_b16 a[216:217], v214 offset:8192
ds_read_b64_tr_b16 a[218:219], v214 offset:12288
v_mfma_f32_16x16x32_bf16 v[164:167], a[220:223], v[40:43], v[164:167]
v_mfma_f32_16x16x32_bf16 v[196:199], a[220:223], v[44:47], v[196:199]
ds_read_b64_tr_b16 a[220:221], v215 offset:8192
ds_read_b64_tr_b16 a[222:223], v215 offset:12288
v_mfma_f32_16x16x32_bf16 v[72:75], a[224:227], v[40:43], v[72:75]
v_mfma_f32_16x16x32_bf16 v[88:91], a[224:227], v[44:47], v[88:91]
ds_read_b64_tr_b16 a[224:225], v216 offset:20480
ds_read_b64_tr_b16 a[226:227], v216 offset:22528
v_mfma_f32_16x16x32_bf16 v[76:79], a[228:231], v[40:43], v[76:79]
s_add_u32 s94, s53, 12288
v_mfma_f32_16x16x32_bf16 v[92:95], a[228:231], v[44:47], v[92:95]
buffer_store_dwordx4 v[68:71], v234, s[20:23], s94 offen offset:3072 sc0 sc1
v_mfma_f32_16x16x32_bf16 v[80:83], a[232:235], v[40:43], v[80:83]
ds_read_b64_tr_b16 a[228:229], v217 offset:20480
ds_read_b64_tr_b16 a[230:231], v217 offset:22528
v_mfma_f32_16x16x32_bf16 v[96:99], a[232:235], v[44:47], v[96:99]
ds_read_b64_tr_b16 a[232:233], v218 offset:20480
ds_read_b64_tr_b16 a[234:235], v218 offset:22528
v_mfma_f32_16x16x32_bf16 v[84:87], a[236:239], v[40:43], v[84:87]
v_mfma_f32_16x16x32_bf16 v[100:103], a[236:239], v[44:47], v[100:103]
ds_read_b64_tr_b16 a[236:237], v219 offset:20480
ds_read_b64_tr_b16 a[238:239], v219 offset:22528
v_mfma_f32_16x16x32_bf16 v[136:139], a[192:195], v[48:51], v[136:139]
v_mfma_f32_16x16x32_bf16 v[168:171], a[192:195], v[52:55], v[168:171]
ds_read_b64_tr_b16 a[192:193], v208 offset:16384
ds_read_b64_tr_b16 a[194:195], v208 offset:20480
v_mfma_f32_16x16x32_bf16 v[140:143], a[196:199], v[48:51], v[140:143]
v_mfma_f32_16x16x32_bf16 v[172:175], a[196:199], v[52:55], v[172:175]
s_waitcnt lgkmcnt(8)
ds_read_b64_tr_b16 a[196:197], v209 offset:16384
ds_read_b64_tr_b16 a[198:199], v209 offset:20480
v_mfma_f32_16x16x32_bf16 v[144:147], a[200:203], v[48:51], v[144:147]
v_mfma_f32_16x16x32_bf16 v[176:179], a[200:203], v[52:55], v[176:179]
s_add_u32 m0, s3, 98304
ds_read_b64_tr_b16 a[200:201], v210 offset:16384
ds_read_b64_tr_b16 a[202:203], v210 offset:20480
v_mfma_f32_16x16x32_bf16 v[148:151], a[204:207], v[48:51], v[148:151]
s_add_u32 s48, s44, 0
v_mfma_f32_16x16x32_bf16 v[180:183], a[204:207], v[52:55], v[180:183]
buffer_load_dwordx4 v236, s[16:19], s48 offen lds
v_mfma_f32_16x16x32_bf16 v[152:155], a[208:211], v[48:51], v[152:155]
ds_read_b64_tr_b16 a[204:205], v211 offset:16384
ds_read_b64_tr_b16 a[206:207], v211 offset:20480
v_mfma_f32_16x16x32_bf16 v[184:187], a[208:211], v[52:55], v[184:187]
s_add_u32 m0, s3, 102400
ds_read_b64_tr_b16 a[208:209], v212 offset:16384
ds_read_b64_tr_b16 a[210:211], v212 offset:20480
v_mfma_f32_16x16x32_bf16 v[156:159], a[212:215], v[48:51], v[156:159]
s_add_u32 s48, s44, 18432
v_mfma_f32_16x16x32_bf16 v[188:191], a[212:215], v[52:55], v[188:191]
buffer_load_dwordx4 v236, s[16:19], s48 offen lds
v_mfma_f32_16x16x32_bf16 v[160:163], a[216:219], v[48:51], v[160:163]
ds_read_b64_tr_b16 a[212:213], v213 offset:16384
ds_read_b64_tr_b16 a[214:215], v213 offset:20480
v_mfma_f32_16x16x32_bf16 v[192:195], a[216:219], v[52:55], v[192:195]
s_add_u32 m0, s3, 106496
ds_read_b64_tr_b16 a[216:217], v214 offset:16384
ds_read_b64_tr_b16 a[218:219], v214 offset:20480
v_mfma_f32_16x16x32_bf16 v[164:167], a[220:223], v[48:51], v[164:167]
s_add_u32 s48, s44, 36864
v_mfma_f32_16x16x32_bf16 v[196:199], a[220:223], v[52:55], v[196:199]
buffer_load_dwordx4 v236, s[16:19], s48 offen lds
v_mfma_f32_16x16x32_bf16 v[72:75], a[224:227], v[48:51], v[72:75]
s_waitcnt lgkmcnt(8)
ds_read_b64_tr_b16 a[220:221], v215 offset:16384
ds_read_b64_tr_b16 a[222:223], v215 offset:20480
v_mfma_f32_16x16x32_bf16 v[88:91], a[224:227], v[52:55], v[88:91]
s_add_u32 m0, s3, 110592
ds_read_b64_tr_b16 a[224:225], v216 offset:24576
ds_read_b64_tr_b16 a[226:227], v216 offset:26624
v_mfma_f32_16x16x32_bf16 v[76:79], a[228:231], v[48:51], v[76:79]
s_add_u32 s48, s44, 55296
v_mfma_f32_16x16x32_bf16 v[92:95], a[228:231], v[52:55], v[92:95]
buffer_load_dwordx4 v236, s[16:19], s48 offen lds
v_mfma_f32_16x16x32_bf16 v[80:83], a[232:235], v[48:51], v[80:83]
ds_read_b64_tr_b16 a[228:229], v217 offset:24576
ds_read_b64_tr_b16 a[230:231], v217 offset:26624
v_mfma_f32_16x16x32_bf16 v[96:99], a[232:235], v[52:55], v[96:99]
ds_read_b64_tr_b16 a[232:233], v218 offset:24576
ds_read_b64_tr_b16 a[234:235], v218 offset:26624
v_mfma_f32_16x16x32_bf16 v[84:87], a[236:239], v[48:51], v[84:87]
v_mfma_f32_16x16x32_bf16 v[100:103], a[236:239], v[52:55], v[100:103]
ds_read_b64_tr_b16 a[236:237], v219 offset:24576
ds_read_b64_tr_b16 a[238:239], v219 offset:26624
v_rcp_f32 v132, v131
s_waitcnt vmcnt(6)
v_cmp_ne_u32 vcc, 1, v246
s_and_b32 s46, vcc_lo, 85
s_cbranch_scc0 K_F0_OK
K_F0:
s_sleep 1
s_add_u32 s100, s100, 1
s_bitcmp1_b32 s100, 19
s_cbranch_scc1 K_END
buffer_load_dword v246, v6, s[20:23], s54 offen sc0 sc1
s_waitcnt vmcnt(0)
v_cmp_ne_u32 vcc, 1, v246
s_and_b32 s46, vcc_lo, 85
s_cbranch_scc1 K_F0
K_F0_OK:
v_mfma_f32_16x16x32_bf16 v[136:139], a[192:195], v[56:59], v[136:139]
s_add_u32 s94, s90, 0
v_mfma_f32_16x16x32_bf16 v[168:171], a[192:195], v[60:63], v[168:171]
buffer_load_dwordx4 a[0:3], v234, s[20:23], s94 offen offset:0 sc0 sc1
v_mfma_f32_16x16x32_bf16 v[140:143], a[196:199], v[56:59], v[140:143]
ds_read_b64_tr_b16 a[192:193], v208 offset:24576
ds_read_b64_tr_b16 a[194:195], v208 offset:28672
v_mfma_f32_16x16x32_bf16 v[172:175], a[196:199], v[60:63], v[172:175]
s_add_u32 s94, s90, 0
ds_read_b64_tr_b16 a[196:197], v209 offset:24576
ds_read_b64_tr_b16 a[198:199], v209 offset:28672
v_mfma_f32_16x16x32_bf16 v[144:147], a[200:203], v[56:59], v[144:147]
buffer_load_dwordx4 a[4:7], v234, s[20:23], s94 offen offset:1024 sc0 sc1
v_mfma_f32_16x16x32_bf16 v[176:179], a[200:203], v[60:63], v[176:179]
s_waitcnt lgkmcnt(10)
ds_read_b64_tr_b16 a[200:201], v210 offset:24576
ds_read_b64_tr_b16 a[202:203], v210 offset:28672
v_mfma_f32_16x16x32_bf16 v[148:151], a[204:207], v[56:59], v[148:151]
s_add_u32 s94, s90, 0
v_mfma_f32_16x16x32_bf16 v[180:183], a[204:207], v[60:63], v[180:183]
buffer_load_dwordx4 a[8:11], v234, s[20:23], s94 offen offset:2048 sc0 sc1
v_mfma_f32_16x16x32_bf16 v[152:155], a[208:211], v[56:59], v[152:155]
ds_read_b64_tr_b16 a[204:205], v211 offset:24576
ds_read_b64_tr_b16 a[206:207], v211 offset:28672
v_mfma_f32_16x16x32_bf16 v[184:187], a[208:211], v[60:63], v[184:187]
s_add_u32 s94, s90, 0
ds_read_b64_tr_b16 a[208:209], v212 offset:24576
ds_read_b64_tr_b16 a[210:211], v212 offset:28672
v_mfma_f32_16x16x32_bf16 v[156:159], a[212:215], v[56:59], v[156:159]
buffer_load_dwordx4 a[12:15], v234, s[20:23], s94 offen offset:3072 sc0 sc1
v_mfma_f32_16x16x32_bf16 v[188:191], a[212:215], v[60:63], v[188:191]
ds_read_b64_tr_b16 a[212:213], v213 offset:24576
ds_read_b64_tr_b16 a[214:215], v213 offset:28672
v_mfma_f32_16x16x32_bf16 v[160:163], a[216:219], v[56:59], v[160:163]
s_add_u32 s94, s90, 4096
v_mfma_f32_16x16x32_bf16 v[192:195], a[216:219], v[60:63], v[192:195]
buffer_load_dwordx4 a[16:19], v234, s[20:23], s94 offen offset:0 sc0 sc1
v_mfma_f32_16x16x32_bf16 v[164:167], a[220:223], v[56:59], v[164:167]
ds_read_b64_tr_b16 a[216:217], v214 offset:24576
ds_read_b64_tr_b16 a[218:219], v214 offset:28672
v_mfma_f32_16x16x32_bf16 v[196:199], a[220:223], v[60:63], v[196:199]
s_add_u32 s94, s90, 4096
ds_read_b64_tr_b16 a[220:221], v215 offset:24576
ds_read_b64_tr_b16 a[222:223], v215 offset:28672
v_mfma_f32_16x16x32_bf16 v[72:75], a[224:227], v[56:59], v[72:75]
buffer_load_dwordx4 a[20:23], v234, s[20:23], s94 offen offset:1024 sc0 sc1
v_mfma_f32_16x16x32_bf16 v[88:91], a[224:227], v[60:63], v[88:91]
s_waitcnt lgkmcnt(10)
ds_read_b64_tr_b16 a[224:225], v216 offset:28672
ds_read_b64_tr_b16 a[226:227], v216 offset:30720
v_mfma_f32_16x16x32_bf16 v[76:79], a[228:231], v[56:59], v[76:79]
s_add_u32 s94, s90, 4096
v_mfma_f32_16x16x32_bf16 v[92:95], a[228:231], v[60:63], v[92:95]
buffer_load_dwordx4 a[24:27], v234, s[20:23], s94 offen offset:2048 sc0 sc1
v_mfma_f32_16x16x32_bf16 v[80:83], a[232:235], v[56:59], v[80:83]
ds_read_b64_tr_b16 a[228:229], v217 offset:28672
ds_read_b64_tr_b16 a[230:231], v217 offset:30720
v_mfma_f32_16x16x32_bf16 v[96:99], a[232:235], v[60:63], v[96:99]
s_add_u32 s94, s90, 4096
ds_read_b64_tr_b16 a[232:233], v218 offset:28672
ds_read_b64_tr_b16 a[234:235], v218 offset:30720
v_mfma_f32_16x16x32_bf16 v[84:87], a[236:239], v[56:59], v[84:87]
buffer_load_dwordx4 a[28:31], v234, s[20:23], s94 offen offset:3072 sc0 sc1
v_mfma_f32_16x16x32_bf16 v[100:103], a[236:239], v[60:63], v[100:103]
ds_read_b64_tr_b16 a[236:237], v219 offset:28672
ds_read_b64_tr_b16 a[238:239], v219 offset:30720
s_waitcnt vmcnt(12)
s_mov_b64 exec, 1
buffer_store_dword v5, v234, s[20:23], s95 offen offset:4 sc0 sc1
s_mov_b64 exec, -1
v_mfma_f32_16x16x32_bf16 v[136:139], a[192:195], v[64:67], v[136:139]
v_mfma_f32_16x16x32_bf16 v[168:171], a[192:195], v[68:71], v[168:171]
v_mfma_f32_16x16x32_bf16 v[140:143], a[196:199], v[64:67], v[140:143]
v_mfma_f32_16x16x32_bf16 v[172:175], a[196:199], v[68:71], v[172:175]
v_mfma_f32_16x16x32_bf16 v[144:147], a[200:203], v[64:67], v[144:147]
s_waitcnt vmcnt(22) lgkmcnt(0)
s_barrier
v_mfma_f32_16x16x32_bf16 v[176:179], a[200:203], v[68:71], v[176:179]
ds_read_b64_tr_b16 a[192:193], v200 offset:32768
ds_read_b64_tr_b16 a[194:195], v200 offset:36864
v_mfma_f32_16x16x32_bf16 v[148:151], a[204:207], v[64:67], v[148:151]
s_add_u32 s94, s91, 0
ds_read_b64_tr_b16 a[196:197], v201 offset:32768
ds_read_b64_tr_b16 a[198:199], v201 offset:36864
v_mfma_f32_16x16x32_bf16 v[180:183], a[204:207], v[68:71], v[180:183]
buffer_load_dwordx4 a[32:35], v234, s[20:23], s94 offen offset:0 sc0 sc1
v_mfma_f32_16x16x32_bf16 v[152:155], a[208:211], v[64:67], v[152:155]
ds_read_b64_tr_b16 a[200:201], v202 offset:32768
ds_read_b64_tr_b16 a[202:203], v202 offset:36864
v_mfma_f32_16x16x32_bf16 v[184:187], a[208:211], v[68:71], v[184:187]
ds_read_b64_tr_b16 a[204:205], v203 offset:32768
ds_read_b64_tr_b16 a[206:207], v203 offset:36864
v_mfma_f32_16x16x32_bf16 v[156:159], a[212:215], v[64:67], v[156:159]
s_add_u32 s94, s91, 0
ds_read_b64_tr_b16 a[208:209], v204 offset:32768
ds_read_b64_tr_b16 a[210:211], v204 offset:36864
v_mfma_f32_16x16x32_bf16 v[188:191], a[212:215], v[68:71], v[188:191]
buffer_load_dwordx4 a[36:39], v234, s[20:23], s94 offen offset:1024 sc0 sc1
v_mfma_f32_16x16x32_bf16 v[160:163], a[216:219], v[64:67], v[160:163]
ds_read_b64_tr_b16 a[212:213], v205 offset:32768
ds_read_b64_tr_b16 a[214:215], v205 offset:36864
v_mfma_f32_16x16x32_bf16 v[192:195], a[216:219], v[68:71], v[192:195]
ds_read_b64_tr_b16 a[216:217], v206 offset:32768
ds_read_b64_tr_b16 a[218:219], v206 offset:36864
v_mfma_f32_16x16x32_bf16 v[164:167], a[220:223], v[64:67], v[164:167]
s_add_u32 s94, s91, 0
v_mfma_f32_16x16x32_bf16 v[196:199], a[220:223], v[68:71], v[196:199]
buffer_load_dwordx4 a[40:43], v234, s[20:23], s94 offen offset:2048 sc0 sc1
v_mfma_f32_16x16x32_bf16 v[72:75], a[224:227], v[64:67], v[72:75]
ds_read_b64_tr_b16 a[220:221], v207 offset:32768
ds_read_b64_tr_b16 a[222:223], v207 offset:36864
v_mfma_f32_16x16x32_bf16 v[88:91], a[224:227], v[68:71], v[88:91]
v_mfma_f32_16x16x32_bf16 v[76:79], a[228:231], v[64:67], v[76:79]
s_add_u32 s94, s91, 0
v_mfma_f32_16x16x32_bf16 v[92:95], a[228:231], v[68:71], v[92:95]
buffer_load_dwordx4 a[44:47], v234, s[20:23], s94 offen offset:3072 sc0 sc1
v_mfma_f32_16x16x32_bf16 v[80:83], a[232:235], v[64:67], v[80:83]
v_mfma_f32_16x16x32_bf16 v[96:99], a[232:235], v[68:71], v[96:99]
v_mfma_f32_16x16x32_bf16 v[84:87], a[236:239], v[64:67], v[84:87]
v_mfma_f32_16x16x32_bf16 v[100:103], a[236:239], v[68:71], v[100:103]
s_waitcnt lgkmcnt(2)
s_cmp_lg_u32 s83, 0
s_cbranch_scc1 K_YR2
K_YR2D:
s_waitcnt vmcnt(5)
v_mfma_f32_16x16x32_bf16 v[136:139], a[192:195], a[0:3], v[136:139]
s_add_u32 s94, s91, 4096
v_mfma_f32_16x16x32_bf16 v[168:171], a[192:195], a[4:7], v[168:171]
buffer_load_dwordx4 a[48:51], v234, s[20:23], s94 offen offset:0 sc0 sc1
v_mfma_f32_16x16x32_bf16 v[140:143], a[196:199], a[0:3], v[140:143]
ds_read_b64_tr_b16 a[192:193], v200 offset:40960
ds_read_b64_tr_b16 a[194:195], v200 offset:45056
v_mfma_f32_16x16x32_bf16 v[172:175], a[196:199], a[4:7], v[172:175]
ds_read_b64_tr_b16 a[196:197], v201 offset:40960
ds_read_b64_tr_b16 a[198:199], v201 offset:45056
v_mfma_f32_16x16x32_bf16 v[144:147], a[200:203], a[0:3], v[144:147]
s_add_u32 s94, s91, 4096
v_cvt_pk_bf16_f32 v72, v72, v73
v_cvt_pk_bf16_f32 v73, v74, v75
v_mfma_f32_16x16x32_bf16 v[176:179], a[200:203], a[4:7], v[176:179]
buffer_load_dwordx4 a[52:55], v234, s[20:23], s94 offen offset:1024 sc0 sc1
v_mfma_f32_16x16x32_bf16 v[148:151], a[204:207], a[0:3], v[148:151]
ds_read_b64_tr_b16 a[200:201], v202 offset:40960
ds_read_b64_tr_b16 a[202:203], v202 offset:45056
v_mfma_f32_16x16x32_bf16 v[180:183], a[204:207], a[4:7], v[180:183]
ds_read_b64_tr_b16 a[204:205], v203 offset:40960
ds_read_b64_tr_b16 a[206:207], v203 offset:45056
v_mfma_f32_16x16x32_bf16 v[152:155], a[208:211], a[0:3], v[152:155]
s_add_u32 s94, s91, 4096
v_cvt_pk_bf16_f32 v76, v76, v77
v_cvt_pk_bf16_f32 v77, v78, v79
v_mfma_f32_16x16x32_bf16 v[184:187], a[208:211], a[4:7], v[184:187]
buffer_load_dwordx4 a[56:59], v234, s[20:23], s94 offen offset:2048 sc0 sc1
v_mfma_f32_16x16x32_bf16 v[156:159], a[212:215], a[0:3], v[156:159]
ds_read_b64_tr_b16 a[208:209], v204 offset:40960
ds_read_b64_tr_b16 a[210:211], v204 offset:45056
v_mfma_f32_16x16x32_bf16 v[188:191], a[212:215], a[4:7], v[188:191]
ds_read_b64_tr_b16 a[212:213], v205 offset:40960
ds_read_b64_tr_b16 a[214:215], v205 offset:45056
v_mfma_f32_16x16x32_bf16 v[160:163], a[216:219], a[0:3], v[160:163]
s_add_u32 s94, s91, 4096
v_cvt_pk_bf16_f32 v80, v80, v81
v_cvt_pk_bf16_f32 v81, v82, v83
v_mfma_f32_16x16x32_bf16 v[192:195], a[216:219], a[4:7], v[192:195]
s_waitcnt lgkmcnt(8)
buffer_load_dwordx4 a[60:63], v234, s[20:23], s94 offen offset:3072 sc0 sc1
v_mfma_f32_16x16x32_bf16 v[164:167], a[220:223], a[0:3], v[164:167]
ds_read_b64_tr_b16 a[216:217], v206 offset:40960
ds_read_b64_tr_b16 a[218:219], v206 offset:45056
v_mfma_f32_16x16x32_bf16 v[196:199], a[220:223], a[4:7], v[196:199]
ds_read_b64_tr_b16 a[220:221], v207 offset:40960
ds_read_b64_tr_b16 a[222:223], v207 offset:45056
v_mfma_f32_16x16x32_bf16 v[136:139], a[192:195], a[8:11], v[136:139]
s_add_u32 m0, s3, 114688
v_cvt_pk_bf16_f32 v84, v84, v85
v_cvt_pk_bf16_f32 v85, v86, v87
v_mfma_f32_16x16x32_bf16 v[168:171], a[192:195], a[12:15], v[168:171]
s_add_u32 s48, s44, 73728
ds_read_b64_tr_b16 a[192:193], v200 offset:49152
ds_read_b64_tr_b16 a[194:195], v200 offset:53248
v_mfma_f32_16x16x32_bf16 v[140:143], a[196:199], a[8:11], v[140:143]
buffer_load_dwordx4 v236, s[16:19], s48 offen lds
v_mfma_f32_16x16x32_bf16 v[172:175], a[196:199], a[12:15], v[172:175]
s_waitcnt lgkmcnt(10)
ds_read_b64_tr_b16 a[196:197], v201 offset:49152
ds_read_b64_tr_b16 a[198:199], v201 offset:53248
v_mfma_f32_16x16x32_bf16 v[144:147], a[200:203], a[8:11], v[144:147]
s_add_u32 m0, s3, 118784
v_cvt_pk_bf16_f32 v88, v88, v89
v_cvt_pk_bf16_f32 v89, v90, v91
v_mfma_f32_16x16x32_bf16 v[176:179], a[200:203], a[12:15], v[176:179]
s_add_u32 s48, s44, 92160
ds_read_b64_tr_b16 a[200:201], v202 offset:49152
ds_read_b64_tr_b16 a[202:203], v202 offset:53248
v_mfma_f32_16x16x32_bf16 v[148:151], a[204:207], a[8:11], v[148:151]
buffer_load_dwordx4 v236, s[16:19], s48 offen lds
v_mfma_f32_16x16x32_bf16 v[180:183], a[204:207], a[12:15], v[180:183]
s_waitcnt lgkmcnt(10)
ds_read_b64_tr_b16 a[204:205], v203 offset:49152
ds_read_b64_tr_b16 a[206:207], v203 offset:53248
v_mfma_f32_16x16x32_bf16 v[152:155], a[208:211], a[8:11], v[152:155]
s_add_u32 m0, s3, 122880
v_cvt_pk_bf16_f32 v92, v92, v93
v_cvt_pk_bf16_f32 v93, v94, v95
v_mfma_f32_16x16x32_bf16 v[184:187], a[208:211], a[12:15], v[184:187]
s_add_u32 s48, s44, 110592
ds_read_b64_tr_b16 a[208:209], v204 offset:49152
ds_read_b64_tr_b16 a[210:211], v204 offset:53248
v_mfma_f32_16x16x32_bf16 v[156:159], a[212:215], a[8:11], v[156:159]
buffer_load_dwordx4 v236, s[16:19], s48 offen lds
v_mfma_f32_16x16x32_bf16 v[188:191], a[212:215], a[12:15], v[188:191]
s_waitcnt lgkmcnt(8)
ds_read_b64_tr_b16 a[212:213], v205 offset:49152
ds_read_b64_tr_b16 a[214:215], v205 offset:53248
v_mfma_f32_16x16x32_bf16 v[160:163], a[216:219], a[8:11], v[160:163]
s_add_u32 m0, s3, 126976
v_cvt_pk_bf16_f32 v96, v96, v97
v_mfma_f32_16x16x32_bf16 v[192:195], a[216:219], a[12:15], v[192:195]
s_add_u32 s48, s44, 129024
ds_read_b64_tr_b16 a[216:217], v206 offset:49152
ds_read_b64_tr_b16 a[218:219], v206 offset:53248
v_mfma_f32_16x16x32_bf16 v[164:167], a[220:223], a[8:11], v[164:167]
buffer_load_dwordx4 v236, s[16:19], s48 offen lds
v_mfma_f32_16x16x32_bf16 v[196:199], a[220:223], a[12:15], v[196:199]
ds_read_b64_tr_b16 a[220:221], v207 offset:49152
ds_read_b64_tr_b16 a[222:223], v207 offset:53248
v_mfma_f32_16x16x32_bf16 v[136:139], a[192:195], a[16:19], v[136:139]
s_waitcnt lgkmcnt(10)
v_cvt_pk_bf16_f32 v97, v98, v99
v_cvt_pk_bf16_f32 v100, v100, v101
v_mfma_f32_16x16x32_bf16 v[168:171], a[192:195], a[20:23], v[168:171]
s_add_u32 s94, s92, 0
ds_read_b64_tr_b16 a[192:193], v200 offset:57344
ds_read_b64_tr_b16 a[194:195], v200 offset:61440
v_mfma_f32_16x16x32_bf16 v[140:143], a[196:199], a[16:19], v[140:143]
buffer_load_dwordx4 a[64:67], v234, s[20:23], s94 offen offset:0 sc0 sc1
v_mfma_f32_16x16x32_bf16 v[172:175], a[196:199], a[20:23], v[172:175]
ds_read_b64_tr_b16 a[196:197], v201 offset:57344
ds_read_b64_tr_b16 a[198:199], v201 offset:61440
v_mfma_f32_16x16x32_bf16 v[144:147], a[200:203], a[16:19], v[144:147]
s_waitcnt lgkmcnt(10)
v_cvt_pk_bf16_f32 v101, v102, v103
v_lshlrev_b32 v249, 7, v1
v_mfma_f32_16x16x32_bf16 v[176:179], a[200:203], a[20:23], v[176:179]
s_add_u32 s94, s92, 0
ds_read_b64_tr_b16 a[200:201], v202 offset:57344
ds_read_b64_tr_b16 a[202:203], v202 offset:61440
v_mfma_f32_16x16x32_bf16 v[148:151], a[204:207], a[16:19], v[148:151]
buffer_load_dwordx4 a[68:71], v234, s[20:23], s94 offen offset:1024 sc0 sc1
v_mfma_f32_16x16x32_bf16 v[180:183], a[204:207], a[20:23], v[180:183]
ds_read_b64_tr_b16 a[204:205], v203 offset:57344
ds_read_b64_tr_b16 a[206:207], v203 offset:61440
v_mfma_f32_16x16x32_bf16 v[152:155], a[208:211], a[16:19], v[152:155]
s_waitcnt lgkmcnt(10)
v_lshlrev_b32 v7, 2, v3
v_subrev_u32 v248, s55, v254
v_mfma_f32_16x16x32_bf16 v[184:187], a[208:211], a[20:23], v[184:187]
s_add_u32 s94, s92, 0
ds_read_b64_tr_b16 a[208:209], v204 offset:57344
ds_read_b64_tr_b16 a[210:211], v204 offset:61440
v_mfma_f32_16x16x32_bf16 v[156:159], a[212:215], a[16:19], v[156:159]
buffer_load_dwordx4 a[72:75], v234, s[20:23], s94 offen offset:2048 sc0 sc1
v_mfma_f32_16x16x32_bf16 v[188:191], a[212:215], a[20:23], v[188:191]
ds_read_b64_tr_b16 a[212:213], v205 offset:57344
ds_read_b64_tr_b16 a[214:215], v205 offset:61440
v_mfma_f32_16x16x32_bf16 v[160:163], a[216:219], a[16:19], v[160:163]
s_waitcnt lgkmcnt(10)
v_subrev_u32 v248, 1, v248
v_mfma_f32_16x16x32_bf16 v[192:195], a[216:219], a[20:23], v[192:195]
s_add_u32 s94, s92, 0
ds_read_b64_tr_b16 a[216:217], v206 offset:57344
ds_read_b64_tr_b16 a[218:219], v206 offset:61440
v_mfma_f32_16x16x32_bf16 v[164:167], a[220:223], a[16:19], v[164:167]
buffer_load_dwordx4 a[76:79], v234, s[20:23], s94 offen offset:3072 sc0 sc1
v_mfma_f32_16x16x32_bf16 v[196:199], a[220:223], a[20:23], v[196:199]
ds_read_b64_tr_b16 a[220:221], v207 offset:57344
ds_read_b64_tr_b16 a[222:223], v207 offset:61440
buffer_load_dword v246, v6, s[20:23], s54 offen sc0 sc1
v_mfma_f32_16x16x32_bf16 v[136:139], a[192:195], a[24:27], v[136:139]
s_waitcnt lgkmcnt(10)
v_add_u32 v241, s37, v241
v_add_u32 v241, 65536, v241
v_mfma_f32_16x16x32_bf16 v[168:171], a[192:195], a[28:31], v[168:171]
s_add_u32 s94, s92, 4096
ds_read_b64_tr_b16 a[192:193], v220 offset:0
ds_read_b64_tr_b16 a[194:195], v220 offset:4096
v_mfma_f32_16x16x32_bf16 v[140:143], a[196:199], a[24:27], v[140:143]
buffer_load_dwordx4 a[80:83], v234, s[20:23], s94 offen offset:0 sc0 sc1
v_mfma_f32_16x16x32_bf16 v[172:175], a[196:199], a[28:31], v[172:175]
ds_read_b64_tr_b16 a[196:197], v221 offset:0
ds_read_b64_tr_b16 a[198:199], v221 offset:4096
v_mfma_f32_16x16x32_bf16 v[144:147], a[200:203], a[24:27], v[144:147]
s_waitcnt lgkmcnt(10)
v_xor_b32 v242, 32, v241
v_xor_b32 v243, 64, v241
v_mfma_f32_16x16x32_bf16 v[176:179], a[200:203], a[28:31], v[176:179]
s_add_u32 s94, s92, 4096
ds_read_b64_tr_b16 a[200:201], v222 offset:0
ds_read_b64_tr_b16 a[202:203], v222 offset:4096
v_mfma_f32_16x16x32_bf16 v[148:151], a[204:207], a[24:27], v[148:151]
buffer_load_dwordx4 a[84:87], v234, s[20:23], s94 offen offset:1024 sc0 sc1
v_mfma_f32_16x16x32_bf16 v[180:183], a[204:207], a[28:31], v[180:183]
ds_read_b64_tr_b16 a[204:205], v223 offset:0
ds_read_b64_tr_b16 a[206:207], v223 offset:4096
v_mfma_f32_16x16x32_bf16 v[152:155], a[208:211], a[24:27], v[152:155]
s_waitcnt lgkmcnt(10)
v_xor_b32 v244, 96, v241
v_mfma_f32_16x16x32_bf16 v[184:187], a[208:211], a[28:31], v[184:187]
s_add_u32 s94, s92, 4096
ds_read_b64_tr_b16 a[208:209], v224 offset:0
ds_read_b64_tr_b16 a[210:211], v224 offset:4096
v_mfma_f32_16x16x32_bf16 v[156:159], a[212:215], a[24:27], v[156:159]
buffer_load_dwordx4 a[88:91], v234, s[20:23], s94 offen offset:2048 sc0 sc1
v_mfma_f32_16x16x32_bf16 v[188:191], a[212:215], a[28:31], v[188:191]
ds_read_b64_tr_b16 a[212:213], v225 offset:0
ds_read_b64_tr_b16 a[214:215], v225 offset:4096
v_mfma_f32_16x16x32_bf16 v[160:163], a[216:219], a[24:27], v[160:163]
s_waitcnt lgkmcnt(10)
v_mfma_f32_16x16x32_bf16 v[192:195], a[216:219], a[28:31], v[192:195]
s_add_u32 s94, s92, 4096
ds_read_b64_tr_b16 a[216:217], v226 offset:0
ds_read_b64_tr_b16 a[218:219], v226 offset:4096
v_mfma_f32_16x16x32_bf16 v[164:167], a[220:223], a[24:27], v[164:167]
buffer_load_dwordx4 a[92:95], v234, s[20:23], s94 offen offset:3072 sc0 sc1
v_mfma_f32_16x16x32_bf16 v[196:199], a[220:223], a[28:31], v[196:199]
ds_read_b64_tr_b16 a[220:221], v227 offset:0
ds_read_b64_tr_b16 a[222:223], v227 offset:4096
s_waitcnt vmcnt(13)
v_mfma_f32_16x16x32_bf16 v[136:139], a[192:195], a[32:35], v[136:139]
s_add_u32 m0, s3, 131072
v_mfma_f32_16x16x32_bf16 v[168:171], a[192:195], a[36:39], v[168:171]
s_waitcnt lgkmcnt(8)
s_add_u32 s48, s42, 147456
ds_read_b64_tr_b16 a[192:193], v220 offset:8192
ds_read_b64_tr_b16 a[194:195], v220 offset:12288
v_mfma_f32_16x16x32_bf16 v[140:143], a[196:199], a[32:35], v[140:143]
buffer_load_dwordx4 v236, s[16:19], s48 offen lds
v_mfma_f32_16x16x32_bf16 v[172:175], a[196:199], a[36:39], v[172:175]
ds_read_b64_tr_b16 a[196:197], v221 offset:8192
ds_read_b64_tr_b16 a[198:199], v221 offset:12288
v_mfma_f32_16x16x32_bf16 v[144:147], a[200:203], a[32:35], v[144:147]
s_add_u32 m0, s3, 135168
v_mfma_f32_16x16x32_bf16 v[176:179], a[200:203], a[36:39], v[176:179]
s_add_u32 s48, s42, 165888
ds_read_b64_tr_b16 a[200:201], v222 offset:8192
ds_read_b64_tr_b16 a[202:203], v222 offset:12288
v_mfma_f32_16x16x32_bf16 v[148:151], a[204:207], a[32:35], v[148:151]
buffer_load_dwordx4 v236, s[16:19], s48 offen lds
v_mfma_f32_16x16x32_bf16 v[180:183], a[204:207], a[36:39], v[180:183]
s_waitcnt lgkmcnt(8)
ds_read_b64_tr_b16 a[204:205], v223 offset:8192
ds_read_b64_tr_b16 a[206:207], v223 offset:12288
v_mfma_f32_16x16x32_bf16 v[152:155], a[208:211], a[32:35], v[152:155]
s_add_u32 m0, s3, 139264
v_mfma_f32_16x16x32_bf16 v[184:187], a[208:211], a[36:39], v[184:187]
s_add_u32 s48, s42, 184320
ds_read_b64_tr_b16 a[208:209], v224 offset:8192
ds_read_b64_tr_b16 a[210:211], v224 offset:12288
v_mfma_f32_16x16x32_bf16 v[156:159], a[212:215], a[32:35], v[156:159]
buffer_load_dwordx4 v236, s[16:19], s48 offen lds
v_mfma_f32_16x16x32_bf16 v[188:191], a[212:215], a[36:39], v[188:191]
ds_read_b64_tr_b16 a[212:213], v225 offset:8192
ds_read_b64_tr_b16 a[214:215], v225 offset:12288
v_mfma_f32_16x16x32_bf16 v[160:163], a[216:219], a[32:35], v[160:163]
s_add_u32 m0, s3, 143360
v_mfma_f32_16x16x32_bf16 v[192:195], a[216:219], a[36:39], v[192:195]
s_waitcnt lgkmcnt(8)
s_add_u32 s48, s42, 202752
ds_read_b64_tr_b16 a[216:217], v226 offset:8192
ds_read_b64_tr_b16 a[218:219], v226 offset:12288
v_mfma_f32_16x16x32_bf16 v[164:167], a[220:223], a[32:35], v[164:167]
buffer_load_dwordx4 v236, s[16:19], s48 offen lds
v_mfma_f32_16x16x32_bf16 v[196:199], a[220:223], a[36:39], v[196:199]
ds_read_b64_tr_b16 a[220:221], v227 offset:8192
ds_read_b64_tr_b16 a[222:223], v227 offset:12288
v_mfma_f32_16x16x32_bf16 v[136:139], a[192:195], a[40:43], v[136:139]
s_add_u32 m0, s3, 147456
v_mfma_f32_16x16x32_bf16 v[168:171], a[192:195], a[44:47], v[168:171]
s_add_u32 s48, s42, 221184
ds_read_b64_tr_b16 a[192:193], v220 offset:16384
ds_read_b64_tr_b16 a[194:195], v220 offset:20480
v_mfma_f32_16x16x32_bf16 v[140:143], a[196:199], a[40:43], v[140:143]
buffer_load_dwordx4 v236, s[16:19], s48 offen lds
v_mfma_f32_16x16x32_bf16 v[172:175], a[196:199], a[44:47], v[172:175]
s_waitcnt lgkmcnt(8)
ds_read_b64_tr_b16 a[196:197], v221 offset:16384
ds_read_b64_tr_b16 a[198:199], v221 offset:20480
v_mfma_f32_16x16x32_bf16 v[144:147], a[200:203], a[40:43], v[144:147]
s_add_u32 m0, s3, 151552
v_mfma_f32_16x16x32_bf16 v[176:179], a[200:203], a[44:47], v[176:179]
s_add_u32 s48, s42, 239616
ds_read_b64_tr_b16 a[200:201], v222 offset:16384
ds_read_b64_tr_b16 a[202:203], v222 offset:20480
v_mfma_f32_16x16x32_bf16 v[148:151], a[204:207], a[40:43], v[148:151]
buffer_load_dwordx4 v236, s[16:19], s48 offen lds
v_mfma_f32_16x16x32_bf16 v[180:183], a[204:207], a[44:47], v[180:183]
ds_read_b64_tr_b16 a[204:205], v223 offset:16384
ds_read_b64_tr_b16 a[206:207], v223 offset:20480
v_mfma_f32_16x16x32_bf16 v[152:155], a[208:211], a[40:43], v[152:155]
s_add_u32 m0, s3, 155648
v_mfma_f32_16x16x32_bf16 v[184:187], a[208:211], a[44:47], v[184:187]
s_waitcnt lgkmcnt(8)
s_add_u32 s48, s42, 258048
ds_read_b64_tr_b16 a[208:209], v224 offset:16384
ds_read_b64_tr_b16 a[210:211], v224 offset:20480
v_mfma_f32_16x16x32_bf16 v[156:159], a[212:215], a[40:43], v[156:159]
buffer_load_dwordx4 v236, s[16:19], s48 offen lds
v_mfma_f32_16x16x32_bf16 v[188:191], a[212:215], a[44:47], v[188:191]
ds_read_b64_tr_b16 a[212:213], v225 offset:16384
ds_read_b64_tr_b16 a[214:215], v225 offset:20480
v_mfma_f32_16x16x32_bf16 v[160:163], a[216:219], a[40:43], v[160:163]
s_add_u32 m0, s3, 159744
v_mfma_f32_16x16x32_bf16 v[192:195], a[216:219], a[44:47], v[192:195]
s_add_u32 s48, s42, 276480
ds_read_b64_tr_b16 a[216:217], v226 offset:16384
ds_read_b64_tr_b16 a[218:219], v226 offset:20480
v_mfma_f32_16x16x32_bf16 v[164:167], a[220:223], a[40:43], v[164:167]
buffer_load_dwordx4 v236, s[16:19], s48 offen lds
v_mfma_f32_16x16x32_bf16 v[196:199], a[220:223], a[44:47], v[196:199]
s_waitcnt lgkmcnt(8)
ds_read_b64_tr_b16 a[220:221], v227 offset:16384
ds_read_b64_tr_b16 a[222:223], v227 offset:20480
s_waitcnt vmcnt(12)
v_cmp_ne_u32 vcc, 1, v246
s_and_b32 s46, vcc_lo, 170
s_cbranch_scc0 K_F1_OK
K_F1:
s_sleep 1
s_add_u32 s100, s100, 1
s_bitcmp1_b32 s100, 19
s_cbranch_scc1 K_END
buffer_load_dword v246, v6, s[20:23], s54 offen sc0 sc1
s_waitcnt vmcnt(0)
v_cmp_ne_u32 vcc, 1, v246
s_and_b32 s46, vcc_lo, 170
s_cbranch_scc1 K_F1
K_F1_OK:
v_mfma_f32_16x16x32_bf16 v[136:139], a[192:195], a[48:51], v[136:139]
v_mfma_f32_16x16x32_bf16 v[168:171], a[192:195], a[52:55], v[168:171]
s_add_u32 s94, s90, 8192
ds_read_b64_tr_b16 a[192:193], v220 offset:24576
ds_read_b64_tr_b16 a[194:195], v220 offset:28672
v_mfma_f32_16x16x32_bf16 v[140:143], a[196:199], a[48:51], v[140:143]
buffer_load_dwordx4 a[96:99], v234, s[20:23], s94 offen offset:0 sc0 sc1
v_mfma_f32_16x16x32_bf16 v[172:175], a[196:199], a[52:55], v[172:175]
ds_read_b64_tr_b16 a[196:197], v221 offset:24576
ds_read_b64_tr_b16 a[198:199], v221 offset:28672
v_mfma_f32_16x16x32_bf16 v[144:147], a[200:203], a[48:51], v[144:147]
s_add_u32 s94, s90, 8192
v_mfma_f32_16x16x32_bf16 v[176:179], a[200:203], a[52:55], v[176:179]
s_waitcnt lgkmcnt(8)
buffer_load_dwordx4 a[100:103], v234, s[20:23], s94 offen offset:1024 sc0 sc1
v_mfma_f32_16x16x32_bf16 v[148:151], a[204:207], a[48:51], v[148:151]
ds_read_b64_tr_b16 a[200:201], v222 offset:24576
ds_read_b64_tr_b16 a[202:203], v222 offset:28672
v_mfma_f32_16x16x32_bf16 v[180:183], a[204:207], a[52:55], v[180:183]
ds_read_b64_tr_b16 a[204:205], v223 offset:24576
ds_read_b64_tr_b16 a[206:207], v223 offset:28672
v_mfma_f32_16x16x32_bf16 v[152:155], a[208:211], a[48:51], v[152:155]
s_add_u32 s94, s90, 8192
v_mfma_f32_16x16x32_bf16 v[184:187], a[208:211], a[52:55], v[184:187]
buffer_load_dwordx4 a[104:107], v234, s[20:23], s94 offen offset:2048 sc0 sc1
v_mfma_f32_16x16x32_bf16 v[156:159], a[212:215], a[48:51], v[156:159]
s_waitcnt lgkmcnt(8)
ds_read_b64_tr_b16 a[208:209], v224 offset:24576
ds_read_b64_tr_b16 a[210:211], v224 offset:28672
v_mfma_f32_16x16x32_bf16 v[188:191], a[212:215], a[52:55], v[188:191]
s_add_u32 s94, s90, 8192
ds_read_b64_tr_b16 a[212:213], v225 offset:24576
ds_read_b64_tr_b16 a[214:215], v225 offset:28672
v_mfma_f32_16x16x32_bf16 v[160:163], a[216:219], a[48:51], v[160:163]
buffer_load_dwordx4 a[108:111], v234, s[20:23], s94 offen offset:3072 sc0 sc1
v_mfma_f32_16x16x32_bf16 v[192:195], a[216:219], a[52:55], v[192:195]
ds_read_b64_tr_b16 a[216:217], v226 offset:24576
ds_read_b64_tr_b16 a[218:219], v226 offset:28672
v_mfma_f32_16x16x32_bf16 v[164:167], a[220:223], a[48:51], v[164:167]
v_mfma_f32_16x16x32_bf16 v[196:199], a[220:223], a[52:55], v[196:199]
s_waitcnt lgkmcnt(10)
ds_read_b64_tr_b16 a[220:221], v227 offset:24576
ds_read_b64_tr_b16 a[222:223], v227 offset:28672
v_mfma_f32_16x16x32_bf16 v[136:139], a[192:195], a[56:59], v[136:139]
v_mfma_f32_16x16x32_bf16 v[168:171], a[192:195], a[60:63], v[168:171]
v_mfma_f32_16x16x32_bf16 v[140:143], a[196:199], a[56:59], v[140:143]
v_mfma_f32_16x16x32_bf16 v[172:175], a[196:199], a[60:63], v[172:175]
s_waitcnt lgkmcnt(8)
v_mfma_f32_16x16x32_bf16 v[144:147], a[200:203], a[56:59], v[144:147]
s_waitcnt vmcnt(21) lgkmcnt(0)
s_barrier
v_mfma_f32_16x16x32_bf16 v[176:179], a[200:203], a[60:63], v[176:179]
ds_read_b64_tr_b16 a[192:193], v220 offset:32768
ds_read_b64_tr_b16 a[194:195], v220 offset:36864
v_mfma_f32_16x16x32_bf16 v[148:151], a[204:207], a[56:59], v[148:151]
s_add_u32 s94, s90, 12288
ds_read_b64_tr_b16 a[196:197], v221 offset:32768
ds_read_b64_tr_b16 a[198:199], v221 offset:36864
v_mfma_f32_16x16x32_bf16 v[180:183], a[204:207], a[60:63], v[180:183]
buffer_load_dwordx4 a[112:115], v234, s[20:23], s94 offen offset:0 sc0 sc1
v_mfma_f32_16x16x32_bf16 v[152:155], a[208:211], a[56:59], v[152:155]
ds_read_b64_tr_b16 a[200:201], v222 offset:32768
ds_read_b64_tr_b16 a[202:203], v222 offset:36864
v_mfma_f32_16x16x32_bf16 v[184:187], a[208:211], a[60:63], v[184:187]
s_add_u32 s94, s90, 12288
ds_read_b64_tr_b16 a[204:205], v223 offset:32768
ds_read_b64_tr_b16 a[206:207], v223 offset:36864
v_mfma_f32_16x16x32_bf16 v[156:159], a[212:215], a[56:59], v[156:159]
buffer_load_dwordx4 a[116:119], v234, s[20:23], s94 offen offset:1024 sc0 sc1
v_mfma_f32_16x16x32_bf16 v[188:191], a[212:215], a[60:63], v[188:191]
ds_read_b64_tr_b16 a[208:209], v224 offset:32768
ds_read_b64_tr_b16 a[210:211], v224 offset:36864
v_mfma_f32_16x16x32_bf16 v[160:163], a[216:219], a[56:59], v[160:163]
ds_read_b64_tr_b16 a[212:213], v225 offset:32768
ds_read_b64_tr_b16 a[214:215], v225 offset:36864
v_mfma_f32_16x16x32_bf16 v[192:195], a[216:219], a[60:63], v[192:195]
s_add_u32 s94, s90, 12288
ds_read_b64_tr_b16 a[216:217], v226 offset:32768
ds_read_b64_tr_b16 a[218:219], v226 offset:36864
v_mfma_f32_16x16x32_bf16 v[164:167], a[220:223], a[56:59], v[164:167]
buffer_load_dwordx4 a[120:123], v234, s[20:23], s94 offen offset:2048 sc0 sc1
v_mfma_f32_16x16x32_bf16 v[196:199], a[220:223], a[60:63], v[196:199]
s_waitcnt lgkmcnt(12)
ds_read_b64_tr_b16 a[220:221], v227 offset:32768
ds_read_b64_tr_b16 a[222:223], v227 offset:36864
s_waitcnt vmcnt(15)
v_mfma_f32_16x16x32_bf16 v[136:139], a[192:195], a[64:67], v[136:139]
s_add_u32 s94, s90, 12288
v_mfma_f32_16x16x32_bf16 v[168:171], a[192:195], a[68:71], v[168:171]
s_waitcnt lgkmcnt(12)
buffer_load_dwordx4 a[124:127], v234, s[20:23], s94 offen offset:3072 sc0 sc1
v_mfma_f32_16x16x32_bf16 v[140:143], a[196:199], a[64:67], v[140:143]
s_waitcnt lgkmcnt(10)
ds_read_b64_tr_b16 a[192:193], v220 offset:40960
ds_read_b64_tr_b16 a[194:195], v220 offset:45056
v_mfma_f32_16x16x32_bf16 v[172:175], a[196:199], a[68:71], v[172:175]
s_add_u32 m0, s3, 0
ds_read_b64_tr_b16 a[196:197], v221 offset:40960
ds_read_b64_tr_b16 a[198:199], v221 offset:45056
v_mfma_f32_16x16x32_bf16 v[144:147], a[200:203], a[64:67], v[144:147]
s_add_u32 s48, s43, 147456
v_mfma_f32_16x16x32_bf16 v[176:179], a[200:203], a[68:71], v[176:179]
s_waitcnt lgkmcnt(10)
buffer_load_dwordx4 v236, s[16:19], s48 offen lds
v_mfma_f32_16x16x32_bf16 v[148:151], a[204:207], a[64:67], v[148:151]
s_add_u32 m0, s3, 4096
ds_read_b64_tr_b16 a[200:201], v222 offset:40960
ds_read_b64_tr_b16 a[202:203], v222 offset:45056
v_mfma_f32_16x16x32_bf16 v[180:183], a[204:207], a[68:71], v[180:183]
s_add_u32 s48, s43, 165888
ds_read_b64_tr_b16 a[204:205], v223 offset:40960
ds_read_b64_tr_b16 a[206:207], v223 offset:45056
v_mfma_f32_16x16x32_bf16 v[152:155], a[208:211], a[64:67], v[152:155]
s_waitcnt lgkmcnt(10)
buffer_load_dwordx4 v236, s[16:19], s48 offen lds
v_mfma_f32_16x16x32_bf16 v[184:187], a[208:211], a[68:71], v[184:187]
s_add_u32 m0, s3, 8192
ds_read_b64_tr_b16 a[208:209], v224 offset:40960
ds_read_b64_tr_b16 a[210:211], v224 offset:45056
v_mfma_f32_16x16x32_bf16 v[156:159], a[212:215], a[64:67], v[156:159]
s_add_u32 s48, s43, 184320
v_mfma_f32_16x16x32_bf16 v[188:191], a[212:215], a[68:71], v[188:191]
buffer_load_dwordx4 v236, s[16:19], s48 offen lds
v_mfma_f32_16x16x32_bf16 v[160:163], a[216:219], a[64:67], v[160:163]
ds_read_b64_tr_b16 a[212:213], v225 offset:40960
ds_read_b64_tr_b16 a[214:215], v225 offset:45056
v_mfma_f32_16x16x32_bf16 v[192:195], a[216:219], a[68:71], v[192:195]
s_waitcnt lgkmcnt(8)
ds_read_b64_tr_b16 a[216:217], v226 offset:40960
ds_read_b64_tr_b16 a[218:219], v226 offset:45056
v_mfma_f32_16x16x32_bf16 v[164:167], a[220:223], a[64:67], v[164:167]
v_mfma_f32_16x16x32_bf16 v[196:199], a[220:223], a[68:71], v[196:199]
ds_read_b64_tr_b16 a[220:221], v227 offset:40960
ds_read_b64_tr_b16 a[222:223], v227 offset:45056
v_mfma_f32_16x16x32_bf16 v[136:139], a[192:195], a[72:75], v[136:139]
s_add_u32 m0, s3, 12288
v_mfma_f32_16x16x32_bf16 v[168:171], a[192:195], a[76:79], v[168:171]
s_add_u32 s48, s43, 202752
ds_read_b64_tr_b16 a[192:193], v220 offset:49152
ds_read_b64_tr_b16 a[194:195], v220 offset:53248
v_mfma_f32_16x16x32_bf16 v[140:143], a[196:199], a[72:75], v[140:143]
s_waitcnt lgkmcnt(10)
buffer_load_dwordx4 v236, s[16:19], s48 offen lds
v_mfma_f32_16x16x32_bf16 v[172:175], a[196:199], a[76:79], v[172:175]
s_add_u32 m0, s3, 16384
ds_read_b64_tr_b16 a[196:197], v221 offset:49152
ds_read_b64_tr_b16 a[198:199], v221 offset:53248
v_mfma_f32_16x16x32_bf16 v[144:147], a[200:203], a[72:75], v[144:147]
s_add_u32 s48, s43, 221184
v_mfma_f32_16x16x32_bf16 v[176:179], a[200:203], a[76:79], v[176:179]
buffer_load_dwordx4 v236, s[16:19], s48 offen lds
v_mfma_f32_16x16x32_bf16 v[148:151], a[204:207], a[72:75], v[148:151]
s_add_u32 m0, s3, 20480
ds_read_b64_tr_b16 a[200:201], v222 offset:49152
ds_read_b64_tr_b16 a[202:203], v222 offset:53248
v_mfma_f32_16x16x32_bf16 v[180:183], a[204:207], a[76:79], v[180:183]
s_waitcnt lgkmcnt(8)
s_add_u32 s48, s43, 239616
ds_read_b64_tr_b16 a[204:205], v223 offset:49152
ds_read_b64_tr_b16 a[206:207], v223 offset:53248
v_mfma_f32_16x16x32_bf16 v[152:155], a[208:211], a[72:75], v[152:155]
buffer_load_dwordx4 v236, s[16:19], s48 offen lds
v_mfma_f32_16x16x32_bf16 v[184:187], a[208:211], a[76:79], v[184:187]
ds_read_b64_tr_b16 a[208:209], v224 offset:49152
ds_read_b64_tr_b16 a[210:211], v224 offset:53248
v_mfma_f32_16x16x32_bf16 v[156:159], a[212:215], a[72:75], v[156:159]
s_add_u32 m0, s3, 24576
v_mfma_f32_16x16x32_bf16 v[188:191], a[212:215], a[76:79], v[188:191]
s_add_u32 s48, s43, 258048
ds_read_b64_tr_b16 a[212:213], v225 offset:49152
ds_read_b64_tr_b16 a[214:215], v225 offset:53248
v_mfma_f32_16x16x32_bf16 v[160:163], a[216:219], a[72:75], v[160:163]
buffer_load_dwordx4 v236, s[16:19], s48 offen lds
v_mfma_f32_16x16x32_bf16 v[192:195], a[216:219], a[76:79], v[192:195]
s_waitcnt lgkmcnt(8)
ds_read_b64_tr_b16 a[216:217], v226 offset:49152
ds_read_b64_tr_b16 a[218:219], v226 offset:53248
v_mfma_f32_16x16x32_bf16 v[164:167], a[220:223], a[72:75], v[164:167]
v_mfma_f32_16x16x32_bf16 v[196:199], a[220:223], a[76:79], v[196:199]
ds_read_b64_tr_b16 a[220:221], v227 offset:49152
ds_read_b64_tr_b16 a[222:223], v227 offset:53248
v_mfma_f32_16x16x32_bf16 v[136:139], a[192:195], a[80:83], v[136:139]
s_add_u32 m0, s3, 28672
v_mfma_f32_16x16x32_bf16 v[168:171], a[192:195], a[84:87], v[168:171]
s_add_u32 s48, s43, 276480
ds_read_b64_tr_b16 a[192:193], v220 offset:57344
ds_read_b64_tr_b16 a[194:195], v220 offset:61440
v_mfma_f32_16x16x32_bf16 v[140:143], a[196:199], a[80:83], v[140:143]
buffer_load_dwordx4 v236, s[16:19], s48 offen lds
v_mfma_f32_16x16x32_bf16 v[172:175], a[196:199], a[84:87], v[172:175]
s_waitcnt lgkmcnt(8)
ds_read_b64_tr_b16 a[196:197], v221 offset:57344
ds_read_b64_tr_b16 a[198:199], v221 offset:61440
v_mfma_f32_16x16x32_bf16 v[144:147], a[200:203], a[80:83], v[144:147]
s_add_u32 s94, s88, 0
v_mfma_f32_16x16x32_bf16 v[176:179], a[200:203], a[84:87], v[176:179]
buffer_store_dwordx2 v[72:73], v250, s[20:23], s94 offen sc0 sc1
v_mfma_f32_16x16x32_bf16 v[148:151], a[204:207], a[80:83], v[148:151]
ds_read_b64_tr_b16 a[200:201], v222 offset:57344
ds_read_b64_tr_b16 a[202:203], v222 offset:61440
v_mfma_f32_16x16x32_bf16 v[180:183], a[204:207], a[84:87], v[180:183]
ds_read_b64_tr_b16 a[204:205], v223 offset:57344
ds_read_b64_tr_b16 a[206:207], v223 offset:61440
v_mfma_f32_16x16x32_bf16 v[152:155], a[208:211], a[80:83], v[152:155]
s_waitcnt lgkmcnt(10)
v_mfma_f32_16x16x32_bf16 v[184:187], a[208:211], a[84:87], v[184:187]
s_add_u32 s94, s88, 8192
ds_read_b64_tr_b16 a[208:209], v224 offset:57344
ds_read_b64_tr_b16 a[210:211], v224 offset:61440
v_mfma_f32_16x16x32_bf16 v[156:159], a[212:215], a[80:83], v[156:159]
buffer_store_dwordx2 v[76:77], v250, s[20:23], s94 offen sc0 sc1
v_mfma_f32_16x16x32_bf16 v[188:191], a[212:215], a[84:87], v[188:191]
ds_read_b64_tr_b16 a[212:213], v225 offset:57344
ds_read_b64_tr_b16 a[214:215], v225 offset:61440
v_mfma_f32_16x16x32_bf16 v[160:163], a[216:219], a[80:83], v[160:163]
s_waitcnt lgkmcnt(10)
v_mfma_f32_16x16x32_bf16 v[192:195], a[216:219], a[84:87], v[192:195]
s_add_u32 s94, s88, 16384
ds_read_b64_tr_b16 a[216:217], v226 offset:57344
ds_read_b64_tr_b16 a[218:219], v226 offset:61440
v_mfma_f32_16x16x32_bf16 v[164:167], a[220:223], a[80:83], v[164:167]
buffer_store_dwordx2 v[80:81], v250, s[20:23], s94 offen sc0 sc1
v_mfma_f32_16x16x32_bf16 v[196:199], a[220:223], a[84:87], v[196:199]
ds_read_b64_tr_b16 a[220:221], v227 offset:57344
ds_read_b64_tr_b16 a[222:223], v227 offset:61440
v_mfma_f32_16x16x32_bf16 v[136:139], a[192:195], a[88:91], v[136:139]
v_mfma_f32_16x16x32_bf16 v[168:171], a[192:195], a[92:95], v[168:171]
s_waitcnt lgkmcnt(8)
v_mfma_f32_16x16x32_bf16 v[140:143], a[196:199], a[88:91], v[140:143]
v_mfma_f32_16x16x32_bf16 v[172:175], a[196:199], a[92:95], v[172:175]
v_mfma_f32_16x16x32_bf16 v[144:147], a[200:203], a[88:91], v[144:147]
s_waitcnt vmcnt(19) lgkmcnt(0)
s_barrier
v_mfma_f32_16x16x32_bf16 v[176:179], a[200:203], a[92:95], v[176:179]
ds_read_b64_tr_b16 a[192:193], v208 offset:0
ds_read_b64_tr_b16 a[194:195], v208 offset:4096
v_mfma_f32_16x16x32_bf16 v[148:151], a[204:207], a[88:91], v[148:151]
s_add_u32 s94, s88, 24576
ds_read_b64_tr_b16 a[196:197], v209 offset:0
ds_read_b64_tr_b16 a[198:199], v209 offset:4096
v_mfma_f32_16x16x32_bf16 v[180:183], a[204:207], a[92:95], v[180:183]
buffer_store_dwordx2 v[84:85], v250, s[20:23], s94 offen sc0 sc1
v_mfma_f32_16x16x32_bf16 v[152:155], a[208:211], a[88:91], v[152:155]
ds_read_b64_tr_b16 a[200:201], v210 offset:0
ds_read_b64_tr_b16 a[202:203], v210 offset:4096
v_mfma_f32_16x16x32_bf16 v[184:187], a[208:211], a[92:95], v[184:187]
ds_read_b64_tr_b16 a[204:205], v211 offset:0
ds_read_b64_tr_b16 a[206:207], v211 offset:4096
v_mfma_f32_16x16x32_bf16 v[156:159], a[212:215], a[88:91], v[156:159]
s_add_u32 s94, s89, 0
ds_read_b64_tr_b16 a[208:209], v212 offset:0
ds_read_b64_tr_b16 a[210:211], v212 offset:4096
v_mfma_f32_16x16x32_bf16 v[188:191], a[212:215], a[92:95], v[188:191]
buffer_store_dwordx2 v[88:89], v250, s[20:23], s94 offen sc0 sc1
v_mfma_f32_16x16x32_bf16 v[160:163], a[216:219], a[88:91], v[160:163]
ds_read_b64_tr_b16 a[212:213], v213 offset:0
ds_read_b64_tr_b16 a[214:215], v213 offset:4096
v_mfma_f32_16x16x32_bf16 v[192:195], a[216:219], a[92:95], v[192:195]
ds_read_b64_tr_b16 a[216:217], v214 offset:0
ds_read_b64_tr_b16 a[218:219], v214 offset:4096
v_mfma_f32_16x16x32_bf16 v[164:167], a[220:223], a[88:91], v[164:167]
v_mfma_f32_16x16x32_bf16 v[196:199], a[220:223], a[92:95], v[196:199]
s_waitcnt lgkmcnt(12)
ds_read_b64_tr_b16 a[220:221], v215 offset:0
ds_read_b64_tr_b16 a[222:223], v215 offset:4096
s_waitcnt vmcnt(13)
v_mfma_f32_16x16x32_bf16 v[136:139], a[192:195], a[96:99], v[136:139]
s_add_u32 s94, s89, 8192
v_mfma_f32_16x16x32_bf16 v[168:171], a[192:195], a[100:103], v[168:171]
s_waitcnt lgkmcnt(12)
buffer_store_dwordx2 v[92:93], v250, s[20:23], s94 offen sc0 sc1
v_mfma_f32_16x16x32_bf16 v[140:143], a[196:199], a[96:99], v[140:143]
ds_read_b64_tr_b16 a[192:193], v208 offset:8192
ds_read_b64_tr_b16 a[194:195], v208 offset:12288
v_mfma_f32_16x16x32_bf16 v[172:175], a[196:199], a[100:103], v[172:175]
s_waitcnt lgkmcnt(10)
ds_read_b64_tr_b16 a[196:197], v209 offset:8192
ds_read_b64_tr_b16 a[198:199], v209 offset:12288
v_mfma_f32_16x16x32_bf16 v[144:147], a[200:203], a[96:99], v[144:147]
s_add_u32 s94, s89, 16384
v_mfma_f32_16x16x32_bf16 v[176:179], a[200:203], a[100:103], v[176:179]
buffer_store_dwordx2 v[96:97], v250, s[20:23], s94 offen sc0 sc1
v_mfma_f32_16x16x32_bf16 v[148:151], a[204:207], a[96:99], v[148:151]
ds_read_b64_tr_b16 a[200:201], v210 offset:8192
ds_read_b64_tr_b16 a[202:203], v210 offset:12288
v_mfma_f32_16x16x32_bf16 v[180:183], a[204:207], a[100:103], v[180:183]
s_waitcnt lgkmcnt(8)
ds_read_b64_tr_b16 a[204:205], v211 offset:8192
ds_read_b64_tr_b16 a[206:207], v211 offset:12288
v_mfma_f32_16x16x32_bf16 v[152:155], a[208:211], a[96:99], v[152:155]
s_add_u32 s94, s89, 24576
v_mfma_f32_16x16x32_bf16 v[184:187], a[208:211], a[100:103], v[184:187]
buffer_store_dwordx2 v[100:101], v250, s[20:23], s94 offen sc0 sc1
v_mfma_f32_16x16x32_bf16 v[156:159], a[212:215], a[96:99], v[156:159]
ds_read_b64_tr_b16 a[208:209], v212 offset:8192
ds_read_b64_tr_b16 a[210:211], v212 offset:12288
v_mfma_f32_16x16x32_bf16 v[188:191], a[212:215], a[100:103], v[188:191]
ds_read_b64_tr_b16 a[212:213], v213 offset:8192
ds_read_b64_tr_b16 a[214:215], v213 offset:12288
v_mfma_f32_16x16x32_bf16 v[160:163], a[216:219], a[96:99], v[160:163]
s_add_u32 s94, s91, 8192
v_mfma_f32_16x16x32_bf16 v[192:195], a[216:219], a[100:103], v[192:195]
s_waitcnt lgkmcnt(8)
buffer_load_dwordx4 a[128:131], v234, s[20:23], s94 offen offset:0 sc0 sc1
v_mfma_f32_16x16x32_bf16 v[164:167], a[220:223], a[96:99], v[164:167]
ds_read_b64_tr_b16 a[216:217], v214 offset:8192
ds_read_b64_tr_b16 a[218:219], v214 offset:12288
v_mfma_f32_16x16x32_bf16 v[196:199], a[220:223], a[100:103], v[196:199]
ds_read_b64_tr_b16 a[220:221], v215 offset:8192
ds_read_b64_tr_b16 a[222:223], v215 offset:12288
v_mfma_f32_16x16x32_bf16 v[136:139], a[192:195], a[104:107], v[136:139]
s_add_u32 s94, s91, 8192
v_mfma_f32_16x16x32_bf16 v[168:171], a[192:195], a[108:111], v[168:171]
buffer_load_dwordx4 a[132:135], v234, s[20:23], s94 offen offset:1024 sc0 sc1
v_mfma_f32_16x16x32_bf16 v[140:143], a[196:199], a[104:107], v[140:143]
s_waitcnt lgkmcnt(8)
ds_read_b64_tr_b16 a[192:193], v208 offset:16384
ds_read_b64_tr_b16 a[194:195], v208 offset:20480
v_mfma_f32_16x16x32_bf16 v[172:175], a[196:199], a[108:111], v[172:175]
s_add_u32 s94, s91, 8192
ds_read_b64_tr_b16 a[196:197], v209 offset:16384
ds_read_b64_tr_b16 a[198:199], v209 offset:20480
v_mfma_f32_16x16x32_bf16 v[144:147], a[200:203], a[104:107], v[144:147]
buffer_load_dwordx4 a[136:139], v234, s[20:23], s94 offen offset:2048 sc0 sc1
v_mfma_f32_16x16x32_bf16 v[176:179], a[200:203], a[108:111], v[176:179]
s_add_u32 s94, s91, 8192
ds_read_b64_tr_b16 a[200:201], v210 offset:16384
ds_read_b64_tr_b16 a[202:203], v210 offset:20480
v_mfma_f32_16x16x32_bf16 v[148:151], a[204:207], a[104:107], v[148:151]
s_waitcnt lgkmcnt(10)
buffer_load_dwordx4 a[140:143], v234, s[20:23], s94 offen offset:3072 sc0 sc1
v_mfma_f32_16x16x32_bf16 v[180:183], a[204:207], a[108:111], v[180:183]
s_add_u32 s94, s91, 12288
ds_read_b64_tr_b16 a[204:205], v211 offset:16384
ds_read_b64_tr_b16 a[206:207], v211 offset:20480
v_mfma_f32_16x16x32_bf16 v[152:155], a[208:211], a[104:107], v[152:155]
buffer_load_dwordx4 a[144:147], v234, s[20:23], s94 offen offset:0 sc0 sc1
v_mfma_f32_16x16x32_bf16 v[184:187], a[208:211], a[108:111], v[184:187]
ds_read_b64_tr_b16 a[208:209], v212 offset:16384
ds_read_b64_tr_b16 a[210:211], v212 offset:20480
v_mfma_f32_16x16x32_bf16 v[156:159], a[212:215], a[104:107], v[156:159]
s_add_u32 s94, s91, 12288
v_mfma_f32_16x16x32_bf16 v[188:191], a[212:215], a[108:111], v[188:191]
s_waitcnt lgkmcnt(10)
buffer_load_dwordx4 a[148:151], v234, s[20:23], s94 offen offset:1024 sc0 sc1
v_mfma_f32_16x16x32_bf16 v[160:163], a[216:219], a[104:107], v[160:163]
s_add_u32 s94, s91, 12288
ds_read_b64_tr_b16 a[212:213], v213 offset:16384
ds_read_b64_tr_b16 a[214:215], v213 offset:20480
v_mfma_f32_16x16x32_bf16 v[192:195], a[216:219], a[108:111], v[192:195]
buffer_load_dwordx4 a[152:155], v234, s[20:23], s94 offen offset:2048 sc0 sc1
v_mfma_f32_16x16x32_bf16 v[164:167], a[220:223], a[104:107], v[164:167]
ds_read_b64_tr_b16 a[216:217], v214 offset:16384
ds_read_b64_tr_b16 a[218:219], v214 offset:20480
v_mfma_f32_16x16x32_bf16 v[196:199], a[220:223], a[108:111], v[196:199]
s_waitcnt lgkmcnt(8)
ds_read_b64_tr_b16 a[220:221], v215 offset:16384
ds_read_b64_tr_b16 a[222:223], v215 offset:20480
v_mfma_f32_16x16x32_bf16 v[136:139], a[192:195], a[112:115], v[136:139]
s_add_u32 s94, s91, 12288
v_mfma_f32_16x16x32_bf16 v[168:171], a[192:195], a[116:119], v[168:171]
buffer_load_dwordx4 a[156:159], v234, s[20:23], s94 offen offset:3072 sc0 sc1
v_mfma_f32_16x16x32_bf16 v[140:143], a[196:199], a[112:115], v[140:143]
ds_read_b64_tr_b16 a[192:193], v208 offset:24576
ds_read_b64_tr_b16 a[194:195], v208 offset:28672
v_mfma_f32_16x16x32_bf16 v[172:175], a[196:199], a[116:119], v[172:175]
s_add_u32 m0, s3, 32768
ds_read_b64_tr_b16 a[196:197], v209 offset:24576
ds_read_b64_tr_b16 a[198:199], v209 offset:28672
v_mfma_f32_16x16x32_bf16 v[144:147], a[200:203], a[112:115], v[144:147]
s_add_u32 s48, s44, 147456
v_mfma_f32_16x16x32_bf16 v[176:179], a[200:203], a[116:119], v[176:179]
s_waitcnt lgkmcnt(10)
buffer_load_dwordx4 v236, s[16:19], s48 offen lds
v_mfma_f32_16x16x32_bf16 v[148:151], a[204:207], a[112:115], v[148:151]
ds_read_b64_tr_b16 a[200:201], v210 offset:24576
ds_read_b64_tr_b16 a[202:203], v210 offset:28672
v_mfma_f32_16x16x32_bf16 v[180:183], a[204:207], a[116:119], v[180:183]
s_add_u32 m0, s3, 36864
ds_read_b64_tr_b16 a[204:205], v211 offset:24576
ds_read_b64_tr_b16 a[206:207], v211 offset:28672
v_mfma_f32_16x16x32_bf16 v[152:155], a[208:211], a[112:115], v[152:155]
s_add_u32 s48, s44, 165888
v_mfma_f32_16x16x32_bf16 v[184:187], a[208:211], a[116:119], v[184:187]
s_waitcnt lgkmcnt(8)
buffer_load_dwordx4 v236, s[16:19], s48 offen lds
v_mfma_f32_16x16x32_bf16 v[156:159], a[212:215], a[112:115], v[156:159]
ds_read_b64_tr_b16 a[208:209], v212 offset:24576
ds_read_b64_tr_b16 a[210:211], v212 offset:28672
v_mfma_f32_16x16x32_bf16 v[188:191], a[212:215], a[116:119], v[188:191]
s_add_u32 m0, s3, 40960
ds_read_b64_tr_b16 a[212:213], v213 offset:24576
ds_read_b64_tr_b16 a[214:215], v213 offset:28672
v_mfma_f32_16x16x32_bf16 v[160:163], a[216:219], a[112:115], v[160:163]
s_add_u32 s48, s44, 184320
v_mfma_f32_16x16x32_bf16 v[192:195], a[216:219], a[116:119], v[192:195]
buffer_load_dwordx4 v236, s[16:19], s48 offen lds
v_mfma_f32_16x16x32_bf16 v[164:167], a[220:223], a[112:115], v[164:167]
ds_read_b64_tr_b16 a[216:217], v214 offset:24576
ds_read_b64_tr_b16 a[218:219], v214 offset:28672
v_mfma_f32_16x16x32_bf16 v[196:199], a[220:223], a[116:119], v[196:199]
s_waitcnt lgkmcnt(10)
ds_read_b64_tr_b16 a[220:221], v215 offset:24576
ds_read_b64_tr_b16 a[222:223], v215 offset:28672
v_mfma_f32_16x16x32_bf16 v[136:139], a[192:195], a[120:123], v[136:139]
v_mfma_f32_16x16x32_bf16 v[168:171], a[192:195], a[124:127], v[168:171]
v_mfma_f32_16x16x32_bf16 v[140:143], a[196:199], a[120:123], v[140:143]
v_mfma_f32_16x16x32_bf16 v[172:175], a[196:199], a[124:127], v[172:175]
s_waitcnt lgkmcnt(8)
v_mfma_f32_16x16x32_bf16 v[144:147], a[200:203], a[120:123], v[144:147]
s_waitcnt vmcnt(19) lgkmcnt(0)
s_barrier
v_mfma_f32_16x16x32_bf16 v[176:179], a[200:203], a[124:127], v[176:179]
s_add_u32 m0, s3, 45056
ds_read_b64_tr_b16 a[192:193], v200 offset:0
ds_read_b64_tr_b16 a[194:195], v200 offset:4096
v_mfma_f32_16x16x32_bf16 v[148:151], a[204:207], a[120:123], v[148:151]
s_add_u32 s48, s44, 202752
ds_read_b64_tr_b16 a[196:197], v201 offset:0
ds_read_b64_tr_b16 a[198:199], v201 offset:4096
v_mfma_f32_16x16x32_bf16 v[180:183], a[204:207], a[124:127], v[180:183]
buffer_load_dwordx4 v236, s[16:19], s48 offen lds
v_mfma_f32_16x16x32_bf16 v[152:155], a[208:211], a[120:123], v[152:155]
s_add_u32 m0, s3, 49152
ds_read_b64_tr_b16 a[200:201], v202 offset:0
ds_read_b64_tr_b16 a[202:203], v202 offset:4096
v_mfma_f32_16x16x32_bf16 v[184:187], a[208:211], a[124:127], v[184:187]
s_add_u32 s48, s44, 221184
ds_read_b64_tr_b16 a[204:205], v203 offset:0
ds_read_b64_tr_b16 a[206:207], v203 offset:4096
v_mfma_f32_16x16x32_bf16 v[156:159], a[212:215], a[120:123], v[156:159]
buffer_load_dwordx4 v236, s[16:19], s48 offen lds
v_mfma_f32_16x16x32_bf16 v[188:191], a[212:215], a[124:127], v[188:191]
ds_read_b64_tr_b16 a[208:209], v204 offset:0
ds_read_b64_tr_b16 a[210:211], v204 offset:4096
v_mfma_f32_16x16x32_bf16 v[160:163], a[216:219], a[120:123], v[160:163]
s_add_u32 m0, s3, 53248
ds_read_b64_tr_b16 a[212:213], v205 offset:0
ds_read_b64_tr_b16 a[214:215], v205 offset:4096
v_mfma_f32_16x16x32_bf16 v[192:195], a[216:219], a[124:127], v[192:195]
s_add_u32 s48, s44, 239616
ds_read_b64_tr_b16 a[216:217], v206 offset:0
ds_read_b64_tr_b16 a[218:219], v206 offset:4096
v_mfma_f32_16x16x32_bf16 v[164:167], a[220:223], a[120:123], v[164:167]
buffer_load_dwordx4 v236, s[16:19], s48 offen lds
v_mfma_f32_16x16x32_bf16 v[196:199], a[220:223], a[124:127], v[196:199]
s_waitcnt lgkmcnt(12)
ds_read_b64_tr_b16 a[220:221], v207 offset:0
ds_read_b64_tr_b16 a[222:223], v207 offset:4096
s_waitcnt vmcnt(6)
s_waitcnt vmcnt(14)
s_lshl_b32 s46, s33, 2
s_add_u32 s46, s46, s86
s_mov_b64 exec, 1
buffer_store_dword v5, v234, s[20:23], s46 offen sc0 sc1
s_mov_b64 exec, -1
v_mfma_f32_16x16x32_bf16 v[136:139], a[192:195], a[128:131], v[136:139]
s_add_u32 m0, s3, 57344
v_mfma_f32_16x16x32_bf16 v[168:171], a[192:195], a[132:135], v[168:171]
s_waitcnt lgkmcnt(12)
s_add_u32 s48, s44, 258048
ds_read_b64_tr_b16 a[192:193], v200 offset:8192
ds_read_b64_tr_b16 a[194:195], v200 offset:12288
v_mfma_f32_16x16x32_bf16 v[140:143], a[196:199], a[128:131], v[140:143]
s_waitcnt lgkmcnt(12)
buffer_load_dwordx4 v236, s[16:19], s48 offen lds
v_mfma_f32_16x16x32_bf16 v[172:175], a[196:199], a[132:135], v[172:175]
s_add_u32 m0, s3, 61440
ds_read_b64_tr_b16 a[196:197], v201 offset:8192
ds_read_b64_tr_b16 a[198:199], v201 offset:12288
v_mfma_f32_16x16x32_bf16 v[144:147], a[200:203], a[128:131], v[144:147]
s_add_u32 s48, s44, 276480
v_mfma_f32_16x16x32_bf16 v[176:179], a[200:203], a[132:135], v[176:179]
s_waitcnt lgkmcnt(10)
buffer_load_dwordx4 v236, s[16:19], s48 offen lds
v_mfma_f32_16x16x32_bf16 v[148:151], a[204:207], a[128:131], v[148:151]
ds_read_b64_tr_b16 a[200:201], v202 offset:8192
ds_read_b64_tr_b16 a[202:203], v202 offset:12288
v_mfma_f32_16x16x32_bf16 v[180:183], a[204:207], a[132:135], v[180:183]
s_add_u32 s94, s92, 8192
ds_read_b64_tr_b16 a[204:205], v203 offset:8192
ds_read_b64_tr_b16 a[206:207], v203 offset:12288
v_mfma_f32_16x16x32_bf16 v[152:155], a[208:211], a[128:131], v[152:155]
buffer_load_dwordx4 a[160:163], v234, s[20:23], s94 offen offset:0 sc0 sc1
v_mfma_f32_16x16x32_bf16 v[184:187], a[208:211], a[132:135], v[184:187]
s_waitcnt lgkmcnt(8)
ds_read_b64_tr_b16 a[208:209], v204 offset:8192
ds_read_b64_tr_b16 a[210:211], v204 offset:12288
v_mfma_f32_16x16x32_bf16 v[156:159], a[212:215], a[128:131], v[156:159]
s_add_u32 s94, s92, 8192
v_mfma_f32_16x16x32_bf16 v[188:191], a[212:215], a[132:135], v[188:191]
buffer_load_dwordx4 a[164:167], v234, s[20:23], s94 offen offset:1024 sc0 sc1
v_mfma_f32_16x16x32_bf16 v[160:163], a[216:219], a[128:131], v[160:163]
ds_read_b64_tr_b16 a[212:213], v205 offset:8192
ds_read_b64_tr_b16 a[214:215], v205 offset:12288
v_mfma_f32_16x16x32_bf16 v[192:195], a[216:219], a[132:135], v[192:195]
ds_read_b64_tr_b16 a[216:217], v206 offset:8192
ds_read_b64_tr_b16 a[218:219], v206 offset:12288
v_mfma_f32_16x16x32_bf16 v[164:167], a[220:223], a[128:131], v[164:167]
v_mfma_f32_16x16x32_bf16 v[196:199], a[220:223], a[132:135], v[196:199]
s_waitcnt lgkmcnt(10)
ds_read_b64_tr_b16 a[220:221], v207 offset:8192
ds_read_b64_tr_b16 a[222:223], v207 offset:12288
v_mfma_f32_16x16x32_bf16 v[136:139], a[192:195], a[136:139], v[136:139]
s_add_u32 s94, s92, 8192
v_mfma_f32_16x16x32_bf16 v[168:171], a[192:195], a[140:143], v[168:171]
buffer_load_dwordx4 a[168:171], v234, s[20:23], s94 offen offset:2048 sc0 sc1
v_mfma_f32_16x16x32_bf16 v[140:143], a[196:199], a[136:139], v[140:143]
s_add_u32 s94, s92, 8192
ds_read_b64_tr_b16 a[192:193], v200 offset:16384
ds_read_b64_tr_b16 a[194:195], v200 offset:20480
v_mfma_f32_16x16x32_bf16 v[172:175], a[196:199], a[140:143], v[172:175]
s_waitcnt lgkmcnt(8)
buffer_load_dwordx4 a[172:175], v234, s[20:23], s94 offen offset:3072 sc0 sc1
v_mfma_f32_16x16x32_bf16 v[144:147], a[200:203], a[136:139], v[144:147]
ds_read_b64_tr_b16 a[196:197], v201 offset:16384
ds_read_b64_tr_b16 a[198:199], v201 offset:20480
v_mfma_f32_16x16x32_bf16 v[176:179], a[200:203], a[140:143], v[176:179]
s_add_u32 s94, s92, 12288
ds_read_b64_tr_b16 a[200:201], v202 offset:16384
ds_read_b64_tr_b16 a[202:203], v202 offset:20480
v_mfma_f32_16x16x32_bf16 v[148:151], a[204:207], a[136:139], v[148:151]
buffer_load_dwordx4 a[176:179], v234, s[20:23], s94 offen offset:0 sc0 sc1
v_mfma_f32_16x16x32_bf16 v[180:183], a[204:207], a[140:143], v[180:183]
ds_read_b64_tr_b16 a[204:205], v203 offset:16384
ds_read_b64_tr_b16 a[206:207], v203 offset:20480
v_mfma_f32_16x16x32_bf16 v[152:155], a[208:211], a[136:139], v[152:155]
s_add_u32 s94, s92, 12288
v_mfma_f32_16x16x32_bf16 v[184:187], a[208:211], a[140:143], v[184:187]
s_waitcnt lgkmcnt(8)
buffer_load_dwordx4 a[180:183], v234, s[20:23], s94 offen offset:1024 sc0 sc1
v_mfma_f32_16x16x32_bf16 v[156:159], a[212:215], a[136:139], v[156:159]
ds_read_b64_tr_b16 a[208:209], v204 offset:16384
ds_read_b64_tr_b16 a[210:211], v204 offset:20480
v_mfma_f32_16x16x32_bf16 v[188:191], a[212:215], a[140:143], v[188:191]
s_add_u32 s94, s92, 12288
ds_read_b64_tr_b16 a[212:213], v205 offset:16384
ds_read_b64_tr_b16 a[214:215], v205 offset:20480
v_mfma_f32_16x16x32_bf16 v[160:163], a[216:219], a[136:139], v[160:163]
buffer_load_dwordx4 a[184:187], v234, s[20:23], s94 offen offset:2048 sc0 sc1
v_mfma_f32_16x16x32_bf16 v[192:195], a[216:219], a[140:143], v[192:195]
ds_read_b64_tr_b16 a[216:217], v206 offset:16384
ds_read_b64_tr_b16 a[218:219], v206 offset:20480
v_mfma_f32_16x16x32_bf16 v[164:167], a[220:223], a[136:139], v[164:167]
v_mfma_f32_16x16x32_bf16 v[196:199], a[220:223], a[140:143], v[196:199]
s_waitcnt lgkmcnt(8)
ds_read_b64_tr_b16 a[220:221], v207 offset:16384
ds_read_b64_tr_b16 a[222:223], v207 offset:20480
v_mfma_f32_16x16x32_bf16 v[136:139], a[192:195], a[144:147], v[136:139]
s_add_u32 s94, s92, 12288
v_mfma_f32_16x16x32_bf16 v[168:171], a[192:195], a[148:151], v[168:171]
buffer_load_dwordx4 a[188:191], v234, s[20:23], s94 offen offset:3072 sc0 sc1
v_mfma_f32_16x16x32_bf16 v[140:143], a[196:199], a[144:147], v[140:143]
ds_read_b64_tr_b16 a[192:193], v200 offset:24576
ds_read_b64_tr_b16 a[194:195], v200 offset:28672
v_mfma_f32_16x16x32_bf16 v[172:175], a[196:199], a[148:151], v[172:175]
ds_read_b64_tr_b16 a[196:197], v201 offset:24576
ds_read_b64_tr_b16 a[198:199], v201 offset:28672
v_mfma_f32_16x16x32_bf16 v[144:147], a[200:203], a[144:147], v[144:147]
v_mfma_f32_16x16x32_bf16 v[176:179], a[200:203], a[148:151], v[176:179]
s_waitcnt lgkmcnt(8)
ds_read_b64_tr_b16 a[200:201], v202 offset:24576
ds_read_b64_tr_b16 a[202:203], v202 offset:28672
v_mfma_f32_16x16x32_bf16 v[148:151], a[204:207], a[144:147], v[148:151]
v_mfma_f32_16x16x32_bf16 v[180:183], a[204:207], a[148:151], v[180:183]
ds_read_b64_tr_b16 a[204:205], v203 offset:24576
ds_read_b64_tr_b16 a[206:207], v203 offset:28672
v_mfma_f32_16x16x32_bf16 v[152:155], a[208:211], a[144:147], v[152:155]
v_mfma_f32_16x16x32_bf16 v[184:187], a[208:211], a[148:151], v[184:187]
ds_read_b64_tr_b16 a[208:209], v204 offset:24576
ds_read_b64_tr_b16 a[210:211], v204 offset:28672
v_mfma_f32_16x16x32_bf16 v[156:159], a[212:215], a[144:147], v[156:159]
v_mfma_f32_16x16x32_bf16 v[188:191], a[212:215], a[148:151], v[188:191]
s_waitcnt lgkmcnt(10)
ds_read_b64_tr_b16 a[212:213], v205 offset:24576
ds_read_b64_tr_b16 a[214:215], v205 offset:28672
v_mfma_f32_16x16x32_bf16 v[160:163], a[216:219], a[144:147], v[160:163]
v_mfma_f32_16x16x32_bf16 v[192:195], a[216:219], a[148:151], v[192:195]
ds_read_b64_tr_b16 a[216:217], v206 offset:24576
ds_read_b64_tr_b16 a[218:219], v206 offset:28672
v_mfma_f32_16x16x32_bf16 v[164:167], a[220:223], a[144:147], v[164:167]
v_mfma_f32_16x16x32_bf16 v[196:199], a[220:223], a[148:151], v[196:199]
s_waitcnt lgkmcnt(8)
ds_read_b64_tr_b16 a[220:221], v207 offset:24576
ds_read_b64_tr_b16 a[222:223], v207 offset:28672
v_mfma_f32_16x16x32_bf16 v[136:139], a[192:195], a[152:155], v[136:139]
v_mfma_f32_16x16x32_bf16 v[168:171], a[192:195], a[156:159], v[168:171]
v_mfma_f32_16x16x32_bf16 v[140:143], a[196:199], a[152:155], v[140:143]
v_mfma_f32_16x16x32_bf16 v[172:175], a[196:199], a[156:159], v[172:175]
v_mfma_f32_16x16x32_bf16 v[144:147], a[200:203], a[152:155], v[144:147]
s_waitcnt vmcnt(8) lgkmcnt(0)
s_barrier
v_mfma_f32_16x16x32_bf16 v[176:179], a[200:203], a[156:159], v[176:179]
ds_read_b64_tr_b16 a[192:193], v200 offset:32768
ds_read_b64_tr_b16 a[194:195], v200 offset:36864
v_mfma_f32_16x16x32_bf16 v[148:151], a[204:207], a[152:155], v[148:151]
ds_read_b64_tr_b16 a[196:197], v201 offset:32768
ds_read_b64_tr_b16 a[198:199], v201 offset:36864
v_mfma_f32_16x16x32_bf16 v[180:183], a[204:207], a[156:159], v[180:183]
ds_read_b64_tr_b16 a[200:201], v202 offset:32768
ds_read_b64_tr_b16 a[202:203], v202 offset:36864
v_mfma_f32_16x16x32_bf16 v[152:155], a[208:211], a[152:155], v[152:155]
ds_read_b64_tr_b16 a[204:205], v203 offset:32768
ds_read_b64_tr_b16 a[206:207], v203 offset:36864
v_mfma_f32_16x16x32_bf16 v[184:187], a[208:211], a[156:159], v[184:187]
ds_read_b64_tr_b16 a[208:209], v204 offset:32768
ds_read_b64_tr_b16 a[210:211], v204 offset:36864
v_mfma_f32_16x16x32_bf16 v[156:159], a[212:215], a[152:155], v[156:159]
v_mfma_f32_16x16x32_bf16 v[188:191], a[212:215], a[156:159], v[188:191]
ds_read_b64_tr_b16 a[212:213], v205 offset:32768
ds_read_b64_tr_b16 a[214:215], v205 offset:36864
v_mfma_f32_16x16x32_bf16 v[160:163], a[216:219], a[152:155], v[160:163]
v_mfma_f32_16x16x32_bf16 v[192:195], a[216:219], a[156:159], v[192:195]
ds_read_b64_tr_b16 a[216:217], v206 offset:32768
ds_read_b64_tr_b16 a[218:219], v206 offset:36864
v_mfma_f32_16x16x32_bf16 v[164:167], a[220:223], a[152:155], v[164:167]
v_mfma_f32_16x16x32_bf16 v[196:199], a[220:223], a[156:159], v[196:199]
s_waitcnt lgkmcnt(12)
ds_read_b64_tr_b16 a[220:221], v207 offset:32768
ds_read_b64_tr_b16 a[222:223], v207 offset:36864
s_waitcnt vmcnt(0)
v_mfma_f32_16x16x32_bf16 v[136:139], a[192:195], a[160:163], v[136:139]
v_mfma_f32_16x16x32_bf16 v[168:171], a[192:195], a[164:167], v[168:171]
s_waitcnt lgkmcnt(10)
ds_read_b64_tr_b16 a[192:193], v200 offset:40960
ds_read_b64_tr_b16 a[194:195], v200 offset:45056
v_mfma_f32_16x16x32_bf16 v[140:143], a[196:199], a[160:163], v[140:143]
v_mfma_f32_16x16x32_bf16 v[172:175], a[196:199], a[164:167], v[172:175]
ds_read_b64_tr_b16 a[196:197], v201 offset:40960
ds_read_b64_tr_b16 a[198:199], v201 offset:45056
v_mfma_f32_16x16x32_bf16 v[144:147], a[200:203], a[160:163], v[144:147]
v_mfma_f32_16x16x32_bf16 v[176:179], a[200:203], a[164:167], v[176:179]
s_waitcnt lgkmcnt(8)
ds_read_b64_tr_b16 a[200:201], v202 offset:40960
ds_read_b64_tr_b16 a[202:203], v202 offset:45056
v_mfma_f32_16x16x32_bf16 v[148:151], a[204:207], a[160:163], v[148:151]
v_mfma_f32_16x16x32_bf16 v[180:183], a[204:207], a[164:167], v[180:183]
ds_read_b64_tr_b16 a[204:205], v203 offset:40960
ds_read_b64_tr_b16 a[206:207], v203 offset:45056
v_mfma_f32_16x16x32_bf16 v[152:155], a[208:211], a[160:163], v[152:155]
v_mfma_f32_16x16x32_bf16 v[184:187], a[208:211], a[164:167], v[184:187]
ds_read_b64_tr_b16 a[208:209], v204 offset:40960
ds_read_b64_tr_b16 a[210:211], v204 offset:45056
v_mfma_f32_16x16x32_bf16 v[156:159], a[212:215], a[160:163], v[156:159]
v_mfma_f32_16x16x32_bf16 v[188:191], a[212:215], a[164:167], v[188:191]
s_waitcnt lgkmcnt(8)
ds_read_b64_tr_b16 a[212:213], v205 offset:40960
ds_read_b64_tr_b16 a[214:215], v205 offset:45056
v_mfma_f32_16x16x32_bf16 v[160:163], a[216:219], a[160:163], v[160:163]
v_mfma_f32_16x16x32_bf16 v[192:195], a[216:219], a[164:167], v[192:195]
ds_read_b64_tr_b16 a[216:217], v206 offset:40960
ds_read_b64_tr_b16 a[218:219], v206 offset:45056
v_mfma_f32_16x16x32_bf16 v[164:167], a[220:223], a[160:163], v[164:167]
v_mfma_f32_16x16x32_bf16 v[196:199], a[220:223], a[164:167], v[196:199]
ds_read_b64_tr_b16 a[220:221], v207 offset:40960
ds_read_b64_tr_b16 a[222:223], v207 offset:45056
v_cmp_gt_u32 vcc, 16, v248
v_lshlrev_b32 v6, 7, v3
v_add_u32 v6, 0x272800, v6
s_and_b32 s93, vcc_lo, 0xff
s_cselect_b32 s47, 0, 0x7f000000
v_mfma_f32_16x16x32_bf16 v[136:139], a[192:195], a[168:171], v[136:139]
buffer_load_dword v246, v7, s[20:23], s86 offen sc0 sc1
v_mfma_f32_16x16x32_bf16 v[168:171], a[192:195], a[172:175], v[168:171]
s_waitcnt lgkmcnt(8)
ds_read_b64_tr_b16 a[192:193], v200 offset:49152
ds_read_b64_tr_b16 a[194:195], v200 offset:53248
v_mfma_f32_16x16x32_bf16 v[140:143], a[196:199], a[168:171], v[140:143]
v_mfma_f32_16x16x32_bf16 v[172:175], a[196:199], a[172:175], v[172:175]
ds_read_b64_tr_b16 a[196:197], v201 offset:49152
ds_read_b64_tr_b16 a[198:199], v201 offset:53248
v_mfma_f32_16x16x32_bf16 v[144:147], a[200:203], a[168:171], v[144:147]
buffer_load_dword v247, v6, s[20:23], s47 offen sc0 sc1
v_mfma_f32_16x16x32_bf16 v[176:179], a[200:203], a[172:175], v[176:179]
ds_read_b64_tr_b16 a[200:201], v202 offset:49152
ds_read_b64_tr_b16 a[202:203], v202 offset:53248
v_mfma_f32_16x16x32_bf16 v[148:151], a[204:207], a[168:171], v[148:151]
v_mfma_f32_16x16x32_bf16 v[180:183], a[204:207], a[172:175], v[180:183]
s_waitcnt lgkmcnt(8)
ds_read_b64_tr_b16 a[204:205], v203 offset:49152
ds_read_b64_tr_b16 a[206:207], v203 offset:53248
v_mfma_f32_16x16x32_bf16 v[152:155], a[208:211], a[168:171], v[152:155]
v_mfma_f32_16x16x32_bf16 v[184:187], a[208:211], a[172:175], v[184:187]
ds_read_b64_tr_b16 a[208:209], v204 offset:49152
ds_read_b64_tr_b16 a[210:211], v204 offset:53248
v_mfma_f32_16x16x32_bf16 v[156:159], a[212:215], a[168:171], v[156:159]
v_mfma_f32_16x16x32_bf16 v[188:191], a[212:215], a[172:175], v[188:191]
ds_read_b64_tr_b16 a[212:213], v205 offset:49152
ds_read_b64_tr_b16 a[214:215], v205 offset:53248
v_mfma_f32_16x16x32_bf16 v[160:163], a[216:219], a[168:171], v[160:163]
v_mfma_f32_16x16x32_bf16 v[192:195], a[216:219], a[172:175], v[192:195]
s_waitcnt lgkmcnt(8)
ds_read_b64_tr_b16 a[216:217], v206 offset:49152
ds_read_b64_tr_b16 a[218:219], v206 offset:53248
v_mfma_f32_16x16x32_bf16 v[164:167], a[220:223], a[168:171], v[164:167]
v_mfma_f32_16x16x32_bf16 v[196:199], a[220:223], a[172:175], v[196:199]
ds_read_b64_tr_b16 a[220:221], v207 offset:49152
ds_read_b64_tr_b16 a[222:223], v207 offset:53248
v_mfma_f32_16x16x32_bf16 v[136:139], a[192:195], a[176:179], v[136:139]
v_mfma_f32_16x16x32_bf16 v[168:171], a[192:195], a[180:183], v[168:171]
ds_read_b64_tr_b16 a[192:193], v200 offset:57344
ds_read_b64_tr_b16 a[194:195], v200 offset:61440
v_mfma_f32_16x16x32_bf16 v[140:143], a[196:199], a[176:179], v[140:143]
v_mfma_f32_16x16x32_bf16 v[172:175], a[196:199], a[180:183], v[172:175]
s_waitcnt lgkmcnt(8)
ds_read_b64_tr_b16 a[196:197], v201 offset:57344
ds_read_b64_tr_b16 a[198:199], v201 offset:61440
v_mfma_f32_16x16x32_bf16 v[144:147], a[200:203], a[176:179], v[144:147]
v_mfma_f32_16x16x32_bf16 v[176:179], a[200:203], a[180:183], v[176:179]
ds_read_b64_tr_b16 a[200:201], v202 offset:57344
ds_read_b64_tr_b16 a[202:203], v202 offset:61440
v_mfma_f32_16x16x32_bf16 v[148:151], a[204:207], a[176:179], v[148:151]
v_mfma_f32_16x16x32_bf16 v[180:183], a[204:207], a[180:183], v[180:183]
ds_read_b64_tr_b16 a[204:205], v203 offset:57344
ds_read_b64_tr_b16 a[206:207], v203 offset:61440
v_mfma_f32_16x16x32_bf16 v[152:155], a[208:211], a[176:179], v[152:155]
v_mfma_f32_16x16x32_bf16 v[184:187], a[208:211], a[180:183], v[184:187]
s_waitcnt lgkmcnt(8)
ds_read_b64_tr_b16 a[208:209], v204 offset:57344
ds_read_b64_tr_b16 a[210:211], v204 offset:61440
v_mfma_f32_16x16x32_bf16 v[156:159], a[212:215], a[176:179], v[156:159]
v_mfma_f32_16x16x32_bf16 v[188:191], a[212:215], a[180:183], v[188:191]
ds_read_b64_tr_b16 a[212:213], v205 offset:57344
ds_read_b64_tr_b16 a[214:215], v205 offset:61440
v_mfma_f32_16x16x32_bf16 v[160:163], a[216:219], a[176:179], v[160:163]
v_mfma_f32_16x16x32_bf16 v[192:195], a[216:219], a[180:183], v[192:195]
ds_read_b64_tr_b16 a[216:217], v206 offset:57344
ds_read_b64_tr_b16 a[218:219], v206 offset:61440
v_mfma_f32_16x16x32_bf16 v[164:167], a[220:223], a[176:179], v[164:167]
v_mfma_f32_16x16x32_bf16 v[196:199], a[220:223], a[180:183], v[196:199]
s_waitcnt lgkmcnt(8)
ds_read_b64_tr_b16 a[220:221], v207 offset:57344
ds_read_b64_tr_b16 a[222:223], v207 offset:61440
v_mfma_f32_16x16x32_bf16 v[136:139], a[192:195], a[184:187], v[136:139]
v_mfma_f32_16x16x32_bf16 v[168:171], a[192:195], a[188:191], v[168:171]
v_mfma_f32_16x16x32_bf16 v[140:143], a[196:199], a[184:187], v[140:143]
v_mfma_f32_16x16x32_bf16 v[172:175], a[196:199], a[188:191], v[172:175]
v_mfma_f32_16x16x32_bf16 v[144:147], a[200:203], a[184:187], v[144:147]
v_mfma_f32_16x16x32_bf16 v[176:179], a[200:203], a[188:191], v[176:179]
s_waitcnt lgkmcnt(4)
v_mfma_f32_16x16x32_bf16 v[148:151], a[204:207], a[184:187], v[148:151]
v_mfma_f32_16x16x32_bf16 v[180:183], a[204:207], a[188:191], v[180:183]
v_mfma_f32_16x16x32_bf16 v[152:155], a[208:211], a[184:187], v[152:155]
v_mfma_f32_16x16x32_bf16 v[184:187], a[208:211], a[188:191], v[184:187]
v_mfma_f32_16x16x32_bf16 v[156:159], a[212:215], a[184:187], v[156:159]
v_mfma_f32_16x16x32_bf16 v[188:191], a[212:215], a[188:191], v[188:191]
s_waitcnt lgkmcnt(0)
v_mfma_f32_16x16x32_bf16 v[160:163], a[216:219], a[184:187], v[160:163]
v_mfma_f32_16x16x32_bf16 v[192:195], a[216:219], a[188:191], v[192:195]
v_mfma_f32_16x16x32_bf16 v[164:167], a[220:223], a[184:187], v[164:167]
v_mfma_f32_16x16x32_bf16 v[196:199], a[220:223], a[188:191], v[196:199]
s_lshl_b32 s95, s35, 2
s_add_u32 s95, s95, s63
s_lshl_b32 s46, s35, 7
s_add_u32 s63, s63, s46
v_cvt_pk_bf16_f32 v200, v168, v169
v_cvt_pk_bf16_f32 v201, v170, v171
v_cvt_pk_bf16_f32 v202, v172, v173
v_cvt_pk_bf16_f32 v203, v174, v175
buffer_store_dwordx4 v[200:203], v234, s[20:23], s65 offen offset:0 sc0 sc1
v_cvt_pk_bf16_f32 v204, v176, v177
v_cvt_pk_bf16_f32 v205, v178, v179
v_cvt_pk_bf16_f32 v206, v180, v181
v_cvt_pk_bf16_f32 v207, v182, v183
buffer_store_dwordx4 v[204:207], v234, s[20:23], s65 offen offset:1024 sc0 sc1
v_cvt_pk_bf16_f32 v208, v152, v153
v_cvt_pk_bf16_f32 v209, v154, v155
v_cvt_pk_bf16_f32 v210, v156, v157
v_cvt_pk_bf16_f32 v211, v158, v159
buffer_store_dwordx4 v[208:211], v234, s[20:23], s64 offen offset:0 sc0 sc1
v_cvt_pk_bf16_f32 v212, v160, v161
v_cvt_pk_bf16_f32 v213, v162, v163
v_cvt_pk_bf16_f32 v214, v164, v165
v_cvt_pk_bf16_f32 v215, v166, v167
buffer_store_dwordx4 v[212:215], v234, s[20:23], s64 offen offset:1024 sc0 sc1
v_cvt_pk_bf16_f32 v216, v184, v185
v_cvt_pk_bf16_f32 v217, v186, v187
v_cvt_pk_bf16_f32 v218, v188, v189
v_cvt_pk_bf16_f32 v219, v190, v191
buffer_store_dwordx4 v[216:219], v234, s[20:23], s66 offen offset:0 sc0 sc1
v_cvt_pk_bf16_f32 v220, v192, v193
v_cvt_pk_bf16_f32 v221, v194, v195
v_cvt_pk_bf16_f32 v222, v196, v197
v_cvt_pk_bf16_f32 v223, v198, v199
buffer_store_dwordx4 v[220:223], v234, s[20:23], s66 offen offset:1024 sc0 sc1
s_waitcnt vmcnt(6)
v_cmp_ne_u32 vcc, 1, v246
s_and_b32 s46, s35, 1
s_or_b32 s46, s46, vcc_lo
s_cselect_b32 s67, 0, 1
s_cbranch_scc1 K_NOER
s_add_u32 s48, s87, 4096
buffer_load_dwordx2 v[40:41], v250, s[20:23], s87 offen offset:0 sc0 sc1
buffer_load_dwordx2 v[42:43], v250, s[20:23], s87 offen offset:512 sc0 sc1
buffer_load_dwordx2 v[44:45], v250, s[20:23], s87 offen offset:1024 sc0 sc1
buffer_load_dwordx2 v[46:47], v250, s[20:23], s87 offen offset:1536 sc0 sc1
buffer_load_dwordx2 v[48:49], v250, s[20:23], s87 offen offset:2048 sc0 sc1
buffer_load_dwordx2 v[50:51], v250, s[20:23], s87 offen offset:2560 sc0 sc1
buffer_load_dwordx2 v[52:53], v250, s[20:23], s87 offen offset:3072 sc0 sc1
buffer_load_dwordx2 v[54:55], v250, s[20:23], s87 offen offset:3584 sc0 sc1
buffer_load_dwordx2 v[56:57], v250, s[20:23], s48 offen offset:0 sc0 sc1
buffer_load_dwordx2 v[58:59], v250, s[20:23], s48 offen offset:512 sc0 sc1
buffer_load_dwordx2 v[60:61], v250, s[20:23], s48 offen offset:1024 sc0 sc1
buffer_load_dwordx2 v[62:63], v250, s[20:23], s48 offen offset:1536 sc0 sc1
buffer_load_dwordx2 v[64:65], v250, s[20:23], s48 offen offset:2048 sc0 sc1
buffer_load_dwordx2 v[66:67], v250, s[20:23], s48 offen offset:2560 sc0 sc1
buffer_load_dwordx2 v[68:69], v250, s[20:23], s48 offen offset:3072 sc0 sc1
buffer_load_dwordx2 v[70:71], v250, s[20:23], s48 offen offset:3584 sc0 sc1
K_NOER:
v_lshlrev_b32 v30, 16, v120
v_and_b32 v31, s56, v120
v_lshlrev_b32 v32, 16, v121
v_and_b32 v33, s56, v121
v_pk_add_f32 v[30:31], v[30:31], v[130:131] op_sel_hi:[1,0] neg_lo:[0,1] neg_hi:[0,1]
v_pk_add_f32 v[32:33], v[32:33], v[130:131] op_sel_hi:[1,0] neg_lo:[0,1] neg_hi:[0,1]
v_cvt_pk_bf16_f32 v28, v30, v31
v_cvt_pk_bf16_f32 v29, v32, v33
v_lshlrev_b32 v30, 16, v28
v_and_b32 v31, s56, v28
v_lshlrev_b32 v32, 16, v29
v_and_b32 v33, s56, v29
v_pk_mul_f32 v[8:9], v[30:31], v[132:133] op_sel_hi:[1,0]
v_pk_mul_f32 v[10:11], v[32:33], v[132:133] op_sel_hi:[1,0]
v_pk_fma_f32 v[30:31], v[8:9], v[130:131], v[30:31] op_sel:[0,1,0] op_sel_hi:[1,1,1] neg_lo:[1,0,0] neg_hi:[1,0,0]
v_pk_fma_f32 v[32:33], v[10:11], v[130:131], v[32:33] op_sel:[0,1,0] op_sel_hi:[1,1,1] neg_lo:[1,0,0] neg_hi:[1,0,0]
v_pk_fma_f32 v[8:9], v[30:31], v[132:133], v[8:9] op_sel_hi:[1,0,1]
v_pk_fma_f32 v[10:11], v[32:33], v[132:133], v[10:11] op_sel_hi:[1,0,1]
v_cvt_pk_bf16_f32 v28, v8, v9
v_cvt_pk_bf16_f32 v29, v10, v11
v_lshlrev_b32 v8, 16, v28
v_and_b32 v9, s56, v28
v_lshlrev_b32 v10, 16, v29
v_and_b32 v11, s56, v29
v_mul_f32 v30, s57, v8
v_mul_f32 v31, s57, v9
v_mul_f32 v32, s57, v10
v_mul_f32 v33, s57, v11
v_exp_f32 v30, v30
v_exp_f32 v31, v31
v_exp_f32 v32, v32
v_exp_f32 v33, v33
s_nop 0
v_add_f32 v30, 1.0, v30
v_add_f32 v31, 1.0, v31
v_add_f32 v32, 1.0, v32
v_add_f32 v33, 1.0, v33
v_rcp_f32 v30, v30
v_rcp_f32 v31, v31
v_rcp_f32 v32, v32
v_rcp_f32 v33, v33
s_nop 0
v_pk_mul_f32 v[8:9], v[8:9], v[30:31]
v_pk_mul_f32 v[10:11], v[10:11], v[32:33]
v_cvt_pk_bf16_f32 v28, v8, v9
v_cvt_pk_bf16_f32 v29, v10, v11
v_lshlrev_b32 v8, 16, v28
v_and_b32 v9, s56, v28
v_lshlrev_b32 v10, 16, v29
v_and_b32 v11, s56, v29
v_lshlrev_b32 v30, 16, v122
v_and_b32 v31, s56, v122
v_lshlrev_b32 v32, 16, v123
v_and_b32 v33, s56, v123
v_pk_add_f32 v[30:31], v[30:31], v[130:131] op_sel_hi:[1,0] neg_lo:[0,1] neg_hi:[0,1]
v_pk_add_f32 v[32:33], v[32:33], v[130:131] op_sel_hi:[1,0] neg_lo:[0,1] neg_hi:[0,1]
v_cvt_pk_bf16_f32 v28, v30, v31
v_cvt_pk_bf16_f32 v29, v32, v33
v_lshlrev_b32 v30, 16, v28
v_and_b32 v31, s56, v28
v_lshlrev_b32 v32, 16, v29
v_and_b32 v33, s56, v29
v_pk_mul_f32 v[12:13], v[30:31], v[132:133] op_sel_hi:[1,0]
v_pk_mul_f32 v[14:15], v[32:33], v[132:133] op_sel_hi:[1,0]
v_pk_fma_f32 v[30:31], v[12:13], v[130:131], v[30:31] op_sel:[0,1,0] op_sel_hi:[1,1,1] neg_lo:[1,0,0] neg_hi:[1,0,0]
v_pk_fma_f32 v[32:33], v[14:15], v[130:131], v[32:33] op_sel:[0,1,0] op_sel_hi:[1,1,1] neg_lo:[1,0,0] neg_hi:[1,0,0]
v_pk_fma_f32 v[12:13], v[30:31], v[132:133], v[12:13] op_sel_hi:[1,0,1]
v_pk_fma_f32 v[14:15], v[32:33], v[132:133], v[14:15] op_sel_hi:[1,0,1]
v_cvt_pk_bf16_f32 v28, v12, v13
v_cvt_pk_bf16_f32 v29, v14, v15
v_lshlrev_b32 v12, 16, v28
v_and_b32 v13, s56, v28
v_lshlrev_b32 v14, 16, v29
v_and_b32 v15, s56, v29
v_mul_f32 v30, s57, v12
v_mul_f32 v31, s57, v13
v_mul_f32 v32, s57, v14
v_mul_f32 v33, s57, v15
v_exp_f32 v30, v30
v_exp_f32 v31, v31
v_exp_f32 v32, v32
v_exp_f32 v33, v33
s_nop 0
v_add_f32 v30, 1.0, v30
v_add_f32 v31, 1.0, v31
v_add_f32 v32, 1.0, v32
v_add_f32 v33, 1.0, v33
v_rcp_f32 v30, v30
v_rcp_f32 v31, v31
v_rcp_f32 v32, v32
v_rcp_f32 v33, v33
s_nop 0
v_pk_mul_f32 v[12:13], v[12:13], v[30:31]
v_pk_mul_f32 v[14:15], v[14:15], v[32:33]
v_cvt_pk_bf16_f32 v28, v12, v13
v_cvt_pk_bf16_f32 v29, v14, v15
v_lshlrev_b32 v12, 16, v28
v_and_b32 v13, s56, v28
v_lshlrev_b32 v14, 16, v29
v_and_b32 v15, s56, v29
s_mov_b32 s47, s67
s_and_b32 s46, s35, 1
s_or_b32 s67, s67, s46
s_cselect_b32 s46, 0, 16
v_and_b32 v153, 3, v1
v_lshl_add_u32 v153, v153, 2, s63
v_add_u32 v7, s86, v7
v_cmp_gt_u32 vcc, s46, v1
s_add_u32 s48, s35, 16
s_nop 0
v_cndmask_b32 v152, v153, v7, vcc
s_waitcnt vmcnt(16)
s_cmp_lg_u32 s47, 0
s_cbranch_scc1 K_FLAGGED
s_waitcnt vmcnt(0)
K_FLAGGED:
buffer_load_dword v246, v152, s[20:23], 0 offen sc0 sc1
s_mov_b32 exec_lo, s38
s_mov_b32 exec_hi, 0
buffer_store_dword v5, v249, s[20:23], s95 offen sc0 sc1
s_mov_b64 exec, -1
v_lshlrev_b32 v30, 16, v124
v_and_b32 v31, s56, v124
v_lshlrev_b32 v32, 16, v125
v_and_b32 v33, s56, v125
v_pk_add_f32 v[30:31], v[30:31], v[130:131] op_sel_hi:[1,0] neg_lo:[0,1] neg_hi:[0,1]
v_pk_add_f32 v[32:33], v[32:33], v[130:131] op_sel_hi:[1,0] neg_lo:[0,1] neg_hi:[0,1]
v_cvt_pk_bf16_f32 v28, v30, v31
v_cvt_pk_bf16_f32 v29, v32, v33
v_lshlrev_b32 v30, 16, v28
v_and_b32 v31, s56, v28
v_lshlrev_b32 v32, 16, v29
v_and_b32 v33, s56, v29
v_pk_mul_f32 v[16:17], v[30:31], v[132:133] op_sel_hi:[1,0]
v_pk_mul_f32 v[18:19], v[32:33], v[132:133] op_sel_hi:[1,0]
v_pk_fma_f32 v[30:31], v[16:17], v[130:131], v[30:31] op_sel:[0,1,0] op_sel_hi:[1,1,1] neg_lo:[1,0,0] neg_hi:[1,0,0]
v_pk_fma_f32 v[32:33], v[18:19], v[130:131], v[32:33] op_sel:[0,1,0] op_sel_hi:[1,1,1] neg_lo:[1,0,0] neg_hi:[1,0,0]
v_pk_fma_f32 v[16:17], v[30:31], v[132:133], v[16:17] op_sel_hi:[1,0,1]
v_pk_fma_f32 v[18:19], v[32:33], v[132:133], v[18:19] op_sel_hi:[1,0,1]
v_cvt_pk_bf16_f32 v28, v16, v17
v_cvt_pk_bf16_f32 v29, v18, v19
v_lshlrev_b32 v16, 16, v28
v_and_b32 v17, s56, v28
v_lshlrev_b32 v18, 16, v29
v_and_b32 v19, s56, v29
v_mul_f32 v30, s57, v16
v_mul_f32 v31, s57, v17
v_mul_f32 v32, s57, v18
v_mul_f32 v33, s57, v19
v_exp_f32 v30, v30
v_exp_f32 v31, v31
v_exp_f32 v32, v32
v_exp_f32 v33, v33
s_nop 0
v_add_f32 v30, 1.0, v30
v_add_f32 v31, 1.0, v31
v_add_f32 v32, 1.0, v32
v_add_f32 v33, 1.0, v33
v_rcp_f32 v30, v30
v_rcp_f32 v31, v31
v_rcp_f32 v32, v32
v_rcp_f32 v33, v33
s_nop 0
v_pk_mul_f32 v[16:17], v[16:17], v[30:31]
v_pk_mul_f32 v[18:19], v[18:19], v[32:33]
v_cvt_pk_bf16_f32 v28, v16, v17
v_cvt_pk_bf16_f32 v29, v18, v19
v_lshlrev_b32 v16, 16, v28
v_and_b32 v17, s56, v28
v_lshlrev_b32 v18, 16, v29
v_and_b32 v19, s56, v29
v_lshlrev_b32 v30, 16, v126
v_and_b32 v31, s56, v126
v_lshlrev_b32 v32, 16, v127
v_and_b32 v33, s56, v127
v_pk_add_f32 v[30:31], v[30:31], v[130:131] op_sel_hi:[1,0] neg_lo:[0,1] neg_hi:[0,1]
v_pk_add_f32 v[32:33], v[32:33], v[130:131] op_sel_hi:[1,0] neg_lo:[0,1] neg_hi:[0,1]
v_cvt_pk_bf16_f32 v28, v30, v31
v_cvt_pk_bf16_f32 v29, v32, v33
v_lshlrev_b32 v30, 16, v28
v_and_b32 v31, s56, v28
v_lshlrev_b32 v32, 16, v29
v_and_b32 v33, s56, v29
v_pk_mul_f32 v[20:21], v[30:31], v[132:133] op_sel_hi:[1,0]
v_pk_mul_f32 v[22:23], v[32:33], v[132:133] op_sel_hi:[1,0]
v_pk_fma_f32 v[30:31], v[20:21], v[130:131], v[30:31] op_sel:[0,1,0] op_sel_hi:[1,1,1] neg_lo:[1,0,0] neg_hi:[1,0,0]
v_pk_fma_f32 v[32:33], v[22:23], v[130:131], v[32:33] op_sel:[0,1,0] op_sel_hi:[1,1,1] neg_lo:[1,0,0] neg_hi:[1,0,0]
v_pk_fma_f32 v[20:21], v[30:31], v[132:133], v[20:21] op_sel_hi:[1,0,1]
v_pk_fma_f32 v[22:23], v[32:33], v[132:133], v[22:23] op_sel_hi:[1,0,1]
v_cvt_pk_bf16_f32 v28, v20, v21
v_cvt_pk_bf16_f32 v29, v22, v23
v_lshlrev_b32 v20, 16, v28
v_and_b32 v21, s56, v28
v_lshlrev_b32 v22, 16, v29
v_and_b32 v23, s56, v29
v_mul_f32 v30, s57, v20
v_mul_f32 v31, s57, v21
v_mul_f32 v32, s57, v22
v_mul_f32 v33, s57, v23
v_exp_f32 v30, v30
v_exp_f32 v31, v31
v_exp_f32 v32, v32
v_exp_f32 v33, v33
s_nop 0
v_add_f32 v30, 1.0, v30
v_add_f32 v31, 1.0, v31
v_add_f32 v32, 1.0, v32
v_add_f32 v33, 1.0, v33
v_rcp_f32 v30, v30
v_rcp_f32 v31, v31
v_rcp_f32 v32, v32
v_rcp_f32 v33, v33
s_nop 0
v_pk_mul_f32 v[20:21], v[20:21], v[30:31]
v_pk_mul_f32 v[22:23], v[22:23], v[32:33]
v_cvt_pk_bf16_f32 v28, v20, v21
v_cvt_pk_bf16_f32 v29, v22, v23
v_lshlrev_b32 v20, 16, v28
v_and_b32 v21, s56, v28
v_lshlrev_b32 v22, 16, v29
v_and_b32 v23, s56, v29
v_lshlrev_b32 v30, 16, v128
v_and_b32 v31, s56, v128
v_lshlrev_b32 v32, 16, v129
v_and_b32 v33, s56, v129
v_pk_add_f32 v[30:31], v[30:31], v[130:131] op_sel_hi:[1,0] neg_lo:[0,1] neg_hi:[0,1]
v_pk_add_f32 v[32:33], v[32:33], v[130:131] op_sel_hi:[1,0] neg_lo:[0,1] neg_hi:[0,1]
v_cvt_pk_bf16_f32 v28, v30, v31
v_cvt_pk_bf16_f32 v29, v32, v33
v_lshlrev_b32 v30, 16, v28
v_and_b32 v31, s56, v28
v_lshlrev_b32 v32, 16, v29
v_and_b32 v33, s56, v29
v_pk_mul_f32 v[24:25], v[30:31], v[132:133] op_sel_hi:[1,0]
v_pk_mul_f32 v[26:27], v[32:33], v[132:133] op_sel_hi:[1,0]
v_pk_fma_f32 v[30:31], v[24:25], v[130:131], v[30:31] op_sel:[0,1,0] op_sel_hi:[1,1,1] neg_lo:[1,0,0] neg_hi:[1,0,0]
v_pk_fma_f32 v[32:33], v[26:27], v[130:131], v[32:33] op_sel:[0,1,0] op_sel_hi:[1,1,1] neg_lo:[1,0,0] neg_hi:[1,0,0]
v_pk_fma_f32 v[24:25], v[30:31], v[132:133], v[24:25] op_sel_hi:[1,0,1]
v_pk_fma_f32 v[26:27], v[32:33], v[132:133], v[26:27] op_sel_hi:[1,0,1]
v_cvt_pk_bf16_f32 v28, v24, v25
v_cvt_pk_bf16_f32 v29, v26, v27
v_lshlrev_b32 v24, 16, v28
v_and_b32 v25, s56, v28
v_lshlrev_b32 v26, 16, v29
v_and_b32 v27, s56, v29
v_mul_f32 v30, s57, v24
v_mul_f32 v31, s57, v25
v_mul_f32 v32, s57, v26
v_mul_f32 v33, s57, v27
v_exp_f32 v30, v30
v_exp_f32 v31, v31
v_exp_f32 v32, v32
v_exp_f32 v33, v33
s_nop 0
v_add_f32 v30, 1.0, v30
v_add_f32 v31, 1.0, v31
v_add_f32 v32, 1.0, v32
v_add_f32 v33, 1.0, v33
v_rcp_f32 v30, v30
v_rcp_f32 v31, v31
v_rcp_f32 v32, v32
v_rcp_f32 v33, v33
s_nop 0
v_pk_mul_f32 v[24:25], v[24:25], v[30:31]
v_pk_mul_f32 v[26:27], v[26:27], v[32:33]
v_cvt_pk_bf16_f32 v28, v24, v25
v_cvt_pk_bf16_f32 v29, v26, v27
v_lshlrev_b32 v24, 16, v28
v_and_b32 v25, s56, v28
v_lshlrev_b32 v26, 16, v29
v_and_b32 v27, s56, v29
s_waitcnt vmcnt(2)
v_lshlrev_b32 v36, 16, v40
v_and_b32 v37, s56, v40
v_lshlrev_b32 v38, 16, v41
v_and_b32 v39, s56, v41
v_dot2_f32_bf16 v36, v42, s58, v36
v_dot2_f32_bf16 v37, v42, s59, v37
v_dot2_f32_bf16 v38, v43, s58, v38
v_dot2_f32_bf16 v39, v43, s59, v39
v_dot2_f32_bf16 v36, v44, s58, v36
v_dot2_f32_bf16 v37, v44, s59, v37
v_dot2_f32_bf16 v38, v45, s58, v38
v_dot2_f32_bf16 v39, v45, s59, v39
v_dot2_f32_bf16 v36, v46, s58, v36
v_dot2_f32_bf16 v37, v46, s59, v37
v_dot2_f32_bf16 v38, v47, s58, v38
v_dot2_f32_bf16 v39, v47, s59, v39
v_dot2_f32_bf16 v36, v48, s58, v36
v_dot2_f32_bf16 v37, v48, s59, v37
v_dot2_f32_bf16 v38, v49, s58, v38
v_dot2_f32_bf16 v39, v49, s59, v39
v_dot2_f32_bf16 v36, v50, s58, v36
v_dot2_f32_bf16 v37, v50, s59, v37
v_dot2_f32_bf16 v38, v51, s58, v38
v_dot2_f32_bf16 v39, v51, s59, v39
v_dot2_f32_bf16 v36, v52, s58, v36
v_dot2_f32_bf16 v37, v52, s59, v37
v_dot2_f32_bf16 v38, v53, s58, v38
v_dot2_f32_bf16 v39, v53, s59, v39
v_dot2_f32_bf16 v36, v54, s58, v36
v_dot2_f32_bf16 v37, v54, s59, v37
v_dot2_f32_bf16 v38, v55, s58, v38
v_dot2_f32_bf16 v39, v55, s59, v39
v_dot2_f32_bf16 v36, v56, s58, v36
v_dot2_f32_bf16 v37, v56, s59, v37
v_dot2_f32_bf16 v38, v57, s58, v38
v_dot2_f32_bf16 v39, v57, s59, v39
v_dot2_f32_bf16 v36, v58, s58, v36
v_dot2_f32_bf16 v37, v58, s59, v37
v_dot2_f32_bf16 v38, v59, s58, v38
v_dot2_f32_bf16 v39, v59, s59, v39
v_dot2_f32_bf16 v36, v60, s58, v36
v_dot2_f32_bf16 v37, v60, s59, v37
v_dot2_f32_bf16 v38, v61, s58, v38
v_dot2_f32_bf16 v39, v61, s59, v39
v_dot2_f32_bf16 v36, v62, s58, v36
v_dot2_f32_bf16 v37, v62, s59, v37
v_dot2_f32_bf16 v38, v63, s58, v38
v_dot2_f32_bf16 v39, v63, s59, v39
v_dot2_f32_bf16 v36, v64, s58, v36
v_dot2_f32_bf16 v37, v64, s59, v37
v_dot2_f32_bf16 v38, v65, s58, v38
v_dot2_f32_bf16 v39, v65, s59, v39
v_dot2_f32_bf16 v36, v66, s58, v36
v_dot2_f32_bf16 v37, v66, s59, v37
v_dot2_f32_bf16 v38, v67, s58, v38
v_dot2_f32_bf16 v39, v67, s59, v39
v_dot2_f32_bf16 v36, v68, s58, v36
v_dot2_f32_bf16 v37, v68, s59, v37
v_dot2_f32_bf16 v38, v69, s58, v38
v_dot2_f32_bf16 v39, v69, s59, v39
v_dot2_f32_bf16 v36, v70, s58, v36
v_dot2_f32_bf16 v37, v70, s59, v37
v_dot2_f32_bf16 v38, v71, s58, v38
v_dot2_f32_bf16 v39, v71, s59, v39
s_cmp_lg_u32 s93, 0
s_cbranch_scc1 K_YG
K_YGD:
s_waitcnt vmcnt(1)
s_branch K_XW
K_XPOLL:
s_sleep 2
s_add_u32 s100, s100, 1
s_bitcmp1_b32 s100, 19
s_cbranch_scc1 K_END
buffer_load_dword v246, v152, s[20:23], 0 offen sc0 sc1
s_waitcnt vmcnt(0)
K_XW:
v_writelane_b32 v246, 1, s48
v_cmp_ne_u32 vcc, 1, v246
s_cmp_lg_u32 s67, 0
s_cbranch_scc1 K_XW2
s_and_b32 s46, vcc_lo, 0xffff
s_cbranch_scc1 K_XPOLL
s_add_u32 s46, s87, 4096
s_mov_b32 s67, 2
v_mov_b32 v152, v153
buffer_load_dwordx2 v[40:41], v250, s[20:23], s87 offen offset:0 sc0 sc1
buffer_load_dwordx2 v[42:43], v250, s[20:23], s87 offen offset:512 sc0 sc1
buffer_load_dwordx2 v[44:45], v250, s[20:23], s87 offen offset:1024 sc0 sc1
buffer_load_dwordx2 v[46:47], v250, s[20:23], s87 offen offset:1536 sc0 sc1
buffer_load_dwordx2 v[48:49], v250, s[20:23], s87 offen offset:2048 sc0 sc1
buffer_load_dwordx2 v[50:51], v250, s[20:23], s87 offen offset:2560 sc0 sc1
buffer_load_dwordx2 v[52:53], v250, s[20:23], s87 offen offset:3072 sc0 sc1
buffer_load_dwordx2 v[54:55], v250, s[20:23], s87 offen offset:3584 sc0 sc1
buffer_load_dwordx2 v[56:57], v250, s[20:23], s46 offen offset:0 sc0 sc1
buffer_load_dwordx2 v[58:59], v250, s[20:23], s46 offen offset:512 sc0 sc1
buffer_load_dwordx2 v[60:61], v250, s[20:23], s46 offen offset:1024 sc0 sc1
buffer_load_dwordx2 v[62:63], v250, s[20:23], s46 offen offset:1536 sc0 sc1
buffer_load_dwordx2 v[64:65], v250, s[20:23], s46 offen offset:2048 sc0 sc1
buffer_load_dwordx2 v[66:67], v250, s[20:23], s46 offen offset:2560 sc0 sc1
buffer_load_dwordx2 v[68:69], v250, s[20:23], s46 offen offset:3072 sc0 sc1
buffer_load_dwordx2 v[70:71], v250, s[20:23], s46 offen offset:3584 sc0 sc1
K_XW2:
s_and_b32 s46, vcc_lo, 0xf0000
s_cbranch_scc1 K_XPOLL
buffer_load_dwordx4 v[96:99], v234, s[20:23], s60 offen offset:0 sc0 sc1
buffer_load_dwordx4 v[104:107], v234, s[20:23], s61 offen offset:0 sc0 sc1
buffer_load_dwordx4 v[112:115], v234, s[20:23], s62 offen offset:0 sc0 sc1
buffer_load_dwordx4 v[100:103], v234, s[20:23], s60 offen offset:1024 sc0 sc1
buffer_load_dwordx4 v[108:111], v234, s[20:23], s61 offen offset:1024 sc0 sc1
buffer_load_dwordx4 v[116:119], v234, s[20:23], s62 offen offset:1024 sc0 sc1
v_lshlrev_b32 v72, 16, v120
v_and_b32 v73, s56, v120
v_lshlrev_b32 v74, 16, v121
v_and_b32 v75, s56, v121
v_lshlrev_b32 v76, 16, v122
v_and_b32 v77, s56, v122
v_lshlrev_b32 v78, 16, v123
v_and_b32 v79, s56, v123
v_lshlrev_b32 v80, 16, v124
v_and_b32 v81, s56, v124
v_lshlrev_b32 v82, 16, v125
v_and_b32 v83, s56, v125
v_lshlrev_b32 v84, 16, v126
v_and_b32 v85, s56, v126
v_lshlrev_b32 v86, 16, v127
v_and_b32 v87, s56, v127
v_lshlrev_b32 v88, 16, v128
v_and_b32 v89, s56, v128
v_lshlrev_b32 v90, 16, v129
v_and_b32 v91, s56, v129
s_cmp_lg_u32 s67, 2
s_cbranch_scc1 K_EFIN
s_waitcnt vmcnt(6)
v_lshlrev_b32 v36, 16, v40
v_and_b32 v37, s56, v40
v_lshlrev_b32 v38, 16, v41
v_and_b32 v39, s56, v41
v_dot2_f32_bf16 v36, v42, s58, v36
v_dot2_f32_bf16 v37, v42, s59, v37
v_dot2_f32_bf16 v38, v43, s58, v38
v_dot2_f32_bf16 v39, v43, s59, v39
v_dot2_f32_bf16 v36, v44, s58, v36
v_dot2_f32_bf16 v37, v44, s59, v37
v_dot2_f32_bf16 v38, v45, s58, v38
v_dot2_f32_bf16 v39, v45, s59, v39
v_dot2_f32_bf16 v36, v46, s58, v36
v_dot2_f32_bf16 v37, v46, s59, v37
v_dot2_f32_bf16 v38, v47, s58, v38
v_dot2_f32_bf16 v39, v47, s59, v39
v_dot2_f32_bf16 v36, v48, s58, v36
v_dot2_f32_bf16 v37, v48, s59, v37
v_dot2_f32_bf16 v38, v49, s58, v38
v_dot2_f32_bf16 v39, v49, s59, v39
v_dot2_f32_bf16 v36, v50, s58, v36
v_dot2_f32_bf16 v37, v50, s59, v37
v_dot2_f32_bf16 v38, v51, s58, v38
v_dot2_f32_bf16 v39, v51, s59, v39
v_dot2_f32_bf16 v36, v52, s58, v36
v_dot2_f32_bf16 v37, v52, s59, v37
v_dot2_f32_bf16 v38, v53, s58, v38
v_dot2_f32_bf16 v39, v53, s59, v39
v_dot2_f32_bf16 v36, v54, s58, v36
v_dot2_f32_bf16 v37, v54, s59, v37
v_dot2_f32_bf16 v38, v55, s58, v38
v_dot2_f32_bf16 v39, v55, s59, v39
v_dot2_f32_bf16 v36, v56, s58, v36
v_dot2_f32_bf16 v37, v56, s59, v37
v_dot2_f32_bf16 v38, v57, s58, v38
v_dot2_f32_bf16 v39, v57, s59, v39
v_dot2_f32_bf16 v36, v58, s58, v36
v_dot2_f32_bf16 v37, v58, s59, v37
v_dot2_f32_bf16 v38, v59, s58, v38
v_dot2_f32_bf16 v39, v59, s59, v39
v_dot2_f32_bf16 v36, v60, s58, v36
v_dot2_f32_bf16 v37, v60, s59, v37
v_dot2_f32_bf16 v38, v61, s58, v38
v_dot2_f32_bf16 v39, v61, s59, v39
v_dot2_f32_bf16 v36, v62, s58, v36
v_dot2_f32_bf16 v37, v62, s59, v37
v_dot2_f32_bf16 v38, v63, s58, v38
v_dot2_f32_bf16 v39, v63, s59, v39
v_dot2_f32_bf16 v36, v64, s58, v36
v_dot2_f32_bf16 v37, v64, s59, v37
v_dot2_f32_bf16 v38, v65, s58, v38
v_dot2_f32_bf16 v39, v65, s59, v39
v_dot2_f32_bf16 v36, v66, s58, v36
v_dot2_f32_bf16 v37, v66, s59, v37
v_dot2_f32_bf16 v38, v67, s58, v38
v_dot2_f32_bf16 v39, v67, s59, v39
v_dot2_f32_bf16 v36, v68, s58, v36
v_dot2_f32_bf16 v37, v68, s59, v37
v_dot2_f32_bf16 v38, v69, s58, v38
v_dot2_f32_bf16 v39, v69, s59, v39
v_dot2_f32_bf16 v36, v70, s58, v36
v_dot2_f32_bf16 v37, v70, s59, v37
v_dot2_f32_bf16 v38, v71, s58, v38
v_dot2_f32_bf16 v39, v71, s59, v39
s_nop 1
K_EFIN:
v_cvt_pk_bf16_f32 v28, v36, v37
v_cvt_pk_bf16_f32 v29, v38, v39
v_lshlrev_b32 v36, 16, v28
v_and_b32 v37, s56, v28
v_lshlrev_b32 v38, 16, v29
v_and_b32 v39, s56, v29
v_pk_mul_f32 v[36:37], v[36:37], v[24:25]
v_pk_mul_f32 v[38:39], v[38:39], v[26:27]
v_cvt_pk_bf16_f32 v28, v36, v37
v_cvt_pk_bf16_f32 v29, v38, v39
v_lshlrev_b32 v36, 16, v28
v_and_b32 v37, s56, v28
v_lshlrev_b32 v38, 16, v29
v_and_b32 v39, s56, v29
v_pk_add_f32 v[36:37], v[36:37], v[88:89]
v_pk_add_f32 v[38:39], v[38:39], v[90:91]
v_cvt_pk_bf16_f32 v36, v36, v37
v_cvt_pk_bf16_f32 v37, v38, v39
buffer_store_dwordx2 v[36:37], v240, s[68:71], s81 offen sc0 sc1 nt
s_add_u32 s46, s37, 65536
v_add_u32 v5, s46, v234
s_add_u32 s46, s80, 9216
s_waitcnt vmcnt(4)
v_dot2_f32_bf16 v136, v96, s58, v136
v_dot2_f32_bf16 v137, v96, s59, v137
v_dot2_f32_bf16 v138, v97, s58, v138
v_dot2_f32_bf16 v139, v97, s59, v139
v_dot2_f32_bf16 v140, v98, s58, v140
v_dot2_f32_bf16 v141, v98, s59, v141
v_dot2_f32_bf16 v142, v99, s58, v142
v_dot2_f32_bf16 v143, v99, s59, v143
v_dot2_f32_bf16 v136, v104, s58, v136
v_dot2_f32_bf16 v137, v104, s59, v137
v_dot2_f32_bf16 v138, v105, s58, v138
v_dot2_f32_bf16 v139, v105, s59, v139
v_dot2_f32_bf16 v140, v106, s58, v140
v_dot2_f32_bf16 v141, v106, s59, v141
v_dot2_f32_bf16 v142, v107, s58, v142
v_dot2_f32_bf16 v143, v107, s59, v143
v_dot2_f32_bf16 v136, v112, s58, v136
v_dot2_f32_bf16 v137, v112, s59, v137
v_dot2_f32_bf16 v138, v113, s58, v138
v_dot2_f32_bf16 v139, v113, s59, v139
v_dot2_f32_bf16 v140, v114, s58, v140
v_dot2_f32_bf16 v141, v114, s59, v141
v_dot2_f32_bf16 v142, v115, s58, v142
v_dot2_f32_bf16 v143, v115, s59, v143
v_cvt_pk_bf16_f32 v28, v136, v137
v_cvt_pk_bf16_f32 v29, v138, v139
v_lshlrev_b32 v136, 16, v28
v_and_b32 v137, s56, v28
v_lshlrev_b32 v138, 16, v29
v_and_b32 v139, s56, v29
v_pk_mul_f32 v[136:137], v[136:137], v[8:9]
v_pk_mul_f32 v[138:139], v[138:139], v[10:11]
v_cvt_pk_bf16_f32 v28, v136, v137
v_cvt_pk_bf16_f32 v29, v138, v139
v_lshlrev_b32 v136, 16, v28
v_and_b32 v137, s56, v28
v_lshlrev_b32 v138, 16, v29
v_and_b32 v139, s56, v29
v_pk_add_f32 v[136:137], v[136:137], v[72:73]
v_pk_add_f32 v[138:139], v[138:139], v[74:75]
v_cvt_pk_bf16_f32 v136, v136, v137
v_cvt_pk_bf16_f32 v137, v138, v139
ds_write_b64 v241, v[136:137]
v_cvt_pk_bf16_f32 v28, v140, v141
v_cvt_pk_bf16_f32 v29, v142, v143
v_lshlrev_b32 v140, 16, v28
v_and_b32 v141, s56, v28
v_lshlrev_b32 v142, 16, v29
v_and_b32 v143, s56, v29
v_pk_mul_f32 v[140:141], v[140:141], v[12:13]
v_pk_mul_f32 v[142:143], v[142:143], v[14:15]
v_cvt_pk_bf16_f32 v28, v140, v141
v_cvt_pk_bf16_f32 v29, v142, v143
v_lshlrev_b32 v140, 16, v28
v_and_b32 v141, s56, v28
v_lshlrev_b32 v142, 16, v29
v_and_b32 v143, s56, v29
v_pk_add_f32 v[140:141], v[140:141], v[76:77]
v_pk_add_f32 v[142:143], v[142:143], v[78:79]
v_cvt_pk_bf16_f32 v140, v140, v141
v_cvt_pk_bf16_f32 v141, v142, v143
ds_write_b64 v242, v[140:141]
s_waitcnt vmcnt(1)
v_dot2_f32_bf16 v144, v100, s58, v144
v_dot2_f32_bf16 v145, v100, s59, v145
v_dot2_f32_bf16 v146, v101, s58, v146
v_dot2_f32_bf16 v147, v101, s59, v147
v_dot2_f32_bf16 v148, v102, s58, v148
v_dot2_f32_bf16 v149, v102, s59, v149
v_dot2_f32_bf16 v150, v103, s58, v150
v_dot2_f32_bf16 v151, v103, s59, v151
v_dot2_f32_bf16 v144, v108, s58, v144
v_dot2_f32_bf16 v145, v108, s59, v145
v_dot2_f32_bf16 v146, v109, s58, v146
v_dot2_f32_bf16 v147, v109, s59, v147
v_dot2_f32_bf16 v148, v110, s58, v148
v_dot2_f32_bf16 v149, v110, s59, v149
v_dot2_f32_bf16 v150, v111, s58, v150
v_dot2_f32_bf16 v151, v111, s59, v151
v_dot2_f32_bf16 v144, v116, s58, v144
v_dot2_f32_bf16 v145, v116, s59, v145
v_dot2_f32_bf16 v146, v117, s58, v146
v_dot2_f32_bf16 v147, v117, s59, v147
v_dot2_f32_bf16 v148, v118, s58, v148
v_dot2_f32_bf16 v149, v118, s59, v149
v_dot2_f32_bf16 v150, v119, s58, v150
v_dot2_f32_bf16 v151, v119, s59, v151
v_cvt_pk_bf16_f32 v28, v144, v145
v_cvt_pk_bf16_f32 v29, v146, v147
v_lshlrev_b32 v144, 16, v28
v_and_b32 v145, s56, v28
v_lshlrev_b32 v146, 16, v29
v_and_b32 v147, s56, v29
v_pk_mul_f32 v[144:145], v[144:145], v[16:17]
v_pk_mul_f32 v[146:147], v[146:147], v[18:19]
v_cvt_pk_bf16_f32 v28, v144, v145
v_cvt_pk_bf16_f32 v29, v146, v147
v_lshlrev_b32 v144, 16, v28
v_and_b32 v145, s56, v28
v_lshlrev_b32 v146, 16, v29
v_and_b32 v147, s56, v29
v_pk_add_f32 v[144:145], v[144:145], v[80:81]
v_pk_add_f32 v[146:147], v[146:147], v[82:83]
v_cvt_pk_bf16_f32 v144, v144, v145
v_cvt_pk_bf16_f32 v145, v146, v147
ds_write_b64 v243, v[144:145]
v_cvt_pk_bf16_f32 v28, v148, v149
v_cvt_pk_bf16_f32 v29, v150, v151
v_lshlrev_b32 v148, 16, v28
v_and_b32 v149, s56, v28
v_lshlrev_b32 v150, 16, v29
v_and_b32 v151, s56, v29
v_pk_mul_f32 v[148:149], v[148:149], v[20:21]
v_pk_mul_f32 v[150:151], v[150:151], v[22:23]
v_cvt_pk_bf16_f32 v28, v148, v149
v_cvt_pk_bf16_f32 v29, v150, v151
v_lshlrev_b32 v148, 16, v28
v_and_b32 v149, s56, v28
v_lshlrev_b32 v150, 16, v29
v_and_b32 v151, s56, v29
v_pk_add_f32 v[148:149], v[148:149], v[84:85]
v_pk_add_f32 v[150:151], v[150:151], v[86:87]
v_cvt_pk_bf16_f32 v148, v148, v149
v_cvt_pk_bf16_f32 v149, v150, v151
ds_write_b64 v244, v[148:149]
ds_read_b128 v[40:43], v5
ds_read_b128 v[44:47], v5 offset:1024
s_waitcnt lgkmcnt(1)
buffer_store_dwordx4 v[40:43], v239, s[68:71], s80 offen sc0 sc1 nt
s_waitcnt lgkmcnt(0)
buffer_store_dwordx4 v[44:47], v239, s[68:71], s46 offen sc0 sc1 nt
K_END:
s_endpgm
K_YSPIN:
s_sleep 4
s_add_u32 s100, s100, 1
s_bitcmp1_b32 s100, 19
s_cbranch_scc1 K_END
buffer_load_dwordx2 v[252:253], v251, s[76:79], s42 offen sc0 sc1
s_waitcnt vmcnt(0)
K_YR0:
s_cmp_lg_u32 s41, 0
s_cbranch_scc1 K_YR0B
s_waitcnt vmcnt(3)
v_cmp_gt_u32 vcc, 9, v252
s_cbranch_vccnz K_YSPIN
K_YR0B:
s_mul_i32 s48, s52, 18560
s_mul_i32 s46, s32, 4608
s_add_u32 s48, s48, s46
s_add_u32 s48, s48, 0x23fb780
s_add_u32 s46, s48, 4096
buffer_load_dwordx4 v[112:115], v234, s[20:23], s48 offen offset:0 sc0 sc1
buffer_load_dwordx4 v[116:119], v234, s[20:23], s48 offen offset:1024 sc0 sc1
buffer_load_dwordx4 v[120:123], v234, s[20:23], s48 offen offset:2048 sc0 sc1
buffer_load_dwordx4 v[124:127], v234, s[20:23], s48 offen offset:3072 sc0 sc1
v_subrev_u32 v245, 1, v254
v_and_b32 v245, 0x7ff, v245
v_mul_u32_u24 v245, 0x480, v245
v_mov_b64 v[128:129], 0
v_mov_b64 v[130:131], 0
s_lshl_b32 s50, s52, 3
s_sub_u32 s50, s50, 8
s_mov_b32 exec_hi, 0
buffer_load_dwordx4 v[128:131], v234, s[20:23], s46 offen sc0 sc1
s_mov_b32 exec_lo, 0xff
buffer_load_dwordx2 v[134:135], v245, s[20:23], s50 offen sc0 sc1
s_mov_b64 exec, -1
s_branch K_LAST
K_YRA:
s_waitcnt vmcnt(35)
v_pk_add_f32 v[112:113], v[112:113], v[116:117]
v_pk_add_f32 v[114:115], v[114:115], v[118:119]
v_pk_add_f32 v[112:113], v[112:113], v[120:121]
v_pk_add_f32 v[114:115], v[114:115], v[122:123]
v_pk_add_f32 v[112:113], v[112:113], v[124:125]
v_pk_add_f32 v[114:115], v[114:115], v[126:127]
v_pk_add_f32 v[112:113], v[112:113], v[128:129]
v_pk_add_f32 v[114:115], v[114:115], v[130:131]
s_lshl_b32 s46, s36, 10
s_lshl_b32 s47, s32, 7
s_add_u32 s46, s46, s47
v_add_f32_dpp v112, v112, v112 row_ror:8 row_mask:0xf bank_mask:0xf
v_add_f32_dpp v113, v113, v113 row_ror:8 row_mask:0xf bank_mask:0xf
v_add_f32_dpp v114, v114, v114 row_ror:8 row_mask:0xf bank_mask:0xf
v_add_f32_dpp v115, v115, v115 row_ror:8 row_mask:0xf bank_mask:0xf
s_add_u32 s46, s46, 77952
v_and_b32 v120, 0x70, v234
v_add_u32 v120, s46, v120
v_mov_b32 v116, v112
v_mov_b32 v117, v113
v_mov_b32 v118, v114
v_mov_b32 v119, v115
v_permlane16_swap_b32 v112, v116
v_permlane16_swap_b32 v113, v117
v_permlane16_swap_b32 v114, v118
v_permlane16_swap_b32 v115, v119
v_pk_add_f32 v[112:113], v[112:113], v[116:117]
v_pk_add_f32 v[114:115], v[114:115], v[118:119]
v_mov_b32 v116, v112
v_mov_b32 v117, v113
v_mov_b32 v118, v114
v_mov_b32 v119, v115
v_permlane32_swap_b32 v112, v116
v_permlane32_swap_b32 v113, v117
v_permlane32_swap_b32 v114, v118
v_permlane32_swap_b32 v115, v119
v_pk_add_f32 v[112:113], v[112:113], v[116:117]
v_pk_add_f32 v[114:115], v[114:115], v[118:119]
ds_write_b128 v120, v[112:115]
v_subrev_u32 v120, s47, v120
s_branch K_YRAD
K_YR1:
ds_read_b128 v[144:147], v120 offset:0
ds_read_b128 v[148:151], v120 offset:128
ds_read_b128 v[152:155], v120 offset:256
ds_read_b128 v[156:159], v120 offset:384
v_mov_b32_dpp v160, v254 row_ror:8 row_mask:0xf bank_mask:0xf
v_mul_u32_u24 v245, 0x480, v1
s_mov_b32 s57, 0xbfb8aa3b
s_mov_b32 s56, 0xffff0000
v_and_b32 v160, s56, v160
s_waitcnt lgkmcnt(0)
v_pk_add_f32 v[112:113], v[144:145], v[148:149]
v_pk_add_f32 v[116:117], v[152:153], v[156:157]
v_pk_add_f32 v[112:113], v[112:113], v[116:117]
v_pk_add_f32 v[114:115], v[146:147], v[150:151]
v_pk_add_f32 v[118:119], v[154:155], v[158:159]
v_pk_add_f32 v[114:115], v[114:115], v[118:119]
v_cvt_pk_bf16_f32 v162, v112, v113
v_cvt_pk_bf16_f32 v163, v114, v115
v_lshlrev_b32 v112, 16, v162
v_and_b32 v113, s56, v162
v_lshlrev_b32 v114, 16, v163
v_and_b32 v115, s56, v163
v_mul_f32 v112, v160, v112
v_mul_f32 v113, v160, v113
v_mul_f32 v114, v160, v114
v_mul_f32 v115, v160, v115
v_cvt_pk_bf16_f32 v162, v112, v113
v_cvt_pk_bf16_f32 v163, v114, v115
v_lshlrev_b32 v112, 16, v162
v_and_b32 v113, s56, v162
v_lshlrev_b32 v114, 16, v163
v_and_b32 v115, s56, v163
v_lshlrev_b32 v116, 16, v134
v_and_b32 v117, 0xffff0000, v134
v_lshlrev_b32 v118, 16, v135
v_and_b32 v119, 0xffff0000, v135
v_pk_add_f32 v[112:113], v[112:113], v[116:117]
v_pk_add_f32 v[114:115], v[114:115], v[118:119]
v_cvt_pk_bf16_f32 v162, v112, v113
v_cvt_pk_bf16_f32 v163, v114, v115
v_lshlrev_b32 v112, 16, v162
v_and_b32 v113, s56, v162
v_lshlrev_b32 v114, 16, v163
v_and_b32 v115, s56, v163
v_mul_f32 v116, s57, v112
v_mul_f32 v117, s57, v113
v_mul_f32 v118, s57, v114
v_mul_f32 v119, s57, v115
v_exp_f32 v116, v116
v_exp_f32 v117, v117
v_exp_f32 v118, v118
v_exp_f32 v119, v119
s_nop 0
v_add_f32 v116, 1.0, v116
v_add_f32 v117, 1.0, v117
v_add_f32 v118, 1.0, v118
v_add_f32 v119, 1.0, v119
v_rcp_f32 v116, v116
v_rcp_f32 v117, v117
v_rcp_f32 v118, v118
v_rcp_f32 v119, v119
s_add_u32 s46, s50, 0x274000
v_pk_mul_f32 v[112:113], v[112:113], v[116:117]
v_pk_mul_f32 v[114:115], v[114:115], v[118:119]
v_cvt_pk_bf16_f32 v134, v112, v113
v_cvt_pk_bf16_f32 v135, v114, v115
s_mov_b64 exec, 0xff
buffer_store_dwordx2 v[134:135], v245, s[20:23], s46 offen sc0 sc1
s_mov_b64 exec, -1
s_branch K_YR1D
K_YR2:
s_waitcnt vmcnt(32)
s_and_b32 s46, s83, 15
s_lshl_b32 s46, s46, 7
s_add_u32 s46, s46, 0x272800
s_mov_b64 exec, 1
buffer_atomic_add v5, v234, s[20:23], s46 offen sc1
s_mov_b64 exec, -1
s_branch K_YR2D
K_YG:
v_mov_b32 v157, -1
K_YG1:
s_ff1_i32_b32 s46, s93
s_bitset0_b32 s93, s46
v_readlane_b32 s47, v248, s46
v_mov_b32 v158, s46
s_nop 0
v_cmp_eq_u32 vcc, s47, v3
s_cmp_lg_u32 s93, 0
s_nop 0
v_cndmask_b32 v157, v157, v158, vcc
s_cbranch_scc1 K_YG1
v_mul_u32_u24 v158, 0x480, v157
v_lshl_add_u32 v158, v4, 3, v158
s_lshl_b32 s46, s36, 8
s_add_u32 s46, s46, s82
s_add_u32 s46, s46, 0x274000
s_lshl_b32 s47, s36, 5
s_add_u32 s47, s47, 0x274400
s_branch K_YG3
K_YG2:
s_sleep 2
s_add_u32 s100, s100, 1
s_bitcmp1_b32 s100, 19
s_cbranch_scc1 K_END
buffer_load_dword v247, v6, s[20:23], 0 offen sc0 sc1
s_waitcnt vmcnt(0)
K_YG3:
v_cmp_gt_u32 vcc, 9, v247
s_cbranch_vccnz K_YG2
v_cmp_gt_u32 vcc, 8, v157
s_nop 1
s_mov_b64 exec, vcc
buffer_load_dwordx2 v[160:161], v158, s[20:23], s46 offen offset:0 sc0 sc1
buffer_load_dwordx2 v[162:163], v158, s[20:23], s46 offen offset:32 sc0 sc1
buffer_load_dwordx2 v[164:165], v158, s[20:23], s46 offen offset:64 sc0 sc1
buffer_load_dwordx2 v[166:167], v158, s[20:23], s46 offen offset:96 sc0 sc1
buffer_load_dwordx2 v[168:169], v158, s[20:23], s47 offen offset:0 sc0 sc1
s_waitcnt vmcnt(0)
v_lshlrev_b32 v8, 16, v160
v_and_b32 v9, s56, v160
v_lshlrev_b32 v10, 16, v161
v_and_b32 v11, s56, v161
v_lshlrev_b32 v12, 16, v162
v_and_b32 v13, s56, v162
v_lshlrev_b32 v14, 16, v163
v_and_b32 v15, s56, v163
v_lshlrev_b32 v16, 16, v164
v_and_b32 v17, s56, v164
v_lshlrev_b32 v18, 16, v165
v_and_b32 v19, s56, v165
v_lshlrev_b32 v20, 16, v166
v_and_b32 v21, s56, v166
v_lshlrev_b32 v22, 16, v167
v_and_b32 v23, s56, v167
v_lshlrev_b32 v24, 16, v168
v_and_b32 v25, s56, v168
v_lshlrev_b32 v26, 16, v169
v_and_b32 v27, s56, v169
s_mov_b64 exec, -1
s_branch K_YGD
K_TAIL_END:
K_HOOK:
s_lshl_b32 s48, s34, 2
s_add_u32 s48, s48, s35
s_cmp_eq_u32 s40, 3
s_cbranch_scc1 K_QTW
s_cmp_eq_u32 s40, 7
s_cbranch_scc1 K_PUB
s_memrealtime s[46:47]
s_waitcnt lgkmcnt(0)
s_sub_u32 s47, s46, s94
s_mul_i32 s47, s47, 12
s_lshr_b32 s47, s47, 2
s_add_u32 s46, s46, s47
s_lshl_b32 s46, s46, 6
s_or_b32 s46, s46, s48
s_bitset1_b32 s46, 31
v_mov_b32 v244, s46
s_lshl_b32 s48, s48, 3
s_mov_b64 exec, 1
buffer_store_dword v244, v234, s[76:79], s48 offen sc0 sc1
s_mov_b64 exec, -1
s_branch K_B4
K_QTSPIN:
s_sleep 4
s_add_u32 s100, s100, 1
s_bitcmp1_b32 s100, 19
s_cbranch_scc1 K_END
buffer_load_dwordx2 v[252:253], v251, s[76:79], 0 offen sc0 sc1
s_waitcnt vmcnt(0)
K_QTW:
s_waitcnt vmcnt(3)
v_cmp_eq_u32 vcc, 0, v252
v_cmp_eq_u32 s[88:89], 0, v253
v_readlane_b32 s46, v252, s48
v_mov_b32 v254, v253
s_and_b32 s88, s88, 0xffff
s_or_b32 s88, s88, vcc_lo
s_or_b32 s88, s88, vcc_hi
v_cmp_gt_u32 vcc, s46, v252
s_cbranch_scc1 K_QTSPIN
s_bcnt1_i32_b64 s46, vcc
s_cmp_ge_u32 s46, 36
s_cbranch_scc1 K_B4
s_lshl_b32 s52, s46, 2
s_add_u32 s52, s52, s36
s_lshl_b32 s50, s52, 6
s_mul_i32 s90, s32, 294912
s_add_u32 s90, s90, s50
v_mfma_f32_16x16x32_bf16 a[16:19], a[160:163], v[72:75], a[16:19]
v_exp_f32 v8, v8
v_mfma_f32_16x16x32_bf16 a[16:19], a[164:167], v[88:91], a[16:19]
v_exp_f32 v9, v9
v_mfma_f32_16x16x32_bf16 a[48:51], a[164:167], v[92:95], a[48:51]
v_cvt_pk_bf16_f32 v56, v8, v9
v_lshlrev_b32 v5, 2, v4
v_mfma_f32_16x16x32_bf16 a[48:51], a[160:163], v[76:79], a[48:51]
v_exp_f32 v10, v10
v_mfma_f32_16x16x32_bf16 a[80:83], a[160:163], v[80:83], a[80:83]
v_add_u32 v6, 16, v5
v_and_b32 v7, 28, v1
v_mfma_f32_16x16x32_bf16 a[80:83], a[164:167], v[96:99], a[80:83]
v_exp_f32 v11, v11
s_waitcnt vmcnt(4) lgkmcnt(0)
s_barrier
v_mfma_f32_16x16x32_bf16 a[112:115], a[164:167], v[100:103], a[112:115]
ds_read_b64_tr_b16 a[164:165], v220 offset:8192
ds_read_b64_tr_b16 a[166:167], v220 offset:12288
v_mfma_f32_16x16x32_bf16 a[112:115], a[160:163], v[84:87], a[112:115]
s_add_u32 m0, s37, 98304
v_exp_f32 v16, v16
v_mfma_f32_16x16x32_bf16 a[116:119], a[168:171], v[84:87], a[116:119]
buffer_load_dwordx4 v232, s[12:15], s39 offen offset:0 lds
v_mfma_f32_16x16x32_bf16 a[116:119], a[172:175], v[100:103], a[116:119]
v_exp_f32 v17, v17
v_mfma_f32_16x16x32_bf16 a[84:87], a[172:175], v[96:99], a[84:87]
ds_read_b64_tr_b16 a[160:161], v220 offset:0
ds_read_b64_tr_b16 a[162:163], v220 offset:4096
v_mfma_f32_16x16x32_bf16 a[84:87], a[168:171], v[80:83], a[84:87]
v_exp_f32 v18, v18
v_mfma_f32_16x16x32_bf16 a[52:55], a[168:171], v[76:79], a[52:55]
s_add_u32 m0, s49, 4096
v_cvt_pk_bf16_f32 v57, v10, v11
v_cvt_pk_bf16_f32 v60, v16, v17
v_mfma_f32_16x16x32_bf16 a[52:55], a[172:175], v[92:95], a[52:55]
s_add_u32 s48, s90, 4718592
v_exp_f32 v19, v19
v_mfma_f32_16x16x32_bf16 a[20:23], a[172:175], v[88:91], a[20:23]
buffer_load_dwordx4 v238, s[56:59], s48 offen  lds
v_mfma_f32_16x16x32_bf16 a[20:23], a[168:171], v[72:75], a[20:23]
v_exp_f32 v24, v24
v_smfmac_f32_16x16x64_bf16 a[248:251], a[208:211], v[40:47], v235
ds_read_b64_tr_b16 a[172:173], v221 offset:8192
ds_read_b64_tr_b16 a[174:175], v221 offset:12288
v_mfma_f32_16x16x32_bf16 v[12:15], a[144:147], v[152:155], v[136:139]
v_exp_f32 v25, v25
v_mfma_f32_16x16x32_bf16 v[12:15], a[148:151], v[156:159], v[12:15]
s_add_u32 m0, s37, 98304
ds_read_b64_tr_b16 a[168:169], v221 offset:0
ds_read_b64_tr_b16 a[170:171], v221 offset:4096
v_mfma_f32_16x16x32_bf16 v[12:15], a[152:155], v[160:163], v[12:15]
v_exp_f32 v26, v26
v_mfma_f32_16x16x32_bf16 v[12:15], a[156:159], v[164:167], v[12:15]
buffer_load_dwordx4 v233, s[12:15], s39 offen offset:1024 lds
v_mfma_f32_16x16x32_bf16 v[20:23], a[156:159], v[180:183], v[140:143]
v_exp_f32 v27, v27
v_mfma_f32_16x16x32_bf16 v[20:23], a[152:155], v[176:179], v[20:23]
ds_read_b128 a[128:131], v216 offset:49152
ds_read_b128 a[132:135], v217 offset:49152
v_mfma_f32_16x16x32_bf16 v[20:23], a[148:151], v[172:175], v[20:23]
s_add_u32 m0, s49, 5120
v_exp_f32 v32, v32
v_mfma_f32_16x16x32_bf16 v[20:23], a[144:147], v[168:171], v[20:23]
s_add_u32 s48, s90, 4866048
buffer_load_dwordx4 v238, s[56:59], s48 offen  lds
v_mfma_f32_16x16x32_bf16 v[28:31], a[144:147], v[184:187], v[144:147]
v_exp_f32 v33, v33
v_mfma_f32_16x16x32_bf16 v[28:31], a[148:151], v[188:191], v[28:31]
ds_read_b128 a[136:139], v218 offset:49152
ds_read_b128 a[140:143], v219 offset:49152
v_mfma_f32_16x16x32_bf16 v[28:31], a[152:155], v[192:195], v[28:31]
v_exp_f32 v34, v34
v_mfma_f32_16x16x32_bf16 v[28:31], a[156:159], v[196:199], v[28:31]
v_cvt_pk_bf16_f32 v61, v18, v19
v_cvt_pk_bf16_f32 v64, v24, v25
v_mfma_f32_16x16x32_bf16 v[36:39], a[156:159], v[212:215], v[148:151]
s_add_u32 m0, s37, 98304
v_exp_f32 v35, v35
v_mfma_f32_16x16x32_bf16 v[36:39], a[152:155], v[208:211], v[36:39]
buffer_load_dwordx4 v232, s[12:15], s39 offen offset:2048 lds
v_mfma_f32_16x16x32_bf16 v[36:39], a[148:151], v[204:207], v[36:39]
v_exp_f32 v12, v12
v_mfma_f32_16x16x32_bf16 v[36:39], a[144:147], v[200:203], v[36:39]
v_exp_f32 v13, v13
v_mfma_f32_16x16x32_bf16 a[24:27], a[176:179], v[72:75], a[24:27]
ds_read_b128 a[156:159], v219 offset:53248
ds_read_b128 a[152:155], v218 offset:53248
v_mfma_f32_16x16x32_bf16 a[24:27], a[180:183], v[88:91], a[24:27]
v_exp_f32 v14, v14
v_mfma_f32_16x16x32_bf16 a[56:59], a[180:183], v[92:95], a[56:59]
s_add_u32 m0, s49, 6144
ds_read_b128 a[148:151], v217 offset:53248
ds_read_b128 a[144:147], v216 offset:53248
v_mfma_f32_16x16x32_bf16 a[56:59], a[176:179], v[76:79], a[56:59]
s_add_u32 s48, s90, 4718592
v_exp_f32 v15, v15
v_mfma_f32_16x16x32_bf16 a[88:91], a[176:179], v[80:83], a[88:91]
buffer_load_dwordx4 v238, s[60:63], s48 offen  lds
v_mfma_f32_16x16x32_bf16 a[88:91], a[180:183], v[96:99], a[88:91]
v_exp_f32 v20, v20
v_mfma_f32_16x16x32_bf16 a[120:123], a[180:183], v[100:103], a[120:123]
ds_read_b64_tr_b16 a[180:181], v222 offset:8192
ds_read_b64_tr_b16 a[182:183], v222 offset:12288
v_mfma_f32_16x16x32_bf16 a[120:123], a[176:179], v[84:87], a[120:123]
s_add_u32 m0, s37, 98304
v_exp_f32 v21, v21
v_mfma_f32_16x16x32_bf16 a[124:127], a[184:187], v[84:87], a[124:127]
buffer_load_dwordx4 v233, s[12:15], s39 offen offset:3072 lds
v_mfma_f32_16x16x32_bf16 a[124:127], a[188:191], v[100:103], a[124:127]
v_exp_f32 v22, v22
v_mfma_f32_16x16x32_bf16 a[92:95], a[188:191], v[96:99], a[92:95]
ds_read_b64_tr_b16 a[176:177], v222 offset:0
ds_read_b64_tr_b16 a[178:179], v222 offset:4096
v_mfma_f32_16x16x32_bf16 a[92:95], a[184:187], v[80:83], a[92:95]
v_exp_f32 v23, v23
v_mfma_f32_16x16x32_bf16 a[60:63], a[184:187], v[76:79], a[60:63]
v_cvt_pk_bf16_f32 v65, v26, v27
v_cvt_pk_bf16_f32 v68, v32, v33
v_mfma_f32_16x16x32_bf16 a[60:63], a[188:191], v[92:95], a[60:63]
s_add_u32 m0, s49, 7168
v_exp_f32 v28, v28
v_mfma_f32_16x16x32_bf16 a[28:31], a[188:191], v[88:91], a[28:31]
s_add_u32 s48, s90, 4866048
buffer_load_dwordx4 v238, s[60:63], s48 offen  lds
v_mfma_f32_16x16x32_bf16 a[28:31], a[184:187], v[72:75], a[28:31]
v_exp_f32 v29, v29
v_smfmac_f32_16x16x64_bf16 a[252:255], a[208:211], v[48:55], v235
s_waitcnt lgkmcnt(2)
ds_read_b64_tr_b16 a[188:189], v223 offset:8192
ds_read_b64_tr_b16 a[190:191], v223 offset:12288
v_mfma_f32_16x16x32_bf16 v[8:11], a[128:131], v[152:155], v[136:139]
v_exp_f32 v30, v30
v_mfma_f32_16x16x32_bf16 v[8:11], a[132:135], v[156:159], v[8:11]
s_add_u32 s39, s39, 16384
ds_read_b64_tr_b16 a[184:185], v223 offset:0
ds_read_b64_tr_b16 a[186:187], v223 offset:4096
v_mfma_f32_16x16x32_bf16 v[8:11], a[136:139], v[160:163], v[8:11]
s_add_u32 m0, s37, 16384
v_exp_f32 v31, v31
v_mfma_f32_16x16x32_bf16 v[8:11], a[140:143], v[164:167], v[8:11]
buffer_load_dwordx4 v228, s[8:11], s38 offen offset:0 lds
v_mfma_f32_16x16x32_bf16 v[16:19], a[140:143], v[180:183], v[140:143]
v_exp_f32 v36, v36
v_mfma_f32_16x16x32_bf16 v[16:19], a[136:139], v[176:179], v[16:19]
v_cvt_pk_bf16_f32 v69, v34, v35
v_cvt_pk_bf16_f32 v58, v12, v13
v_mfma_f32_16x16x32_bf16 v[16:19], a[132:135], v[172:175], v[16:19]
v_exp_f32 v37, v37
v_mfma_f32_16x16x32_bf16 v[16:19], a[128:131], v[168:171], v[16:19]
buffer_load_dwordx4 v229, s[8:11], s38 offen offset:1024 lds
v_mfma_f32_16x16x32_bf16 v[24:27], a[128:131], v[184:187], v[144:147]
v_exp_f32 v38, v38
v_mfma_f32_16x16x32_bf16 v[24:27], a[132:135], v[188:191], v[24:27]
v_cvt_pk_bf16_f32 v59, v14, v15
v_cvt_pk_bf16_f32 v62, v20, v21
v_mfma_f32_16x16x32_bf16 v[24:27], a[136:139], v[192:195], v[24:27]
v_exp_f32 v39, v39
v_mfma_f32_16x16x32_bf16 v[24:27], a[140:143], v[196:199], v[24:27]
v_cvt_pk_bf16_f32 v63, v22, v23
v_cvt_pk_bf16_f32 v66, v28, v29
v_mfma_f32_16x16x32_bf16 v[32:35], a[140:143], v[212:215], v[148:151]
v_cvt_pk_bf16_f32 v67, v30, v31
v_cvt_pk_bf16_f32 v70, v36, v37
v_mfma_f32_16x16x32_bf16 v[32:35], a[136:139], v[208:211], v[32:35]
ds_bpermute_b32 v5, v5, v254
v_cvt_pk_bf16_f32 v71, v38, v39
v_mfma_f32_16x16x32_bf16 v[32:35], a[132:135], v[204:207], v[32:35]
ds_bpermute_b32 v6, v6, v254
ds_bpermute_b32 v7, v7, v254
v_mfma_f32_16x16x32_bf16 v[32:35], a[128:131], v[200:203], v[32:35]
s_mul_i32 s91, s52, 36864
s_lshl_b32 s46, s32, 5
s_add_u32 s92, s91, s46
s_mul_i32 s46, s32, 1179648
s_add_u32 s50, s50, s46
s_lshl_b32 s46, s32, 8
s_add_u32 s91, s91, s46
s_and_b32 s47, s32, 1
s_lshl_b32 s47, s47, 6
s_add_u32 s47, s47, 1024
s_mov_b32 s88, 0x480
v_and_b32 v250, 3, v1
v_mfma_f32_16x16x32_bf16 a[0:3], a[160:163], v[40:43], a[0:3]
v_exp_f32 v8, v8
v_mfma_f32_16x16x32_bf16 a[0:3], a[164:167], v[56:59], a[0:3]
v_exp_f32 v9, v9
v_mfma_f32_16x16x32_bf16 a[32:35], a[164:167], v[60:63], a[32:35]
buffer_load_dwordx4 v230, s[8:11], s38 offen offset:2048 lds
v_mfma_f32_16x16x32_bf16 a[32:35], a[160:163], v[44:47], a[32:35]
v_exp_f32 v10, v10
v_mfma_f32_16x16x32_bf16 a[64:67], a[160:163], v[48:51], a[64:67]
v_cvt_pk_bf16_f32 v72, v8, v9
v_lshlrev_b32 v244, 1, v4
v_mfma_f32_16x16x32_bf16 a[64:67], a[164:167], v[64:67], a[64:67]
v_exp_f32 v11, v11
v_mfma_f32_16x16x32_bf16 a[96:99], a[164:167], v[68:71], a[96:99]
ds_read_b64_tr_b16 a[164:165], v224 offset:8192
ds_read_b64_tr_b16 a[166:167], v224 offset:12288
v_mfma_f32_16x16x32_bf16 a[96:99], a[160:163], v[52:55], a[96:99]
v_exp_f32 v16, v16
v_mfma_f32_16x16x32_bf16 a[100:103], a[168:171], v[52:55], a[100:103]
ds_read_b64_tr_b16 a[160:161], v224 offset:0
ds_read_b64_tr_b16 a[162:163], v224 offset:4096
v_mfma_f32_16x16x32_bf16 a[100:103], a[172:175], v[68:71], a[100:103]
v_exp_f32 v17, v17
v_mfma_f32_16x16x32_bf16 a[68:71], a[172:175], v[64:67], a[68:71]
v_cvt_pk_bf16_f32 v73, v10, v11
v_cvt_pk_bf16_f32 v76, v16, v17
v_mfma_f32_16x16x32_bf16 a[68:71], a[168:171], v[48:51], a[68:71]
v_exp_f32 v18, v18
v_mfma_f32_16x16x32_bf16 a[36:39], a[168:171], v[44:47], a[36:39]
v_xor_b32 v244, v244, v3
v_lshlrev_b32 v244, 4, v244
v_mfma_f32_16x16x32_bf16 a[36:39], a[172:175], v[60:63], a[36:39]
v_exp_f32 v19, v19
v_mfma_f32_16x16x32_bf16 a[4:7], a[172:175], v[56:59], a[4:7]
buffer_load_dwordx4 v231, s[8:11], s38 offen offset:3072 lds
v_mfma_f32_16x16x32_bf16 a[4:7], a[168:171], v[40:43], a[4:7]
v_exp_f32 v24, v24
v_smfmac_f32_16x16x64_bf16 a[248:251], a[208:211], v[56:63], v235
ds_read_b64_tr_b16 a[172:173], v225 offset:8192
ds_read_b64_tr_b16 a[174:175], v225 offset:12288
v_mfma_f32_16x16x32_bf16 v[12:15], a[144:147], v[152:155], v[136:139]
v_exp_f32 v25, v25
v_mfma_f32_16x16x32_bf16 v[12:15], a[148:151], v[156:159], v[12:15]
ds_read_b64_tr_b16 a[168:169], v225 offset:0
ds_read_b64_tr_b16 a[170:171], v225 offset:4096
v_mfma_f32_16x16x32_bf16 v[12:15], a[152:155], v[160:163], v[12:15]
v_exp_f32 v26, v26
v_mfma_f32_16x16x32_bf16 v[12:15], a[156:159], v[164:167], v[12:15]
ds_read_b128 a[128:131], v216 offset:57344
ds_read_b128 a[132:135], v217 offset:57344
v_mfma_f32_16x16x32_bf16 v[20:23], a[156:159], v[180:183], v[140:143]
v_exp_f32 v27, v27
v_mfma_f32_16x16x32_bf16 v[20:23], a[152:155], v[176:179], v[20:23]
ds_read_b128 a[136:139], v218 offset:57344
v_cvt_pk_bf16_f32 v77, v18, v19
v_mfma_f32_16x16x32_bf16 v[20:23], a[148:151], v[172:175], v[20:23]
v_exp_f32 v32, v32
v_mfma_f32_16x16x32_bf16 v[20:23], a[144:147], v[168:171], v[20:23]
ds_read_b128 a[140:143], v219 offset:57344
v_cvt_pk_bf16_f32 v80, v24, v25
v_mfma_f32_16x16x32_bf16 v[28:31], a[144:147], v[184:187], v[144:147]
s_add_u32 s38, s38, 16384
v_exp_f32 v33, v33
v_mfma_f32_16x16x32_bf16 v[28:31], a[148:151], v[188:191], v[28:31]
s_add_u32 m0, s37, 114688
v_cvt_pk_bf16_f32 v81, v26, v27
v_cvt_pk_bf16_f32 v84, v32, v33
v_mfma_f32_16x16x32_bf16 v[28:31], a[152:155], v[192:195], v[28:31]
v_exp_f32 v34, v34
v_mfma_f32_16x16x32_bf16 v[28:31], a[156:159], v[196:199], v[28:31]
buffer_load_dwordx4 v232, s[12:15], s39 offen offset:0 lds
v_mfma_f32_16x16x32_bf16 v[36:39], a[156:159], v[212:215], v[148:151]
v_exp_f32 v35, v35
v_mfma_f32_16x16x32_bf16 v[36:39], a[152:155], v[208:211], v[36:39]
ds_read_b128 a[156:159], v219 offset:61440
ds_read_b128 a[152:155], v218 offset:61440
v_mfma_f32_16x16x32_bf16 v[36:39], a[148:151], v[204:207], v[36:39]
v_exp_f32 v12, v12
v_mfma_f32_16x16x32_bf16 v[36:39], a[144:147], v[200:203], v[36:39]
s_waitcnt lgkmcnt(3)
v_exp_f32 v13, v13
v_mfma_f32_16x16x32_bf16 a[8:11], a[176:179], v[40:43], a[8:11]
ds_read_b128 a[148:151], v217 offset:61440
ds_read_b128 a[144:147], v216 offset:61440
v_mfma_f32_16x16x32_bf16 a[8:11], a[180:183], v[56:59], a[8:11]
v_exp_f32 v14, v14
v_mfma_f32_16x16x32_bf16 a[40:43], a[180:183], v[60:63], a[40:43]
v_cvt_pk_bf16_f32 v85, v34, v35
v_cvt_pk_bf16_f32 v74, v12, v13
v_mfma_f32_16x16x32_bf16 a[40:43], a[176:179], v[44:47], a[40:43]
v_exp_f32 v15, v15
v_mfma_f32_16x16x32_bf16 a[72:75], a[176:179], v[48:51], a[72:75]
v_cvt_pk_bf16_f32 v75, v14, v15
v_xor_b32 v245, 128, v244
v_mfma_f32_16x16x32_bf16 a[72:75], a[180:183], v[64:67], a[72:75]
v_exp_f32 v20, v20
v_mfma_f32_16x16x32_bf16 a[104:107], a[180:183], v[68:71], a[104:107]
buffer_load_dwordx4 v233, s[12:15], s39 offen offset:1024 lds
v_mfma_f32_16x16x32_bf16 a[104:107], a[176:179], v[52:55], a[104:107]
v_exp_f32 v21, v21
v_mfma_f32_16x16x32_bf16 a[108:111], a[184:187], v[52:55], a[108:111]
ds_read_b64_tr_b16 a[180:181], v226 offset:8192
ds_read_b64_tr_b16 a[182:183], v226 offset:12288
v_mfma_f32_16x16x32_bf16 a[108:111], a[188:191], v[68:71], a[108:111]
v_exp_f32 v22, v22
v_mfma_f32_16x16x32_bf16 a[76:79], a[188:191], v[64:67], a[76:79]
ds_read_b64_tr_b16 a[176:177], v226 offset:0
ds_read_b64_tr_b16 a[178:179], v226 offset:4096
v_mfma_f32_16x16x32_bf16 a[76:79], a[184:187], v[48:51], a[76:79]
v_exp_f32 v23, v23
v_mfma_f32_16x16x32_bf16 a[44:47], a[184:187], v[44:47], a[44:47]
v_cvt_pk_bf16_f32 v78, v20, v21
v_cvt_pk_bf16_f32 v79, v22, v23
v_mfma_f32_16x16x32_bf16 a[44:47], a[188:191], v[60:63], a[44:47]
v_exp_f32 v28, v28
v_mfma_f32_16x16x32_bf16 a[12:15], a[188:191], v[56:59], a[12:15]
ds_read_b64_tr_b16 a[188:189], v227 offset:8192
ds_read_b64_tr_b16 a[190:191], v227 offset:12288
v_mfma_f32_16x16x32_bf16 a[12:15], a[184:187], v[40:43], a[12:15]
v_exp_f32 v29, v29
v_smfmac_f32_16x16x64_bf16 a[252:255], a[208:211], v[64:71], v235
ds_read_b64_tr_b16 a[184:185], v227 offset:0
ds_read_b64_tr_b16 a[186:187], v227 offset:4096
v_mfma_f32_16x16x32_bf16 v[8:11], a[128:131], v[152:155], v[136:139]
v_exp_f32 v30, v30
v_mfma_f32_16x16x32_bf16 v[8:11], a[132:135], v[156:159], v[8:11]
buffer_load_dwordx4 v232, s[12:15], s39 offen offset:2048 lds
v_mfma_f32_16x16x32_bf16 v[8:11], a[136:139], v[160:163], v[8:11]
s_waitcnt lgkmcnt(6)
v_exp_f32 v31, v31
v_mfma_f32_16x16x32_bf16 v[8:11], a[140:143], v[164:167], v[8:11]
v_cvt_pk_bf16_f32 v82, v28, v29
v_cvt_pk_bf16_f32 v83, v30, v31
v_mfma_f32_16x16x32_bf16 v[16:19], a[140:143], v[180:183], v[140:143]
v_exp_f32 v36, v36
v_mfma_f32_16x16x32_bf16 v[16:19], a[136:139], v[176:179], v[16:19]
v_subrev_u32 v244, 0x480, v244
v_subrev_u32 v245, 0x480, v245
v_mfma_f32_16x16x32_bf16 v[16:19], a[132:135], v[172:175], v[16:19]
v_exp_f32 v37, v37
v_mfma_f32_16x16x32_bf16 v[16:19], a[128:131], v[168:171], v[16:19]
v_cvt_pk_bf16_f32 v86, v36, v37
v_lshlrev_b32 v246, 4, v250
v_mfma_f32_16x16x32_bf16 v[24:27], a[128:131], v[184:187], v[144:147]
v_exp_f32 v38, v38
v_mfma_f32_16x16x32_bf16 v[24:27], a[132:135], v[188:191], v[24:27]
v_subrev_u32 v246, 0x480, v246
v_mad_u32_u24 v5, v5, s88, v244
v_mfma_f32_16x16x32_bf16 v[24:27], a[136:139], v[192:195], v[24:27]
v_exp_f32 v39, v39
v_mfma_f32_16x16x32_bf16 v[24:27], a[140:143], v[196:199], v[24:27]
v_cvt_pk_bf16_f32 v87, v38, v39
v_mad_u32_u24 v6, v6, s88, v245
v_mfma_f32_16x16x32_bf16 v[32:35], a[140:143], v[212:215], v[148:151]
v_mad_u32_u24 v7, v7, s88, v246
v_lshrrev_b32 v249, 1, v1
v_mfma_f32_16x16x32_bf16 v[32:35], a[136:139], v[208:211], v[32:35]
v_mul_u32_u24 v249, 0x480, v249
v_and_b32 v248, 1, v1
v_mfma_f32_16x16x32_bf16 v[32:35], a[132:135], v[204:207], v[32:35]
v_lshl_add_u32 v249, v248, 4, v249
v_bfe_u32 v248, v1, 2, 2
v_mfma_f32_16x16x32_bf16 v[32:35], a[128:131], v[200:203], v[32:35]
v_lshl_add_u32 v248, v4, 3, v248
v_lshlrev_b32 v248, 6, v248
v_lshl_add_u32 v248, v250, 3, v248
v_mfma_f32_16x16x32_bf16 a[16:19], a[160:163], v[40:43], a[16:19]
v_exp_f32 v8, v8
v_mfma_f32_16x16x32_bf16 a[16:19], a[164:167], v[56:59], a[16:19]
s_add_u32 m0, s49, 0
v_exp_f32 v9, v9
v_mfma_f32_16x16x32_bf16 a[48:51], a[164:167], v[60:63], a[48:51]
buffer_load_dwordx4 v5, s[20:23], s46 offen sc0 sc1 lds
v_mfma_f32_16x16x32_bf16 a[48:51], a[160:163], v[44:47], a[48:51]
v_exp_f32 v10, v10
v_mfma_f32_16x16x32_bf16 a[80:83], a[160:163], v[48:51], a[80:83]
v_cvt_pk_bf16_f32 v88, v8, v9
v_add_u32 v248, s49, v248
v_mfma_f32_16x16x32_bf16 a[80:83], a[164:167], v[64:67], a[80:83]
v_exp_f32 v11, v11
v_mfma_f32_16x16x32_bf16 a[112:115], a[164:167], v[68:71], a[112:115]
ds_read_b64_tr_b16 a[164:165], v220 offset:24576
ds_read_b64_tr_b16 a[166:167], v220 offset:28672
v_mfma_f32_16x16x32_bf16 a[112:115], a[160:163], v[52:55], a[112:115]
s_add_u32 m0, s49, 1024
v_exp_f32 v16, v16
v_mfma_f32_16x16x32_bf16 a[116:119], a[168:171], v[52:55], a[116:119]
buffer_load_dwordx4 v6, s[20:23], s46 offen sc0 sc1 lds
v_mfma_f32_16x16x32_bf16 a[116:119], a[172:175], v[68:71], a[116:119]
v_exp_f32 v17, v17
v_mfma_f32_16x16x32_bf16 a[84:87], a[172:175], v[64:67], a[84:87]
ds_read_b64_tr_b16 a[160:161], v220 offset:16384
ds_read_b64_tr_b16 a[162:163], v220 offset:20480
v_mfma_f32_16x16x32_bf16 a[84:87], a[168:171], v[48:51], a[84:87]
v_exp_f32 v18, v18
v_mfma_f32_16x16x32_bf16 a[52:55], a[168:171], v[44:47], a[52:55]
v_cvt_pk_bf16_f32 v89, v10, v11
v_cvt_pk_bf16_f32 v92, v16, v17
v_mfma_f32_16x16x32_bf16 a[52:55], a[172:175], v[60:63], a[52:55]
v_exp_f32 v19, v19
v_mfma_f32_16x16x32_bf16 a[20:23], a[172:175], v[56:59], a[20:23]
s_add_u32 m0, s49, 2048
ds_read_b64_tr_b16 a[172:173], v221 offset:24576
ds_read_b64_tr_b16 a[174:175], v221 offset:28672
v_mfma_f32_16x16x32_bf16 a[20:23], a[168:171], v[40:43], a[20:23]
v_exp_f32 v24, v24
v_smfmac_f32_16x16x64_bf16 a[248:251], a[208:211], v[72:79], v235
buffer_load_dwordx4 v7, s[20:23], s47 offen sc0 sc1 lds
v_mfma_f32_16x16x32_bf16 v[12:15], a[144:147], v[152:155], v[136:139]
v_exp_f32 v25, v25
v_mfma_f32_16x16x32_bf16 v[12:15], a[148:151], v[156:159], v[12:15]
ds_read_b64_tr_b16 a[168:169], v221 offset:16384
ds_read_b64_tr_b16 a[170:171], v221 offset:20480
v_mfma_f32_16x16x32_bf16 v[12:15], a[152:155], v[160:163], v[12:15]
v_exp_f32 v26, v26
v_mfma_f32_16x16x32_bf16 v[12:15], a[156:159], v[164:167], v[12:15]
ds_read_b128 a[128:131], v216 offset:32768
ds_read_b128 a[132:135], v217 offset:32768
v_mfma_f32_16x16x32_bf16 v[20:23], a[156:159], v[180:183], v[140:143]
s_add_u32 m0, s49, 3072
v_exp_f32 v27, v27
v_mfma_f32_16x16x32_bf16 v[20:23], a[152:155], v[176:179], v[20:23]
s_add_u32 s48, s92, 1024
buffer_load_dwordx4 v249, s[64:67], s48 offen  lds
v_mfma_f32_16x16x32_bf16 v[20:23], a[148:151], v[172:175], v[20:23]
v_exp_f32 v32, v32
v_mfma_f32_16x16x32_bf16 v[20:23], a[144:147], v[168:171], v[20:23]
ds_read_b128 a[136:139], v218 offset:32768
ds_read_b128 a[140:143], v219 offset:32768
v_mfma_f32_16x16x32_bf16 v[28:31], a[144:147], v[184:187], v[144:147]
v_exp_f32 v33, v33
v_mfma_f32_16x16x32_bf16 v[28:31], a[148:151], v[188:191], v[28:31]
v_cvt_pk_bf16_f32 v93, v18, v19
v_cvt_pk_bf16_f32 v96, v24, v25
v_mfma_f32_16x16x32_bf16 v[28:31], a[152:155], v[192:195], v[28:31]
v_exp_f32 v34, v34
v_mfma_f32_16x16x32_bf16 v[28:31], a[156:159], v[196:199], v[28:31]
s_add_u32 m0, s37, 114688
v_cvt_pk_bf16_f32 v97, v26, v27
v_cvt_pk_bf16_f32 v100, v32, v33
v_mfma_f32_16x16x32_bf16 v[36:39], a[156:159], v[212:215], v[148:151]
v_exp_f32 v35, v35
v_mfma_f32_16x16x32_bf16 v[36:39], a[152:155], v[208:211], v[36:39]
buffer_load_dwordx4 v233, s[12:15], s39 offen offset:3072 lds
v_mfma_f32_16x16x32_bf16 v[36:39], a[148:151], v[204:207], v[36:39]
v_exp_f32 v12, v12
v_mfma_f32_16x16x32_bf16 v[36:39], a[144:147], v[200:203], v[36:39]
s_waitcnt lgkmcnt(2)
v_exp_f32 v13, v13
v_mfma_f32_16x16x32_bf16 a[24:27], a[176:179], v[40:43], a[24:27]
ds_read_b128 a[156:159], v219 offset:36864
ds_read_b128 a[152:155], v218 offset:36864
v_mfma_f32_16x16x32_bf16 a[24:27], a[180:183], v[56:59], a[24:27]
v_exp_f32 v14, v14
v_mfma_f32_16x16x32_bf16 a[56:59], a[180:183], v[60:63], a[56:59]
s_add_u32 s39, s39, 16384
ds_read_b128 a[148:151], v217 offset:36864
ds_read_b128 a[144:147], v216 offset:36864
v_mfma_f32_16x16x32_bf16 a[56:59], a[176:179], v[44:47], a[56:59]
s_add_u32 m0, s37, 0
v_exp_f32 v15, v15
v_mfma_f32_16x16x32_bf16 a[88:91], a[176:179], v[48:51], a[88:91]
buffer_load_dwordx4 v228, s[8:11], s38 offen offset:0 lds
v_mfma_f32_16x16x32_bf16 a[88:91], a[180:183], v[64:67], a[88:91]
v_exp_f32 v20, v20
v_mfma_f32_16x16x32_bf16 a[120:123], a[180:183], v[68:71], a[120:123]
ds_read_b64_tr_b16 a[180:181], v222 offset:24576
ds_read_b64_tr_b16 a[182:183], v222 offset:28672
v_mfma_f32_16x16x32_bf16 a[120:123], a[176:179], v[52:55], a[120:123]
v_exp_f32 v21, v21
v_mfma_f32_16x16x32_bf16 a[124:127], a[184:187], v[52:55], a[124:127]
ds_read_b64_tr_b16 a[176:177], v222 offset:16384
ds_read_b64_tr_b16 a[178:179], v222 offset:20480
v_mfma_f32_16x16x32_bf16 a[124:127], a[188:191], v[68:71], a[124:127]
v_exp_f32 v22, v22
v_mfma_f32_16x16x32_bf16 a[92:95], a[188:191], v[64:67], a[92:95]
buffer_load_dwordx4 v229, s[8:11], s38 offen offset:1024 lds
v_mfma_f32_16x16x32_bf16 a[92:95], a[184:187], v[48:51], a[92:95]
v_exp_f32 v23, v23
v_mfma_f32_16x16x32_bf16 a[60:63], a[184:187], v[44:47], a[60:63]
v_cvt_pk_bf16_f32 v101, v34, v35
v_cvt_pk_bf16_f32 v90, v12, v13
v_mfma_f32_16x16x32_bf16 a[60:63], a[188:191], v[60:63], a[60:63]
v_exp_f32 v28, v28
v_mfma_f32_16x16x32_bf16 a[28:31], a[188:191], v[56:59], a[28:31]
ds_read_b64_tr_b16 a[188:189], v223 offset:24576
ds_read_b64_tr_b16 a[190:191], v223 offset:28672
v_mfma_f32_16x16x32_bf16 a[28:31], a[184:187], v[40:43], a[28:31]
v_exp_f32 v29, v29
v_smfmac_f32_16x16x64_bf16 a[252:255], a[208:211], v[80:87], v235
buffer_load_dwordx4 v230, s[8:11], s38 offen offset:2048 lds
v_mfma_f32_16x16x32_bf16 v[8:11], a[128:131], v[152:155], v[136:139]
v_exp_f32 v30, v30
v_mfma_f32_16x16x32_bf16 v[8:11], a[132:135], v[156:159], v[8:11]
s_waitcnt lgkmcnt(2)
ds_read_b64_tr_b16 a[184:185], v223 offset:16384
ds_read_b64_tr_b16 a[186:187], v223 offset:20480
v_mfma_f32_16x16x32_bf16 v[8:11], a[136:139], v[160:163], v[8:11]
v_exp_f32 v31, v31
v_mfma_f32_16x16x32_bf16 v[8:11], a[140:143], v[164:167], v[8:11]
v_cvt_pk_bf16_f32 v91, v14, v15
v_cvt_pk_bf16_f32 v94, v20, v21
v_mfma_f32_16x16x32_bf16 v[16:19], a[140:143], v[180:183], v[140:143]
v_exp_f32 v36, v36
v_mfma_f32_16x16x32_bf16 v[16:19], a[136:139], v[176:179], v[16:19]
v_cvt_pk_bf16_f32 v95, v22, v23
v_cvt_pk_bf16_f32 v98, v28, v29
v_mfma_f32_16x16x32_bf16 v[16:19], a[132:135], v[172:175], v[16:19]
v_exp_f32 v37, v37
v_mfma_f32_16x16x32_bf16 v[16:19], a[128:131], v[168:171], v[16:19]
buffer_load_dwordx4 v231, s[8:11], s38 offen offset:3072 lds
v_mfma_f32_16x16x32_bf16 v[24:27], a[128:131], v[184:187], v[144:147]
v_exp_f32 v38, v38
v_mfma_f32_16x16x32_bf16 v[24:27], a[132:135], v[188:191], v[24:27]
v_cvt_pk_bf16_f32 v99, v30, v31
v_cvt_pk_bf16_f32 v102, v36, v37
v_mfma_f32_16x16x32_bf16 v[24:27], a[136:139], v[192:195], v[24:27]
v_exp_f32 v39, v39
v_mfma_f32_16x16x32_bf16 v[24:27], a[140:143], v[196:199], v[24:27]
v_cvt_pk_bf16_f32 v103, v38, v39
v_and_b32 v244, 7, v1
v_mfma_f32_16x16x32_bf16 v[32:35], a[140:143], v[212:215], v[148:151]
v_lshlrev_b32 v245, 1, v244
v_xor_b32 v245, v245, v4
v_mfma_f32_16x16x32_bf16 v[32:35], a[136:139], v[208:211], v[32:35]
s_add_u32 s38, s38, 16384
v_lshlrev_b32 v245, 4, v245
v_lshl_add_u32 v245, v244, 8, v245
v_mfma_f32_16x16x32_bf16 v[32:35], a[132:135], v[204:207], v[32:35]
v_add_u32 v245, s49, v245
v_lshlrev_b32 v246, 4, v4
v_mfma_f32_16x16x32_bf16 v[32:35], a[128:131], v[200:203], v[32:35]
v_lshl_add_u32 v246, v244, 6, v246
s_cmp_lt_u32 s32, 2
s_cselect_b64 s[88:89], -1, 0
v_mfma_f32_16x16x32_bf16 a[0:3], a[160:163], v[72:75], a[0:3]
v_exp_f32 v8, v8
v_mfma_f32_16x16x32_bf16 a[0:3], a[164:167], v[88:91], a[0:3]
v_exp_f32 v9, v9
v_mfma_f32_16x16x32_bf16 a[32:35], a[164:167], v[92:95], a[32:35]
buffer_load_dwordx2 v[252:253], v251, s[76:79], s42 offen sc1
v_mfma_f32_16x16x32_bf16 a[32:35], a[160:163], v[76:79], a[32:35]
v_exp_f32 v10, v10
v_mfma_f32_16x16x32_bf16 a[64:67], a[160:163], v[80:83], a[64:67]
v_cvt_pk_bf16_f32 v40, v8, v9
v_add_u32 v246, s49, v246
v_mfma_f32_16x16x32_bf16 a[64:67], a[164:167], v[96:99], a[64:67]
v_exp_f32 v11, v11
v_mfma_f32_16x16x32_bf16 a[96:99], a[164:167], v[100:103], a[96:99]
ds_read_b64_tr_b16 a[164:165], v224 offset:24576
ds_read_b64_tr_b16 a[166:167], v224 offset:28672
v_mfma_f32_16x16x32_bf16 a[96:99], a[160:163], v[84:87], a[96:99]
v_exp_f32 v16, v16
v_mfma_f32_16x16x32_bf16 a[100:103], a[168:171], v[84:87], a[100:103]
ds_read_b64_tr_b16 a[160:161], v224 offset:16384
ds_read_b64_tr_b16 a[162:163], v224 offset:20480
v_mfma_f32_16x16x32_bf16 a[100:103], a[172:175], v[100:103], a[100:103]
v_exp_f32 v17, v17
v_mfma_f32_16x16x32_bf16 a[68:71], a[172:175], v[96:99], a[68:71]
v_cvt_pk_bf16_f32 v41, v10, v11
v_cvt_pk_bf16_f32 v44, v16, v17
v_mfma_f32_16x16x32_bf16 a[68:71], a[168:171], v[80:83], a[68:71]
v_exp_f32 v18, v18
v_mfma_f32_16x16x32_bf16 a[36:39], a[168:171], v[76:79], a[36:39]
v_xor_b32 v5, 64, v245
v_xor_b32 v6, 128, v245
v_mfma_f32_16x16x32_bf16 a[36:39], a[172:175], v[92:95], a[36:39]
v_exp_f32 v19, v19
v_mfma_f32_16x16x32_bf16 a[4:7], a[172:175], v[88:91], a[4:7]
ds_read_b64_tr_b16 a[172:173], v225 offset:24576
ds_read_b64_tr_b16 a[174:175], v225 offset:28672
v_mfma_f32_16x16x32_bf16 a[4:7], a[168:171], v[72:75], a[4:7]
v_exp_f32 v24, v24
v_smfmac_f32_16x16x64_bf16 a[248:251], a[208:211], v[88:95], v235
s_add_u32 s42, s42, s43
buffer_load_dword v255, v243, s[28:31], s45 offen
v_mfma_f32_16x16x32_bf16 v[12:15], a[144:147], v[152:155], v[136:139]
v_exp_f32 v25, v25
v_mfma_f32_16x16x32_bf16 v[12:15], a[148:151], v[156:159], v[12:15]
ds_read_b64_tr_b16 a[168:169], v225 offset:16384
ds_read_b64_tr_b16 a[170:171], v225 offset:20480
v_mfma_f32_16x16x32_bf16 v[12:15], a[152:155], v[160:163], v[12:15]
v_exp_f32 v26, v26
v_mfma_f32_16x16x32_bf16 v[12:15], a[156:159], v[164:167], v[12:15]
ds_read_b128 a[128:131], v216 offset:40960
ds_read_b128 a[132:135], v217 offset:40960
v_mfma_f32_16x16x32_bf16 v[20:23], a[156:159], v[180:183], v[140:143]
v_exp_f32 v27, v27
v_mfma_f32_16x16x32_bf16 v[20:23], a[152:155], v[176:179], v[20:23]
ds_read_b128 a[136:139], v218 offset:40960
v_cvt_pk_bf16_f32 v45, v18, v19
v_mfma_f32_16x16x32_bf16 v[20:23], a[148:151], v[172:175], v[20:23]
v_exp_f32 v32, v32
v_mfma_f32_16x16x32_bf16 v[20:23], a[144:147], v[168:171], v[20:23]
ds_read_b128 a[140:143], v219 offset:40960
v_cvt_pk_bf16_f32 v48, v24, v25
v_mfma_f32_16x16x32_bf16 v[28:31], a[144:147], v[184:187], v[144:147]
v_exp_f32 v33, v33
v_mfma_f32_16x16x32_bf16 v[28:31], a[148:151], v[188:191], v[28:31]
v_cvt_pk_bf16_f32 v49, v26, v27
v_cvt_pk_bf16_f32 v52, v32, v33
v_mfma_f32_16x16x32_bf16 v[28:31], a[152:155], v[192:195], v[28:31]
v_exp_f32 v34, v34
v_mfma_f32_16x16x32_bf16 v[28:31], a[156:159], v[196:199], v[28:31]
v_xor_b32 v7, 192, v245
v_lshrrev_b32 v249, 2, v1
v_mfma_f32_16x16x32_bf16 v[36:39], a[156:159], v[212:215], v[148:151]
v_exp_f32 v35, v35
v_mfma_f32_16x16x32_bf16 v[36:39], a[152:155], v[208:211], v[36:39]
ds_read_b128 a[156:159], v219 offset:45056
ds_read_b128 a[152:155], v218 offset:45056
v_mfma_f32_16x16x32_bf16 v[36:39], a[148:151], v[204:207], v[36:39]
v_exp_f32 v12, v12
v_mfma_f32_16x16x32_bf16 v[36:39], a[144:147], v[200:203], v[36:39]
s_add_u32 s45, s45, 589824
v_exp_f32 v13, v13
v_mfma_f32_16x16x32_bf16 a[8:11], a[176:179], v[72:75], a[8:11]
global_load_dword v255, v242, s[72:73]
v_mfma_f32_16x16x32_bf16 a[8:11], a[180:183], v[88:91], a[8:11]
v_exp_f32 v14, v14
v_mfma_f32_16x16x32_bf16 a[40:43], a[180:183], v[92:95], a[40:43]
ds_read_b128 a[148:151], v217 offset:45056
ds_read_b128 a[144:147], v216 offset:45056
v_mfma_f32_16x16x32_bf16 a[40:43], a[176:179], v[76:79], a[40:43]
v_exp_f32 v15, v15
v_mfma_f32_16x16x32_bf16 a[72:75], a[176:179], v[80:83], a[72:75]
v_cvt_pk_bf16_f32 v53, v34, v35
v_cvt_pk_bf16_f32 v42, v12, v13
v_mfma_f32_16x16x32_bf16 a[72:75], a[180:183], v[96:99], a[72:75]
v_exp_f32 v20, v20
v_mfma_f32_16x16x32_bf16 a[104:107], a[180:183], v[100:103], a[104:107]
ds_read_b64_tr_b16 a[180:181], v226 offset:24576
ds_read_b64_tr_b16 a[182:183], v226 offset:28672
v_mfma_f32_16x16x32_bf16 a[104:107], a[176:179], v[84:87], a[104:107]
s_waitcnt lgkmcnt(4)
v_exp_f32 v21, v21
v_mfma_f32_16x16x32_bf16 a[108:111], a[184:187], v[84:87], a[108:111]
ds_read_b64_tr_b16 a[176:177], v226 offset:16384
ds_read_b64_tr_b16 a[178:179], v226 offset:20480
v_mfma_f32_16x16x32_bf16 a[108:111], a[188:191], v[100:103], a[108:111]
v_exp_f32 v22, v22
v_mfma_f32_16x16x32_bf16 a[76:79], a[188:191], v[96:99], a[76:79]
v_cvt_pk_bf16_f32 v43, v14, v15
v_cvt_pk_bf16_f32 v46, v20, v21
v_mfma_f32_16x16x32_bf16 a[76:79], a[184:187], v[80:83], a[76:79]
v_exp_f32 v23, v23
v_mfma_f32_16x16x32_bf16 a[44:47], a[184:187], v[76:79], a[44:47]
v_cvt_pk_bf16_f32 v47, v22, v23
v_lshlrev_b32 v249, 5, v249
v_mfma_f32_16x16x32_bf16 a[44:47], a[188:191], v[92:95], a[44:47]
v_exp_f32 v28, v28
v_mfma_f32_16x16x32_bf16 a[12:15], a[188:191], v[88:91], a[12:15]
buffer_load_dword v255, v0, s[24:27], s44 offen
v_mfma_f32_16x16x32_bf16 a[12:15], a[184:187], v[72:75], a[12:15]
v_exp_f32 v29, v29
v_smfmac_f32_16x16x64_bf16 a[252:255], a[208:211], v[96:103], v235
ds_read_b64_tr_b16 a[188:189], v227 offset:24576
ds_read_b64_tr_b16 a[190:191], v227 offset:28672
v_mfma_f32_16x16x32_bf16 v[8:11], a[128:131], v[152:155], v[136:139]
v_exp_f32 v30, v30
v_mfma_f32_16x16x32_bf16 v[8:11], a[132:135], v[156:159], v[8:11]
ds_read_b64_tr_b16 a[184:185], v227 offset:16384
ds_read_b64_tr_b16 a[186:187], v227 offset:20480
v_mfma_f32_16x16x32_bf16 v[8:11], a[136:139], v[160:163], v[8:11]
v_exp_f32 v31, v31
v_mfma_f32_16x16x32_bf16 v[8:11], a[140:143], v[164:167], v[8:11]
v_cvt_pk_bf16_f32 v50, v28, v29
v_cvt_pk_bf16_f32 v51, v30, v31
v_mfma_f32_16x16x32_bf16 v[16:19], a[140:143], v[180:183], v[140:143]
v_exp_f32 v36, v36
v_mfma_f32_16x16x32_bf16 v[16:19], a[136:139], v[176:179], v[16:19]
v_lshl_add_u32 v249, v250, 3, v249
v_add_u32 v249, s49, v249
v_mfma_f32_16x16x32_bf16 v[16:19], a[132:135], v[172:175], v[16:19]
v_exp_f32 v37, v37
v_mfma_f32_16x16x32_bf16 v[16:19], a[128:131], v[168:171], v[16:19]
v_cvt_pk_bf16_f32 v54, v36, v37
v_mfma_f32_16x16x32_bf16 v[24:27], a[128:131], v[184:187], v[144:147]
v_exp_f32 v38, v38
v_mfma_f32_16x16x32_bf16 v[24:27], a[132:135], v[188:191], v[24:27]
v_mfma_f32_16x16x32_bf16 v[24:27], a[136:139], v[192:195], v[24:27]
v_exp_f32 v39, v39
v_mfma_f32_16x16x32_bf16 v[24:27], a[140:143], v[196:199], v[24:27]
v_cvt_pk_bf16_f32 v55, v38, v39
v_mfma_f32_16x16x32_bf16 v[32:35], a[140:143], v[212:215], v[148:151]
v_mfma_f32_16x16x32_bf16 v[32:35], a[136:139], v[208:211], v[32:35]
s_add_u32 s44, s44, 4096
v_mfma_f32_16x16x32_bf16 v[32:35], a[132:135], v[204:207], v[32:35]
v_mfma_f32_16x16x32_bf16 v[32:35], a[128:131], v[200:203], v[32:35]
v_mfma_f32_16x16x32_bf16 a[16:19], a[160:163], v[72:75], a[16:19]
v_exp_f32 v8, v8
v_mfma_f32_16x16x32_bf16 a[16:19], a[164:167], v[88:91], a[16:19]
v_exp_f32 v9, v9
v_mfma_f32_16x16x32_bf16 a[48:51], a[164:167], v[92:95], a[48:51]
v_cvt_pk_bf16_f32 v56, v8, v9
v_mfma_f32_16x16x32_bf16 a[48:51], a[160:163], v[76:79], a[48:51]
v_exp_f32 v10, v10
v_mfma_f32_16x16x32_bf16 a[80:83], a[160:163], v[80:83], a[80:83]
v_mfma_f32_16x16x32_bf16 a[80:83], a[164:167], v[96:99], a[80:83]
v_exp_f32 v11, v11
s_waitcnt vmcnt(4) lgkmcnt(0)
s_barrier
v_mfma_f32_16x16x32_bf16 a[112:115], a[164:167], v[100:103], a[112:115]
ds_read_b64_tr_b16 a[164:165], v220 offset:40960
ds_read_b64_tr_b16 a[166:167], v220 offset:45056
v_mfma_f32_16x16x32_bf16 a[112:115], a[160:163], v[84:87], a[112:115]
s_add_u32 m0, s37, 65536
v_exp_f32 v16, v16
v_mfma_f32_16x16x32_bf16 a[116:119], a[168:171], v[84:87], a[116:119]
s_waitcnt vmcnt(9)
s_nop 0
buffer_load_dwordx4 v232, s[12:15], s39 offen offset:0 lds
v_mfma_f32_16x16x32_bf16 a[116:119], a[172:175], v[100:103], a[116:119]
v_exp_f32 v17, v17
v_mfma_f32_16x16x32_bf16 a[84:87], a[172:175], v[96:99], a[84:87]
ds_read_b64_tr_b16 a[160:161], v220 offset:32768
ds_read_b64_tr_b16 a[162:163], v220 offset:36864
v_mfma_f32_16x16x32_bf16 a[84:87], a[168:171], v[80:83], a[84:87]
v_exp_f32 v18, v18
v_mfma_f32_16x16x32_bf16 a[52:55], a[168:171], v[76:79], a[52:55]
v_cvt_pk_bf16_f32 v57, v10, v11
v_cvt_pk_bf16_f32 v60, v16, v17
v_mfma_f32_16x16x32_bf16 a[52:55], a[172:175], v[92:95], a[52:55]
v_exp_f32 v19, v19
v_mfma_f32_16x16x32_bf16 a[20:23], a[172:175], v[88:91], a[20:23]
ds_read_b64_tr_b16 a[172:173], v221 offset:40960
ds_read_b64_tr_b16 a[174:175], v221 offset:45056
v_mfma_f32_16x16x32_bf16 a[20:23], a[168:171], v[72:75], a[20:23]
v_exp_f32 v24, v24
v_smfmac_f32_16x16x64_bf16 a[248:251], a[208:211], v[40:47], v235
buffer_load_dwordx4 v233, s[12:15], s39 offen offset:1024 lds
v_mfma_f32_16x16x32_bf16 v[12:15], a[144:147], v[152:155], v[136:139]
v_exp_f32 v25, v25
v_mfma_f32_16x16x32_bf16 v[12:15], a[148:151], v[156:159], v[12:15]
ds_read_b64_tr_b16 a[168:169], v221 offset:32768
ds_read_b64_tr_b16 a[170:171], v221 offset:36864
v_mfma_f32_16x16x32_bf16 v[12:15], a[152:155], v[160:163], v[12:15]
v_exp_f32 v26, v26
v_mfma_f32_16x16x32_bf16 v[12:15], a[156:159], v[164:167], v[12:15]
ds_read_b128 a[128:131], v216 offset:16384
ds_read_b128 a[132:135], v217 offset:16384
v_mfma_f32_16x16x32_bf16 v[20:23], a[156:159], v[180:183], v[140:143]
v_exp_f32 v27, v27
v_mfma_f32_16x16x32_bf16 v[20:23], a[152:155], v[176:179], v[20:23]
ds_read_b128 a[136:139], v218 offset:16384
v_cvt_pk_bf16_f32 v61, v18, v19
v_mfma_f32_16x16x32_bf16 v[20:23], a[148:151], v[172:175], v[20:23]
v_exp_f32 v32, v32
v_mfma_f32_16x16x32_bf16 v[20:23], a[144:147], v[168:171], v[20:23]
ds_read_b128 a[140:143], v219 offset:16384
v_cvt_pk_bf16_f32 v64, v24, v25
v_mfma_f32_16x16x32_bf16 v[28:31], a[144:147], v[184:187], v[144:147]
v_exp_f32 v33, v33
v_mfma_f32_16x16x32_bf16 v[28:31], a[148:151], v[188:191], v[28:31]
buffer_load_dwordx4 v232, s[12:15], s39 offen offset:2048 lds
v_mfma_f32_16x16x32_bf16 v[28:31], a[152:155], v[192:195], v[28:31]
v_exp_f32 v34, v34
v_mfma_f32_16x16x32_bf16 v[28:31], a[156:159], v[196:199], v[28:31]
v_cvt_pk_bf16_f32 v65, v26, v27
v_cvt_pk_bf16_f32 v68, v32, v33
v_mfma_f32_16x16x32_bf16 v[36:39], a[156:159], v[212:215], v[148:151]
v_exp_f32 v35, v35
v_mfma_f32_16x16x32_bf16 v[36:39], a[152:155], v[208:211], v[36:39]
ds_read_b128 a[156:159], v219 offset:20480
ds_read_b128 a[152:155], v218 offset:20480
v_mfma_f32_16x16x32_bf16 v[36:39], a[148:151], v[204:207], v[36:39]
v_exp_f32 v12, v12
v_mfma_f32_16x16x32_bf16 v[36:39], a[144:147], v[200:203], v[36:39]
v_exp_f32 v13, v13
v_mfma_f32_16x16x32_bf16 a[24:27], a[176:179], v[72:75], a[24:27]
ds_read_b128 a[148:151], v217 offset:20480
ds_read_b128 a[144:147], v216 offset:20480
v_mfma_f32_16x16x32_bf16 a[24:27], a[180:183], v[88:91], a[24:27]
v_exp_f32 v14, v14
v_mfma_f32_16x16x32_bf16 a[56:59], a[180:183], v[92:95], a[56:59]
buffer_load_dwordx4 v233, s[12:15], s39 offen offset:3072 lds
v_mfma_f32_16x16x32_bf16 a[56:59], a[176:179], v[76:79], a[56:59]
v_exp_f32 v15, v15
v_mfma_f32_16x16x32_bf16 a[88:91], a[176:179], v[80:83], a[88:91]
v_cvt_pk_bf16_f32 v69, v34, v35
v_cvt_pk_bf16_f32 v58, v12, v13
v_mfma_f32_16x16x32_bf16 a[88:91], a[180:183], v[96:99], a[88:91]
v_exp_f32 v20, v20
v_mfma_f32_16x16x32_bf16 a[120:123], a[180:183], v[100:103], a[120:123]
ds_read_b64_tr_b16 a[180:181], v222 offset:40960
ds_read_b64_tr_b16 a[182:183], v222 offset:45056
v_mfma_f32_16x16x32_bf16 a[120:123], a[176:179], v[84:87], a[120:123]
v_exp_f32 v21, v21
v_mfma_f32_16x16x32_bf16 a[124:127], a[184:187], v[84:87], a[124:127]
ds_read_b64_tr_b16 a[176:177], v222 offset:32768
ds_read_b64_tr_b16 a[178:179], v222 offset:36864
v_mfma_f32_16x16x32_bf16 a[124:127], a[188:191], v[100:103], a[124:127]
v_exp_f32 v22, v22
v_mfma_f32_16x16x32_bf16 a[92:95], a[188:191], v[96:99], a[92:95]
v_cvt_pk_bf16_f32 v59, v14, v15
v_cvt_pk_bf16_f32 v62, v20, v21
v_mfma_f32_16x16x32_bf16 a[92:95], a[184:187], v[80:83], a[92:95]
s_add_u32 s39, s39, 16384
v_exp_f32 v23, v23
v_mfma_f32_16x16x32_bf16 a[60:63], a[184:187], v[76:79], a[60:63]
s_add_u32 m0, s37, 49152
ds_read_b64_tr_b16 a[192:193], v248 offset:4096
v_cvt_pk_bf16_f32 v63, v22, v23
v_mfma_f32_16x16x32_bf16 a[60:63], a[188:191], v[92:95], a[60:63]
v_exp_f32 v28, v28
v_mfma_f32_16x16x32_bf16 a[28:31], a[188:191], v[88:91], a[28:31]
buffer_load_dwordx4 v228, s[8:11], s38 offen offset:0 lds
v_mfma_f32_16x16x32_bf16 a[28:31], a[184:187], v[72:75], a[28:31]
v_exp_f32 v29, v29
v_smfmac_f32_16x16x64_bf16 a[252:255], a[208:211], v[48:55], v235
s_waitcnt lgkmcnt(3)
ds_read_b64_tr_b16 a[188:189], v223 offset:40960
ds_read_b64_tr_b16 a[190:191], v223 offset:45056
v_mfma_f32_16x16x32_bf16 v[8:11], a[128:131], v[152:155], v[136:139]
v_exp_f32 v30, v30
v_mfma_f32_16x16x32_bf16 v[8:11], a[132:135], v[156:159], v[8:11]
ds_read_b64_tr_b16 a[184:185], v223 offset:32768
ds_read_b64_tr_b16 a[186:187], v223 offset:36864
v_mfma_f32_16x16x32_bf16 v[8:11], a[136:139], v[160:163], v[8:11]
v_exp_f32 v31, v31
v_mfma_f32_16x16x32_bf16 v[8:11], a[140:143], v[164:167], v[8:11]
buffer_load_dwordx4 v229, s[8:11], s38 offen offset:1024 lds
v_mfma_f32_16x16x32_bf16 v[16:19], a[140:143], v[180:183], v[140:143]
v_exp_f32 v36, v36
v_mfma_f32_16x16x32_bf16 v[16:19], a[136:139], v[176:179], v[16:19]
v_cvt_pk_bf16_f32 v66, v28, v29
v_cvt_pk_bf16_f32 v67, v30, v31
v_mfma_f32_16x16x32_bf16 v[16:19], a[132:135], v[172:175], v[16:19]
v_exp_f32 v37, v37
v_mfma_f32_16x16x32_bf16 v[16:19], a[128:131], v[168:171], v[16:19]
ds_read_b64_tr_b16 a[194:195], v248 offset:4352
v_cvt_pk_bf16_f32 v70, v36, v37
v_mfma_f32_16x16x32_bf16 v[24:27], a[128:131], v[184:187], v[144:147]
v_exp_f32 v38, v38
v_mfma_f32_16x16x32_bf16 v[24:27], a[132:135], v[188:191], v[24:27]
ds_read_b64_tr_b16 a[196:197], v248 offset:4128
ds_read_b64_tr_b16 a[198:199], v248 offset:4384
v_mfma_f32_16x16x32_bf16 v[24:27], a[136:139], v[192:195], v[24:27]
v_exp_f32 v39, v39
v_mfma_f32_16x16x32_bf16 v[24:27], a[140:143], v[196:199], v[24:27]
ds_read_b64_tr_b16 a[200:201], v248 offset:6144
v_cvt_pk_bf16_f32 v71, v38, v39
v_mfma_f32_16x16x32_bf16 v[32:35], a[140:143], v[212:215], v[148:151]
ds_read_b64_tr_b16 a[202:203], v248 offset:6400
ds_read_b64_tr_b16 a[204:205], v248 offset:6176
v_mfma_f32_16x16x32_bf16 v[32:35], a[136:139], v[208:211], v[32:35]
ds_read_b64_tr_b16 a[206:207], v248 offset:6432
ds_read_b128 a[228:231], v246 offset:2048
v_mfma_f32_16x16x32_bf16 v[32:35], a[132:135], v[204:207], v[32:35]
ds_read_b128 a[212:215], v245
ds_read_b128 a[216:219], v5
v_mfma_f32_16x16x32_bf16 v[32:35], a[128:131], v[200:203], v[32:35]
v_mfma_f32_16x16x32_bf16 a[0:3], a[160:163], v[40:43], a[0:3]
v_exp_f32 v8, v8
v_mfma_f32_16x16x32_bf16 a[0:3], a[164:167], v[56:59], a[0:3]
buffer_load_dwordx4 v230, s[8:11], s38 offen offset:2048 lds
v_mfma_f32_16x16x32_bf16 a[32:35], a[164:167], v[60:63], a[32:35]
v_exp_f32 v9, v9
v_mfma_f32_16x16x32_bf16 a[32:35], a[160:163], v[44:47], a[32:35]
ds_read_b128 a[220:223], v6
v_cvt_pk_bf16_f32 v72, v8, v9
v_mfma_f32_16x16x32_bf16 a[64:67], a[160:163], v[48:51], a[64:67]
v_exp_f32 v10, v10
v_mfma_f32_16x16x32_bf16 a[64:67], a[164:167], v[64:67], a[64:67]
ds_read_b128 a[224:227], v7
ds_read_b64_tr_b16 a[232:233], v249 offset:3072
v_mfma_f32_16x16x32_bf16 a[96:99], a[164:167], v[68:71], a[96:99]
v_exp_f32 v11, v11
v_mfma_f32_16x16x32_bf16 a[96:99], a[160:163], v[52:55], a[96:99]
ds_read_b64_tr_b16 a[164:165], v224 offset:40960
ds_read_b64_tr_b16 a[166:167], v224 offset:45056
v_mfma_f32_16x16x32_bf16 a[100:103], a[168:171], v[52:55], a[100:103]
v_exp_f32 v16, v16
v_mfma_f32_16x16x32_bf16 a[100:103], a[172:175], v[68:71], a[100:103]
s_add_u32 m0, s49, 4096
ds_read_b64_tr_b16 a[160:161], v224 offset:32768
ds_read_b64_tr_b16 a[162:163], v224 offset:36864
v_mfma_f32_16x16x32_bf16 a[68:71], a[172:175], v[64:67], a[68:71]
s_add_u32 s48, s50, 0
v_exp_f32 v17, v17
v_mfma_f32_16x16x32_bf16 a[68:71], a[168:171], v[48:51], a[68:71]
s_waitcnt lgkmcnt(10)
buffer_load_dwordx4 v238, s[60:63], s48 offen  lds
v_mfma_f32_16x16x32_bf16 a[36:39], a[168:171], v[44:47], a[36:39]
v_exp_f32 v18, v18
v_mfma_f32_16x16x32_bf16 a[36:39], a[172:175], v[60:63], a[36:39]
v_cvt_pk_bf16_f32 v73, v10, v11
v_cvt_pk_bf16_f32 v76, v16, v17
v_mfma_f32_16x16x32_bf16 a[4:7], a[172:175], v[56:59], a[4:7]
v_exp_f32 v19, v19
v_mfma_f32_16x16x32_bf16 a[4:7], a[168:171], v[40:43], a[4:7]
ds_read_b64_tr_b16 a[172:173], v225 offset:40960
ds_read_b64_tr_b16 a[174:175], v225 offset:45056
v_smfmac_f32_16x16x64_bf16 a[248:251], a[208:211], v[56:63], v235
s_waitcnt lgkmcnt(6)
v_exp_f32 v24, v24
v_mfma_f32_16x16x32_bf16 v[104:107], a[192:195], a[228:231], 0
s_add_u32 m0, s37, 49152
ds_read_b64_tr_b16 a[168:169], v225 offset:32768
ds_read_b64_tr_b16 a[170:171], v225 offset:36864
v_mfma_f32_16x16x32_bf16 v[12:15], a[144:147], v[152:155], v[136:139]
v_exp_f32 v25, v25
v_mfma_f32_16x16x32_bf16 v[12:15], a[148:151], v[156:159], v[12:15]
buffer_load_dwordx4 v231, s[8:11], s38 offen offset:3072 lds
v_mfma_f32_16x16x32_bf16 v[12:15], a[152:155], v[160:163], v[12:15]
v_exp_f32 v26, v26
v_mfma_f32_16x16x32_bf16 v[12:15], a[156:159], v[164:167], v[12:15]
ds_read_b128 a[128:131], v216 offset:24576
ds_read_b128 a[132:135], v217 offset:24576
v_mfma_f32_16x16x32_bf16 v[20:23], a[156:159], v[180:183], v[140:143]
v_exp_f32 v27, v27
v_mfma_f32_16x16x32_bf16 v[20:23], a[152:155], v[176:179], v[20:23]
ds_read_b128 a[136:139], v218 offset:24576
v_cvt_pk_bf16_f32 v77, v18, v19
v_mfma_f32_16x16x32_bf16 v[20:23], a[148:151], v[172:175], v[20:23]
v_exp_f32 v32, v32
v_mfma_f32_16x16x32_bf16 v[20:23], a[144:147], v[168:171], v[20:23]
s_add_u32 m0, s49, 5120
ds_read_b128 a[140:143], v219 offset:24576
v_cvt_pk_bf16_f32 v80, v24, v25
v_mfma_f32_16x16x32_bf16 v[28:31], a[144:147], v[184:187], v[144:147]
s_add_u32 s48, s50, 147456
v_exp_f32 v33, v33
v_mfma_f32_16x16x32_bf16 v[28:31], a[148:151], v[188:191], v[28:31]
buffer_load_dwordx4 v238, s[60:63], s48 offen  lds
v_mfma_f32_16x16x32_bf16 v[28:31], a[152:155], v[192:195], v[28:31]
v_exp_f32 v34, v34
v_mfma_f32_16x16x32_bf16 v[28:31], a[156:159], v[196:199], v[28:31]
v_cvt_pk_bf16_f32 v81, v26, v27
v_cvt_pk_bf16_f32 v84, v32, v33
v_mfma_f32_16x16x32_bf16 v[36:39], a[156:159], v[212:215], v[148:151]
v_exp_f32 v35, v35
v_mfma_f32_16x16x32_bf16 v[36:39], a[152:155], v[208:211], v[36:39]
ds_read_b128 a[156:159], v219 offset:28672
ds_read_b128 a[152:155], v218 offset:28672
v_mfma_f32_16x16x32_bf16 v[36:39], a[148:151], v[204:207], v[36:39]
ds_read_b128 a[148:151], v217 offset:28672
v_cvt_pk_bf16_f32 v85, v34, v35
v_mfma_f32_16x16x32_bf16 v[36:39], a[144:147], v[200:203], v[36:39]
v_exp_f32 v12, v12
v_mfma_f32_16x16x32_bf16 v[108:111], a[196:199], a[228:231], 0
s_add_u32 s38, s38, 16384
ds_read_b128 a[144:147], v216 offset:28672
ds_read_b64_tr_b16 a[234:235], v249 offset:3584
v_mfma_f32_16x16x32_bf16 a[8:11], a[176:179], v[40:43], a[8:11]
s_add_u32 m0, s37, 81920
v_exp_f32 v13, v13
v_mfma_f32_16x16x32_bf16 a[8:11], a[180:183], v[56:59], a[8:11]
buffer_load_dwordx4 v232, s[12:15], s39 offen offset:0 lds
v_mfma_f32_16x16x32_bf16 a[40:43], a[180:183], v[60:63], a[40:43]
v_exp_f32 v14, v14
v_mfma_f32_16x16x32_bf16 a[40:43], a[176:179], v[44:47], a[40:43]
v_cvt_pk_bf16_f32 v74, v12, v13
v_mfma_f32_16x16x32_bf16 a[72:75], a[176:179], v[48:51], a[72:75]
v_exp_f32 v15, v15
v_mfma_f32_16x16x32_bf16 a[72:75], a[180:183], v[64:67], a[72:75]
v_cvt_pk_bf16_f32 v75, v14, v15
v_mfma_f32_16x16x32_bf16 a[104:107], a[180:183], v[68:71], a[104:107]
v_exp_f32 v20, v20
v_mfma_f32_16x16x32_bf16 a[104:107], a[176:179], v[52:55], a[104:107]
s_add_u32 m0, s49, 6144
ds_read_b64_tr_b16 a[180:181], v226 offset:40960
ds_read_b64_tr_b16 a[182:183], v226 offset:45056
v_mfma_f32_16x16x32_bf16 a[108:111], a[184:187], v[52:55], a[108:111]
s_add_u32 s48, s50, 294912
v_exp_f32 v21, v21
v_mfma_f32_16x16x32_bf16 a[108:111], a[188:191], v[68:71], a[108:111]
buffer_load_dwordx4 v238, s[60:63], s48 offen  lds
v_mfma_f32_16x16x32_bf16 a[76:79], a[188:191], v[64:67], a[76:79]
v_exp_f32 v22, v22
v_mfma_f32_16x16x32_bf16 a[76:79], a[184:187], v[48:51], a[76:79]
ds_read_b64_tr_b16 a[176:177], v226 offset:32768
ds_read_b64_tr_b16 a[178:179], v226 offset:36864
v_mfma_f32_16x16x32_bf16 a[44:47], a[184:187], v[44:47], a[44:47]
v_exp_f32 v23, v23
v_mfma_f32_16x16x32_bf16 a[44:47], a[188:191], v[60:63], a[44:47]
v_cvt_pk_bf16_f32 v78, v20, v21
v_cvt_pk_bf16_f32 v79, v22, v23
v_mfma_f32_16x16x32_bf16 a[12:15], a[188:191], v[56:59], a[12:15]
v_exp_f32 v28, v28
v_mfma_f32_16x16x32_bf16 a[12:15], a[184:187], v[40:43], a[12:15]
s_add_u32 m0, s37, 81920
ds_read_b64_tr_b16 a[188:189], v227 offset:40960
ds_read_b64_tr_b16 a[190:191], v227 offset:45056
v_smfmac_f32_16x16x64_bf16 a[252:255], a[208:211], v[64:71], v235
v_exp_f32 v29, v29
v_mfma_f32_16x16x32_bf16 v[112:115], a[200:203], a[228:231], 0
s_waitcnt lgkmcnt(4)
buffer_load_dwordx4 v233, s[12:15], s39 offen offset:1024 lds
v_mfma_f32_16x16x32_bf16 v[8:11], a[128:131], v[152:155], v[136:139]
v_exp_f32 v30, v30
v_mfma_f32_16x16x32_bf16 v[8:11], a[132:135], v[156:159], v[8:11]
ds_read_b64_tr_b16 a[184:185], v227 offset:32768
ds_read_b64_tr_b16 a[186:187], v227 offset:36864
v_mfma_f32_16x16x32_bf16 v[8:11], a[136:139], v[160:163], v[8:11]
v_exp_f32 v31, v31
v_mfma_f32_16x16x32_bf16 v[8:11], a[140:143], v[164:167], v[8:11]
v_cvt_pk_bf16_f32 v82, v28, v29
v_cvt_pk_bf16_f32 v83, v30, v31
v_mfma_f32_16x16x32_bf16 v[16:19], a[140:143], v[180:183], v[140:143]
v_exp_f32 v36, v36
v_mfma_f32_16x16x32_bf16 v[16:19], a[136:139], v[176:179], v[16:19]
buffer_load_dwordx4 v232, s[12:15], s39 offen offset:2048 lds
v_mfma_f32_16x16x32_bf16 v[16:19], a[132:135], v[172:175], v[16:19]
v_exp_f32 v37, v37
v_mfma_f32_16x16x32_bf16 v[16:19], a[128:131], v[168:171], v[16:19]
v_cvt_pk_bf16_f32 v86, v36, v37
v_mfma_f32_16x16x32_bf16 v[24:27], a[128:131], v[184:187], v[144:147]
v_exp_f32 v38, v38
v_mfma_f32_16x16x32_bf16 v[24:27], a[132:135], v[188:191], v[24:27]
v_mfma_f32_16x16x32_bf16 v[24:27], a[136:139], v[192:195], v[24:27]
v_exp_f32 v39, v39
v_mfma_f32_16x16x32_bf16 v[24:27], a[140:143], v[196:199], v[24:27]
v_cvt_pk_bf16_f32 v87, v38, v39
v_mfma_f32_16x16x32_bf16 v[32:35], a[140:143], v[212:215], v[148:151]
v_mfma_f32_16x16x32_bf16 v[32:35], a[136:139], v[208:211], v[32:35]
v_mfma_f32_16x16x32_bf16 v[32:35], a[132:135], v[204:207], v[32:35]
v_mfma_f32_16x16x32_bf16 v[32:35], a[128:131], v[200:203], v[32:35]
v_mfma_f32_16x16x32_bf16 v[116:119], a[204:207], a[228:231], 0
v_mfma_f32_16x16x32_bf16 a[16:19], a[160:163], v[40:43], a[16:19]
v_exp_f32 v8, v8
v_mfma_f32_16x16x32_bf16 a[16:19], a[164:167], v[56:59], a[16:19]
v_exp_f32 v9, v9
v_mfma_f32_16x16x32_bf16 a[48:51], a[164:167], v[60:63], a[48:51]
buffer_load_dwordx4 v233, s[12:15], s39 offen offset:3072 lds
v_mfma_f32_16x16x32_bf16 a[48:51], a[160:163], v[44:47], a[48:51]
v_exp_f32 v10, v10
v_mfma_f32_16x16x32_bf16 a[80:83], a[160:163], v[48:51], a[80:83]
v_cvt_pk_bf16_f32 v88, v8, v9
v_mfma_f32_16x16x32_bf16 a[80:83], a[164:167], v[64:67], a[80:83]
v_exp_f32 v11, v11
v_mfma_f32_16x16x32_bf16 a[112:115], a[164:167], v[68:71], a[112:115]
ds_read_b64_tr_b16 a[164:165], v220 offset:57344
ds_read_b64_tr_b16 a[166:167], v220 offset:61440
v_mfma_f32_16x16x32_bf16 a[112:115], a[160:163], v[52:55], a[112:115]
v_exp_f32 v16, v16
v_mfma_f32_16x16x32_bf16 a[116:119], a[168:171], v[52:55], a[116:119]
s_add_u32 m0, s49, 7168
ds_read_b64_tr_b16 a[160:161], v220 offset:49152
ds_read_b64_tr_b16 a[162:163], v220 offset:53248
v_mfma_f32_16x16x32_bf16 a[116:119], a[172:175], v[68:71], a[116:119]
s_add_u32 s48, s50, 442368
v_exp_f32 v17, v17
v_mfma_f32_16x16x32_bf16 a[84:87], a[172:175], v[64:67], a[84:87]
buffer_load_dwordx4 v238, s[60:63], s48 offen  lds
v_mfma_f32_16x16x32_bf16 a[84:87], a[168:171], v[48:51], a[84:87]
v_exp_f32 v18, v18
v_mfma_f32_16x16x32_bf16 a[52:55], a[168:171], v[44:47], a[52:55]
v_cvt_pk_bf16_f32 v89, v10, v11
v_cvt_pk_bf16_f32 v92, v16, v17
v_mfma_f32_16x16x32_bf16 a[52:55], a[172:175], v[60:63], a[52:55]
v_exp_f32 v19, v19
v_mfma_f32_16x16x32_bf16 a[20:23], a[172:175], v[56:59], a[20:23]
ds_read_b64_tr_b16 a[172:173], v221 offset:57344
ds_read_b64_tr_b16 a[174:175], v221 offset:61440
v_mfma_f32_16x16x32_bf16 a[20:23], a[168:171], v[40:43], a[20:23]
v_exp_f32 v24, v24
v_smfmac_f32_16x16x64_bf16 a[248:251], a[208:211], v[72:79], v235
s_add_u32 s39, s39, 16384
ds_read_b64_tr_b16 a[168:169], v221 offset:49152
ds_read_b64_tr_b16 a[170:171], v221 offset:53248
v_mfma_f32_16x16x32_bf16 v[12:15], a[144:147], v[152:155], v[136:139]
s_add_u32 m0, s37, 32768
v_exp_f32 v25, v25
v_mfma_f32_16x16x32_bf16 v[12:15], a[148:151], v[156:159], v[12:15]
buffer_load_dwordx4 v228, s[8:11], s38 offen offset:0 lds
v_mfma_f32_16x16x32_bf16 v[12:15], a[152:155], v[160:163], v[12:15]
v_exp_f32 v26, v26
v_mfma_f32_16x16x32_bf16 v[12:15], a[156:159], v[164:167], v[12:15]
ds_read_b128 a[128:131], v216 offset:0
ds_read_b128 a[132:135], v217 offset:0
v_mfma_f32_16x16x32_bf16 v[20:23], a[156:159], v[180:183], v[140:143]
v_exp_f32 v27, v27
v_mfma_f32_16x16x32_bf16 v[20:23], a[152:155], v[176:179], v[20:23]
ds_read_b128 a[136:139], v218 offset:0
v_cvt_pk_bf16_f32 v93, v18, v19
v_mfma_f32_16x16x32_bf16 v[20:23], a[148:151], v[172:175], v[20:23]
v_exp_f32 v32, v32
v_mfma_f32_16x16x32_bf16 v[20:23], a[144:147], v[168:171], v[20:23]
s_add_u32 m0, s49, 0
ds_read_b128 a[140:143], v219 offset:0
v_cvt_pk_bf16_f32 v96, v24, v25
v_mfma_f32_16x16x32_bf16 v[28:31], a[144:147], v[184:187], v[144:147]
s_add_u32 s48, s50, 0
v_exp_f32 v33, v33
v_mfma_f32_16x16x32_bf16 v[28:31], a[148:151], v[188:191], v[28:31]
buffer_load_dwordx4 v238, s[56:59], s48 offen  lds
v_mfma_f32_16x16x32_bf16 v[28:31], a[152:155], v[192:195], v[28:31]
v_exp_f32 v34, v34
v_mfma_f32_16x16x32_bf16 v[28:31], a[156:159], v[196:199], v[28:31]
v_cvt_pk_bf16_f32 v97, v26, v27
v_cvt_pk_bf16_f32 v100, v32, v33
v_mfma_f32_16x16x32_bf16 v[36:39], a[156:159], v[212:215], v[148:151]
v_exp_f32 v35, v35
v_mfma_f32_16x16x32_bf16 v[36:39], a[152:155], v[208:211], v[36:39]
ds_read_b128 a[156:159], v219 offset:4096
ds_read_b128 a[152:155], v218 offset:4096
v_mfma_f32_16x16x32_bf16 v[36:39], a[148:151], v[204:207], v[36:39]
s_waitcnt lgkmcnt(4)
v_exp_f32 v12, v12
v_mfma_f32_16x16x32_bf16 v[36:39], a[144:147], v[200:203], v[36:39]
s_add_u32 m0, s37, 32768
v_exp_f32 v13, v13
v_mfma_f32_16x16x32_bf16 a[24:27], a[176:179], v[40:43], a[24:27]
buffer_load_dwordx4 v229, s[8:11], s38 offen offset:1024 lds
v_mfma_f32_16x16x32_bf16 a[24:27], a[180:183], v[56:59], a[24:27]
v_exp_f32 v14, v14
v_mfma_f32_16x16x32_bf16 a[56:59], a[180:183], v[60:63], a[56:59]
ds_read_b128 a[148:151], v217 offset:4096
ds_read_b128 a[144:147], v216 offset:4096
v_mfma_f32_16x16x32_bf16 a[56:59], a[176:179], v[44:47], a[56:59]
v_exp_f32 v15, v15
v_mfma_f32_16x16x32_bf16 a[88:91], a[176:179], v[48:51], a[88:91]
v_cvt_pk_bf16_f32 v101, v34, v35
v_cvt_pk_bf16_f32 v90, v12, v13
v_mfma_f32_16x16x32_bf16 a[88:91], a[180:183], v[64:67], a[88:91]
v_exp_f32 v20, v20
v_mfma_f32_16x16x32_bf16 a[120:123], a[180:183], v[68:71], a[120:123]
s_add_u32 m0, s49, 1024
ds_read_b64_tr_b16 a[180:181], v222 offset:57344
ds_read_b64_tr_b16 a[182:183], v222 offset:61440
v_mfma_f32_16x16x32_bf16 a[120:123], a[176:179], v[52:55], a[120:123]
s_add_u32 s48, s50, 147456
v_exp_f32 v21, v21
v_mfma_f32_16x16x32_bf16 a[124:127], a[184:187], v[52:55], a[124:127]
buffer_load_dwordx4 v238, s[56:59], s48 offen  lds
v_mfma_f32_16x16x32_bf16 a[124:127], a[188:191], v[68:71], a[124:127]
v_exp_f32 v22, v22
v_mfma_f32_16x16x32_bf16 a[92:95], a[188:191], v[64:67], a[92:95]
ds_read_b64_tr_b16 a[176:177], v222 offset:49152
ds_read_b64_tr_b16 a[178:179], v222 offset:53248
v_mfma_f32_16x16x32_bf16 a[92:95], a[184:187], v[48:51], a[92:95]
v_exp_f32 v23, v23
v_mfma_f32_16x16x32_bf16 a[60:63], a[184:187], v[44:47], a[60:63]
v_cvt_pk_bf16_f32 v91, v14, v15
v_cvt_pk_bf16_f32 v94, v20, v21
v_mfma_f32_16x16x32_bf16 a[60:63], a[188:191], v[60:63], a[60:63]
v_exp_f32 v28, v28
v_mfma_f32_16x16x32_bf16 a[28:31], a[188:191], v[56:59], a[28:31]
s_add_u32 m0, s37, 32768
ds_read_b64_tr_b16 a[188:189], v223 offset:57344
ds_read_b64_tr_b16 a[190:191], v223 offset:61440
v_mfma_f32_16x16x32_bf16 a[28:31], a[184:187], v[40:43], a[28:31]
v_exp_f32 v29, v29
v_smfmac_f32_16x16x64_bf16 a[252:255], a[208:211], v[80:87], v235
buffer_load_dwordx4 v230, s[8:11], s38 offen offset:2048 lds
v_mfma_f32_16x16x32_bf16 v[8:11], a[128:131], v[152:155], v[136:139]
v_exp_f32 v30, v30
v_mfma_f32_16x16x32_bf16 v[8:11], a[132:135], v[156:159], v[8:11]
s_waitcnt lgkmcnt(4)
ds_read_b64_tr_b16 a[184:185], v223 offset:49152
ds_read_b64_tr_b16 a[186:187], v223 offset:53248
v_mfma_f32_16x16x32_bf16 v[8:11], a[136:139], v[160:163], v[8:11]
v_exp_f32 v31, v31
v_mfma_f32_16x16x32_bf16 v[8:11], a[140:143], v[164:167], v[8:11]
v_cvt_pk_bf16_f32 v95, v22, v23
v_cvt_pk_bf16_f32 v98, v28, v29
v_mfma_f32_16x16x32_bf16 v[16:19], a[140:143], v[180:183], v[140:143]
v_exp_f32 v36, v36
v_mfma_f32_16x16x32_bf16 v[16:19], a[136:139], v[176:179], v[16:19]
buffer_load_dwordx4 v231, s[8:11], s38 offen offset:3072 lds
v_mfma_f32_16x16x32_bf16 v[16:19], a[132:135], v[172:175], v[16:19]
v_exp_f32 v37, v37
v_mfma_f32_16x16x32_bf16 v[16:19], a[128:131], v[168:171], v[16:19]
v_cvt_pk_bf16_f32 v99, v30, v31
v_cvt_pk_bf16_f32 v102, v36, v37
v_mfma_f32_16x16x32_bf16 v[24:27], a[128:131], v[184:187], v[144:147]
v_exp_f32 v38, v38
v_mfma_f32_16x16x32_bf16 v[24:27], a[132:135], v[188:191], v[24:27]
v_mfma_f32_16x16x32_bf16 v[24:27], a[136:139], v[192:195], v[24:27]
v_exp_f32 v39, v39
v_mfma_f32_16x16x32_bf16 v[24:27], a[140:143], v[196:199], v[24:27]
v_cvt_pk_bf16_f32 v103, v38, v39
v_mfma_f32_16x16x32_bf16 v[32:35], a[140:143], v[212:215], v[148:151]
v_mfma_f32_16x16x32_bf16 v[32:35], a[136:139], v[208:211], v[32:35]
s_add_u32 s38, s38, 16384
v_mfma_f32_16x16x32_bf16 v[32:35], a[132:135], v[204:207], v[32:35]
v_mfma_f32_16x16x32_bf16 v[32:35], a[128:131], v[200:203], v[32:35]
v_mfma_f32_16x16x32_bf16 a[0:3], a[160:163], v[72:75], a[0:3]
v_exp_f32 v8, v8
v_mfma_f32_16x16x32_bf16 a[0:3], a[164:167], v[88:91], a[0:3]
s_add_u32 m0, s49, 2048
v_exp_f32 v9, v9
v_mfma_f32_16x16x32_bf16 a[32:35], a[164:167], v[92:95], a[32:35]
s_add_u32 s48, s50, 294912
buffer_load_dwordx4 v238, s[56:59], s48 offen  lds
v_mfma_f32_16x16x32_bf16 a[32:35], a[160:163], v[76:79], a[32:35]
v_exp_f32 v10, v10
v_mfma_f32_16x16x32_bf16 a[64:67], a[160:163], v[80:83], a[64:67]
v_cvt_pk_bf16_f32 v40, v8, v9
v_mfma_f32_16x16x32_bf16 a[64:67], a[164:167], v[96:99], a[64:67]
v_exp_f32 v11, v11
v_mfma_f32_16x16x32_bf16 a[96:99], a[164:167], v[100:103], a[96:99]
ds_read_b64_tr_b16 a[164:165], v224 offset:57344
ds_read_b64_tr_b16 a[166:167], v224 offset:61440
v_mfma_f32_16x16x32_bf16 a[96:99], a[160:163], v[84:87], a[96:99]
v_exp_f32 v16, v16
v_mfma_f32_16x16x32_bf16 a[100:103], a[168:171], v[84:87], a[100:103]
ds_read_b64_tr_b16 a[160:161], v224 offset:49152
ds_read_b64_tr_b16 a[162:163], v224 offset:53248
v_mfma_f32_16x16x32_bf16 a[100:103], a[172:175], v[100:103], a[100:103]
v_exp_f32 v17, v17
v_mfma_f32_16x16x32_bf16 a[68:71], a[172:175], v[96:99], a[68:71]
v_cvt_pk_bf16_f32 v41, v10, v11
v_cvt_pk_bf16_f32 v44, v16, v17
v_mfma_f32_16x16x32_bf16 a[68:71], a[168:171], v[80:83], a[68:71]
s_add_u32 m0, s49, 3072
v_exp_f32 v18, v18
v_mfma_f32_16x16x32_bf16 a[36:39], a[168:171], v[76:79], a[36:39]
s_add_u32 s48, s50, 442368
buffer_load_dwordx4 v238, s[56:59], s48 offen  lds
v_mfma_f32_16x16x32_bf16 a[36:39], a[172:175], v[92:95], a[36:39]
v_exp_f32 v19, v19
v_mfma_f32_16x16x32_bf16 a[4:7], a[172:175], v[88:91], a[4:7]
ds_read_b64_tr_b16 a[172:173], v225 offset:57344
ds_read_b64_tr_b16 a[174:175], v225 offset:61440
v_mfma_f32_16x16x32_bf16 a[4:7], a[168:171], v[72:75], a[4:7]
v_exp_f32 v24, v24
v_smfmac_f32_16x16x64_bf16 a[248:251], a[208:211], v[88:95], v235
ds_read_b64_tr_b16 a[168:169], v225 offset:49152
ds_read_b64_tr_b16 a[170:171], v225 offset:53248
v_mfma_f32_16x16x32_bf16 v[12:15], a[144:147], v[152:155], v[136:139]
v_exp_f32 v25, v25
v_mfma_f32_16x16x32_bf16 v[12:15], a[148:151], v[156:159], v[12:15]
ds_read_b128 a[128:131], v216 offset:8192
v_cvt_pk_bf16_f32 v45, v18, v19
v_mfma_f32_16x16x32_bf16 v[12:15], a[152:155], v[160:163], v[12:15]
v_exp_f32 v26, v26
v_mfma_f32_16x16x32_bf16 v[12:15], a[156:159], v[164:167], v[12:15]
ds_read_b128 a[132:135], v217 offset:8192
v_cvt_pk_bf16_f32 v48, v24, v25
v_mfma_f32_16x16x32_bf16 v[20:23], a[156:159], v[180:183], v[140:143]
v_exp_f32 v27, v27
v_mfma_f32_16x16x32_bf16 v[20:23], a[152:155], v[176:179], v[20:23]
buffer_load_dwordx2 v[252:253], v251, s[76:79], s42 offen sc1
v_mfma_f32_16x16x32_bf16 v[20:23], a[148:151], v[172:175], v[20:23]
v_exp_f32 v32, v32
v_mfma_f32_16x16x32_bf16 v[20:23], a[144:147], v[168:171], v[20:23]
ds_read_b128 a[136:139], v218 offset:8192
ds_read_b128 a[140:143], v219 offset:8192
v_mfma_f32_16x16x32_bf16 v[28:31], a[144:147], v[184:187], v[144:147]
v_exp_f32 v33, v33
v_mfma_f32_16x16x32_bf16 v[28:31], a[148:151], v[188:191], v[28:31]
v_cvt_pk_bf16_f32 v49, v26, v27
v_cvt_pk_bf16_f32 v52, v32, v33
v_mfma_f32_16x16x32_bf16 v[28:31], a[152:155], v[192:195], v[28:31]
v_exp_f32 v34, v34
v_mfma_f32_16x16x32_bf16 v[28:31], a[156:159], v[196:199], v[28:31]
v_mfma_f32_16x16x32_bf16 v[36:39], a[156:159], v[212:215], v[148:151]
v_exp_f32 v35, v35
v_mfma_f32_16x16x32_bf16 v[36:39], a[152:155], v[208:211], v[36:39]
ds_read_b128 a[156:159], v219 offset:12288
ds_read_b128 a[152:155], v218 offset:12288
v_mfma_f32_16x16x32_bf16 v[36:39], a[148:151], v[204:207], v[36:39]
s_waitcnt lgkmcnt(4)
v_exp_f32 v12, v12
v_mfma_f32_16x16x32_bf16 v[36:39], a[144:147], v[200:203], v[36:39]
s_add_u32 s42, s42, s43
v_exp_f32 v13, v13
v_mfma_f32_16x16x32_bf16 a[8:11], a[176:179], v[72:75], a[8:11]
buffer_load_dword v255, v243, s[28:31], s45 offen
v_mfma_f32_16x16x32_bf16 a[8:11], a[180:183], v[88:91], a[8:11]
v_exp_f32 v14, v14
v_mfma_f32_16x16x32_bf16 a[40:43], a[180:183], v[92:95], a[40:43]
ds_read_b128 a[148:151], v217 offset:12288
ds_read_b128 a[144:147], v216 offset:12288
v_mfma_f32_16x16x32_bf16 a[40:43], a[176:179], v[76:79], a[40:43]
v_exp_f32 v15, v15
v_mfma_f32_16x16x32_bf16 a[72:75], a[176:179], v[80:83], a[72:75]
v_cvt_pk_bf16_f32 v53, v34, v35
v_cvt_pk_bf16_f32 v42, v12, v13
v_mfma_f32_16x16x32_bf16 a[72:75], a[180:183], v[96:99], a[72:75]
v_exp_f32 v20, v20
v_mfma_f32_16x16x32_bf16 a[104:107], a[180:183], v[100:103], a[104:107]
ds_read_b64_tr_b16 a[180:181], v226 offset:57344
ds_read_b64_tr_b16 a[182:183], v226 offset:61440
v_mfma_f32_16x16x32_bf16 a[104:107], a[176:179], v[84:87], a[104:107]
v_exp_f32 v21, v21
v_mfma_f32_16x16x32_bf16 a[108:111], a[184:187], v[84:87], a[108:111]
ds_read_b64_tr_b16 a[176:177], v226 offset:49152
ds_read_b64_tr_b16 a[178:179], v226 offset:53248
v_mfma_f32_16x16x32_bf16 a[108:111], a[188:191], v[100:103], a[108:111]
s_add_u32 s45, s45, 589824
v_exp_f32 v22, v22
v_mfma_f32_16x16x32_bf16 a[76:79], a[188:191], v[96:99], a[76:79]
global_load_dword v255, v242, s[72:73]
v_mfma_f32_16x16x32_bf16 a[76:79], a[184:187], v[80:83], a[76:79]
v_exp_f32 v23, v23
v_mfma_f32_16x16x32_bf16 a[44:47], a[184:187], v[76:79], a[44:47]
v_cvt_pk_bf16_f32 v43, v14, v15
v_cvt_pk_bf16_f32 v46, v20, v21
v_mfma_f32_16x16x32_bf16 a[44:47], a[188:191], v[92:95], a[44:47]
v_exp_f32 v28, v28
v_mfma_f32_16x16x32_bf16 a[12:15], a[188:191], v[88:91], a[12:15]
ds_read_b64_tr_b16 a[188:189], v227 offset:57344
ds_read_b64_tr_b16 a[190:191], v227 offset:61440
v_mfma_f32_16x16x32_bf16 a[12:15], a[184:187], v[72:75], a[12:15]
v_exp_f32 v29, v29
v_smfmac_f32_16x16x64_bf16 a[252:255], a[208:211], v[96:103], v235
ds_read_b64_tr_b16 a[184:185], v227 offset:49152
ds_read_b64_tr_b16 a[186:187], v227 offset:53248
v_mfma_f32_16x16x32_bf16 v[8:11], a[128:131], v[152:155], v[136:139]
v_exp_f32 v30, v30
v_mfma_f32_16x16x32_bf16 v[8:11], a[132:135], v[156:159], v[8:11]
s_waitcnt lgkmcnt(4)
v_cvt_pk_bf16_f32 v47, v22, v23
v_cvt_pk_bf16_f32 v50, v28, v29
v_mfma_f32_16x16x32_bf16 v[8:11], a[136:139], v[160:163], v[8:11]
v_exp_f32 v31, v31
v_mfma_f32_16x16x32_bf16 v[8:11], a[140:143], v[164:167], v[8:11]
buffer_load_dword v255, v0, s[24:27], s44 offen
v_mfma_f32_16x16x32_bf16 v[16:19], a[140:143], v[180:183], v[140:143]
v_exp_f32 v36, v36
v_mfma_f32_16x16x32_bf16 v[16:19], a[136:139], v[176:179], v[16:19]
v_cvt_pk_bf16_f32 v51, v30, v31
v_mfma_f32_16x16x32_bf16 v[16:19], a[132:135], v[172:175], v[16:19]
v_exp_f32 v37, v37
v_mfma_f32_16x16x32_bf16 v[16:19], a[128:131], v[168:171], v[16:19]
v_cvt_pk_bf16_f32 v54, v36, v37
v_mfma_f32_16x16x32_bf16 v[24:27], a[128:131], v[184:187], v[144:147]
v_exp_f32 v38, v38
v_mfma_f32_16x16x32_bf16 v[24:27], a[132:135], v[188:191], v[24:27]
v_mfma_f32_16x16x32_bf16 v[24:27], a[136:139], v[192:195], v[24:27]
v_exp_f32 v39, v39
v_mfma_f32_16x16x32_bf16 v[24:27], a[140:143], v[196:199], v[24:27]
v_cvt_pk_bf16_f32 v55, v38, v39
v_mfma_f32_16x16x32_bf16 v[32:35], a[140:143], v[212:215], v[148:151]
v_mfma_f32_16x16x32_bf16 v[32:35], a[136:139], v[208:211], v[32:35]
s_add_u32 s44, s44, 4096
v_mfma_f32_16x16x32_bf16 v[32:35], a[132:135], v[204:207], v[32:35]
v_mfma_f32_16x16x32_bf16 v[32:35], a[128:131], v[200:203], v[32:35]
v_mfma_f32_16x16x32_bf16 a[16:19], a[160:163], v[72:75], a[16:19]
v_exp_f32 v8, v8
v_mfma_f32_16x16x32_bf16 a[16:19], a[164:167], v[88:91], a[16:19]
v_exp_f32 v9, v9
v_mfma_f32_16x16x32_bf16 a[48:51], a[164:167], v[92:95], a[48:51]
v_cvt_pk_bf16_f32 v56, v8, v9
v_add_u32 v5, s49, v234
v_mfma_f32_16x16x32_bf16 a[48:51], a[160:163], v[76:79], a[48:51]
s_add_u32 s46, s3, 131072
v_exp_f32 v10, v10
v_mfma_f32_16x16x32_bf16 a[80:83], a[160:163], v[80:83], a[80:83]
v_add_u32 v6, s46, v234
v_lshlrev_b32 v7, 1, v4
v_mfma_f32_16x16x32_bf16 a[80:83], a[164:167], v[96:99], a[80:83]
v_exp_f32 v11, v11
s_waitcnt vmcnt(6) lgkmcnt(0)
s_barrier
v_mfma_f32_16x16x32_bf16 a[112:115], a[164:167], v[100:103], a[112:115]
ds_read_b64_tr_b16 a[164:165], v220 offset:8192
ds_read_b64_tr_b16 a[166:167], v220 offset:12288
v_mfma_f32_16x16x32_bf16 a[112:115], a[160:163], v[84:87], a[112:115]
s_add_u32 m0, s37, 98304
v_exp_f32 v16, v16
v_mfma_f32_16x16x32_bf16 a[116:119], a[168:171], v[84:87], a[116:119]
buffer_load_dwordx4 v232, s[12:15], s39 offen offset:0 lds
v_mfma_f32_16x16x32_bf16 a[116:119], a[172:175], v[100:103], a[116:119]
v_exp_f32 v17, v17
v_mfma_f32_16x16x32_bf16 a[84:87], a[172:175], v[96:99], a[84:87]
ds_read_b64_tr_b16 a[160:161], v220 offset:0
ds_read_b64_tr_b16 a[162:163], v220 offset:4096
v_mfma_f32_16x16x32_bf16 a[84:87], a[168:171], v[80:83], a[84:87]
v_exp_f32 v18, v18
v_mfma_f32_16x16x32_bf16 a[52:55], a[168:171], v[76:79], a[52:55]
v_cvt_pk_bf16_f32 v57, v10, v11
v_cvt_pk_bf16_f32 v60, v16, v17
v_mfma_f32_16x16x32_bf16 a[52:55], a[172:175], v[92:95], a[52:55]
v_exp_f32 v19, v19
v_mfma_f32_16x16x32_bf16 a[20:23], a[172:175], v[88:91], a[20:23]
ds_read_b64_tr_b16 a[172:173], v221 offset:8192
ds_read_b64_tr_b16 a[174:175], v221 offset:12288
v_mfma_f32_16x16x32_bf16 a[20:23], a[168:171], v[72:75], a[20:23]
v_exp_f32 v24, v24
v_smfmac_f32_16x16x64_bf16 a[248:251], a[208:211], v[40:47], v235
buffer_load_dwordx4 v233, s[12:15], s39 offen offset:1024 lds
v_mfma_f32_16x16x32_bf16 v[12:15], a[144:147], v[152:155], v[136:139]
v_exp_f32 v25, v25
v_mfma_f32_16x16x32_bf16 v[12:15], a[148:151], v[156:159], v[12:15]
ds_read_b64_tr_b16 a[168:169], v221 offset:0
ds_read_b64_tr_b16 a[170:171], v221 offset:4096
v_mfma_f32_16x16x32_bf16 v[12:15], a[152:155], v[160:163], v[12:15]
v_exp_f32 v26, v26
v_mfma_f32_16x16x32_bf16 v[12:15], a[156:159], v[164:167], v[12:15]
ds_read_b128 a[128:131], v216 offset:49152
ds_read_b128 a[132:135], v217 offset:49152
v_mfma_f32_16x16x32_bf16 v[20:23], a[156:159], v[180:183], v[140:143]
v_exp_f32 v27, v27
v_mfma_f32_16x16x32_bf16 v[20:23], a[152:155], v[176:179], v[20:23]
ds_read_b128 a[136:139], v218 offset:49152
v_cvt_pk_bf16_f32 v61, v18, v19
v_mfma_f32_16x16x32_bf16 v[20:23], a[148:151], v[172:175], v[20:23]
v_exp_f32 v32, v32
v_mfma_f32_16x16x32_bf16 v[20:23], a[144:147], v[168:171], v[20:23]
ds_read_b128 a[140:143], v219 offset:49152
v_cvt_pk_bf16_f32 v64, v24, v25
v_mfma_f32_16x16x32_bf16 v[28:31], a[144:147], v[184:187], v[144:147]
v_exp_f32 v33, v33
v_mfma_f32_16x16x32_bf16 v[28:31], a[148:151], v[188:191], v[28:31]
buffer_load_dwordx4 v232, s[12:15], s39 offen offset:2048 lds
v_mfma_f32_16x16x32_bf16 v[28:31], a[152:155], v[192:195], v[28:31]
v_exp_f32 v34, v34
v_mfma_f32_16x16x32_bf16 v[28:31], a[156:159], v[196:199], v[28:31]
v_cvt_pk_bf16_f32 v65, v26, v27
v_cvt_pk_bf16_f32 v68, v32, v33
v_mfma_f32_16x16x32_bf16 v[36:39], a[156:159], v[212:215], v[148:151]
v_exp_f32 v35, v35
v_mfma_f32_16x16x32_bf16 v[36:39], a[152:155], v[208:211], v[36:39]
ds_read_b128 a[156:159], v219 offset:53248
ds_read_b128 a[152:155], v218 offset:53248
v_mfma_f32_16x16x32_bf16 v[36:39], a[148:151], v[204:207], v[36:39]
v_exp_f32 v12, v12
v_mfma_f32_16x16x32_bf16 v[36:39], a[144:147], v[200:203], v[36:39]
v_exp_f32 v13, v13
v_mfma_f32_16x16x32_bf16 a[24:27], a[176:179], v[72:75], a[24:27]
ds_read_b128 a[148:151], v217 offset:53248
ds_read_b128 a[144:147], v216 offset:53248
v_mfma_f32_16x16x32_bf16 a[24:27], a[180:183], v[88:91], a[24:27]
v_exp_f32 v14, v14
v_mfma_f32_16x16x32_bf16 a[56:59], a[180:183], v[92:95], a[56:59]
buffer_load_dwordx4 v233, s[12:15], s39 offen offset:3072 lds
v_mfma_f32_16x16x32_bf16 a[56:59], a[176:179], v[76:79], a[56:59]
v_exp_f32 v15, v15
v_mfma_f32_16x16x32_bf16 a[88:91], a[176:179], v[80:83], a[88:91]
v_cvt_pk_bf16_f32 v69, v34, v35
v_cvt_pk_bf16_f32 v58, v12, v13
v_mfma_f32_16x16x32_bf16 a[88:91], a[180:183], v[96:99], a[88:91]
v_exp_f32 v20, v20
v_mfma_f32_16x16x32_bf16 a[120:123], a[180:183], v[100:103], a[120:123]
ds_read_b64_tr_b16 a[180:181], v222 offset:8192
ds_read_b64_tr_b16 a[182:183], v222 offset:12288
v_mfma_f32_16x16x32_bf16 a[120:123], a[176:179], v[84:87], a[120:123]
v_exp_f32 v21, v21
v_mfma_f32_16x16x32_bf16 a[124:127], a[184:187], v[84:87], a[124:127]
ds_read_b64_tr_b16 a[176:177], v222 offset:0
ds_read_b64_tr_b16 a[178:179], v222 offset:4096
v_mfma_f32_16x16x32_bf16 a[124:127], a[188:191], v[100:103], a[124:127]
v_exp_f32 v22, v22
v_mfma_f32_16x16x32_bf16 a[92:95], a[188:191], v[96:99], a[92:95]
v_cvt_pk_bf16_f32 v59, v14, v15
v_cvt_pk_bf16_f32 v62, v20, v21
v_mfma_f32_16x16x32_bf16 a[92:95], a[184:187], v[80:83], a[92:95]
s_add_u32 s39, s39, 16384
v_exp_f32 v23, v23
v_mfma_f32_16x16x32_bf16 a[60:63], a[184:187], v[76:79], a[60:63]
s_add_u32 m0, s37, 16384
v_cvt_pk_bf16_f32 v63, v22, v23
v_xor_b32 v7, v7, v3
v_mfma_f32_16x16x32_bf16 a[60:63], a[188:191], v[92:95], a[60:63]
v_exp_f32 v28, v28
v_mfma_f32_16x16x32_bf16 a[28:31], a[188:191], v[88:91], a[28:31]
buffer_load_dwordx4 v228, s[8:11], s38 offen offset:0 lds
v_mfma_f32_16x16x32_bf16 a[28:31], a[184:187], v[72:75], a[28:31]
v_exp_f32 v29, v29
v_smfmac_f32_16x16x64_bf16 a[252:255], a[208:211], v[48:55], v235
s_waitcnt lgkmcnt(2)
ds_read_b64_tr_b16 a[188:189], v223 offset:8192
ds_read_b64_tr_b16 a[190:191], v223 offset:12288
v_mfma_f32_16x16x32_bf16 v[8:11], a[128:131], v[152:155], v[136:139]
v_exp_f32 v30, v30
v_mfma_f32_16x16x32_bf16 v[8:11], a[132:135], v[156:159], v[8:11]
ds_read_b64_tr_b16 a[184:185], v223 offset:0
ds_read_b64_tr_b16 a[186:187], v223 offset:4096
v_mfma_f32_16x16x32_bf16 v[8:11], a[136:139], v[160:163], v[8:11]
v_exp_f32 v31, v31
v_mfma_f32_16x16x32_bf16 v[8:11], a[140:143], v[164:167], v[8:11]
buffer_load_dwordx4 v229, s[8:11], s38 offen offset:1024 lds
v_mfma_f32_16x16x32_bf16 v[16:19], a[140:143], v[180:183], v[140:143]
v_exp_f32 v36, v36
v_mfma_f32_16x16x32_bf16 v[16:19], a[136:139], v[176:179], v[16:19]
v_cvt_pk_bf16_f32 v66, v28, v29
v_cvt_pk_bf16_f32 v67, v30, v31
v_mfma_f32_16x16x32_bf16 v[16:19], a[132:135], v[172:175], v[16:19]
v_exp_f32 v37, v37
v_mfma_f32_16x16x32_bf16 v[16:19], a[128:131], v[168:171], v[16:19]
v_cvt_pk_bf16_f32 v70, v36, v37
v_mul_u32_u24 v249, 0x480, v4
v_mfma_f32_16x16x32_bf16 v[24:27], a[128:131], v[184:187], v[144:147]
v_exp_f32 v38, v38
v_mfma_f32_16x16x32_bf16 v[24:27], a[132:135], v[188:191], v[24:27]
v_lshl_add_u32 v249, v7, 4, v249
v_and_b32 v7, 8, v7
v_mfma_f32_16x16x32_bf16 v[24:27], a[136:139], v[192:195], v[24:27]
v_exp_f32 v39, v39
v_mfma_f32_16x16x32_bf16 v[24:27], a[140:143], v[196:199], v[24:27]
v_cvt_pk_bf16_f32 v71, v38, v39
v_lshlrev_b32 v7, 5, v7
v_mfma_f32_16x16x32_bf16 v[32:35], a[140:143], v[212:215], v[148:151]
v_sub_u32 v250, v249, v7
v_add_u32 v250, 128, v250
v_mfma_f32_16x16x32_bf16 v[32:35], a[136:139], v[208:211], v[32:35]
v_mfma_f32_16x16x32_bf16 v[32:35], a[132:135], v[204:207], v[32:35]
v_mfma_f32_16x16x32_bf16 v[32:35], a[128:131], v[200:203], v[32:35]
v_mfma_f32_16x16x32_bf16 a[0:3], a[160:163], v[40:43], a[0:3]
s_waitcnt vmcnt(10)
s_nop 0
v_exp_f32 v8, v8
v_mfma_f32_16x16x32_bf16 a[0:3], a[164:167], v[56:59], a[0:3]
v_exp_f32 v9, v9
v_mfma_f32_16x16x32_bf16 a[32:35], a[164:167], v[60:63], a[32:35]
buffer_load_dwordx4 v230, s[8:11], s38 offen offset:2048 lds
v_mfma_f32_16x16x32_bf16 a[32:35], a[160:163], v[44:47], a[32:35]
v_exp_f32 v10, v10
v_mfma_f32_16x16x32_bf16 a[64:67], a[160:163], v[48:51], a[64:67]
ds_read_b64_tr_b16 a[192:193], v248 offset:0
v_cvt_pk_bf16_f32 v72, v8, v9
v_mfma_f32_16x16x32_bf16 a[64:67], a[164:167], v[64:67], a[64:67]
v_exp_f32 v11, v11
v_mfma_f32_16x16x32_bf16 a[96:99], a[164:167], v[68:71], a[96:99]
ds_read_b64_tr_b16 a[164:165], v224 offset:8192
ds_read_b64_tr_b16 a[166:167], v224 offset:12288
v_mfma_f32_16x16x32_bf16 a[96:99], a[160:163], v[52:55], a[96:99]
v_exp_f32 v16, v16
v_mfma_f32_16x16x32_bf16 a[100:103], a[168:171], v[52:55], a[100:103]
ds_read_b64_tr_b16 a[160:161], v224 offset:0
ds_read_b64_tr_b16 a[162:163], v224 offset:4096
v_mfma_f32_16x16x32_bf16 a[100:103], a[172:175], v[68:71], a[100:103]
v_exp_f32 v17, v17
v_mfma_f32_16x16x32_bf16 a[68:71], a[172:175], v[64:67], a[68:71]
v_cvt_pk_bf16_f32 v73, v10, v11
v_cvt_pk_bf16_f32 v76, v16, v17
v_mfma_f32_16x16x32_bf16 a[68:71], a[168:171], v[48:51], a[68:71]
v_exp_f32 v18, v18
v_mfma_f32_16x16x32_bf16 a[36:39], a[168:171], v[44:47], a[36:39]
ds_read_b64_tr_b16 a[194:195], v248 offset:256
ds_read_b64_tr_b16 a[196:197], v248 offset:32
v_mfma_f32_16x16x32_bf16 a[36:39], a[172:175], v[60:63], a[36:39]
v_exp_f32 v19, v19
v_mfma_f32_16x16x32_bf16 a[4:7], a[172:175], v[56:59], a[4:7]
buffer_load_dwordx4 v231, s[8:11], s38 offen offset:3072 lds
v_mfma_f32_16x16x32_bf16 a[4:7], a[168:171], v[40:43], a[4:7]
v_exp_f32 v24, v24
v_smfmac_f32_16x16x64_bf16 a[248:251], a[208:211], v[56:63], v235
ds_read_b64_tr_b16 a[172:173], v225 offset:8192
ds_read_b64_tr_b16 a[174:175], v225 offset:12288
v_mfma_f32_16x16x32_bf16 v[12:15], a[144:147], v[152:155], v[136:139]
v_exp_f32 v25, v25
v_mfma_f32_16x16x32_bf16 v[12:15], a[148:151], v[156:159], v[12:15]
ds_read_b64_tr_b16 a[168:169], v225 offset:0
ds_read_b64_tr_b16 a[170:171], v225 offset:4096
v_mfma_f32_16x16x32_bf16 v[12:15], a[152:155], v[160:163], v[12:15]
v_exp_f32 v26, v26
v_mfma_f32_16x16x32_bf16 v[12:15], a[156:159], v[164:167], v[12:15]
ds_read_b128 a[128:131], v216 offset:57344
ds_read_b128 a[132:135], v217 offset:57344
v_mfma_f32_16x16x32_bf16 v[20:23], a[156:159], v[180:183], v[140:143]
v_exp_f32 v27, v27
v_mfma_f32_16x16x32_bf16 v[20:23], a[152:155], v[176:179], v[20:23]
ds_read_b128 a[136:139], v218 offset:57344
v_cvt_pk_bf16_f32 v77, v18, v19
v_mfma_f32_16x16x32_bf16 v[20:23], a[148:151], v[172:175], v[20:23]
v_exp_f32 v32, v32
v_mfma_f32_16x16x32_bf16 v[20:23], a[144:147], v[168:171], v[20:23]
ds_read_b128 a[140:143], v219 offset:57344
v_cvt_pk_bf16_f32 v80, v24, v25
v_mfma_f32_16x16x32_bf16 v[28:31], a[144:147], v[184:187], v[144:147]
s_add_u32 s38, s38, 16384
v_exp_f32 v33, v33
v_mfma_f32_16x16x32_bf16 v[28:31], a[148:151], v[188:191], v[28:31]
s_add_u32 m0, s37, 114688
v_cvt_pk_bf16_f32 v81, v26, v27
v_cvt_pk_bf16_f32 v84, v32, v33
v_mfma_f32_16x16x32_bf16 v[28:31], a[152:155], v[192:195], v[28:31]
v_exp_f32 v34, v34
v_mfma_f32_16x16x32_bf16 v[28:31], a[156:159], v[196:199], v[28:31]
buffer_load_dwordx4 v232, s[12:15], s39 offen offset:0 lds
v_mfma_f32_16x16x32_bf16 v[36:39], a[156:159], v[212:215], v[148:151]
v_exp_f32 v35, v35
v_mfma_f32_16x16x32_bf16 v[36:39], a[152:155], v[208:211], v[36:39]
ds_read_b128 a[156:159], v219 offset:61440
ds_read_b128 a[152:155], v218 offset:61440
v_mfma_f32_16x16x32_bf16 v[36:39], a[148:151], v[204:207], v[36:39]
v_exp_f32 v12, v12
v_mfma_f32_16x16x32_bf16 v[36:39], a[144:147], v[200:203], v[36:39]
s_waitcnt lgkmcnt(3)
v_exp_f32 v13, v13
v_mfma_f32_16x16x32_bf16 a[8:11], a[176:179], v[40:43], a[8:11]
ds_read_b128 a[148:151], v217 offset:61440
ds_read_b128 a[144:147], v216 offset:61440
v_mfma_f32_16x16x32_bf16 a[8:11], a[180:183], v[56:59], a[8:11]
v_exp_f32 v14, v14
v_mfma_f32_16x16x32_bf16 a[40:43], a[180:183], v[60:63], a[40:43]
v_cvt_pk_bf16_f32 v85, v34, v35
v_cvt_pk_bf16_f32 v74, v12, v13
v_mfma_f32_16x16x32_bf16 a[40:43], a[176:179], v[44:47], a[40:43]
v_exp_f32 v15, v15
v_mfma_f32_16x16x32_bf16 a[72:75], a[176:179], v[48:51], a[72:75]
ds_read_b64_tr_b16 a[198:199], v248 offset:288
v_cvt_pk_bf16_f32 v75, v14, v15
v_mfma_f32_16x16x32_bf16 a[72:75], a[180:183], v[64:67], a[72:75]
v_exp_f32 v20, v20
v_mfma_f32_16x16x32_bf16 a[104:107], a[180:183], v[68:71], a[104:107]
buffer_load_dwordx4 v233, s[12:15], s39 offen offset:1024 lds
v_mfma_f32_16x16x32_bf16 a[104:107], a[176:179], v[52:55], a[104:107]
v_exp_f32 v21, v21
v_mfma_f32_16x16x32_bf16 a[108:111], a[184:187], v[52:55], a[108:111]
ds_read_b64_tr_b16 a[180:181], v226 offset:8192
ds_read_b64_tr_b16 a[182:183], v226 offset:12288
v_mfma_f32_16x16x32_bf16 a[108:111], a[188:191], v[68:71], a[108:111]
v_exp_f32 v22, v22
v_mfma_f32_16x16x32_bf16 a[76:79], a[188:191], v[64:67], a[76:79]
ds_read_b64_tr_b16 a[176:177], v226 offset:0
ds_read_b64_tr_b16 a[178:179], v226 offset:4096
v_mfma_f32_16x16x32_bf16 a[76:79], a[184:187], v[48:51], a[76:79]
v_exp_f32 v23, v23
v_mfma_f32_16x16x32_bf16 a[44:47], a[184:187], v[44:47], a[44:47]
v_cvt_pk_bf16_f32 v78, v20, v21
v_cvt_pk_bf16_f32 v79, v22, v23
v_mfma_f32_16x16x32_bf16 a[44:47], a[188:191], v[60:63], a[44:47]
v_exp_f32 v28, v28
v_mfma_f32_16x16x32_bf16 a[12:15], a[188:191], v[56:59], a[12:15]
ds_read_b64_tr_b16 a[188:189], v227 offset:8192
ds_read_b64_tr_b16 a[190:191], v227 offset:12288
v_mfma_f32_16x16x32_bf16 a[12:15], a[184:187], v[40:43], a[12:15]
v_exp_f32 v29, v29
v_smfmac_f32_16x16x64_bf16 a[252:255], a[208:211], v[64:71], v235
ds_read_b64_tr_b16 a[184:185], v227 offset:0
ds_read_b64_tr_b16 a[186:187], v227 offset:4096
v_mfma_f32_16x16x32_bf16 v[8:11], a[128:131], v[152:155], v[136:139]
v_exp_f32 v30, v30
v_mfma_f32_16x16x32_bf16 v[8:11], a[132:135], v[156:159], v[8:11]
buffer_load_dwordx4 v232, s[12:15], s39 offen offset:2048 lds
v_mfma_f32_16x16x32_bf16 v[8:11], a[136:139], v[160:163], v[8:11]
s_waitcnt lgkmcnt(6)
v_exp_f32 v31, v31
v_mfma_f32_16x16x32_bf16 v[8:11], a[140:143], v[164:167], v[8:11]
v_cvt_pk_bf16_f32 v82, v28, v29
v_cvt_pk_bf16_f32 v83, v30, v31
v_mfma_f32_16x16x32_bf16 v[16:19], a[140:143], v[180:183], v[140:143]
v_exp_f32 v36, v36
v_mfma_f32_16x16x32_bf16 v[16:19], a[136:139], v[176:179], v[16:19]
ds_read_b64_tr_b16 a[200:201], v248 offset:4096
ds_read_b64_tr_b16 a[202:203], v248 offset:4352
v_mfma_f32_16x16x32_bf16 v[16:19], a[132:135], v[172:175], v[16:19]
v_exp_f32 v37, v37
v_mfma_f32_16x16x32_bf16 v[16:19], a[128:131], v[168:171], v[16:19]
ds_read_b64_tr_b16 a[204:205], v248 offset:4128
v_cvt_pk_bf16_f32 v86, v36, v37
v_mfma_f32_16x16x32_bf16 v[24:27], a[128:131], v[184:187], v[144:147]
v_exp_f32 v38, v38
v_mfma_f32_16x16x32_bf16 v[24:27], a[132:135], v[188:191], v[24:27]
ds_read_b64_tr_b16 a[206:207], v248 offset:4384
ds_read_b64_tr_b16 v[120:121], v248 offset:2048
v_mfma_f32_16x16x32_bf16 v[24:27], a[136:139], v[192:195], v[24:27]
v_exp_f32 v39, v39
v_mfma_f32_16x16x32_bf16 v[24:27], a[140:143], v[196:199], v[24:27]
ds_read_b64_tr_b16 v[122:123], v248 offset:2304
v_cvt_pk_bf16_f32 v87, v38, v39
v_mfma_f32_16x16x32_bf16 v[32:35], a[140:143], v[212:215], v[148:151]
ds_read_b64_tr_b16 v[124:125], v248 offset:2080
ds_read_b64_tr_b16 v[126:127], v248 offset:2336
v_mfma_f32_16x16x32_bf16 v[32:35], a[136:139], v[208:211], v[32:35]
ds_read_b64_tr_b16 v[128:129], v248 offset:6144
ds_read_b64_tr_b16 v[130:131], v248 offset:6400
v_mfma_f32_16x16x32_bf16 v[32:35], a[132:135], v[204:207], v[32:35]
ds_read_b64_tr_b16 v[132:133], v248 offset:6176
ds_read_b64_tr_b16 v[134:135], v248 offset:6432
v_mfma_f32_16x16x32_bf16 v[32:35], a[128:131], v[200:203], v[32:35]
v_mfma_f32_16x16x32_bf16 a[16:19], a[160:163], v[40:43], a[16:19]
v_exp_f32 v8, v8
v_mfma_f32_16x16x32_bf16 a[16:19], a[164:167], v[56:59], a[16:19]
buffer_load_dwordx4 v233, s[12:15], s39 offen offset:3072 lds
v_mfma_f32_16x16x32_bf16 a[48:51], a[164:167], v[60:63], a[48:51]
v_exp_f32 v9, v9
v_mfma_f32_16x16x32_bf16 a[48:51], a[160:163], v[44:47], a[48:51]
v_cvt_pk_bf16_f32 v88, v8, v9
v_mfma_f32_16x16x32_bf16 a[80:83], a[160:163], v[48:51], a[80:83]
v_exp_f32 v10, v10
v_mfma_f32_16x16x32_bf16 a[80:83], a[164:167], v[64:67], a[80:83]
v_mfma_f32_16x16x32_bf16 a[112:115], a[164:167], v[68:71], a[112:115]
v_exp_f32 v11, v11
v_mfma_f32_16x16x32_bf16 a[112:115], a[160:163], v[52:55], a[112:115]
ds_read_b64_tr_b16 a[164:165], v220 offset:24576
ds_read_b64_tr_b16 a[166:167], v220 offset:28672
v_mfma_f32_16x16x32_bf16 v[104:107], a[192:195], a[212:215], v[104:107]
s_add_u32 m0, s49, 0
v_exp_f32 v16, v16
v_mfma_f32_16x16x32_bf16 a[116:119], a[168:171], v[52:55], a[116:119]
s_add_u32 s48, s50, 589824
s_waitcnt lgkmcnt(2)
buffer_load_dwordx4 v238, s[56:59], s48 offen  lds
v_mfma_f32_16x16x32_bf16 a[116:119], a[172:175], v[68:71], a[116:119]
v_exp_f32 v17, v17
v_mfma_f32_16x16x32_bf16 a[84:87], a[172:175], v[64:67], a[84:87]
ds_read_b64_tr_b16 a[160:161], v220 offset:16384
ds_read_b64_tr_b16 a[162:163], v220 offset:20480
v_mfma_f32_16x16x32_bf16 a[84:87], a[168:171], v[48:51], a[84:87]
v_cvt_pk_bf16_f32 v89, v10, v11
v_cvt_pk_bf16_f32 v92, v16, v17
v_mfma_f32_16x16x32_bf16 a[52:55], a[168:171], v[44:47], a[52:55]
v_exp_f32 v18, v18
v_mfma_f32_16x16x32_bf16 a[52:55], a[172:175], v[60:63], a[52:55]
v_mfma_f32_16x16x32_bf16 a[20:23], a[172:175], v[56:59], a[20:23]
v_exp_f32 v19, v19
v_mfma_f32_16x16x32_bf16 a[20:23], a[168:171], v[40:43], a[20:23]
s_add_u32 s39, s39, 16384
ds_read_b64_tr_b16 a[172:173], v221 offset:24576
ds_read_b64_tr_b16 a[174:175], v221 offset:28672
v_smfmac_f32_16x16x64_bf16 a[248:251], a[208:211], v[72:79], v235
s_add_u32 m0, s37, 0
v_exp_f32 v24, v24
v_mfma_f32_16x16x32_bf16 v[108:111], a[196:199], a[212:215], v[108:111]
buffer_load_dwordx4 v228, s[8:11], s38 offen offset:0 lds
v_mfma_f32_16x16x32_bf16 v[12:15], a[144:147], v[152:155], v[136:139]
v_exp_f32 v25, v25
v_mfma_f32_16x16x32_bf16 v[12:15], a[148:151], v[156:159], v[12:15]
ds_read_b64_tr_b16 a[168:169], v221 offset:16384
ds_read_b64_tr_b16 a[170:171], v221 offset:20480
v_mfma_f32_16x16x32_bf16 v[12:15], a[152:155], v[160:163], v[12:15]
v_exp_f32 v26, v26
v_mfma_f32_16x16x32_bf16 v[12:15], a[156:159], v[164:167], v[12:15]
ds_read_b128 a[128:131], v216 offset:32768
ds_read_b128 a[132:135], v217 offset:32768
v_mfma_f32_16x16x32_bf16 v[20:23], a[156:159], v[180:183], v[140:143]
ds_read_b128 a[136:139], v218 offset:32768
v_cvt_pk_bf16_f32 v93, v18, v19
v_mfma_f32_16x16x32_bf16 v[20:23], a[152:155], v[176:179], v[20:23]
s_add_u32 m0, s49, 1024
v_exp_f32 v27, v27
v_mfma_f32_16x16x32_bf16 v[20:23], a[148:151], v[172:175], v[20:23]
s_add_u32 s48, s50, 737280
buffer_load_dwordx4 v238, s[56:59], s48 offen  lds
v_mfma_f32_16x16x32_bf16 v[20:23], a[144:147], v[168:171], v[20:23]
v_exp_f32 v32, v32
v_mfma_f32_16x16x32_bf16 v[112:115], a[200:203], a[212:215], v[112:115]
ds_read_b128 a[140:143], v219 offset:32768
v_cvt_pk_bf16_f32 v96, v24, v25
v_mfma_f32_16x16x32_bf16 v[28:31], a[144:147], v[184:187], v[144:147]
v_exp_f32 v33, v33
v_mfma_f32_16x16x32_bf16 v[28:31], a[148:151], v[188:191], v[28:31]
v_cvt_pk_bf16_f32 v97, v26, v27
v_cvt_pk_bf16_f32 v100, v32, v33
v_mfma_f32_16x16x32_bf16 v[28:31], a[152:155], v[192:195], v[28:31]
v_exp_f32 v34, v34
v_mfma_f32_16x16x32_bf16 v[28:31], a[156:159], v[196:199], v[28:31]
v_mfma_f32_16x16x32_bf16 v[36:39], a[156:159], v[212:215], v[148:151]
s_add_u32 m0, s37, 0
v_exp_f32 v35, v35
v_mfma_f32_16x16x32_bf16 v[36:39], a[152:155], v[208:211], v[36:39]
buffer_load_dwordx4 v229, s[8:11], s38 offen offset:1024 lds
v_mfma_f32_16x16x32_bf16 v[36:39], a[148:151], v[204:207], v[36:39]
ds_read_b128 a[156:159], v219 offset:36864
ds_read_b128 a[152:155], v218 offset:36864
v_mfma_f32_16x16x32_bf16 v[36:39], a[144:147], v[200:203], v[36:39]
v_exp_f32 v12, v12
v_mfma_f32_16x16x32_bf16 v[116:119], a[204:207], a[212:215], v[116:119]
ds_read_b128 a[148:151], v217 offset:36864
ds_read_b128 a[144:147], v216 offset:36864
v_mfma_f32_16x16x32_bf16 a[24:27], a[176:179], v[40:43], a[24:27]
v_exp_f32 v13, v13
v_mfma_f32_16x16x32_bf16 a[24:27], a[180:183], v[56:59], a[24:27]
v_cvt_pk_bf16_f32 v101, v34, v35
v_cvt_pk_bf16_f32 v90, v12, v13
v_mfma_f32_16x16x32_bf16 a[56:59], a[180:183], v[60:63], a[56:59]
s_add_u32 m0, s49, 2048
v_exp_f32 v14, v14
v_mfma_f32_16x16x32_bf16 a[56:59], a[176:179], v[44:47], a[56:59]
s_add_u32 s48, s50, 884736
buffer_load_dwordx4 v238, s[56:59], s48 offen  lds
v_mfma_f32_16x16x32_bf16 a[88:91], a[176:179], v[48:51], a[88:91]
v_exp_f32 v15, v15
v_mfma_f32_16x16x32_bf16 a[88:91], a[180:183], v[64:67], a[88:91]
v_cvt_pk_bf16_f32 v91, v14, v15
v_mfma_f32_16x16x32_bf16 a[120:123], a[180:183], v[68:71], a[120:123]
v_exp_f32 v20, v20
v_mfma_f32_16x16x32_bf16 a[120:123], a[176:179], v[52:55], a[120:123]
ds_read_b64_tr_b16 a[180:181], v222 offset:24576
ds_read_b64_tr_b16 a[182:183], v222 offset:28672
v_mfma_f32_16x16x32_bf16 v[104:107], v[120:123], a[216:219], v[104:107]
v_exp_f32 v21, v21
v_mfma_f32_16x16x32_bf16 a[124:127], a[184:187], v[52:55], a[124:127]
ds_read_b64_tr_b16 a[176:177], v222 offset:16384
ds_read_b64_tr_b16 a[178:179], v222 offset:20480
v_mfma_f32_16x16x32_bf16 a[124:127], a[188:191], v[68:71], a[124:127]
s_add_u32 m0, s37, 0
v_cvt_pk_bf16_f32 v94, v20, v21
v_mfma_f32_16x16x32_bf16 a[92:95], a[188:191], v[64:67], a[92:95]
v_exp_f32 v22, v22
v_mfma_f32_16x16x32_bf16 a[92:95], a[184:187], v[48:51], a[92:95]
buffer_load_dwordx4 v230, s[8:11], s38 offen offset:2048 lds
v_mfma_f32_16x16x32_bf16 a[60:63], a[184:187], v[44:47], a[60:63]
v_exp_f32 v23, v23
v_mfma_f32_16x16x32_bf16 a[60:63], a[188:191], v[60:63], a[60:63]
v_cvt_pk_bf16_f32 v95, v22, v23
v_mfma_f32_16x16x32_bf16 a[28:31], a[188:191], v[56:59], a[28:31]
v_exp_f32 v28, v28
v_mfma_f32_16x16x32_bf16 a[28:31], a[184:187], v[40:43], a[28:31]
ds_read_b64_tr_b16 a[188:189], v223 offset:24576
ds_read_b64_tr_b16 a[190:191], v223 offset:28672
v_smfmac_f32_16x16x64_bf16 a[252:255], a[208:211], v[80:87], v235
s_waitcnt lgkmcnt(4)
v_exp_f32 v29, v29
v_mfma_f32_16x16x32_bf16 v[108:111], v[124:127], a[216:219], v[108:111]
s_add_u32 m0, s49, 3072
ds_read_b64_tr_b16 a[184:185], v223 offset:16384
ds_read_b64_tr_b16 a[186:187], v223 offset:20480
v_mfma_f32_16x16x32_bf16 v[8:11], a[128:131], v[152:155], v[136:139]
s_add_u32 s48, s50, 1032192
v_exp_f32 v30, v30
v_mfma_f32_16x16x32_bf16 v[8:11], a[132:135], v[156:159], v[8:11]
buffer_load_dwordx4 v238, s[56:59], s48 offen  lds
v_mfma_f32_16x16x32_bf16 v[8:11], a[136:139], v[160:163], v[8:11]
v_cvt_pk_bf16_f32 v98, v28, v29
v_mfma_f32_16x16x32_bf16 v[8:11], a[140:143], v[164:167], v[8:11]
v_exp_f32 v31, v31
v_mfma_f32_16x16x32_bf16 v[16:19], a[140:143], v[180:183], v[140:143]
v_cvt_pk_bf16_f32 v99, v30, v31
v_mfma_f32_16x16x32_bf16 v[16:19], a[136:139], v[176:179], v[16:19]
v_exp_f32 v36, v36
v_mfma_f32_16x16x32_bf16 v[16:19], a[132:135], v[172:175], v[16:19]
v_mfma_f32_16x16x32_bf16 v[16:19], a[128:131], v[168:171], v[16:19]
s_add_u32 m0, s37, 0
v_exp_f32 v37, v37
v_mfma_f32_16x16x32_bf16 v[112:115], v[128:131], a[216:219], v[112:115]
buffer_load_dwordx4 v231, s[8:11], s38 offen offset:3072 lds
v_mfma_f32_16x16x32_bf16 v[24:27], a[128:131], v[184:187], v[144:147]
v_exp_f32 v38, v38
v_mfma_f32_16x16x32_bf16 v[24:27], a[132:135], v[188:191], v[24:27]
v_cvt_pk_bf16_f32 v102, v36, v37
v_mfma_f32_16x16x32_bf16 v[24:27], a[136:139], v[192:195], v[24:27]
v_exp_f32 v39, v39
v_mfma_f32_16x16x32_bf16 v[24:27], a[140:143], v[196:199], v[24:27]
v_cvt_pk_bf16_f32 v103, v38, v39
v_mfma_f32_16x16x32_bf16 v[32:35], a[140:143], v[212:215], v[148:151]
v_mfma_f32_16x16x32_bf16 v[32:35], a[136:139], v[208:211], v[32:35]
v_mfma_f32_16x16x32_bf16 v[32:35], a[132:135], v[204:207], v[32:35]
s_add_u32 s38, s38, 16384
v_mfma_f32_16x16x32_bf16 v[32:35], a[128:131], v[200:203], v[32:35]
v_mfma_f32_16x16x32_bf16 v[116:119], v[132:135], a[216:219], v[116:119]
v_mfma_f32_16x16x32_bf16 a[0:3], a[160:163], v[72:75], a[0:3]
v_exp_f32 v8, v8
v_mfma_f32_16x16x32_bf16 a[0:3], a[164:167], v[88:91], a[0:3]
s_add_u32 m0, s49, 4096
v_exp_f32 v9, v9
v_mfma_f32_16x16x32_bf16 a[32:35], a[164:167], v[92:95], a[32:35]
s_add_u32 s48, s50, 589824
buffer_load_dwordx4 v238, s[60:63], s48 offen  lds
v_mfma_f32_16x16x32_bf16 a[32:35], a[160:163], v[76:79], a[32:35]
v_exp_f32 v10, v10
v_mfma_f32_16x16x32_bf16 a[64:67], a[160:163], v[80:83], a[64:67]
v_cvt_pk_bf16_f32 v40, v8, v9
v_mfma_f32_16x16x32_bf16 a[64:67], a[164:167], v[96:99], a[64:67]
v_exp_f32 v11, v11
v_mfma_f32_16x16x32_bf16 a[96:99], a[164:167], v[100:103], a[96:99]
ds_read_b64_tr_b16 a[164:165], v224 offset:24576
ds_read_b64_tr_b16 a[166:167], v224 offset:28672
v_mfma_f32_16x16x32_bf16 a[96:99], a[160:163], v[84:87], a[96:99]
v_exp_f32 v16, v16
v_mfma_f32_16x16x32_bf16 a[100:103], a[168:171], v[84:87], a[100:103]
s_add_u32 m0, s49, 5120
ds_read_b64_tr_b16 a[160:161], v224 offset:16384
ds_read_b64_tr_b16 a[162:163], v224 offset:20480
v_mfma_f32_16x16x32_bf16 a[100:103], a[172:175], v[100:103], a[100:103]
s_add_u32 s48, s50, 737280
v_exp_f32 v17, v17
v_mfma_f32_16x16x32_bf16 a[68:71], a[172:175], v[96:99], a[68:71]
buffer_load_dwordx4 v238, s[60:63], s48 offen  lds
v_mfma_f32_16x16x32_bf16 a[68:71], a[168:171], v[80:83], a[68:71]
v_exp_f32 v18, v18
v_mfma_f32_16x16x32_bf16 a[36:39], a[168:171], v[76:79], a[36:39]
v_cvt_pk_bf16_f32 v41, v10, v11
v_cvt_pk_bf16_f32 v44, v16, v17
v_mfma_f32_16x16x32_bf16 a[36:39], a[172:175], v[92:95], a[36:39]
v_exp_f32 v19, v19
v_mfma_f32_16x16x32_bf16 a[4:7], a[172:175], v[88:91], a[4:7]
ds_read_b64_tr_b16 a[172:173], v225 offset:24576
ds_read_b64_tr_b16 a[174:175], v225 offset:28672
v_mfma_f32_16x16x32_bf16 a[4:7], a[168:171], v[72:75], a[4:7]
v_exp_f32 v24, v24
v_smfmac_f32_16x16x64_bf16 a[248:251], a[208:211], v[88:95], v235
s_add_u32 m0, s49, 6144
ds_read_b64_tr_b16 a[168:169], v225 offset:16384
ds_read_b64_tr_b16 a[170:171], v225 offset:20480
v_mfma_f32_16x16x32_bf16 v[12:15], a[144:147], v[152:155], v[136:139]
s_add_u32 s48, s50, 884736
v_exp_f32 v25, v25
v_mfma_f32_16x16x32_bf16 v[12:15], a[148:151], v[156:159], v[12:15]
buffer_load_dwordx4 v238, s[60:63], s48 offen  lds
v_mfma_f32_16x16x32_bf16 v[12:15], a[152:155], v[160:163], v[12:15]
v_exp_f32 v26, v26
v_mfma_f32_16x16x32_bf16 v[12:15], a[156:159], v[164:167], v[12:15]
ds_read_b128 a[128:131], v216 offset:40960
ds_read_b128 a[132:135], v217 offset:40960
v_mfma_f32_16x16x32_bf16 v[20:23], a[156:159], v[180:183], v[140:143]
v_exp_f32 v27, v27
v_mfma_f32_16x16x32_bf16 v[20:23], a[152:155], v[176:179], v[20:23]
ds_read_b128 a[136:139], v218 offset:40960
v_cvt_pk_bf16_f32 v45, v18, v19
v_mfma_f32_16x16x32_bf16 v[20:23], a[148:151], v[172:175], v[20:23]
v_exp_f32 v32, v32
v_mfma_f32_16x16x32_bf16 v[20:23], a[144:147], v[168:171], v[20:23]
s_add_u32 m0, s49, 7168
ds_read_b128 a[140:143], v219 offset:40960
v_cvt_pk_bf16_f32 v48, v24, v25
v_mfma_f32_16x16x32_bf16 v[28:31], a[144:147], v[184:187], v[144:147]
s_add_u32 s48, s50, 1032192
v_exp_f32 v33, v33
v_mfma_f32_16x16x32_bf16 v[28:31], a[148:151], v[188:191], v[28:31]
buffer_load_dwordx4 v238, s[60:63], s48 offen  lds
v_mfma_f32_16x16x32_bf16 v[28:31], a[152:155], v[192:195], v[28:31]
v_exp_f32 v34, v34
v_mfma_f32_16x16x32_bf16 v[28:31], a[156:159], v[196:199], v[28:31]
v_cvt_pk_bf16_f32 v49, v26, v27
v_cvt_pk_bf16_f32 v52, v32, v33
v_mfma_f32_16x16x32_bf16 v[36:39], a[156:159], v[212:215], v[148:151]
v_exp_f32 v35, v35
v_mfma_f32_16x16x32_bf16 v[36:39], a[152:155], v[208:211], v[36:39]
ds_read_b128 a[156:159], v219 offset:45056
ds_read_b128 a[152:155], v218 offset:45056
v_mfma_f32_16x16x32_bf16 v[36:39], a[148:151], v[204:207], v[36:39]
v_exp_f32 v12, v12
v_mfma_f32_16x16x32_bf16 v[36:39], a[144:147], v[200:203], v[36:39]
s_waitcnt lgkmcnt(3)
v_exp_f32 v13, v13
v_mfma_f32_16x16x32_bf16 a[8:11], a[176:179], v[72:75], a[8:11]
buffer_load_dwordx2 v[252:253], v251, s[76:79], s42 offen sc1
v_mfma_f32_16x16x32_bf16 a[8:11], a[180:183], v[88:91], a[8:11]
v_exp_f32 v14, v14
v_mfma_f32_16x16x32_bf16 a[40:43], a[180:183], v[92:95], a[40:43]
ds_read_b128 a[148:151], v217 offset:45056
ds_read_b128 a[144:147], v216 offset:45056
v_mfma_f32_16x16x32_bf16 a[40:43], a[176:179], v[76:79], a[40:43]
v_exp_f32 v15, v15
v_mfma_f32_16x16x32_bf16 a[72:75], a[176:179], v[80:83], a[72:75]
v_cvt_pk_bf16_f32 v53, v34, v35
v_cvt_pk_bf16_f32 v42, v12, v13
v_mfma_f32_16x16x32_bf16 a[72:75], a[180:183], v[96:99], a[72:75]
v_exp_f32 v20, v20
v_mfma_f32_16x16x32_bf16 a[104:107], a[180:183], v[100:103], a[104:107]
s_add_u32 s42, s42, s43
buffer_load_dword v255, v243, s[28:31], s45 offen
v_mfma_f32_16x16x32_bf16 a[104:107], a[176:179], v[84:87], a[104:107]
v_exp_f32 v21, v21
v_mfma_f32_16x16x32_bf16 a[108:111], a[184:187], v[84:87], a[108:111]
ds_read_b64_tr_b16 a[180:181], v226 offset:24576
ds_read_b64_tr_b16 a[182:183], v226 offset:28672
v_mfma_f32_16x16x32_bf16 a[108:111], a[188:191], v[100:103], a[108:111]
v_exp_f32 v22, v22
v_mfma_f32_16x16x32_bf16 a[76:79], a[188:191], v[96:99], a[76:79]
ds_read_b64_tr_b16 a[176:177], v226 offset:16384
ds_read_b64_tr_b16 a[178:179], v226 offset:20480
v_mfma_f32_16x16x32_bf16 a[76:79], a[184:187], v[80:83], a[76:79]
v_exp_f32 v23, v23
v_mfma_f32_16x16x32_bf16 a[44:47], a[184:187], v[76:79], a[44:47]
v_cvt_pk_bf16_f32 v43, v14, v15
v_cvt_pk_bf16_f32 v46, v20, v21
v_mfma_f32_16x16x32_bf16 a[44:47], a[188:191], v[92:95], a[44:47]
v_exp_f32 v28, v28
v_mfma_f32_16x16x32_bf16 a[12:15], a[188:191], v[88:91], a[12:15]
s_add_u32 s45, s45, 589824
global_load_dword v255, v242, s[72:73]
v_mfma_f32_16x16x32_bf16 a[12:15], a[184:187], v[72:75], a[12:15]
v_exp_f32 v29, v29
v_smfmac_f32_16x16x64_bf16 a[252:255], a[208:211], v[96:103], v235
ds_read_b64_tr_b16 a[188:189], v227 offset:24576
ds_read_b64_tr_b16 a[190:191], v227 offset:28672
v_mfma_f32_16x16x32_bf16 v[8:11], a[128:131], v[152:155], v[136:139]
v_exp_f32 v30, v30
v_mfma_f32_16x16x32_bf16 v[8:11], a[132:135], v[156:159], v[8:11]
ds_read_b64_tr_b16 a[184:185], v227 offset:16384
ds_read_b64_tr_b16 a[186:187], v227 offset:20480
v_mfma_f32_16x16x32_bf16 v[8:11], a[136:139], v[160:163], v[8:11]
s_waitcnt lgkmcnt(6)
v_exp_f32 v31, v31
v_mfma_f32_16x16x32_bf16 v[8:11], a[140:143], v[164:167], v[8:11]
v_cvt_pk_bf16_f32 v47, v22, v23
v_cvt_pk_bf16_f32 v50, v28, v29
v_mfma_f32_16x16x32_bf16 v[16:19], a[140:143], v[180:183], v[140:143]
v_exp_f32 v36, v36
v_mfma_f32_16x16x32_bf16 v[16:19], a[136:139], v[176:179], v[16:19]
buffer_load_dword v255, v0, s[24:27], s44 offen
v_mfma_f32_16x16x32_bf16 v[16:19], a[132:135], v[172:175], v[16:19]
v_exp_f32 v37, v37
v_mfma_f32_16x16x32_bf16 v[16:19], a[128:131], v[168:171], v[16:19]
v_cvt_pk_bf16_f32 v51, v30, v31
v_cvt_pk_bf16_f32 v54, v36, v37
v_mfma_f32_16x16x32_bf16 v[24:27], a[128:131], v[184:187], v[144:147]
v_exp_f32 v38, v38
v_mfma_f32_16x16x32_bf16 v[24:27], a[132:135], v[188:191], v[24:27]
v_mfma_f32_16x16x32_bf16 v[24:27], a[136:139], v[192:195], v[24:27]
v_exp_f32 v39, v39
v_mfma_f32_16x16x32_bf16 v[24:27], a[140:143], v[196:199], v[24:27]
v_cvt_pk_bf16_f32 v55, v38, v39
v_mfma_f32_16x16x32_bf16 v[32:35], a[140:143], v[212:215], v[148:151]
v_mfma_f32_16x16x32_bf16 v[32:35], a[136:139], v[208:211], v[32:35]
s_add_u32 s44, s44, 4096
v_mfma_f32_16x16x32_bf16 v[32:35], a[132:135], v[204:207], v[32:35]
v_mfma_f32_16x16x32_bf16 v[32:35], a[128:131], v[200:203], v[32:35]
v_mfma_f32_16x16x32_bf16 a[16:19], a[160:163], v[72:75], a[16:19]
v_exp_f32 v8, v8
v_mfma_f32_16x16x32_bf16 a[16:19], a[164:167], v[88:91], a[16:19]
v_exp_f32 v9, v9
v_mfma_f32_16x16x32_bf16 a[48:51], a[164:167], v[92:95], a[48:51]
v_cvt_pk_bf16_f32 v56, v8, v9
v_mfma_f32_16x16x32_bf16 a[48:51], a[160:163], v[76:79], a[48:51]
v_exp_f32 v10, v10
v_mfma_f32_16x16x32_bf16 a[80:83], a[160:163], v[80:83], a[80:83]
v_mfma_f32_16x16x32_bf16 a[80:83], a[164:167], v[96:99], a[80:83]
v_exp_f32 v11, v11
s_waitcnt vmcnt(8) lgkmcnt(0)
s_barrier
v_mfma_f32_16x16x32_bf16 a[112:115], a[164:167], v[100:103], a[112:115]
ds_read_b64_tr_b16 a[164:165], v220 offset:40960
ds_read_b64_tr_b16 a[166:167], v220 offset:45056
v_mfma_f32_16x16x32_bf16 a[112:115], a[160:163], v[84:87], a[112:115]
s_add_u32 m0, s37, 65536
v_exp_f32 v16, v16
v_mfma_f32_16x16x32_bf16 a[116:119], a[168:171], v[84:87], a[116:119]
buffer_load_dwordx4 v232, s[12:15], s39 offen offset:0 lds
v_mfma_f32_16x16x32_bf16 a[116:119], a[172:175], v[100:103], a[116:119]
v_exp_f32 v17, v17
v_mfma_f32_16x16x32_bf16 a[84:87], a[172:175], v[96:99], a[84:87]
ds_read_b64_tr_b16 a[160:161], v220 offset:32768
ds_read_b64_tr_b16 a[162:163], v220 offset:36864
v_mfma_f32_16x16x32_bf16 a[84:87], a[168:171], v[80:83], a[84:87]
v_exp_f32 v18, v18
v_mfma_f32_16x16x32_bf16 a[52:55], a[168:171], v[76:79], a[52:55]
v_cvt_pk_bf16_f32 v57, v10, v11
v_cvt_pk_bf16_f32 v60, v16, v17
v_mfma_f32_16x16x32_bf16 a[52:55], a[172:175], v[92:95], a[52:55]
v_exp_f32 v19, v19
v_mfma_f32_16x16x32_bf16 a[20:23], a[172:175], v[88:91], a[20:23]
ds_read_b64_tr_b16 a[172:173], v221 offset:40960
ds_read_b64_tr_b16 a[174:175], v221 offset:45056
v_mfma_f32_16x16x32_bf16 a[20:23], a[168:171], v[72:75], a[20:23]
v_exp_f32 v24, v24
v_smfmac_f32_16x16x64_bf16 a[248:251], a[208:211], v[40:47], v235
buffer_load_dwordx4 v233, s[12:15], s39 offen offset:1024 lds
v_mfma_f32_16x16x32_bf16 v[12:15], a[144:147], v[152:155], v[136:139]
v_exp_f32 v25, v25
v_mfma_f32_16x16x32_bf16 v[12:15], a[148:151], v[156:159], v[12:15]
ds_read_b64_tr_b16 a[168:169], v221 offset:32768
ds_read_b64_tr_b16 a[170:171], v221 offset:36864
v_mfma_f32_16x16x32_bf16 v[12:15], a[152:155], v[160:163], v[12:15]
v_exp_f32 v26, v26
v_mfma_f32_16x16x32_bf16 v[12:15], a[156:159], v[164:167], v[12:15]
ds_read_b128 a[128:131], v216 offset:16384
ds_read_b128 a[132:135], v217 offset:16384
v_mfma_f32_16x16x32_bf16 v[20:23], a[156:159], v[180:183], v[140:143]
v_exp_f32 v27, v27
v_mfma_f32_16x16x32_bf16 v[20:23], a[152:155], v[176:179], v[20:23]
ds_read_b128 a[136:139], v218 offset:16384
v_cvt_pk_bf16_f32 v61, v18, v19
v_mfma_f32_16x16x32_bf16 v[20:23], a[148:151], v[172:175], v[20:23]
v_exp_f32 v32, v32
v_mfma_f32_16x16x32_bf16 v[20:23], a[144:147], v[168:171], v[20:23]
ds_read_b128 a[140:143], v219 offset:16384
v_cvt_pk_bf16_f32 v64, v24, v25
v_mfma_f32_16x16x32_bf16 v[28:31], a[144:147], v[184:187], v[144:147]
v_exp_f32 v33, v33
v_mfma_f32_16x16x32_bf16 v[28:31], a[148:151], v[188:191], v[28:31]
buffer_load_dwordx4 v232, s[12:15], s39 offen offset:2048 lds
v_mfma_f32_16x16x32_bf16 v[28:31], a[152:155], v[192:195], v[28:31]
v_exp_f32 v34, v34
v_mfma_f32_16x16x32_bf16 v[28:31], a[156:159], v[196:199], v[28:31]
v_cvt_pk_bf16_f32 v65, v26, v27
v_cvt_pk_bf16_f32 v68, v32, v33
v_mfma_f32_16x16x32_bf16 v[36:39], a[156:159], v[212:215], v[148:151]
v_exp_f32 v35, v35
v_mfma_f32_16x16x32_bf16 v[36:39], a[152:155], v[208:211], v[36:39]
ds_read_b128 a[156:159], v219 offset:20480
ds_read_b128 a[152:155], v218 offset:20480
v_mfma_f32_16x16x32_bf16 v[36:39], a[148:151], v[204:207], v[36:39]
v_exp_f32 v12, v12
v_mfma_f32_16x16x32_bf16 v[36:39], a[144:147], v[200:203], v[36:39]
v_exp_f32 v13, v13
v_mfma_f32_16x16x32_bf16 a[24:27], a[176:179], v[72:75], a[24:27]
ds_read_b128 a[148:151], v217 offset:20480
ds_read_b128 a[144:147], v216 offset:20480
v_mfma_f32_16x16x32_bf16 a[24:27], a[180:183], v[88:91], a[24:27]
v_exp_f32 v14, v14
v_mfma_f32_16x16x32_bf16 a[56:59], a[180:183], v[92:95], a[56:59]
buffer_load_dwordx4 v233, s[12:15], s39 offen offset:3072 lds
v_mfma_f32_16x16x32_bf16 a[56:59], a[176:179], v[76:79], a[56:59]
v_exp_f32 v15, v15
v_mfma_f32_16x16x32_bf16 a[88:91], a[176:179], v[80:83], a[88:91]
v_cvt_pk_bf16_f32 v69, v34, v35
v_cvt_pk_bf16_f32 v58, v12, v13
v_mfma_f32_16x16x32_bf16 a[88:91], a[180:183], v[96:99], a[88:91]
v_exp_f32 v20, v20
v_mfma_f32_16x16x32_bf16 a[120:123], a[180:183], v[100:103], a[120:123]
ds_read_b64_tr_b16 a[180:181], v222 offset:40960
ds_read_b64_tr_b16 a[182:183], v222 offset:45056
v_mfma_f32_16x16x32_bf16 a[120:123], a[176:179], v[84:87], a[120:123]
v_exp_f32 v21, v21
v_mfma_f32_16x16x32_bf16 a[124:127], a[184:187], v[84:87], a[124:127]
ds_read_b64_tr_b16 a[176:177], v222 offset:32768
ds_read_b64_tr_b16 a[178:179], v222 offset:36864
v_mfma_f32_16x16x32_bf16 a[124:127], a[188:191], v[100:103], a[124:127]
v_exp_f32 v22, v22
v_mfma_f32_16x16x32_bf16 a[92:95], a[188:191], v[96:99], a[92:95]
v_cvt_pk_bf16_f32 v59, v14, v15
v_cvt_pk_bf16_f32 v62, v20, v21
v_mfma_f32_16x16x32_bf16 a[92:95], a[184:187], v[80:83], a[92:95]
s_add_u32 s39, s39, 16384
v_exp_f32 v23, v23
v_mfma_f32_16x16x32_bf16 a[60:63], a[184:187], v[76:79], a[60:63]
s_add_u32 m0, s37, 49152
v_cvt_pk_bf16_f32 v63, v22, v23
v_mfma_f32_16x16x32_bf16 a[60:63], a[188:191], v[92:95], a[60:63]
v_exp_f32 v28, v28
v_mfma_f32_16x16x32_bf16 a[28:31], a[188:191], v[88:91], a[28:31]
buffer_load_dwordx4 v228, s[8:11], s38 offen offset:0 lds
v_mfma_f32_16x16x32_bf16 a[28:31], a[184:187], v[72:75], a[28:31]
v_exp_f32 v29, v29
v_smfmac_f32_16x16x64_bf16 a[252:255], a[208:211], v[48:55], v235
s_waitcnt lgkmcnt(2)
ds_read_b64_tr_b16 a[188:189], v223 offset:40960
ds_read_b64_tr_b16 a[190:191], v223 offset:45056
v_mfma_f32_16x16x32_bf16 v[8:11], a[128:131], v[152:155], v[136:139]
v_exp_f32 v30, v30
v_mfma_f32_16x16x32_bf16 v[8:11], a[132:135], v[156:159], v[8:11]
ds_read_b64_tr_b16 a[184:185], v223 offset:32768
ds_read_b64_tr_b16 a[186:187], v223 offset:36864
v_mfma_f32_16x16x32_bf16 v[8:11], a[136:139], v[160:163], v[8:11]
v_exp_f32 v31, v31
v_mfma_f32_16x16x32_bf16 v[8:11], a[140:143], v[164:167], v[8:11]
buffer_load_dwordx4 v229, s[8:11], s38 offen offset:1024 lds
v_mfma_f32_16x16x32_bf16 v[16:19], a[140:143], v[180:183], v[140:143]
v_exp_f32 v36, v36
v_mfma_f32_16x16x32_bf16 v[16:19], a[136:139], v[176:179], v[16:19]
v_cvt_pk_bf16_f32 v66, v28, v29
v_cvt_pk_bf16_f32 v67, v30, v31
v_mfma_f32_16x16x32_bf16 v[16:19], a[132:135], v[172:175], v[16:19]
v_exp_f32 v37, v37
v_mfma_f32_16x16x32_bf16 v[16:19], a[128:131], v[168:171], v[16:19]
v_cvt_pk_bf16_f32 v70, v36, v37
v_mfma_f32_16x16x32_bf16 v[24:27], a[128:131], v[184:187], v[144:147]
v_exp_f32 v38, v38
v_mfma_f32_16x16x32_bf16 v[24:27], a[132:135], v[188:191], v[24:27]
v_mfma_f32_16x16x32_bf16 v[24:27], a[136:139], v[192:195], v[24:27]
v_exp_f32 v39, v39
v_mfma_f32_16x16x32_bf16 v[24:27], a[140:143], v[196:199], v[24:27]
v_cvt_pk_bf16_f32 v71, v38, v39
v_mfma_f32_16x16x32_bf16 v[32:35], a[140:143], v[212:215], v[148:151]
v_mfma_f32_16x16x32_bf16 v[32:35], a[136:139], v[208:211], v[32:35]
v_mfma_f32_16x16x32_bf16 v[32:35], a[132:135], v[204:207], v[32:35]
v_mfma_f32_16x16x32_bf16 v[32:35], a[128:131], v[200:203], v[32:35]
v_mfma_f32_16x16x32_bf16 a[0:3], a[160:163], v[40:43], a[0:3]
v_exp_f32 v8, v8
v_mfma_f32_16x16x32_bf16 a[0:3], a[164:167], v[56:59], a[0:3]
v_exp_f32 v9, v9
v_mfma_f32_16x16x32_bf16 a[32:35], a[164:167], v[60:63], a[32:35]
buffer_load_dwordx4 v230, s[8:11], s38 offen offset:2048 lds
v_mfma_f32_16x16x32_bf16 a[32:35], a[160:163], v[44:47], a[32:35]
v_exp_f32 v10, v10
v_mfma_f32_16x16x32_bf16 a[64:67], a[160:163], v[48:51], a[64:67]
v_cvt_pk_bf16_f32 v72, v8, v9
v_mfma_f32_16x16x32_bf16 a[64:67], a[164:167], v[64:67], a[64:67]
v_exp_f32 v11, v11
v_mfma_f32_16x16x32_bf16 a[96:99], a[164:167], v[68:71], a[96:99]
ds_read_b64_tr_b16 a[164:165], v224 offset:40960
ds_read_b64_tr_b16 a[166:167], v224 offset:45056
v_mfma_f32_16x16x32_bf16 a[96:99], a[160:163], v[52:55], a[96:99]
v_exp_f32 v16, v16
v_mfma_f32_16x16x32_bf16 a[100:103], a[168:171], v[52:55], a[100:103]
ds_read_b64_tr_b16 a[160:161], v224 offset:32768
ds_read_b64_tr_b16 a[162:163], v224 offset:36864
v_mfma_f32_16x16x32_bf16 a[100:103], a[172:175], v[68:71], a[100:103]
v_exp_f32 v17, v17
v_mfma_f32_16x16x32_bf16 a[68:71], a[172:175], v[64:67], a[68:71]
v_cvt_pk_bf16_f32 v73, v10, v11
v_cvt_pk_bf16_f32 v76, v16, v17
v_mfma_f32_16x16x32_bf16 a[68:71], a[168:171], v[48:51], a[68:71]
v_exp_f32 v18, v18
v_mfma_f32_16x16x32_bf16 a[36:39], a[168:171], v[44:47], a[36:39]
v_mfma_f32_16x16x32_bf16 a[36:39], a[172:175], v[60:63], a[36:39]
v_exp_f32 v19, v19
v_mfma_f32_16x16x32_bf16 a[4:7], a[172:175], v[56:59], a[4:7]
buffer_load_dwordx4 v231, s[8:11], s38 offen offset:3072 lds
v_mfma_f32_16x16x32_bf16 a[4:7], a[168:171], v[40:43], a[4:7]
v_exp_f32 v24, v24
v_smfmac_f32_16x16x64_bf16 a[248:251], a[208:211], v[56:63], v235
ds_read_b64_tr_b16 a[172:173], v225 offset:40960
ds_read_b64_tr_b16 a[174:175], v225 offset:45056
v_mfma_f32_16x16x32_bf16 v[12:15], a[144:147], v[152:155], v[136:139]
v_exp_f32 v25, v25
v_mfma_f32_16x16x32_bf16 v[12:15], a[148:151], v[156:159], v[12:15]
ds_read_b64_tr_b16 a[168:169], v225 offset:32768
ds_read_b64_tr_b16 a[170:171], v225 offset:36864
v_mfma_f32_16x16x32_bf16 v[12:15], a[152:155], v[160:163], v[12:15]
v_exp_f32 v26, v26
v_mfma_f32_16x16x32_bf16 v[12:15], a[156:159], v[164:167], v[12:15]
s_waitcnt vmcnt(12)
s_nop 0
ds_read_b128 a[128:131], v216 offset:24576
ds_read_b128 a[132:135], v217 offset:24576
v_mfma_f32_16x16x32_bf16 v[20:23], a[156:159], v[180:183], v[140:143]
v_exp_f32 v27, v27
v_mfma_f32_16x16x32_bf16 v[20:23], a[152:155], v[176:179], v[20:23]
ds_read_b128 a[136:139], v218 offset:24576
v_cvt_pk_bf16_f32 v77, v18, v19
v_mfma_f32_16x16x32_bf16 v[20:23], a[148:151], v[172:175], v[20:23]
v_exp_f32 v32, v32
v_mfma_f32_16x16x32_bf16 v[20:23], a[144:147], v[168:171], v[20:23]
ds_read_b128 a[140:143], v219 offset:24576
v_cvt_pk_bf16_f32 v80, v24, v25
v_mfma_f32_16x16x32_bf16 v[28:31], a[144:147], v[184:187], v[144:147]
s_add_u32 s38, s38, 16384
v_exp_f32 v33, v33
v_mfma_f32_16x16x32_bf16 v[28:31], a[148:151], v[188:191], v[28:31]
s_add_u32 m0, s37, 81920
v_cvt_pk_bf16_f32 v81, v26, v27
v_cvt_pk_bf16_f32 v84, v32, v33
v_mfma_f32_16x16x32_bf16 v[28:31], a[152:155], v[192:195], v[28:31]
v_exp_f32 v34, v34
v_mfma_f32_16x16x32_bf16 v[28:31], a[156:159], v[196:199], v[28:31]
buffer_load_dwordx4 v232, s[12:15], s39 offen offset:0 lds
v_mfma_f32_16x16x32_bf16 v[36:39], a[156:159], v[212:215], v[148:151]
v_exp_f32 v35, v35
v_mfma_f32_16x16x32_bf16 v[36:39], a[152:155], v[208:211], v[36:39]
ds_read_b128 a[156:159], v219 offset:28672
ds_read_b128 a[152:155], v218 offset:28672
v_mfma_f32_16x16x32_bf16 v[36:39], a[148:151], v[204:207], v[36:39]
v_exp_f32 v12, v12
v_mfma_f32_16x16x32_bf16 v[36:39], a[144:147], v[200:203], v[36:39]
s_waitcnt lgkmcnt(3)
v_exp_f32 v13, v13
v_mfma_f32_16x16x32_bf16 a[8:11], a[176:179], v[40:43], a[8:11]
ds_read_b128 a[148:151], v217 offset:28672
ds_read_b128 a[144:147], v216 offset:28672
v_mfma_f32_16x16x32_bf16 a[8:11], a[180:183], v[56:59], a[8:11]
v_exp_f32 v14, v14
v_mfma_f32_16x16x32_bf16 a[40:43], a[180:183], v[60:63], a[40:43]
v_cvt_pk_bf16_f32 v85, v34, v35
v_cvt_pk_bf16_f32 v74, v12, v13
v_mfma_f32_16x16x32_bf16 a[40:43], a[176:179], v[44:47], a[40:43]
v_exp_f32 v15, v15
v_mfma_f32_16x16x32_bf16 a[72:75], a[176:179], v[48:51], a[72:75]
ds_read_b64_tr_b16 a[192:193], v248 offset:0
v_cvt_pk_bf16_f32 v75, v14, v15
v_mfma_f32_16x16x32_bf16 a[72:75], a[180:183], v[64:67], a[72:75]
v_exp_f32 v20, v20
v_mfma_f32_16x16x32_bf16 a[104:107], a[180:183], v[68:71], a[104:107]
buffer_load_dwordx4 v233, s[12:15], s39 offen offset:1024 lds
v_mfma_f32_16x16x32_bf16 a[104:107], a[176:179], v[52:55], a[104:107]
v_exp_f32 v21, v21
v_mfma_f32_16x16x32_bf16 a[108:111], a[184:187], v[52:55], a[108:111]
ds_read_b64_tr_b16 a[180:181], v226 offset:40960
ds_read_b64_tr_b16 a[182:183], v226 offset:45056
v_mfma_f32_16x16x32_bf16 a[108:111], a[188:191], v[68:71], a[108:111]
v_exp_f32 v22, v22
v_mfma_f32_16x16x32_bf16 a[76:79], a[188:191], v[64:67], a[76:79]
ds_read_b64_tr_b16 a[176:177], v226 offset:32768
ds_read_b64_tr_b16 a[178:179], v226 offset:36864
v_mfma_f32_16x16x32_bf16 a[76:79], a[184:187], v[48:51], a[76:79]
v_exp_f32 v23, v23
v_mfma_f32_16x16x32_bf16 a[44:47], a[184:187], v[44:47], a[44:47]
v_cvt_pk_bf16_f32 v78, v20, v21
v_cvt_pk_bf16_f32 v79, v22, v23
v_mfma_f32_16x16x32_bf16 a[44:47], a[188:191], v[60:63], a[44:47]
v_exp_f32 v28, v28
v_mfma_f32_16x16x32_bf16 a[12:15], a[188:191], v[56:59], a[12:15]
ds_read_b64_tr_b16 a[188:189], v227 offset:40960
ds_read_b64_tr_b16 a[190:191], v227 offset:45056
v_mfma_f32_16x16x32_bf16 a[12:15], a[184:187], v[40:43], a[12:15]
v_exp_f32 v29, v29
v_smfmac_f32_16x16x64_bf16 a[252:255], a[208:211], v[64:71], v235
ds_read_b64_tr_b16 a[184:185], v227 offset:32768
ds_read_b64_tr_b16 a[186:187], v227 offset:36864
v_mfma_f32_16x16x32_bf16 v[8:11], a[128:131], v[152:155], v[136:139]
v_exp_f32 v30, v30
v_mfma_f32_16x16x32_bf16 v[8:11], a[132:135], v[156:159], v[8:11]
buffer_load_dwordx4 v232, s[12:15], s39 offen offset:2048 lds
v_mfma_f32_16x16x32_bf16 v[8:11], a[136:139], v[160:163], v[8:11]
s_waitcnt lgkmcnt(6)
v_exp_f32 v31, v31
v_mfma_f32_16x16x32_bf16 v[8:11], a[140:143], v[164:167], v[8:11]
v_cvt_pk_bf16_f32 v82, v28, v29
v_cvt_pk_bf16_f32 v83, v30, v31
v_mfma_f32_16x16x32_bf16 v[16:19], a[140:143], v[180:183], v[140:143]
v_exp_f32 v36, v36
v_mfma_f32_16x16x32_bf16 v[16:19], a[136:139], v[176:179], v[16:19]
ds_read_b64_tr_b16 a[194:195], v248 offset:256
ds_read_b64_tr_b16 a[196:197], v248 offset:32
v_mfma_f32_16x16x32_bf16 v[16:19], a[132:135], v[172:175], v[16:19]
v_exp_f32 v37, v37
v_mfma_f32_16x16x32_bf16 v[16:19], a[128:131], v[168:171], v[16:19]
ds_read_b64_tr_b16 a[198:199], v248 offset:288
v_cvt_pk_bf16_f32 v86, v36, v37
v_mfma_f32_16x16x32_bf16 v[24:27], a[128:131], v[184:187], v[144:147]
v_exp_f32 v38, v38
v_mfma_f32_16x16x32_bf16 v[24:27], a[132:135], v[188:191], v[24:27]
ds_read_b64_tr_b16 a[200:201], v248 offset:4096
ds_read_b64_tr_b16 a[202:203], v248 offset:4352
v_mfma_f32_16x16x32_bf16 v[24:27], a[136:139], v[192:195], v[24:27]
v_exp_f32 v39, v39
v_mfma_f32_16x16x32_bf16 v[24:27], a[140:143], v[196:199], v[24:27]
ds_read_b64_tr_b16 a[204:205], v248 offset:4128
v_cvt_pk_bf16_f32 v87, v38, v39
v_mfma_f32_16x16x32_bf16 v[32:35], a[140:143], v[212:215], v[148:151]
ds_read_b64_tr_b16 a[206:207], v248 offset:4384
ds_read_b64_tr_b16 v[120:121], v248 offset:2048
v_mfma_f32_16x16x32_bf16 v[32:35], a[136:139], v[208:211], v[32:35]
ds_read_b64_tr_b16 v[122:123], v248 offset:2304
v_mfma_f32_16x16x32_bf16 v[32:35], a[132:135], v[204:207], v[32:35]
v_mfma_f32_16x16x32_bf16 v[32:35], a[128:131], v[200:203], v[32:35]
v_mfma_f32_16x16x32_bf16 a[16:19], a[160:163], v[40:43], a[16:19]
s_sub_u32 s90, s49, 0xf000
v_exp_f32 v8, v8
v_mfma_f32_16x16x32_bf16 a[16:19], a[164:167], v[56:59], a[16:19]
buffer_load_dwordx4 v233, s[12:15], s39 offen offset:3072 lds
v_mfma_f32_16x16x32_bf16 a[48:51], a[164:167], v[60:63], a[48:51]
v_exp_f32 v9, v9
v_mfma_f32_16x16x32_bf16 a[48:51], a[160:163], v[44:47], a[48:51]
ds_read_b64_tr_b16 v[124:125], v248 offset:2080
v_cvt_pk_bf16_f32 v88, v8, v9
v_mfma_f32_16x16x32_bf16 a[80:83], a[160:163], v[48:51], a[80:83]
v_exp_f32 v10, v10
v_mfma_f32_16x16x32_bf16 a[80:83], a[164:167], v[64:67], a[80:83]
ds_read_b64_tr_b16 v[126:127], v248 offset:2336
ds_read_b64_tr_b16 v[128:129], v248 offset:6144
v_mfma_f32_16x16x32_bf16 a[112:115], a[164:167], v[68:71], a[112:115]
v_exp_f32 v11, v11
v_mfma_f32_16x16x32_bf16 a[112:115], a[160:163], v[52:55], a[112:115]
s_waitcnt lgkmcnt(3)
ds_read_b64_tr_b16 a[164:165], v220 offset:57344
ds_read_b64_tr_b16 a[166:167], v220 offset:61440
v_mfma_f32_16x16x32_bf16 v[104:107], a[192:195], a[220:223], v[104:107]
v_exp_f32 v16, v16
v_mfma_f32_16x16x32_bf16 a[116:119], a[168:171], v[52:55], a[116:119]
ds_read_b64_tr_b16 a[160:161], v220 offset:49152
ds_read_b64_tr_b16 a[162:163], v220 offset:53248
v_mfma_f32_16x16x32_bf16 a[116:119], a[172:175], v[68:71], a[116:119]
v_exp_f32 v17, v17
v_mfma_f32_16x16x32_bf16 a[84:87], a[172:175], v[64:67], a[84:87]
v_cvt_pk_bf16_f32 v89, v10, v11
v_cvt_pk_bf16_f32 v92, v16, v17
v_mfma_f32_16x16x32_bf16 a[84:87], a[168:171], v[48:51], a[84:87]
ds_read_b64_tr_b16 v[130:131], v248 offset:6400
ds_read_b64_tr_b16 v[132:133], v248 offset:6176
v_mfma_f32_16x16x32_bf16 a[52:55], a[168:171], v[44:47], a[52:55]
v_exp_f32 v18, v18
v_mfma_f32_16x16x32_bf16 a[52:55], a[172:175], v[60:63], a[52:55]
ds_read_b64_tr_b16 v[134:135], v248 offset:6432
v_mfma_f32_16x16x32_bf16 a[20:23], a[172:175], v[56:59], a[20:23]
s_add_u32 s39, s39, 16384
v_exp_f32 v19, v19
v_mfma_f32_16x16x32_bf16 a[20:23], a[168:171], v[40:43], a[20:23]
s_add_u32 m0, s37, 32768
ds_read_b64_tr_b16 a[172:173], v221 offset:57344
ds_read_b64_tr_b16 a[174:175], v221 offset:61440
v_smfmac_f32_16x16x64_bf16 a[248:251], a[208:211], v[72:79], v235
v_exp_f32 v24, v24
v_mfma_f32_16x16x32_bf16 v[108:111], a[196:199], a[220:223], v[108:111]
buffer_load_dwordx4 v228, s[8:11], s38 offen offset:0 lds
v_mfma_f32_16x16x32_bf16 v[12:15], a[144:147], v[152:155], v[136:139]
v_exp_f32 v25, v25
v_mfma_f32_16x16x32_bf16 v[12:15], a[148:151], v[156:159], v[12:15]
ds_read_b64_tr_b16 a[168:169], v221 offset:49152
ds_read_b64_tr_b16 a[170:171], v221 offset:53248
v_mfma_f32_16x16x32_bf16 v[12:15], a[152:155], v[160:163], v[12:15]
v_exp_f32 v26, v26
v_mfma_f32_16x16x32_bf16 v[12:15], a[156:159], v[164:167], v[12:15]
ds_read_b128 a[128:131], v216 offset:0
ds_read_b128 a[132:135], v217 offset:0
v_mfma_f32_16x16x32_bf16 v[20:23], a[156:159], v[180:183], v[140:143]
ds_read_b128 a[136:139], v218 offset:0
v_cvt_pk_bf16_f32 v93, v18, v19
v_mfma_f32_16x16x32_bf16 v[20:23], a[152:155], v[176:179], v[20:23]
v_exp_f32 v27, v27
v_mfma_f32_16x16x32_bf16 v[20:23], a[148:151], v[172:175], v[20:23]
ds_read_b128 a[140:143], v219 offset:0
v_cvt_pk_bf16_f32 v96, v24, v25
v_mfma_f32_16x16x32_bf16 v[20:23], a[144:147], v[168:171], v[20:23]
v_exp_f32 v32, v32
v_mfma_f32_16x16x32_bf16 v[112:115], a[200:203], a[220:223], v[112:115]
v_cvt_pk_bf16_f32 v97, v26, v27
v_mfma_f32_16x16x32_bf16 v[28:31], a[144:147], v[184:187], v[144:147]
v_exp_f32 v33, v33
v_mfma_f32_16x16x32_bf16 v[28:31], a[148:151], v[188:191], v[28:31]
buffer_load_dwordx4 v229, s[8:11], s38 offen offset:1024 lds
v_mfma_f32_16x16x32_bf16 v[28:31], a[152:155], v[192:195], v[28:31]
v_exp_f32 v34, v34
v_mfma_f32_16x16x32_bf16 v[28:31], a[156:159], v[196:199], v[28:31]
v_cvt_pk_bf16_f32 v100, v32, v33
v_mfma_f32_16x16x32_bf16 v[36:39], a[156:159], v[212:215], v[148:151]
v_exp_f32 v35, v35
v_mfma_f32_16x16x32_bf16 v[36:39], a[152:155], v[208:211], v[36:39]
ds_read_b128 a[156:159], v219 offset:4096
ds_read_b128 a[152:155], v218 offset:4096
v_mfma_f32_16x16x32_bf16 v[36:39], a[148:151], v[204:207], v[36:39]
ds_read_b128 a[148:151], v217 offset:4096
v_cvt_pk_bf16_f32 v101, v34, v35
v_mfma_f32_16x16x32_bf16 v[36:39], a[144:147], v[200:203], v[36:39]
v_exp_f32 v12, v12
v_mfma_f32_16x16x32_bf16 v[116:119], a[204:207], a[220:223], v[116:119]
ds_read_b128 a[144:147], v216 offset:4096
v_mfma_f32_16x16x32_bf16 a[24:27], a[176:179], v[40:43], a[24:27]
v_exp_f32 v13, v13
v_mfma_f32_16x16x32_bf16 a[24:27], a[180:183], v[56:59], a[24:27]
v_cvt_pk_bf16_f32 v90, v12, v13
v_mfma_f32_16x16x32_bf16 a[56:59], a[180:183], v[60:63], a[56:59]
v_exp_f32 v14, v14
v_mfma_f32_16x16x32_bf16 a[56:59], a[176:179], v[44:47], a[56:59]
v_mfma_f32_16x16x32_bf16 a[88:91], a[176:179], v[48:51], a[88:91]
v_exp_f32 v15, v15
v_mfma_f32_16x16x32_bf16 a[88:91], a[180:183], v[64:67], a[88:91]
v_cvt_pk_bf16_f32 v91, v14, v15
v_mfma_f32_16x16x32_bf16 a[120:123], a[180:183], v[68:71], a[120:123]
v_exp_f32 v20, v20
v_mfma_f32_16x16x32_bf16 a[120:123], a[176:179], v[52:55], a[120:123]
buffer_load_dwordx4 v230, s[8:11], s38 offen offset:2048 lds
v_mfma_f32_16x16x32_bf16 a[124:127], a[184:187], v[52:55], a[124:127]
v_exp_f32 v21, v21
v_mfma_f32_16x16x32_bf16 a[124:127], a[188:191], v[68:71], a[124:127]
ds_read_b64_tr_b16 a[180:181], v222 offset:57344
ds_read_b64_tr_b16 a[182:183], v222 offset:61440
v_mfma_f32_16x16x32_bf16 a[92:95], a[188:191], v[64:67], a[92:95]
ds_read_b64_tr_b16 a[176:177], v222 offset:49152
ds_read_b64_tr_b16 a[178:179], v222 offset:53248
v_mfma_f32_16x16x32_bf16 a[92:95], a[184:187], v[48:51], a[92:95]
v_exp_f32 v22, v22
v_mfma_f32_16x16x32_bf16 a[60:63], a[184:187], v[44:47], a[60:63]
v_cvt_pk_bf16_f32 v94, v20, v21
v_mfma_f32_16x16x32_bf16 a[60:63], a[188:191], v[60:63], a[60:63]
v_exp_f32 v23, v23
v_mfma_f32_16x16x32_bf16 a[28:31], a[188:191], v[56:59], a[28:31]
ds_read_b64_tr_b16 a[188:189], v223 offset:57344
ds_read_b64_tr_b16 a[190:191], v223 offset:61440
v_mfma_f32_16x16x32_bf16 a[28:31], a[184:187], v[40:43], a[28:31]
v_exp_f32 v28, v28
v_smfmac_f32_16x16x64_bf16 a[252:255], a[208:211], v[80:87], v235
ds_read_b64_tr_b16 a[184:185], v223 offset:49152
ds_read_b64_tr_b16 a[186:187], v223 offset:53248
v_mfma_f32_16x16x32_bf16 v[104:107], v[120:123], a[224:227], v[104:107]
s_waitcnt lgkmcnt(8)
v_exp_f32 v29, v29
v_mfma_f32_16x16x32_bf16 v[8:11], a[128:131], v[152:155], v[136:139]
v_cvt_pk_bf16_f32 v95, v22, v23
v_cvt_pk_bf16_f32 v98, v28, v29
v_mfma_f32_16x16x32_bf16 v[8:11], a[132:135], v[156:159], v[8:11]
v_exp_f32 v30, v30
v_mfma_f32_16x16x32_bf16 v[8:11], a[136:139], v[160:163], v[8:11]
buffer_load_dwordx4 v231, s[8:11], s38 offen offset:3072 lds
v_mfma_f32_16x16x32_bf16 v[8:11], a[140:143], v[164:167], v[8:11]
v_mfma_f32_16x16x32_bf16 v[16:19], a[140:143], v[180:183], v[140:143]
v_exp_f32 v31, v31
v_mfma_f32_16x16x32_bf16 v[16:19], a[136:139], v[176:179], v[16:19]
v_cvt_pk_bf16_f32 v99, v30, v31
v_mfma_f32_16x16x32_bf16 v[16:19], a[132:135], v[172:175], v[16:19]
v_exp_f32 v36, v36
v_mfma_f32_16x16x32_bf16 v[16:19], a[128:131], v[168:171], v[16:19]
v_mfma_f32_16x16x32_bf16 v[108:111], v[124:127], a[224:227], v[108:111]
v_exp_f32 v37, v37
v_mfma_f32_16x16x32_bf16 v[24:27], a[128:131], v[184:187], v[144:147]
v_cvt_pk_bf16_f32 v102, v36, v37
v_mfma_f32_16x16x32_bf16 v[24:27], a[132:135], v[188:191], v[24:27]
v_exp_f32 v38, v38
v_mfma_f32_16x16x32_bf16 v[24:27], a[136:139], v[192:195], v[24:27]
v_mfma_f32_16x16x32_bf16 v[24:27], a[140:143], v[196:199], v[24:27]
v_exp_f32 v39, v39
v_mfma_f32_16x16x32_bf16 v[32:35], a[140:143], v[212:215], v[148:151]
v_cvt_pk_bf16_f32 v103, v38, v39
v_mfma_f32_16x16x32_bf16 v[32:35], a[136:139], v[208:211], v[32:35]
v_mfma_f32_16x16x32_bf16 v[32:35], a[132:135], v[204:207], v[32:35]
v_mfma_f32_16x16x32_bf16 v[32:35], a[128:131], v[200:203], v[32:35]
s_add_u32 s38, s38, 16384
v_mfma_f32_16x16x32_bf16 v[112:115], v[128:131], a[224:227], v[112:115]
v_mfma_f32_16x16x32_bf16 v[116:119], v[132:135], a[224:227], v[116:119]
v_mfma_f32_16x16x32_bf16 a[0:3], a[160:163], v[72:75], a[0:3]
v_exp_f32 v8, v8
v_mfma_f32_16x16x32_bf16 a[0:3], a[164:167], v[88:91], a[0:3]
s_add_u32 m0, s49, 4096
v_exp_f32 v9, v9
v_mfma_f32_16x16x32_bf16 a[32:35], a[164:167], v[92:95], a[32:35]
s_add_u32 s48, s91, 0
buffer_load_dwordx4 v249, s[64:67], s48 offen  lds
v_mfma_f32_16x16x32_bf16 a[32:35], a[160:163], v[76:79], a[32:35]
v_exp_f32 v10, v10
v_mfma_f32_16x16x32_bf16 a[64:67], a[160:163], v[80:83], a[64:67]
v_cvt_pk_bf16_f32 v40, v8, v9
v_add_u32 v131, s90, v223
v_mfma_f32_16x16x32_bf16 a[64:67], a[164:167], v[96:99], a[64:67]
v_exp_f32 v11, v11
v_mfma_f32_16x16x32_bf16 a[96:99], a[164:167], v[100:103], a[96:99]
ds_read_b64_tr_b16 a[164:165], v224 offset:57344
ds_read_b64_tr_b16 a[166:167], v224 offset:61440
v_mfma_f32_16x16x32_bf16 a[96:99], a[160:163], v[84:87], a[96:99]
v_exp_f32 v16, v16
v_mfma_f32_16x16x32_bf16 a[100:103], a[168:171], v[84:87], a[100:103]
s_add_u32 m0, s49, 5120
ds_read_b64_tr_b16 a[160:161], v224 offset:49152
ds_read_b64_tr_b16 a[162:163], v224 offset:53248
v_mfma_f32_16x16x32_bf16 a[100:103], a[172:175], v[100:103], a[100:103]
s_add_u32 s48, s91, 4608
v_exp_f32 v17, v17
v_mfma_f32_16x16x32_bf16 a[68:71], a[172:175], v[96:99], a[68:71]
buffer_load_dwordx4 v250, s[64:67], s48 offen  lds
v_mfma_f32_16x16x32_bf16 a[68:71], a[168:171], v[80:83], a[68:71]
v_exp_f32 v18, v18
v_mfma_f32_16x16x32_bf16 a[36:39], a[168:171], v[76:79], a[36:39]
v_cvt_pk_bf16_f32 v41, v10, v11
v_cvt_pk_bf16_f32 v44, v16, v17
v_mfma_f32_16x16x32_bf16 a[36:39], a[172:175], v[92:95], a[36:39]
v_exp_f32 v19, v19
v_mfma_f32_16x16x32_bf16 a[4:7], a[172:175], v[88:91], a[4:7]
ds_read_b64_tr_b16 a[172:173], v225 offset:57344
ds_read_b64_tr_b16 a[174:175], v225 offset:61440
v_mfma_f32_16x16x32_bf16 a[4:7], a[168:171], v[72:75], a[4:7]
v_exp_f32 v24, v24
v_smfmac_f32_16x16x64_bf16 a[248:251], a[208:211], v[88:95], v235
s_add_u32 m0, s49, 6144
ds_read_b64_tr_b16 a[168:169], v225 offset:49152
ds_read_b64_tr_b16 a[170:171], v225 offset:53248
v_mfma_f32_16x16x32_bf16 v[12:15], a[144:147], v[152:155], v[136:139]
s_add_u32 s48, s91, 9216
v_exp_f32 v25, v25
v_mfma_f32_16x16x32_bf16 v[12:15], a[148:151], v[156:159], v[12:15]
buffer_load_dwordx4 v249, s[64:67], s48 offen  lds
v_mfma_f32_16x16x32_bf16 v[12:15], a[152:155], v[160:163], v[12:15]
v_exp_f32 v26, v26
v_mfma_f32_16x16x32_bf16 v[12:15], a[156:159], v[164:167], v[12:15]
ds_read_b128 a[128:131], v216 offset:8192
ds_read_b128 a[132:135], v217 offset:8192
v_mfma_f32_16x16x32_bf16 v[20:23], a[156:159], v[180:183], v[140:143]
v_exp_f32 v27, v27
v_mfma_f32_16x16x32_bf16 v[20:23], a[152:155], v[176:179], v[20:23]
ds_read_b128 a[136:139], v218 offset:8192
v_cvt_pk_bf16_f32 v45, v18, v19
v_mfma_f32_16x16x32_bf16 v[20:23], a[148:151], v[172:175], v[20:23]
v_exp_f32 v32, v32
v_mfma_f32_16x16x32_bf16 v[20:23], a[144:147], v[168:171], v[20:23]
s_add_u32 m0, s49, 7168
ds_read_b128 a[140:143], v219 offset:8192
v_cvt_pk_bf16_f32 v48, v24, v25
v_mfma_f32_16x16x32_bf16 v[28:31], a[144:147], v[184:187], v[144:147]
s_add_u32 s48, s91, 13824
v_exp_f32 v33, v33
v_mfma_f32_16x16x32_bf16 v[28:31], a[148:151], v[188:191], v[28:31]
buffer_load_dwordx4 v250, s[64:67], s48 offen  lds
v_mfma_f32_16x16x32_bf16 v[28:31], a[152:155], v[192:195], v[28:31]
v_exp_f32 v34, v34
v_mfma_f32_16x16x32_bf16 v[28:31], a[156:159], v[196:199], v[28:31]
v_cvt_pk_bf16_f32 v49, v26, v27
v_cvt_pk_bf16_f32 v52, v32, v33
v_mfma_f32_16x16x32_bf16 v[36:39], a[156:159], v[212:215], v[148:151]
v_exp_f32 v35, v35
v_mfma_f32_16x16x32_bf16 v[36:39], a[152:155], v[208:211], v[36:39]
ds_read_b128 a[156:159], v219 offset:12288
ds_read_b128 a[152:155], v218 offset:12288
v_mfma_f32_16x16x32_bf16 v[36:39], a[148:151], v[204:207], v[36:39]
v_exp_f32 v12, v12
v_mfma_f32_16x16x32_bf16 v[36:39], a[144:147], v[200:203], v[36:39]
s_waitcnt lgkmcnt(3)
v_exp_f32 v13, v13
v_mfma_f32_16x16x32_bf16 a[8:11], a[176:179], v[72:75], a[8:11]
buffer_load_dwordx2 v[252:253], v251, s[76:79], s42 offen sc1
v_mfma_f32_16x16x32_bf16 a[8:11], a[180:183], v[88:91], a[8:11]
v_exp_f32 v14, v14
v_mfma_f32_16x16x32_bf16 a[40:43], a[180:183], v[92:95], a[40:43]
ds_read_b128 a[148:151], v217 offset:12288
ds_read_b128 a[144:147], v216 offset:12288
v_mfma_f32_16x16x32_bf16 a[40:43], a[176:179], v[76:79], a[40:43]
v_exp_f32 v15, v15
v_mfma_f32_16x16x32_bf16 a[72:75], a[176:179], v[80:83], a[72:75]
v_cvt_pk_bf16_f32 v53, v34, v35
v_cvt_pk_bf16_f32 v42, v12, v13
v_mfma_f32_16x16x32_bf16 a[72:75], a[180:183], v[96:99], a[72:75]
v_exp_f32 v20, v20
v_mfma_f32_16x16x32_bf16 a[104:107], a[180:183], v[100:103], a[104:107]
s_add_u32 s42, s42, s43
buffer_load_dword v255, v243, s[28:31], s45 offen
v_mfma_f32_16x16x32_bf16 a[104:107], a[176:179], v[84:87], a[104:107]
v_exp_f32 v21, v21
v_mfma_f32_16x16x32_bf16 a[108:111], a[184:187], v[84:87], a[108:111]
ds_read_b64_tr_b16 a[180:181], v226 offset:57344
ds_read_b64_tr_b16 a[182:183], v226 offset:61440
v_mfma_f32_16x16x32_bf16 a[108:111], a[188:191], v[100:103], a[108:111]
v_exp_f32 v22, v22
v_mfma_f32_16x16x32_bf16 a[76:79], a[188:191], v[96:99], a[76:79]
ds_read_b64_tr_b16 a[176:177], v226 offset:49152
ds_read_b64_tr_b16 a[178:179], v226 offset:53248
v_mfma_f32_16x16x32_bf16 a[76:79], a[184:187], v[80:83], a[76:79]
v_exp_f32 v23, v23
v_mfma_f32_16x16x32_bf16 a[44:47], a[184:187], v[76:79], a[44:47]
v_cvt_pk_bf16_f32 v43, v14, v15
v_cvt_pk_bf16_f32 v46, v20, v21
v_mfma_f32_16x16x32_bf16 a[44:47], a[188:191], v[92:95], a[44:47]
v_exp_f32 v28, v28
v_mfma_f32_16x16x32_bf16 a[12:15], a[188:191], v[88:91], a[12:15]
s_add_u32 s45, s45, 589824
global_load_dword v255, v242, s[72:73]
v_mfma_f32_16x16x32_bf16 a[12:15], a[184:187], v[72:75], a[12:15]
v_exp_f32 v29, v29
v_smfmac_f32_16x16x64_bf16 a[252:255], a[208:211], v[96:103], v235
ds_read_b64_tr_b16 a[188:189], v227 offset:57344
ds_read_b64_tr_b16 a[190:191], v227 offset:61440
v_mfma_f32_16x16x32_bf16 v[8:11], a[128:131], v[152:155], v[136:139]
v_exp_f32 v30, v30
v_mfma_f32_16x16x32_bf16 v[8:11], a[132:135], v[156:159], v[8:11]
ds_read_b64_tr_b16 a[184:185], v227 offset:49152
ds_read_b64_tr_b16 a[186:187], v227 offset:53248
v_mfma_f32_16x16x32_bf16 v[8:11], a[136:139], v[160:163], v[8:11]
s_waitcnt lgkmcnt(6)
v_exp_f32 v31, v31
v_mfma_f32_16x16x32_bf16 v[8:11], a[140:143], v[164:167], v[8:11]
v_cvt_pk_bf16_f32 v47, v22, v23
v_cvt_pk_bf16_f32 v50, v28, v29
v_mfma_f32_16x16x32_bf16 v[16:19], a[140:143], v[180:183], v[140:143]
v_exp_f32 v36, v36
v_mfma_f32_16x16x32_bf16 v[16:19], a[136:139], v[176:179], v[16:19]
buffer_load_dword v255, v0, s[24:27], s44 offen
v_mfma_f32_16x16x32_bf16 v[16:19], a[132:135], v[172:175], v[16:19]
v_exp_f32 v37, v37
v_mfma_f32_16x16x32_bf16 v[16:19], a[128:131], v[168:171], v[16:19]
v_cvt_pk_bf16_f32 v51, v30, v31
v_cvt_pk_bf16_f32 v54, v36, v37
v_mfma_f32_16x16x32_bf16 v[24:27], a[128:131], v[184:187], v[144:147]
v_exp_f32 v38, v38
v_mfma_f32_16x16x32_bf16 v[24:27], a[132:135], v[188:191], v[24:27]
ds_write_b128 v5, v[104:107] offset:0
v_mfma_f32_16x16x32_bf16 v[24:27], a[136:139], v[192:195], v[24:27]
v_exp_f32 v39, v39
v_mfma_f32_16x16x32_bf16 v[24:27], a[140:143], v[196:199], v[24:27]
v_cvt_pk_bf16_f32 v55, v38, v39
v_add_u32 v132, s90, v224
v_mfma_f32_16x16x32_bf16 v[32:35], a[140:143], v[212:215], v[148:151]
ds_write_b128 v5, v[108:111] offset:1024
v_mfma_f32_16x16x32_bf16 v[32:35], a[136:139], v[208:211], v[32:35]
s_add_u32 s44, s44, 4096
ds_write_b128 v5, v[112:115] offset:2048
v_mfma_f32_16x16x32_bf16 v[32:35], a[132:135], v[204:207], v[32:35]
ds_write_b128 v5, v[116:119] offset:3072
v_mfma_f32_16x16x32_bf16 v[32:35], a[128:131], v[200:203], v[32:35]
s_sub_u32 s46, s49, 0xf000
v_add_u32 v133, s90, v225
v_add_u32 v134, s90, v226
v_add_u32 v135, s90, v227
v_mfma_f32_16x16x32_bf16 a[16:19], a[160:163], v[72:75], a[16:19]
v_exp_f32 v8, v8
v_mfma_f32_16x16x32_bf16 a[16:19], a[164:167], v[88:91], a[16:19]
v_exp_f32 v9, v9
v_mfma_f32_16x16x32_bf16 a[48:51], a[164:167], v[92:95], a[48:51]
v_cvt_pk_bf16_f32 v56, v8, v9
v_add_u32 v128, s46, v220
v_mfma_f32_16x16x32_bf16 a[48:51], a[160:163], v[76:79], a[48:51]
v_exp_f32 v10, v10
v_mfma_f32_16x16x32_bf16 a[80:83], a[160:163], v[80:83], a[80:83]
v_add_u32 v129, s46, v221
v_add_u32 v130, s46, v222
v_mfma_f32_16x16x32_bf16 a[80:83], a[164:167], v[96:99], a[80:83]
v_exp_f32 v11, v11
s_waitcnt vmcnt(8) lgkmcnt(0)
s_barrier
v_mfma_f32_16x16x32_bf16 a[112:115], a[164:167], v[100:103], a[112:115]
ds_read_b64_tr_b16 a[164:165], v220 offset:8192
ds_read_b64_tr_b16 a[166:167], v220 offset:12288
v_mfma_f32_16x16x32_bf16 a[112:115], a[160:163], v[84:87], a[112:115]
s_add_u32 m0, s37, 98304
v_exp_f32 v16, v16
v_mfma_f32_16x16x32_bf16 a[116:119], a[168:171], v[84:87], a[116:119]
buffer_load_dwordx4 v232, s[12:15], s39 offen offset:0 lds
v_mfma_f32_16x16x32_bf16 a[116:119], a[172:175], v[100:103], a[116:119]
v_exp_f32 v17, v17
v_mfma_f32_16x16x32_bf16 a[84:87], a[172:175], v[96:99], a[84:87]
ds_read_b64_tr_b16 a[160:161], v220 offset:0
ds_read_b64_tr_b16 a[162:163], v220 offset:4096
v_mfma_f32_16x16x32_bf16 a[84:87], a[168:171], v[80:83], a[84:87]
v_exp_f32 v18, v18
v_mfma_f32_16x16x32_bf16 a[52:55], a[168:171], v[76:79], a[52:55]
v_cvt_pk_bf16_f32 v57, v10, v11
v_cvt_pk_bf16_f32 v60, v16, v17
v_mfma_f32_16x16x32_bf16 a[52:55], a[172:175], v[92:95], a[52:55]
v_exp_f32 v19, v19
v_mfma_f32_16x16x32_bf16 a[20:23], a[172:175], v[88:91], a[20:23]
ds_read_b64_tr_b16 a[172:173], v221 offset:8192
ds_read_b64_tr_b16 a[174:175], v221 offset:12288
v_mfma_f32_16x16x32_bf16 a[20:23], a[168:171], v[72:75], a[20:23]
v_exp_f32 v24, v24
v_smfmac_f32_16x16x64_bf16 a[248:251], a[208:211], v[40:47], v235
buffer_load_dwordx4 v233, s[12:15], s39 offen offset:1024 lds
v_mfma_f32_16x16x32_bf16 v[12:15], a[144:147], v[152:155], v[136:139]
v_exp_f32 v25, v25
v_mfma_f32_16x16x32_bf16 v[12:15], a[148:151], v[156:159], v[12:15]
ds_read_b64_tr_b16 a[168:169], v221 offset:0
ds_read_b64_tr_b16 a[170:171], v221 offset:4096
v_mfma_f32_16x16x32_bf16 v[12:15], a[152:155], v[160:163], v[12:15]
v_exp_f32 v26, v26
v_mfma_f32_16x16x32_bf16 v[12:15], a[156:159], v[164:167], v[12:15]
ds_read_b128 a[128:131], v216 offset:49152
ds_read_b128 a[132:135], v217 offset:49152
v_mfma_f32_16x16x32_bf16 v[20:23], a[156:159], v[180:183], v[140:143]
v_exp_f32 v27, v27
v_mfma_f32_16x16x32_bf16 v[20:23], a[152:155], v[176:179], v[20:23]
ds_read_b128 a[136:139], v218 offset:49152
v_cvt_pk_bf16_f32 v61, v18, v19
v_mfma_f32_16x16x32_bf16 v[20:23], a[148:151], v[172:175], v[20:23]
v_exp_f32 v32, v32
v_mfma_f32_16x16x32_bf16 v[20:23], a[144:147], v[168:171], v[20:23]
ds_read_b128 a[140:143], v219 offset:49152
v_cvt_pk_bf16_f32 v64, v24, v25
v_mfma_f32_16x16x32_bf16 v[28:31], a[144:147], v[184:187], v[144:147]
v_exp_f32 v33, v33
v_mfma_f32_16x16x32_bf16 v[28:31], a[148:151], v[188:191], v[28:31]
buffer_load_dwordx4 v232, s[12:15], s39 offen offset:2048 lds
v_mfma_f32_16x16x32_bf16 v[28:31], a[152:155], v[192:195], v[28:31]
v_exp_f32 v34, v34
v_mfma_f32_16x16x32_bf16 v[28:31], a[156:159], v[196:199], v[28:31]
v_cvt_pk_bf16_f32 v65, v26, v27
v_cvt_pk_bf16_f32 v68, v32, v33
v_mfma_f32_16x16x32_bf16 v[36:39], a[156:159], v[212:215], v[148:151]
v_exp_f32 v35, v35
v_mfma_f32_16x16x32_bf16 v[36:39], a[152:155], v[208:211], v[36:39]
ds_read_b128 a[156:159], v219 offset:53248
ds_read_b128 a[152:155], v218 offset:53248
v_mfma_f32_16x16x32_bf16 v[36:39], a[148:151], v[204:207], v[36:39]
v_exp_f32 v12, v12
v_mfma_f32_16x16x32_bf16 v[36:39], a[144:147], v[200:203], v[36:39]
v_exp_f32 v13, v13
v_mfma_f32_16x16x32_bf16 a[24:27], a[176:179], v[72:75], a[24:27]
ds_read_b128 a[148:151], v217 offset:53248
ds_read_b128 a[144:147], v216 offset:53248
v_mfma_f32_16x16x32_bf16 a[24:27], a[180:183], v[88:91], a[24:27]
v_exp_f32 v14, v14
v_mfma_f32_16x16x32_bf16 a[56:59], a[180:183], v[92:95], a[56:59]
buffer_load_dwordx4 v233, s[12:15], s39 offen offset:3072 lds
v_mfma_f32_16x16x32_bf16 a[56:59], a[176:179], v[76:79], a[56:59]
v_exp_f32 v15, v15
v_mfma_f32_16x16x32_bf16 a[88:91], a[176:179], v[80:83], a[88:91]
v_cvt_pk_bf16_f32 v69, v34, v35
v_cvt_pk_bf16_f32 v58, v12, v13
v_mfma_f32_16x16x32_bf16 a[88:91], a[180:183], v[96:99], a[88:91]
v_exp_f32 v20, v20
v_mfma_f32_16x16x32_bf16 a[120:123], a[180:183], v[100:103], a[120:123]
ds_read_b64_tr_b16 a[180:181], v222 offset:8192
ds_read_b64_tr_b16 a[182:183], v222 offset:12288
v_mfma_f32_16x16x32_bf16 a[120:123], a[176:179], v[84:87], a[120:123]
v_exp_f32 v21, v21
v_mfma_f32_16x16x32_bf16 a[124:127], a[184:187], v[84:87], a[124:127]
ds_read_b64_tr_b16 a[176:177], v222 offset:0
ds_read_b64_tr_b16 a[178:179], v222 offset:4096
v_mfma_f32_16x16x32_bf16 a[124:127], a[188:191], v[100:103], a[124:127]
v_exp_f32 v22, v22
v_mfma_f32_16x16x32_bf16 a[92:95], a[188:191], v[96:99], a[92:95]
v_cvt_pk_bf16_f32 v59, v14, v15
v_cvt_pk_bf16_f32 v62, v20, v21
v_mfma_f32_16x16x32_bf16 a[92:95], a[184:187], v[80:83], a[92:95]
s_add_u32 s39, s39, 16384
v_exp_f32 v23, v23
v_mfma_f32_16x16x32_bf16 a[60:63], a[184:187], v[76:79], a[60:63]
s_add_u32 m0, s37, 16384
ds_read_b128 v[104:107], v6 offset:0
v_cvt_pk_bf16_f32 v63, v22, v23
v_mfma_f32_16x16x32_bf16 a[60:63], a[188:191], v[92:95], a[60:63]
v_exp_f32 v28, v28
v_mfma_f32_16x16x32_bf16 a[28:31], a[188:191], v[88:91], a[28:31]
buffer_load_dwordx4 v228, s[8:11], s38 offen offset:0 lds
v_mfma_f32_16x16x32_bf16 a[28:31], a[184:187], v[72:75], a[28:31]
v_exp_f32 v29, v29
v_smfmac_f32_16x16x64_bf16 a[252:255], a[208:211], v[48:55], v235
s_waitcnt lgkmcnt(3)
ds_read_b64_tr_b16 a[188:189], v223 offset:8192
ds_read_b64_tr_b16 a[190:191], v223 offset:12288
v_mfma_f32_16x16x32_bf16 v[8:11], a[128:131], v[152:155], v[136:139]
v_exp_f32 v30, v30
v_mfma_f32_16x16x32_bf16 v[8:11], a[132:135], v[156:159], v[8:11]
ds_read_b64_tr_b16 a[184:185], v223 offset:0
ds_read_b64_tr_b16 a[186:187], v223 offset:4096
v_mfma_f32_16x16x32_bf16 v[8:11], a[136:139], v[160:163], v[8:11]
v_exp_f32 v31, v31
v_mfma_f32_16x16x32_bf16 v[8:11], a[140:143], v[164:167], v[8:11]
buffer_load_dwordx4 v229, s[8:11], s38 offen offset:1024 lds
v_mfma_f32_16x16x32_bf16 v[16:19], a[140:143], v[180:183], v[140:143]
v_exp_f32 v36, v36
v_mfma_f32_16x16x32_bf16 v[16:19], a[136:139], v[176:179], v[16:19]
v_cvt_pk_bf16_f32 v66, v28, v29
v_cvt_pk_bf16_f32 v67, v30, v31
v_mfma_f32_16x16x32_bf16 v[16:19], a[132:135], v[172:175], v[16:19]
v_exp_f32 v37, v37
v_mfma_f32_16x16x32_bf16 v[16:19], a[128:131], v[168:171], v[16:19]
ds_read_b128 v[108:111], v6 offset:8192
v_cvt_pk_bf16_f32 v70, v36, v37
v_mfma_f32_16x16x32_bf16 v[24:27], a[128:131], v[184:187], v[144:147]
v_exp_f32 v38, v38
v_mfma_f32_16x16x32_bf16 v[24:27], a[132:135], v[188:191], v[24:27]
ds_read_b128 v[112:115], v6 offset:16384
ds_read_b128 v[116:119], v6 offset:24576
v_mfma_f32_16x16x32_bf16 v[24:27], a[136:139], v[192:195], v[24:27]
v_exp_f32 v39, v39
v_mfma_f32_16x16x32_bf16 v[24:27], a[140:143], v[196:199], v[24:27]
v_cvt_pk_bf16_f32 v71, v38, v39
s_waitcnt lgkmcnt(0)
v_add_f32 v104, v104, v108
v_mfma_f32_16x16x32_bf16 v[32:35], a[140:143], v[212:215], v[148:151]
v_add_f32 v112, v112, v116
v_add_f32 v105, v105, v109
v_mfma_f32_16x16x32_bf16 v[32:35], a[136:139], v[208:211], v[32:35]
v_add_f32 v113, v113, v117
v_add_f32 v106, v106, v110
v_mfma_f32_16x16x32_bf16 v[32:35], a[132:135], v[204:207], v[32:35]
v_add_f32 v114, v114, v118
v_add_f32 v107, v107, v111
v_mfma_f32_16x16x32_bf16 v[32:35], a[128:131], v[200:203], v[32:35]
v_add_f32 v115, v115, v119
v_mfma_f32_16x16x32_bf16 a[0:3], a[160:163], v[40:43], a[0:3]
v_exp_f32 v8, v8
v_mfma_f32_16x16x32_bf16 a[0:3], a[164:167], v[56:59], a[0:3]
v_exp_f32 v9, v9
v_mfma_f32_16x16x32_bf16 a[32:35], a[164:167], v[60:63], a[32:35]
buffer_load_dwordx4 v230, s[8:11], s38 offen offset:2048 lds
v_mfma_f32_16x16x32_bf16 a[32:35], a[160:163], v[44:47], a[32:35]
v_exp_f32 v10, v10
v_mfma_f32_16x16x32_bf16 a[64:67], a[160:163], v[48:51], a[64:67]
v_cvt_pk_bf16_f32 v72, v8, v9
v_add_f32 v104, v104, v112
v_mfma_f32_16x16x32_bf16 a[64:67], a[164:167], v[64:67], a[64:67]
v_exp_f32 v11, v11
v_mfma_f32_16x16x32_bf16 a[96:99], a[164:167], v[68:71], a[96:99]
ds_read_b64_tr_b16 a[164:165], v224 offset:8192
ds_read_b64_tr_b16 a[166:167], v224 offset:12288
v_mfma_f32_16x16x32_bf16 a[96:99], a[160:163], v[52:55], a[96:99]
v_exp_f32 v16, v16
v_mfma_f32_16x16x32_bf16 a[100:103], a[168:171], v[52:55], a[100:103]
ds_read_b64_tr_b16 a[160:161], v224 offset:0
ds_read_b64_tr_b16 a[162:163], v224 offset:4096
v_mfma_f32_16x16x32_bf16 a[100:103], a[172:175], v[68:71], a[100:103]
v_exp_f32 v17, v17
v_mfma_f32_16x16x32_bf16 a[68:71], a[172:175], v[64:67], a[68:71]
v_cvt_pk_bf16_f32 v73, v10, v11
v_cvt_pk_bf16_f32 v76, v16, v17
v_mfma_f32_16x16x32_bf16 a[68:71], a[168:171], v[48:51], a[68:71]
v_exp_f32 v18, v18
v_mfma_f32_16x16x32_bf16 a[36:39], a[168:171], v[44:47], a[36:39]
v_add_f32 v105, v105, v113
v_add_f32 v106, v106, v114
v_mfma_f32_16x16x32_bf16 a[36:39], a[172:175], v[60:63], a[36:39]
v_exp_f32 v19, v19
v_mfma_f32_16x16x32_bf16 a[4:7], a[172:175], v[56:59], a[4:7]
buffer_load_dwordx4 v231, s[8:11], s38 offen offset:3072 lds
v_mfma_f32_16x16x32_bf16 a[4:7], a[168:171], v[40:43], a[4:7]
v_exp_f32 v24, v24
v_smfmac_f32_16x16x64_bf16 a[248:251], a[208:211], v[56:63], v235
ds_read_b64_tr_b16 a[172:173], v225 offset:8192
ds_read_b64_tr_b16 a[174:175], v225 offset:12288
v_mfma_f32_16x16x32_bf16 v[12:15], a[144:147], v[152:155], v[136:139]
v_exp_f32 v25, v25
v_mfma_f32_16x16x32_bf16 v[12:15], a[148:151], v[156:159], v[12:15]
ds_read_b64_tr_b16 a[168:169], v225 offset:0
ds_read_b64_tr_b16 a[170:171], v225 offset:4096
v_mfma_f32_16x16x32_bf16 v[12:15], a[152:155], v[160:163], v[12:15]
v_exp_f32 v26, v26
v_mfma_f32_16x16x32_bf16 v[12:15], a[156:159], v[164:167], v[12:15]
ds_read_b128 a[128:131], v216 offset:57344
ds_read_b128 a[132:135], v217 offset:57344
v_mfma_f32_16x16x32_bf16 v[20:23], a[156:159], v[180:183], v[140:143]
v_exp_f32 v27, v27
v_mfma_f32_16x16x32_bf16 v[20:23], a[152:155], v[176:179], v[20:23]
ds_read_b128 a[136:139], v218 offset:57344
v_cvt_pk_bf16_f32 v77, v18, v19
v_mfma_f32_16x16x32_bf16 v[20:23], a[148:151], v[172:175], v[20:23]
v_exp_f32 v32, v32
v_mfma_f32_16x16x32_bf16 v[20:23], a[144:147], v[168:171], v[20:23]
ds_read_b128 a[140:143], v219 offset:57344
v_cvt_pk_bf16_f32 v80, v24, v25
v_mfma_f32_16x16x32_bf16 v[28:31], a[144:147], v[184:187], v[144:147]
s_add_u32 s38, s38, 16384
v_exp_f32 v33, v33
v_mfma_f32_16x16x32_bf16 v[28:31], a[148:151], v[188:191], v[28:31]
s_add_u32 m0, s37, 114688
v_cvt_pk_bf16_f32 v81, v26, v27
v_cvt_pk_bf16_f32 v84, v32, v33
v_mfma_f32_16x16x32_bf16 v[28:31], a[152:155], v[192:195], v[28:31]
v_exp_f32 v34, v34
v_mfma_f32_16x16x32_bf16 v[28:31], a[156:159], v[196:199], v[28:31]
buffer_load_dwordx4 v232, s[12:15], s39 offen offset:0 lds
v_mfma_f32_16x16x32_bf16 v[36:39], a[156:159], v[212:215], v[148:151]
v_exp_f32 v35, v35
v_mfma_f32_16x16x32_bf16 v[36:39], a[152:155], v[208:211], v[36:39]
ds_read_b128 a[156:159], v219 offset:61440
ds_read_b128 a[152:155], v218 offset:61440
v_mfma_f32_16x16x32_bf16 v[36:39], a[148:151], v[204:207], v[36:39]
v_exp_f32 v12, v12
v_mfma_f32_16x16x32_bf16 v[36:39], a[144:147], v[200:203], v[36:39]
v_exp_f32 v13, v13
v_mfma_f32_16x16x32_bf16 a[8:11], a[176:179], v[40:43], a[8:11]
ds_read_b128 a[148:151], v217 offset:61440
ds_read_b128 a[144:147], v216 offset:61440
v_mfma_f32_16x16x32_bf16 a[8:11], a[180:183], v[56:59], a[8:11]
v_exp_f32 v14, v14
v_mfma_f32_16x16x32_bf16 a[40:43], a[180:183], v[60:63], a[40:43]
v_cvt_pk_bf16_f32 v85, v34, v35
v_cvt_pk_bf16_f32 v74, v12, v13
v_mfma_f32_16x16x32_bf16 a[40:43], a[176:179], v[44:47], a[40:43]
v_exp_f32 v15, v15
v_mfma_f32_16x16x32_bf16 a[72:75], a[176:179], v[48:51], a[72:75]
v_cvt_pk_bf16_f32 v75, v14, v15
v_add_f32 v107, v107, v115
v_mfma_f32_16x16x32_bf16 a[72:75], a[180:183], v[64:67], a[72:75]
v_exp_f32 v20, v20
v_mfma_f32_16x16x32_bf16 a[104:107], a[180:183], v[68:71], a[104:107]
buffer_load_dwordx4 v233, s[12:15], s39 offen offset:1024 lds
v_mfma_f32_16x16x32_bf16 a[104:107], a[176:179], v[52:55], a[104:107]
v_exp_f32 v21, v21
v_mfma_f32_16x16x32_bf16 a[108:111], a[184:187], v[52:55], a[108:111]
ds_read_b64_tr_b16 a[180:181], v226 offset:8192
ds_read_b64_tr_b16 a[182:183], v226 offset:12288
v_mfma_f32_16x16x32_bf16 a[108:111], a[188:191], v[68:71], a[108:111]
v_exp_f32 v22, v22
v_mfma_f32_16x16x32_bf16 a[76:79], a[188:191], v[64:67], a[76:79]
ds_read_b64_tr_b16 a[176:177], v226 offset:0
ds_read_b64_tr_b16 a[178:179], v226 offset:4096
v_mfma_f32_16x16x32_bf16 a[76:79], a[184:187], v[48:51], a[76:79]
v_exp_f32 v23, v23
v_mfma_f32_16x16x32_bf16 a[44:47], a[184:187], v[44:47], a[44:47]
v_cvt_pk_bf16_f32 v78, v20, v21
v_cvt_pk_bf16_f32 v79, v22, v23
v_mfma_f32_16x16x32_bf16 a[44:47], a[188:191], v[60:63], a[44:47]
v_exp_f32 v28, v28
v_mfma_f32_16x16x32_bf16 a[12:15], a[188:191], v[56:59], a[12:15]
ds_read_b64_tr_b16 a[188:189], v227 offset:8192
ds_read_b64_tr_b16 a[190:191], v227 offset:12288
v_mfma_f32_16x16x32_bf16 a[12:15], a[184:187], v[40:43], a[12:15]
v_exp_f32 v29, v29
v_smfmac_f32_16x16x64_bf16 a[252:255], a[208:211], v[64:71], v235
s_waitcnt lgkmcnt(6)
ds_read_b64_tr_b16 a[184:185], v227 offset:0
ds_read_b64_tr_b16 a[186:187], v227 offset:4096
v_mfma_f32_16x16x32_bf16 v[8:11], a[128:131], v[152:155], v[136:139]
v_exp_f32 v30, v30
v_mfma_f32_16x16x32_bf16 v[8:11], a[132:135], v[156:159], v[8:11]
buffer_load_dwordx4 v232, s[12:15], s39 offen offset:2048 lds
v_mfma_f32_16x16x32_bf16 v[8:11], a[136:139], v[160:163], v[8:11]
v_exp_f32 v31, v31
v_mfma_f32_16x16x32_bf16 v[8:11], a[140:143], v[164:167], v[8:11]
v_cvt_pk_bf16_f32 v82, v28, v29
v_cvt_pk_bf16_f32 v83, v30, v31
v_mfma_f32_16x16x32_bf16 v[16:19], a[140:143], v[180:183], v[140:143]
v_exp_f32 v36, v36
v_mfma_f32_16x16x32_bf16 v[16:19], a[136:139], v[176:179], v[16:19]
v_cvt_pk_bf16_f32 v244, v104, v105
v_cvt_pk_bf16_f32 v245, v106, v107
v_mfma_f32_16x16x32_bf16 v[16:19], a[132:135], v[172:175], v[16:19]
v_exp_f32 v37, v37
v_mfma_f32_16x16x32_bf16 v[16:19], a[128:131], v[168:171], v[16:19]
v_cvt_pk_bf16_f32 v86, v36, v37
v_lshlrev_b32 v104, 16, v244
v_mfma_f32_16x16x32_bf16 v[24:27], a[128:131], v[184:187], v[144:147]
v_exp_f32 v38, v38
v_mfma_f32_16x16x32_bf16 v[24:27], a[132:135], v[188:191], v[24:27]
v_and_b32 v105, 0xffff0000, v244
v_lshlrev_b32 v106, 16, v245
v_mfma_f32_16x16x32_bf16 v[24:27], a[136:139], v[192:195], v[24:27]
v_exp_f32 v39, v39
v_mfma_f32_16x16x32_bf16 v[24:27], a[140:143], v[196:199], v[24:27]
v_cvt_pk_bf16_f32 v87, v38, v39
v_and_b32 v107, 0xffff0000, v245
v_mfma_f32_16x16x32_bf16 v[32:35], a[140:143], v[212:215], v[148:151]
v_mul_f32 v120, 0xbfb8aa3b, v104
v_mul_f32 v121, 0xbfb8aa3b, v105
v_mfma_f32_16x16x32_bf16 v[32:35], a[136:139], v[208:211], v[32:35]
v_mul_f32 v122, 0xbfb8aa3b, v106
v_mul_f32 v123, 0xbfb8aa3b, v107
v_mfma_f32_16x16x32_bf16 v[32:35], a[132:135], v[204:207], v[32:35]
v_exp_f32 v120, v120
v_mfma_f32_16x16x32_bf16 v[32:35], a[128:131], v[200:203], v[32:35]
v_exp_f32 v121, v121
v_mfma_f32_16x16x32_bf16 a[16:19], a[160:163], v[40:43], a[16:19]
v_exp_f32 v8, v8
v_mfma_f32_16x16x32_bf16 a[16:19], a[164:167], v[56:59], a[16:19]
v_exp_f32 v9, v9
v_mfma_f32_16x16x32_bf16 a[48:51], a[164:167], v[60:63], a[48:51]
buffer_load_dwordx4 v233, s[12:15], s39 offen offset:3072 lds
v_mfma_f32_16x16x32_bf16 a[48:51], a[160:163], v[44:47], a[48:51]
v_exp_f32 v10, v10
v_mfma_f32_16x16x32_bf16 a[80:83], a[160:163], v[48:51], a[80:83]
s_waitcnt vmcnt(16)
ds_read_b64_tr_b16 a[192:193], v128
v_cvt_pk_bf16_f32 v88, v8, v9
v_mfma_f32_16x16x32_bf16 a[80:83], a[164:167], v[64:67], a[80:83]
v_exp_f32 v11, v11
v_mfma_f32_16x16x32_bf16 a[112:115], a[164:167], v[68:71], a[112:115]
ds_read_b64_tr_b16 a[164:165], v220 offset:24576
ds_read_b64_tr_b16 a[166:167], v220 offset:28672
v_mfma_f32_16x16x32_bf16 a[112:115], a[160:163], v[52:55], a[112:115]
v_exp_f32 v16, v16
v_mfma_f32_16x16x32_bf16 a[116:119], a[168:171], v[52:55], a[116:119]
ds_read_b64_tr_b16 a[160:161], v220 offset:16384
ds_read_b64_tr_b16 a[162:163], v220 offset:20480
v_mfma_f32_16x16x32_bf16 a[116:119], a[172:175], v[68:71], a[116:119]
v_exp_f32 v17, v17
v_mfma_f32_16x16x32_bf16 a[84:87], a[172:175], v[64:67], a[84:87]
v_cvt_pk_bf16_f32 v89, v10, v11
v_cvt_pk_bf16_f32 v92, v16, v17
v_mfma_f32_16x16x32_bf16 a[84:87], a[168:171], v[48:51], a[84:87]
v_exp_f32 v18, v18
v_mfma_f32_16x16x32_bf16 a[52:55], a[168:171], v[44:47], a[52:55]
v_exp_f32 v122, v122
v_mfma_f32_16x16x32_bf16 a[52:55], a[172:175], v[60:63], a[52:55]
s_add_u32 s39, s39, 16384
v_exp_f32 v19, v19
v_mfma_f32_16x16x32_bf16 a[20:23], a[172:175], v[56:59], a[20:23]
s_add_u32 m0, s37, 0
ds_read_b64_tr_b16 a[172:173], v221 offset:24576
ds_read_b64_tr_b16 a[174:175], v221 offset:28672
v_mfma_f32_16x16x32_bf16 a[20:23], a[168:171], v[40:43], a[20:23]
v_exp_f32 v24, v24
v_smfmac_f32_16x16x64_bf16 a[248:251], a[208:211], v[72:79], v235
buffer_load_dwordx4 v228, s[8:11], s38 offen offset:0 lds
v_mfma_f32_16x16x32_bf16 v[12:15], a[144:147], v[152:155], v[136:139]
v_exp_f32 v25, v25
v_mfma_f32_16x16x32_bf16 v[12:15], a[148:151], v[156:159], v[12:15]
ds_read_b64_tr_b16 a[168:169], v221 offset:16384
ds_read_b64_tr_b16 a[170:171], v221 offset:20480
v_mfma_f32_16x16x32_bf16 v[12:15], a[152:155], v[160:163], v[12:15]
v_exp_f32 v26, v26
v_mfma_f32_16x16x32_bf16 v[12:15], a[156:159], v[164:167], v[12:15]
ds_read_b128 a[128:131], v216 offset:32768
ds_read_b128 a[132:135], v217 offset:32768
v_mfma_f32_16x16x32_bf16 v[20:23], a[156:159], v[180:183], v[140:143]
v_exp_f32 v27, v27
v_mfma_f32_16x16x32_bf16 v[20:23], a[152:155], v[176:179], v[20:23]
ds_read_b128 a[136:139], v218 offset:32768
v_cvt_pk_bf16_f32 v93, v18, v19
v_mfma_f32_16x16x32_bf16 v[20:23], a[148:151], v[172:175], v[20:23]
v_exp_f32 v32, v32
v_mfma_f32_16x16x32_bf16 v[20:23], a[144:147], v[168:171], v[20:23]
ds_read_b128 a[140:143], v219 offset:32768
v_cvt_pk_bf16_f32 v96, v24, v25
v_mfma_f32_16x16x32_bf16 v[28:31], a[144:147], v[184:187], v[144:147]
v_exp_f32 v33, v33
v_mfma_f32_16x16x32_bf16 v[28:31], a[148:151], v[188:191], v[28:31]
buffer_load_dwordx4 v229, s[8:11], s38 offen offset:1024 lds
v_mfma_f32_16x16x32_bf16 v[28:31], a[152:155], v[192:195], v[28:31]
v_exp_f32 v34, v34
v_mfma_f32_16x16x32_bf16 v[28:31], a[156:159], v[196:199], v[28:31]
v_cvt_pk_bf16_f32 v97, v26, v27
v_cvt_pk_bf16_f32 v100, v32, v33
v_mfma_f32_16x16x32_bf16 v[36:39], a[156:159], v[212:215], v[148:151]
v_exp_f32 v35, v35
v_mfma_f32_16x16x32_bf16 v[36:39], a[152:155], v[208:211], v[36:39]
ds_read_b128 a[156:159], v219 offset:36864
ds_read_b128 a[152:155], v218 offset:36864
v_mfma_f32_16x16x32_bf16 v[36:39], a[148:151], v[204:207], v[36:39]
v_exp_f32 v12, v12
v_mfma_f32_16x16x32_bf16 v[36:39], a[144:147], v[200:203], v[36:39]
s_waitcnt lgkmcnt(3)
v_exp_f32 v13, v13
v_mfma_f32_16x16x32_bf16 a[24:27], a[176:179], v[40:43], a[24:27]
ds_read_b128 a[148:151], v217 offset:36864
ds_read_b128 a[144:147], v216 offset:36864
v_mfma_f32_16x16x32_bf16 a[24:27], a[180:183], v[56:59], a[24:27]
v_exp_f32 v14, v14
v_mfma_f32_16x16x32_bf16 a[56:59], a[180:183], v[60:63], a[56:59]
v_cvt_pk_bf16_f32 v101, v34, v35
v_cvt_pk_bf16_f32 v90, v12, v13
v_mfma_f32_16x16x32_bf16 a[56:59], a[176:179], v[44:47], a[56:59]
v_exp_f32 v15, v15
v_mfma_f32_16x16x32_bf16 a[88:91], a[176:179], v[48:51], a[88:91]
ds_read_b64_tr_b16 a[196:197], v129
v_cvt_pk_bf16_f32 v91, v14, v15
v_mfma_f32_16x16x32_bf16 a[88:91], a[180:183], v[64:67], a[88:91]
v_exp_f32 v20, v20
v_mfma_f32_16x16x32_bf16 a[120:123], a[180:183], v[68:71], a[120:123]
buffer_load_dwordx4 v230, s[8:11], s38 offen offset:2048 lds
v_mfma_f32_16x16x32_bf16 a[120:123], a[176:179], v[52:55], a[120:123]
v_exp_f32 v21, v21
v_mfma_f32_16x16x32_bf16 a[124:127], a[184:187], v[52:55], a[124:127]
ds_read_b64_tr_b16 a[180:181], v222 offset:24576
ds_read_b64_tr_b16 a[182:183], v222 offset:28672
v_mfma_f32_16x16x32_bf16 a[124:127], a[188:191], v[68:71], a[124:127]
v_exp_f32 v22, v22
v_mfma_f32_16x16x32_bf16 a[92:95], a[188:191], v[64:67], a[92:95]
ds_read_b64_tr_b16 a[176:177], v222 offset:16384
ds_read_b64_tr_b16 a[178:179], v222 offset:20480
v_mfma_f32_16x16x32_bf16 a[92:95], a[184:187], v[48:51], a[92:95]
v_exp_f32 v23, v23
v_mfma_f32_16x16x32_bf16 a[60:63], a[184:187], v[44:47], a[60:63]
v_cvt_pk_bf16_f32 v94, v20, v21
v_cvt_pk_bf16_f32 v95, v22, v23
v_mfma_f32_16x16x32_bf16 a[60:63], a[188:191], v[60:63], a[60:63]
v_exp_f32 v28, v28
v_mfma_f32_16x16x32_bf16 a[28:31], a[188:191], v[56:59], a[28:31]
ds_read_b64_tr_b16 a[188:189], v223 offset:24576
ds_read_b64_tr_b16 a[190:191], v223 offset:28672
v_mfma_f32_16x16x32_bf16 a[28:31], a[184:187], v[40:43], a[28:31]
v_exp_f32 v29, v29
v_smfmac_f32_16x16x64_bf16 a[252:255], a[208:211], v[80:87], v235
ds_read_b64_tr_b16 a[184:185], v223 offset:16384
ds_read_b64_tr_b16 a[186:187], v223 offset:20480
v_mfma_f32_16x16x32_bf16 v[8:11], a[128:131], v[152:155], v[136:139]
v_exp_f32 v30, v30
v_mfma_f32_16x16x32_bf16 v[8:11], a[132:135], v[156:159], v[8:11]
buffer_load_dwordx4 v231, s[8:11], s38 offen offset:3072 lds
v_mfma_f32_16x16x32_bf16 v[8:11], a[136:139], v[160:163], v[8:11]
s_waitcnt lgkmcnt(6)
v_exp_f32 v31, v31
v_mfma_f32_16x16x32_bf16 v[8:11], a[140:143], v[164:167], v[8:11]
v_cvt_pk_bf16_f32 v98, v28, v29
v_cvt_pk_bf16_f32 v99, v30, v31
v_mfma_f32_16x16x32_bf16 v[16:19], a[140:143], v[180:183], v[140:143]
v_exp_f32 v36, v36
v_mfma_f32_16x16x32_bf16 v[16:19], a[136:139], v[176:179], v[16:19]
v_exp_f32 v123, v123
v_mfma_f32_16x16x32_bf16 v[16:19], a[132:135], v[172:175], v[16:19]
v_exp_f32 v37, v37
v_mfma_f32_16x16x32_bf16 v[16:19], a[128:131], v[168:171], v[16:19]
v_cvt_pk_bf16_f32 v102, v36, v37
v_add_f32 v120, 1.0, v120
v_mfma_f32_16x16x32_bf16 v[24:27], a[128:131], v[184:187], v[144:147]
v_exp_f32 v38, v38
v_mfma_f32_16x16x32_bf16 v[24:27], a[132:135], v[188:191], v[24:27]
v_add_f32 v121, 1.0, v121
v_add_f32 v122, 1.0, v122
v_mfma_f32_16x16x32_bf16 v[24:27], a[136:139], v[192:195], v[24:27]
v_exp_f32 v39, v39
v_mfma_f32_16x16x32_bf16 v[24:27], a[140:143], v[196:199], v[24:27]
v_cvt_pk_bf16_f32 v103, v38, v39
v_add_f32 v123, 1.0, v123
v_mfma_f32_16x16x32_bf16 v[32:35], a[140:143], v[212:215], v[148:151]
v_rcp_f32 v120, v120
v_mfma_f32_16x16x32_bf16 v[32:35], a[136:139], v[208:211], v[32:35]
s_add_u32 s38, s38, 16384
v_rcp_f32 v121, v121
v_mfma_f32_16x16x32_bf16 v[32:35], a[132:135], v[204:207], v[32:35]
v_rcp_f32 v122, v122
v_mfma_f32_16x16x32_bf16 v[32:35], a[128:131], v[200:203], v[32:35]
ds_read_b64_tr_b16 a[200:201], v130
ds_read_b64_tr_b16 a[204:205], v131
v_mfma_f32_16x16x32_bf16 a[0:3], a[160:163], v[72:75], a[0:3]
v_exp_f32 v8, v8
v_mfma_f32_16x16x32_bf16 a[0:3], a[164:167], v[88:91], a[0:3]
v_exp_f32 v9, v9
v_mfma_f32_16x16x32_bf16 a[32:35], a[164:167], v[92:95], a[32:35]
buffer_load_dwordx2 v[252:253], v251, s[76:79], s42 offen sc1
v_mfma_f32_16x16x32_bf16 a[32:35], a[160:163], v[76:79], a[32:35]
v_exp_f32 v10, v10
v_mfma_f32_16x16x32_bf16 a[64:67], a[160:163], v[80:83], a[64:67]
ds_read_b64_tr_b16 a[212:213], v132
v_cvt_pk_bf16_f32 v40, v8, v9
v_mfma_f32_16x16x32_bf16 a[64:67], a[164:167], v[96:99], a[64:67]
v_exp_f32 v11, v11
v_mfma_f32_16x16x32_bf16 a[96:99], a[164:167], v[100:103], a[96:99]
ds_read_b64_tr_b16 a[164:165], v224 offset:24576
ds_read_b64_tr_b16 a[166:167], v224 offset:28672
v_mfma_f32_16x16x32_bf16 a[96:99], a[160:163], v[84:87], a[96:99]
v_exp_f32 v16, v16
v_mfma_f32_16x16x32_bf16 a[100:103], a[168:171], v[84:87], a[100:103]
ds_read_b64_tr_b16 a[160:161], v224 offset:16384
ds_read_b64_tr_b16 a[162:163], v224 offset:20480
v_mfma_f32_16x16x32_bf16 a[100:103], a[172:175], v[100:103], a[100:103]
v_exp_f32 v17, v17
v_mfma_f32_16x16x32_bf16 a[68:71], a[172:175], v[96:99], a[68:71]
v_cvt_pk_bf16_f32 v41, v10, v11
v_cvt_pk_bf16_f32 v44, v16, v17
v_mfma_f32_16x16x32_bf16 a[68:71], a[168:171], v[80:83], a[68:71]
v_exp_f32 v18, v18
v_mfma_f32_16x16x32_bf16 a[36:39], a[168:171], v[76:79], a[36:39]
v_rcp_f32 v123, v123
v_mfma_f32_16x16x32_bf16 a[36:39], a[172:175], v[92:95], a[36:39]
v_exp_f32 v19, v19
v_mfma_f32_16x16x32_bf16 a[4:7], a[172:175], v[88:91], a[4:7]
ds_read_b64_tr_b16 a[172:173], v225 offset:24576
ds_read_b64_tr_b16 a[174:175], v225 offset:28672
v_mfma_f32_16x16x32_bf16 a[4:7], a[168:171], v[72:75], a[4:7]
v_exp_f32 v24, v24
v_smfmac_f32_16x16x64_bf16 a[248:251], a[208:211], v[88:95], v235
s_add_u32 s42, s42, s43
buffer_load_dword v255, v243, s[28:31], s45 offen
v_mfma_f32_16x16x32_bf16 v[12:15], a[144:147], v[152:155], v[136:139]
v_exp_f32 v25, v25
v_mfma_f32_16x16x32_bf16 v[12:15], a[148:151], v[156:159], v[12:15]
ds_read_b64_tr_b16 a[168:169], v225 offset:16384
ds_read_b64_tr_b16 a[170:171], v225 offset:20480
v_mfma_f32_16x16x32_bf16 v[12:15], a[152:155], v[160:163], v[12:15]
v_exp_f32 v26, v26
v_mfma_f32_16x16x32_bf16 v[12:15], a[156:159], v[164:167], v[12:15]
ds_read_b128 a[128:131], v216 offset:40960
ds_read_b128 a[132:135], v217 offset:40960
v_mfma_f32_16x16x32_bf16 v[20:23], a[156:159], v[180:183], v[140:143]
v_exp_f32 v27, v27
v_mfma_f32_16x16x32_bf16 v[20:23], a[152:155], v[176:179], v[20:23]
ds_read_b128 a[136:139], v218 offset:40960
v_cvt_pk_bf16_f32 v45, v18, v19
v_mfma_f32_16x16x32_bf16 v[20:23], a[148:151], v[172:175], v[20:23]
v_exp_f32 v32, v32
v_mfma_f32_16x16x32_bf16 v[20:23], a[144:147], v[168:171], v[20:23]
ds_read_b128 a[140:143], v219 offset:40960
v_cvt_pk_bf16_f32 v48, v24, v25
v_mfma_f32_16x16x32_bf16 v[28:31], a[144:147], v[184:187], v[144:147]
v_exp_f32 v33, v33
v_mfma_f32_16x16x32_bf16 v[28:31], a[148:151], v[188:191], v[28:31]
v_cvt_pk_bf16_f32 v49, v26, v27
v_cvt_pk_bf16_f32 v52, v32, v33
v_mfma_f32_16x16x32_bf16 v[28:31], a[152:155], v[192:195], v[28:31]
v_exp_f32 v34, v34
v_mfma_f32_16x16x32_bf16 v[28:31], a[156:159], v[196:199], v[28:31]
v_mul_f32 v104, v104, v120
v_mul_f32 v105, v105, v121
v_mfma_f32_16x16x32_bf16 v[36:39], a[156:159], v[212:215], v[148:151]
v_exp_f32 v35, v35
v_mfma_f32_16x16x32_bf16 v[36:39], a[152:155], v[208:211], v[36:39]
ds_read_b128 a[156:159], v219 offset:45056
ds_read_b128 a[152:155], v218 offset:45056
v_mfma_f32_16x16x32_bf16 v[36:39], a[148:151], v[204:207], v[36:39]
s_waitcnt lgkmcnt(4)
v_exp_f32 v12, v12
v_mfma_f32_16x16x32_bf16 v[36:39], a[144:147], v[200:203], v[36:39]
s_add_u32 s45, s45, 589824
v_exp_f32 v13, v13
v_mfma_f32_16x16x32_bf16 a[8:11], a[176:179], v[72:75], a[8:11]
global_load_dword v255, v242, s[72:73]
v_mfma_f32_16x16x32_bf16 a[8:11], a[180:183], v[88:91], a[8:11]
v_exp_f32 v14, v14
v_mfma_f32_16x16x32_bf16 a[40:43], a[180:183], v[92:95], a[40:43]
ds_read_b128 a[148:151], v217 offset:45056
ds_read_b128 a[144:147], v216 offset:45056
v_mfma_f32_16x16x32_bf16 a[40:43], a[176:179], v[76:79], a[40:43]
v_exp_f32 v15, v15
v_mfma_f32_16x16x32_bf16 a[72:75], a[176:179], v[80:83], a[72:75]
v_cvt_pk_bf16_f32 v53, v34, v35
v_cvt_pk_bf16_f32 v42, v12, v13
v_mfma_f32_16x16x32_bf16 a[72:75], a[180:183], v[96:99], a[72:75]
v_exp_f32 v20, v20
v_mfma_f32_16x16x32_bf16 a[104:107], a[180:183], v[100:103], a[104:107]
ds_read_b64_tr_b16 a[180:181], v226 offset:24576
ds_read_b64_tr_b16 a[182:183], v226 offset:28672
v_mfma_f32_16x16x32_bf16 a[104:107], a[176:179], v[84:87], a[104:107]
v_exp_f32 v21, v21
v_mfma_f32_16x16x32_bf16 a[108:111], a[184:187], v[84:87], a[108:111]
ds_read_b64_tr_b16 a[176:177], v226 offset:16384
ds_read_b64_tr_b16 a[178:179], v226 offset:20480
v_mfma_f32_16x16x32_bf16 a[108:111], a[188:191], v[100:103], a[108:111]
v_exp_f32 v22, v22
v_mfma_f32_16x16x32_bf16 a[76:79], a[188:191], v[96:99], a[76:79]
v_cvt_pk_bf16_f32 v43, v14, v15
v_cvt_pk_bf16_f32 v46, v20, v21
v_mfma_f32_16x16x32_bf16 a[76:79], a[184:187], v[80:83], a[76:79]
v_exp_f32 v23, v23
v_mfma_f32_16x16x32_bf16 a[44:47], a[184:187], v[76:79], a[44:47]
v_cvt_pk_bf16_f32 v47, v22, v23
v_mul_f32 v106, v106, v122
v_mfma_f32_16x16x32_bf16 a[44:47], a[188:191], v[92:95], a[44:47]
v_exp_f32 v28, v28
v_mfma_f32_16x16x32_bf16 a[12:15], a[188:191], v[88:91], a[12:15]
buffer_load_dword v255, v0, s[24:27], s44 offen
v_mfma_f32_16x16x32_bf16 a[12:15], a[184:187], v[72:75], a[12:15]
v_exp_f32 v29, v29
v_smfmac_f32_16x16x64_bf16 a[252:255], a[208:211], v[96:103], v235
ds_read_b64_tr_b16 a[188:189], v227 offset:24576
ds_read_b64_tr_b16 a[190:191], v227 offset:28672
v_mfma_f32_16x16x32_bf16 v[8:11], a[128:131], v[152:155], v[136:139]
v_exp_f32 v30, v30
v_mfma_f32_16x16x32_bf16 v[8:11], a[132:135], v[156:159], v[8:11]
s_waitcnt lgkmcnt(2)
ds_read_b64_tr_b16 a[184:185], v227 offset:16384
ds_read_b64_tr_b16 a[186:187], v227 offset:20480
v_mfma_f32_16x16x32_bf16 v[8:11], a[136:139], v[160:163], v[8:11]
v_exp_f32 v31, v31
v_mfma_f32_16x16x32_bf16 v[8:11], a[140:143], v[164:167], v[8:11]
v_cvt_pk_bf16_f32 v50, v28, v29
v_cvt_pk_bf16_f32 v51, v30, v31
v_mfma_f32_16x16x32_bf16 v[16:19], a[140:143], v[180:183], v[140:143]
v_exp_f32 v36, v36
v_mfma_f32_16x16x32_bf16 v[16:19], a[136:139], v[176:179], v[16:19]
v_mul_f32 v107, v107, v123
v_cvt_pk_bf16_f32 v120, v104, v105
v_mfma_f32_16x16x32_bf16 v[16:19], a[132:135], v[172:175], v[16:19]
v_exp_f32 v37, v37
v_mfma_f32_16x16x32_bf16 v[16:19], a[128:131], v[168:171], v[16:19]
v_cvt_pk_bf16_f32 v54, v36, v37
v_cvt_pk_bf16_f32 v121, v106, v107
v_mfma_f32_16x16x32_bf16 v[24:27], a[128:131], v[184:187], v[144:147]
v_exp_f32 v38, v38
v_mfma_f32_16x16x32_bf16 v[24:27], a[132:135], v[188:191], v[24:27]
v_cndmask_b32 v244, v244, v120, s[88:89]
v_cndmask_b32 v245, v245, v121, s[88:89]
v_mfma_f32_16x16x32_bf16 v[24:27], a[136:139], v[192:195], v[24:27]
v_exp_f32 v39, v39
v_mfma_f32_16x16x32_bf16 v[24:27], a[140:143], v[196:199], v[24:27]
ds_write_b64 v6, v[244:245] offset:0
v_cvt_pk_bf16_f32 v55, v38, v39
v_mfma_f32_16x16x32_bf16 v[32:35], a[140:143], v[212:215], v[148:151]
ds_write_b64 v6, v[244:245] offset:8192
ds_write_b64 v6, v[244:245] offset:16384
v_mfma_f32_16x16x32_bf16 v[32:35], a[136:139], v[208:211], v[32:35]
s_add_u32 s44, s44, 4096
ds_write_b64 v6, v[244:245] offset:24576
ds_read_b64_tr_b16 a[216:217], v133
v_mfma_f32_16x16x32_bf16 v[32:35], a[132:135], v[204:207], v[32:35]
ds_read_b64_tr_b16 a[220:221], v134
ds_read_b64_tr_b16 a[224:225], v135
v_mfma_f32_16x16x32_bf16 v[32:35], a[128:131], v[200:203], v[32:35]
v_mfma_f32_16x16x32_bf16 a[16:19], a[160:163], v[72:75], a[16:19]
s_lshl_b32 s90, s52, 7
v_exp_f32 v8, v8
v_mfma_f32_16x16x32_bf16 a[16:19], a[164:167], v[88:91], a[16:19]
s_add_u32 s90, s90, 0x2400000
v_exp_f32 v9, v9
v_mfma_f32_16x16x32_bf16 a[48:51], a[164:167], v[92:95], a[48:51]
s_add_u32 s47, s32, 32
v_cvt_pk_bf16_f32 v56, v8, v9
v_mfma_f32_16x16x32_bf16 a[48:51], a[160:163], v[76:79], a[48:51]
s_mul_i32 s92, s47, 74240
v_exp_f32 v10, v10
v_mfma_f32_16x16x32_bf16 a[80:83], a[160:163], v[80:83], a[80:83]
s_add_u32 s92, s92, s90
v_mfma_f32_16x16x32_bf16 a[80:83], a[164:167], v[96:99], a[80:83]
s_mul_i32 s47, s32, 593920
v_exp_f32 v11, v11
s_waitcnt vmcnt(4) lgkmcnt(0)
s_barrier
v_mfma_f32_16x16x32_bf16 a[112:115], a[164:167], v[100:103], a[112:115]
s_add_u32 s90, s90, s47
ds_read_b64_tr_b16 a[164:165], v220 offset:40960
ds_read_b64_tr_b16 a[166:167], v220 offset:45056
v_mfma_f32_16x16x32_bf16 a[112:115], a[160:163], v[84:87], a[112:115]
s_add_u32 m0, s49, 4096
v_exp_f32 v16, v16
v_mfma_f32_16x16x32_bf16 a[116:119], a[168:171], v[84:87], a[116:119]
s_add_u32 s48, s91, 18432
buffer_load_dwordx4 v249, s[64:67], s48 offen  lds
v_mfma_f32_16x16x32_bf16 a[116:119], a[172:175], v[100:103], a[116:119]
v_exp_f32 v17, v17
v_mfma_f32_16x16x32_bf16 a[84:87], a[172:175], v[96:99], a[84:87]
ds_read_b64_tr_b16 a[160:161], v220 offset:32768
ds_read_b64_tr_b16 a[162:163], v220 offset:36864
v_mfma_f32_16x16x32_bf16 a[84:87], a[168:171], v[80:83], a[84:87]
v_exp_f32 v18, v18
v_mfma_f32_16x16x32_bf16 a[52:55], a[168:171], v[76:79], a[52:55]
s_add_u32 m0, s49, 5120
v_cvt_pk_bf16_f32 v57, v10, v11
v_cvt_pk_bf16_f32 v60, v16, v17
v_mfma_f32_16x16x32_bf16 a[52:55], a[172:175], v[92:95], a[52:55]
s_add_u32 s48, s91, 23040
v_exp_f32 v19, v19
v_mfma_f32_16x16x32_bf16 a[20:23], a[172:175], v[88:91], a[20:23]
buffer_load_dwordx4 v250, s[64:67], s48 offen  lds
v_mfma_f32_16x16x32_bf16 a[20:23], a[168:171], v[72:75], a[20:23]
v_exp_f32 v24, v24
v_smfmac_f32_16x16x64_bf16 a[248:251], a[208:211], v[40:47], v235
ds_read_b64_tr_b16 a[172:173], v221 offset:40960
ds_read_b64_tr_b16 a[174:175], v221 offset:45056
v_mfma_f32_16x16x32_bf16 v[12:15], a[144:147], v[152:155], v[136:139]
v_exp_f32 v25, v25
v_mfma_f32_16x16x32_bf16 v[12:15], a[148:151], v[156:159], v[12:15]
s_add_u32 m0, s49, 6144
ds_read_b64_tr_b16 a[168:169], v221 offset:32768
ds_read_b64_tr_b16 a[170:171], v221 offset:36864
v_mfma_f32_16x16x32_bf16 v[12:15], a[152:155], v[160:163], v[12:15]
s_add_u32 s48, s91, 27648
v_exp_f32 v26, v26
v_mfma_f32_16x16x32_bf16 v[12:15], a[156:159], v[164:167], v[12:15]
buffer_load_dwordx4 v249, s[64:67], s48 offen  lds
v_mfma_f32_16x16x32_bf16 v[20:23], a[156:159], v[180:183], v[140:143]
v_exp_f32 v27, v27
v_mfma_f32_16x16x32_bf16 v[20:23], a[152:155], v[176:179], v[20:23]
ds_read_b128 a[128:131], v216 offset:16384
ds_read_b128 a[132:135], v217 offset:16384
v_mfma_f32_16x16x32_bf16 v[20:23], a[148:151], v[172:175], v[20:23]
s_add_u32 m0, s49, 7168
v_exp_f32 v32, v32
v_mfma_f32_16x16x32_bf16 v[20:23], a[144:147], v[168:171], v[20:23]
s_add_u32 s48, s91, 32256
buffer_load_dwordx4 v250, s[64:67], s48 offen  lds
v_mfma_f32_16x16x32_bf16 v[28:31], a[144:147], v[184:187], v[144:147]
v_exp_f32 v33, v33
v_mfma_f32_16x16x32_bf16 v[28:31], a[148:151], v[188:191], v[28:31]
ds_read_b128 a[136:139], v218 offset:16384
ds_read_b128 a[140:143], v219 offset:16384
v_mfma_f32_16x16x32_bf16 v[28:31], a[152:155], v[192:195], v[28:31]
v_exp_f32 v34, v34
v_mfma_f32_16x16x32_bf16 v[28:31], a[156:159], v[196:199], v[28:31]
v_cvt_pk_bf16_f32 v61, v18, v19
v_cvt_pk_bf16_f32 v64, v24, v25
v_mfma_f32_16x16x32_bf16 v[36:39], a[156:159], v[212:215], v[148:151]
s_add_u32 m0, s37, 65536
v_exp_f32 v35, v35
v_mfma_f32_16x16x32_bf16 v[36:39], a[152:155], v[208:211], v[36:39]
buffer_load_dwordx4 v232, s[12:15], s39 offen offset:0 lds
v_mfma_f32_16x16x32_bf16 v[36:39], a[148:151], v[204:207], v[36:39]
v_exp_f32 v12, v12
v_mfma_f32_16x16x32_bf16 v[36:39], a[144:147], v[200:203], v[36:39]
v_exp_f32 v13, v13
v_mfma_f32_16x16x32_bf16 a[24:27], a[176:179], v[72:75], a[24:27]
ds_read_b128 a[156:159], v219 offset:20480
ds_read_b128 a[152:155], v218 offset:20480
v_mfma_f32_16x16x32_bf16 a[24:27], a[180:183], v[88:91], a[24:27]
v_exp_f32 v14, v14
v_mfma_f32_16x16x32_bf16 a[56:59], a[180:183], v[92:95], a[56:59]
buffer_load_dwordx4 v233, s[12:15], s39 offen offset:1024 lds
v_mfma_f32_16x16x32_bf16 a[56:59], a[176:179], v[76:79], a[56:59]
v_exp_f32 v15, v15
v_mfma_f32_16x16x32_bf16 a[88:91], a[176:179], v[80:83], a[88:91]
ds_read_b128 a[148:151], v217 offset:20480
ds_read_b128 a[144:147], v216 offset:20480
v_mfma_f32_16x16x32_bf16 a[88:91], a[180:183], v[96:99], a[88:91]
v_exp_f32 v20, v20
v_mfma_f32_16x16x32_bf16 a[120:123], a[180:183], v[100:103], a[120:123]
ds_read_b64_tr_b16 a[180:181], v222 offset:40960
ds_read_b64_tr_b16 a[182:183], v222 offset:45056
v_mfma_f32_16x16x32_bf16 a[120:123], a[176:179], v[84:87], a[120:123]
v_exp_f32 v21, v21
v_mfma_f32_16x16x32_bf16 a[124:127], a[184:187], v[84:87], a[124:127]
buffer_load_dwordx4 v232, s[12:15], s39 offen offset:2048 lds
v_mfma_f32_16x16x32_bf16 a[124:127], a[188:191], v[100:103], a[124:127]
v_exp_f32 v22, v22
v_mfma_f32_16x16x32_bf16 a[92:95], a[188:191], v[96:99], a[92:95]
ds_read_b64_tr_b16 a[176:177], v222 offset:32768
ds_read_b64_tr_b16 a[178:179], v222 offset:36864
v_mfma_f32_16x16x32_bf16 a[92:95], a[184:187], v[80:83], a[92:95]
v_exp_f32 v23, v23
v_mfma_f32_16x16x32_bf16 a[60:63], a[184:187], v[76:79], a[60:63]
v_cvt_pk_bf16_f32 v65, v26, v27
v_cvt_pk_bf16_f32 v68, v32, v33
v_mfma_f32_16x16x32_bf16 a[60:63], a[188:191], v[92:95], a[60:63]
v_exp_f32 v28, v28
v_mfma_f32_16x16x32_bf16 a[28:31], a[188:191], v[88:91], a[28:31]
buffer_load_dwordx4 v233, s[12:15], s39 offen offset:3072 lds
v_mfma_f32_16x16x32_bf16 a[28:31], a[184:187], v[72:75], a[28:31]
v_exp_f32 v29, v29
v_smfmac_f32_16x16x64_bf16 a[252:255], a[208:211], v[48:55], v235
s_waitcnt lgkmcnt(2)
ds_read_b64_tr_b16 a[188:189], v223 offset:40960
ds_read_b64_tr_b16 a[190:191], v223 offset:45056
v_mfma_f32_16x16x32_bf16 v[8:11], a[128:131], v[152:155], v[136:139]
v_exp_f32 v30, v30
v_mfma_f32_16x16x32_bf16 v[8:11], a[132:135], v[156:159], v[8:11]
s_add_u32 s39, s39, 16384
ds_read_b64_tr_b16 a[184:185], v223 offset:32768
ds_read_b64_tr_b16 a[186:187], v223 offset:36864
v_mfma_f32_16x16x32_bf16 v[8:11], a[136:139], v[160:163], v[8:11]
s_add_u32 m0, s37, 49152
v_exp_f32 v31, v31
v_mfma_f32_16x16x32_bf16 v[8:11], a[140:143], v[164:167], v[8:11]
buffer_load_dwordx4 v228, s[8:11], s38 offen offset:0 lds
v_mfma_f32_16x16x32_bf16 v[16:19], a[140:143], v[180:183], v[140:143]
v_exp_f32 v36, v36
v_mfma_f32_16x16x32_bf16 v[16:19], a[136:139], v[176:179], v[16:19]
v_cvt_pk_bf16_f32 v69, v34, v35
v_cvt_pk_bf16_f32 v58, v12, v13
v_mfma_f32_16x16x32_bf16 v[16:19], a[132:135], v[172:175], v[16:19]
v_exp_f32 v37, v37
v_mfma_f32_16x16x32_bf16 v[16:19], a[128:131], v[168:171], v[16:19]
buffer_load_dwordx4 v229, s[8:11], s38 offen offset:1024 lds
v_mfma_f32_16x16x32_bf16 v[24:27], a[128:131], v[184:187], v[144:147]
v_exp_f32 v38, v38
v_mfma_f32_16x16x32_bf16 v[24:27], a[132:135], v[188:191], v[24:27]
v_cvt_pk_bf16_f32 v59, v14, v15
v_cvt_pk_bf16_f32 v62, v20, v21
v_mfma_f32_16x16x32_bf16 v[24:27], a[136:139], v[192:195], v[24:27]
v_exp_f32 v39, v39
v_mfma_f32_16x16x32_bf16 v[24:27], a[140:143], v[196:199], v[24:27]
v_cvt_pk_bf16_f32 v63, v22, v23
v_cvt_pk_bf16_f32 v66, v28, v29
v_mfma_f32_16x16x32_bf16 v[32:35], a[140:143], v[212:215], v[148:151]
v_cvt_pk_bf16_f32 v67, v30, v31
v_cvt_pk_bf16_f32 v70, v36, v37
v_mfma_f32_16x16x32_bf16 v[32:35], a[136:139], v[208:211], v[32:35]
ds_read_b64 v[104:105], v5 offset:0
v_cvt_pk_bf16_f32 v71, v38, v39
v_mfma_f32_16x16x32_bf16 v[32:35], a[132:135], v[204:207], v[32:35]
ds_read_b64 v[106:107], v5 offset:1024
ds_read_b64 v[108:109], v5 offset:2048
v_mfma_f32_16x16x32_bf16 v[32:35], a[128:131], v[200:203], v[32:35]
ds_read_b64 v[110:111], v5 offset:3072
v_and_b32 v7, 7, v1
v_mul_u32_u24 v248, 18560, v4
v_lshl_add_u32 v248, v7, 4, v248
v_mfma_f32_16x16x32_bf16 a[0:3], a[160:163], v[40:43], a[0:3]
v_exp_f32 v8, v8
v_mfma_f32_16x16x32_bf16 a[0:3], a[164:167], v[56:59], a[0:3]
v_exp_f32 v9, v9
v_mfma_f32_16x16x32_bf16 a[32:35], a[164:167], v[60:63], a[32:35]
buffer_load_dwordx4 v230, s[8:11], s38 offen offset:2048 lds
v_mfma_f32_16x16x32_bf16 a[32:35], a[160:163], v[44:47], a[32:35]
v_exp_f32 v10, v10
v_mfma_f32_16x16x32_bf16 a[64:67], a[160:163], v[48:51], a[64:67]
v_cvt_pk_bf16_f32 v72, v8, v9
s_waitcnt lgkmcnt(0)
v_lshlrev_b32 v112, 16, v104
v_mfma_f32_16x16x32_bf16 a[64:67], a[164:167], v[64:67], a[64:67]
v_exp_f32 v11, v11
v_mfma_f32_16x16x32_bf16 a[96:99], a[164:167], v[68:71], a[96:99]
ds_read_b64_tr_b16 a[164:165], v224 offset:40960
ds_read_b64_tr_b16 a[166:167], v224 offset:45056
v_mfma_f32_16x16x32_bf16 a[96:99], a[160:163], v[52:55], a[96:99]
v_exp_f32 v16, v16
v_mfma_f32_16x16x32_bf16 a[100:103], a[168:171], v[52:55], a[100:103]
ds_read_b64_tr_b16 a[160:161], v224 offset:32768
ds_read_b64_tr_b16 a[162:163], v224 offset:36864
v_mfma_f32_16x16x32_bf16 a[100:103], a[172:175], v[68:71], a[100:103]
v_exp_f32 v17, v17
v_mfma_f32_16x16x32_bf16 a[68:71], a[172:175], v[64:67], a[68:71]
v_cvt_pk_bf16_f32 v73, v10, v11
v_cvt_pk_bf16_f32 v76, v16, v17
v_mfma_f32_16x16x32_bf16 a[68:71], a[168:171], v[48:51], a[68:71]
v_exp_f32 v18, v18
v_mfma_f32_16x16x32_bf16 a[36:39], a[168:171], v[44:47], a[36:39]
v_and_b32 v113, 0xffff0000, v104
v_lshlrev_b32 v114, 16, v105
v_mfma_f32_16x16x32_bf16 a[36:39], a[172:175], v[60:63], a[36:39]
v_exp_f32 v19, v19
v_mfma_f32_16x16x32_bf16 a[4:7], a[172:175], v[56:59], a[4:7]
buffer_load_dwordx4 v231, s[8:11], s38 offen offset:3072 lds
v_mfma_f32_16x16x32_bf16 a[4:7], a[168:171], v[40:43], a[4:7]
v_exp_f32 v24, v24
v_smfmac_f32_16x16x64_bf16 a[248:251], a[208:211], v[56:63], v235
ds_read_b64_tr_b16 a[172:173], v225 offset:40960
ds_read_b64_tr_b16 a[174:175], v225 offset:45056
v_mfma_f32_16x16x32_bf16 v[12:15], a[144:147], v[152:155], v[136:139]
v_exp_f32 v25, v25
v_mfma_f32_16x16x32_bf16 v[12:15], a[148:151], v[156:159], v[12:15]
ds_read_b64_tr_b16 a[168:169], v225 offset:32768
ds_read_b64_tr_b16 a[170:171], v225 offset:36864
v_mfma_f32_16x16x32_bf16 v[12:15], a[152:155], v[160:163], v[12:15]
v_exp_f32 v26, v26
v_mfma_f32_16x16x32_bf16 v[12:15], a[156:159], v[164:167], v[12:15]
ds_read_b128 a[128:131], v216 offset:24576
ds_read_b128 a[132:135], v217 offset:24576
v_mfma_f32_16x16x32_bf16 v[20:23], a[156:159], v[180:183], v[140:143]
v_exp_f32 v27, v27
v_mfma_f32_16x16x32_bf16 v[20:23], a[152:155], v[176:179], v[20:23]
ds_read_b128 a[136:139], v218 offset:24576
v_cvt_pk_bf16_f32 v77, v18, v19
v_mfma_f32_16x16x32_bf16 v[20:23], a[148:151], v[172:175], v[20:23]
v_exp_f32 v32, v32
v_mfma_f32_16x16x32_bf16 v[20:23], a[144:147], v[168:171], v[20:23]
ds_read_b128 a[140:143], v219 offset:24576
v_cvt_pk_bf16_f32 v80, v24, v25
v_mfma_f32_16x16x32_bf16 v[28:31], a[144:147], v[184:187], v[144:147]
s_add_u32 s38, s38, 16384
v_exp_f32 v33, v33
v_mfma_f32_16x16x32_bf16 v[28:31], a[148:151], v[188:191], v[28:31]
s_add_u32 m0, s37, 81920
v_cvt_pk_bf16_f32 v81, v26, v27
v_cvt_pk_bf16_f32 v84, v32, v33
v_mfma_f32_16x16x32_bf16 v[28:31], a[152:155], v[192:195], v[28:31]
v_exp_f32 v34, v34
v_mfma_f32_16x16x32_bf16 v[28:31], a[156:159], v[196:199], v[28:31]
buffer_load_dwordx4 v232, s[12:15], s39 offen offset:0 lds
v_mfma_f32_16x16x32_bf16 v[36:39], a[156:159], v[212:215], v[148:151]
v_exp_f32 v35, v35
v_mfma_f32_16x16x32_bf16 v[36:39], a[152:155], v[208:211], v[36:39]
ds_read_b128 a[156:159], v219 offset:28672
ds_read_b128 a[152:155], v218 offset:28672
v_mfma_f32_16x16x32_bf16 v[36:39], a[148:151], v[204:207], v[36:39]
v_exp_f32 v12, v12
v_mfma_f32_16x16x32_bf16 v[36:39], a[144:147], v[200:203], v[36:39]
v_exp_f32 v13, v13
v_mfma_f32_16x16x32_bf16 a[8:11], a[176:179], v[40:43], a[8:11]
ds_read_b128 a[148:151], v217 offset:28672
ds_read_b128 a[144:147], v216 offset:28672
v_mfma_f32_16x16x32_bf16 a[8:11], a[180:183], v[56:59], a[8:11]
v_exp_f32 v14, v14
v_mfma_f32_16x16x32_bf16 a[40:43], a[180:183], v[60:63], a[40:43]
v_cvt_pk_bf16_f32 v85, v34, v35
v_cvt_pk_bf16_f32 v74, v12, v13
v_mfma_f32_16x16x32_bf16 a[40:43], a[176:179], v[44:47], a[40:43]
v_exp_f32 v15, v15
v_mfma_f32_16x16x32_bf16 a[72:75], a[176:179], v[48:51], a[72:75]
v_cvt_pk_bf16_f32 v75, v14, v15
v_and_b32 v115, 0xffff0000, v105
v_mfma_f32_16x16x32_bf16 a[72:75], a[180:183], v[64:67], a[72:75]
v_exp_f32 v20, v20
v_mfma_f32_16x16x32_bf16 a[104:107], a[180:183], v[68:71], a[104:107]
buffer_load_dwordx4 v233, s[12:15], s39 offen offset:1024 lds
v_mfma_f32_16x16x32_bf16 a[104:107], a[176:179], v[52:55], a[104:107]
v_exp_f32 v21, v21
v_mfma_f32_16x16x32_bf16 a[108:111], a[184:187], v[52:55], a[108:111]
ds_read_b64_tr_b16 a[180:181], v226 offset:40960
ds_read_b64_tr_b16 a[182:183], v226 offset:45056
v_mfma_f32_16x16x32_bf16 a[108:111], a[188:191], v[68:71], a[108:111]
v_exp_f32 v22, v22
v_mfma_f32_16x16x32_bf16 a[76:79], a[188:191], v[64:67], a[76:79]
ds_read_b64_tr_b16 a[176:177], v226 offset:32768
ds_read_b64_tr_b16 a[178:179], v226 offset:36864
v_mfma_f32_16x16x32_bf16 a[76:79], a[184:187], v[48:51], a[76:79]
v_exp_f32 v23, v23
v_mfma_f32_16x16x32_bf16 a[44:47], a[184:187], v[44:47], a[44:47]
v_cvt_pk_bf16_f32 v78, v20, v21
v_cvt_pk_bf16_f32 v79, v22, v23
v_mfma_f32_16x16x32_bf16 a[44:47], a[188:191], v[60:63], a[44:47]
v_exp_f32 v28, v28
v_mfma_f32_16x16x32_bf16 a[12:15], a[188:191], v[56:59], a[12:15]
ds_read_b64_tr_b16 a[188:189], v227 offset:40960
ds_read_b64_tr_b16 a[190:191], v227 offset:45056
v_mfma_f32_16x16x32_bf16 a[12:15], a[184:187], v[40:43], a[12:15]
v_exp_f32 v29, v29
v_smfmac_f32_16x16x64_bf16 a[252:255], a[208:211], v[64:71], v235
s_waitcnt lgkmcnt(6)
ds_read_b64_tr_b16 a[184:185], v227 offset:32768
ds_read_b64_tr_b16 a[186:187], v227 offset:36864
v_mfma_f32_16x16x32_bf16 v[8:11], a[128:131], v[152:155], v[136:139]
v_exp_f32 v30, v30
v_mfma_f32_16x16x32_bf16 v[8:11], a[132:135], v[156:159], v[8:11]
buffer_load_dwordx4 v232, s[12:15], s39 offen offset:2048 lds
v_mfma_f32_16x16x32_bf16 v[8:11], a[136:139], v[160:163], v[8:11]
v_exp_f32 v31, v31
v_mfma_f32_16x16x32_bf16 v[8:11], a[140:143], v[164:167], v[8:11]
v_cvt_pk_bf16_f32 v82, v28, v29
v_cvt_pk_bf16_f32 v83, v30, v31
v_mfma_f32_16x16x32_bf16 v[16:19], a[140:143], v[180:183], v[140:143]
v_exp_f32 v36, v36
v_mfma_f32_16x16x32_bf16 v[16:19], a[136:139], v[176:179], v[16:19]
v_lshlrev_b32 v116, 16, v106
v_and_b32 v117, 0xffff0000, v106
v_mfma_f32_16x16x32_bf16 v[16:19], a[132:135], v[172:175], v[16:19]
v_exp_f32 v37, v37
v_mfma_f32_16x16x32_bf16 v[16:19], a[128:131], v[168:171], v[16:19]
v_cvt_pk_bf16_f32 v86, v36, v37
v_lshlrev_b32 v118, 16, v107
v_mfma_f32_16x16x32_bf16 v[24:27], a[128:131], v[184:187], v[144:147]
v_exp_f32 v38, v38
v_mfma_f32_16x16x32_bf16 v[24:27], a[132:135], v[188:191], v[24:27]
v_and_b32 v119, 0xffff0000, v107
v_lshlrev_b32 v120, 16, v108
v_mfma_f32_16x16x32_bf16 v[24:27], a[136:139], v[192:195], v[24:27]
v_exp_f32 v39, v39
v_mfma_f32_16x16x32_bf16 v[24:27], a[140:143], v[196:199], v[24:27]
v_cvt_pk_bf16_f32 v87, v38, v39
v_and_b32 v121, 0xffff0000, v108
v_mfma_f32_16x16x32_bf16 v[32:35], a[140:143], v[212:215], v[148:151]
v_lshlrev_b32 v122, 16, v109
v_and_b32 v123, 0xffff0000, v109
v_mfma_f32_16x16x32_bf16 v[32:35], a[136:139], v[208:211], v[32:35]
v_lshlrev_b32 v124, 16, v110
v_and_b32 v125, 0xffff0000, v110
v_mfma_f32_16x16x32_bf16 v[32:35], a[132:135], v[204:207], v[32:35]
v_lshlrev_b32 v126, 16, v111
v_and_b32 v127, 0xffff0000, v111
v_mfma_f32_16x16x32_bf16 v[32:35], a[128:131], v[200:203], v[32:35]
v_mul_f32 v112, v112, v120
v_mul_f32 v113, v113, v121
v_mfma_f32_16x16x32_bf16 a[16:19], a[160:163], v[40:43], a[16:19]
v_exp_f32 v8, v8
v_mfma_f32_16x16x32_bf16 a[16:19], a[164:167], v[56:59], a[16:19]
v_exp_f32 v9, v9
v_mfma_f32_16x16x32_bf16 a[48:51], a[164:167], v[60:63], a[48:51]
buffer_load_dwordx4 v233, s[12:15], s39 offen offset:3072 lds
v_mfma_f32_16x16x32_bf16 a[48:51], a[160:163], v[44:47], a[48:51]
v_exp_f32 v10, v10
v_mfma_f32_16x16x32_bf16 a[80:83], a[160:163], v[48:51], a[80:83]
v_cvt_pk_bf16_f32 v88, v8, v9
v_mul_f32 v114, v114, v122
v_mfma_f32_16x16x32_bf16 a[80:83], a[164:167], v[64:67], a[80:83]
v_exp_f32 v11, v11
v_mfma_f32_16x16x32_bf16 a[112:115], a[164:167], v[68:71], a[112:115]
ds_read_b64_tr_b16 a[164:165], v220 offset:57344
ds_read_b64_tr_b16 a[166:167], v220 offset:61440
v_mfma_f32_16x16x32_bf16 a[112:115], a[160:163], v[52:55], a[112:115]
v_exp_f32 v16, v16
v_mfma_f32_16x16x32_bf16 a[116:119], a[168:171], v[52:55], a[116:119]
ds_read_b64_tr_b16 a[160:161], v220 offset:49152
ds_read_b64_tr_b16 a[162:163], v220 offset:53248
v_mfma_f32_16x16x32_bf16 a[116:119], a[172:175], v[68:71], a[116:119]
v_exp_f32 v17, v17
v_mfma_f32_16x16x32_bf16 a[84:87], a[172:175], v[64:67], a[84:87]
v_cvt_pk_bf16_f32 v89, v10, v11
v_cvt_pk_bf16_f32 v92, v16, v17
v_mfma_f32_16x16x32_bf16 a[84:87], a[168:171], v[48:51], a[84:87]
v_exp_f32 v18, v18
v_mfma_f32_16x16x32_bf16 a[52:55], a[168:171], v[44:47], a[52:55]
v_mul_f32 v115, v115, v123
v_mul_f32 v116, v116, v124
v_mfma_f32_16x16x32_bf16 a[52:55], a[172:175], v[60:63], a[52:55]
s_add_u32 s39, s39, 16384
v_exp_f32 v19, v19
v_mfma_f32_16x16x32_bf16 a[20:23], a[172:175], v[56:59], a[20:23]
s_add_u32 m0, s37, 32768
ds_read_b64_tr_b16 a[172:173], v221 offset:57344
ds_read_b64_tr_b16 a[174:175], v221 offset:61440
v_mfma_f32_16x16x32_bf16 a[20:23], a[168:171], v[40:43], a[20:23]
v_exp_f32 v24, v24
v_smfmac_f32_16x16x64_bf16 a[248:251], a[208:211], v[72:79], v235
buffer_load_dwordx4 v228, s[8:11], s38 offen offset:0 lds
v_mfma_f32_16x16x32_bf16 v[12:15], a[144:147], v[152:155], v[136:139]
v_exp_f32 v25, v25
v_mfma_f32_16x16x32_bf16 v[12:15], a[148:151], v[156:159], v[12:15]
ds_read_b64_tr_b16 a[168:169], v221 offset:49152
ds_read_b64_tr_b16 a[170:171], v221 offset:53248
v_mfma_f32_16x16x32_bf16 v[12:15], a[152:155], v[160:163], v[12:15]
v_exp_f32 v26, v26
v_mfma_f32_16x16x32_bf16 v[12:15], a[156:159], v[164:167], v[12:15]
ds_read_b128 a[128:131], v216 offset:0
ds_read_b128 a[132:135], v217 offset:0
v_mfma_f32_16x16x32_bf16 v[20:23], a[156:159], v[180:183], v[140:143]
v_exp_f32 v27, v27
v_mfma_f32_16x16x32_bf16 v[20:23], a[152:155], v[176:179], v[20:23]
ds_read_b128 a[136:139], v218 offset:0
v_cvt_pk_bf16_f32 v93, v18, v19
v_mfma_f32_16x16x32_bf16 v[20:23], a[148:151], v[172:175], v[20:23]
v_exp_f32 v32, v32
v_mfma_f32_16x16x32_bf16 v[20:23], a[144:147], v[168:171], v[20:23]
ds_read_b128 a[140:143], v219 offset:0
v_cvt_pk_bf16_f32 v96, v24, v25
v_mfma_f32_16x16x32_bf16 v[28:31], a[144:147], v[184:187], v[144:147]
v_exp_f32 v33, v33
v_mfma_f32_16x16x32_bf16 v[28:31], a[148:151], v[188:191], v[28:31]
buffer_load_dwordx4 v229, s[8:11], s38 offen offset:1024 lds
v_mfma_f32_16x16x32_bf16 v[28:31], a[152:155], v[192:195], v[28:31]
v_exp_f32 v34, v34
v_mfma_f32_16x16x32_bf16 v[28:31], a[156:159], v[196:199], v[28:31]
v_cvt_pk_bf16_f32 v97, v26, v27
v_cvt_pk_bf16_f32 v100, v32, v33
v_mfma_f32_16x16x32_bf16 v[36:39], a[156:159], v[212:215], v[148:151]
v_exp_f32 v35, v35
v_mfma_f32_16x16x32_bf16 v[36:39], a[152:155], v[208:211], v[36:39]
ds_read_b128 a[156:159], v219 offset:4096
ds_read_b128 a[152:155], v218 offset:4096
v_mfma_f32_16x16x32_bf16 v[36:39], a[148:151], v[204:207], v[36:39]
v_exp_f32 v12, v12
v_mfma_f32_16x16x32_bf16 v[36:39], a[144:147], v[200:203], v[36:39]
s_waitcnt lgkmcnt(3)
v_exp_f32 v13, v13
v_mfma_f32_16x16x32_bf16 a[24:27], a[176:179], v[40:43], a[24:27]
ds_read_b128 a[148:151], v217 offset:4096
ds_read_b128 a[144:147], v216 offset:4096
v_mfma_f32_16x16x32_bf16 a[24:27], a[180:183], v[56:59], a[24:27]
v_exp_f32 v14, v14
v_mfma_f32_16x16x32_bf16 a[56:59], a[180:183], v[60:63], a[56:59]
v_cvt_pk_bf16_f32 v101, v34, v35
v_cvt_pk_bf16_f32 v90, v12, v13
v_mfma_f32_16x16x32_bf16 a[56:59], a[176:179], v[44:47], a[56:59]
v_exp_f32 v15, v15
v_mfma_f32_16x16x32_bf16 a[88:91], a[176:179], v[48:51], a[88:91]
v_cvt_pk_bf16_f32 v91, v14, v15
v_mul_f32 v117, v117, v125
v_mfma_f32_16x16x32_bf16 a[88:91], a[180:183], v[64:67], a[88:91]
v_exp_f32 v20, v20
v_mfma_f32_16x16x32_bf16 a[120:123], a[180:183], v[68:71], a[120:123]
buffer_load_dwordx4 v230, s[8:11], s38 offen offset:2048 lds
v_mfma_f32_16x16x32_bf16 a[120:123], a[176:179], v[52:55], a[120:123]
v_exp_f32 v21, v21
v_mfma_f32_16x16x32_bf16 a[124:127], a[184:187], v[52:55], a[124:127]
ds_read_b64_tr_b16 a[180:181], v222 offset:57344
ds_read_b64_tr_b16 a[182:183], v222 offset:61440
v_mfma_f32_16x16x32_bf16 a[124:127], a[188:191], v[68:71], a[124:127]
v_exp_f32 v22, v22
v_mfma_f32_16x16x32_bf16 a[92:95], a[188:191], v[64:67], a[92:95]
ds_read_b64_tr_b16 a[176:177], v222 offset:49152
ds_read_b64_tr_b16 a[178:179], v222 offset:53248
v_mfma_f32_16x16x32_bf16 a[92:95], a[184:187], v[48:51], a[92:95]
v_exp_f32 v23, v23
v_mfma_f32_16x16x32_bf16 a[60:63], a[184:187], v[44:47], a[60:63]
v_cvt_pk_bf16_f32 v94, v20, v21
v_cvt_pk_bf16_f32 v95, v22, v23
v_mfma_f32_16x16x32_bf16 a[60:63], a[188:191], v[60:63], a[60:63]
v_exp_f32 v28, v28
v_mfma_f32_16x16x32_bf16 a[28:31], a[188:191], v[56:59], a[28:31]
ds_read_b64_tr_b16 a[188:189], v223 offset:57344
ds_read_b64_tr_b16 a[190:191], v223 offset:61440
v_mfma_f32_16x16x32_bf16 a[28:31], a[184:187], v[40:43], a[28:31]
v_exp_f32 v29, v29
v_smfmac_f32_16x16x64_bf16 a[252:255], a[208:211], v[80:87], v235
ds_read_b64_tr_b16 a[184:185], v223 offset:49152
ds_read_b64_tr_b16 a[186:187], v223 offset:53248
v_mfma_f32_16x16x32_bf16 v[8:11], a[128:131], v[152:155], v[136:139]
v_exp_f32 v30, v30
v_mfma_f32_16x16x32_bf16 v[8:11], a[132:135], v[156:159], v[8:11]
buffer_load_dwordx4 v231, s[8:11], s38 offen offset:3072 lds
v_mfma_f32_16x16x32_bf16 v[8:11], a[136:139], v[160:163], v[8:11]
s_waitcnt lgkmcnt(6)
v_exp_f32 v31, v31
v_mfma_f32_16x16x32_bf16 v[8:11], a[140:143], v[164:167], v[8:11]
v_cvt_pk_bf16_f32 v98, v28, v29
v_cvt_pk_bf16_f32 v99, v30, v31
v_mfma_f32_16x16x32_bf16 v[16:19], a[140:143], v[180:183], v[140:143]
v_exp_f32 v36, v36
v_mfma_f32_16x16x32_bf16 v[16:19], a[136:139], v[176:179], v[16:19]
v_mul_f32 v118, v118, v126
v_mul_f32 v119, v119, v127
v_mfma_f32_16x16x32_bf16 v[16:19], a[132:135], v[172:175], v[16:19]
v_exp_f32 v37, v37
v_mfma_f32_16x16x32_bf16 v[16:19], a[128:131], v[168:171], v[16:19]
v_cvt_pk_bf16_f32 v102, v36, v37
v_cvt_pk_bf16_f32 v244, v112, v113
v_mfma_f32_16x16x32_bf16 v[24:27], a[128:131], v[184:187], v[144:147]
v_exp_f32 v38, v38
v_mfma_f32_16x16x32_bf16 v[24:27], a[132:135], v[188:191], v[24:27]
v_cvt_pk_bf16_f32 v245, v114, v115
v_cvt_pk_bf16_f32 v246, v116, v117
v_mfma_f32_16x16x32_bf16 v[24:27], a[136:139], v[192:195], v[24:27]
v_exp_f32 v39, v39
v_mfma_f32_16x16x32_bf16 v[24:27], a[140:143], v[196:199], v[24:27]
v_cvt_pk_bf16_f32 v103, v38, v39
v_cvt_pk_bf16_f32 v247, v118, v119
v_mfma_f32_16x16x32_bf16 v[32:35], a[140:143], v[212:215], v[148:151]
s_waitcnt vmcnt(16)
ds_read_b64_tr_b16 a[194:195], v128
ds_read_b64_tr_b16 a[198:199], v129
v_mfma_f32_16x16x32_bf16 v[32:35], a[136:139], v[208:211], v[32:35]
s_add_u32 s38, s38, 16384
ds_read_b64_tr_b16 a[202:203], v130
ds_read_b64_tr_b16 a[206:207], v131
v_mfma_f32_16x16x32_bf16 v[32:35], a[132:135], v[204:207], v[32:35]
ds_read_b64_tr_b16 a[214:215], v132
ds_read_b64_tr_b16 a[218:219], v133
v_mfma_f32_16x16x32_bf16 v[32:35], a[128:131], v[200:203], v[32:35]
ds_read_b64_tr_b16 a[222:223], v134
ds_read_b64_tr_b16 a[226:227], v135
v_mfma_f32_16x16x32_bf16 a[0:3], a[160:163], v[72:75], a[0:3]
s_mov_b32 s40, 6
v_exp_f32 v8, v8
v_mfma_f32_16x16x32_bf16 a[0:3], a[164:167], v[88:91], a[0:3]
s_mov_b32 s74, 0x180
buffer_load_dwordx2 v[252:253], v251, s[76:79], s42 offen sc1
v_mfma_f32_16x16x32_bf16 a[32:35], a[164:167], v[92:95], a[32:35]
s_add_u32 s52, s52, 1
v_exp_f32 v9, v9
v_mfma_f32_16x16x32_bf16 a[32:35], a[160:163], v[76:79], a[32:35]
v_cvt_pk_bf16_f32 v40, v8, v9
v_mfma_f32_16x16x32_bf16 a[64:67], a[160:163], v[80:83], a[64:67]
v_exp_f32 v10, v10
v_mfma_f32_16x16x32_bf16 a[64:67], a[164:167], v[96:99], a[64:67]
v_mfma_f32_16x16x32_bf16 a[96:99], a[164:167], v[100:103], a[96:99]
s_add_u32 s42, s42, s43
v_exp_f32 v11, v11
v_mfma_f32_16x16x32_bf16 a[96:99], a[160:163], v[84:87], a[96:99]
buffer_load_dword v255, v243, s[28:31], s45 offen
v_mfma_f32_16x16x32_bf16 a[228:231], a[232:235], v[244:247], 0
s_waitcnt lgkmcnt(2)
v_exp_f32 v16, v16
v_mfma_f32_16x16x32_bf16 v[104:107], a[192:195], v[244:247], 0
ds_read_b64_tr_b16 a[164:165], v224 offset:57344
ds_read_b64_tr_b16 a[166:167], v224 offset:61440
v_mfma_f32_16x16x32_bf16 v[108:111], a[196:199], v[244:247], 0
ds_read_b64_tr_b16 a[160:161], v224 offset:49152
ds_read_b64_tr_b16 a[162:163], v224 offset:53248
v_mfma_f32_16x16x32_bf16 v[112:115], a[200:203], v[244:247], 0
s_add_u32 s45, s45, 589824
v_exp_f32 v17, v17
v_mfma_f32_16x16x32_bf16 v[116:119], a[204:207], v[244:247], 0
global_load_dword v255, v242, s[72:73]
v_mfma_f32_16x16x32_bf16 a[100:103], a[168:171], v[84:87], a[100:103]
v_exp_f32 v18, v18
v_mfma_f32_16x16x32_bf16 a[100:103], a[172:175], v[100:103], a[100:103]
v_cvt_pk_bf16_f32 v41, v10, v11
v_cvt_pk_bf16_f32 v44, v16, v17
v_mfma_f32_16x16x32_bf16 a[68:71], a[172:175], v[96:99], a[68:71]
v_exp_f32 v19, v19
v_mfma_f32_16x16x32_bf16 a[68:71], a[168:171], v[80:83], a[68:71]
v_cvt_pk_bf16_f32 v45, v18, v19
v_mfma_f32_16x16x32_bf16 a[36:39], a[168:171], v[76:79], a[36:39]
v_exp_f32 v24, v24
v_mfma_f32_16x16x32_bf16 a[36:39], a[172:175], v[92:95], a[36:39]
buffer_load_dword v255, v0, s[24:27], s44 offen
v_mfma_f32_16x16x32_bf16 a[4:7], a[172:175], v[88:91], a[4:7]
v_exp_f32 v25, v25
v_mfma_f32_16x16x32_bf16 a[4:7], a[168:171], v[72:75], a[4:7]
ds_read_b128 a[128:131], v216 offset:8192
ds_read_b64_tr_b16 a[172:173], v225 offset:57344
v_smfmac_f32_16x16x64_bf16 a[248:251], a[208:211], v[88:95], v235
ds_read_b64_tr_b16 a[174:175], v225 offset:61440
ds_read_b128 a[132:135], v217 offset:8192
v_mfma_f32_16x16x32_bf16 v[120:123], a[212:215], v[244:247], 0
s_add_u32 s44, s44, 4096
v_exp_f32 v26, v26
v_mfma_f32_16x16x32_bf16 v[124:127], a[216:219], v[244:247], 0
s_waitcnt lgkmcnt(4)
buffer_store_dwordx4 a[228:231], v248, s[20:23], s92 offen sc0 sc1
v_mfma_f32_16x16x32_bf16 v[128:131], a[220:223], v[244:247], 0
v_exp_f32 v27, v27
v_mfma_f32_16x16x32_bf16 v[132:135], a[224:227], v[244:247], 0
ds_read_b64_tr_b16 a[168:169], v225 offset:49152
ds_read_b64_tr_b16 a[170:171], v225 offset:53248
v_mfma_f32_16x16x32_bf16 v[12:15], a[144:147], v[152:155], v[136:139]
v_exp_f32 v32, v32
v_mfma_f32_16x16x32_bf16 v[12:15], a[148:151], v[156:159], v[12:15]
ds_read_b128 a[136:139], v218 offset:8192
ds_read_b128 a[140:143], v219 offset:8192
v_mfma_f32_16x16x32_bf16 v[12:15], a[152:155], v[160:163], v[12:15]
s_add_u32 s48, s90, 0
v_exp_f32 v33, v33
v_mfma_f32_16x16x32_bf16 v[12:15], a[156:159], v[164:167], v[12:15]
buffer_store_dwordx4 v[104:107], v248, s[20:23], s48 offen sc0 sc1
v_mfma_f32_16x16x32_bf16 v[20:23], a[156:159], v[180:183], v[140:143]
v_cvt_pk_bf16_f32 v48, v24, v25
v_cvt_pk_bf16_f32 v49, v26, v27
v_mfma_f32_16x16x32_bf16 v[20:23], a[152:155], v[176:179], v[20:23]
v_exp_f32 v34, v34
v_mfma_f32_16x16x32_bf16 v[20:23], a[148:151], v[172:175], v[20:23]
v_cvt_pk_bf16_f32 v52, v32, v33
v_mfma_f32_16x16x32_bf16 v[20:23], a[144:147], v[168:171], v[20:23]
s_add_u32 s48, s90, 74240
v_exp_f32 v35, v35
v_mfma_f32_16x16x32_bf16 v[28:31], a[144:147], v[184:187], v[144:147]
buffer_store_dwordx4 v[108:111], v248, s[20:23], s48 offen sc0 sc1
v_mfma_f32_16x16x32_bf16 v[28:31], a[148:151], v[188:191], v[28:31]
v_exp_f32 v12, v12
v_mfma_f32_16x16x32_bf16 v[28:31], a[152:155], v[192:195], v[28:31]
v_cvt_pk_bf16_f32 v53, v34, v35
v_mfma_f32_16x16x32_bf16 v[28:31], a[156:159], v[196:199], v[28:31]
v_exp_f32 v13, v13
v_mfma_f32_16x16x32_bf16 v[36:39], a[156:159], v[212:215], v[148:151]
ds_read_b128 a[156:159], v219 offset:12288
v_cvt_pk_bf16_f32 v42, v12, v13
v_mfma_f32_16x16x32_bf16 v[36:39], a[152:155], v[208:211], v[36:39]
s_add_u32 s48, s90, 148480
v_exp_f32 v14, v14
v_mfma_f32_16x16x32_bf16 v[36:39], a[148:151], v[204:207], v[36:39]
buffer_store_dwordx4 v[112:115], v248, s[20:23], s48 offen sc0 sc1
v_mfma_f32_16x16x32_bf16 v[36:39], a[144:147], v[200:203], v[36:39]
ds_read_b128 a[152:155], v218 offset:12288
ds_read_b128 a[148:151], v217 offset:12288
v_mfma_f32_16x16x32_bf16 a[8:11], a[176:179], v[72:75], a[8:11]
v_exp_f32 v15, v15
v_mfma_f32_16x16x32_bf16 a[8:11], a[180:183], v[88:91], a[8:11]
ds_read_b128 a[144:147], v216 offset:12288
v_cvt_pk_bf16_f32 v43, v14, v15
v_mfma_f32_16x16x32_bf16 a[40:43], a[180:183], v[92:95], a[40:43]
s_add_u32 s48, s90, 222720
v_exp_f32 v20, v20
v_mfma_f32_16x16x32_bf16 a[40:43], a[176:179], v[76:79], a[40:43]
buffer_store_dwordx4 v[116:119], v248, s[20:23], s48 offen sc0 sc1
v_mfma_f32_16x16x32_bf16 a[72:75], a[176:179], v[80:83], a[72:75]
v_exp_f32 v21, v21
v_mfma_f32_16x16x32_bf16 a[72:75], a[180:183], v[96:99], a[72:75]
v_cvt_pk_bf16_f32 v46, v20, v21
v_mfma_f32_16x16x32_bf16 a[104:107], a[180:183], v[100:103], a[104:107]
v_exp_f32 v22, v22
v_mfma_f32_16x16x32_bf16 a[104:107], a[176:179], v[84:87], a[104:107]
ds_read_b64_tr_b16 a[180:181], v226 offset:57344
ds_read_b64_tr_b16 a[182:183], v226 offset:61440
v_mfma_f32_16x16x32_bf16 a[108:111], a[184:187], v[84:87], a[108:111]
s_add_u32 s48, s90, 296960
buffer_store_dwordx4 v[120:123], v248, s[20:23], s48 offen sc0 sc1
v_mfma_f32_16x16x32_bf16 a[108:111], a[188:191], v[100:103], a[108:111]
v_exp_f32 v23, v23
v_mfma_f32_16x16x32_bf16 a[76:79], a[188:191], v[96:99], a[76:79]
ds_read_b64_tr_b16 a[176:177], v226 offset:49152
ds_read_b64_tr_b16 a[178:179], v226 offset:53248
v_mfma_f32_16x16x32_bf16 a[76:79], a[184:187], v[80:83], a[76:79]
v_exp_f32 v28, v28
v_mfma_f32_16x16x32_bf16 a[44:47], a[184:187], v[76:79], a[44:47]
v_cvt_pk_bf16_f32 v47, v22, v23
v_mfma_f32_16x16x32_bf16 a[44:47], a[188:191], v[92:95], a[44:47]
s_add_u32 s48, s90, 371200
v_exp_f32 v29, v29
v_mfma_f32_16x16x32_bf16 a[12:15], a[188:191], v[88:91], a[12:15]
buffer_store_dwordx4 v[124:127], v248, s[20:23], s48 offen sc0 sc1
v_mfma_f32_16x16x32_bf16 a[12:15], a[184:187], v[72:75], a[12:15]
v_exp_f32 v30, v30
v_smfmac_f32_16x16x64_bf16 a[252:255], a[208:211], v[96:103], v235
s_waitcnt lgkmcnt(4)
ds_read_b64_tr_b16 a[188:189], v227 offset:57344
ds_read_b64_tr_b16 a[190:191], v227 offset:61440
v_mfma_f32_16x16x32_bf16 v[8:11], a[128:131], v[152:155], v[136:139]
v_exp_f32 v31, v31
v_mfma_f32_16x16x32_bf16 v[8:11], a[132:135], v[156:159], v[8:11]
ds_read_b64_tr_b16 a[184:185], v227 offset:49152
ds_read_b64_tr_b16 a[186:187], v227 offset:53248
v_mfma_f32_16x16x32_bf16 v[8:11], a[136:139], v[160:163], v[8:11]
s_add_u32 s48, s90, 445440
buffer_store_dwordx4 v[128:131], v248, s[20:23], s48 offen sc0 sc1
v_mfma_f32_16x16x32_bf16 v[8:11], a[140:143], v[164:167], v[8:11]
v_exp_f32 v36, v36
v_mfma_f32_16x16x32_bf16 v[16:19], a[140:143], v[180:183], v[140:143]
v_cvt_pk_bf16_f32 v50, v28, v29
v_cvt_pk_bf16_f32 v51, v30, v31
v_mfma_f32_16x16x32_bf16 v[16:19], a[136:139], v[176:179], v[16:19]
v_exp_f32 v37, v37
v_mfma_f32_16x16x32_bf16 v[16:19], a[132:135], v[172:175], v[16:19]
v_cvt_pk_bf16_f32 v54, v36, v37
v_mfma_f32_16x16x32_bf16 v[16:19], a[128:131], v[168:171], v[16:19]
s_add_u32 s48, s90, 519680
v_exp_f32 v38, v38
v_mfma_f32_16x16x32_bf16 v[24:27], a[128:131], v[184:187], v[144:147]
buffer_store_dwordx4 v[132:135], v248, s[20:23], s48 offen sc0 sc1
v_mfma_f32_16x16x32_bf16 v[24:27], a[132:135], v[188:191], v[24:27]
v_exp_f32 v39, v39
v_mfma_f32_16x16x32_bf16 v[24:27], a[136:139], v[192:195], v[24:27]
v_cvt_pk_bf16_f32 v55, v38, v39
v_mfma_f32_16x16x32_bf16 v[24:27], a[140:143], v[196:199], v[24:27]
v_mfma_f32_16x16x32_bf16 v[32:35], a[140:143], v[212:215], v[148:151]
v_mfma_f32_16x16x32_bf16 v[32:35], a[136:139], v[208:211], v[32:35]
v_mfma_f32_16x16x32_bf16 v[32:35], a[132:135], v[204:207], v[32:35]
v_mfma_f32_16x16x32_bf16 v[32:35], a[128:131], v[200:203], v[32:35]
v_mfma_f32_16x16x32_bf16 a[16:19], a[160:163], v[72:75], a[16:19]
v_exp_f32 v8, v8
v_mfma_f32_16x16x32_bf16 a[16:19], a[164:167], v[88:91], a[16:19]
v_exp_f32 v9, v9
v_mfma_f32_16x16x32_bf16 a[48:51], a[164:167], v[92:95], a[48:51]
v_cvt_pk_bf16_f32 v56, v8, v9
v_mfma_f32_16x16x32_bf16 a[48:51], a[160:163], v[76:79], a[48:51]
v_exp_f32 v10, v10
v_mfma_f32_16x16x32_bf16 a[80:83], a[160:163], v[80:83], a[80:83]
v_mfma_f32_16x16x32_bf16 a[80:83], a[164:167], v[96:99], a[80:83]
v_exp_f32 v11, v11
s_waitcnt vmcnt(13) lgkmcnt(0)
s_barrier
v_mfma_f32_16x16x32_bf16 a[112:115], a[164:167], v[100:103], a[112:115]
ds_read_b64_tr_b16 a[164:165], v220 offset:8192
ds_read_b64_tr_b16 a[166:167], v220 offset:12288
v_mfma_f32_16x16x32_bf16 a[112:115], a[160:163], v[84:87], a[112:115]
s_add_u32 m0, s37, 98304
v_exp_f32 v16, v16
v_mfma_f32_16x16x32_bf16 a[116:119], a[168:171], v[84:87], a[116:119]
buffer_load_dwordx4 v232, s[12:15], s39 offen offset:0 lds
v_mfma_f32_16x16x32_bf16 a[116:119], a[172:175], v[100:103], a[116:119]
v_exp_f32 v17, v17
v_mfma_f32_16x16x32_bf16 a[84:87], a[172:175], v[96:99], a[84:87]
ds_read_b64_tr_b16 a[160:161], v220 offset:0
ds_read_b64_tr_b16 a[162:163], v220 offset:4096
v_mfma_f32_16x16x32_bf16 a[84:87], a[168:171], v[80:83], a[84:87]
v_exp_f32 v18, v18
v_mfma_f32_16x16x32_bf16 a[52:55], a[168:171], v[76:79], a[52:55]
v_cvt_pk_bf16_f32 v57, v10, v11
v_cvt_pk_bf16_f32 v60, v16, v17
v_mfma_f32_16x16x32_bf16 a[52:55], a[172:175], v[92:95], a[52:55]
v_exp_f32 v19, v19
v_mfma_f32_16x16x32_bf16 a[20:23], a[172:175], v[88:91], a[20:23]
ds_read_b64_tr_b16 a[172:173], v221 offset:8192
ds_read_b64_tr_b16 a[174:175], v221 offset:12288
v_mfma_f32_16x16x32_bf16 a[20:23], a[168:171], v[72:75], a[20:23]
v_exp_f32 v24, v24
v_smfmac_f32_16x16x64_bf16 a[248:251], a[208:211], v[40:47], v235
buffer_load_dwordx4 v233, s[12:15], s39 offen offset:1024 lds
v_mfma_f32_16x16x32_bf16 v[12:15], a[144:147], v[152:155], v[136:139]
v_exp_f32 v25, v25
v_mfma_f32_16x16x32_bf16 v[12:15], a[148:151], v[156:159], v[12:15]
ds_read_b64_tr_b16 a[168:169], v221 offset:0
ds_read_b64_tr_b16 a[170:171], v221 offset:4096
v_mfma_f32_16x16x32_bf16 v[12:15], a[152:155], v[160:163], v[12:15]
v_exp_f32 v26, v26
v_mfma_f32_16x16x32_bf16 v[12:15], a[156:159], v[164:167], v[12:15]
ds_read_b128 a[128:131], v216 offset:49152
ds_read_b128 a[132:135], v217 offset:49152
v_mfma_f32_16x16x32_bf16 v[20:23], a[156:159], v[180:183], v[140:143]
v_exp_f32 v27, v27
v_mfma_f32_16x16x32_bf16 v[20:23], a[152:155], v[176:179], v[20:23]
ds_read_b128 a[136:139], v218 offset:49152
v_cvt_pk_bf16_f32 v61, v18, v19
v_mfma_f32_16x16x32_bf16 v[20:23], a[148:151], v[172:175], v[20:23]
v_exp_f32 v32, v32
v_mfma_f32_16x16x32_bf16 v[20:23], a[144:147], v[168:171], v[20:23]
ds_read_b128 a[140:143], v219 offset:49152
v_cvt_pk_bf16_f32 v64, v24, v25
v_mfma_f32_16x16x32_bf16 v[28:31], a[144:147], v[184:187], v[144:147]
v_exp_f32 v33, v33
v_mfma_f32_16x16x32_bf16 v[28:31], a[148:151], v[188:191], v[28:31]
buffer_load_dwordx4 v232, s[12:15], s39 offen offset:2048 lds
v_mfma_f32_16x16x32_bf16 v[28:31], a[152:155], v[192:195], v[28:31]
v_exp_f32 v34, v34
v_mfma_f32_16x16x32_bf16 v[28:31], a[156:159], v[196:199], v[28:31]
v_cvt_pk_bf16_f32 v65, v26, v27
v_cvt_pk_bf16_f32 v68, v32, v33
v_mfma_f32_16x16x32_bf16 v[36:39], a[156:159], v[212:215], v[148:151]
v_exp_f32 v35, v35
v_mfma_f32_16x16x32_bf16 v[36:39], a[152:155], v[208:211], v[36:39]
ds_read_b128 a[156:159], v219 offset:53248
ds_read_b128 a[152:155], v218 offset:53248
v_mfma_f32_16x16x32_bf16 v[36:39], a[148:151], v[204:207], v[36:39]
v_exp_f32 v12, v12
v_mfma_f32_16x16x32_bf16 v[36:39], a[144:147], v[200:203], v[36:39]
v_exp_f32 v13, v13
v_mfma_f32_16x16x32_bf16 a[24:27], a[176:179], v[72:75], a[24:27]
ds_read_b128 a[148:151], v217 offset:53248
ds_read_b128 a[144:147], v216 offset:53248
v_mfma_f32_16x16x32_bf16 a[24:27], a[180:183], v[88:91], a[24:27]
v_exp_f32 v14, v14
v_mfma_f32_16x16x32_bf16 a[56:59], a[180:183], v[92:95], a[56:59]
buffer_load_dwordx4 v233, s[12:15], s39 offen offset:3072 lds
v_mfma_f32_16x16x32_bf16 a[56:59], a[176:179], v[76:79], a[56:59]
v_exp_f32 v15, v15
v_mfma_f32_16x16x32_bf16 a[88:91], a[176:179], v[80:83], a[88:91]
v_cvt_pk_bf16_f32 v69, v34, v35
v_cvt_pk_bf16_f32 v58, v12, v13
v_mfma_f32_16x16x32_bf16 a[88:91], a[180:183], v[96:99], a[88:91]
v_exp_f32 v20, v20
v_mfma_f32_16x16x32_bf16 a[120:123], a[180:183], v[100:103], a[120:123]
ds_read_b64_tr_b16 a[180:181], v222 offset:8192
ds_read_b64_tr_b16 a[182:183], v222 offset:12288
v_mfma_f32_16x16x32_bf16 a[120:123], a[176:179], v[84:87], a[120:123]
v_exp_f32 v21, v21
v_mfma_f32_16x16x32_bf16 a[124:127], a[184:187], v[84:87], a[124:127]
ds_read_b64_tr_b16 a[176:177], v222 offset:0
ds_read_b64_tr_b16 a[178:179], v222 offset:4096
v_mfma_f32_16x16x32_bf16 a[124:127], a[188:191], v[100:103], a[124:127]
v_exp_f32 v22, v22
v_mfma_f32_16x16x32_bf16 a[92:95], a[188:191], v[96:99], a[92:95]
v_cvt_pk_bf16_f32 v59, v14, v15
v_cvt_pk_bf16_f32 v62, v20, v21
v_mfma_f32_16x16x32_bf16 a[92:95], a[184:187], v[80:83], a[92:95]
s_add_u32 s39, s39, 16384
v_exp_f32 v23, v23
v_mfma_f32_16x16x32_bf16 a[60:63], a[184:187], v[76:79], a[60:63]
s_add_u32 m0, s37, 16384
v_cvt_pk_bf16_f32 v63, v22, v23
v_mfma_f32_16x16x32_bf16 a[60:63], a[188:191], v[92:95], a[60:63]
v_exp_f32 v28, v28
v_mfma_f32_16x16x32_bf16 a[28:31], a[188:191], v[88:91], a[28:31]
buffer_load_dwordx4 v228, s[8:11], s38 offen offset:0 lds
v_mfma_f32_16x16x32_bf16 a[28:31], a[184:187], v[72:75], a[28:31]
v_exp_f32 v29, v29
v_smfmac_f32_16x16x64_bf16 a[252:255], a[208:211], v[48:55], v235
s_waitcnt lgkmcnt(2)
ds_read_b64_tr_b16 a[188:189], v223 offset:8192
ds_read_b64_tr_b16 a[190:191], v223 offset:12288
v_mfma_f32_16x16x32_bf16 v[8:11], a[128:131], v[152:155], v[136:139]
v_exp_f32 v30, v30
v_mfma_f32_16x16x32_bf16 v[8:11], a[132:135], v[156:159], v[8:11]
ds_read_b64_tr_b16 a[184:185], v223 offset:0
ds_read_b64_tr_b16 a[186:187], v223 offset:4096
v_mfma_f32_16x16x32_bf16 v[8:11], a[136:139], v[160:163], v[8:11]
v_exp_f32 v31, v31
v_mfma_f32_16x16x32_bf16 v[8:11], a[140:143], v[164:167], v[8:11]
buffer_load_dwordx4 v229, s[8:11], s38 offen offset:1024 lds
v_mfma_f32_16x16x32_bf16 v[16:19], a[140:143], v[180:183], v[140:143]
v_exp_f32 v36, v36
v_mfma_f32_16x16x32_bf16 v[16:19], a[136:139], v[176:179], v[16:19]
v_cvt_pk_bf16_f32 v66, v28, v29
v_cvt_pk_bf16_f32 v67, v30, v31
v_mfma_f32_16x16x32_bf16 v[16:19], a[132:135], v[172:175], v[16:19]
v_exp_f32 v37, v37
v_mfma_f32_16x16x32_bf16 v[16:19], a[128:131], v[168:171], v[16:19]
v_cvt_pk_bf16_f32 v70, v36, v37
v_mfma_f32_16x16x32_bf16 v[24:27], a[128:131], v[184:187], v[144:147]
v_exp_f32 v38, v38
v_mfma_f32_16x16x32_bf16 v[24:27], a[132:135], v[188:191], v[24:27]
v_mfma_f32_16x16x32_bf16 v[24:27], a[136:139], v[192:195], v[24:27]
v_exp_f32 v39, v39
v_mfma_f32_16x16x32_bf16 v[24:27], a[140:143], v[196:199], v[24:27]
v_cvt_pk_bf16_f32 v71, v38, v39
v_mfma_f32_16x16x32_bf16 v[32:35], a[140:143], v[212:215], v[148:151]
v_mfma_f32_16x16x32_bf16 v[32:35], a[136:139], v[208:211], v[32:35]
v_mfma_f32_16x16x32_bf16 v[32:35], a[132:135], v[204:207], v[32:35]
v_mfma_f32_16x16x32_bf16 v[32:35], a[128:131], v[200:203], v[32:35]
s_waitcnt lgkmcnt(6)
s_branch K_B5
K_PUB:
s_mov_b32 s78, 0x4000
v_lshlrev_b32 v251, 7, v3
s_mov_b32 s42, 0x2000
s_mov_b32 s43, 0
s_cmp_lg_u32 s32, 0
s_cbranch_scc1 K_B4
v_mov_b32 v244, 1
s_and_b32 s46, s52, 15
s_lshl_b32 s46, s46, 7
s_add_u32 s46, s46, 0x272000
s_mov_b64 exec, 1
buffer_atomic_add v244, v234, s[20:23], s46 offen sc1
s_mov_b64 exec, -1
s_branch K_B4
K_RANK:
s_mov_b32 s46, 2
K_RANK1:
v_cmp_lt_u32 vcc, s92, v255
s_bcnt1_i32_b64 s48, vcc
s_cmp_lt_u32 s48, 8
s_cbranch_scc0 K_RANK2
v_mov_b32 v246, 0
v_cmp_lt_u32 vcc, s92, v104
v_addc_co_u32 v246, vcc, 0, v246, vcc
v_cmp_lt_u32 vcc, s92, v105
v_addc_co_u32 v246, vcc, 0, v246, vcc
v_cmp_lt_u32 vcc, s92, v106
v_addc_co_u32 v246, vcc, 0, v246, vcc
v_cmp_lt_u32 vcc, s92, v107
v_addc_co_u32 v246, vcc, 0, v246, vcc
v_cmp_lt_u32 vcc, s92, v108
v_addc_co_u32 v246, vcc, 0, v246, vcc
v_cmp_lt_u32 vcc, s92, v109
v_addc_co_u32 v246, vcc, 0, v246, vcc
v_cmp_lt_u32 vcc, s92, v110
v_addc_co_u32 v246, vcc, 0, v246, vcc
v_cmp_lt_u32 vcc, s92, v111
v_addc_co_u32 v246, vcc, 0, v246, vcc
v_cmp_lt_u32 vcc, s92, v112
v_addc_co_u32 v246, vcc, 0, v246, vcc
v_cmp_lt_u32 vcc, s92, v113
v_addc_co_u32 v246, vcc, 0, v246, vcc
v_cmp_lt_u32 vcc, s92, v114
v_addc_co_u32 v246, vcc, 0, v246, vcc
v_cmp_lt_u32 vcc, s92, v115
v_addc_co_u32 v246, vcc, 0, v246, vcc
v_cmp_lt_u32 vcc, s92, v116
v_addc_co_u32 v246, vcc, 0, v246, vcc
v_cmp_lt_u32 vcc, s92, v117
v_addc_co_u32 v246, vcc, 0, v246, vcc
v_cmp_lt_u32 vcc, s92, v118
v_addc_co_u32 v246, vcc, 0, v246, vcc
v_cmp_lt_u32 vcc, s92, v119
v_addc_co_u32 v246, vcc, 0, v246, vcc
v_cmp_lt_u32 vcc, s92, v120
v_addc_co_u32 v246, vcc, 0, v246, vcc
v_cmp_lt_u32 vcc, s92, v121
v_addc_co_u32 v246, vcc, 0, v246, vcc
v_cmp_lt_u32 vcc, s92, v122
v_addc_co_u32 v246, vcc, 0, v246, vcc
v_cmp_lt_u32 vcc, s92, v123
v_addc_co_u32 v246, vcc, 0, v246, vcc
v_cmp_lt_u32 vcc, s92, v124
v_addc_co_u32 v246, vcc, 0, v246, vcc
v_cmp_lt_u32 vcc, s92, v125
v_addc_co_u32 v246, vcc, 0, v246, vcc
v_cmp_lt_u32 vcc, s92, v126
v_addc_co_u32 v246, vcc, 0, v246, vcc
v_cmp_lt_u32 vcc, s92, v127
v_addc_co_u32 v246, vcc, 0, v246, vcc
v_cmp_lt_u32 vcc, s92, v128
v_addc_co_u32 v246, vcc, 0, v246, vcc
v_cmp_lt_u32 vcc, s92, v129
v_addc_co_u32 v246, vcc, 0, v246, vcc
v_cmp_lt_u32 vcc, s92, v130
v_addc_co_u32 v246, vcc, 0, v246, vcc
v_cmp_lt_u32 vcc, s92, v131
v_addc_co_u32 v246, vcc, 0, v246, vcc
v_cmp_lt_u32 vcc, s92, v132
v_addc_co_u32 v246, vcc, 0, v246, vcc
v_cmp_lt_u32 vcc, s92, v133
v_addc_co_u32 v246, vcc, 0, v246, vcc
v_cmp_lt_u32 vcc, s92, v134
v_addc_co_u32 v246, vcc, 0, v246, vcc
v_cmp_lt_u32 vcc, s92, v135
v_addc_co_u32 v246, vcc, 0, v246, vcc
s_mov_b32 s48, 0
v_cmp_lt_u32 vcc, 0, v246
s_bcnt1_i32_b64 s47, vcc
s_add_u32 s48, s48, s47
v_cmp_lt_u32 vcc, 1, v246
s_bcnt1_i32_b64 s47, vcc
s_add_u32 s48, s48, s47
v_cmp_lt_u32 vcc, 2, v246
s_bcnt1_i32_b64 s47, vcc
s_add_u32 s48, s48, s47
v_cmp_lt_u32 vcc, 3, v246
s_bcnt1_i32_b64 s47, vcc
s_add_u32 s48, s48, s47
v_cmp_lt_u32 vcc, 4, v246
s_bcnt1_i32_b64 s47, vcc
s_add_u32 s48, s48, s47
v_cmp_lt_u32 vcc, 5, v246
s_bcnt1_i32_b64 s47, vcc
s_add_u32 s48, s48, s47
v_cmp_lt_u32 vcc, 6, v246
s_bcnt1_i32_b64 s47, vcc
s_add_u32 s48, s48, s47
v_cmp_lt_u32 vcc, 7, v246
s_bcnt1_i32_b64 s47, vcc
s_add_u32 s48, s48, s47
s_cmp_lt_u32 s48, 8
s_cbranch_scc0 K_RANK2
s_and_b32 s47, s92, 0xffff
s_sub_u32 s47, 2048, s47
s_ashr_i32 s94, s92, 31
s_not_b32 s94, s94
s_or_b32 s94, s94, 0x80000000
s_xor_b32 s94, s94, s92
s_and_b32 s94, s94, 0xffff0000
v_mov_b32 v247, s94
v_mul_f32 v247, 0xbfb8aa3b, v247
v_exp_f32 v247, v247
s_nop 0
v_add_f32 v247, 1.0, v247
v_rcp_f32 v247, v247
s_nop 0
v_cvt_pk_bf16_f32 v247, v247, v247
v_lshlrev_b32 v247, 16, v247
v_or_b32 v247, 1, v247
v_mov_b32 v246, s47
s_lshl_b32 s48, s48, 3
s_add_u32 s48, s48, 0x270000
s_mov_b64 exec, 1
buffer_store_dword v246, v234, s[20:23], s48 offen offset:4 sc0 sc1
buffer_store_dword v247, v234, s[20:23], s48 offen offset:68 sc0 sc1
s_mov_b64 exec, -1
K_RANK2:
s_mov_b32 s92, s93
s_sub_u32 s46, s46, 1
s_cmp_lg_u32 s46, 0
s_cbranch_scc1 K_RANK1
s_branch K_RANKED
K_CODE_END:
K_FB:
s_mov_b32 s41, 1
s_waitcnt vmcnt(0) lgkmcnt(0)
s_barrier
v_mov_b32 v136, 0xff800000
v_mov_b32 v140, 0xff800000
v_mov_b32 v144, 0xff800000
v_mov_b32 v148, 0xff800000
s_mov_b32 s38, 0
s_mov_b32 s40, 32
K_FBLOOP:
s_add_u32 m0, s37, 0
s_nop 0
buffer_load_dwordx4 v228, s[8:11], s38 offen offset:0 lds
buffer_load_dwordx4 v229, s[8:11], s38 offen offset:1024 lds
buffer_load_dwordx4 v230, s[8:11], s38 offen offset:2048 lds
buffer_load_dwordx4 v231, s[8:11], s38 offen offset:3072 lds
s_add_u32 s38, s38, 16384
s_waitcnt vmcnt(0)
s_barrier
ds_read_b128 a[128:131], v216 offset:0
ds_read_b128 a[132:135], v217 offset:0
ds_read_b128 a[136:139], v218 offset:0
ds_read_b128 a[140:143], v219 offset:0
ds_read_b128 a[144:147], v216 offset:4096
ds_read_b128 a[148:151], v217 offset:4096
ds_read_b128 a[152:155], v218 offset:4096
ds_read_b128 a[156:159], v219 offset:4096
s_waitcnt lgkmcnt(0)
v_mfma_f32_16x16x32_bf16 v[8:11], a[128:131], v[152:155], 0
v_mfma_f32_16x16x32_bf16 v[8:11], a[132:135], v[156:159], v[8:11]
v_mfma_f32_16x16x32_bf16 v[8:11], a[136:139], v[160:163], v[8:11]
v_mfma_f32_16x16x32_bf16 v[8:11], a[140:143], v[164:167], v[8:11]
v_mfma_f32_16x16x32_bf16 v[12:15], a[144:147], v[152:155], 0
v_mfma_f32_16x16x32_bf16 v[12:15], a[148:151], v[156:159], v[12:15]
v_mfma_f32_16x16x32_bf16 v[12:15], a[152:155], v[160:163], v[12:15]
v_mfma_f32_16x16x32_bf16 v[12:15], a[156:159], v[164:167], v[12:15]
v_mfma_f32_16x16x32_bf16 v[16:19], a[128:131], v[168:171], 0
v_mfma_f32_16x16x32_bf16 v[16:19], a[132:135], v[172:175], v[16:19]
v_mfma_f32_16x16x32_bf16 v[16:19], a[136:139], v[176:179], v[16:19]
v_mfma_f32_16x16x32_bf16 v[16:19], a[140:143], v[180:183], v[16:19]
v_mfma_f32_16x16x32_bf16 v[20:23], a[144:147], v[168:171], 0
v_mfma_f32_16x16x32_bf16 v[20:23], a[148:151], v[172:175], v[20:23]
v_mfma_f32_16x16x32_bf16 v[20:23], a[152:155], v[176:179], v[20:23]
v_mfma_f32_16x16x32_bf16 v[20:23], a[156:159], v[180:183], v[20:23]
v_mfma_f32_16x16x32_bf16 v[24:27], a[128:131], v[184:187], 0
v_mfma_f32_16x16x32_bf16 v[24:27], a[132:135], v[188:191], v[24:27]
v_mfma_f32_16x16x32_bf16 v[24:27], a[136:139], v[192:195], v[24:27]
v_mfma_f32_16x16x32_bf16 v[24:27], a[140:143], v[196:199], v[24:27]
v_mfma_f32_16x16x32_bf16 v[28:31], a[144:147], v[184:187], 0
v_mfma_f32_16x16x32_bf16 v[28:31], a[148:151], v[188:191], v[28:31]
v_mfma_f32_16x16x32_bf16 v[28:31], a[152:155], v[192:195], v[28:31]
v_mfma_f32_16x16x32_bf16 v[28:31], a[156:159], v[196:199], v[28:31]
v_mfma_f32_16x16x32_bf16 v[32:35], a[128:131], v[200:203], 0
v_mfma_f32_16x16x32_bf16 v[32:35], a[132:135], v[204:207], v[32:35]
v_mfma_f32_16x16x32_bf16 v[32:35], a[136:139], v[208:211], v[32:35]
v_mfma_f32_16x16x32_bf16 v[32:35], a[140:143], v[212:215], v[32:35]
v_mfma_f32_16x16x32_bf16 v[36:39], a[144:147], v[200:203], 0
v_mfma_f32_16x16x32_bf16 v[36:39], a[148:151], v[204:207], v[36:39]
v_mfma_f32_16x16x32_bf16 v[36:39], a[152:155], v[208:211], v[36:39]
v_mfma_f32_16x16x32_bf16 v[36:39], a[156:159], v[212:215], v[36:39]
s_nop 7
v_max3_f32 v136, v136, v8, v9
v_max3_f32 v136, v136, v10, v11
v_max3_f32 v136, v136, v12, v13
v_max3_f32 v136, v136, v14, v15
v_max3_f32 v140, v140, v16, v17
v_max3_f32 v140, v140, v18, v19
v_max3_f32 v140, v140, v20, v21
v_max3_f32 v140, v140, v22, v23
v_max3_f32 v144, v144, v24, v25
v_max3_f32 v144, v144, v26, v27
v_max3_f32 v144, v144, v28, v29
v_max3_f32 v144, v144, v30, v31
v_max3_f32 v148, v148, v32, v33
v_max3_f32 v148, v148, v34, v35
v_max3_f32 v148, v148, v36, v37
v_max3_f32 v148, v148, v38, v39
ds_read_b128 a[128:131], v216 offset:8192
ds_read_b128 a[132:135], v217 offset:8192
ds_read_b128 a[136:139], v218 offset:8192
ds_read_b128 a[140:143], v219 offset:8192
ds_read_b128 a[144:147], v216 offset:12288
ds_read_b128 a[148:151], v217 offset:12288
ds_read_b128 a[152:155], v218 offset:12288
ds_read_b128 a[156:159], v219 offset:12288
s_waitcnt lgkmcnt(0)
v_mfma_f32_16x16x32_bf16 v[8:11], a[128:131], v[152:155], 0
v_mfma_f32_16x16x32_bf16 v[8:11], a[132:135], v[156:159], v[8:11]
v_mfma_f32_16x16x32_bf16 v[8:11], a[136:139], v[160:163], v[8:11]
v_mfma_f32_16x16x32_bf16 v[8:11], a[140:143], v[164:167], v[8:11]
v_mfma_f32_16x16x32_bf16 v[12:15], a[144:147], v[152:155], 0
v_mfma_f32_16x16x32_bf16 v[12:15], a[148:151], v[156:159], v[12:15]
v_mfma_f32_16x16x32_bf16 v[12:15], a[152:155], v[160:163], v[12:15]
v_mfma_f32_16x16x32_bf16 v[12:15], a[156:159], v[164:167], v[12:15]
v_mfma_f32_16x16x32_bf16 v[16:19], a[128:131], v[168:171], 0
v_mfma_f32_16x16x32_bf16 v[16:19], a[132:135], v[172:175], v[16:19]
v_mfma_f32_16x16x32_bf16 v[16:19], a[136:139], v[176:179], v[16:19]
v_mfma_f32_16x16x32_bf16 v[16:19], a[140:143], v[180:183], v[16:19]
v_mfma_f32_16x16x32_bf16 v[20:23], a[144:147], v[168:171], 0
v_mfma_f32_16x16x32_bf16 v[20:23], a[148:151], v[172:175], v[20:23]
v_mfma_f32_16x16x32_bf16 v[20:23], a[152:155], v[176:179], v[20:23]
v_mfma_f32_16x16x32_bf16 v[20:23], a[156:159], v[180:183], v[20:23]
v_mfma_f32_16x16x32_bf16 v[24:27], a[128:131], v[184:187], 0
v_mfma_f32_16x16x32_bf16 v[24:27], a[132:135], v[188:191], v[24:27]
v_mfma_f32_16x16x32_bf16 v[24:27], a[136:139], v[192:195], v[24:27]
v_mfma_f32_16x16x32_bf16 v[24:27], a[140:143], v[196:199], v[24:27]
v_mfma_f32_16x16x32_bf16 v[28:31], a[144:147], v[184:187], 0
v_mfma_f32_16x16x32_bf16 v[28:31], a[148:151], v[188:191], v[28:31]
v_mfma_f32_16x16x32_bf16 v[28:31], a[152:155], v[192:195], v[28:31]
v_mfma_f32_16x16x32_bf16 v[28:31], a[156:159], v[196:199], v[28:31]
v_mfma_f32_16x16x32_bf16 v[32:35], a[128:131], v[200:203], 0
v_mfma_f32_16x16x32_bf16 v[32:35], a[132:135], v[204:207], v[32:35]
v_mfma_f32_16x16x32_bf16 v[32:35], a[136:139], v[208:211], v[32:35]
v_mfma_f32_16x16x32_bf16 v[32:35], a[140:143], v[212:215], v[32:35]
v_mfma_f32_16x16x32_bf16 v[36:39], a[144:147], v[200:203], 0
v_mfma_f32_16x16x32_bf16 v[36:39], a[148:151], v[204:207], v[36:39]
v_mfma_f32_16x16x32_bf16 v[36:39], a[152:155], v[208:211], v[36:39]
v_mfma_f32_16x16x32_bf16 v[36:39], a[156:159], v[212:215], v[36:39]
s_nop 7
v_max3_f32 v136, v136, v8, v9
v_max3_f32 v136, v136, v10, v11
v_max3_f32 v136, v136, v12, v13
v_max3_f32 v136, v136, v14, v15
v_max3_f32 v140, v140, v16, v17
v_max3_f32 v140, v140, v18, v19
v_max3_f32 v140, v140, v20, v21
v_max3_f32 v140, v140, v22, v23
v_max3_f32 v144, v144, v24, v25
v_max3_f32 v144, v144, v26, v27
v_max3_f32 v144, v144, v28, v29
v_max3_f32 v144, v144, v30, v31
v_max3_f32 v148, v148, v32, v33
v_max3_f32 v148, v148, v34, v35
v_max3_f32 v148, v148, v36, v37
v_max3_f32 v148, v148, v38, v39
s_barrier
s_sub_u32 s40, s40, 1
s_cmp_lg_u32 s40, 0
s_cbranch_scc1 K_FBLOOP
v_mov_b32 v137, v136
s_nop 1
v_permlane16_swap_b32 v136, v137
v_max_f32 v136, v136, v137
v_mov_b32 v137, v136
s_nop 1
v_permlane32_swap_b32 v136, v137
v_max_f32 v136, v136, v137
v_sub_f32 v139, 0, v136
v_sub_f32 v138, 0, v136
v_sub_f32 v137, 0, v136
v_sub_f32 v136, 0, v136
v_mov_b32 v141, v140
s_nop 1
v_permlane16_swap_b32 v140, v141
v_max_f32 v140, v140, v141
v_mov_b32 v141, v140
s_nop 1
v_permlane32_swap_b32 v140, v141
v_max_f32 v140, v140, v141
v_sub_f32 v143, 0, v140
v_sub_f32 v142, 0, v140
v_sub_f32 v141, 0, v140
v_sub_f32 v140, 0, v140
v_mov_b32 v145, v144
s_nop 1
v_permlane16_swap_b32 v144, v145
v_max_f32 v144, v144, v145
v_mov_b32 v145, v144
s_nop 1
v_permlane32_swap_b32 v144, v145
v_max_f32 v144, v144, v145
v_sub_f32 v147, 0, v144
v_sub_f32 v146, 0, v144
v_sub_f32 v145, 0, v144
v_sub_f32 v144, 0, v144
v_mov_b32 v149, v148
s_nop 1
v_permlane16_swap_b32 v148, v149
v_max_f32 v148, v148, v149
v_mov_b32 v149, v148
s_nop 1
v_permlane32_swap_b32 v148, v149
v_max_f32 v148, v148, v149
v_sub_f32 v151, 0, v148
v_sub_f32 v150, 0, v148
v_sub_f32 v149, 0, v148
v_sub_f32 v148, 0, v148
s_mov_b32 s38, 0
s_add_u32 m0, s37, 32768
s_nop 0
buffer_load_dwordx4 v228, s[8:11], s38 offen offset:0 lds
buffer_load_dwordx4 v229, s[8:11], s38 offen offset:1024 lds
buffer_load_dwordx4 v230, s[8:11], s38 offen offset:2048 lds
buffer_load_dwordx4 v231, s[8:11], s38 offen offset:3072 lds
s_add_u32 s38, s38, 16384
s_add_u32 m0, s37, 16384
s_nop 0
buffer_load_dwordx4 v228, s[8:11], s38 offen offset:0 lds
buffer_load_dwordx4 v229, s[8:11], s38 offen offset:1024 lds
buffer_load_dwordx4 v230, s[8:11], s38 offen offset:2048 lds
buffer_load_dwordx4 v231, s[8:11], s38 offen offset:3072 lds
s_add_u32 s38, s38, 16384
s_add_u32 m0, s37, 0
s_nop 0
buffer_load_dwordx4 v228, s[8:11], s38 offen offset:0 lds
buffer_load_dwordx4 v229, s[8:11], s38 offen offset:1024 lds
buffer_load_dwordx4 v230, s[8:11], s38 offen offset:2048 lds
buffer_load_dwordx4 v231, s[8:11], s38 offen offset:3072 lds
s_add_u32 s38, s38, 16384
s_mov_b32 s39, 0
s_add_u32 m0, s37, 98304
s_nop 0
buffer_load_dwordx4 v232, s[12:15], s39 offen offset:0 lds
buffer_load_dwordx4 v233, s[12:15], s39 offen offset:1024 lds
buffer_load_dwordx4 v232, s[12:15], s39 offen offset:2048 lds
buffer_load_dwordx4 v233, s[12:15], s39 offen offset:3072 lds
s_add_u32 s39, s39, 16384
s_add_u32 m0, s37, 114688
s_nop 0
buffer_load_dwordx4 v232, s[12:15], s39 offen offset:0 lds
buffer_load_dwordx4 v233, s[12:15], s39 offen offset:1024 lds
buffer_load_dwordx4 v232, s[12:15], s39 offen offset:2048 lds
buffer_load_dwordx4 v233, s[12:15], s39 offen offset:3072 lds
s_add_u32 s39, s39, 16384
s_mov_b32 s78, 0
s_mov_b32 s42, 0
s_mov_b32 s43, 0
s_mov_b32 s44, 0x100000
s_mov_b32 s74, 0x100
s_mov_b32 s97, 0
s_mov_b32 s40, 0
v_accvgpr_write_b32 a0, 0
v_accvgpr_write_b32 a1, 0
v_accvgpr_write_b32 a2, 0
v_accvgpr_write_b32 a3, 0
v_accvgpr_write_b32 a4, 0
v_accvgpr_write_b32 a5, 0
v_accvgpr_write_b32 a6, 0
v_accvgpr_write_b32 a7, 0
v_accvgpr_write_b32 a8, 0
v_accvgpr_write_b32 a9, 0
v_accvgpr_write_b32 a10, 0
v_accvgpr_write_b32 a11, 0
v_accvgpr_write_b32 a12, 0
v_accvgpr_write_b32 a13, 0
v_accvgpr_write_b32 a14, 0
v_accvgpr_write_b32 a15, 0
v_accvgpr_write_b32 a16, 0
v_accvgpr_write_b32 a17, 0
v_accvgpr_write_b32 a18, 0
v_accvgpr_write_b32 a19, 0
v_accvgpr_write_b32 a20, 0
v_accvgpr_write_b32 a21, 0
v_accvgpr_write_b32 a22, 0
v_accvgpr_write_b32 a23, 0
v_accvgpr_write_b32 a24, 0
v_accvgpr_write_b32 a25, 0
v_accvgpr_write_b32 a26, 0
v_accvgpr_write_b32 a27, 0
v_accvgpr_write_b32 a28, 0
v_accvgpr_write_b32 a29, 0
v_accvgpr_write_b32 a30, 0
v_accvgpr_write_b32 a31, 0
v_accvgpr_write_b32 a32, 0
v_accvgpr_write_b32 a33, 0
v_accvgpr_write_b32 a34, 0
v_accvgpr_write_b32 a35, 0
v_accvgpr_write_b32 a36, 0
v_accvgpr_write_b32 a37, 0
v_accvgpr_write_b32 a38, 0
v_accvgpr_write_b32 a39, 0
v_accvgpr_write_b32 a40, 0
v_accvgpr_write_b32 a41, 0
v_accvgpr_write_b32 a42, 0
v_accvgpr_write_b32 a43, 0
v_accvgpr_write_b32 a44, 0
v_accvgpr_write_b32 a45, 0
v_accvgpr_write_b32 a46, 0
v_accvgpr_write_b32 a47, 0
v_accvgpr_write_b32 a48, 0
v_accvgpr_write_b32 a49, 0
v_accvgpr_write_b32 a50, 0
v_accvgpr_write_b32 a51, 0
v_accvgpr_write_b32 a52, 0
v_accvgpr_write_b32 a53, 0
v_accvgpr_write_b32 a54, 0
v_accvgpr_write_b32 a55, 0
v_accvgpr_write_b32 a56, 0
v_accvgpr_write_b32 a57, 0
v_accvgpr_write_b32 a58, 0
v_accvgpr_write_b32 a59, 0
v_accvgpr_write_b32 a60, 0
v_accvgpr_write_b32 a61, 0
v_accvgpr_write_b32 a62, 0
v_accvgpr_write_b32 a63, 0
v_accvgpr_write_b32 a64, 0
v_accvgpr_write_b32 a65, 0
v_accvgpr_write_b32 a66, 0
v_accvgpr_write_b32 a67, 0
v_accvgpr_write_b32 a68, 0
v_accvgpr_write_b32 a69, 0
v_accvgpr_write_b32 a70, 0
v_accvgpr_write_b32 a71, 0
v_accvgpr_write_b32 a72, 0
v_accvgpr_write_b32 a73, 0
v_accvgpr_write_b32 a74, 0
v_accvgpr_write_b32 a75, 0
v_accvgpr_write_b32 a76, 0
v_accvgpr_write_b32 a77, 0
v_accvgpr_write_b32 a78, 0
v_accvgpr_write_b32 a79, 0
v_accvgpr_write_b32 a80, 0
v_accvgpr_write_b32 a81, 0
v_accvgpr_write_b32 a82, 0
v_accvgpr_write_b32 a83, 0
v_accvgpr_write_b32 a84, 0
v_accvgpr_write_b32 a85, 0
v_accvgpr_write_b32 a86, 0
v_accvgpr_write_b32 a87, 0
v_accvgpr_write_b32 a88, 0
v_accvgpr_write_b32 a89, 0
v_accvgpr_write_b32 a90, 0
v_accvgpr_write_b32 a91, 0
v_accvgpr_write_b32 a92, 0
v_accvgpr_write_b32 a93, 0
v_accvgpr_write_b32 a94, 0
v_accvgpr_write_b32 a95, 0
v_accvgpr_write_b32 a96, 0
v_accvgpr_write_b32 a97, 0
v_accvgpr_write_b32 a98, 0
v_accvgpr_write_b32 a99, 0
v_accvgpr_write_b32 a100, 0
v_accvgpr_write_b32 a101, 0
v_accvgpr_write_b32 a102, 0
v_accvgpr_write_b32 a103, 0
v_accvgpr_write_b32 a104, 0
v_accvgpr_write_b32 a105, 0
v_accvgpr_write_b32 a106, 0
v_accvgpr_write_b32 a107, 0
v_accvgpr_write_b32 a108, 0
v_accvgpr_write_b32 a109, 0
v_accvgpr_write_b32 a110, 0
v_accvgpr_write_b32 a111, 0
v_accvgpr_write_b32 a112, 0
v_accvgpr_write_b32 a113, 0
v_accvgpr_write_b32 a114, 0
v_accvgpr_write_b32 a115, 0
v_accvgpr_write_b32 a116, 0
v_accvgpr_write_b32 a117, 0
v_accvgpr_write_b32 a118, 0
v_accvgpr_write_b32 a119, 0
v_accvgpr_write_b32 a120, 0
v_accvgpr_write_b32 a121, 0
v_accvgpr_write_b32 a122, 0
v_accvgpr_write_b32 a123, 0
v_accvgpr_write_b32 a124, 0
v_accvgpr_write_b32 a125, 0
v_accvgpr_write_b32 a126, 0
v_accvgpr_write_b32 a127, 0
v_accvgpr_write_b32 a248, 0
v_accvgpr_write_b32 a249, 0
v_accvgpr_write_b32 a250, 0
v_accvgpr_write_b32 a251, 0
v_accvgpr_write_b32 a252, 0
v_accvgpr_write_b32 a253, 0
v_accvgpr_write_b32 a254, 0
v_accvgpr_write_b32 a255, 0
s_waitcnt vmcnt(0)
s_barrier
ds_read_b128 a[128:131], v216 offset:32768
ds_read_b128 a[132:135], v217 offset:32768
ds_read_b128 a[136:139], v218 offset:32768
ds_read_b128 a[140:143], v219 offset:32768
ds_read_b128 a[144:147], v216 offset:36864
ds_read_b128 a[148:151], v217 offset:36864
ds_read_b128 a[152:155], v218 offset:36864
ds_read_b128 a[156:159], v219 offset:36864
s_waitcnt lgkmcnt(0)
v_mfma_f32_16x16x32_bf16 v[8:11], a[128:131], v[152:155], 0
v_mfma_f32_16x16x32_bf16 v[8:11], a[132:135], v[156:159], v[8:11]
v_mfma_f32_16x16x32_bf16 v[8:11], a[136:139], v[160:163], v[8:11]
v_mfma_f32_16x16x32_bf16 v[8:11], a[140:143], v[164:167], v[8:11]
v_mfma_f32_16x16x32_bf16 v[16:19], a[128:131], v[168:171], 0
v_mfma_f32_16x16x32_bf16 v[16:19], a[132:135], v[172:175], v[16:19]
v_mfma_f32_16x16x32_bf16 v[16:19], a[136:139], v[176:179], v[16:19]
v_mfma_f32_16x16x32_bf16 v[16:19], a[140:143], v[180:183], v[16:19]
v_mfma_f32_16x16x32_bf16 v[24:27], a[128:131], v[184:187], 0
v_mfma_f32_16x16x32_bf16 v[24:27], a[132:135], v[188:191], v[24:27]
v_mfma_f32_16x16x32_bf16 v[24:27], a[136:139], v[192:195], v[24:27]
v_mfma_f32_16x16x32_bf16 v[24:27], a[140:143], v[196:199], v[24:27]
v_mfma_f32_16x16x32_bf16 v[32:35], a[128:131], v[200:203], 0
v_mfma_f32_16x16x32_bf16 v[32:35], a[132:135], v[204:207], v[32:35]
v_mfma_f32_16x16x32_bf16 v[32:35], a[136:139], v[208:211], v[32:35]
v_mfma_f32_16x16x32_bf16 v[32:35], a[140:143], v[212:215], v[32:35]
s_nop 7
s_branch K_HAVEMAX
.section .rodata,"a"
.p2align 6
.amdhsa_kernel recurrent_scan__gqa_block_cached__moe_arch_mod__prompt_kernel
  .amdhsa_next_free_vgpr 512
  .amdhsa_next_free_sgpr 102
  .amdhsa_accum_offset 256
  .amdhsa_group_segment_fixed_size 0
  .amdhsa_kernarg_size 104
  .amdhsa_user_sgpr_count 2
  .amdhsa_user_sgpr_kernarg_segment_ptr 1
  .amdhsa_system_sgpr_workgroup_id_x 1
  .amdhsa_float_denorm_mode_32 3
.end_amdhsa_kernel
```
